```python
import torch

def _softmax(x, axis=-1):
    return torch.softmax(x, dim=axis)
def _gelu(x):
    return torch.nn.functional.gelu(x, approximate="tanh")
def _silu(x):
    return torch.nn.functional.silu(x)
def _sigmoid(x):
    return torch.sigmoid(x)
def _layernorm(x, axis=-1, eps=1e-5):
    m = x.mean(dim=axis, keepdim=True)
    v = x.var(dim=axis, keepdim=True, unbiased=False)
    return (x - m) / torch.sqrt(v + eps)
def _scatter_add(tgt, idx, src, axis=0):
    return tgt.clone().index_add_(axis, idx, src)
def _segment_sum(src, seg, n):
    out = torch.zeros((n,) + src.shape[1:], dtype=src.dtype)
    return out.index_add_(0, seg, src)
def _pad(x, pw):
    flat = tuple(v for pair in reversed(pw) for v in pair)
    return torch.nn.functional.pad(x, flat)

kernel_name = 'recurrent_scan__ssm_conv_s4__moe_arch_mod__prompt'

def setup_inputs():

    _w = (lambda a: (lambda t: t.to(torch.bfloat16) if t.is_floating_point() else t)(torch.as_tensor(a)))
    def _A_setup():
        B, L, D, N = 1, 2048, 576, 128
        A_re = -(lambda _x: torch.exp(torch.as_tensor(_x)))((lambda *s: torch.randn(*s, dtype=torch.bfloat16) * 6.4)(D, N))
        A_im = torch.pi * (lambda *s: torch.randn(*s, dtype=torch.bfloat16) * 0.05)(D, N)
        B_re = (lambda *s: torch.randn(*s, dtype=torch.bfloat16) * 0.1)(D, N)
        B_im = (lambda *s: torch.randn(*s, dtype=torch.bfloat16) * 0.1)(D, N)
        C_re = (lambda *s: torch.randn(*s, dtype=torch.bfloat16) * 0.1)(D, N)
        C_im = (lambda *s: torch.randn(*s, dtype=torch.bfloat16) * 0.1)(D, N)
        log_dt = (lambda *s: torch.randn(*s, dtype=torch.bfloat16) * 0.05)(D) * 0.5 - 4.0
        Dskip = (lambda *s: torch.randn(*s, dtype=torch.bfloat16) * 0.05)(D)
        return {
            "u": _w((lambda *s: torch.randn(*s, dtype=torch.bfloat16) * 0.05)(B, L, D)),
            "A_re": _w(A_re),
            "A_im": _w(A_im),
            "B_re": _w(B_re),
            "B_im": _w(B_im),
            "C_re": _w(C_re),
            "C_im": _w(C_im),
            "log_dt": _w(log_dt),
            "Dskip": _w(Dskip),
        }
    _A_in = _A_setup()

    def _B_setup():
        B, S, D, F, C = 1, 2048, 576, 4608, 8
        return {
            "x": _w((lambda *s: torch.randn(*s, dtype=torch.bfloat16) * 0.05)(B, S, D)),
            "w_r": _w((lambda *s: torch.randn(*s, dtype=torch.bfloat16) * 0.05)(D)),
            "w_gate": _w((lambda *s: torch.randn(*s, dtype=torch.bfloat16) * 0.05)(D, F)),
            "w_up": _w((lambda *s: torch.randn(*s, dtype=torch.bfloat16) * 0.05)(D, F)),
            "w_down": _w((lambda *s: torch.randn(*s, dtype=torch.bfloat16) * 0.05)(F, D)),
        }
    _B_in = _B_setup()

    return {
        "A_u": _A_in["u"],
        "A_A_re": _A_in["A_re"],
        "A_A_im": _A_in["A_im"],
        "A_B_re": _A_in["B_re"],
        "A_B_im": _A_in["B_im"],
        "A_C_re": _A_in["C_re"],
        "A_C_im": _A_in["C_im"],
        "A_log_dt": _A_in["log_dt"],
        "A_Dskip": _A_in["Dskip"],
        "B_x": _B_in["x"],
        "B_w_r": _B_in["w_r"],
        "B_w_gate": _B_in["w_gate"],
        "B_w_up": _B_in["w_up"],
        "B_w_down": _B_in["w_down"],
    }

def reference(A_u, A_A_re, A_A_im, A_B_re, A_B_im, A_C_re, A_C_im, A_log_dt, A_Dskip, B_x, B_w_r, B_w_gate, B_w_up, B_w_down):
    def _A_ref(u, A_re, A_im, B_re, B_im, C_re, C_im, log_dt, Dskip):
        Bsz, L, D = u.shape
        dt = torch.exp(log_dt)[:, None]
        A = A_re + 1j * A_im
        Bc = B_re + 1j * B_im
        Cc = C_re + 1j * C_im
        logdA = dt * A
        dB = dt * Bc
        l = (lambda x, dt: x.to(dt))(torch.arange(L), A_re.dtype)
        P = torch.exp(logdA[:, :, None] * l[None, None, :])
        K = torch.einsum("dn,dnl,dn->dl", Cc, P, dB).real
        L2 = 2 * L
        Kp = _pad(K, ((0, 0), (0, L)))
        up = (lambda x, *d: x.permute(*d))(u, 0, 2, 1)
        up = _pad(up, ((0, 0), (0, 0), (0, L)))
        Kf = (lambda x, axes=(-2,-1): torch.fft.rfft2(x.float(), dim=axes))(Kp[:, None, :], axes=(-2, -1))
        Uf = (lambda x, axes=(-2,-1): torch.fft.rfft2(x.float(), dim=axes))(up[:, :, None, :], axes=(-2, -1))
        Yf = Uf * Kf[None, :, :, :]
        y = (lambda x, s, axes=(-2,-1): torch.fft.irfft2(x, s=s, dim=axes).to(torch.bfloat16))(Yf, (1, L2), axes=(-2, -1))[:, :, 0, :L]
        y = (lambda x, *d: x.permute(*d))(y, 0, 2, 1) + u * Dskip[None, None, :]
        return y

    def _B_ref(x, w_r, w_gate, w_up, w_down):
        B, S, D = x.shape
        C = 8
        r = x @ w_r
        idx = torch.argsort(-r, axis=-1)[:, :C]
        idx_e = (lambda x, n, axis: torch.repeat_interleave(x, n, dim=axis))(idx.reshape(B, C, 1), D, axis=2)
        x_sel = (lambda x, i, axis: torch.take_along_dim(x, i, dim=axis))(x, idx_e, axis=1)
        g = _silu(x_sel @ w_gate)
        u = x_sel @ w_up
        y = (g * u) @ w_down
        r_sel = _sigmoid((lambda x, i, axis: torch.take_along_dim(x, i, dim=axis))(r, idx, axis=1))
        y = y * r_sel.reshape(B, C, 1)
        b_off = (torch.arange(B) * S).reshape(B, 1)
        flat_idx = (idx + b_off).reshape(B * C)
        zero = (x * 0.0).reshape(B * S, D)
        upd = _scatter_add(zero, flat_idx, y.reshape(B * C, D), axis=0)
        return x + upd.reshape(B, S, D)

    x = A_u
    xn = _layernorm(x, axis=-1)
    s = _A_ref(xn, A_A_re, A_A_im, A_B_re, A_B_im, A_C_re, A_C_im, A_log_dt, A_Dskip)
    g = _silu(_B_ref(xn, B_w_r, B_w_gate, B_w_up, B_w_down))
    return x + s * g
```

```asm
; @launch kernel=ln_kernel grid=(256,1,1) block=(512,1,1) lds=256
; @launch kernel=ffn_kernel grid=(72,1,1) block=(512,1,1) lds=157840
; @launch kernel=conv_kernel grid=(144,1,1) block=(512,1,1) lds=143360
.amdgcn_target "amdgcn-amd-amdhsa--gfx950"
.text
.globl ln_kernel
.p2align 8
.type ln_kernel,@function
ln_kernel:
    s_load_dwordx2 s[4:5], s[0:1], 0
    s_load_dwordx2 s[6:7], s[0:1], 80
    s_load_dwordx2 s[8:9], s[0:1], 128
    s_cmp_ge_u32 s2, 256
    s_cbranch_scc1 ln_end
    v_lshrrev_b32 v1, 6, v0
    v_and_b32 v2, 63, v0
    v_readfirstlane_b32 s10, v1
    s_mul_i32 s11, s2, 9216
    v_lshlrev_b32 v3, 4, v2
    v_lshlrev_b32 v4, 1, v2
    v_mul_u32_u24 v5, 1152, v1
    v_add3_u32 v6, v5, v3, s11
    v_add3_u32 v7, v5, v4, s11
    v_and_b32 v8, 7, v0
    v_mul_u32_u24 v9, 1152, v8
    v_and_b32 v10, 0x1f8, v0
    v_add3_u32 v9, v9, v10, s11
    s_mov_b32 s12, 0x3f803f80
    s_mov_b32 s13, 0
    s_mov_b32 s14, 0xffff
    s_waitcnt lgkmcnt(0)
    global_load_dwordx4 v[12:15], v6, s[4:5]
    global_load_ushort v16, v7, s[4:5] offset:1024
    global_load_dwordx4 v[20:23], v3, s[6:7]
    global_load_ushort v24, v4, s[6:7] offset:1024
    s_cmp_ge_u32 s10, 2
    s_cbranch_scc1 ln_no2
    global_load_dwordx2 v[36:37], v9, s[4:5] offset:1024
ln_no2:
    global_load_dwordx2 v[28:29], v9, s[4:5]
    global_load_dwordx2 v[32:33], v9, s[4:5] offset:512
    v_mov_b32 v40, 0
    v_mov_b32 v41, 0
    v_mov_b32 v42, 0
    v_mov_b32 v43, 0
    v_lshlrev_b32 v11, 12, v10
    v_lshlrev_b32 v8, 4, v8
    s_lshl_b32 s15, s2, 7
    s_add_u32 s15, s15, 2097152
    v_add3_u32 v11, v11, v8, s15
    v_lshlrev_b32 v5, 4, v1
    s_waitcnt vmcnt(2)
    v_dot2c_f32_bf16 v40, s12, v12
    v_dot2c_f32_bf16 v41, v12, v12
    v_dot2c_f32_bf16 v42, v12, v20
    v_dot2c_f32_bf16 v43, s12, v20
    v_dot2c_f32_bf16 v40, s12, v13
    v_dot2c_f32_bf16 v41, v13, v13
    v_dot2c_f32_bf16 v42, v13, v21
    v_dot2c_f32_bf16 v43, s12, v21
    v_dot2c_f32_bf16 v40, s12, v14
    v_dot2c_f32_bf16 v41, v14, v14
    v_dot2c_f32_bf16 v42, v14, v22
    v_dot2c_f32_bf16 v43, s12, v22
    v_dot2c_f32_bf16 v40, s12, v15
    v_dot2c_f32_bf16 v41, v15, v15
    v_dot2c_f32_bf16 v42, v15, v23
    v_dot2c_f32_bf16 v43, s12, v23
    v_dot2c_f32_bf16 v40, s12, v16
    v_dot2c_f32_bf16 v41, v16, v16
    v_dot2c_f32_bf16 v42, v16, v24
    v_dot2c_f32_bf16 v43, s12, v24
    v_add_f32_dpp v40, v40, v40 row_shr:1 row_mask:0xf bank_mask:0xf
    v_add_f32_dpp v41, v41, v41 row_shr:1 row_mask:0xf bank_mask:0xf
    v_add_f32_dpp v42, v42, v42 row_shr:1 row_mask:0xf bank_mask:0xf
    v_add_f32_dpp v43, v43, v43 row_shr:1 row_mask:0xf bank_mask:0xf
    v_add_f32_dpp v40, v40, v40 row_shr:2 row_mask:0xf bank_mask:0xf
    v_add_f32_dpp v41, v41, v41 row_shr:2 row_mask:0xf bank_mask:0xf
    v_add_f32_dpp v42, v42, v42 row_shr:2 row_mask:0xf bank_mask:0xf
    v_add_f32_dpp v43, v43, v43 row_shr:2 row_mask:0xf bank_mask:0xf
    v_add_f32_dpp v40, v40, v40 row_shr:4 row_mask:0xf bank_mask:0xf
    v_add_f32_dpp v41, v41, v41 row_shr:4 row_mask:0xf bank_mask:0xf
    v_add_f32_dpp v42, v42, v42 row_shr:4 row_mask:0xf bank_mask:0xf
    v_add_f32_dpp v43, v43, v43 row_shr:4 row_mask:0xf bank_mask:0xf
    v_add_f32_dpp v40, v40, v40 row_shr:8 row_mask:0xf bank_mask:0xf
    v_add_f32_dpp v41, v41, v41 row_shr:8 row_mask:0xf bank_mask:0xf
    v_add_f32_dpp v42, v42, v42 row_shr:8 row_mask:0xf bank_mask:0xf
    v_add_f32_dpp v43, v43, v43 row_shr:8 row_mask:0xf bank_mask:0xf
    v_add_f32_dpp v40, v40, v40 row_bcast:15 row_mask:0xa bank_mask:0xf
    v_add_f32_dpp v41, v41, v41 row_bcast:15 row_mask:0xa bank_mask:0xf
    v_add_f32_dpp v42, v42, v42 row_bcast:15 row_mask:0xa bank_mask:0xf
    v_add_f32_dpp v43, v43, v43 row_bcast:15 row_mask:0xa bank_mask:0xf
    v_add_f32_dpp v40, v40, v40 row_bcast:31 row_mask:0xc bank_mask:0xf
    v_add_f32_dpp v41, v41, v41 row_bcast:31 row_mask:0xc bank_mask:0xf
    v_add_f32_dpp v42, v42, v42 row_bcast:31 row_mask:0xc bank_mask:0xf
    v_add_f32_dpp v43, v43, v43 row_bcast:31 row_mask:0xc bank_mask:0xf
    v_mul_f32 v40, 0x3ae38e39, v40
    v_mul_f32 v41, 0x3ae38e39, v41
    v_fma_f32 v41, -v40, v40, v41
    v_max_f32 v41, 0, v41
    v_cvt_pk_bf16_f32 v44, v40, v41
    v_and_b32 v41, 0xffff0000, v44
    v_add_f32 v41, 0x3727c5ac, v41
    v_cvt_pk_bf16_f32 v41, v41, v41
    v_lshlrev_b32 v41, 16, v41
    v_sqrt_f32 v41, v41
    v_lshlrev_b32 v49, 16, v44
    v_cvt_pk_bf16_f32 v45, v41, v41
    v_lshlrev_b32 v41, 16, v45
    v_rcp_f32 v48, v41
    v_fma_f32 v42, -v49, v43, v42
    v_bfi_b32 v50, s14, v44, v45
    v_mul_f32 v42, v42, v48
    v_cvt_pk_bf16_f32 v42, v42, v42
    v_ashrrev_i32 v43, 31, v42
    v_or_b32 v43, 0x80000000, v43
    v_xor_b32 v42, v42, v43
    v_and_b32 v42, 0xffff0000, v42
    v_or_b32 v51, s13, v42
    v_or_b32 v49, s13, v49
    s_mov_b32 exec_lo, 0
    s_mov_b32 exec_hi, 0x80000000
    ds_write_b128 v5, v[48:51]
    s_mov_b64 exec, -1
    s_waitcnt lgkmcnt(0)
    s_barrier
    ds_read_b64 v[30:31], v8
    ds_read_b64 v[34:35], v8
    ds_read_b64 v[38:39], v8
    ds_read_b64 v[40:41], v8 offset:8
    v_add_u32 v12, 0x200000, v11
    v_add_u32 v13, 0x400000, v11
    s_waitcnt vmcnt(0) lgkmcnt(0)
    s_cmp_lg_u32 s10, 7
    s_cbranch_scc1 ln_nostat
    s_lshl_b32 s15, s2, 6
    v_lshrrev_b32 v14, 1, v8
    v_add_u32 v14, s15, v14
    s_mov_b64 exec, 0xff
    global_store_dwordx2 v14, v[40:41], s[8:9] offset:0
    s_mov_b64 exec, -1
ln_nostat:
    global_store_dwordx4 v11, v[28:31], s[8:9]
    global_store_dwordx4 v12, v[32:35], s[8:9]
    s_cmp_ge_u32 s10, 2
    s_cbranch_scc1 ln_end
    global_store_dwordx4 v13, v[36:39], s[8:9]
ln_end:
    s_endpgm
.text
.globl ffn_kernel
.p2align 8
.type ffn_kernel,@function
ffn_kernel:
    s_load_dwordx2 s[4:5], s[0:1], 0
    s_load_dwordx4 s[16:19], s[0:1], 88
    s_load_dwordx2 s[20:21], s[0:1], 104
    s_load_dwordx2 s[8:9], s[0:1], 128
    s_cmp_ge_u32 s2, 72
    s_cbranch_scc1 ffn_end
    v_lshrrev_b32 v1, 6, v0
    v_and_b32 v2, 63, v0
    v_readfirstlane_b32 s10, v1
    v_lshrrev_b32 v3, 3, v0
    v_bfe_u32 v4, v0, 4, 1
    v_bfe_u32 v5, v0, 6, 1
    v_lshl_add_u32 v4, v5, 1, v4
    v_lshlrev_b32 v4, 1, v4
    v_and_b32 v6, 7, v0
    v_xor_b32 v4, v4, v6
    v_mul_u32_u24 v5, 9216, v3
    v_lshlrev_b32 v4, 4, v4
    s_lshl_b32 s11, s2, 7
    v_add3_u32 v4, v4, v5, s11
    v_mul_u32_u24 v5, 1152, v3
    v_lshlrev_b32 v6, 4, v6
    s_mul_i32 s12, s2, 73728
    v_add3_u32 v5, v5, v6, s12
    v_mul_u32_u24 v7, 1184, v3
    v_add_u32 v7, v7, v6
    v_lshlrev_b32 v8, 5, v0
    s_lshl_b32 s13, s10, 10
    s_mov_b32 s14, 0
    s_waitcnt lgkmcnt(0)
    global_load_dwordx4 v[12:15], v8, s[8:9] offset:0
    global_load_dwordx4 v[16:19], v8, s[8:9] offset:16
ffn_dma:
    s_mov_b32 m0, s13
    s_add_u32 s15, s13, 73728
    global_load_lds_dwordx4 v4, s[16:17]
    s_mov_b32 m0, s15
    s_add_u32 s13, s13, 8192
    global_load_lds_dwordx4 v4, s[18:19]
    v_add_u32 v4, 589824, v4
    s_add_u32 s14, s14, 1
    s_cmp_lt_u32 s14, 9
    s_cbranch_scc1 ffn_dma
    global_load_dwordx4 v[40:43], v5, s[20:21] offset:0
    global_load_dwordx4 v[44:47], v5, s[20:21] offset:128
    global_load_dwordx4 v[48:51], v5, s[20:21] offset:256
    global_load_dwordx4 v[52:55], v5, s[20:21] offset:384
    global_load_dwordx4 v[56:59], v5, s[20:21] offset:512
    global_load_dwordx4 v[60:63], v5, s[20:21] offset:640
    global_load_dwordx4 v[64:67], v5, s[20:21] offset:768
    global_load_dwordx4 v[68:71], v5, s[20:21] offset:896
    global_load_dwordx4 v[72:75], v5, s[20:21] offset:1024
    v_mov_b32 v20, 0
    v_mov_b32 v21, 0
    v_mov_b32 v22, 0
    v_mov_b32 v23, 0
    v_lshlrev_b32 v9, 4, v0
    s_mov_b32 s22, 147456
    v_add_u32 v9, s22, v9
    ds_write_b128 v9, v[20:23]
    ds_write_b128 v9, v[20:23] offset:144
    v_lshlrev_b32 v10, 2, v0
    v_sub_u32 v10, 2047, v10
    s_waitcnt vmcnt(27)
    v_lshrrev_b32 v13, 16, v13
    v_lshrrev_b32 v15, 16, v15
    v_lshrrev_b32 v17, 16, v17
    v_lshrrev_b32 v19, 16, v19
    v_lshl_add_u32 v13, v13, 11, v10
    v_lshl_add_u32 v15, v15, 11, v10
    v_lshl_add_u32 v17, v17, 11, v10
    v_lshl_add_u32 v19, v19, 11, v10
    v_subrev_u32 v15, 1, v15
    v_subrev_u32 v17, 2, v17
    v_subrev_u32 v19, 3, v19
    v_max_u32 v24, v13, v15
    v_max3_u32 v24, v24, v17, v19
    s_nop 1
    v_max_u32_dpp v24, v24, v24 row_shr:1 row_mask:0xf bank_mask:0xf
    s_nop 1
    v_max_u32_dpp v24, v24, v24 row_shr:2 row_mask:0xf bank_mask:0xf
    s_nop 1
    v_max_u32_dpp v24, v24, v24 row_shr:4 row_mask:0xf bank_mask:0xf
    s_nop 1
    v_max_u32_dpp v24, v24, v24 row_shr:8 row_mask:0xf bank_mask:0xf
    s_nop 1
    v_max_u32_dpp v24, v24, v24 row_bcast:15 row_mask:0xa bank_mask:0xf
    s_nop 1
    v_max_u32_dpp v24, v24, v24 row_bcast:31 row_mask:0xc bank_mask:0xf
    v_lshl_add_u32 v25, v1, 2, s22
    v_mov_b32 v26, s22
    s_waitcnt lgkmcnt(0)
    s_barrier
    s_mov_b32 exec_lo, 0
    s_mov_b32 exec_hi, 0x80000000
    ds_write_b32 v25, v24
    s_mov_b64 exec, -1
    s_waitcnt lgkmcnt(0)
    s_barrier
    ds_read_b128 v[28:31], v26
    ds_read_b128 v[32:35], v26 offset:16
    v_mov_b32 v27, 4
    s_waitcnt lgkmcnt(0)
    v_min3_u32 v28, v28, v29, v30
    v_min3_u32 v31, v31, v32, v33
    v_min3_u32 v28, v28, v34, v35
    v_min_u32 v28, v28, v31
    v_cmp_ge_u32 s[24:25], v13, v28
    v_cmp_ge_u32 s[26:27], v15, v28
    v_cmp_ge_u32 s[28:29], v17, v28
    v_cmp_ge_u32 s[30:31], v19, v28
    s_mov_b64 exec, s[24:25]
    ds_add_rtn_u32 v30, v26, v27 offset:32
    s_mov_b64 exec, s[26:27]
    ds_add_rtn_u32 v31, v26, v27 offset:32
    s_mov_b64 exec, s[28:29]
    ds_add_rtn_u32 v32, v26, v27 offset:32
    s_mov_b64 exec, s[30:31]
    ds_add_rtn_u32 v33, v26, v27 offset:32
    s_mov_b64 exec, -1
    s_waitcnt lgkmcnt(0)
    v_add_u32 v30, s22, v30
    v_add_u32 v31, s22, v31
    v_add_u32 v32, s22, v32
    v_add_u32 v33, s22, v33
    s_mov_b64 exec, s[24:25]
    ds_write_b32 v30, v13 offset:128
    s_mov_b64 exec, s[26:27]
    ds_write_b32 v31, v15 offset:128
    s_mov_b64 exec, s[28:29]
    ds_write_b32 v32, v17 offset:128
    s_mov_b64 exec, s[30:31]
    ds_write_b32 v33, v19 offset:128
    s_mov_b64 exec, -1
    s_waitcnt lgkmcnt(0)
    s_barrier
    ds_read_b32 v28, v26 offset:32
    v_lshlrev_b32 v29, 2, v0
    s_lshl_b32 s23, s10, 8
    s_waitcnt lgkmcnt(0)
    v_readfirstlane_b32 s24, v28
ffn_rk_outer:
    s_nop 0
    s_cmp_ge_u32 s23, s24
    s_cbranch_scc1 ffn_rk_done
    v_add_u32 v30, s22, v29
    ds_read_b32 v31, v30 offset:128
    v_mov_b32 v32, 0
    v_mov_b32 v33, s22
    s_mov_b32 s25, 0
ffn_rk_inner:
    ds_read_b128 v[36:39], v33 offset:128
    v_add_u32 v33, 16, v33
    s_add_u32 s25, s25, 16
    s_waitcnt lgkmcnt(0)
    v_sub_u32 v36, v31, v36
    v_sub_u32 v37, v31, v37
    v_sub_u32 v38, v31, v38
    v_sub_u32 v39, v31, v39
    v_lshrrev_b32 v36, 31, v36
    v_lshrrev_b32 v37, 31, v37
    v_lshrrev_b32 v38, 31, v38
    v_lshrrev_b32 v39, 31, v39
    v_add3_u32 v32, v32, v36, v37
    v_add3_u32 v32, v32, v38, v39
    s_cmp_lt_u32 s25, s24
    s_cbranch_scc1 ffn_rk_inner
    v_cmp_gt_u32 vcc, 8, v32
    v_cmp_gt_u32 s[26:27], s24, v29
    v_lshl_add_u32 v32, v32, 2, s22
    s_and_b64 exec, vcc, s[26:27]
    ds_write_b32 v32, v31 offset:64
    s_mov_b64 exec, -1
    v_add_u32 v29, 2048, v29
    s_add_u32 s23, s23, 2048
    s_branch ffn_rk_outer
ffn_rk_done:
    s_waitcnt vmcnt(0) lgkmcnt(0)
    s_barrier
    v_and_b32 v11, 7, v0
    v_lshl_add_u32 v12, v11, 2, s22
    ds_read_b32 v13, v12 offset:64
    v_bfe_u32 v14, v0, 4, 2
    v_bfe_u32 v15, v0, 2, 2
    v_and_b32 v16, 3, v0
    s_cmp_ge_u32 s10, 4
    s_cbranch_scc1 ffn_nogu
    v_lshl_add_u32 v17, v14, 3, v15
    v_bfe_u32 v18, v0, 3, 2
    v_xor_b32 v18, v18, v1
    v_lshlrev_b32 v18, 5, v18
    v_lshl_add_u32 v18, v16, 3, v18
    v_lshl_add_u32 v18, v17, 7, v18
    v_add_u32 v19, 36864, v18
    v_add_u32 v20, 73728, v18
    v_add_u32 v21, 110592, v18
    ds_read_b64_tr_b16 v[112:113], v18 offset:0
    ds_read_b64_tr_b16 v[114:115], v18 offset:512
    ds_read_b64_tr_b16 v[116:117], v18 offset:4096
    ds_read_b64_tr_b16 v[118:119], v18 offset:4608
    ds_read_b64_tr_b16 v[120:121], v18 offset:8192
    ds_read_b64_tr_b16 v[122:123], v18 offset:8704
    ds_read_b64_tr_b16 v[124:125], v18 offset:12288
    ds_read_b64_tr_b16 v[126:127], v18 offset:12800
    ds_read_b64_tr_b16 v[128:129], v18 offset:16384
    ds_read_b64_tr_b16 v[130:131], v18 offset:16896
    ds_read_b64_tr_b16 v[132:133], v18 offset:20480
    ds_read_b64_tr_b16 v[134:135], v18 offset:20992
    ds_read_b64_tr_b16 v[136:137], v18 offset:24576
    ds_read_b64_tr_b16 v[138:139], v18 offset:25088
    ds_read_b64_tr_b16 v[140:141], v18 offset:28672
    ds_read_b64_tr_b16 v[142:143], v18 offset:29184
    ds_read_b64_tr_b16 v[144:145], v18 offset:32768
    ds_read_b64_tr_b16 v[146:147], v18 offset:33280
    ds_read_b64_tr_b16 v[148:149], v19 offset:0
    ds_read_b64_tr_b16 v[150:151], v19 offset:512
    ds_read_b64_tr_b16 v[152:153], v19 offset:4096
    ds_read_b64_tr_b16 v[154:155], v19 offset:4608
    ds_read_b64_tr_b16 v[156:157], v19 offset:8192
    ds_read_b64_tr_b16 v[158:159], v19 offset:8704
    ds_read_b64_tr_b16 v[160:161], v19 offset:12288
    ds_read_b64_tr_b16 v[162:163], v19 offset:12800
    ds_read_b64_tr_b16 v[164:165], v19 offset:16384
    ds_read_b64_tr_b16 v[166:167], v19 offset:16896
    ds_read_b64_tr_b16 v[168:169], v19 offset:20480
    ds_read_b64_tr_b16 v[170:171], v19 offset:20992
    ds_read_b64_tr_b16 v[172:173], v19 offset:24576
    ds_read_b64_tr_b16 v[174:175], v19 offset:25088
    ds_read_b64_tr_b16 v[176:177], v19 offset:28672
    ds_read_b64_tr_b16 v[178:179], v19 offset:29184
    ds_read_b64_tr_b16 v[180:181], v19 offset:32768
    ds_read_b64_tr_b16 v[182:183], v19 offset:33280
    ds_read_b64_tr_b16 v[184:185], v20 offset:0
    ds_read_b64_tr_b16 v[186:187], v20 offset:512
    ds_read_b64_tr_b16 v[188:189], v20 offset:4096
    ds_read_b64_tr_b16 v[190:191], v20 offset:4608
    ds_read_b64_tr_b16 v[192:193], v20 offset:8192
    ds_read_b64_tr_b16 v[194:195], v20 offset:8704
    ds_read_b64_tr_b16 v[196:197], v20 offset:12288
    ds_read_b64_tr_b16 v[198:199], v20 offset:12800
    ds_read_b64_tr_b16 v[200:201], v20 offset:16384
    ds_read_b64_tr_b16 v[202:203], v20 offset:16896
    ds_read_b64_tr_b16 v[204:205], v20 offset:20480
    ds_read_b64_tr_b16 v[206:207], v20 offset:20992
    ds_read_b64_tr_b16 v[208:209], v20 offset:24576
    ds_read_b64_tr_b16 v[210:211], v20 offset:25088
    ds_read_b64_tr_b16 v[212:213], v20 offset:28672
    ds_read_b64_tr_b16 v[214:215], v20 offset:29184
    ds_read_b64_tr_b16 v[216:217], v20 offset:32768
    ds_read_b64_tr_b16 v[218:219], v20 offset:33280
    ds_read_b64_tr_b16 v[220:221], v21 offset:0
    ds_read_b64_tr_b16 v[222:223], v21 offset:512
    ds_read_b64_tr_b16 v[224:225], v21 offset:4096
    ds_read_b64_tr_b16 v[226:227], v21 offset:4608
    ds_read_b64_tr_b16 v[228:229], v21 offset:8192
    ds_read_b64_tr_b16 v[230:231], v21 offset:8704
    ds_read_b64_tr_b16 v[232:233], v21 offset:12288
    ds_read_b64_tr_b16 v[234:235], v21 offset:12800
    ds_read_b64_tr_b16 v[236:237], v21 offset:16384
    ds_read_b64_tr_b16 v[238:239], v21 offset:16896
    ds_read_b64_tr_b16 v[240:241], v21 offset:20480
    ds_read_b64_tr_b16 v[242:243], v21 offset:20992
    ds_read_b64_tr_b16 v[244:245], v21 offset:24576
    ds_read_b64_tr_b16 v[246:247], v21 offset:25088
    ds_read_b64_tr_b16 v[248:249], v21 offset:28672
    ds_read_b64_tr_b16 v[250:251], v21 offset:29184
    ds_read_b64_tr_b16 v[252:253], v21 offset:32768
    ds_read_b64_tr_b16 v[254:255], v21 offset:33280
ffn_nogu:
    s_waitcnt lgkmcnt(0)
    s_barrier
    ds_write_b128 v7, v[40:43] offset:0
    ds_write_b128 v7, v[44:47] offset:128
    ds_write_b128 v7, v[48:51] offset:256
    ds_write_b128 v7, v[52:55] offset:384
    ds_write_b128 v7, v[56:59] offset:512
    ds_write_b128 v7, v[60:63] offset:640
    ds_write_b128 v7, v[64:67] offset:768
    ds_write_b128 v7, v[68:71] offset:896
    ds_write_b128 v7, v[72:75] offset:1024
    v_and_b32 v22, 0x7ff, v13
    v_sub_u32 v22, 2047, v22
    s_mov_b32 s26, 0x00ff00ff
    s_mov_b32 s27, 0x00ff00ff
    s_waitcnt lgkmcnt(0)
    s_barrier
    s_cmp_ge_u32 s10, 4
    s_cbranch_scc1 ffn_down
    s_mov_b32 s28, 0x3f803f80
    s_mov_b32 s29, 0x3f803f80
    v_mov_b64 v[40:41], s[28:29]
    v_mov_b64 v[42:43], s[28:29]
    v_mov_b64 v[44:45], s[28:29]
    v_mov_b64 v[46:47], s[28:29]
    v_mov_b64 v[48:49], s[28:29]
    v_mov_b64 v[50:51], s[28:29]
    v_mov_b64 v[52:53], s[28:29]
    v_mov_b64 v[54:55], s[28:29]
    v_mov_b64 v[56:57], s[28:29]
    v_mov_b64 v[58:59], s[28:29]
    v_mov_b64 v[60:61], s[28:29]
    v_mov_b64 v[62:63], s[28:29]
    v_mov_b64 v[64:65], s[28:29]
    v_mov_b64 v[66:67], s[28:29]
    v_mov_b64 v[68:69], s[28:29]
    v_mov_b64 v[70:71], s[28:29]
    v_mov_b64 v[72:73], s[28:29]
    v_mov_b64 v[74:75], s[28:29]
    v_mov_b64 v[76:77], s[28:29]
    v_mov_b64 v[78:79], s[28:29]
    v_mov_b64 v[80:81], s[28:29]
    v_mov_b64 v[82:83], s[28:29]
    v_mov_b64 v[84:85], s[28:29]
    v_mov_b64 v[86:87], s[28:29]
    v_mov_b64 v[88:89], s[28:29]
    v_mov_b64 v[90:91], s[28:29]
    v_mov_b64 v[92:93], s[28:29]
    v_mov_b64 v[94:95], s[28:29]
    v_mov_b64 v[96:97], s[28:29]
    v_mov_b64 v[98:99], s[28:29]
    v_mov_b64 v[100:101], s[28:29]
    v_mov_b64 v[102:103], s[28:29]
    v_mov_b64 v[104:105], s[28:29]
    v_mov_b64 v[106:107], s[28:29]
    v_mov_b64 v[108:109], s[28:29]
    v_mov_b64 v[110:111], s[28:29]
    v_mul_u32_u24 v23, 1152, v22
    v_lshl_add_u32 v23, v14, 4, v23
    v_lshlrev_b32 v24, 3, v22
    global_load_dword v25, v24, s[8:9] offset:0
    s_mov_b64 exec, s[26:27]
    global_load_dwordx4 v[40:43], v23, s[4:5] offset:0
    global_load_dwordx4 v[44:47], v23, s[4:5] offset:64
    global_load_dwordx4 v[48:51], v23, s[4:5] offset:128
    global_load_dwordx4 v[52:55], v23, s[4:5] offset:192
    global_load_dwordx4 v[56:59], v23, s[4:5] offset:256
    global_load_dwordx4 v[60:63], v23, s[4:5] offset:320
    global_load_dwordx4 v[64:67], v23, s[4:5] offset:384
    global_load_dwordx4 v[68:71], v23, s[4:5] offset:448
    global_load_dwordx4 v[72:75], v23, s[4:5] offset:512
    global_load_dwordx4 v[76:79], v23, s[4:5] offset:576
    global_load_dwordx4 v[80:83], v23, s[4:5] offset:640
    global_load_dwordx4 v[84:87], v23, s[4:5] offset:704
    global_load_dwordx4 v[88:91], v23, s[4:5] offset:768
    global_load_dwordx4 v[92:95], v23, s[4:5] offset:832
    global_load_dwordx4 v[96:99], v23, s[4:5] offset:896
    global_load_dwordx4 v[100:103], v23, s[4:5] offset:960
    global_load_dwordx4 v[104:107], v23, s[4:5] offset:1024
    global_load_dwordx4 v[108:111], v23, s[4:5] offset:1088
    s_mov_b64 exec, -1
    s_waitcnt vmcnt(17)
    v_mfma_f32_16x16x32_bf16 v[28:31], v[112:115], v[40:43], 0
    v_mfma_f32_16x16x32_bf16 v[32:35], v[184:187], v[40:43], 0
    s_waitcnt vmcnt(16)
    v_mfma_f32_16x16x32_bf16 v[28:31], v[116:119], v[44:47], v[28:31]
    v_mfma_f32_16x16x32_bf16 v[32:35], v[188:191], v[44:47], v[32:35]
    s_waitcnt vmcnt(15)
    v_mfma_f32_16x16x32_bf16 v[28:31], v[120:123], v[48:51], v[28:31]
    v_mfma_f32_16x16x32_bf16 v[32:35], v[192:195], v[48:51], v[32:35]
    s_waitcnt vmcnt(14)
    v_mfma_f32_16x16x32_bf16 v[28:31], v[124:127], v[52:55], v[28:31]
    v_mfma_f32_16x16x32_bf16 v[32:35], v[196:199], v[52:55], v[32:35]
    s_waitcnt vmcnt(13)
    v_mfma_f32_16x16x32_bf16 v[28:31], v[128:131], v[56:59], v[28:31]
    v_mfma_f32_16x16x32_bf16 v[32:35], v[200:203], v[56:59], v[32:35]
    s_waitcnt vmcnt(12)
    v_mfma_f32_16x16x32_bf16 v[28:31], v[132:135], v[60:63], v[28:31]
    v_mfma_f32_16x16x32_bf16 v[32:35], v[204:207], v[60:63], v[32:35]
    s_waitcnt vmcnt(11)
    v_mfma_f32_16x16x32_bf16 v[28:31], v[136:139], v[64:67], v[28:31]
    v_mfma_f32_16x16x32_bf16 v[32:35], v[208:211], v[64:67], v[32:35]
    s_waitcnt vmcnt(10)
    v_mfma_f32_16x16x32_bf16 v[28:31], v[140:143], v[68:71], v[28:31]
    v_mfma_f32_16x16x32_bf16 v[32:35], v[212:215], v[68:71], v[32:35]
    s_waitcnt vmcnt(9)
    v_mfma_f32_16x16x32_bf16 v[28:31], v[144:147], v[72:75], v[28:31]
    v_mfma_f32_16x16x32_bf16 v[32:35], v[216:219], v[72:75], v[32:35]
    s_waitcnt vmcnt(8)
    v_mfma_f32_16x16x32_bf16 v[28:31], v[148:151], v[76:79], v[28:31]
    v_mfma_f32_16x16x32_bf16 v[32:35], v[220:223], v[76:79], v[32:35]
    s_waitcnt vmcnt(7)
    v_mfma_f32_16x16x32_bf16 v[28:31], v[152:155], v[80:83], v[28:31]
    v_mfma_f32_16x16x32_bf16 v[32:35], v[224:227], v[80:83], v[32:35]
    s_waitcnt vmcnt(6)
    v_mfma_f32_16x16x32_bf16 v[28:31], v[156:159], v[84:87], v[28:31]
    v_mfma_f32_16x16x32_bf16 v[32:35], v[228:231], v[84:87], v[32:35]
    s_waitcnt vmcnt(5)
    v_mfma_f32_16x16x32_bf16 v[28:31], v[160:163], v[88:91], v[28:31]
    v_mfma_f32_16x16x32_bf16 v[32:35], v[232:235], v[88:91], v[32:35]
    s_waitcnt vmcnt(4)
    v_mfma_f32_16x16x32_bf16 v[28:31], v[164:167], v[92:95], v[28:31]
    v_mfma_f32_16x16x32_bf16 v[32:35], v[236:239], v[92:95], v[32:35]
    s_waitcnt vmcnt(3)
    v_mfma_f32_16x16x32_bf16 v[28:31], v[168:171], v[96:99], v[28:31]
    v_mfma_f32_16x16x32_bf16 v[32:35], v[240:243], v[96:99], v[32:35]
    s_waitcnt vmcnt(2)
    v_mfma_f32_16x16x32_bf16 v[28:31], v[172:175], v[100:103], v[28:31]
    v_mfma_f32_16x16x32_bf16 v[32:35], v[244:247], v[100:103], v[32:35]
    s_waitcnt vmcnt(1)
    v_mfma_f32_16x16x32_bf16 v[28:31], v[176:179], v[104:107], v[28:31]
    v_mfma_f32_16x16x32_bf16 v[32:35], v[248:251], v[104:107], v[32:35]
    s_waitcnt vmcnt(0)
    v_mfma_f32_16x16x32_bf16 v[28:31], v[180:183], v[108:111], v[28:31]
    v_mfma_f32_16x16x32_bf16 v[32:35], v[252:255], v[108:111], v[32:35]
    v_and_b32 v26, 0xffff0000, v25
    v_rcp_f32 v26, v26
    v_lshlrev_b32 v25, 16, v25
    v_xor_b32 v25, 0x80000000, v25
    v_lshlrev_b32 v27, 4, v2
    v_lshrrev_b32 v36, 1, v1
    v_lshl_add_u32 v27, v36, 10, v27
    v_and_b32 v36, 1, v1
    v_lshl_add_u32 v27, v36, 3, v27
    v_add_u32 v27, 155792, v27
    v_fmac_f32_dpp v28, v28, v25 row_newbcast:8 row_mask:0xf bank_mask:0xf
    v_fmac_f32_dpp v29, v29, v25 row_newbcast:8 row_mask:0xf bank_mask:0xf
    v_fmac_f32_dpp v30, v30, v25 row_newbcast:8 row_mask:0xf bank_mask:0xf
    v_fmac_f32_dpp v31, v31, v25 row_newbcast:8 row_mask:0xf bank_mask:0xf
    v_fmac_f32_dpp v32, v32, v25 row_newbcast:8 row_mask:0xf bank_mask:0xf
    v_fmac_f32_dpp v33, v33, v25 row_newbcast:8 row_mask:0xf bank_mask:0xf
    v_fmac_f32_dpp v34, v34, v25 row_newbcast:8 row_mask:0xf bank_mask:0xf
    v_fmac_f32_dpp v35, v35, v25 row_newbcast:8 row_mask:0xf bank_mask:0xf
    v_mul_f32 v28, v28, v26
    v_mul_f32 v29, v29, v26
    v_mul_f32 v30, v30, v26
    v_mul_f32 v31, v31, v26
    v_mul_f32 v32, v32, v26
    v_mul_f32 v33, v33, v26
    v_mul_f32 v34, v34, v26
    v_mul_f32 v35, v35, v26
    v_mul_f32 v36, 0xbfb8aa3b, v28
    v_mul_f32 v37, 0xbfb8aa3b, v29
    v_mul_f32 v38, 0xbfb8aa3b, v30
    v_mul_f32 v39, 0xbfb8aa3b, v31
    v_exp_f32 v36, v36
    v_exp_f32 v37, v37
    v_exp_f32 v38, v38
    v_exp_f32 v39, v39
    v_add_f32 v36, 1.0, v36
    v_add_f32 v37, 1.0, v37
    v_add_f32 v38, 1.0, v38
    v_add_f32 v39, 1.0, v39
    v_rcp_f32 v36, v36
    v_rcp_f32 v37, v37
    v_rcp_f32 v38, v38
    v_rcp_f32 v39, v39
    v_mul_f32 v28, v28, v32
    v_mul_f32 v29, v29, v33
    v_mul_f32 v30, v30, v34
    v_mul_f32 v31, v31, v35
    v_mul_f32 v28, v28, v36
    v_mul_f32 v29, v29, v37
    v_mul_f32 v30, v30, v38
    v_mul_f32 v31, v31, v39
    v_cvt_pk_bf16_f32 v28, v28, v29
    v_cvt_pk_bf16_f32 v29, v30, v31
    ds_write_b64 v27, v[28:29]
    s_waitcnt lgkmcnt(0)
    s_barrier
    s_endpgm
ffn_down:
    v_lshl_add_u32 v17, v14, 2, v15
    v_mul_u32_u24 v17, 1184, v17
    v_lshl_add_u32 v17, v16, 3, v17
    s_sub_u32 s11, s10, 4
    s_mul_i32 s12, s11, 288
    v_add_u32 v17, s12, v17
    ds_read_b64_tr_b16 v[112:113], v17 offset:0
    ds_read_b64_tr_b16 v[114:115], v17 offset:18944
    ds_read_b64_tr_b16 v[116:117], v17 offset:37888
    ds_read_b64_tr_b16 v[118:119], v17 offset:56832
    ds_read_b64_tr_b16 v[120:121], v17 offset:32
    ds_read_b64_tr_b16 v[122:123], v17 offset:18976
    ds_read_b64_tr_b16 v[124:125], v17 offset:37920
    ds_read_b64_tr_b16 v[126:127], v17 offset:56864
    ds_read_b64_tr_b16 v[128:129], v17 offset:64
    ds_read_b64_tr_b16 v[130:131], v17 offset:19008
    ds_read_b64_tr_b16 v[132:133], v17 offset:37952
    ds_read_b64_tr_b16 v[134:135], v17 offset:56896
    ds_read_b64_tr_b16 v[136:137], v17 offset:96
    ds_read_b64_tr_b16 v[138:139], v17 offset:19040
    ds_read_b64_tr_b16 v[140:141], v17 offset:37984
    ds_read_b64_tr_b16 v[142:143], v17 offset:56928
    ds_read_b64_tr_b16 v[144:145], v17 offset:128
    ds_read_b64_tr_b16 v[146:147], v17 offset:19072
    ds_read_b64_tr_b16 v[148:149], v17 offset:38016
    ds_read_b64_tr_b16 v[150:151], v17 offset:56960
    ds_read_b64_tr_b16 v[152:153], v17 offset:160
    ds_read_b64_tr_b16 v[154:155], v17 offset:19104
    ds_read_b64_tr_b16 v[156:157], v17 offset:38048
    ds_read_b64_tr_b16 v[158:159], v17 offset:56992
    ds_read_b64_tr_b16 v[160:161], v17 offset:192
    ds_read_b64_tr_b16 v[162:163], v17 offset:19136
    ds_read_b64_tr_b16 v[164:165], v17 offset:38080
    ds_read_b64_tr_b16 v[166:167], v17 offset:57024
    ds_read_b64_tr_b16 v[168:169], v17 offset:224
    ds_read_b64_tr_b16 v[170:171], v17 offset:19168
    ds_read_b64_tr_b16 v[172:173], v17 offset:38112
    ds_read_b64_tr_b16 v[174:175], v17 offset:57056
    ds_read_b64_tr_b16 v[176:177], v17 offset:256
    ds_read_b64_tr_b16 v[178:179], v17 offset:19200
    ds_read_b64_tr_b16 v[180:181], v17 offset:38144
    ds_read_b64_tr_b16 v[182:183], v17 offset:57088
    v_lshlrev_b32 v27, 4, v2
    v_add_u32 v27, 155792, v27
    v_mul_u32_u24 v18, 9216, v14
    v_lshl_add_u32 v18, v11, 4, v18
    s_mul_i32 s12, s11, 331776
    s_lshl_b32 s13, s2, 7
    s_add_u32 s12, s12, s13
    s_add_u32 s12, s12, 65536
    v_add_u32 v18, s12, v18
    s_add_u32 s11, s11, s2
    s_cmp_lg_u32 s11, 0
    s_cbranch_scc1 ffn_noidx
    v_lshlrev_b32 v19, 2, v11
    v_add_u32 v19, 32768, v19
    global_store_dword v19, v13, s[8:9]
ffn_noidx:
    s_waitcnt lgkmcnt(0)
    s_barrier
    ds_read_b128 v[28:31], v27
    ds_read_b128 v[32:35], v27 offset:1024
    s_waitcnt lgkmcnt(0)
    v_mfma_f32_16x16x32_bf16 v[40:43], v[112:115], v[28:31], 0
    v_mfma_f32_16x16x32_bf16 v[40:43], v[116:119], v[32:35], v[40:43]
    v_mfma_f32_16x16x32_bf16 v[44:47], v[120:123], v[28:31], 0
    v_mfma_f32_16x16x32_bf16 v[44:47], v[124:127], v[32:35], v[44:47]
    v_mfma_f32_16x16x32_bf16 v[48:51], v[128:131], v[28:31], 0
    v_mfma_f32_16x16x32_bf16 v[48:51], v[132:135], v[32:35], v[48:51]
    v_mfma_f32_16x16x32_bf16 v[52:55], v[136:139], v[28:31], 0
    v_mfma_f32_16x16x32_bf16 v[52:55], v[140:143], v[32:35], v[52:55]
    v_mfma_f32_16x16x32_bf16 v[56:59], v[144:147], v[28:31], 0
    v_mfma_f32_16x16x32_bf16 v[56:59], v[148:151], v[32:35], v[56:59]
    v_mfma_f32_16x16x32_bf16 v[60:63], v[152:155], v[28:31], 0
    v_mfma_f32_16x16x32_bf16 v[60:63], v[156:159], v[32:35], v[60:63]
    v_mfma_f32_16x16x32_bf16 v[64:67], v[160:163], v[28:31], 0
    v_mfma_f32_16x16x32_bf16 v[64:67], v[164:167], v[32:35], v[64:67]
    v_mfma_f32_16x16x32_bf16 v[68:71], v[168:171], v[28:31], 0
    v_mfma_f32_16x16x32_bf16 v[68:71], v[172:175], v[32:35], v[68:71]
    v_mfma_f32_16x16x32_bf16 v[72:75], v[176:179], v[28:31], 0
    v_mfma_f32_16x16x32_bf16 v[72:75], v[180:183], v[32:35], v[72:75]
    s_mov_b64 exec, s[26:27]
    global_store_dwordx4 v18, v[40:43], s[8:9]
    v_add_u32 v18, 36864, v18
    global_store_dwordx4 v18, v[44:47], s[8:9]
    v_add_u32 v18, 36864, v18
    global_store_dwordx4 v18, v[48:51], s[8:9]
    v_add_u32 v18, 36864, v18
    global_store_dwordx4 v18, v[52:55], s[8:9]
    v_add_u32 v18, 36864, v18
    global_store_dwordx4 v18, v[56:59], s[8:9]
    v_add_u32 v18, 36864, v18
    global_store_dwordx4 v18, v[60:63], s[8:9]
    v_add_u32 v18, 36864, v18
    global_store_dwordx4 v18, v[64:67], s[8:9]
    v_add_u32 v18, 36864, v18
    global_store_dwordx4 v18, v[68:71], s[8:9]
    v_add_u32 v18, 36864, v18
    global_store_dwordx4 v18, v[72:75], s[8:9]
ffn_end:
    s_endpgm
.text
.globl conv_kernel
.p2align 8
.type conv_kernel,@function
conv_kernel:
    s_load_dwordx8 s[12:19], s[0:1], 8
    s_load_dwordx8 s[20:27], s[0:1], 40
    s_load_dwordx2 s[6:7], s[0:1], 112
    s_load_dwordx2 s[8:9], s[0:1], 128
    s_cmp_ge_u32 s2, 144
    s_cbranch_scc1 conv_end
    v_lshrrev_b32 v1, 6, v0
    v_and_b32 v2, 63, v0
    v_readfirstlane_b32 s10, v1
    s_nop 0
    s_and_b32 s28, s10, 3
    s_lshr_b32 s29, s10, 2
    s_lshl_b32 s30, s2, 2
    s_add_u32 s30, s30, s28
    s_lshl_b32 s31, s30, 8
    s_lshl_b32 s11, s29, 7
    s_add_u32 s31, s31, s11
    v_lshl_add_u32 v3, v2, 1, s31
    s_lshl_b32 s31, s30, 1
    v_mov_b32 v4, s31
    s_lshl_b32 s31, s2, 3
    v_mov_b32 v5, s31
    s_mul_i32 s33, s28, 31744
    s_lshl_b32 s11, s2, 15
    s_add_u32 s11, s11, 2097152
    v_lshl_add_u32 v6, v0, 6, s11
    s_waitcnt lgkmcnt(0)
    global_load_ushort v16, v4, s[24:25]
    global_load_ushort v10, v3, s[12:13]
    global_load_ushort v11, v3, s[14:15]
    global_load_ushort v12, v3, s[16:17]
    global_load_ushort v13, v3, s[18:19]
    global_load_ushort v14, v3, s[20:21]
    global_load_ushort v15, v3, s[22:23]
    global_load_dwordx2 v[254:255], v5, s[26:27]
    global_load_dwordx4 v[200:203], v6, s[8:9] offset:-16
    global_load_dwordx4 v[204:207], v6, s[8:9] offset:0
    global_load_dwordx4 v[208:211], v6, s[8:9] offset:16
    global_load_dwordx4 v[212:215], v6, s[8:9] offset:32
    global_load_dwordx4 v[216:219], v6, s[8:9] offset:48
    s_lshl_b32 s11, s29, 8
    s_add_u32 s11, s11, s33
    v_lshl_add_u32 v7, v2, 2, s11
    s_waitcnt vmcnt(6)
    v_lshlrev_b32 v16, 16, v16
    v_mul_f32 v16, 0x3fb8aa3b, v16
    v_exp_f32 v16, v16
    v_lshlrev_b32 v10, 16, v10
    v_lshlrev_b32 v11, 16, v11
    v_lshlrev_b32 v12, 16, v12
    v_lshlrev_b32 v13, 16, v13
    v_lshlrev_b32 v14, 16, v14
    v_lshlrev_b32 v15, 16, v15
    v_cvt_pk_bf16_f32 v16, v16, v16
    v_lshlrev_b32 v16, 16, v16
    v_mul_f32 v10, v16, v10
    v_mul_f32 v11, v16, v11
    v_mul_f32 v12, v16, v12
    v_mul_f32 v13, v16, v13
    v_mul_f32 v10, 0x3fb8aa3b, v10
    v_mul_f32 v11, 0x3e22f983, v11
    v_pk_mul_f32 v[18:19], v[14:15], v[12:13] op_sel:[0,0] op_sel_hi:[0,1]
    v_pk_fma_f32 v[20:21], v[14:15], v[12:13], v[18:19] op_sel:[1,1,0] op_sel_hi:[1,0,1] neg_lo:[0,1,0]
    v_xor_b32 v21, 0x80000000, v21
    v_mul_f32 v17, 0x3f800000, v10
    v_mul_f32 v18, 0x3f800000, v11
    v_exp_f32 v17, v17
    v_fract_f32 v18, v18
    v_cos_f32 v22, v18
    v_sin_f32 v23, v18
    v_mul_f32 v22, v17, v22
    v_mul_f32 v23, -v17, v23
    v_mul_f32 v17, 0x41800000, v10
    v_mul_f32 v18, 0x41800000, v11
    v_exp_f32 v17, v17
    v_fract_f32 v18, v18
    v_cos_f32 v24, v18
    v_sin_f32 v25, v18
    v_mul_f32 v24, v17, v24
    v_mul_f32 v25, v17, v25
    v_mul_f32 v17, 0x44000000, v10
    v_mul_f32 v18, 0x44000000, v11
    v_exp_f32 v17, v17
    v_fract_f32 v18, v18
    v_cos_f32 v26, v18
    v_sin_f32 v27, v18
    v_mul_f32 v26, v17, v26
    v_mul_f32 v27, -v17, v27
    v_mov_b32 v28, 1.0
    v_mov_b32 v29, 0
    v_mov_b32 v40, v20
    v_mov_b32 v41, v21
    v_cvt_pk_bf16_f32 v34, v40, v41
    ds_write_b32 v7, v34 offset:16896
    v_cvt_pk_bf16_f32 v34, v28, v29
    ds_write_b32 v7, v34 offset:0
    v_pk_mul_f32 v[30:31], v[28:29], v[24:25] op_sel:[0,0] op_sel_hi:[0,1]
    v_pk_fma_f32 v[28:29], v[28:29], v[24:25], v[30:31] op_sel:[1,1,0] op_sel_hi:[1,0,1] neg_lo:[0,1,0]
    v_pk_mul_f32 v[32:33], v[40:41], v[22:23] op_sel:[0,0] op_sel_hi:[0,1]
    v_pk_fma_f32 v[42:43], v[40:41], v[22:23], v[32:33] op_sel:[1,1,0] op_sel_hi:[1,0,1] neg_lo:[0,1,0]
    v_cvt_pk_bf16_f32 v35, v42, v43
    ds_write_b32 v7, v35 offset:17424
    v_cvt_pk_bf16_f32 v36, v28, v29
    ds_write_b32 v7, v36 offset:528
    v_pk_mul_f32 v[30:31], v[28:29], v[24:25] op_sel:[0,0] op_sel_hi:[0,1]
    v_pk_fma_f32 v[28:29], v[28:29], v[24:25], v[30:31] op_sel:[1,1,0] op_sel_hi:[1,0,1] neg_lo:[0,1,0]
    v_pk_mul_f32 v[32:33], v[42:43], v[22:23] op_sel:[0,0] op_sel_hi:[0,1]
    v_pk_fma_f32 v[44:45], v[42:43], v[22:23], v[32:33] op_sel:[1,1,0] op_sel_hi:[1,0,1] neg_lo:[0,1,0]
    v_cvt_pk_bf16_f32 v37, v44, v45
    ds_write_b32 v7, v37 offset:17952
    v_cvt_pk_bf16_f32 v34, v28, v29
    ds_write_b32 v7, v34 offset:1056
    v_pk_mul_f32 v[30:31], v[28:29], v[24:25] op_sel:[0,0] op_sel_hi:[0,1]
    v_pk_fma_f32 v[28:29], v[28:29], v[24:25], v[30:31] op_sel:[1,1,0] op_sel_hi:[1,0,1] neg_lo:[0,1,0]
    v_pk_mul_f32 v[32:33], v[44:45], v[22:23] op_sel:[0,0] op_sel_hi:[0,1]
    v_pk_fma_f32 v[46:47], v[44:45], v[22:23], v[32:33] op_sel:[1,1,0] op_sel_hi:[1,0,1] neg_lo:[0,1,0]
    v_cvt_pk_bf16_f32 v35, v46, v47
    ds_write_b32 v7, v35 offset:18480
    v_cvt_pk_bf16_f32 v36, v28, v29
    ds_write_b32 v7, v36 offset:1584
    v_pk_mul_f32 v[30:31], v[28:29], v[24:25] op_sel:[0,0] op_sel_hi:[0,1]
    v_pk_fma_f32 v[28:29], v[28:29], v[24:25], v[30:31] op_sel:[1,1,0] op_sel_hi:[1,0,1] neg_lo:[0,1,0]
    v_pk_mul_f32 v[32:33], v[46:47], v[22:23] op_sel:[0,0] op_sel_hi:[0,1]
    v_pk_fma_f32 v[48:49], v[46:47], v[22:23], v[32:33] op_sel:[1,1,0] op_sel_hi:[1,0,1] neg_lo:[0,1,0]
    v_cvt_pk_bf16_f32 v37, v48, v49
    ds_write_b32 v7, v37 offset:19008
    v_cvt_pk_bf16_f32 v34, v28, v29
    ds_write_b32 v7, v34 offset:2112
    v_pk_mul_f32 v[30:31], v[28:29], v[24:25] op_sel:[0,0] op_sel_hi:[0,1]
    v_pk_fma_f32 v[28:29], v[28:29], v[24:25], v[30:31] op_sel:[1,1,0] op_sel_hi:[1,0,1] neg_lo:[0,1,0]
    v_pk_mul_f32 v[32:33], v[48:49], v[22:23] op_sel:[0,0] op_sel_hi:[0,1]
    v_pk_fma_f32 v[50:51], v[48:49], v[22:23], v[32:33] op_sel:[1,1,0] op_sel_hi:[1,0,1] neg_lo:[0,1,0]
    v_cvt_pk_bf16_f32 v35, v50, v51
    ds_write_b32 v7, v35 offset:19536
    v_cvt_pk_bf16_f32 v36, v28, v29
    ds_write_b32 v7, v36 offset:2640
    v_pk_mul_f32 v[30:31], v[28:29], v[24:25] op_sel:[0,0] op_sel_hi:[0,1]
    v_pk_fma_f32 v[28:29], v[28:29], v[24:25], v[30:31] op_sel:[1,1,0] op_sel_hi:[1,0,1] neg_lo:[0,1,0]
    v_pk_mul_f32 v[32:33], v[50:51], v[22:23] op_sel:[0,0] op_sel_hi:[0,1]
    v_pk_fma_f32 v[52:53], v[50:51], v[22:23], v[32:33] op_sel:[1,1,0] op_sel_hi:[1,0,1] neg_lo:[0,1,0]
    v_cvt_pk_bf16_f32 v37, v52, v53
    ds_write_b32 v7, v37 offset:20064
    v_cvt_pk_bf16_f32 v34, v28, v29
    ds_write_b32 v7, v34 offset:3168
    v_pk_mul_f32 v[30:31], v[28:29], v[24:25] op_sel:[0,0] op_sel_hi:[0,1]
    v_pk_fma_f32 v[28:29], v[28:29], v[24:25], v[30:31] op_sel:[1,1,0] op_sel_hi:[1,0,1] neg_lo:[0,1,0]
    v_pk_mul_f32 v[32:33], v[52:53], v[22:23] op_sel:[0,0] op_sel_hi:[0,1]
    v_pk_fma_f32 v[54:55], v[52:53], v[22:23], v[32:33] op_sel:[1,1,0] op_sel_hi:[1,0,1] neg_lo:[0,1,0]
    v_cvt_pk_bf16_f32 v35, v54, v55
    ds_write_b32 v7, v35 offset:20592
    v_cvt_pk_bf16_f32 v36, v28, v29
    ds_write_b32 v7, v36 offset:3696
    v_pk_mul_f32 v[30:31], v[28:29], v[24:25] op_sel:[0,0] op_sel_hi:[0,1]
    v_pk_fma_f32 v[28:29], v[28:29], v[24:25], v[30:31] op_sel:[1,1,0] op_sel_hi:[1,0,1] neg_lo:[0,1,0]
    v_pk_mul_f32 v[32:33], v[54:55], v[22:23] op_sel:[0,0] op_sel_hi:[0,1]
    v_pk_fma_f32 v[56:57], v[54:55], v[22:23], v[32:33] op_sel:[1,1,0] op_sel_hi:[1,0,1] neg_lo:[0,1,0]
    v_cvt_pk_bf16_f32 v37, v56, v57
    ds_write_b32 v7, v37 offset:21120
    v_cvt_pk_bf16_f32 v34, v28, v29
    ds_write_b32 v7, v34 offset:4224
    v_pk_mul_f32 v[30:31], v[28:29], v[24:25] op_sel:[0,0] op_sel_hi:[0,1]
    v_pk_fma_f32 v[28:29], v[28:29], v[24:25], v[30:31] op_sel:[1,1,0] op_sel_hi:[1,0,1] neg_lo:[0,1,0]
    v_pk_mul_f32 v[32:33], v[56:57], v[22:23] op_sel:[0,0] op_sel_hi:[0,1]
    v_pk_fma_f32 v[58:59], v[56:57], v[22:23], v[32:33] op_sel:[1,1,0] op_sel_hi:[1,0,1] neg_lo:[0,1,0]
    v_cvt_pk_bf16_f32 v35, v58, v59
    ds_write_b32 v7, v35 offset:21648
    v_cvt_pk_bf16_f32 v36, v28, v29
    ds_write_b32 v7, v36 offset:4752
    v_pk_mul_f32 v[30:31], v[28:29], v[24:25] op_sel:[0,0] op_sel_hi:[0,1]
    v_pk_fma_f32 v[28:29], v[28:29], v[24:25], v[30:31] op_sel:[1,1,0] op_sel_hi:[1,0,1] neg_lo:[0,1,0]
    v_pk_mul_f32 v[32:33], v[58:59], v[22:23] op_sel:[0,0] op_sel_hi:[0,1]
    v_pk_fma_f32 v[60:61], v[58:59], v[22:23], v[32:33] op_sel:[1,1,0] op_sel_hi:[1,0,1] neg_lo:[0,1,0]
    v_cvt_pk_bf16_f32 v37, v60, v61
    ds_write_b32 v7, v37 offset:22176
    v_cvt_pk_bf16_f32 v34, v28, v29
    ds_write_b32 v7, v34 offset:5280
    v_pk_mul_f32 v[30:31], v[28:29], v[24:25] op_sel:[0,0] op_sel_hi:[0,1]
    v_pk_fma_f32 v[28:29], v[28:29], v[24:25], v[30:31] op_sel:[1,1,0] op_sel_hi:[1,0,1] neg_lo:[0,1,0]
    v_pk_mul_f32 v[32:33], v[60:61], v[22:23] op_sel:[0,0] op_sel_hi:[0,1]
    v_pk_fma_f32 v[62:63], v[60:61], v[22:23], v[32:33] op_sel:[1,1,0] op_sel_hi:[1,0,1] neg_lo:[0,1,0]
    v_cvt_pk_bf16_f32 v35, v62, v63
    ds_write_b32 v7, v35 offset:22704
    v_cvt_pk_bf16_f32 v36, v28, v29
    ds_write_b32 v7, v36 offset:5808
    v_pk_mul_f32 v[30:31], v[28:29], v[24:25] op_sel:[0,0] op_sel_hi:[0,1]
    v_pk_fma_f32 v[28:29], v[28:29], v[24:25], v[30:31] op_sel:[1,1,0] op_sel_hi:[1,0,1] neg_lo:[0,1,0]
    v_pk_mul_f32 v[32:33], v[62:63], v[22:23] op_sel:[0,0] op_sel_hi:[0,1]
    v_pk_fma_f32 v[64:65], v[62:63], v[22:23], v[32:33] op_sel:[1,1,0] op_sel_hi:[1,0,1] neg_lo:[0,1,0]
    v_cvt_pk_bf16_f32 v37, v64, v65
    ds_write_b32 v7, v37 offset:23232
    v_cvt_pk_bf16_f32 v34, v28, v29
    ds_write_b32 v7, v34 offset:6336
    v_pk_mul_f32 v[30:31], v[28:29], v[24:25] op_sel:[0,0] op_sel_hi:[0,1]
    v_pk_fma_f32 v[28:29], v[28:29], v[24:25], v[30:31] op_sel:[1,1,0] op_sel_hi:[1,0,1] neg_lo:[0,1,0]
    v_pk_mul_f32 v[32:33], v[64:65], v[22:23] op_sel:[0,0] op_sel_hi:[0,1]
    v_pk_fma_f32 v[66:67], v[64:65], v[22:23], v[32:33] op_sel:[1,1,0] op_sel_hi:[1,0,1] neg_lo:[0,1,0]
    v_cvt_pk_bf16_f32 v35, v66, v67
    ds_write_b32 v7, v35 offset:23760
    v_cvt_pk_bf16_f32 v36, v28, v29
    ds_write_b32 v7, v36 offset:6864
    v_pk_mul_f32 v[30:31], v[28:29], v[24:25] op_sel:[0,0] op_sel_hi:[0,1]
    v_pk_fma_f32 v[28:29], v[28:29], v[24:25], v[30:31] op_sel:[1,1,0] op_sel_hi:[1,0,1] neg_lo:[0,1,0]
    v_pk_mul_f32 v[32:33], v[66:67], v[22:23] op_sel:[0,0] op_sel_hi:[0,1]
    v_pk_fma_f32 v[68:69], v[66:67], v[22:23], v[32:33] op_sel:[1,1,0] op_sel_hi:[1,0,1] neg_lo:[0,1,0]
    v_cvt_pk_bf16_f32 v37, v68, v69
    ds_write_b32 v7, v37 offset:24288
    v_cvt_pk_bf16_f32 v34, v28, v29
    ds_write_b32 v7, v34 offset:7392
    v_pk_mul_f32 v[30:31], v[28:29], v[24:25] op_sel:[0,0] op_sel_hi:[0,1]
    v_pk_fma_f32 v[28:29], v[28:29], v[24:25], v[30:31] op_sel:[1,1,0] op_sel_hi:[1,0,1] neg_lo:[0,1,0]
    v_pk_mul_f32 v[32:33], v[68:69], v[22:23] op_sel:[0,0] op_sel_hi:[0,1]
    v_pk_fma_f32 v[70:71], v[68:69], v[22:23], v[32:33] op_sel:[1,1,0] op_sel_hi:[1,0,1] neg_lo:[0,1,0]
    v_cvt_pk_bf16_f32 v35, v70, v71
    ds_write_b32 v7, v35 offset:24816
    v_cvt_pk_bf16_f32 v36, v28, v29
    ds_write_b32 v7, v36 offset:7920
    v_pk_mul_f32 v[30:31], v[28:29], v[24:25] op_sel:[0,0] op_sel_hi:[0,1]
    v_pk_fma_f32 v[28:29], v[28:29], v[24:25], v[30:31] op_sel:[1,1,0] op_sel_hi:[1,0,1] neg_lo:[0,1,0]
    v_pk_mul_f32 v[32:33], v[70:71], v[22:23] op_sel:[0,0] op_sel_hi:[0,1]
    v_pk_fma_f32 v[72:73], v[70:71], v[22:23], v[32:33] op_sel:[1,1,0] op_sel_hi:[1,0,1] neg_lo:[0,1,0]
    v_cvt_pk_bf16_f32 v37, v72, v73
    ds_write_b32 v7, v37 offset:25344
    v_cvt_pk_bf16_f32 v34, v28, v29
    ds_write_b32 v7, v34 offset:8448
    v_pk_mul_f32 v[30:31], v[28:29], v[24:25] op_sel:[0,0] op_sel_hi:[0,1]
    v_pk_fma_f32 v[28:29], v[28:29], v[24:25], v[30:31] op_sel:[1,1,0] op_sel_hi:[1,0,1] neg_lo:[0,1,0]
    v_pk_mul_f32 v[32:33], v[40:41], v[26:27] op_sel:[0,0] op_sel_hi:[0,1]
    v_pk_fma_f32 v[40:41], v[40:41], v[26:27], v[32:33] op_sel:[1,1,0] op_sel_hi:[1,0,1] neg_lo:[0,1,0]
    v_cvt_pk_bf16_f32 v35, v40, v41
    ds_write_b32 v7, v35 offset:25872
    v_cvt_pk_bf16_f32 v36, v28, v29
    ds_write_b32 v7, v36 offset:8976
    v_pk_mul_f32 v[30:31], v[28:29], v[24:25] op_sel:[0,0] op_sel_hi:[0,1]
    v_pk_fma_f32 v[28:29], v[28:29], v[24:25], v[30:31] op_sel:[1,1,0] op_sel_hi:[1,0,1] neg_lo:[0,1,0]
    v_pk_mul_f32 v[32:33], v[48:49], v[26:27] op_sel:[0,0] op_sel_hi:[0,1]
    v_pk_fma_f32 v[48:49], v[48:49], v[26:27], v[32:33] op_sel:[1,1,0] op_sel_hi:[1,0,1] neg_lo:[0,1,0]
    v_cvt_pk_bf16_f32 v37, v48, v49
    ds_write_b32 v7, v37 offset:26400
    v_cvt_pk_bf16_f32 v34, v28, v29
    ds_write_b32 v7, v34 offset:9504
    v_pk_mul_f32 v[30:31], v[28:29], v[24:25] op_sel:[0,0] op_sel_hi:[0,1]
    v_pk_fma_f32 v[28:29], v[28:29], v[24:25], v[30:31] op_sel:[1,1,0] op_sel_hi:[1,0,1] neg_lo:[0,1,0]
    v_pk_mul_f32 v[32:33], v[56:57], v[26:27] op_sel:[0,0] op_sel_hi:[0,1]
    v_pk_fma_f32 v[56:57], v[56:57], v[26:27], v[32:33] op_sel:[1,1,0] op_sel_hi:[1,0,1] neg_lo:[0,1,0]
    v_cvt_pk_bf16_f32 v35, v56, v57
    ds_write_b32 v7, v35 offset:26928
    v_cvt_pk_bf16_f32 v36, v28, v29
    ds_write_b32 v7, v36 offset:10032
    v_pk_mul_f32 v[30:31], v[28:29], v[24:25] op_sel:[0,0] op_sel_hi:[0,1]
    v_pk_fma_f32 v[28:29], v[28:29], v[24:25], v[30:31] op_sel:[1,1,0] op_sel_hi:[1,0,1] neg_lo:[0,1,0]
    v_pk_mul_f32 v[32:33], v[64:65], v[26:27] op_sel:[0,0] op_sel_hi:[0,1]
    v_pk_fma_f32 v[64:65], v[64:65], v[26:27], v[32:33] op_sel:[1,1,0] op_sel_hi:[1,0,1] neg_lo:[0,1,0]
    v_cvt_pk_bf16_f32 v37, v64, v65
    ds_write_b32 v7, v37 offset:27456
    v_cvt_pk_bf16_f32 v34, v28, v29
    ds_write_b32 v7, v34 offset:10560
    v_pk_mul_f32 v[30:31], v[28:29], v[24:25] op_sel:[0,0] op_sel_hi:[0,1]
    v_pk_fma_f32 v[28:29], v[28:29], v[24:25], v[30:31] op_sel:[1,1,0] op_sel_hi:[1,0,1] neg_lo:[0,1,0]
    v_pk_mul_f32 v[32:33], v[72:73], v[26:27] op_sel:[0,0] op_sel_hi:[0,1]
    v_pk_fma_f32 v[72:73], v[72:73], v[26:27], v[32:33] op_sel:[1,1,0] op_sel_hi:[1,0,1] neg_lo:[0,1,0]
    v_cvt_pk_bf16_f32 v35, v72, v73
    ds_write_b32 v7, v35 offset:27984
    v_cvt_pk_bf16_f32 v36, v28, v29
    ds_write_b32 v7, v36 offset:11088
    v_pk_mul_f32 v[30:31], v[28:29], v[24:25] op_sel:[0,0] op_sel_hi:[0,1]
    v_pk_fma_f32 v[28:29], v[28:29], v[24:25], v[30:31] op_sel:[1,1,0] op_sel_hi:[1,0,1] neg_lo:[0,1,0]
    v_pk_mul_f32 v[32:33], v[40:41], v[26:27] op_sel:[0,0] op_sel_hi:[0,1]
    v_pk_fma_f32 v[40:41], v[40:41], v[26:27], v[32:33] op_sel:[1,1,0] op_sel_hi:[1,0,1] neg_lo:[0,1,0]
    v_cvt_pk_bf16_f32 v37, v40, v41
    ds_write_b32 v7, v37 offset:28512
    v_cvt_pk_bf16_f32 v34, v28, v29
    ds_write_b32 v7, v34 offset:11616
    v_pk_mul_f32 v[30:31], v[28:29], v[24:25] op_sel:[0,0] op_sel_hi:[0,1]
    v_pk_fma_f32 v[28:29], v[28:29], v[24:25], v[30:31] op_sel:[1,1,0] op_sel_hi:[1,0,1] neg_lo:[0,1,0]
    v_pk_mul_f32 v[32:33], v[56:57], v[26:27] op_sel:[0,0] op_sel_hi:[0,1]
    v_pk_fma_f32 v[56:57], v[56:57], v[26:27], v[32:33] op_sel:[1,1,0] op_sel_hi:[1,0,1] neg_lo:[0,1,0]
    v_cvt_pk_bf16_f32 v35, v56, v57
    ds_write_b32 v7, v35 offset:29040
    v_cvt_pk_bf16_f32 v36, v28, v29
    ds_write_b32 v7, v36 offset:12144
    v_pk_mul_f32 v[30:31], v[28:29], v[24:25] op_sel:[0,0] op_sel_hi:[0,1]
    v_pk_fma_f32 v[28:29], v[28:29], v[24:25], v[30:31] op_sel:[1,1,0] op_sel_hi:[1,0,1] neg_lo:[0,1,0]
    v_pk_mul_f32 v[32:33], v[72:73], v[26:27] op_sel:[0,0] op_sel_hi:[0,1]
    v_pk_fma_f32 v[72:73], v[72:73], v[26:27], v[32:33] op_sel:[1,1,0] op_sel_hi:[1,0,1] neg_lo:[0,1,0]
    v_cvt_pk_bf16_f32 v37, v72, v73
    ds_write_b32 v7, v37 offset:29568
    v_cvt_pk_bf16_f32 v34, v28, v29
    ds_write_b32 v7, v34 offset:12672
    v_pk_mul_f32 v[30:31], v[28:29], v[24:25] op_sel:[0,0] op_sel_hi:[0,1]
    v_pk_fma_f32 v[28:29], v[28:29], v[24:25], v[30:31] op_sel:[1,1,0] op_sel_hi:[1,0,1] neg_lo:[0,1,0]
    v_pk_mul_f32 v[32:33], v[40:41], v[26:27] op_sel:[0,0] op_sel_hi:[0,1]
    v_pk_fma_f32 v[40:41], v[40:41], v[26:27], v[32:33] op_sel:[1,1,0] op_sel_hi:[1,0,1] neg_lo:[0,1,0]
    v_cvt_pk_bf16_f32 v35, v40, v41
    ds_write_b32 v7, v35 offset:30096
    v_cvt_pk_bf16_f32 v36, v28, v29
    ds_write_b32 v7, v36 offset:13200
    v_pk_mul_f32 v[30:31], v[28:29], v[24:25] op_sel:[0,0] op_sel_hi:[0,1]
    v_pk_fma_f32 v[28:29], v[28:29], v[24:25], v[30:31] op_sel:[1,1,0] op_sel_hi:[1,0,1] neg_lo:[0,1,0]
    v_pk_mul_f32 v[32:33], v[56:57], v[26:27] op_sel:[0,0] op_sel_hi:[0,1]
    v_pk_fma_f32 v[56:57], v[56:57], v[26:27], v[32:33] op_sel:[1,1,0] op_sel_hi:[1,0,1] neg_lo:[0,1,0]
    v_cvt_pk_bf16_f32 v37, v56, v57
    ds_write_b32 v7, v37 offset:30624
    v_cvt_pk_bf16_f32 v34, v28, v29
    ds_write_b32 v7, v34 offset:13728
    v_pk_mul_f32 v[30:31], v[28:29], v[24:25] op_sel:[0,0] op_sel_hi:[0,1]
    v_pk_fma_f32 v[28:29], v[28:29], v[24:25], v[30:31] op_sel:[1,1,0] op_sel_hi:[1,0,1] neg_lo:[0,1,0]
    v_pk_mul_f32 v[32:33], v[72:73], v[26:27] op_sel:[0,0] op_sel_hi:[0,1]
    v_pk_fma_f32 v[72:73], v[72:73], v[26:27], v[32:33] op_sel:[1,1,0] op_sel_hi:[1,0,1] neg_lo:[0,1,0]
    v_cvt_pk_bf16_f32 v35, v72, v73
    ds_write_b32 v7, v35 offset:31152
    v_cvt_pk_bf16_f32 v36, v28, v29
    ds_write_b32 v7, v36 offset:14256
    v_pk_mul_f32 v[30:31], v[28:29], v[24:25] op_sel:[0,0] op_sel_hi:[0,1]
    v_pk_fma_f32 v[28:29], v[28:29], v[24:25], v[30:31] op_sel:[1,1,0] op_sel_hi:[1,0,1] neg_lo:[0,1,0]
    v_cvt_pk_bf16_f32 v34, v28, v29
    ds_write_b32 v7, v34 offset:14784
    v_pk_mul_f32 v[30:31], v[28:29], v[24:25] op_sel:[0,0] op_sel_hi:[0,1]
    v_pk_fma_f32 v[28:29], v[28:29], v[24:25], v[30:31] op_sel:[1,1,0] op_sel_hi:[1,0,1] neg_lo:[0,1,0]
    v_cvt_pk_bf16_f32 v36, v28, v29
    ds_write_b32 v7, v36 offset:15312
    v_pk_mul_f32 v[30:31], v[28:29], v[24:25] op_sel:[0,0] op_sel_hi:[0,1]
    v_pk_fma_f32 v[28:29], v[28:29], v[24:25], v[30:31] op_sel:[1,1,0] op_sel_hi:[1,0,1] neg_lo:[0,1,0]
    v_cvt_pk_bf16_f32 v34, v28, v29
    ds_write_b32 v7, v34 offset:15840
    v_pk_mul_f32 v[30:31], v[28:29], v[24:25] op_sel:[0,0] op_sel_hi:[0,1]
    v_pk_fma_f32 v[28:29], v[28:29], v[24:25], v[30:31] op_sel:[1,1,0] op_sel_hi:[1,0,1] neg_lo:[0,1,0]
    v_cvt_pk_bf16_f32 v36, v28, v29
    ds_write_b32 v7, v36 offset:16368
    v_and_b32 v8, 15, v0
    v_bfe_u32 v9, v0, 4, 2
    v_and_b32 v10, 1, v9
    v_lshrrev_b32 v11, 1, v9
    v_lshlrev_b32 v10, 8, v10
    v_lshl_add_u32 v10, v11, 7, v10
    v_add_u32 v10, s33, v10
    s_lshl_b32 s11, s29, 4
    v_add_u32 v11, s11, v8
    s_movk_i32 s34, 528
    v_mad_u32_u24 v11, v11, s34, v10
    v_add_u32 v10, 16896, v10
    v_bfe_u32 v12, v8, 1, 1
    v_and_b32 v12, s29, v12
    v_add_u32 v12, v12, v8
    s_not_b32 s11, s29
    v_and_b32 v12, s11, v12
    v_mad_u32_u24 v12, v12, s34, v10
    v_bfe_u32 v13, v8, 2, 1
    v_add3_u32 v13, v13, v8, 1
    v_lshrrev_b32 v13, 2, v13
    v_mad_u32_u24 v13, v13, s34, v10
    v_bfe_u32 v14, v8, 3, 1
    v_add3_u32 v14, v14, v8, 3
    v_lshrrev_b32 v14, 3, v14
    v_mad_u32_u24 v14, v14, s34, v10
    s_waitcnt lgkmcnt(0)
    s_barrier
    ds_read_b128 v[40:43], v11 offset:0
    ds_read_b128 v[44:47], v11 offset:16
    ds_read_b128 v[48:51], v11 offset:32
    ds_read_b128 v[52:55], v11 offset:48
    ds_read_b128 v[56:59], v11 offset:64
    ds_read_b128 v[60:63], v11 offset:80
    ds_read_b128 v[64:67], v11 offset:96
    ds_read_b128 v[68:71], v11 offset:112
    ds_read_b128 v[72:75], v12 offset:0
    ds_read_b128 v[76:79], v12 offset:16
    ds_read_b128 v[80:83], v12 offset:32
    ds_read_b128 v[84:87], v12 offset:48
    ds_read_b128 v[88:91], v12 offset:64
    ds_read_b128 v[92:95], v12 offset:80
    ds_read_b128 v[96:99], v12 offset:96
    s_waitcnt lgkmcnt(6)
    v_mfma_f32_16x16x32_bf16 v[20:23], v[72:75], v[40:43], 0
    ds_read_b128 v[100:103], v12 offset:112
    s_waitcnt lgkmcnt(6)
    v_mfma_f32_16x16x32_bf16 v[20:23], v[76:79], v[44:47], v[20:23]
    ds_read_b128 v[104:107], v13 offset:8976
    s_waitcnt lgkmcnt(6)
    v_mfma_f32_16x16x32_bf16 v[20:23], v[80:83], v[48:51], v[20:23]
    ds_read_b128 v[108:111], v13 offset:8992
    s_waitcnt lgkmcnt(6)
    v_mfma_f32_16x16x32_bf16 v[20:23], v[84:87], v[52:55], v[20:23]
    ds_read_b128 v[112:115], v13 offset:9008
    s_waitcnt lgkmcnt(6)
    v_mfma_f32_16x16x32_bf16 v[20:23], v[88:91], v[56:59], v[20:23]
    ds_read_b128 v[116:119], v13 offset:9024
    s_waitcnt lgkmcnt(6)
    v_mfma_f32_16x16x32_bf16 v[20:23], v[92:95], v[60:63], v[20:23]
    ds_read_b128 v[120:123], v13 offset:9040
    s_waitcnt lgkmcnt(6)
    v_mfma_f32_16x16x32_bf16 v[20:23], v[96:99], v[64:67], v[20:23]
    ds_read_b128 v[124:127], v13 offset:9056
    s_waitcnt lgkmcnt(6)
    v_mfma_f32_16x16x32_bf16 v[20:23], v[100:103], v[68:71], v[20:23]
    ds_read_b128 v[128:131], v13 offset:9072
    s_waitcnt lgkmcnt(6)
    v_mfma_f32_16x16x32_bf16 v[24:27], v[104:107], v[40:43], 0
    ds_read_b128 v[132:135], v13 offset:9088
    s_waitcnt lgkmcnt(6)
    v_mfma_f32_16x16x32_bf16 v[24:27], v[108:111], v[44:47], v[24:27]
    ds_read_b128 v[136:139], v14 offset:11616
    s_waitcnt lgkmcnt(6)
    v_mfma_f32_16x16x32_bf16 v[24:27], v[112:115], v[48:51], v[24:27]
    ds_read_b128 v[140:143], v14 offset:11632
    s_waitcnt lgkmcnt(6)
    v_mfma_f32_16x16x32_bf16 v[24:27], v[116:119], v[52:55], v[24:27]
    ds_read_b128 v[144:147], v14 offset:11648
    s_waitcnt lgkmcnt(6)
    v_mfma_f32_16x16x32_bf16 v[24:27], v[120:123], v[56:59], v[24:27]
    ds_read_b128 v[148:151], v14 offset:11664
    s_waitcnt lgkmcnt(6)
    v_mfma_f32_16x16x32_bf16 v[24:27], v[124:127], v[60:63], v[24:27]
    ds_read_b128 v[152:155], v14 offset:11680
    s_waitcnt lgkmcnt(6)
    v_mfma_f32_16x16x32_bf16 v[24:27], v[128:131], v[64:67], v[24:27]
    ds_read_b128 v[156:159], v14 offset:11696
    s_waitcnt lgkmcnt(6)
    v_mfma_f32_16x16x32_bf16 v[24:27], v[132:135], v[68:71], v[24:27]
    ds_read_b128 v[160:163], v14 offset:11712
    s_waitcnt lgkmcnt(6)
    v_mfma_f32_16x16x32_bf16 v[28:31], v[136:139], v[40:43], 0
    ds_read_b128 v[164:167], v14 offset:11728
    s_waitcnt lgkmcnt(6)
    v_mfma_f32_16x16x32_bf16 v[28:31], v[140:143], v[44:47], v[28:31]
    ds_read_b128 v[168:171], v14 offset:13200
    s_waitcnt lgkmcnt(6)
    v_mfma_f32_16x16x32_bf16 v[28:31], v[144:147], v[48:51], v[28:31]
    ds_read_b128 v[172:175], v14 offset:13216
    s_waitcnt lgkmcnt(6)
    v_mfma_f32_16x16x32_bf16 v[28:31], v[148:151], v[52:55], v[28:31]
    ds_read_b128 v[176:179], v14 offset:13232
    s_waitcnt lgkmcnt(6)
    v_mfma_f32_16x16x32_bf16 v[28:31], v[152:155], v[56:59], v[28:31]
    ds_read_b128 v[180:183], v14 offset:13248
    s_waitcnt lgkmcnt(6)
    v_mfma_f32_16x16x32_bf16 v[28:31], v[156:159], v[60:63], v[28:31]
    ds_read_b128 v[184:187], v14 offset:13264
    s_waitcnt lgkmcnt(6)
    v_mfma_f32_16x16x32_bf16 v[28:31], v[160:163], v[64:67], v[28:31]
    ds_read_b128 v[188:191], v14 offset:13280
    s_waitcnt lgkmcnt(6)
    v_mfma_f32_16x16x32_bf16 v[28:31], v[164:167], v[68:71], v[28:31]
    ds_read_b128 v[192:195], v14 offset:13296
    s_waitcnt lgkmcnt(6)
    v_mfma_f32_16x16x32_bf16 v[32:35], v[168:171], v[40:43], 0
    ds_read_b128 v[196:199], v14 offset:13312
    s_waitcnt lgkmcnt(6)
    v_mfma_f32_16x16x32_bf16 v[32:35], v[172:175], v[44:47], v[32:35]
    s_waitcnt lgkmcnt(5)
    v_mfma_f32_16x16x32_bf16 v[32:35], v[176:179], v[48:51], v[32:35]
    s_waitcnt lgkmcnt(4)
    v_mfma_f32_16x16x32_bf16 v[32:35], v[180:183], v[52:55], v[32:35]
    s_waitcnt lgkmcnt(3)
    v_mfma_f32_16x16x32_bf16 v[32:35], v[184:187], v[56:59], v[32:35]
    s_waitcnt lgkmcnt(2)
    v_mfma_f32_16x16x32_bf16 v[32:35], v[188:191], v[60:63], v[32:35]
    s_waitcnt lgkmcnt(1)
    v_mfma_f32_16x16x32_bf16 v[32:35], v[192:195], v[64:67], v[32:35]
    s_waitcnt lgkmcnt(0)
    v_mfma_f32_16x16x32_bf16 v[32:35], v[196:199], v[68:71], v[32:35]
    v_lshlrev_b32 v10, 5, v8
    v_lshl_add_u32 v10, v9, 3, v10
    s_lshl_b32 s11, s29, 9
    s_sub_u32 s11, s33, s11
    s_add_u32 s11, s11, 1272
    v_sub_u32 v10, s11, v10
    v_lshrrev_b32 v15, 2, v8
    s_movk_i32 s34, 4156
    v_add_u32 v16, 0, v15
    v_and_b32 v16, 3, v16
    v_mad_u32_u24 v16, v16, s34, v10
    v_add_u32 v17, 1, v15
    v_and_b32 v17, 3, v17
    v_mad_u32_u24 v17, v17, s34, v10
    v_add_u32 v18, 2, v15
    v_and_b32 v18, 3, v18
    v_mad_u32_u24 v18, v18, s34, v10
    v_add_u32 v19, 3, v15
    v_and_b32 v19, 3, v19
    v_mad_u32_u24 v19, v19, s34, v10
    v_mul_u32_u24 v11, 4156, v9
    v_lshl_add_u32 v11, v8, 2, v11
    v_add_u32 v11, s33, v11
    v_mov_b32 v36, 0
    v_mov_b32 v37, 0
    v_mov_b32 v38, 0
    v_mov_b32 v39, 0
    v_min_u32 v12, 27, v2
    s_mul_i32 s11, s29, 4576
    s_add_u32 s11, s11, s33
    v_lshl_add_u32 v12, v12, 4, s11
    v_cvt_pk_bf16_f32 v40, v23, v22
    v_cvt_pk_bf16_f32 v41, v21, v20
    v_cvt_pk_bf16_f32 v42, v27, v26
    v_cvt_pk_bf16_f32 v43, v25, v24
    v_cvt_pk_bf16_f32 v44, v31, v30
    v_cvt_pk_bf16_f32 v45, v29, v28
    v_cvt_pk_bf16_f32 v46, v35, v34
    v_cvt_pk_bf16_f32 v47, v33, v32
    s_barrier
    ds_write_b32 v16, v40 offset:3072
    ds_write_b32 v16, v41 offset:3076
    ds_write_b32 v17, v40 offset:3072
    ds_write_b32 v17, v41 offset:3076
    ds_write_b32 v18, v40 offset:3072
    ds_write_b32 v18, v41 offset:3076
    ds_write_b32 v19, v40 offset:3072
    ds_write_b32 v19, v41 offset:3076
    ds_write_b32 v16, v42 offset:2048
    ds_write_b32 v16, v43 offset:2052
    ds_write_b32 v17, v42 offset:2048
    ds_write_b32 v17, v43 offset:2052
    ds_write_b32 v18, v42 offset:2048
    ds_write_b32 v18, v43 offset:2052
    ds_write_b32 v19, v42 offset:2048
    ds_write_b32 v19, v43 offset:2052
    ds_write_b32 v16, v44 offset:1024
    ds_write_b32 v16, v45 offset:1028
    ds_write_b32 v17, v44 offset:1024
    ds_write_b32 v17, v45 offset:1028
    ds_write_b32 v18, v44 offset:1024
    ds_write_b32 v18, v45 offset:1028
    ds_write_b32 v19, v44 offset:1024
    ds_write_b32 v19, v45 offset:1028
    ds_write_b32 v16, v46 offset:0
    ds_write_b32 v16, v47 offset:4
    ds_write_b32 v17, v46 offset:0
    ds_write_b32 v17, v47 offset:4
    ds_write_b32 v18, v46 offset:0
    ds_write_b32 v18, v47 offset:4
    ds_write_b32 v19, v46 offset:0
    ds_write_b32 v19, v47 offset:4
    ds_write_b32 v11, v36 offset:4352
    ds_write_b128 v12, v[36:39] offset:16896
    s_waitcnt vmcnt(0)
    v_and_b32 v203, 0xffff0000, v203
    v_mul_f32 v203, v203, v202
    v_lshlrev_b32 v220, 16, v200
    v_and_b32 v221, 0xffff0000, v200
    v_lshlrev_b32 v222, 16, v201
    v_and_b32 v223, 0xffff0000, v201
    v_fma_f32 v220, v220, v202, -v203
    v_fma_f32 v221, v221, v202, -v203
    v_fma_f32 v222, v222, v202, -v203
    v_fma_f32 v223, v223, v202, -v203
    v_and_b32 v207, 0xffff0000, v207
    v_mul_f32 v207, v207, v206
    v_lshlrev_b32 v224, 16, v204
    v_and_b32 v225, 0xffff0000, v204
    v_lshlrev_b32 v226, 16, v205
    v_and_b32 v227, 0xffff0000, v205
    v_fma_f32 v224, v224, v206, -v207
    v_fma_f32 v225, v225, v206, -v207
    v_fma_f32 v226, v226, v206, -v207
    v_fma_f32 v227, v227, v206, -v207
    v_and_b32 v211, 0xffff0000, v211
    v_mul_f32 v211, v211, v210
    v_lshlrev_b32 v228, 16, v208
    v_and_b32 v229, 0xffff0000, v208
    v_lshlrev_b32 v230, 16, v209
    v_and_b32 v231, 0xffff0000, v209
    v_fma_f32 v228, v228, v210, -v211
    v_fma_f32 v229, v229, v210, -v211
    v_fma_f32 v230, v230, v210, -v211
    v_fma_f32 v231, v231, v210, -v211
    v_and_b32 v215, 0xffff0000, v215
    v_mul_f32 v215, v215, v214
    v_lshlrev_b32 v232, 16, v212
    v_and_b32 v233, 0xffff0000, v212
    v_lshlrev_b32 v234, 16, v213
    v_and_b32 v235, 0xffff0000, v213
    v_fma_f32 v232, v232, v214, -v215
    v_fma_f32 v233, v233, v214, -v215
    v_fma_f32 v234, v234, v214, -v215
    v_fma_f32 v235, v235, v214, -v215
    v_and_b32 v219, 0xffff0000, v219
    v_mul_f32 v219, v219, v218
    v_lshlrev_b32 v236, 16, v216
    v_and_b32 v237, 0xffff0000, v216
    v_lshlrev_b32 v238, 16, v217
    v_and_b32 v239, 0xffff0000, v217
    v_fma_f32 v236, v236, v218, -v219
    v_fma_f32 v237, v237, v218, -v219
    v_fma_f32 v238, v238, v218, -v219
    v_fma_f32 v239, v239, v218, -v219
    v_cmp_ne_u32 vcc, 0, v0
    v_lshlrev_b32 v13, 3, v0
    v_lshlrev_b32 v14, 5, v0
    v_add_u32 v15, 63488, v13
    v_add_u32 v14, 126976, v14
    v_cndmask_b32 v220, 0, v220, vcc
    v_cndmask_b32 v221, 0, v221, vcc
    v_cndmask_b32 v222, 0, v222, vcc
    v_cndmask_b32 v223, 0, v223, vcc
    v_cvt_pk_bf16_f32 v40, v224, v228
    v_cvt_pk_bf16_f32 v41, v232, v236
    v_cvt_pk_bf16_f32 v42, v220, v224
    v_cvt_pk_bf16_f32 v43, v228, v232
    ds_write_b64 v13, v[40:41] offset:17344
    ds_write_b64 v13, v[42:43] offset:21920
    v_cvt_pk_bf16_f32 v44, v225, v229
    v_cvt_pk_bf16_f32 v45, v233, v237
    v_cvt_pk_bf16_f32 v46, v221, v225
    v_cvt_pk_bf16_f32 v47, v229, v233
    ds_write_b64 v13, v[44:45] offset:49088
    ds_write_b64 v13, v[46:47] offset:53664
    v_cvt_pk_bf16_f32 v48, v226, v230
    v_cvt_pk_bf16_f32 v49, v234, v238
    v_cvt_pk_bf16_f32 v50, v222, v226
    v_cvt_pk_bf16_f32 v51, v230, v234
    ds_write_b64 v15, v[48:49] offset:17344
    ds_write_b64 v15, v[50:51] offset:21920
    v_cvt_pk_bf16_f32 v52, v227, v231
    v_cvt_pk_bf16_f32 v53, v235, v239
    v_cvt_pk_bf16_f32 v54, v223, v227
    v_cvt_pk_bf16_f32 v55, v231, v235
    ds_write_b64 v15, v[52:53] offset:49088
    ds_write_b64 v15, v[54:55] offset:53664
    ds_write_b64 v14, v[204:205] offset:0
    ds_write_b64 v14, v[208:209] offset:8
    ds_write_b64 v14, v[212:213] offset:16
    ds_write_b64 v14, v[216:217] offset:24
    v_and_b32 v10, 3, v8
    v_sub_u32 v10, 3, v10
    v_mul_u32_u24 v10, 4160, v10
    v_lshrrev_b32 v11, 2, v8
    v_sub_u32 v11, v9, v11
    v_lshl_add_u32 v10, v11, 4, v10
    s_add_u32 s11, s33, 752
    v_add_u32 v10, s11, v10
    v_and_b32 v11, 1, v8
    v_sub_u32 v11, 1, v11
    v_mul_u32_u24 v11, 4576, v11
    v_lshrrev_b32 v12, 1, v8
    v_lshl_add_u32 v12, v12, 2, v9
    v_lshl_add_u32 v11, v12, 4, v11
    s_add_u32 s11, s33, 17344
    v_add_u32 v11, s11, v11
    s_waitcnt lgkmcnt(0)
    s_barrier
    s_cmp_ge_u32 s10, 4
    s_cbranch_scc1 conv_skip
    ds_read_b128 v[124:127], v11 offset:3584
    ds_read_b128 v[64:67], v10 offset:3584
    ds_read_b128 v[120:123], v11 offset:3072
    ds_read_b128 v[68:71], v10 offset:3072
    ds_read_b128 v[116:119], v11 offset:2560
    ds_read_b128 v[72:75], v10 offset:2560
    ds_read_b128 v[112:115], v11 offset:2048
    ds_read_b128 v[76:79], v10 offset:2048
    ds_read_b128 v[108:111], v11 offset:1536
    ds_read_b128 v[80:83], v10 offset:1536
    ds_read_b128 v[104:107], v11 offset:1024
    ds_read_b128 v[84:87], v10 offset:1024
    ds_read_b128 v[100:103], v11 offset:512
    ds_read_b128 v[88:91], v10 offset:512
    ds_read_b128 v[96:99], v11 offset:0
    ds_read_b128 v[92:95], v10 offset:0
    v_mov_b64 v[128:129], 0
    v_mov_b64 v[130:131], 0
    v_mov_b64 v[132:133], 0
    v_mov_b64 v[134:135], 0
    v_mov_b64 v[136:137], 0
    v_mov_b64 v[138:139], 0
    v_mov_b64 v[140:141], 0
    v_mov_b64 v[142:143], 0
    v_mov_b64 v[144:145], 0
    v_mov_b64 v[146:147], 0
    v_mov_b64 v[148:149], 0
    v_mov_b64 v[150:151], 0
    v_mov_b64 v[152:153], 0
    v_mov_b64 v[154:155], 0
    v_mov_b64 v[156:157], 0
    v_mov_b64 v[158:159], 0
    s_mov_b32 s11, 8
conv_loop:
    v_subrev_u32 v10, 64, v10
    v_subrev_u32 v11, 64, v11
    s_waitcnt lgkmcnt(14)
    v_mfma_f32_16x16x32_bf16 v[156:159], v[124:127], v[64:67], v[156:159]
    ds_read_b128 v[124:127], v11 offset:3584
    s_waitcnt lgkmcnt(14)
    v_mfma_f32_16x16x32_bf16 v[152:155], v[120:123], v[64:67], v[152:155]
    s_waitcnt lgkmcnt(12)
    v_mfma_f32_16x16x32_bf16 v[148:151], v[116:119], v[64:67], v[148:151]
    s_waitcnt lgkmcnt(10)
    v_mfma_f32_16x16x32_bf16 v[144:147], v[112:115], v[64:67], v[144:147]
    s_waitcnt lgkmcnt(8)
    v_mfma_f32_16x16x32_bf16 v[140:143], v[108:111], v[64:67], v[140:143]
    s_waitcnt lgkmcnt(6)
    v_mfma_f32_16x16x32_bf16 v[136:139], v[104:107], v[64:67], v[136:139]
    s_waitcnt lgkmcnt(4)
    v_mfma_f32_16x16x32_bf16 v[132:135], v[100:103], v[64:67], v[132:135]
    s_waitcnt lgkmcnt(2)
    v_mfma_f32_16x16x32_bf16 v[128:131], v[96:99], v[64:67], v[128:131]
    ds_read_b128 v[64:67], v10 offset:3584
    v_mfma_f32_16x16x32_bf16 v[156:159], v[120:123], v[68:71], v[156:159]
    ds_read_b128 v[120:123], v11 offset:3072
    v_mfma_f32_16x16x32_bf16 v[152:155], v[116:119], v[68:71], v[152:155]
    v_mfma_f32_16x16x32_bf16 v[148:151], v[112:115], v[68:71], v[148:151]
    v_mfma_f32_16x16x32_bf16 v[144:147], v[108:111], v[68:71], v[144:147]
    v_mfma_f32_16x16x32_bf16 v[140:143], v[104:107], v[68:71], v[140:143]
    v_mfma_f32_16x16x32_bf16 v[136:139], v[100:103], v[68:71], v[136:139]
    v_mfma_f32_16x16x32_bf16 v[132:135], v[96:99], v[68:71], v[132:135]
    ds_read_b128 v[68:71], v10 offset:3072
    v_mfma_f32_16x16x32_bf16 v[156:159], v[116:119], v[72:75], v[156:159]
    ds_read_b128 v[116:119], v11 offset:2560
    v_mfma_f32_16x16x32_bf16 v[152:155], v[112:115], v[72:75], v[152:155]
    v_mfma_f32_16x16x32_bf16 v[148:151], v[108:111], v[72:75], v[148:151]
    v_mfma_f32_16x16x32_bf16 v[144:147], v[104:107], v[72:75], v[144:147]
    v_mfma_f32_16x16x32_bf16 v[140:143], v[100:103], v[72:75], v[140:143]
    v_mfma_f32_16x16x32_bf16 v[136:139], v[96:99], v[72:75], v[136:139]
    ds_read_b128 v[72:75], v10 offset:2560
    v_mfma_f32_16x16x32_bf16 v[156:159], v[112:115], v[76:79], v[156:159]
    ds_read_b128 v[112:115], v11 offset:2048
    v_mfma_f32_16x16x32_bf16 v[152:155], v[108:111], v[76:79], v[152:155]
    v_mfma_f32_16x16x32_bf16 v[148:151], v[104:107], v[76:79], v[148:151]
    v_mfma_f32_16x16x32_bf16 v[144:147], v[100:103], v[76:79], v[144:147]
    v_mfma_f32_16x16x32_bf16 v[140:143], v[96:99], v[76:79], v[140:143]
    ds_read_b128 v[76:79], v10 offset:2048
    v_mfma_f32_16x16x32_bf16 v[156:159], v[108:111], v[80:83], v[156:159]
    ds_read_b128 v[108:111], v11 offset:1536
    v_mfma_f32_16x16x32_bf16 v[152:155], v[104:107], v[80:83], v[152:155]
    v_mfma_f32_16x16x32_bf16 v[148:151], v[100:103], v[80:83], v[148:151]
    v_mfma_f32_16x16x32_bf16 v[144:147], v[96:99], v[80:83], v[144:147]
    ds_read_b128 v[80:83], v10 offset:1536
    v_mfma_f32_16x16x32_bf16 v[156:159], v[104:107], v[84:87], v[156:159]
    ds_read_b128 v[104:107], v11 offset:1024
    v_mfma_f32_16x16x32_bf16 v[152:155], v[100:103], v[84:87], v[152:155]
    v_mfma_f32_16x16x32_bf16 v[148:151], v[96:99], v[84:87], v[148:151]
    ds_read_b128 v[84:87], v10 offset:1024
    v_mfma_f32_16x16x32_bf16 v[156:159], v[100:103], v[88:91], v[156:159]
    ds_read_b128 v[100:103], v11 offset:512
    v_mfma_f32_16x16x32_bf16 v[152:155], v[96:99], v[88:91], v[152:155]
    ds_read_b128 v[88:91], v10 offset:512
    s_waitcnt lgkmcnt(14)
    v_mfma_f32_16x16x32_bf16 v[156:159], v[96:99], v[92:95], v[156:159]
    ds_read_b128 v[96:99], v11 offset:0
    ds_read_b128 v[92:95], v10 offset:0
    s_sub_u32 s11, s11, 1
    s_cmp_lg_u32 s11, 0
    s_cbranch_scc1 conv_loop
    v_lshlrev_b32 v12, 7, v9
    v_lshl_add_u32 v12, v8, 2, v12
    v_add_u32 v12, s33, v12
    s_waitcnt lgkmcnt(0)
    v_cvt_pk_bf16_f32 v128, v128, v129
    v_cvt_pk_bf16_f32 v130, v130, v131
    ds_write_b32 v12, v128 offset:26048
    ds_write_b32 v12, v130 offset:26112
    v_cvt_pk_bf16_f32 v132, v132, v133
    v_cvt_pk_bf16_f32 v134, v134, v135
    ds_write_b32 v12, v132 offset:26560
    ds_write_b32 v12, v134 offset:26624
    v_cvt_pk_bf16_f32 v136, v136, v137
    v_cvt_pk_bf16_f32 v138, v138, v139
    ds_write_b32 v12, v136 offset:27072
    ds_write_b32 v12, v138 offset:27136
    v_cvt_pk_bf16_f32 v140, v140, v141
    v_cvt_pk_bf16_f32 v142, v142, v143
    ds_write_b32 v12, v140 offset:27584
    ds_write_b32 v12, v142 offset:27648
    v_cvt_pk_bf16_f32 v144, v144, v145
    v_cvt_pk_bf16_f32 v146, v146, v147
    ds_write_b32 v12, v144 offset:28096
    ds_write_b32 v12, v146 offset:28160
    v_cvt_pk_bf16_f32 v148, v148, v149
    v_cvt_pk_bf16_f32 v150, v150, v151
    ds_write_b32 v12, v148 offset:28608
    ds_write_b32 v12, v150 offset:28672
    v_cvt_pk_bf16_f32 v152, v152, v153
    v_cvt_pk_bf16_f32 v154, v154, v155
    ds_write_b32 v12, v152 offset:29120
    ds_write_b32 v12, v154 offset:29184
    v_cvt_pk_bf16_f32 v156, v156, v157
    v_cvt_pk_bf16_f32 v158, v158, v159
    ds_write_b32 v12, v156 offset:29632
    ds_write_b32 v12, v158 offset:29696
conv_skip:
    v_lshlrev_b32 v250, 16, v254
    v_and_b32 v251, 0xffff0000, v254
    v_lshlrev_b32 v252, 16, v255
    v_and_b32 v253, 0xffff0000, v255
    v_mul_f32 v40, 0xbfb8aa3b, v224
    v_mul_f32 v41, 0xbfb8aa3b, v225
    v_mul_f32 v42, 0xbfb8aa3b, v226
    v_mul_f32 v43, 0xbfb8aa3b, v227
    v_mul_f32 v44, 0xbfb8aa3b, v228
    v_mul_f32 v45, 0xbfb8aa3b, v229
    v_mul_f32 v46, 0xbfb8aa3b, v230
    v_mul_f32 v47, 0xbfb8aa3b, v231
    v_mul_f32 v48, 0xbfb8aa3b, v232
    v_mul_f32 v49, 0xbfb8aa3b, v233
    v_mul_f32 v50, 0xbfb8aa3b, v234
    v_mul_f32 v51, 0xbfb8aa3b, v235
    v_mul_f32 v52, 0xbfb8aa3b, v236
    v_mul_f32 v53, 0xbfb8aa3b, v237
    v_mul_f32 v54, 0xbfb8aa3b, v238
    v_mul_f32 v55, 0xbfb8aa3b, v239
    v_exp_f32 v40, v40
    v_exp_f32 v41, v41
    v_exp_f32 v42, v42
    v_exp_f32 v43, v43
    v_exp_f32 v44, v44
    v_exp_f32 v45, v45
    v_exp_f32 v46, v46
    v_exp_f32 v47, v47
    v_exp_f32 v48, v48
    v_exp_f32 v49, v49
    v_exp_f32 v50, v50
    v_exp_f32 v51, v51
    v_exp_f32 v52, v52
    v_exp_f32 v53, v53
    v_exp_f32 v54, v54
    v_exp_f32 v55, v55
    v_add_f32 v40, 1.0, v40
    v_add_f32 v41, 1.0, v41
    v_add_f32 v42, 1.0, v42
    v_add_f32 v43, 1.0, v43
    v_add_f32 v44, 1.0, v44
    v_add_f32 v45, 1.0, v45
    v_add_f32 v46, 1.0, v46
    v_add_f32 v47, 1.0, v47
    v_add_f32 v48, 1.0, v48
    v_add_f32 v49, 1.0, v49
    v_add_f32 v50, 1.0, v50
    v_add_f32 v51, 1.0, v51
    v_add_f32 v52, 1.0, v52
    v_add_f32 v53, 1.0, v53
    v_add_f32 v54, 1.0, v54
    v_add_f32 v55, 1.0, v55
    v_rcp_f32 v40, v40
    v_rcp_f32 v41, v41
    v_rcp_f32 v42, v42
    v_rcp_f32 v43, v43
    v_rcp_f32 v44, v44
    v_rcp_f32 v45, v45
    v_rcp_f32 v46, v46
    v_rcp_f32 v47, v47
    v_rcp_f32 v48, v48
    v_rcp_f32 v49, v49
    v_rcp_f32 v50, v50
    v_rcp_f32 v51, v51
    v_rcp_f32 v52, v52
    v_rcp_f32 v53, v53
    v_rcp_f32 v54, v54
    v_rcp_f32 v55, v55
    v_mul_f32 v40, v40, v224
    v_mul_f32 v41, v41, v225
    v_mul_f32 v42, v42, v226
    v_mul_f32 v43, v43, v227
    v_mul_f32 v44, v44, v228
    v_mul_f32 v45, v45, v229
    v_mul_f32 v46, v46, v230
    v_mul_f32 v47, v47, v231
    v_mul_f32 v48, v48, v232
    v_mul_f32 v49, v49, v233
    v_mul_f32 v50, v50, v234
    v_mul_f32 v51, v51, v235
    v_mul_f32 v52, v52, v236
    v_mul_f32 v53, v53, v237
    v_mul_f32 v54, v54, v238
    v_mul_f32 v55, v55, v239
    v_mul_f32 v224, v250, v224
    v_mul_f32 v225, v251, v225
    v_mul_f32 v226, v252, v226
    v_mul_f32 v227, v253, v227
    v_mul_f32 v228, v250, v228
    v_mul_f32 v229, v251, v229
    v_mul_f32 v230, v252, v230
    v_mul_f32 v231, v253, v231
    v_mul_f32 v232, v250, v232
    v_mul_f32 v233, v251, v233
    v_mul_f32 v234, v252, v234
    v_mul_f32 v235, v253, v235
    v_mul_f32 v236, v250, v236
    v_mul_f32 v237, v251, v237
    v_mul_f32 v238, v252, v238
    v_mul_f32 v239, v253, v239
    v_mul_u32_u24 v16, 4608, v0
    v_add_u32 v16, v5, v16
    s_waitcnt lgkmcnt(0)
    s_barrier
    ds_read_b64 v[56:57], v13 offset:26048
    ds_read_b64 v[58:59], v13 offset:57792
    ds_read_b64 v[60:61], v15 offset:26048
    ds_read_b64 v[62:63], v15 offset:57792
    s_waitcnt lgkmcnt(0)
    v_lshlrev_b32 v64, 16, v56
    v_lshlrev_b32 v68, 16, v204
    v_add_f32 v64, v64, v224
    v_fmac_f32 v68, v64, v40
    v_lshlrev_b32 v65, 16, v58
    v_and_b32 v69, 0xffff0000, v204
    v_add_f32 v65, v65, v225
    v_fmac_f32 v69, v65, v41
    v_lshlrev_b32 v66, 16, v60
    v_lshlrev_b32 v70, 16, v205
    v_add_f32 v66, v66, v226
    v_fmac_f32 v70, v66, v42
    v_lshlrev_b32 v67, 16, v62
    v_and_b32 v71, 0xffff0000, v205
    v_add_f32 v67, v67, v227
    v_fmac_f32 v71, v67, v43
    v_cvt_pk_bf16_f32 v72, v68, v69
    v_cvt_pk_bf16_f32 v73, v70, v71
    global_store_dwordx2 v16, v[72:73], s[6:7] offset:0
    v_and_b32 v64, 0xffff0000, v56
    v_lshlrev_b32 v68, 16, v208
    v_add_f32 v64, v64, v228
    v_fmac_f32 v68, v64, v44
    v_and_b32 v65, 0xffff0000, v58
    v_and_b32 v69, 0xffff0000, v208
    v_add_f32 v65, v65, v229
    v_fmac_f32 v69, v65, v45
    v_and_b32 v66, 0xffff0000, v60
    v_lshlrev_b32 v70, 16, v209
    v_add_f32 v66, v66, v230
    v_fmac_f32 v70, v66, v46
    v_and_b32 v67, 0xffff0000, v62
    v_and_b32 v71, 0xffff0000, v209
    v_add_f32 v67, v67, v231
    v_fmac_f32 v71, v67, v47
    v_cvt_pk_bf16_f32 v74, v68, v69
    v_cvt_pk_bf16_f32 v75, v70, v71
    global_store_dwordx2 v16, v[74:75], s[6:7] offset:1152
    v_lshlrev_b32 v64, 16, v57
    v_lshlrev_b32 v68, 16, v212
    v_add_f32 v64, v64, v232
    v_fmac_f32 v68, v64, v48
    v_lshlrev_b32 v65, 16, v59
    v_and_b32 v69, 0xffff0000, v212
    v_add_f32 v65, v65, v233
    v_fmac_f32 v69, v65, v49
    v_lshlrev_b32 v66, 16, v61
    v_lshlrev_b32 v70, 16, v213
    v_add_f32 v66, v66, v234
    v_fmac_f32 v70, v66, v50
    v_lshlrev_b32 v67, 16, v63
    v_and_b32 v71, 0xffff0000, v213
    v_add_f32 v67, v67, v235
    v_fmac_f32 v71, v67, v51
    v_cvt_pk_bf16_f32 v76, v68, v69
    v_cvt_pk_bf16_f32 v77, v70, v71
    global_store_dwordx2 v16, v[76:77], s[6:7] offset:2304
    v_and_b32 v64, 0xffff0000, v57
    v_lshlrev_b32 v68, 16, v216
    v_add_f32 v64, v64, v236
    v_fmac_f32 v68, v64, v52
    v_and_b32 v65, 0xffff0000, v59
    v_and_b32 v69, 0xffff0000, v216
    v_add_f32 v65, v65, v237
    v_fmac_f32 v69, v65, v53
    v_and_b32 v66, 0xffff0000, v61
    v_lshlrev_b32 v70, 16, v217
    v_add_f32 v66, v66, v238
    v_fmac_f32 v70, v66, v54
    v_and_b32 v67, 0xffff0000, v63
    v_and_b32 v71, 0xffff0000, v217
    v_add_f32 v67, v67, v239
    v_fmac_f32 v71, v67, v55
    v_cvt_pk_bf16_f32 v78, v68, v69
    v_cvt_pk_bf16_f32 v79, v70, v71
    global_store_dwordx2 v16, v[78:79], s[6:7] offset:3456
    s_cmp_lg_u32 s10, 7
    s_cbranch_scc1 conv_wait
    v_and_b32 v17, 7, v0
    v_lshlrev_b32 v18, 2, v17
    v_add_u32 v18, 32768, v18
    global_load_dword v19, v18, s[8:9]
    s_mul_i32 s11, s2, 9216
    s_add_u32 s11, s11, 69632
    v_lshl_add_u32 v18, v2, 4, s11
    v_add_u32 v20, 4096, v18
    global_load_dwordx4 v[80:83], v18, s[8:9] offset:-4096
    global_load_dwordx4 v[84:87], v18, s[8:9] offset:-3072
    global_load_dwordx4 v[88:91], v18, s[8:9] offset:-2048
    global_load_dwordx4 v[92:95], v18, s[8:9] offset:-1024
    global_load_dwordx4 v[96:99], v18, s[8:9] offset:0
    global_load_dwordx4 v[100:103], v18, s[8:9] offset:1024
    global_load_dwordx4 v[104:107], v18, s[8:9] offset:2048
    global_load_dwordx4 v[108:111], v18, s[8:9] offset:3072
    global_load_dwordx4 v[112:115], v20, s[8:9] offset:0
    s_waitcnt vmcnt(9)
    v_and_b32 v21, 0x7ff, v19
    v_sub_u32 v21, 2047, v21
    v_lshlrev_b32 v22, 1, v21
    v_add_u32 v23, 63488, v22
    v_lshlrev_b32 v24, 3, v21
    v_add_u32 v24, 126976, v24
    ds_read_b64 v[26:27], v24
    ds_read_u16 v28, v22 offset:17344
    ds_read_u16 v32, v22 offset:26048
    ds_read_u16 v29, v22 offset:49088
    ds_read_u16 v33, v22 offset:57792
    ds_read_u16 v30, v23 offset:17344
    ds_read_u16 v34, v23 offset:26048
    ds_read_u16 v31, v23 offset:49088
    ds_read_u16 v35, v23 offset:57792
    v_lshlrev_b32 v19, 5, v19
    v_not_b32 v25, v19
    v_ashrrev_i32 v25, 31, v25
    v_or_b32 v25, 0x80000000, v25
    v_xor_b32 v19, v19, v25
    v_and_b32 v19, 0xffff0000, v19
    v_mul_f32 v19, 0xbfb8aa3b, v19
    v_exp_f32 v19, v19
    v_mul_u32_u24 v21, 1152, v21
    v_add_f32 v19, 1.0, v19
    v_rcp_f32 v19, v19
    v_add_u32 v21, v5, v21
    s_waitcnt vmcnt(0)
    v_pk_add_f32 v[80:81], v[80:81], v[84:85]
    v_pk_add_f32 v[82:83], v[82:83], v[86:87]
    v_pk_add_f32 v[80:81], v[80:81], v[88:89]
    v_pk_add_f32 v[82:83], v[82:83], v[90:91]
    v_pk_add_f32 v[80:81], v[80:81], v[92:93]
    v_pk_add_f32 v[82:83], v[82:83], v[94:95]
    v_pk_add_f32 v[80:81], v[80:81], v[96:97]
    v_pk_add_f32 v[82:83], v[82:83], v[98:99]
    v_pk_add_f32 v[80:81], v[80:81], v[100:101]
    v_pk_add_f32 v[82:83], v[82:83], v[102:103]
    v_pk_add_f32 v[80:81], v[80:81], v[104:105]
    v_pk_add_f32 v[82:83], v[82:83], v[106:107]
    v_pk_add_f32 v[80:81], v[80:81], v[108:109]
    v_pk_add_f32 v[82:83], v[82:83], v[110:111]
    v_pk_add_f32 v[80:81], v[80:81], v[112:113]
    v_pk_add_f32 v[82:83], v[82:83], v[114:115]
    s_nop 0
    v_add_f32_dpp v80, v80, v80 row_ror:8 row_mask:0xf bank_mask:0xf
    v_add_f32_dpp v81, v81, v81 row_ror:8 row_mask:0xf bank_mask:0xf
    v_add_f32_dpp v82, v82, v82 row_ror:8 row_mask:0xf bank_mask:0xf
    v_add_f32_dpp v83, v83, v83 row_ror:8 row_mask:0xf bank_mask:0xf
    v_mov_b32 v84, v80
    v_mov_b32 v85, v81
    v_mov_b32 v86, v82
    v_mov_b32 v87, v83
    v_permlane16_swap_b32 v80, v84
    v_permlane16_swap_b32 v81, v85
    v_permlane16_swap_b32 v82, v86
    v_permlane16_swap_b32 v83, v87
    v_add_f32 v80, v80, v84
    v_add_f32 v81, v81, v85
    v_add_f32 v82, v82, v86
    v_add_f32 v83, v83, v87
    v_mov_b32 v84, v80
    v_mov_b32 v85, v81
    v_mov_b32 v86, v82
    v_mov_b32 v87, v83
    v_permlane32_swap_b32 v80, v84
    v_permlane32_swap_b32 v81, v85
    v_permlane32_swap_b32 v82, v86
    v_permlane32_swap_b32 v83, v87
    v_add_f32 v80, v80, v84
    v_add_f32 v81, v81, v85
    v_add_f32 v82, v82, v86
    v_add_f32 v83, v83, v87
    s_waitcnt lgkmcnt(0)
    v_lshlrev_b32 v28, 16, v28
    v_lshlrev_b32 v32, 16, v32
    v_fma_f32 v80, v80, v19, v28
    v_fmac_f32 v32, v28, v250
    v_mul_f32 v84, 0xbfb8aa3b, v80
    v_exp_f32 v84, v84
    v_lshlrev_b32 v88, 16, v26
    v_add_f32 v84, 1.0, v84
    v_rcp_f32 v84, v84
    v_mul_f32 v80, v80, v32
    v_fmac_f32 v88, v80, v84
    v_lshlrev_b32 v29, 16, v29
    v_lshlrev_b32 v33, 16, v33
    v_fma_f32 v81, v81, v19, v29
    v_fmac_f32 v33, v29, v251
    v_mul_f32 v85, 0xbfb8aa3b, v81
    v_exp_f32 v85, v85
    v_and_b32 v89, 0xffff0000, v26
    v_add_f32 v85, 1.0, v85
    v_rcp_f32 v85, v85
    v_mul_f32 v81, v81, v33
    v_fmac_f32 v89, v81, v85
    v_lshlrev_b32 v30, 16, v30
    v_lshlrev_b32 v34, 16, v34
    v_fma_f32 v82, v82, v19, v30
    v_fmac_f32 v34, v30, v252
    v_mul_f32 v86, 0xbfb8aa3b, v82
    v_exp_f32 v86, v86
    v_lshlrev_b32 v90, 16, v27
    v_add_f32 v86, 1.0, v86
    v_rcp_f32 v86, v86
    v_mul_f32 v82, v82, v34
    v_fmac_f32 v90, v82, v86
    v_lshlrev_b32 v31, 16, v31
    v_lshlrev_b32 v35, 16, v35
    v_fma_f32 v83, v83, v19, v31
    v_fmac_f32 v35, v31, v253
    v_mul_f32 v87, 0xbfb8aa3b, v83
    v_exp_f32 v87, v87
    v_and_b32 v91, 0xffff0000, v27
    v_add_f32 v87, 1.0, v87
    v_rcp_f32 v87, v87
    v_mul_f32 v83, v83, v35
    v_fmac_f32 v91, v83, v87
    v_cvt_pk_bf16_f32 v88, v88, v89
    v_cvt_pk_bf16_f32 v89, v90, v91
    s_barrier
    s_mov_b64 exec, 0xff
    global_store_dwordx2 v21, v[88:89], s[6:7]
    s_endpgm
conv_wait:
    s_waitcnt vmcnt(0)
    s_barrier
conv_end:
    s_endpgm
.section .rodata,"a"
.p2align 6
.amdhsa_kernel ln_kernel
  .amdhsa_next_free_vgpr 56
  .amdhsa_next_free_sgpr 40
  .amdhsa_accum_offset 56
  .amdhsa_group_segment_fixed_size 0
  .amdhsa_kernarg_size 136
  .amdhsa_user_sgpr_count 2
  .amdhsa_user_sgpr_kernarg_segment_ptr 1
  .amdhsa_system_sgpr_workgroup_id_x 1
  .amdhsa_float_denorm_mode_32 3
.end_amdhsa_kernel
.p2align 6
.amdhsa_kernel ffn_kernel
  .amdhsa_next_free_vgpr 256
  .amdhsa_next_free_sgpr 40
  .amdhsa_accum_offset 256
  .amdhsa_group_segment_fixed_size 0
  .amdhsa_kernarg_size 136
  .amdhsa_user_sgpr_count 2
  .amdhsa_user_sgpr_kernarg_segment_ptr 1
  .amdhsa_system_sgpr_workgroup_id_x 1
  .amdhsa_float_denorm_mode_32 3
.end_amdhsa_kernel
.p2align 6
.amdhsa_kernel conv_kernel
  .amdhsa_next_free_vgpr 256
  .amdhsa_next_free_sgpr 40
  .amdhsa_accum_offset 256
  .amdhsa_group_segment_fixed_size 0
  .amdhsa_kernarg_size 136
  .amdhsa_user_sgpr_count 2
  .amdhsa_user_sgpr_kernarg_segment_ptr 1
  .amdhsa_system_sgpr_workgroup_id_x 1
  .amdhsa_float_denorm_mode_32 3
.end_amdhsa_kernel
```

```asm
; @launch grid=(256,1,1) block=(512,1,1) lds=163840
.amdgcn_target "amdgcn-amd-amdhsa--gfx950"
.text
.globl recurrent_scan__ssm_conv_s4__moe_arch_mod__prompt_kernel
.p2align 8
.type recurrent_scan__ssm_conv_s4__moe_arch_mod__prompt_kernel,@function
recurrent_scan__ssm_conv_s4__moe_arch_mod__prompt_kernel:
    s_load_dwordx16 s[4:19], s[0:1], 0
    s_load_dwordx16 s[20:35], s[0:1], 64
    s_load_dwordx2 s[36:37], s[0:1], 128
    s_cmp_ge_u32 s2, 256
    s_cbranch_scc1 L_end
    s_lshr_b32 s41, s2, 3
    s_getpc_b64 s[42:43]
L_pc:
    s_mul_i32 s47, s41, 640
    s_add_u32 s42, s42, s47
    s_addc_u32 s43, s43, 0
    v_lshlrev_b32 v4, 7, v0
    v_mov_b32 v5, s43
    v_add_co_u32 v4, vcc, s42, v4
    v_lshrrev_b32 v1, 6, v0
    v_and_b32 v2, 63, v0
    v_addc_co_u32 v5, vcc, 0, v5, vcc
    v_cmp_gt_u32 vcc, 5, v0
    s_cmp_lt_u32 s47, L_end - L_pc - 516
    s_cselect_b64 vcc, vcc, 0
    s_and_saveexec_b64 s[48:49], vcc
    s_cbranch_execz L_nopf
    global_load_dword v255, v[4:5], off
L_nopf:
    s_mov_b64 exec, -1
    v_readfirstlane_b32 s39, v1
    s_and_b32 s40, s2, 7
    s_mul_i32 s42, s2, 9216
    v_lshlrev_b32 v3, 4, v2
    v_lshlrev_b32 v4, 1, v2
    v_mul_u32_u24 v5, 1152, v1
    v_add3_u32 v6, v5, v3, s42
    v_add3_u32 v7, v5, v4, s42
    s_waitcnt lgkmcnt(0)
    global_load_dwordx4 v[12:15], v6, s[4:5]
    global_load_ushort v16, v7, s[4:5] offset:1024
    s_load_dword s38, s[36:37], 0
    global_load_dwordx4 v[20:23], v3, s[24:25]
    global_load_ushort v24, v4, s[24:25] offset:1024
    s_and_b32 s51, s39, 3
    s_lshr_b32 s52, s39, 2
    s_cmp_lt_u32 s41, 18
    s_cbranch_scc1 L_conv_pre
    s_cmp_lt_u32 s41, 27
    s_cbranch_scc1 L_ffn_pre
    s_sub_u32 s53, s41, 27
    s_and_b32 s58, s39, 1
    s_lshr_b32 s43, s39, 1
    s_mul_i32 s42, s43, 320
    s_add_u32 s42, s42, 2304
    s_cmp_eq_u32 s43, 0
    s_cmovk_i32 s42, 1152
    s_cmp_eq_u32 s43, 1
    s_cselect_b32 s48, 1, 0
    s_mul_i32 s59, s58, 320
    s_cmp_eq_u32 s43, 3
    s_cselect_b32 s42, s59, s42
    s_cmovk_i32 s58, 2
    s_lshl_b32 s53, s53, 6
    s_add_u32 s42, s42, s53
    s_mul_i32 s43, s40, 1152
    s_add_u32 s43, s43, 884736
    s_mul_i32 s59, s40, 663552
    s_cmp_eq_u32 s58, 0
    s_cselect_b32 s56, s26, s28
    s_cselect_b32 s57, s27, s29
    s_cmp_eq_u32 s58, 2
    s_cselect_b32 s56, s30, s56
    s_cselect_b32 s57, s31, s57
    s_cselect_b32 s43, s59, s43
    s_movk_i32 s58, 128
    s_movk_i32 s59, 8064
    s_movk_i32 s60, 4319
    s_cmov_b32 s58, 73728
    s_cmov_b32 s59, -663424
    s_cmovk_i32 s60, 5183
    v_add_u32 v76, s42, v2
    v_min_u32 v76, s60, v76
    v_mul_u32_u24 v63, 7282, v76
    v_lshrrev_b32 v63, 16, v63
    v_mul_u32_u24 v76, s58, v76
    v_mad_i32_i24 v76, v63, s59, v76
    v_add_u32 v76, s43, v76
    s_barrier
    s_mov_b32 s47, 0
    s_cmp_ge_u32 s39, 2
    s_cbranch_scc1 L_lnp
    global_load_dword v1, v76, s[56:57]
    s_mov_b32 s47, 1
    s_branch L_lnp
L_ffn_pre:
    s_sub_u32 s54, s41, 18
    s_mul_i32 s50, s40, 9
    s_add_u32 s50, s50, s54
    v_bfe_u32 v76, v0, 3, 5
    v_bfe_u32 v61, v0, 4, 1
    v_bfe_u32 v62, v0, 6, 1
    v_lshl_add_u32 v61, v62, 1, v61
    v_lshlrev_b32 v61, 1, v61
    v_and_b32 v62, 7, v0
    v_xor_b32 v61, v61, v62
    v_mul_u32_u24 v76, 9216, v76
    v_lshlrev_b32 v61, 4, v61
    s_lshl_b32 s42, s50, 7
    v_add3_u32 v76, v76, v61, s42
    s_lshl_b32 s53, s51, 10
    s_cmp_eq_u32 s52, 0
    s_cselect_b32 s56, s26, s28
    s_cselect_b32 s57, s27, s29
    s_cselect_b32 s42, 0, 73728
    s_add_u32 s42, s53, s42
    s_barrier
    s_add_u32 m0, s42, 0
    s_nop 0
    global_load_lds_dwordx4 v76, s[56:57]
    v_add_u32 v76, 294912, v76
    s_add_u32 m0, s42, 4096
    s_nop 0
    global_load_lds_dwordx4 v76, s[56:57]
    v_add_u32 v76, 294912, v76
    s_add_u32 m0, s42, 8192
    s_nop 0
    global_load_lds_dwordx4 v76, s[56:57]
    v_add_u32 v76, 294912, v76
    v_mov_b32 v62, 0
    v_mov_b32 v63, 0
    v_lshrrev_b32 v61, 1, v3
    v_add_u32 v61, 147456, v61
    ds_write_b64 v61, v[62:63]
    s_mov_b32 s47, 3
    s_mov_b32 s48, 0
    s_branch L_lnp
L_conv_pre:
    s_mul_i32 s50, s40, 18
    s_add_u32 s50, s50, s41
    s_lshl_b32 s53, s50, 2
    s_add_u32 s53, s53, s51
    s_lshl_b32 s42, s53, 8
    s_lshl_b32 s43, s52, 7
    s_add_u32 s42, s42, s43
    v_add_u32 v60, s42, v4
    s_lshl_b32 s54, s50, 3
    s_lshl_b32 s42, s53, 1
    v_mov_b32 v61, s42
    s_barrier
    global_load_ushort v70, v61, s[18:19]
    global_load_ushort v71, v61, s[20:21]
    global_load_ushort v64, v60, s[6:7]
    global_load_ushort v65, v60, s[8:9]
    global_load_ushort v66, v60, s[10:11]
    global_load_ushort v67, v60, s[12:13]
    global_load_ushort v68, v60, s[14:15]
    global_load_ushort v69, v60, s[16:17]
    s_lshr_b32 s42, s51, 1
    s_mul_i32 s42, s42, 1472
    s_and_b32 s58, s51, 1
    s_mul_i32 s43, s51, -1152
    s_add_u32 s43, s43, 4032
    s_cmp_eq_u32 s52, 0
    s_cselect_b32 s42, s43, s42
    s_cmovk_i32 s58, 2
    s_lshl_b32 s43, s41, 6
    s_add_u32 s42, s42, s43
    s_mul_i32 s43, s40, 1152
    s_add_u32 s43, s43, 884736
    s_mul_i32 s59, s40, 663552
    s_cmp_eq_u32 s58, 0
    s_cselect_b32 s56, s26, s28
    s_cselect_b32 s57, s27, s29
    s_cmp_eq_u32 s58, 2
    s_cselect_b32 s56, s30, s56
    s_cselect_b32 s57, s31, s57
    s_cselect_b32 s43, s59, s43
    s_movk_i32 s58, 128
    s_movk_i32 s59, 8064
    s_movk_i32 s60, 4319
    s_cmov_b32 s58, 73728
    s_cmov_b32 s59, -663424
    s_cmovk_i32 s60, 5183
    v_add_u32 v76, s42, v2
    v_min_u32 v76, s60, v76
    v_mul_u32_u24 v63, 7282, v76
    v_lshrrev_b32 v63, 16, v63
    v_mul_u32_u24 v76, s58, v76
    v_mad_i32_i24 v76, v63, s59, v76
    v_add_u32 v76, s43, v76
    s_mov_b32 s47, 8
    s_lshr_b32 s42, s39, 1
    s_cmp_eq_u32 s42, 3
    s_cselect_b32 s48, 1, 0
    s_cmp_lg_u32 s42, 2
    s_cbranch_scc1 L_cp2
    global_load_dword v1, v76, s[56:57]
    s_mov_b32 s47, 9
L_cp2:
    v_and_b32 v8, 15, v0
    v_bfe_u32 v9, v0, 4, 2
    s_mul_i32 s55, s51, 33792
    v_mul_u32_u24 v78, 528, v8
    v_and_b32 v79, 0x100, v3
    v_add3_u32 v78, v78, v79, s55
    v_and_b32 v79, 0x200, v3
    v_lshrrev_b32 v79, 2, v79
    v_add_u32 v78, v78, v79
    s_mul_i32 s42, s52, 8448
    v_add_u32 v79, s42, v78
    v_and_b32 v80, 3, v0
    v_add_u32 v80, -1, v80
    v_lshrrev_b32 v80, 16, v80
    v_and_b32 v80, 6336, v80
    v_sub_u32 v80, v78, v80
    s_mul_i32 s62, s51, 9280
    s_lshl_b32 s42, s52, 9
    s_sub_u32 s42, s62, s42
    s_add_u32 s42, s42, 1080
    v_lshlrev_b32 v81, 5, v8
    v_lshl_add_u32 v81, v9, 3, v81
    v_sub_u32 v81, s42, v81
    v_bfe_u32 v83, v0, 2, 1
    v_mul_u32_u24 v83, 4476, v83
    v_sub_u32 v82, v81, v83
    v_add_u32 v82, 4476, v82
    v_add_u32 v81, v81, v83
    v_min_u32 v83, 29, v2
    s_mul_i32 s63, s51, 4640
    s_add_u32 s63, s63, 135168
    v_lshl_add_u32 v83, v83, 4, s63
    v_mov_b32 v84, 0
    v_mov_b32 v85, 0
    v_mov_b32 v86, 0
    v_mov_b32 v87, 0
    ds_write_b128 v83, v[84:87]
    v_and_b32 v88, 0x30, v3
    v_add_u32 v88, 153728, v88
    ds_write_b128 v88, v[84:87]
L_lnp:
    s_mul_i32 s43, s39, 1216
    s_add_u32 s43, s43, 154048
    v_add_u32 v52, s43, v3
    v_add_u32 v53, s43, v4
    s_lshl_b32 s43, s39, 3
    s_add_u32 s43, s43, 163776
    v_mov_b32 v54, s43
    v_bfe_u32 v55, v0, 2, 2
    v_mul_u32_u24 v55, 1216, v55
    v_and_b32 v56, 3, v0
    v_lshl_add_u32 v55, v56, 3, v55
    v_lshrrev_b32 v56, 4, v0
    v_lshl_add_u32 v55, v56, 5, v55
    v_add_u32 v55, 154048, v55
    v_lshrrev_b32 v56, 2, v0
    v_lshlrev_b32 v56, 14, v56
    v_and_b32 v57, 48, v3
    s_lshl_b32 s43, s2, 6
    s_add_u32 s43, s43, 2097152
    v_add3_u32 v56, v56, v57, s43
    v_mov_b32 v40, 0
    v_mov_b32 v41, 0
    v_mov_b32 v42, 0
    v_mov_b32 v43, 0
    v_mov_b32 v44, 0x3ae38e39
    v_mov_b32 v38, 0xbfffbfff
    v_mov_b32 v37, 0xffff
    s_lshl_b32 s58, s2, 3
    s_add_u32 s58, s58, s39
    s_xor_b32 s58, s58, 0x7ff
    s_lshl_b32 s58, s58, 5
    s_waitcnt lgkmcnt(0)
    s_add_u32 s38, s38, 0x9e370001
    s_lshr_b32 s44, s38, 16
    s_and_b32 s45, s38, 0xff
    s_and_b32 s46, s38, 0xfb
    s_bitcmp0_b32 s38, 0
    s_cselect_b32 s43, 4, 0
    s_or_b32 s46, s46, s43
    s_bitcmp1_b32 s46, s39
    s_cselect_b32 s43, 0x40004000, 0
    v_mov_b32 v39, s43
    s_xor_b32 s58, s58, s44
    v_mov_b32 v57, s58
    s_mov_b32 s42, 0x3f803f80
    s_waitcnt vmcnt(9)
    s_cmp_eq_u32 s47, 9
    s_cbranch_scc1 L_ln
    s_waitcnt vmcnt(8)
    s_cmp_eq_u32 s47, 8
    s_cbranch_scc1 L_ln
    s_waitcnt vmcnt(3)
    s_cmp_eq_u32 s47, 3
    s_cbranch_scc1 L_ln
    s_waitcnt vmcnt(1)
    s_cmp_eq_u32 s47, 1
    s_cbranch_scc1 L_ln
    s_waitcnt vmcnt(0)
L_ln:
    v_dot2c_f32_bf16 v40, s42, v12
    v_dot2c_f32_bf16 v41, v12, v12
    v_dot2c_f32_bf16 v42, v12, v20
    v_dot2c_f32_bf16 v43, s42, v20
    v_dot2c_f32_bf16 v40, s42, v13
    v_dot2c_f32_bf16 v41, v13, v13
    v_dot2c_f32_bf16 v42, v13, v21
    v_dot2c_f32_bf16 v43, s42, v21
    v_dot2c_f32_bf16 v40, s42, v14
    v_dot2c_f32_bf16 v41, v14, v14
    v_dot2c_f32_bf16 v42, v14, v22
    v_dot2c_f32_bf16 v43, s42, v22
    v_dot2c_f32_bf16 v40, s42, v15
    v_dot2c_f32_bf16 v41, v15, v15
    v_dot2c_f32_bf16 v42, v15, v23
    v_dot2c_f32_bf16 v43, s42, v23
    v_dot2c_f32_bf16 v40, s42, v16
    v_dot2c_f32_bf16 v41, v16, v16
    v_dot2c_f32_bf16 v42, v16, v24
    v_dot2c_f32_bf16 v43, s42, v24
    v_lshlrev_b32 v36, 16, v16
    v_lshlrev_b32 v28, 16, v12
    v_and_b32 v29, 0xffff0000, v12
    v_permlane32_swap_b32 v40, v42
    v_permlane32_swap_b32 v41, v43
    v_add_f32 v40, v40, v42
    v_add_f32 v41, v41, v43
    v_lshlrev_b32 v30, 16, v13
    v_and_b32 v31, 0xffff0000, v13
    v_permlane16_swap_b32 v40, v41
    v_add_f32 v40, v40, v41
    v_lshlrev_b32 v32, 16, v14
    v_and_b32 v33, 0xffff0000, v14
    v_add_f32_dpp v40, v40, v40 row_ror:8 row_mask:0xf bank_mask:0xf
    v_lshlrev_b32 v34, 16, v15
    v_and_b32 v35, 0xffff0000, v15
    v_add_f32_dpp v40, v40, v40 row_ror:4 row_mask:0xf bank_mask:0xf
    s_nop 1
    v_add_f32_dpp v40, v40, v40 row_ror:2 row_mask:0xf bank_mask:0xf
    s_nop 1
    v_add_f32_dpp v40, v40, v40 row_ror:1 row_mask:0xf bank_mask:0xf
    s_nop 0
    v_readlane_b32 s58, v40, 0
    v_readlane_b32 s59, v40, 16
    v_readlane_b32 s60, v40, 32
    v_readlane_b32 s61, v40, 48
    v_mul_f32 v40, s58, v44
    v_mul_f32 v41, s59, v44
    v_fma_f32 v41, -v40, v40, v41
    v_max_f32 v41, 0, v41
    v_cvt_pk_bf16_f32 v44, v41, v40
    v_lshlrev_b32 v41, 16, v44
    v_add_f32 v41, 0x3727c5ac, v41
    v_cvt_pk_bf16_f32 v41, v41, v41
    v_and_b32 v41, 0xffff0000, v41
    v_sqrt_f32 v41, v41
    v_and_b32 v49, 0xffff0000, v44
    v_cvt_pk_bf16_f32 v50, v49, v41
    v_and_b32 v41, 0xffff0000, v50
    v_rcp_f32 v48, v41
    v_mul_f32 v42, s61, v49
    v_mul_f32 v46, 0x3d000000, v48
    v_mul_f32 v47, v49, v46
    v_sub_f32 v42, s60, v42
    v_mul_f32 v42, v42, v48
    v_cvt_pk_bf16_f32 v42, v42, v42
    v_ashrrev_i32 v43, 31, v42
    v_or_b32 v43, 0x80000000, v43
    v_xor_b32 v42, v42, v43
    v_bitop3_b32 v51, v37, v57, v42 bitop3:0xca
    s_mov_b64 exec, 1
    ds_write_b64 v54, v[50:51]
    s_mov_b64 exec, -1
    s_waitcnt lgkmcnt(0)
    s_barrier
    s_cmp_eq_u32 s39, 1
    s_cbranch_scc0 L_ln_n
    v_and_b32 v41, 0x30, v3
    v_add_u32 v40, 163776, v41
    ds_read_b128 v[48:51], v40
    s_lshl_b32 s43, s2, 6
    s_add_u32 s43, s43, 16384
    v_add_u32 v41, s43, v41
    s_mov_b64 exec, 15
    s_waitcnt lgkmcnt(0)
    global_store_dwordx4 v41, v[48:51], s[36:37] sc1
    s_mov_b64 exec, -1
L_ln_n:
    v_fma_f32 v28, v28, v46, -v47
    v_fma_f32 v29, v29, v46, -v47
    v_fma_f32 v30, v30, v46, -v47
    v_fma_f32 v31, v31, v46, -v47
    v_fma_f32 v32, v32, v46, -v47
    v_fma_f32 v33, v33, v46, -v47
    v_fma_f32 v34, v34, v46, -v47
    v_fma_f32 v35, v35, v46, -v47
    v_fma_f32 v36, v36, v46, -v47
    v_cvt_pk_bf16_f32 v28, v28, v29
    v_cvt_pk_bf16_f32 v29, v30, v31
    v_cvt_pk_bf16_f32 v30, v32, v33
    v_cvt_pk_bf16_f32 v31, v34, v35
    v_cvt_pk_bf16_f32 v32, v36, v36
    v_bitop3_b32 v28, v28, v38, v39 bitop3:0xea
    v_bitop3_b32 v29, v29, v38, v39 bitop3:0xea
    v_bitop3_b32 v30, v30, v38, v39 bitop3:0xea
    v_bitop3_b32 v31, v31, v38, v39 bitop3:0xea
    v_bitop3_b32 v32, v32, v38, v39 bitop3:0xea
    ds_write_b128 v52, v[28:31]
    ds_write_b16 v53, v32 offset:1024
    s_waitcnt lgkmcnt(0)
    s_barrier
    ds_read_b64_tr_b16 v[28:29], v55
    ds_read_b64_tr_b16 v[30:31], v55 offset:4864
    s_cmp_eq_u32 s39, 0
    s_cbranch_scc0 L_ln_st
    ds_read_b64_tr_b16 v[32:33], v55 offset:1024
    ds_read_b64_tr_b16 v[34:35], v55 offset:5888
    v_add_u32 v38, 2097152, v56
    s_waitcnt lgkmcnt(0)
    global_store_dwordx4 v38, v[32:35], s[36:37] sc1
L_ln_st:
    s_waitcnt lgkmcnt(0)
    global_store_dwordx4 v56, v[28:31], s[36:37] sc1
    s_cmp_lt_u32 s41, 18
    s_cbranch_scc1 L_conv
    s_barrier
    s_cmp_lt_u32 s41, 27
    s_cbranch_scc1 L_ffn
    s_cmp_lt_u32 s39, 2
    s_cbranch_scc1 L_sp2
    s_waitcnt vmcnt(0)
    global_load_dword v1, v76, s[56:57]
L_sp2:
    s_mul_i32 s42, s39, 320
    s_add_u32 s42, s42, s53
    s_add_u32 s42, s42, 640
    s_mov_b32 s58, 2
    s_mul_i32 s43, s40, 1152
    s_add_u32 s43, s43, 884736
    s_mul_i32 s59, s40, 663552
    s_cmp_eq_u32 s58, 0
    s_cselect_b32 s56, s26, s28
    s_cselect_b32 s57, s27, s29
    s_cmp_eq_u32 s58, 2
    s_cselect_b32 s56, s30, s56
    s_cselect_b32 s57, s31, s57
    s_cselect_b32 s43, s59, s43
    s_movk_i32 s58, 128
    s_movk_i32 s59, 8064
    s_movk_i32 s60, 4319
    s_cmov_b32 s58, 73728
    s_cmov_b32 s59, -663424
    s_cmovk_i32 s60, 5183
    v_add_u32 v76, s42, v2
    v_min_u32 v76, s60, v76
    v_mul_u32_u24 v63, 7282, v76
    v_lshrrev_b32 v63, 16, v63
    v_mul_u32_u24 v76, s58, v76
    v_mad_i32_i24 v76, v63, s59, v76
    v_add_u32 v76, s43, v76
    s_barrier
    global_load_dword v1, v76, s[56:57]
    s_waitcnt vmcnt(0)
    s_endpgm
L_ffn:
    v_bfe_u32 v14, v0, 4, 2
    v_and_b32 v11, 7, v0
    v_mov_b32 v26, 147456
    v_mov_b32 v27, 4
    s_cmp_eq_u32 s52, 0
    s_cbranch_scc0 L_gu
    s_setprio 1
    v_lshlrev_b32 v8, 4, v0
    v_add_u32 v9, 20480, v8
    v_add_u32 v10, 8192, v9
    v_lshlrev_b32 v13, 6, v0
    v_xor_b32 v128, 65504, v13
    v_xor_b32 v129, 65472, v13
    v_xor_b32 v130, 49120, v13
    v_xor_b32 v131, 49088, v13
    v_xor_b32 v132, 32736, v13
    v_xor_b32 v133, 32704, v13
    v_xor_b32 v134, 16352, v13
    v_xor_b32 v135, 16320, v13
    v_mov_b32 v36, s44
    v_lshrrev_b32 v25, 5, v0
    v_lshl_add_u32 v25, v25, 2, v26
    s_mul_i32 s62, s39, 80
    s_add_u32 s62, s62, 147584
    v_and_b32 v15, 0x3c, v0
    v_add_u32 v15, s62, v15
    v_and_b32 v16, 3, v0
    v_mul_u32_u24 v16, 80, v16
    v_add_u32 v16, 147584, v16
    v_lshrrev_b32 v12, 3, v2
    v_lshl_add_u32 v17, v12, 2, v26
    v_lshl_add_u32 v18, v11, 2, v26
    v_and_b32 v12, 6, v12
    v_xor_b32 v12, v12, v11
    v_lshlrev_b32 v12, 4, v12
    v_lshl_add_u32 v12, v1, 7, v12
    v_add_u32 v12, 2358144, v12
    s_lshl_b32 s63, s54, 7
    s_add_u32 s63, s63, 2358144
    v_mov_b32 v37, s63
    s_movk_i32 s63, -1152
    s_mul_i32 s64, s39, 1040
    s_mul_i32 s42, s50, 73728
    s_add_u32 s12, s30, s42
    s_addc_u32 s13, s31, 0
    s_add_u32 s14, s12, 18432
    s_addc_u32 s15, s13, 0
    s_add_u32 s16, s12, 36864
    s_addc_u32 s17, s13, 0
    s_add_u32 s18, s12, 55296
    s_addc_u32 s19, s13, 0
    v_mul_u32_u24 v19, 4608, v14
    v_and_b32 v20, 0xf0, v3
    s_lshl_b32 s42, s51, 8
    v_add3_u32 v19, v19, v20, s42
    v_lshrrev_b32 v20, 1, v2
    v_mul_u32_u24 v20, 1152, v20
    v_and_b32 v21, 16, v3
    s_lshl_b32 s42, s51, 5
    v_add3_u32 v20, v20, v21, s42
    v_bfe_i32 v232, v0, 3, 1
    v_mul_u32_u24 v4, 74752, v14
    v_lshl_add_u32 v4, v11, 4, v4
    v_and_b32 v5, 9344, v232
    s_lshl_b32 s43, s50, 7
    s_add_u32 s43, s43, 65536
    s_mul_i32 s42, s51, 299008
    s_add_u32 s42, s42, s43
    v_add3_u32 v4, v4, v5, s42
    v_add_u32 v5, 18688, v4
    v_add_u32 v6, 37376, v4
    v_add_u32 v7, 56064, v4
    v_mul_u32_u24 v8, 9344, v14
    v_lshl_add_u32 v8, v11, 4, v8
    s_mul_i32 s42, s51, 37376
    s_add_u32 s42, s42, s43
    s_add_u32 s42, s42, 1196032
    v_add_u32 v8, s42, v8
    v_mov_b32 v233, s45
    v_mov_b32 v234, 0xff
    v_and_b32 v235, 0x370, v3
    v_add_u32 v235, 147968, v235
    s_lshl_b32 s42, s51, 10
    s_add_u32 s42, s42, 159376
    v_add_u32 v236, s42, v3
    v_lshl_add_u32 v237, v2, 3, s42
    s_mov_b32 s66, 0x05040100
    s_mov_b32 s67, 0x07060302
    s_movk_i32 s55, 4096
    s_waitcnt vmcnt(0)
    s_barrier
    global_load_dwordx4 v[112:115], v9, s[36:37] offset:-4096 sc1
    global_load_dwordx4 v[116:119], v9, s[36:37] offset:0 sc1
    global_load_dwordx4 v[120:123], v10, s[36:37] offset:-4096 sc1
    global_load_dwordx4 v[124:127], v10, s[36:37] offset:0 sc1
    s_barrier
L_ffn_poll:
    v_mov_b32 v24, 0
    s_waitcnt vmcnt(3)
    v_xor_b32 v28, v36, v113
    v_bitop3_b32 v24, v24, v28, v128 bitop3:0xf6
    v_xor_b32 v29, v36, v115
    v_bitop3_b32 v24, v24, v29, v129 bitop3:0xf6
    s_waitcnt vmcnt(2)
    v_xor_b32 v30, v36, v117
    v_bitop3_b32 v24, v24, v30, v130 bitop3:0xf6
    v_xor_b32 v31, v36, v119
    v_bitop3_b32 v24, v24, v31, v131 bitop3:0xf6
    s_waitcnt vmcnt(1)
    v_xor_b32 v32, v36, v121
    v_bitop3_b32 v24, v24, v32, v132 bitop3:0xf6
    v_xor_b32 v33, v36, v123
    v_bitop3_b32 v24, v24, v33, v133 bitop3:0xf6
    s_waitcnt vmcnt(0)
    v_xor_b32 v34, v36, v125
    v_bitop3_b32 v24, v24, v34, v134 bitop3:0xf6
    v_xor_b32 v35, v36, v127
    v_bitop3_b32 v24, v24, v35, v135 bitop3:0xf6
    v_and_b32 v24, 0xffff, v24
    v_cmp_ne_u32 vcc, 0, v24
    v_max3_u32 v38, v28, v29, v30
    v_max3_u32 v39, v31, v32, v33
    s_cbranch_vccz L_ffn_go
    global_load_dwordx4 v[112:115], v9, s[36:37] offset:-4096 sc1
    global_load_dwordx4 v[116:119], v9, s[36:37] offset:0 sc1
    global_load_dwordx4 v[120:123], v10, s[36:37] offset:-4096 sc1
    global_load_dwordx4 v[124:127], v10, s[36:37] offset:0 sc1
    s_sub_u32 s55, s55, 1
    s_cbranch_scc0 L_ffn_poll
    s_waitcnt vmcnt(0)
L_ffn_go:
    v_max3_u32 v38, v38, v34, v35
    v_max_u32 v38, v38, v39
    v_alignbit_b32 v24, 1, v38, 5
    v_sub_u32 v128, v28, v38
    v_sub_u32 v129, v29, v38
    v_max_u32_dpp v21, v24, v24 row_ror:1 row_mask:0xf bank_mask:0xf
    v_sub_u32 v130, v30, v38
    v_sub_u32 v131, v31, v38
    v_max_u32_dpp v21, v21, v21 row_ror:2 row_mask:0xf bank_mask:0xf
    v_sub_u32 v132, v32, v38
    v_sub_u32 v133, v33, v38
    v_max_u32_dpp v21, v21, v21 row_ror:4 row_mask:0xf bank_mask:0xf
    v_sub_u32 v134, v34, v38
    v_sub_u32 v135, v35, v38
    v_max_u32_dpp v21, v21, v21 row_ror:8 row_mask:0xf bank_mask:0xf
    v_max3_u32 v39, v128, v129, v130
    v_max3_u32 v22, v131, v132, v133
    v_max_u32_dpp v21, v21, v21 row_bcast:15 row_mask:0xa bank_mask:0xf
    s_mov_b32 exec_lo, 0x80000000
    s_mov_b32 exec_hi, 0x80000000
    ds_write_b32 v25, v21
    s_mov_b64 exec, -1
    s_mov_b32 s55, 262144
    ds_read_b128 v[112:115], v26
    ds_read_b128 v[116:119], v26 offset:16
    v_max3_u32 v39, v39, v134, v135
    v_max_u32 v39, v39, v22
    v_add_u32 v39, v39, v38
    v_alignbit_b32 v23, 1, v39, 5
L_s1:
    s_waitcnt lgkmcnt(0)
    v_min3_u32 v21, v112, v113, v114
    v_min3_u32 v22, v115, v116, v117
    v_min3_u32 v21, v21, v118, v119
    v_min_u32 v21, v21, v22
    v_cmp_eq_u32 vcc, 0, v21
    v_cmp_ge_u32 s[6:7], v24, v21
    v_cmp_ge_u32 s[8:9], v23, v21
    s_cbranch_vccz L_s1_ok
    ds_read_b128 v[112:115], v26
    ds_read_b128 v[116:119], v26 offset:16
    s_sub_u32 s55, s55, 1
    s_cbranch_scc0 L_s1
L_s1_ok:
    s_bcnt1_i32_b64 s10, s[6:7]
    v_mbcnt_lo_u32_b32 v22, s6, 0
    v_mbcnt_lo_u32_b32 v13, s8, 0
    v_mbcnt_hi_u32_b32 v22, s7, v22
    v_mbcnt_hi_u32_b32 v13, s9, v13
    v_min_u32 v22, 16, v22
    v_add_u32 v13, s10, v13
    v_lshl_add_u32 v22, v22, 2, s62
    v_min_u32 v13, 16, v13
    s_mov_b64 exec, s[6:7]
    ds_write_b32 v22, v24
    v_lshl_add_u32 v13, v13, 2, s62
    s_mov_b64 exec, s[8:9]
    ds_write_b32 v13, v23
    s_mov_b64 exec, 1
    ds_add_u32 v26, v27 offset:32
    s_mov_b64 exec, -1
    ds_read_b32 v22, v26 offset:32
    ds_read_b32 v13, v15
    ds_read_b128 v[112:115], v16 offset:0
    ds_read_b128 v[116:119], v16 offset:16
    ds_read_b128 v[120:123], v16 offset:32
    ds_read_b128 v[124:127], v16 offset:48
    v_and_b32 v24, 0x7ff, v24
    v_and_b32 v23, 0x7ff, v23
    v_mad_i32_i24 v24, v24, s63, v37
    v_mad_i32_i24 v23, v23, s63, v37
    s_mov_b64 exec, s[6:7]
    global_load_dword v239, v24, s[4:5]
    s_cmp_eq_u64 s[8:9], 0
    s_cbranch_scc1 L_no2
    s_mov_b64 exec, s[8:9]
    global_load_dword v239, v23, s[4:5]
L_no2:
    s_mov_b64 exec, -1
L_s2:
    s_waitcnt lgkmcnt(0)
    v_cmp_ne_u32 vcc, 16, v22
    v_mov_b32 v24, 0
    s_cbranch_vccz L_s2_ok
    ds_read_b32 v22, v26 offset:32
    ds_read_b32 v13, v15
    ds_read_b128 v[112:115], v16 offset:0
    ds_read_b128 v[116:119], v16 offset:16
    ds_read_b128 v[120:123], v16 offset:32
    ds_read_b128 v[124:127], v16 offset:48
    s_sub_u32 s55, s55, 1
    s_cbranch_scc0 L_s2
L_s2_ok:
    v_sub_u32 v112, v13, v112
    v_alignbit_b32 v24, v24, v112, 31
    v_sub_u32 v113, v13, v113
    v_alignbit_b32 v24, v24, v113, 31
    v_sub_u32 v114, v13, v114
    v_alignbit_b32 v24, v24, v114, 31
    v_sub_u32 v115, v13, v115
    v_alignbit_b32 v24, v24, v115, 31
    v_sub_u32 v116, v13, v116
    v_alignbit_b32 v24, v24, v116, 31
    v_sub_u32 v117, v13, v117
    v_alignbit_b32 v24, v24, v117, 31
    v_sub_u32 v118, v13, v118
    v_alignbit_b32 v24, v24, v118, 31
    v_sub_u32 v119, v13, v119
    v_alignbit_b32 v24, v24, v119, 31
    v_sub_u32 v120, v13, v120
    v_alignbit_b32 v24, v24, v120, 31
    v_sub_u32 v121, v13, v121
    v_alignbit_b32 v24, v24, v121, 31
    v_sub_u32 v122, v13, v122
    v_alignbit_b32 v24, v24, v122, 31
    v_sub_u32 v123, v13, v123
    v_alignbit_b32 v24, v24, v123, 31
    v_sub_u32 v124, v13, v124
    v_alignbit_b32 v24, v24, v124, 31
    v_sub_u32 v125, v13, v125
    v_alignbit_b32 v24, v24, v125, 31
    v_sub_u32 v126, v13, v126
    v_alignbit_b32 v24, v24, v126, 31
    v_sub_u32 v127, v13, v127
    v_alignbit_b32 v24, v24, v127, 31
    v_bcnt_u32_b32 v24, v24, 0
    s_nop 1
    v_add_u32_dpp v24, v24, v24 quad_perm:[1,0,3,2] row_mask:0xf bank_mask:0xf
    s_nop 1
    v_add_u32_dpp v24, v24, v24 quad_perm:[2,3,0,1] row_mask:0xf bank_mask:0xf
    v_cmp_gt_u32 vcc, 8, v24
    v_lshl_add_u32 v24, v24, 2, v26
    s_mov_b64 exec, vcc
    ds_write_b32 v24, v13 offset:64
    s_mov_b64 exec, -1
L_s3:
    ds_read_b32 v23, v17 offset:64
    ds_read_b32 v13, v18 offset:64
    s_add_u32 m0, s64, 150016
    s_waitcnt lgkmcnt(0)
    v_cmp_eq_u32 vcc, 0, v23
    v_and_b32 v23, 0x7ff, v23
    s_sub_u32 s55, s55, 1
    s_cselect_b64 vcc, 0, vcc
    s_cbranch_vccnz L_s3
    v_mad_i32_i24 v23, v23, s63, v12
    global_load_lds_dwordx4 v23, s[4:5]
    s_add_u32 m0, s64, 153664
    v_and_b32 v22, 0x7ff, v13
    global_load_lds_dwordx4 v23, s[4:5] offset:512
    v_sub_u32 v22, 2047, v22
    s_cmp_lg_u32 s39, 0
    s_cbranch_scc1 L_nox9
    s_mov_b32 m0, 157312
    s_nop 0
    global_load_lds_dwordx4 v23, s[4:5] offset:1024
    s_branch L_x3
L_nox9:
    v_lshlrev_b32 v24, 3, v22
    v_add_u32 v24, 16384, v24
    global_load_dword v25, v24, s[36:37] sc1
L_x3:
    global_load_dwordx4 v[40:43], v19, s[12:13] offset:0
    v_readlane_b32 s10, v13, 7
    s_mov_b32 s11, 0
    s_lshl_b32 s10, s10, 5
    v_cmp_le_u32 vcc, s10, v28
    s_nop 0
    s_bcnt1_i32_b64 s56, vcc
    s_add_u32 s11, s11, s56
    global_load_dwordx4 v[44:47], v19, s[12:13] offset:1152
    v_cmp_le_u32 vcc, s10, v29
    s_nop 0
    s_bcnt1_i32_b64 s56, vcc
    s_add_u32 s11, s11, s56
    v_cmp_le_u32 vcc, s10, v30
    s_nop 0
    s_bcnt1_i32_b64 s56, vcc
    s_add_u32 s11, s11, s56
    global_load_dwordx4 v[48:51], v19, s[12:13] offset:2304
    v_cmp_le_u32 vcc, s10, v31
    s_nop 0
    s_bcnt1_i32_b64 s56, vcc
    s_add_u32 s11, s11, s56
    v_cmp_le_u32 vcc, s10, v32
    s_nop 0
    s_bcnt1_i32_b64 s56, vcc
    s_add_u32 s11, s11, s56
    global_load_dwordx4 v[52:55], v19, s[12:13] offset:3456
    v_cmp_le_u32 vcc, s10, v33
    s_nop 0
    s_bcnt1_i32_b64 s56, vcc
    s_add_u32 s11, s11, s56
    v_cmp_le_u32 vcc, s10, v34
    s_nop 0
    s_bcnt1_i32_b64 s56, vcc
    s_add_u32 s11, s11, s56
    v_cmp_le_u32 vcc, s10, v35
    s_nop 0
    s_bcnt1_i32_b64 s56, vcc
    s_add_u32 s11, s11, s56
    s_lshl_b32 s11, s11, 16
    s_or_b32 s11, s11, 4
    v_mov_b32 v36, s11
    s_waitcnt vmcnt(4)
    s_cmp_lg_u32 s39, 1
    s_cbranch_scc1 L_nost
    ds_write_b32 v18, v25 offset:448
L_nost:
    s_mov_b64 exec, 1
    ds_add_u32 v26, v36 offset:36
    s_mov_b64 exec, -1
    global_load_dwordx4 v[56:59], v19, s[14:15] offset:0
    global_load_dwordx4 v[60:63], v19, s[14:15] offset:1152
    global_load_dwordx4 v[64:67], v19, s[14:15] offset:2304
    global_load_dwordx4 v[68:71], v19, s[14:15] offset:3456
    global_load_dwordx4 v[216:219], v20, s[12:13] offset:1024
    global_load_dwordx4 v[220:223], v20, s[16:17] offset:1024
    global_load_dwordx4 v[72:75], v19, s[16:17] offset:0
    global_load_dwordx4 v[76:79], v19, s[16:17] offset:1152
    global_load_dwordx4 v[80:83], v19, s[16:17] offset:2304
    global_load_dwordx4 v[84:87], v19, s[16:17] offset:3456
    global_load_dwordx4 v[88:91], v19, s[18:19] offset:0
    global_load_dwordx4 v[92:95], v19, s[18:19] offset:1152
    global_load_dwordx4 v[96:99], v19, s[18:19] offset:2304
    global_load_dwordx4 v[100:103], v19, s[18:19] offset:3456
L_s4:
    ds_read_b32 v24, v26 offset:36
    s_waitcnt lgkmcnt(0)
    v_readfirstlane_b32 s61, v24
    s_nop 0
    s_and_b32 s60, s61, 0xffff
    s_cmp_ge_u32 s60, 16
    s_cbranch_scc1 L_s4_ok
    s_sub_u32 s55, s55, 1
    s_cbranch_scc0 L_s4
L_s4_ok:
    s_cmp_eq_u32 s61, 0x80010
    s_cbranch_scc0 L_slow
L_dgo:
    s_waitcnt vmcnt(16)
    v_perm_b32 v112, v44, v40, s66
    v_perm_b32 v116, v44, v40, s67
    v_perm_b32 v120, v45, v41, s66
    v_perm_b32 v124, v45, v41, s67
    v_perm_b32 v128, v46, v42, s66
    v_perm_b32 v132, v46, v42, s67
    v_perm_b32 v136, v47, v43, s66
    v_perm_b32 v140, v47, v43, s67
    s_waitcnt vmcnt(14)
    v_perm_b32 v113, v52, v48, s66
    v_perm_b32 v117, v52, v48, s67
    v_perm_b32 v121, v53, v49, s66
    v_perm_b32 v125, v53, v49, s67
    v_perm_b32 v129, v54, v50, s66
    v_perm_b32 v133, v54, v50, s67
    v_perm_b32 v137, v55, v51, s66
    v_perm_b32 v141, v55, v51, s67
    s_waitcnt vmcnt(12)
    v_perm_b32 v114, v60, v56, s66
    v_perm_b32 v118, v60, v56, s67
    v_perm_b32 v122, v61, v57, s66
    v_perm_b32 v126, v61, v57, s67
    v_perm_b32 v130, v62, v58, s66
    v_perm_b32 v134, v62, v58, s67
    v_perm_b32 v138, v63, v59, s66
    v_perm_b32 v142, v63, v59, s67
    s_waitcnt vmcnt(10)
    v_perm_b32 v115, v68, v64, s66
    v_perm_b32 v119, v68, v64, s67
    v_perm_b32 v123, v69, v65, s66
    v_perm_b32 v127, v69, v65, s67
    v_perm_b32 v131, v70, v66, s66
    v_perm_b32 v135, v70, v66, s67
    v_perm_b32 v139, v71, v67, s66
    v_perm_b32 v143, v71, v67, s67
    s_waitcnt vmcnt(6)
    ds_write_b128 v236, v[216:219]
    ds_read_b64_tr_b16 v[104:105], v237
    ds_read_b64_tr_b16 v[106:107], v237 offset:512
    ds_write_b128 v236, v[220:223]
    ds_read_b64_tr_b16 v[108:109], v237
    ds_read_b64_tr_b16 v[110:111], v237 offset:512
    v_perm_b32 v144, v76, v72, s66
    v_perm_b32 v148, v76, v72, s67
    v_perm_b32 v152, v77, v73, s66
    v_perm_b32 v156, v77, v73, s67
    v_perm_b32 v160, v78, v74, s66
    v_perm_b32 v164, v78, v74, s67
    v_perm_b32 v168, v79, v75, s66
    v_perm_b32 v172, v79, v75, s67
    s_waitcnt vmcnt(4)
    v_perm_b32 v145, v84, v80, s66
    v_perm_b32 v149, v84, v80, s67
    v_perm_b32 v153, v85, v81, s66
    v_perm_b32 v157, v85, v81, s67
    v_perm_b32 v161, v86, v82, s66
    v_perm_b32 v165, v86, v82, s67
    v_perm_b32 v169, v87, v83, s66
    v_perm_b32 v173, v87, v83, s67
    s_waitcnt vmcnt(2)
    v_perm_b32 v146, v92, v88, s66
    v_perm_b32 v150, v92, v88, s67
    v_perm_b32 v154, v93, v89, s66
    v_perm_b32 v158, v93, v89, s67
    v_perm_b32 v162, v94, v90, s66
    v_perm_b32 v166, v94, v90, s67
    v_perm_b32 v170, v95, v91, s66
    v_perm_b32 v174, v95, v91, s67
    s_waitcnt vmcnt(0)
    v_perm_b32 v147, v100, v96, s66
    v_perm_b32 v151, v100, v96, s67
    v_perm_b32 v155, v101, v97, s66
    v_perm_b32 v159, v101, v97, s67
    v_perm_b32 v163, v102, v98, s66
    v_perm_b32 v167, v102, v98, s67
    v_perm_b32 v171, v103, v99, s66
    v_perm_b32 v175, v103, v99, s67
    s_barrier
    ds_read_b128 v[28:31], v235
    ds_read_b128 v[32:35], v235 offset:1024
    s_mov_b32 s58, 0x00ff00ff
    s_mov_b32 s59, 0x00ff00ff
    s_waitcnt lgkmcnt(0)
    v_mfma_f32_16x16x32_bf16 v[208:211], v[104:107], v[28:31], 0
    v_mfma_f32_16x16x32_bf16 v[208:211], v[108:111], v[32:35], v[208:211]
    v_mfma_f32_16x16x32_bf16 v[176:179], v[112:115], v[28:31], 0
    v_mfma_f32_16x16x32_bf16 v[176:179], v[144:147], v[32:35], v[176:179]
    v_mfma_f32_16x16x32_bf16 v[192:195], v[128:131], v[28:31], 0
    v_mfma_f32_16x16x32_bf16 v[192:195], v[160:163], v[32:35], v[192:195]
    v_mfma_f32_16x16x32_bf16 v[180:183], v[116:119], v[28:31], 0
    v_mfma_f32_16x16x32_bf16 v[180:183], v[148:151], v[32:35], v[180:183]
    v_mfma_f32_16x16x32_bf16 v[196:199], v[132:135], v[28:31], 0
    v_mfma_f32_16x16x32_bf16 v[196:199], v[164:167], v[32:35], v[196:199]
    v_bitop3_b32 v208, v234, v233, v208 bitop3:0xca
    s_mov_b64 exec, s[58:59]
    global_store_dwordx4 v8, v[208:211], s[36:37] sc1
    s_mov_b64 exec, -1
    v_mfma_f32_16x16x32_bf16 v[184:187], v[120:123], v[28:31], 0
    v_bitop3_b32 v40, v232, v192, v176 bitop3:0xca
    v_bitop3_b32 v44, v232, v193, v177 bitop3:0xca
    v_mfma_f32_16x16x32_bf16 v[184:187], v[152:155], v[32:35], v[184:187]
    v_bitop3_b32 v48, v232, v194, v178 bitop3:0xca
    v_bitop3_b32 v52, v232, v195, v179 bitop3:0xca
    v_mfma_f32_16x16x32_bf16 v[200:203], v[136:139], v[28:31], 0
    v_bitop3_b32 v40, v234, v233, v40 bitop3:0xca
    v_bitop3_b32 v44, v234, v233, v44 bitop3:0xca
    v_mfma_f32_16x16x32_bf16 v[200:203], v[168:171], v[32:35], v[200:203]
    v_bitop3_b32 v48, v234, v233, v48 bitop3:0xca
    v_bitop3_b32 v52, v234, v233, v52 bitop3:0xca
    v_mfma_f32_16x16x32_bf16 v[188:191], v[124:127], v[28:31], 0
    v_bitop3_b32 v41, v232, v196, v180 bitop3:0xca
    v_bitop3_b32 v45, v232, v197, v181 bitop3:0xca
    v_mfma_f32_16x16x32_bf16 v[188:191], v[156:159], v[32:35], v[188:191]
    v_bitop3_b32 v49, v232, v198, v182 bitop3:0xca
    v_bitop3_b32 v53, v232, v199, v183 bitop3:0xca
    v_mfma_f32_16x16x32_bf16 v[204:207], v[140:143], v[28:31], 0
    v_mfma_f32_16x16x32_bf16 v[204:207], v[172:175], v[32:35], v[204:207]
    v_bitop3_b32 v42, v232, v200, v184 bitop3:0xca
    v_bitop3_b32 v46, v232, v201, v185 bitop3:0xca
    v_bitop3_b32 v50, v232, v202, v186 bitop3:0xca
    v_bitop3_b32 v54, v232, v203, v187 bitop3:0xca
    s_nop 3
    v_bitop3_b32 v43, v232, v204, v188 bitop3:0xca
    global_store_dwordx4 v4, v[40:43], s[36:37] sc1
    v_bitop3_b32 v47, v232, v205, v189 bitop3:0xca
    global_store_dwordx4 v5, v[44:47], s[36:37] sc1
    v_bitop3_b32 v51, v232, v206, v190 bitop3:0xca
    global_store_dwordx4 v6, v[48:51], s[36:37] sc1
    v_bitop3_b32 v55, v232, v207, v191 bitop3:0xca
    global_store_dwordx4 v7, v[52:55], s[36:37] sc1
    s_endpgm
L_slow:
    v_mov_b32 v21, 0
    v_mov_b32 v38, v26
    s_mov_b32 s10, 16
L_slow_r:
    v_sub_u32 v176, v28, v21
    v_sub_u32 v177, v29, v21
    v_sub_u32 v178, v30, v21
    v_sub_u32 v179, v31, v21
    v_sub_u32 v180, v32, v21
    v_sub_u32 v181, v33, v21
    v_sub_u32 v182, v34, v21
    v_sub_u32 v183, v35, v21
    v_max3_u32 v24, v176, v177, v178
    v_max3_u32 v24, v24, v179, v180
    v_max3_u32 v24, v24, v181, v182
    v_max_u32 v24, v24, v183
    ds_max_u32 v38, v24 offset:96
    s_mov_b64 exec, 1
    ds_add_u32 v26, v27 offset:40
    s_mov_b64 exec, -1
L_slow_s:
    ds_read_b32 v24, v26 offset:40
    ds_read_b32 v39, v38 offset:96
    s_waitcnt lgkmcnt(0)
    v_readfirstlane_b32 s11, v24
    s_nop 0
    s_cmp_ge_u32 s11, s10
    s_cbranch_scc1 L_slow_ok
    s_sub_u32 s55, s55, 1
    s_cbranch_scc0 L_slow_s
L_slow_ok:
    v_add_u32 v21, v21, v39
    v_alignbit_b32 v24, 1, v21, 5
    ds_write_b32 v38, v24 offset:64
    v_add_u32 v38, 4, v38
    s_add_u32 s10, s10, 16
    s_cmp_le_u32 s10, 128
    s_cbranch_scc1 L_slow_r
    ds_read_b32 v23, v17 offset:64
    ds_read_b32 v13, v18 offset:64
    s_add_u32 m0, s64, 150016
    s_waitcnt lgkmcnt(0)
    v_and_b32 v23, 0x7ff, v23
    v_mad_i32_i24 v23, v23, s63, v12
    global_load_lds_dwordx4 v23, s[4:5]
    s_add_u32 m0, s64, 153664
    v_and_b32 v22, 0x7ff, v13
    global_load_lds_dwordx4 v23, s[4:5] offset:512
    v_sub_u32 v22, 2047, v22
    s_cmp_lg_u32 s39, 0
    s_cbranch_scc1 L_nox9b
    s_mov_b32 m0, 157312
    s_nop 0
    global_load_lds_dwordx4 v23, s[4:5] offset:1024
    s_branch L_x3b
L_nox9b:
    v_lshlrev_b32 v24, 3, v22
    v_add_u32 v24, 16384, v24
    global_load_dword v25, v24, s[36:37] sc1
L_x3b:
    v_mov_b32 v36, 4
    s_waitcnt vmcnt(0)
    s_cmp_lg_u32 s39, 1
    s_cbranch_scc1 L_nostb
    ds_write_b32 v18, v25 offset:448
L_nostb:
    s_mov_b64 exec, 1
    ds_add_u32 v26, v36 offset:36
    s_mov_b64 exec, -1
    s_branch L_dgo
L_gu:
    s_add_u32 s53, s53, 12288
    s_movk_i32 s55, 10
L_dma1:
    s_mov_b32 m0, s53
    s_add_u32 s42, s53, 73728
    global_load_lds_dwordx4 v76, s[26:27]
    s_mov_b32 m0, s42
    s_add_u32 s53, s53, 4096
    global_load_lds_dwordx4 v76, s[28:29]
    v_add_u32 v76, 294912, v76
    s_sub_u32 s55, s55, 1
    s_cmp_lg_u32 s55, 0
    s_cbranch_scc1 L_dma1
    v_min_u32 v12, 8, v2
    v_mul_u32_u24 v12, 1040, v12
    v_add_u32 v12, 151040, v12
    v_mov_b32 v20, 0x3f803f80
    v_mov_b32 v21, v20
    v_mov_b32 v22, v20
    v_mov_b32 v23, v20
    ds_write_b128 v12, v[20:23]
    v_bfe_u32 v15, v0, 2, 2
    v_and_b32 v16, 3, v0
    v_lshl_add_u32 v17, v14, 3, v15
    v_bfe_u32 v18, v0, 3, 2
    v_xor_b32 v18, s51, v18
    v_lshlrev_b32 v18, 5, v18
    v_lshl_add_u32 v18, v16, 3, v18
    v_lshl_add_u32 v4, v17, 7, v18
    v_add_u32 v5, 36864, v4
    v_add_u32 v6, 73728, v4
    v_add_u32 v7, 110592, v4
    v_and_b32 v19, 6, v11
    v_xor_b32 v19, v19, v14
    v_lshlrev_b32 v19, 4, v19
    v_lshl_add_u32 v19, v11, 7, v19
    v_xor_b32 v20, 64, v19
    v_bfe_i32 v21, v0, 3, 1
    v_mov_b32 v22, 1024
    v_bfi_b32 v19, v21, v22, v19
    v_bfi_b32 v20, v21, v22, v20
    v_add_u32 v19, 150016, v19
    v_add_u32 v20, 150016, v20
    v_lshl_add_u32 v18, v11, 2, v26
    s_lshr_b32 s42, s51, 1
    s_lshl_b32 s42, s42, 10
    s_and_b32 s43, s51, 1
    s_lshl_b32 s43, s43, 3
    s_add_u32 s42, s42, s43
    s_add_u32 s42, s42, 147968
    v_add_u32 v27, s42, v3
    v_and_b32 v8, 9344, v21
    v_lshl_add_u32 v8, v11, 4, v8
    s_mul_i32 s42, s50, 18688
    s_add_u32 s42, s42, 74752
    v_add_u32 v8, s42, v8
    s_waitcnt vmcnt(0)
    s_barrier
    s_barrier
    s_movk_i32 s55, 5
L_dma2:
    s_mov_b32 m0, s53
    s_add_u32 s42, s53, 73728
    global_load_lds_dwordx4 v76, s[26:27]
    s_mov_b32 m0, s42
    s_add_u32 s53, s53, 4096
    global_load_lds_dwordx4 v76, s[28:29]
    v_add_u32 v76, 294912, v76
    s_sub_u32 s55, s55, 1
    s_cmp_lg_u32 s55, 0
    s_cbranch_scc1 L_dma2
    ds_read_b64_tr_b16 v[112:113], v4 offset:0
    ds_read_b64_tr_b16 v[114:115], v4 offset:512
    ds_read_b64_tr_b16 v[184:185], v6 offset:0
    ds_read_b64_tr_b16 v[186:187], v6 offset:512
    ds_read_b64_tr_b16 v[116:117], v4 offset:4096
    ds_read_b64_tr_b16 v[118:119], v4 offset:4608
    ds_read_b64_tr_b16 v[188:189], v6 offset:4096
    ds_read_b64_tr_b16 v[190:191], v6 offset:4608
    ds_read_b64_tr_b16 v[120:121], v4 offset:8192
    ds_read_b64_tr_b16 v[122:123], v4 offset:8704
    ds_read_b64_tr_b16 v[192:193], v6 offset:8192
    ds_read_b64_tr_b16 v[194:195], v6 offset:8704
    ds_read_b64_tr_b16 v[124:125], v4 offset:12288
    ds_read_b64_tr_b16 v[126:127], v4 offset:12800
    ds_read_b64_tr_b16 v[196:197], v6 offset:12288
    ds_read_b64_tr_b16 v[198:199], v6 offset:12800
    ds_read_b64_tr_b16 v[128:129], v4 offset:16384
    ds_read_b64_tr_b16 v[130:131], v4 offset:16896
    ds_read_b64_tr_b16 v[200:201], v6 offset:16384
    ds_read_b64_tr_b16 v[202:203], v6 offset:16896
    ds_read_b64_tr_b16 v[132:133], v4 offset:20480
    ds_read_b64_tr_b16 v[134:135], v4 offset:20992
    ds_read_b64_tr_b16 v[204:205], v6 offset:20480
    ds_read_b64_tr_b16 v[206:207], v6 offset:20992
    ds_read_b64_tr_b16 v[136:137], v4 offset:24576
    ds_read_b64_tr_b16 v[138:139], v4 offset:25088
    ds_read_b64_tr_b16 v[208:209], v6 offset:24576
    ds_read_b64_tr_b16 v[210:211], v6 offset:25088
    ds_read_b64_tr_b16 v[140:141], v4 offset:28672
    ds_read_b64_tr_b16 v[142:143], v4 offset:29184
    ds_read_b64_tr_b16 v[212:213], v6 offset:28672
    ds_read_b64_tr_b16 v[214:215], v6 offset:29184
    ds_read_b64_tr_b16 v[144:145], v4 offset:32768
    ds_read_b64_tr_b16 v[146:147], v4 offset:33280
    ds_read_b64_tr_b16 v[216:217], v6 offset:32768
    ds_read_b64_tr_b16 v[218:219], v6 offset:33280
    ds_read_b64_tr_b16 v[148:149], v5 offset:0
    ds_read_b64_tr_b16 v[150:151], v5 offset:512
    ds_read_b64_tr_b16 v[220:221], v7 offset:0
    ds_read_b64_tr_b16 v[222:223], v7 offset:512
    ds_read_b64_tr_b16 v[152:153], v5 offset:4096
    ds_read_b64_tr_b16 v[154:155], v5 offset:4608
    ds_read_b64_tr_b16 v[224:225], v7 offset:4096
    ds_read_b64_tr_b16 v[226:227], v7 offset:4608
    ds_read_b64_tr_b16 v[156:157], v5 offset:8192
    ds_read_b64_tr_b16 v[158:159], v5 offset:8704
    ds_read_b64_tr_b16 v[228:229], v7 offset:8192
    ds_read_b64_tr_b16 v[230:231], v7 offset:8704
    ds_read_b64_tr_b16 v[160:161], v5 offset:12288
    ds_read_b64_tr_b16 v[162:163], v5 offset:12800
    ds_read_b64_tr_b16 v[232:233], v7 offset:12288
    ds_read_b64_tr_b16 v[234:235], v7 offset:12800
    s_mov_b32 s55, 262144
    v_mov_b32 v23, 4
    s_waitcnt vmcnt(0)
    s_mov_b64 exec, 1
    ds_add_u32 v26, v23 offset:44
    s_mov_b64 exec, -1
L_s5:
    ds_read_b32 v24, v26 offset:44
    s_waitcnt lgkmcnt(0)
    v_readfirstlane_b32 s61, v24
    s_nop 0
    s_and_b32 s60, s61, 0xffff
    s_cmp_ge_u32 s60, 16
    s_cbranch_scc1 L_s5_ok
    s_sub_u32 s55, s55, 1
    s_cbranch_scc0 L_s5
L_s5_ok:
    ds_read_b64_tr_b16 v[164:165], v5 offset:16384
    ds_read_b64_tr_b16 v[166:167], v5 offset:16896
    ds_read_b64_tr_b16 v[236:237], v7 offset:16384
    ds_read_b64_tr_b16 v[238:239], v7 offset:16896
    ds_read_b64_tr_b16 v[168:169], v5 offset:20480
    ds_read_b64_tr_b16 v[170:171], v5 offset:20992
    ds_read_b64_tr_b16 v[240:241], v7 offset:20480
    ds_read_b64_tr_b16 v[242:243], v7 offset:20992
    ds_read_b64_tr_b16 v[172:173], v5 offset:24576
    ds_read_b64_tr_b16 v[174:175], v5 offset:25088
    ds_read_b64_tr_b16 v[244:245], v7 offset:24576
    ds_read_b64_tr_b16 v[246:247], v7 offset:25088
    ds_read_b64_tr_b16 v[176:177], v5 offset:28672
    ds_read_b64_tr_b16 v[178:179], v5 offset:29184
    ds_read_b64_tr_b16 v[248:249], v7 offset:28672
    ds_read_b64_tr_b16 v[250:251], v7 offset:29184
    ds_read_b64_tr_b16 v[180:181], v5 offset:32768
    ds_read_b64_tr_b16 v[182:183], v5 offset:33280
    ds_read_b64_tr_b16 v[252:253], v7 offset:32768
    ds_read_b64_tr_b16 v[254:255], v7 offset:33280
L_s6:
    ds_read_b32 v24, v26 offset:36
    s_waitcnt lgkmcnt(0)
    v_readfirstlane_b32 s61, v24
    s_nop 0
    s_and_b32 s60, s61, 0xffff
    s_cmp_ge_u32 s60, 16
    s_cbranch_scc1 L_s6_ok
    s_sub_u32 s55, s55, 1
    s_cbranch_scc0 L_s6
L_s6_ok:
    s_cmp_eq_u32 s61, 0x80010
    s_cbranch_scc1 L_s7_ok
L_s7:
    ds_read_b32 v24, v26 offset:36
    s_waitcnt lgkmcnt(0)
    v_readfirstlane_b32 s61, v24
    s_nop 0
    s_and_b32 s60, s61, 0xffff
    s_cmp_ge_u32 s60, 32
    s_cbranch_scc1 L_s7_ok
    s_sub_u32 s55, s55, 1
    s_cbranch_scc0 L_s7
L_s7_ok:
    ds_read_b128 v[40:43], v19 offset:0
    ds_read_b128 v[44:47], v20 offset:0
    ds_read_b128 v[48:51], v19 offset:1040
    ds_read_b128 v[52:55], v20 offset:1040
    ds_read_b128 v[56:59], v19 offset:2080
    ds_read_b128 v[60:63], v20 offset:2080
    s_waitcnt lgkmcnt(5)
    v_mfma_f32_16x16x32_bf16 v[28:31], v[112:115], v[40:43], 0
    ds_read_b128 v[64:67], v19 offset:3120
    v_mfma_f32_16x16x32_bf16 v[32:35], v[184:187], v[40:43], 0
    ds_read_b128 v[68:71], v20 offset:3120
    s_waitcnt lgkmcnt(5)
    v_mfma_f32_16x16x32_bf16 v[28:31], v[116:119], v[44:47], v[28:31]
    ds_read_b128 v[72:75], v19 offset:4160
    v_mfma_f32_16x16x32_bf16 v[32:35], v[188:191], v[44:47], v[32:35]
    ds_read_b128 v[76:79], v20 offset:4160
    v_mfma_f32_16x16x32_bf16 v[28:31], v[120:123], v[48:51], v[28:31]
    ds_read_b128 v[80:83], v19 offset:5200
    v_mfma_f32_16x16x32_bf16 v[32:35], v[192:195], v[48:51], v[32:35]
    ds_read_b128 v[84:87], v20 offset:5200
    s_waitcnt lgkmcnt(7)
    v_mfma_f32_16x16x32_bf16 v[28:31], v[124:127], v[52:55], v[28:31]
    ds_read_b128 v[88:91], v19 offset:6240
    v_mfma_f32_16x16x32_bf16 v[32:35], v[196:199], v[52:55], v[32:35]
    ds_read_b128 v[92:95], v20 offset:6240
    v_mfma_f32_16x16x32_bf16 v[28:31], v[128:131], v[56:59], v[28:31]
    ds_read_b128 v[96:99], v19 offset:7280
    v_mfma_f32_16x16x32_bf16 v[32:35], v[200:203], v[56:59], v[32:35]
    ds_read_b128 v[100:103], v20 offset:7280
    s_waitcnt lgkmcnt(7)
    v_mfma_f32_16x16x32_bf16 v[28:31], v[132:135], v[60:63], v[28:31]
    ds_read_b128 v[104:107], v19 offset:8320
    v_mfma_f32_16x16x32_bf16 v[28:31], v[136:139], v[64:67], v[28:31]
    ds_read_b128 v[108:111], v20 offset:8320
    v_mfma_f32_16x16x32_bf16 v[28:31], v[140:143], v[68:71], v[28:31]
    ds_read_b32 v25, v18 offset:448
    v_mfma_f32_16x16x32_bf16 v[28:31], v[144:147], v[72:75], v[28:31]
    ds_read_b32 v13, v18 offset:64
    s_waitcnt lgkmcnt(7)
    v_mfma_f32_16x16x32_bf16 v[28:31], v[148:151], v[76:79], v[28:31]
    v_mfma_f32_16x16x32_bf16 v[28:31], v[152:155], v[80:83], v[28:31]
    v_mfma_f32_16x16x32_bf16 v[28:31], v[156:159], v[84:87], v[28:31]
    v_mfma_f32_16x16x32_bf16 v[28:31], v[160:163], v[88:91], v[28:31]
    s_waitcnt lgkmcnt(3)
    v_mfma_f32_16x16x32_bf16 v[28:31], v[164:167], v[92:95], v[28:31]
    v_mfma_f32_16x16x32_bf16 v[28:31], v[168:171], v[96:99], v[28:31]
    v_mfma_f32_16x16x32_bf16 v[28:31], v[172:175], v[100:103], v[28:31]
    s_waitcnt lgkmcnt(0)
    v_mfma_f32_16x16x32_bf16 v[28:31], v[176:179], v[104:107], v[28:31]
    v_and_b32 v7, 0xffff0000, v25
    s_waitcnt lgkmcnt(2)
    v_mfma_f32_16x16x32_bf16 v[28:31], v[180:183], v[108:111], v[28:31]
    v_rcp_f32 v26, v7
    v_mfma_f32_16x16x32_bf16 v[32:35], v[204:207], v[60:63], v[32:35]
    v_lshlrev_b32 v6, 16, v25
    v_mfma_f32_16x16x32_bf16 v[32:35], v[208:211], v[64:67], v[32:35]
    v_xor_b32 v25, 0x80000000, v6
    v_mfma_f32_16x16x32_bf16 v[32:35], v[212:215], v[68:71], v[32:35]
    v_mul_f32 v9, 0xbfb8aa3b, v26
    v_mfma_f32_16x16x32_bf16 v[32:35], v[216:219], v[72:75], v[32:35]
    v_mul_f32 v10, v26, v26
    v_mfma_f32_16x16x32_bf16 v[32:35], v[220:223], v[76:79], v[32:35]
    v_fmac_f32_dpp v28, v28, v25 row_newbcast:8 row_mask:0xf bank_mask:0xf
    v_fmac_f32_dpp v29, v29, v25 row_newbcast:8 row_mask:0xf bank_mask:0xf
    v_mfma_f32_16x16x32_bf16 v[32:35], v[224:227], v[80:83], v[32:35]
    v_fmac_f32_dpp v30, v30, v25 row_newbcast:8 row_mask:0xf bank_mask:0xf
    v_fmac_f32_dpp v31, v31, v25 row_newbcast:8 row_mask:0xf bank_mask:0xf
    v_mfma_f32_16x16x32_bf16 v[32:35], v[228:231], v[84:87], v[32:35]
    v_mul_f32 v36, v9, v28
    v_mul_f32 v37, v9, v29
    v_mfma_f32_16x16x32_bf16 v[32:35], v[232:235], v[88:91], v[32:35]
    v_mul_f32 v38, v9, v30
    v_mul_f32 v39, v9, v31
    v_mfma_f32_16x16x32_bf16 v[32:35], v[236:239], v[92:95], v[32:35]
    v_exp_f32 v36, v36
    v_exp_f32 v37, v37
    v_mfma_f32_16x16x32_bf16 v[32:35], v[240:243], v[96:99], v[32:35]
    v_exp_f32 v38, v38
    v_exp_f32 v39, v39
    v_mfma_f32_16x16x32_bf16 v[32:35], v[244:247], v[100:103], v[32:35]
    v_mul_f32 v28, v28, v10
    v_mul_f32 v29, v29, v10
    v_mfma_f32_16x16x32_bf16 v[32:35], v[248:251], v[104:107], v[32:35]
    v_mul_f32 v30, v30, v10
    v_mul_f32 v31, v31, v10
    v_mfma_f32_16x16x32_bf16 v[32:35], v[252:255], v[108:111], v[32:35]
    v_add_f32 v36, 1.0, v36
    v_add_f32 v37, 1.0, v37
    v_add_f32 v38, 1.0, v38
    v_add_f32 v39, 1.0, v39
    v_rcp_f32 v36, v36
    v_rcp_f32 v37, v37
    v_rcp_f32 v38, v38
    v_rcp_f32 v39, v39
    v_mul_f32 v28, v28, v36
    v_mul_f32 v29, v29, v37
    v_mul_f32 v30, v30, v38
    v_mul_f32 v31, v31, v39
    v_fmac_f32_dpp v32, v32, v25 row_newbcast:8 row_mask:0xf bank_mask:0xf
    v_fmac_f32_dpp v33, v33, v25 row_newbcast:8 row_mask:0xf bank_mask:0xf
    v_fmac_f32_dpp v34, v34, v25 row_newbcast:8 row_mask:0xf bank_mask:0xf
    v_fmac_f32_dpp v35, v35, v25 row_newbcast:8 row_mask:0xf bank_mask:0xf
    v_mul_f32 v28, v28, v32
    v_mul_f32 v29, v29, v33
    v_mul_f32 v30, v30, v34
    v_mul_f32 v31, v31, v35
    v_cvt_pk_bf16_f32 v28, v28, v29
    v_cvt_pk_bf16_f32 v29, v30, v31
    ds_write_b64 v27, v[28:29]
    s_waitcnt lgkmcnt(0)
    s_barrier
    s_cmp_lg_u32 s39, 4
    s_cbranch_scc1 L_gu_end
    v_lshlrev_b32 v36, 5, v13
    v_not_b32 v37, v36
    v_ashrrev_i32 v38, 31, v37
    v_or_b32 v38, 0x80000000, v38
    v_xor_b32 v36, v36, v38
    v_and_b32 v36, 0xffff0000, v36
    v_mul_f32 v36, 0xbfb8aa3b, v36
    v_exp_f32 v36, v36
    v_bfe_u32 v4, v37, 5, 11
    v_add_f32 v36, 1.0, v36
    v_rcp_f32 v5, v36
    v_lshl_or_b32 v4, v4, 8, s45
    s_mov_b64 exec, 0xffff
    global_store_dwordx4 v8, v[4:7], s[36:37] sc1
    s_cmp_lg_u32 s50, 0
    s_cbranch_scc1 L_gu_end
    v_mov_b32 v9, 0
    v_mov_b32 v10, s38
    s_mov_b64 exec, 1
    global_store_dword v9, v10, s[36:37]
L_gu_end:
    s_endpgm
L_conv:
    s_cmp_eq_u32 s52, 0
    s_cbranch_scc1 L_cprio
    s_setprio 1
L_cprio:
    s_lshl_b32 s42, s52, 8
    s_add_u32 m0, s55, s42
    s_waitcnt vmcnt(2)
    s_lshr_b32 s43, s39, 1
    s_cmp_lt_u32 s51, 2
    s_cbranch_scc1 L_cw
    s_waitcnt vmcnt(1)
L_cw:
    v_lshlrev_b32 v70, 16, v70
    v_mul_f32 v70, 0x3fb8aa3b, v70
    v_exp_f32 v70, v70
    v_lshlrev_b32 v64, 16, v64
    v_lshlrev_b32 v65, 16, v65
    v_lshlrev_b32 v66, 16, v66
    v_lshlrev_b32 v67, 16, v67
    v_lshlrev_b32 v68, 16, v68
    v_lshlrev_b32 v69, 16, v69
    v_cvt_pk_bf16_f32 v70, v70, v70
    v_and_b32 v70, 0xffff0000, v70
    v_mul_f32 v64, v70, v64
    v_mul_f32 v65, v70, v65
    v_mul_f32 v70, 0x44800000, v70
    v_mul_f32 v64, 0x3fb8aa3b, v64
    v_mul_f32 v65, 0x3e22f983, v65
    v_mul_f32 v66, v70, v66
    v_mul_f32 v67, v70, v67
    s_cmp_eq_u32 s48, 1
    s_cbranch_scc0 L_ct1
    global_load_dword v1, v76, s[56:57]
L_ct1:
    v_mul_f32 v13, 0x41800000, v64
    v_mul_f32 v17, 0x41800000, v65
    v_mul_f32 v14, 0x44000000, v64
    v_mul_f32 v18, 0x44000000, v65
    v_exp_f32 v12, v64
    v_fract_f32 v16, v65
    v_exp_f32 v13, v13
    v_fract_f32 v17, v17
    v_exp_f32 v14, v14
    v_fract_f32 v18, v18
    v_pk_mul_f32 v[20:21], v[68:69], v[66:67] op_sel:[0,0] op_sel_hi:[0,1] neg_hi:[0,1]
    v_pk_fma_f32 v[90:91], v[68:69], v[66:67], v[20:21] op_sel:[1,1,0] op_sel_hi:[1,0,1] neg_lo:[0,1,0] neg_hi:[0,1,0]
    v_cos_f32 v22, v16
    v_sin_f32 v23, v16
    v_cos_f32 v24, v17
    v_sin_f32 v25, v17
    v_cos_f32 v26, v18
    v_sin_f32 v27, v18
    v_mov_b32 v34, 0x3f80
    ds_write_addtid_b32 v34
    v_mul_f32 v22, v12, v22
    v_mul_f32 v23, -v12, v23
    v_mul_f32 v24, v13, v24
    v_mul_f32 v25, v13, v25
    v_mul_f32 v26, v14, v26
    v_mul_f32 v27, -v14, v27
    v_cvt_pk_bf16_f32 v35, v90, v91
    ds_write_addtid_b32 v35 offset:16896
    v_cvt_pk_bf16_f32 v36, v24, v25
    ds_write_addtid_b32 v36 offset:528
    v_pk_mul_f32 v[30:31], v[24:25], v[24:25] op_sel:[0,0] op_sel_hi:[0,1]
    v_pk_fma_f32 v[28:29], v[24:25], v[24:25], v[30:31] op_sel:[1,1,0] op_sel_hi:[1,0,1] neg_lo:[0,1,0]
    v_cvt_pk_bf16_f32 v34, v28, v29
    s_bfe_u32 s43, s46, 131072
    ds_write_addtid_b32 v34 offset:1056
    v_pk_mul_f32 v[32:33], v[90:91], v[22:23] op_sel:[0,0] op_sel_hi:[0,1]
    v_pk_fma_f32 v[92:93], v[90:91], v[22:23], v[32:33] op_sel:[1,1,0] op_sel_hi:[1,0,1] neg_lo:[0,1,0]
    v_cvt_pk_bf16_f32 v35, v92, v93
    s_mul_i32 s43, s43, 0x20004000
    ds_write_addtid_b32 v35 offset:17424
    v_pk_mul_f32 v[30:31], v[28:29], v[24:25] op_sel:[0,0] op_sel_hi:[0,1]
    v_pk_fma_f32 v[28:29], v[28:29], v[24:25], v[30:31] op_sel:[1,1,0] op_sel_hi:[1,0,1] neg_lo:[0,1,0]
    v_cvt_pk_bf16_f32 v36, v28, v29
    s_and_b32 s4, s43, 0x40004000
    ds_write_addtid_b32 v36 offset:1584
    v_pk_mul_f32 v[32:33], v[92:93], v[22:23] op_sel:[0,0] op_sel_hi:[0,1]
    v_pk_fma_f32 v[94:95], v[92:93], v[22:23], v[32:33] op_sel:[1,1,0] op_sel_hi:[1,0,1] neg_lo:[0,1,0]
    v_cvt_pk_bf16_f32 v37, v94, v95
    s_bfe_u32 s43, s46, 131074
    ds_write_addtid_b32 v37 offset:17952
    v_pk_mul_f32 v[30:31], v[28:29], v[24:25] op_sel:[0,0] op_sel_hi:[0,1]
    v_pk_fma_f32 v[28:29], v[28:29], v[24:25], v[30:31] op_sel:[1,1,0] op_sel_hi:[1,0,1] neg_lo:[0,1,0]
    v_cvt_pk_bf16_f32 v34, v28, v29
    s_mul_i32 s43, s43, 0x20004000
    ds_write_addtid_b32 v34 offset:2112
    v_pk_mul_f32 v[32:33], v[94:95], v[22:23] op_sel:[0,0] op_sel_hi:[0,1]
    v_pk_fma_f32 v[96:97], v[94:95], v[22:23], v[32:33] op_sel:[1,1,0] op_sel_hi:[1,0,1] neg_lo:[0,1,0]
    v_cvt_pk_bf16_f32 v35, v96, v97
    s_and_b32 s5, s43, 0x40004000
    ds_write_addtid_b32 v35 offset:18480
    v_pk_mul_f32 v[30:31], v[28:29], v[24:25] op_sel:[0,0] op_sel_hi:[0,1]
    v_pk_fma_f32 v[28:29], v[28:29], v[24:25], v[30:31] op_sel:[1,1,0] op_sel_hi:[1,0,1] neg_lo:[0,1,0]
    v_cvt_pk_bf16_f32 v36, v28, v29
    s_bfe_u32 s43, s46, 131076
    ds_write_addtid_b32 v36 offset:2640
    v_pk_mul_f32 v[32:33], v[96:97], v[22:23] op_sel:[0,0] op_sel_hi:[0,1]
    v_pk_fma_f32 v[98:99], v[96:97], v[22:23], v[32:33] op_sel:[1,1,0] op_sel_hi:[1,0,1] neg_lo:[0,1,0]
    v_cvt_pk_bf16_f32 v37, v98, v99
    s_mul_i32 s43, s43, 0x20004000
    ds_write_addtid_b32 v37 offset:19008
    v_pk_mul_f32 v[30:31], v[28:29], v[24:25] op_sel:[0,0] op_sel_hi:[0,1]
    v_pk_fma_f32 v[28:29], v[28:29], v[24:25], v[30:31] op_sel:[1,1,0] op_sel_hi:[1,0,1] neg_lo:[0,1,0]
    v_cvt_pk_bf16_f32 v34, v28, v29
    s_and_b32 s6, s43, 0x40004000
    ds_write_addtid_b32 v34 offset:3168
    v_pk_mul_f32 v[32:33], v[98:99], v[22:23] op_sel:[0,0] op_sel_hi:[0,1]
    v_pk_fma_f32 v[100:101], v[98:99], v[22:23], v[32:33] op_sel:[1,1,0] op_sel_hi:[1,0,1] neg_lo:[0,1,0]
    v_cvt_pk_bf16_f32 v35, v100, v101
    s_bfe_u32 s43, s46, 131078
    ds_write_addtid_b32 v35 offset:19536
    v_pk_mul_f32 v[30:31], v[28:29], v[24:25] op_sel:[0,0] op_sel_hi:[0,1]
    v_pk_fma_f32 v[28:29], v[28:29], v[24:25], v[30:31] op_sel:[1,1,0] op_sel_hi:[1,0,1] neg_lo:[0,1,0]
    v_cvt_pk_bf16_f32 v36, v28, v29
    s_mul_i32 s43, s43, 0x20004000
    ds_write_addtid_b32 v36 offset:3696
    v_pk_mul_f32 v[32:33], v[100:101], v[22:23] op_sel:[0,0] op_sel_hi:[0,1]
    v_pk_fma_f32 v[102:103], v[100:101], v[22:23], v[32:33] op_sel:[1,1,0] op_sel_hi:[1,0,1] neg_lo:[0,1,0]
    v_cvt_pk_bf16_f32 v37, v102, v103
    s_and_b32 s7, s43, 0x40004000
    ds_write_addtid_b32 v37 offset:20064
    v_pk_mul_f32 v[30:31], v[28:29], v[24:25] op_sel:[0,0] op_sel_hi:[0,1]
    v_pk_fma_f32 v[28:29], v[28:29], v[24:25], v[30:31] op_sel:[1,1,0] op_sel_hi:[1,0,1] neg_lo:[0,1,0]
    v_cvt_pk_bf16_f32 v34, v28, v29
    s_sub_u32 s8, s52, 1
    ds_write_addtid_b32 v34 offset:4224
    v_pk_mul_f32 v[32:33], v[102:103], v[22:23] op_sel:[0,0] op_sel_hi:[0,1]
    v_pk_fma_f32 v[104:105], v[102:103], v[22:23], v[32:33] op_sel:[1,1,0] op_sel_hi:[1,0,1] neg_lo:[0,1,0]
    v_cvt_pk_bf16_f32 v35, v104, v105
    s_lshl_b32 s9, s52, 2
    ds_write_addtid_b32 v35 offset:20592
    s_cmp_eq_u32 s47, 9
    s_cbranch_scc0 L_ct2
    v_add_u32 v76, 3244032, v76
    global_load_dword v1, v76, s[56:57]
L_ct2:
    v_pk_mul_f32 v[30:31], v[28:29], v[24:25] op_sel:[0,0] op_sel_hi:[0,1]
    v_pk_fma_f32 v[28:29], v[28:29], v[24:25], v[30:31] op_sel:[1,1,0] op_sel_hi:[1,0,1] neg_lo:[0,1,0]
    v_cvt_pk_bf16_f32 v36, v28, v29
    s_and_b32 s10, s8, 2056
    ds_write_addtid_b32 v36 offset:4752
    v_pk_mul_f32 v[32:33], v[104:105], v[22:23] op_sel:[0,0] op_sel_hi:[0,1]
    v_pk_fma_f32 v[106:107], v[104:105], v[22:23], v[32:33] op_sel:[1,1,0] op_sel_hi:[1,0,1] neg_lo:[0,1,0]
    v_cvt_pk_bf16_f32 v37, v106, v107
    s_add_u32 s10, s10, 54
    ds_write_addtid_b32 v37 offset:21120
    v_pk_mul_f32 v[30:31], v[28:29], v[24:25] op_sel:[0,0] op_sel_hi:[0,1]
    v_pk_fma_f32 v[28:29], v[28:29], v[24:25], v[30:31] op_sel:[1,1,0] op_sel_hi:[1,0,1] neg_lo:[0,1,0]
    v_cvt_pk_bf16_f32 v34, v28, v29
    s_add_u32 s10, s10, s62
    ds_write_addtid_b32 v34 offset:5280
    v_pk_mul_f32 v[32:33], v[106:107], v[22:23] op_sel:[0,0] op_sel_hi:[0,1]
    v_pk_fma_f32 v[108:109], v[106:107], v[22:23], v[32:33] op_sel:[1,1,0] op_sel_hi:[1,0,1] neg_lo:[0,1,0]
    v_cvt_pk_bf16_f32 v35, v108, v109
    s_lshl_b32 s11, s52, 6
    ds_write_addtid_b32 v35 offset:21648
    v_pk_mul_f32 v[30:31], v[28:29], v[24:25] op_sel:[0,0] op_sel_hi:[0,1]
    v_pk_fma_f32 v[28:29], v[28:29], v[24:25], v[30:31] op_sel:[1,1,0] op_sel_hi:[1,0,1] neg_lo:[0,1,0]
    v_cvt_pk_bf16_f32 v36, v28, v29
    s_sub_u32 s11, s62, s11
    ds_write_addtid_b32 v36 offset:5808
    v_pk_mul_f32 v[32:33], v[108:109], v[22:23] op_sel:[0,0] op_sel_hi:[0,1]
    v_pk_fma_f32 v[110:111], v[108:109], v[22:23], v[32:33] op_sel:[1,1,0] op_sel_hi:[1,0,1] neg_lo:[0,1,0]
    v_cvt_pk_bf16_f32 v37, v110, v111
    s_add_u32 s11, s11, 9214
    ds_write_addtid_b32 v37 offset:22176
    v_pk_mul_f32 v[30:31], v[28:29], v[24:25] op_sel:[0,0] op_sel_hi:[0,1]
    v_pk_fma_f32 v[28:29], v[28:29], v[24:25], v[30:31] op_sel:[1,1,0] op_sel_hi:[1,0,1] neg_lo:[0,1,0]
    v_cvt_pk_bf16_f32 v34, v28, v29
    s_lshl_b32 s42, s50, 14
    ds_write_addtid_b32 v34 offset:6336
    v_pk_mul_f32 v[32:33], v[110:111], v[22:23] op_sel:[0,0] op_sel_hi:[0,1]
    v_pk_fma_f32 v[112:113], v[110:111], v[22:23], v[32:33] op_sel:[1,1,0] op_sel_hi:[1,0,1] neg_lo:[0,1,0]
    v_cvt_pk_bf16_f32 v35, v112, v113
    s_add_u32 s42, s42, 2097152
    ds_write_addtid_b32 v35 offset:22704
    v_pk_mul_f32 v[30:31], v[28:29], v[24:25] op_sel:[0,0] op_sel_hi:[0,1]
    v_pk_fma_f32 v[28:29], v[28:29], v[24:25], v[30:31] op_sel:[1,1,0] op_sel_hi:[1,0,1] neg_lo:[0,1,0]
    v_cvt_pk_bf16_f32 v36, v28, v29
    s_add_u32 s12, s36, s42
    s_addc_u32 s13, s37, 0
    ds_write_addtid_b32 v36 offset:6864
    v_pk_mul_f32 v[32:33], v[112:113], v[22:23] op_sel:[0,0] op_sel_hi:[0,1]
    v_pk_fma_f32 v[114:115], v[112:113], v[22:23], v[32:33] op_sel:[1,1,0] op_sel_hi:[1,0,1] neg_lo:[0,1,0]
    v_cvt_pk_bf16_f32 v37, v114, v115
    s_add_u32 s14, s12, 4096
    s_addc_u32 s15, s13, 0
    ds_write_addtid_b32 v37 offset:23232
    v_pk_mul_f32 v[30:31], v[28:29], v[24:25] op_sel:[0,0] op_sel_hi:[0,1]
    v_pk_fma_f32 v[28:29], v[28:29], v[24:25], v[30:31] op_sel:[1,1,0] op_sel_hi:[1,0,1] neg_lo:[0,1,0]
    v_cvt_pk_bf16_f32 v34, v28, v29
    s_add_u32 s16, s12, 8192
    s_addc_u32 s17, s13, 0
    ds_write_addtid_b32 v34 offset:7392
    v_pk_mul_f32 v[32:33], v[114:115], v[22:23] op_sel:[0,0] op_sel_hi:[0,1]
    v_pk_fma_f32 v[116:117], v[114:115], v[22:23], v[32:33] op_sel:[1,1,0] op_sel_hi:[1,0,1] neg_lo:[0,1,0]
    v_cvt_pk_bf16_f32 v35, v116, v117
    s_add_u32 s18, s12, 12288
    s_addc_u32 s19, s13, 0
    ds_write_addtid_b32 v35 offset:23760
    v_pk_mul_f32 v[30:31], v[28:29], v[24:25] op_sel:[0,0] op_sel_hi:[0,1]
    v_pk_fma_f32 v[28:29], v[28:29], v[24:25], v[30:31] op_sel:[1,1,0] op_sel_hi:[1,0,1] neg_lo:[0,1,0]
    v_cvt_pk_bf16_f32 v36, v28, v29
    ds_write_addtid_b32 v36 offset:7920
    v_pk_mul_f32 v[32:33], v[116:117], v[22:23] op_sel:[0,0] op_sel_hi:[0,1]
    v_pk_fma_f32 v[118:119], v[116:117], v[22:23], v[32:33] op_sel:[1,1,0] op_sel_hi:[1,0,1] neg_lo:[0,1,0]
    v_cvt_pk_bf16_f32 v37, v118, v119
    ds_write_addtid_b32 v37 offset:24288
    v_pk_mul_f32 v[30:31], v[28:29], v[24:25] op_sel:[0,0] op_sel_hi:[0,1]
    v_pk_fma_f32 v[28:29], v[28:29], v[24:25], v[30:31] op_sel:[1,1,0] op_sel_hi:[1,0,1] neg_lo:[0,1,0]
    v_cvt_pk_bf16_f32 v34, v28, v29
    ds_write_addtid_b32 v34 offset:8448
    v_pk_mul_f32 v[32:33], v[118:119], v[22:23] op_sel:[0,0] op_sel_hi:[0,1]
    v_pk_fma_f32 v[120:121], v[118:119], v[22:23], v[32:33] op_sel:[1,1,0] op_sel_hi:[1,0,1] neg_lo:[0,1,0]
    v_cvt_pk_bf16_f32 v35, v120, v121
    ds_write_addtid_b32 v35 offset:24816
    v_pk_mul_f32 v[30:31], v[28:29], v[24:25] op_sel:[0,0] op_sel_hi:[0,1]
    v_pk_fma_f32 v[28:29], v[28:29], v[24:25], v[30:31] op_sel:[1,1,0] op_sel_hi:[1,0,1] neg_lo:[0,1,0]
    v_cvt_pk_bf16_f32 v36, v28, v29
    ds_write_addtid_b32 v36 offset:8976
    v_pk_mul_f32 v[32:33], v[120:121], v[22:23] op_sel:[0,0] op_sel_hi:[0,1]
    v_pk_fma_f32 v[122:123], v[120:121], v[22:23], v[32:33] op_sel:[1,1,0] op_sel_hi:[1,0,1] neg_lo:[0,1,0]
    v_cvt_pk_bf16_f32 v37, v122, v123
    ds_write_addtid_b32 v37 offset:25344
    v_pk_mul_f32 v[30:31], v[28:29], v[24:25] op_sel:[0,0] op_sel_hi:[0,1]
    v_pk_fma_f32 v[28:29], v[28:29], v[24:25], v[30:31] op_sel:[1,1,0] op_sel_hi:[1,0,1] neg_lo:[0,1,0]
    v_cvt_pk_bf16_f32 v34, v28, v29
    ds_write_addtid_b32 v34 offset:9504
    v_pk_mul_f32 v[32:33], v[90:91], v[26:27] op_sel:[0,0] op_sel_hi:[0,1]
    v_pk_fma_f32 v[90:91], v[90:91], v[26:27], v[32:33] op_sel:[1,1,0] op_sel_hi:[1,0,1] neg_lo:[0,1,0]
    v_cvt_pk_bf16_f32 v35, v90, v91
    ds_write_addtid_b32 v35 offset:25872
    v_pk_mul_f32 v[30:31], v[28:29], v[24:25] op_sel:[0,0] op_sel_hi:[0,1]
    v_pk_fma_f32 v[28:29], v[28:29], v[24:25], v[30:31] op_sel:[1,1,0] op_sel_hi:[1,0,1] neg_lo:[0,1,0]
    v_cvt_pk_bf16_f32 v36, v28, v29
    ds_write_addtid_b32 v36 offset:10032
    v_pk_mul_f32 v[32:33], v[98:99], v[26:27] op_sel:[0,0] op_sel_hi:[0,1]
    v_pk_fma_f32 v[98:99], v[98:99], v[26:27], v[32:33] op_sel:[1,1,0] op_sel_hi:[1,0,1] neg_lo:[0,1,0]
    v_cvt_pk_bf16_f32 v13, v98, v99
    ds_write_addtid_b32 v13 offset:27984
    v_pk_mul_f32 v[30:31], v[28:29], v[24:25] op_sel:[0,0] op_sel_hi:[0,1]
    v_pk_fma_f32 v[28:29], v[28:29], v[24:25], v[30:31] op_sel:[1,1,0] op_sel_hi:[1,0,1] neg_lo:[0,1,0]
    v_cvt_pk_bf16_f32 v34, v28, v29
    ds_write_addtid_b32 v34 offset:10560
    v_pk_mul_f32 v[32:33], v[106:107], v[26:27] op_sel:[0,0] op_sel_hi:[0,1]
    v_pk_fma_f32 v[106:107], v[106:107], v[26:27], v[32:33] op_sel:[1,1,0] op_sel_hi:[1,0,1] neg_lo:[0,1,0]
    v_cvt_pk_bf16_f32 v14, v106, v107
    ds_write_addtid_b32 v14 offset:30096
    v_pk_mul_f32 v[30:31], v[28:29], v[24:25] op_sel:[0,0] op_sel_hi:[0,1]
    v_pk_fma_f32 v[28:29], v[28:29], v[24:25], v[30:31] op_sel:[1,1,0] op_sel_hi:[1,0,1] neg_lo:[0,1,0]
    v_cvt_pk_bf16_f32 v36, v28, v29
    ds_write_addtid_b32 v36 offset:11088
    v_pk_mul_f32 v[32:33], v[114:115], v[26:27] op_sel:[0,0] op_sel_hi:[0,1]
    v_pk_fma_f32 v[114:115], v[114:115], v[26:27], v[32:33] op_sel:[1,1,0] op_sel_hi:[1,0,1] neg_lo:[0,1,0]
    v_cvt_pk_bf16_f32 v15, v114, v115
    ds_write_addtid_b32 v15 offset:32208
    v_pk_mul_f32 v[30:31], v[28:29], v[24:25] op_sel:[0,0] op_sel_hi:[0,1]
    v_pk_fma_f32 v[28:29], v[28:29], v[24:25], v[30:31] op_sel:[1,1,0] op_sel_hi:[1,0,1] neg_lo:[0,1,0]
    v_cvt_pk_bf16_f32 v34, v28, v29
    ds_write_addtid_b32 v34 offset:11616
    v_pk_mul_f32 v[32:33], v[122:123], v[26:27] op_sel:[0,0] op_sel_hi:[0,1]
    v_pk_fma_f32 v[122:123], v[122:123], v[26:27], v[32:33] op_sel:[1,1,0] op_sel_hi:[1,0,1] neg_lo:[0,1,0]
    v_cvt_pk_bf16_f32 v35, v122, v123
    ds_write_addtid_b32 v35 offset:32736
    v_pk_mul_f32 v[30:31], v[28:29], v[24:25] op_sel:[0,0] op_sel_hi:[0,1]
    v_pk_fma_f32 v[28:29], v[28:29], v[24:25], v[30:31] op_sel:[1,1,0] op_sel_hi:[1,0,1] neg_lo:[0,1,0]
    v_cvt_pk_bf16_f32 v36, v28, v29
    ds_write_addtid_b32 v36 offset:12144
    v_pk_mul_f32 v[32:33], v[106:107], v[26:27] op_sel:[0,0] op_sel_hi:[0,1]
    v_pk_fma_f32 v[106:107], v[106:107], v[26:27], v[32:33] op_sel:[1,1,0] op_sel_hi:[1,0,1] neg_lo:[0,1,0]
    v_cvt_pk_bf16_f32 v37, v106, v107
    ds_write_addtid_b32 v37 offset:26928
    v_pk_mul_f32 v[30:31], v[28:29], v[24:25] op_sel:[0,0] op_sel_hi:[0,1]
    v_pk_fma_f32 v[28:29], v[28:29], v[24:25], v[30:31] op_sel:[1,1,0] op_sel_hi:[1,0,1] neg_lo:[0,1,0]
    v_cvt_pk_bf16_f32 v34, v28, v29
    ds_write_addtid_b32 v34 offset:12672
    v_pk_mul_f32 v[32:33], v[122:123], v[26:27] op_sel:[0,0] op_sel_hi:[0,1]
    v_pk_fma_f32 v[122:123], v[122:123], v[26:27], v[32:33] op_sel:[1,1,0] op_sel_hi:[1,0,1] neg_lo:[0,1,0]
    v_cvt_pk_bf16_f32 v35, v122, v123
    ds_write_addtid_b32 v35 offset:29040
    v_pk_mul_f32 v[30:31], v[28:29], v[24:25] op_sel:[0,0] op_sel_hi:[0,1]
    v_pk_fma_f32 v[28:29], v[28:29], v[24:25], v[30:31] op_sel:[1,1,0] op_sel_hi:[1,0,1] neg_lo:[0,1,0]
    v_cvt_pk_bf16_f32 v36, v28, v29
    ds_write_addtid_b32 v36 offset:13200
    v_pk_mul_f32 v[32:33], v[106:107], v[26:27] op_sel:[0,0] op_sel_hi:[0,1]
    v_pk_fma_f32 v[106:107], v[106:107], v[26:27], v[32:33] op_sel:[1,1,0] op_sel_hi:[1,0,1] neg_lo:[0,1,0]
    v_cvt_pk_bf16_f32 v37, v106, v107
    ds_write_addtid_b32 v37 offset:31152
    v_pk_mul_f32 v[30:31], v[28:29], v[24:25] op_sel:[0,0] op_sel_hi:[0,1]
    v_pk_fma_f32 v[28:29], v[28:29], v[24:25], v[30:31] op_sel:[1,1,0] op_sel_hi:[1,0,1] neg_lo:[0,1,0]
    v_cvt_pk_bf16_f32 v34, v28, v29
    ds_write_addtid_b32 v34 offset:13728
    v_pk_mul_f32 v[32:33], v[122:123], v[26:27] op_sel:[0,0] op_sel_hi:[0,1]
    v_pk_fma_f32 v[122:123], v[122:123], v[26:27], v[32:33] op_sel:[1,1,0] op_sel_hi:[1,0,1] neg_lo:[0,1,0]
    v_cvt_pk_bf16_f32 v35, v122, v123
    ds_write_addtid_b32 v35 offset:33264
    v_pk_mul_f32 v[30:31], v[28:29], v[24:25] op_sel:[0,0] op_sel_hi:[0,1]
    v_pk_fma_f32 v[28:29], v[28:29], v[24:25], v[30:31] op_sel:[1,1,0] op_sel_hi:[1,0,1] neg_lo:[0,1,0]
    v_cvt_pk_bf16_f32 v36, v28, v29
    ds_write_addtid_b32 v36 offset:14256
    v_pk_mul_f32 v[30:31], v[28:29], v[24:25] op_sel:[0,0] op_sel_hi:[0,1]
    v_pk_fma_f32 v[28:29], v[28:29], v[24:25], v[30:31] op_sel:[1,1,0] op_sel_hi:[1,0,1] neg_lo:[0,1,0]
    v_cvt_pk_bf16_f32 v34, v28, v29
    ds_write_addtid_b32 v34 offset:14784
    s_cmp_eq_u32 s52, 0
    s_cbranch_scc1 L_hp0
    v_bfe_u32 v12, v0, 2, 6
    v_and_b32 v6, 0x30, v3
    v_lshl_add_u32 v6, v12, 6, v6
    global_load_dwordx4 v[40:43], v6, s[12:13] sc1
    global_load_dwordx4 v[44:47], v6, s[14:15] sc1
L_hp0:
    v_pk_mul_f32 v[30:31], v[28:29], v[24:25] op_sel:[0,0] op_sel_hi:[0,1]
    v_pk_fma_f32 v[28:29], v[28:29], v[24:25], v[30:31] op_sel:[1,1,0] op_sel_hi:[1,0,1] neg_lo:[0,1,0]
    v_cvt_pk_bf16_f32 v36, v28, v29
    ds_write_addtid_b32 v36 offset:15312
    v_pk_mul_f32 v[30:31], v[28:29], v[24:25] op_sel:[0,0] op_sel_hi:[0,1]
    v_pk_fma_f32 v[28:29], v[28:29], v[24:25], v[30:31] op_sel:[1,1,0] op_sel_hi:[1,0,1] neg_lo:[0,1,0]
    v_cvt_pk_bf16_f32 v34, v28, v29
    ds_write_addtid_b32 v34 offset:15840
    v_pk_mul_f32 v[30:31], v[28:29], v[24:25] op_sel:[0,0] op_sel_hi:[0,1]
    v_pk_fma_f32 v[28:29], v[28:29], v[24:25], v[30:31] op_sel:[1,1,0] op_sel_hi:[1,0,1] neg_lo:[0,1,0]
    v_cvt_pk_bf16_f32 v36, v28, v29
    ds_write_addtid_b32 v36 offset:16368
    ds_write_addtid_b32 v13 offset:26400
    ds_write_addtid_b32 v14 offset:28512
    ds_write_addtid_b32 v15 offset:30624
    s_cmp_eq_u32 s52, 0
    s_cbranch_scc1 L_hp1
    global_load_dwordx4 v[48:51], v6, s[16:17] sc1
    global_load_dwordx4 v[52:55], v6, s[18:19] sc1
L_hp1:
    s_waitcnt lgkmcnt(0)
    s_barrier
    s_cmp_eq_u32 s52, 0
    s_cbranch_scc0 L_helper
    ds_read_b128 v[128:131], v79 offset:0
    ds_read_b128 v[160:163], v78 offset:16896
    ds_read_b128 v[192:195], v80 offset:25344
    ds_read_b128 v[132:135], v79 offset:16
    ds_read_b128 v[164:167], v78 offset:16912
    ds_read_b128 v[196:199], v80 offset:25360
    ds_read_b128 v[136:139], v79 offset:32
    ds_read_b128 v[168:171], v78 offset:16928
    ds_read_b128 v[200:203], v80 offset:25376
    ds_read_b128 v[140:143], v79 offset:48
    ds_read_b128 v[172:175], v78 offset:16944
    ds_read_b128 v[204:207], v80 offset:25392
    v_add_u32 v14, 1, v9
    v_and_b32 v14, 6, v14
    v_add_u32 v14, v14, v14
    v_sub_u32 v14, 2112, v14
    v_and_b32 v14, s8, v14
    v_lshl_add_u32 v17, v8, 2, s62
    v_mul_u32_u24 v18, 2240, v9
    v_add3_u32 v14, v14, v18, v17
    ds_read_b128 v[144:147], v79 offset:64
    ds_read_b128 v[176:179], v78 offset:16960
    ds_read_b128 v[208:211], v80 offset:25408
    s_waitcnt lgkmcnt(12)
    v_mfma_f32_16x16x32_bf16 v[20:23], v[160:163], v[128:131], 0
    v_mfma_f32_16x16x32_bf16 v[24:27], v[192:195], v[128:131], 0
    v_min_u32 v15, s9, v8
    v_sub_u32 v15, v15, v9
    v_lshl_add_u32 v15, v15, 1, v18
    v_add_u32 v15, s10, v15
    v_and_b32 v18, 32, v0
    v_add_u32 v18, v18, v8
    ds_read_b128 v[148:151], v79 offset:80
    ds_read_b128 v[180:183], v78 offset:16976
    ds_read_b128 v[212:215], v80 offset:25424
    s_waitcnt lgkmcnt(12)
    v_mfma_f32_16x16x32_bf16 v[20:23], v[164:167], v[132:135], v[20:23]
    v_mfma_f32_16x16x32_bf16 v[24:27], v[196:199], v[132:135], v[24:27]
    v_bfe_i32 v19, v0, 4, 1
    v_add_u32 v18, v18, v18
    v_sub_u32 v18, v19, v18
    v_lshl_add_u32 v18, v18, 1, s11
    v_add_u32 v72, -1, v2
    v_lshlrev_b32 v71, 16, v71
    ds_read_b128 v[152:155], v79 offset:96
    ds_read_b128 v[184:187], v78 offset:16992
    ds_read_b128 v[216:219], v80 offset:25440
    s_waitcnt lgkmcnt(12)
    v_mfma_f32_16x16x32_bf16 v[20:23], v[168:171], v[136:139], v[20:23]
    v_mfma_f32_16x16x32_bf16 v[24:27], v[200:203], v[136:139], v[24:27]
    v_and_b32 v71, v71, v72
    v_mul_f32 v71, 0x44800000, v71
    s_cmp_lt_u32 s39, 2
    s_cbranch_scc0 L_ct3
    global_load_dword v1, v76, s[56:57]
L_ct3:
    v_and_b32 v10, 3, v8
    v_mul_u32_u24 v10, 2238, v10
    v_lshl_add_u32 v11, v8, 1, v9
    ds_read_b128 v[156:159], v79 offset:112
    ds_read_b128 v[188:191], v78 offset:17008
    ds_read_b128 v[220:223], v80 offset:25456
    s_waitcnt lgkmcnt(12)
    v_mfma_f32_16x16x32_bf16 v[20:23], v[172:175], v[140:143], v[20:23]
    v_mfma_f32_16x16x32_bf16 v[24:27], v[204:207], v[140:143], v[24:27]
    v_mul_u32_u24 v4, 17, v9
    v_sub_u32 v4, v4, v11
    s_add_u32 s43, s62, 6744
    v_sub_u32 v10, v4, v10
    v_add_u32 v10, s43, v10
    v_lshl_add_u32 v11, v11, 4, s63
    s_waitcnt lgkmcnt(9)
    v_mfma_f32_16x16x32_bf16 v[20:23], v[176:179], v[144:147], v[20:23]
    v_mfma_f32_16x16x32_bf16 v[24:27], v[208:211], v[144:147], v[24:27]
    v_lshlrev_b32 v7, 5, v8
    v_lshl_add_u32 v7, v9, 3, v7
    s_lshl_b32 s43, s51, 12
    s_add_u32 s43, s43, 37120
    v_add_u32 v7, s43, v7
    v_lshlrev_b32 v4, 2, v9
    s_waitcnt lgkmcnt(6)
    v_mfma_f32_16x16x32_bf16 v[20:23], v[180:183], v[148:151], v[20:23]
    v_mfma_f32_16x16x32_bf16 v[24:27], v[212:215], v[148:151], v[24:27]
    v_sub_u32 v4, v4, v8
    s_add_u32 s43, s62, 9020
    v_lshl_add_u32 v4, v4, 2, s43
    s_lshl_b32 s43, s51, 2
    s_add_u32 s43, s43, 153728
    v_mov_b32 v88, s43
    s_waitcnt lgkmcnt(3)
    v_mfma_f32_16x16x32_bf16 v[20:23], v[184:187], v[152:155], v[20:23]
    v_mfma_f32_16x16x32_bf16 v[24:27], v[216:219], v[152:155], v[24:27]
    s_waitcnt lgkmcnt(0)
    v_mfma_f32_16x16x32_bf16 v[20:23], v[188:191], v[156:159], v[20:23]
    v_mfma_f32_16x16x32_bf16 v[24:27], v[220:223], v[156:159], v[24:27]
    s_barrier
    ds_write_b32 v14, v84
    ds_write_b32 v17, v84 offset:9216
    s_nop 3
    v_add_f32 v20, v20, v71
    v_bitop3_b32 v19, v19, v26, v25 bitop3:0xca
    v_readlane_b32 s42, v20, 0
    v_cvt_pk_bf16_f32 v28, v23, v22
    v_cvt_pk_bf16_f32 v29, v21, v20
    ds_write_b32 v81, v28 offset:1024
    v_cvt_pk_bf16_f32 v30, v24, v23
    ds_write_b32 v81, v29 offset:1028
    v_cvt_pk_bf16_f32 v31, v22, v21
    ds_write_b32 v82, v28 offset:1024
    v_cvt_pk_bf16_f32 v32, v26, v19
    ds_write_b32 v82, v29 offset:1028
    v_cvt_pk_bf16_f32 v33, v25, v25
    ds_write_b32 v81, v30 offset:3260
    v_cvt_pk_bf16_f32 v34, v26, v26
    ds_write_b32 v81, v31 offset:3264
    v_cvt_pk_bf16_f32 v35, v19, v25
    ds_write_b32 v82, v30 offset:3260
    v_cvt_pk_bf16_f32 v27, v27, s42
    ds_write_b32 v82, v31 offset:3264
    v_lshlrev_b32 v5, 3, v9
    v_mov_b32 v6, 4064
    v_lshlrev_b32 v6, v8, v6
    ds_write_b32 v81, v32 offset:0
    v_bfe_u32 v6, v6, v5, 8
    v_lshl_or_b32 v6, v6, 15, v6
    v_and_b32 v40, 65537, v6
    ds_write_b32 v81, v33 offset:4
    v_mul_u32_u24 v40, 16256, v40
    v_and_b32 v41, 262148, v6
    v_mul_u32_u24 v41, 4064, v41
    ds_write_b32 v82, v32 offset:0
    v_and_b32 v42, 1048592, v6
    v_mul_u32_u24 v42, 1016, v42
    v_and_b32 v43, 4194368, v6
    ds_write_b32 v82, v33 offset:4
    v_mul_u32_u24 v43, 254, v43
    v_mov_b32 v6, 8176
    v_lshlrev_b32 v6, v8, v6
    ds_write_b32 v81, v34 offset:2236
    v_bfe_u32 v6, v6, v5, 8
    v_lshl_or_b32 v6, v6, 15, v6
    v_and_b32 v44, 65537, v6
    ds_write_b32 v81, v35 offset:2240
    v_mul_u32_u24 v44, 16256, v44
    v_and_b32 v45, 262148, v6
    v_mul_u32_u24 v45, 4064, v45
    ds_write_b32 v82, v34 offset:2236
    v_and_b32 v46, 1048592, v6
    v_mul_u32_u24 v46, 1016, v46
    v_and_b32 v47, 4194368, v6
    ds_write_b32 v82, v35 offset:2240
    v_mul_u32_u24 v47, 254, v47
    ds_write_b16_d16_hi v15, v27
    ds_write_b16 v18, v27
    s_waitcnt lgkmcnt(0)
    s_barrier
    s_setprio 1
    ds_read_b64 v[128:129], v10 offset:2048
    ds_read_b64 v[130:131], v10 offset:2056
    ds_read_b128 v[64:67], v11 offset:448
    ds_read_b64 v[160:161], v10 offset:1536
    ds_read_b64 v[162:163], v10 offset:1544
    ds_read_b128 v[68:71], v11 offset:960
    ds_read_b64 v[132:133], v10 offset:1984
    ds_read_b64 v[134:135], v10 offset:1992
    ds_read_b128 v[72:75], v11 offset:384
    ds_read_b64 v[164:165], v10 offset:1472
    ds_read_b64 v[166:167], v10 offset:1480
    ds_read_b128 v[76:79], v11 offset:896
    ds_read_b64 v[136:137], v10 offset:1920
    ds_read_b64 v[138:139], v10 offset:1928
    s_waitcnt lgkmcnt(11)
    v_mfma_f32_16x16x32_bf16 v[80:83], v[128:131], v[64:67], 0
    ds_read_b128 v[108:111], v11 offset:320
    ds_read_b64 v[168:169], v10 offset:1408
    s_waitcnt lgkmcnt(5)
    v_mfma_f32_16x16x32_bf16 v[84:87], v[160:163], v[64:67], 0
    ds_read_b64 v[170:171], v10 offset:1416
    ds_read_b128 v[112:115], v11 offset:832
    v_mfma_f32_16x16x32_bf16 v[84:87], v[128:131], v[68:71], v[84:87]
    ds_read_b64 v[140:141], v10 offset:1856
    ds_read_b64 v[142:143], v10 offset:1864
    v_mfma_f32_16x16x32_bf16 v[80:83], v[132:135], v[72:75], v[80:83]
    ds_read_b128 v[116:119], v11 offset:256
    ds_read_b64 v[172:173], v10 offset:1344
    v_mfma_f32_16x16x32_bf16 v[84:87], v[164:167], v[72:75], v[84:87]
    ds_read_b64 v[174:175], v10 offset:1352
    ds_read_b128 v[120:123], v11 offset:768
    s_waitcnt lgkmcnt(6)
    v_mfma_f32_16x16x32_bf16 v[84:87], v[132:135], v[76:79], v[84:87]
    ds_read_b64 v[144:145], v10 offset:1792
    ds_read_b64 v[146:147], v10 offset:1800
    v_mfma_f32_16x16x32_bf16 v[80:83], v[136:139], v[108:111], v[80:83]
    ds_read_b128 v[124:127], v11 offset:192
    ds_read_b64 v[176:177], v10 offset:1280
    v_mfma_f32_16x16x32_bf16 v[84:87], v[168:171], v[108:111], v[84:87]
    ds_read_b64 v[178:179], v10 offset:1288
    ds_read_b128 v[64:67], v11 offset:704
    v_mfma_f32_16x16x32_bf16 v[84:87], v[136:139], v[112:115], v[84:87]
    ds_read_b64 v[148:149], v10 offset:1728
    ds_read_b64 v[150:151], v10 offset:1736
    s_waitcnt lgkmcnt(5)
    v_mfma_f32_16x16x32_bf16 v[80:83], v[140:143], v[116:119], v[80:83]
    ds_read_b128 v[68:71], v11 offset:128
    ds_read_b64 v[180:181], v10 offset:1216
    v_mfma_f32_16x16x32_bf16 v[84:87], v[172:175], v[116:119], v[84:87]
    ds_read_b64 v[182:183], v10 offset:1224
    ds_read_b128 v[72:75], v11 offset:640
    v_mfma_f32_16x16x32_bf16 v[84:87], v[140:143], v[120:123], v[84:87]
    ds_read_b64 v[152:153], v10 offset:1664
    ds_read_b64 v[154:155], v10 offset:1672
    v_mfma_f32_16x16x32_bf16 v[80:83], v[144:147], v[124:127], v[80:83]
    ds_read_b128 v[76:79], v11 offset:64
    ds_read_b64 v[184:185], v10 offset:1152
    s_waitcnt lgkmcnt(5)
    v_mfma_f32_16x16x32_bf16 v[84:87], v[176:179], v[124:127], v[84:87]
    ds_read_b64 v[186:187], v10 offset:1160
    ds_read_b128 v[108:111], v11 offset:576
    v_mfma_f32_16x16x32_bf16 v[84:87], v[144:147], v[64:67], v[84:87]
    ds_read_b64 v[156:157], v10 offset:1600
    ds_read_b64 v[158:159], v10 offset:1608
    v_mfma_f32_16x16x32_bf16 v[80:83], v[148:151], v[68:71], v[80:83]
    ds_read_b128 v[112:115], v11 offset:0
    ds_read_b64 v[188:189], v10 offset:1088
    v_mfma_f32_16x16x32_bf16 v[84:87], v[180:183], v[68:71], v[84:87]
    ds_read_b64 v[190:191], v10 offset:1096
    ds_read_b128 v[116:119], v11 offset:512
    s_waitcnt lgkmcnt(6)
    v_mfma_f32_16x16x32_bf16 v[84:87], v[148:151], v[72:75], v[84:87]
    ds_read_b64 v[192:193], v10 offset:1024
    ds_read_b64 v[194:195], v10 offset:1032
    v_mfma_f32_16x16x32_bf16 v[80:83], v[152:155], v[76:79], v[80:83]
    ds_read_b128 v[120:123], v11 offset:448
    ds_read_b64 v[224:225], v10 offset:512
    v_mfma_f32_16x16x32_bf16 v[84:87], v[184:187], v[76:79], v[84:87]
    ds_read_b64 v[226:227], v10 offset:520
    ds_read_b128 v[124:127], v11 offset:960
    v_mfma_f32_16x16x32_bf16 v[84:87], v[152:155], v[108:111], v[84:87]
    ds_read_b128 v[64:67], v11 offset:1472
    s_waitcnt lgkmcnt(4)
    v_mfma_f32_16x16x32_bf16 v[80:83], v[156:159], v[112:115], v[80:83]
    ds_read_b128 v[68:71], v11 offset:1984
    v_mfma_f32_16x16x32_bf16 v[84:87], v[188:191], v[112:115], v[84:87]
    ds_read_b64 v[196:197], v10 offset:960
    v_mfma_f32_16x16x32_bf16 v[84:87], v[156:159], v[116:119], v[84:87]
    ds_read_b64 v[198:199], v10 offset:968
    v_mfma_f32_16x16x32_bf16 v[32:35], v[192:195], v[120:123], 0
    ds_read_b128 v[72:75], v11 offset:384
    s_waitcnt lgkmcnt(5)
    v_mfma_f32_16x16x32_bf16 v[36:39], v[224:227], v[120:123], 0
    ds_read_b64 v[228:229], v10 offset:448
    ds_read_b64 v[230:231], v10 offset:456
    v_mfma_f32_16x16x32_bf16 v[32:35], v[160:163], v[124:127], v[32:35]
    ds_read_b128 v[76:79], v11 offset:896
    v_cvt_pk_bf16_f32 v80, v80, v81
    v_mfma_f32_16x16x32_bf16 v[36:39], v[192:195], v[124:127], v[36:39]
    ds_read_b128 v[108:111], v11 offset:1408
    s_waitcnt lgkmcnt(7)
    v_cvt_pk_bf16_f32 v81, v82, v83
    v_mfma_f32_16x16x32_bf16 v[32:35], v[128:131], v[64:67], v[32:35]
    ds_read_b128 v[112:115], v11 offset:1920
    ds_write_b64 v7, v[80:81] offset:0
    v_mfma_f32_16x16x32_bf16 v[36:39], v[160:163], v[64:67], v[36:39]
    ds_read_b64 v[200:201], v10 offset:896
    ds_read_b64 v[202:203], v10 offset:904
    v_cvt_pk_bf16_f32 v84, v84, v85
    v_mfma_f32_16x16x32_bf16 v[36:39], v[128:131], v[68:71], v[36:39]
    ds_read_b128 v[116:119], v11 offset:320
    ds_read_b64 v[232:233], v10 offset:384
    s_waitcnt lgkmcnt(7)
    v_cvt_pk_bf16_f32 v85, v86, v87
    v_mfma_f32_16x16x32_bf16 v[32:35], v[196:199], v[72:75], v[32:35]
    ds_read_b64 v[234:235], v10 offset:392
    ds_read_b128 v[120:123], v11 offset:832
    ds_write_b64 v7, v[84:85] offset:512
    v_mfma_f32_16x16x32_bf16 v[36:39], v[228:231], v[72:75], v[36:39]
    ds_read_b128 v[124:127], v11 offset:1344
    ds_write_b32 v88, v88 offset:0
    v_mfma_f32_16x16x32_bf16 v[32:35], v[164:167], v[76:79], v[32:35]
    ds_read_b128 v[64:67], v11 offset:1856
    v_mfma_f32_16x16x32_bf16 v[36:39], v[196:199], v[76:79], v[36:39]
    ds_read_b64 v[204:205], v10 offset:832
    s_waitcnt lgkmcnt(8)
    v_mfma_f32_16x16x32_bf16 v[32:35], v[132:135], v[108:111], v[32:35]
    ds_read_b64 v[206:207], v10 offset:840
    ds_read_b128 v[68:71], v11 offset:256
    v_mfma_f32_16x16x32_bf16 v[36:39], v[164:167], v[108:111], v[36:39]
    ds_read_b64 v[236:237], v10 offset:320
    ds_read_b64 v[238:239], v10 offset:328
    v_mfma_f32_16x16x32_bf16 v[36:39], v[132:135], v[112:115], v[36:39]
    ds_read_b128 v[72:75], v11 offset:768
    v_mfma_f32_16x16x32_bf16 v[32:35], v[200:203], v[116:119], v[32:35]
    ds_read_b128 v[76:79], v11 offset:1280
    s_waitcnt lgkmcnt(9)
    v_mfma_f32_16x16x32_bf16 v[36:39], v[232:235], v[116:119], v[36:39]
    ds_read_b128 v[108:111], v11 offset:1792
    v_mfma_f32_16x16x32_bf16 v[32:35], v[168:171], v[120:123], v[32:35]
    ds_read_b64 v[208:209], v10 offset:768
    v_mfma_f32_16x16x32_bf16 v[36:39], v[200:203], v[120:123], v[36:39]
    ds_read_b64 v[210:211], v10 offset:776
    v_mfma_f32_16x16x32_bf16 v[32:35], v[136:139], v[124:127], v[32:35]
    ds_read_b128 v[112:115], v11 offset:192
    v_mfma_f32_16x16x32_bf16 v[36:39], v[168:171], v[124:127], v[36:39]
    ds_read_b64 v[240:241], v10 offset:256
    ds_read_b64 v[242:243], v10 offset:264
    s_waitcnt lgkmcnt(7)
    v_mfma_f32_16x16x32_bf16 v[36:39], v[136:139], v[64:67], v[36:39]
    ds_read_b128 v[116:119], v11 offset:704
    v_mfma_f32_16x16x32_bf16 v[32:35], v[204:207], v[68:71], v[32:35]
    ds_read_b128 v[120:123], v11 offset:1216
    v_mfma_f32_16x16x32_bf16 v[36:39], v[236:239], v[68:71], v[36:39]
    ds_read_b128 v[124:127], v11 offset:1728
    v_mfma_f32_16x16x32_bf16 v[32:35], v[172:175], v[72:75], v[32:35]
    ds_read_b64 v[212:213], v10 offset:704
    v_mfma_f32_16x16x32_bf16 v[36:39], v[204:207], v[72:75], v[36:39]
    ds_read_b64 v[214:215], v10 offset:712
    s_waitcnt lgkmcnt(7)
    v_mfma_f32_16x16x32_bf16 v[32:35], v[140:143], v[76:79], v[32:35]
    ds_read_b128 v[64:67], v11 offset:128
    v_mfma_f32_16x16x32_bf16 v[36:39], v[172:175], v[76:79], v[36:39]
    ds_read_b64 v[244:245], v10 offset:192
    ds_read_b64 v[246:247], v10 offset:200
    v_mfma_f32_16x16x32_bf16 v[36:39], v[140:143], v[108:111], v[36:39]
    ds_read_b128 v[68:71], v11 offset:640
    v_mfma_f32_16x16x32_bf16 v[32:35], v[208:211], v[112:115], v[32:35]
    ds_read_b128 v[72:75], v11 offset:1152
    s_waitcnt lgkmcnt(8)
    v_mfma_f32_16x16x32_bf16 v[36:39], v[240:243], v[112:115], v[36:39]
    ds_read_b128 v[76:79], v11 offset:1664
    v_mfma_f32_16x16x32_bf16 v[32:35], v[176:179], v[116:119], v[32:35]
    ds_read_b64 v[216:217], v10 offset:640
    v_mfma_f32_16x16x32_bf16 v[36:39], v[208:211], v[116:119], v[36:39]
    ds_read_b64 v[218:219], v10 offset:648
    v_mfma_f32_16x16x32_bf16 v[32:35], v[144:147], v[120:123], v[32:35]
    ds_read_b128 v[108:111], v11 offset:64
    v_mfma_f32_16x16x32_bf16 v[36:39], v[176:179], v[120:123], v[36:39]
    ds_read_b64 v[248:249], v10 offset:128
    ds_read_b64 v[250:251], v10 offset:136
    s_waitcnt lgkmcnt(7)
    v_mfma_f32_16x16x32_bf16 v[36:39], v[144:147], v[124:127], v[36:39]
    ds_read_b128 v[112:115], v11 offset:576
    v_mfma_f32_16x16x32_bf16 v[32:35], v[212:215], v[64:67], v[32:35]
    ds_read_b128 v[116:119], v11 offset:1088
    v_mfma_f32_16x16x32_bf16 v[36:39], v[244:247], v[64:67], v[36:39]
    ds_read_b128 v[120:123], v11 offset:1600
    v_mfma_f32_16x16x32_bf16 v[32:35], v[180:183], v[68:71], v[32:35]
    ds_read_b64 v[220:221], v10 offset:576
    v_mfma_f32_16x16x32_bf16 v[36:39], v[212:215], v[68:71], v[36:39]
    ds_read_b64 v[222:223], v10 offset:584
    s_waitcnt lgkmcnt(7)
    v_mfma_f32_16x16x32_bf16 v[32:35], v[148:151], v[72:75], v[32:35]
    ds_read_b128 v[124:127], v11 offset:0
    v_mfma_f32_16x16x32_bf16 v[36:39], v[180:183], v[72:75], v[36:39]
    ds_read_b64 v[252:253], v10 offset:64
    ds_read_b64 v[254:255], v10 offset:72
    v_mfma_f32_16x16x32_bf16 v[36:39], v[148:151], v[76:79], v[36:39]
    ds_read_b128 v[64:67], v11 offset:512
    v_mfma_f32_16x16x32_bf16 v[32:35], v[216:219], v[108:111], v[32:35]
    ds_read_b128 v[68:71], v11 offset:1024
    s_waitcnt lgkmcnt(8)
    v_mfma_f32_16x16x32_bf16 v[36:39], v[248:251], v[108:111], v[36:39]
    ds_read_b128 v[72:75], v11 offset:1536
    v_mfma_f32_16x16x32_bf16 v[32:35], v[184:187], v[112:115], v[32:35]
    ds_read_b128 v[76:79], v11 offset:960
    v_mfma_f32_16x16x32_bf16 v[36:39], v[216:219], v[112:115], v[36:39]
    ds_read_b128 v[108:111], v11 offset:1472
    v_mfma_f32_16x16x32_bf16 v[32:35], v[152:155], v[116:119], v[32:35]
    ds_read_b128 v[112:115], v11 offset:1984
    v_mfma_f32_16x16x32_bf16 v[36:39], v[184:187], v[116:119], v[36:39]
    s_waitcnt lgkmcnt(5)
    v_mfma_f32_16x16x32_bf16 v[36:39], v[152:155], v[120:123], v[36:39]
    ds_read_b128 v[116:119], v11 offset:2496
    v_mfma_f32_16x16x32_bf16 v[32:35], v[220:223], v[124:127], v[32:35]
    v_mfma_f32_16x16x32_bf16 v[36:39], v[252:255], v[124:127], v[36:39]
    ds_read_b128 v[120:123], v11 offset:3008
    v_mfma_f32_16x16x32_bf16 v[32:35], v[188:191], v[64:67], v[32:35]
    v_mfma_f32_16x16x32_bf16 v[36:39], v[220:223], v[64:67], v[36:39]
    ds_read_b128 v[124:127], v11 offset:896
    s_waitcnt lgkmcnt(5)
    v_mfma_f32_16x16x32_bf16 v[32:35], v[156:159], v[68:71], v[32:35]
    ds_read_b128 v[64:67], v11 offset:1408
    v_mfma_f32_16x16x32_bf16 v[36:39], v[188:191], v[68:71], v[36:39]
    v_mfma_f32_16x16x32_bf16 v[36:39], v[156:159], v[72:75], v[36:39]
    ds_read_b128 v[68:71], v11 offset:1920
    v_mfma_f32_16x16x32_bf16 v[48:51], v[224:227], v[76:79], 0
    s_waitcnt lgkmcnt(5)
    v_mfma_f32_16x16x32_bf16 v[48:51], v[192:195], v[108:111], v[48:51]
    ds_read_b128 v[72:75], v11 offset:2432
    v_mfma_f32_16x16x32_bf16 v[52:55], v[224:227], v[108:111], 0
    ds_read_b128 v[76:79], v11 offset:2944
    v_cvt_pk_bf16_f32 v32, v32, v33
    v_mfma_f32_16x16x32_bf16 v[48:51], v[160:163], v[112:115], v[48:51]
    ds_read_b128 v[108:111], v11 offset:448
    v_cvt_pk_bf16_f32 v33, v34, v35
    v_mfma_f32_16x16x32_bf16 v[52:55], v[192:195], v[112:115], v[52:55]
    ds_read_b64 v[12:13], v10 offset:0
    s_waitcnt lgkmcnt(7)
    ds_write_b64 v7, v[32:33] offset:1024
    v_mfma_f32_16x16x32_bf16 v[48:51], v[128:131], v[116:119], v[48:51]
    ds_read_b64 v[14:15], v10 offset:8
    v_cvt_pk_bf16_f32 v36, v36, v37
    v_mfma_f32_16x16x32_bf16 v[52:55], v[160:163], v[116:119], v[52:55]
    ds_read_b128 v[112:115], v11 offset:432
    v_cvt_pk_bf16_f32 v37, v38, v39
    v_mfma_f32_16x16x32_bf16 v[52:55], v[128:131], v[120:123], v[52:55]
    ds_read_b128 v[116:119], v11 offset:960
    s_waitcnt lgkmcnt(8)
    ds_write_b64 v7, v[36:37] offset:1536
    v_mfma_f32_16x16x32_bf16 v[48:51], v[228:231], v[124:127], v[48:51]
    ds_read_b128 v[120:123], v11 offset:944
    ds_write_b32 v88, v88 offset:16
    v_mfma_f32_16x16x32_bf16 v[48:51], v[196:199], v[64:67], v[48:51]
    ds_read_b128 v[124:127], v11 offset:832
    v_mfma_f32_16x16x32_bf16 v[52:55], v[228:231], v[64:67], v[52:55]
    ds_read_b128 v[64:67], v11 offset:1344
    v_mfma_f32_16x16x32_bf16 v[48:51], v[164:167], v[68:71], v[48:51]
    v_mfma_f32_16x16x32_bf16 v[52:55], v[196:199], v[68:71], v[52:55]
    ds_read_b128 v[68:71], v11 offset:1856
    s_waitcnt lgkmcnt(11)
    v_mfma_f32_16x16x32_bf16 v[48:51], v[132:135], v[72:75], v[48:51]
    v_mfma_f32_16x16x32_bf16 v[52:55], v[164:167], v[72:75], v[52:55]
    ds_read_b128 v[72:75], v11 offset:2368
    v_mfma_f32_16x16x32_bf16 v[52:55], v[132:135], v[76:79], v[52:55]
    ds_read_b128 v[76:79], v11 offset:2880
    v_mfma_f32_16x16x32_bf16 v[80:83], v[108:111], v[40:43], 0
    s_waitcnt lgkmcnt(8)
    v_mfma_f32_16x16x32_bf16 v[48:51], v[12:15], v[108:111], v[48:51]
    ds_read_b128 v[108:111], v11 offset:768
    v_mfma_f32_16x16x32_bf16 v[84:87], v[112:115], v[44:47], 0
    ds_read_b128 v[112:115], v11 offset:1280
    v_mfma_f32_16x16x32_bf16 v[32:35], v[116:119], v[40:43], 0
    v_mfma_f32_16x16x32_bf16 v[52:55], v[12:15], v[116:119], v[52:55]
    ds_read_b128 v[116:119], v11 offset:1792
    s_waitcnt lgkmcnt(6)
    v_mfma_f32_16x16x32_bf16 v[36:39], v[120:123], v[44:47], 0
    ds_read_b128 v[120:123], v11 offset:2304
    v_mfma_f32_16x16x32_bf16 v[48:51], v[232:235], v[124:127], v[48:51]
    v_mfma_f32_16x16x32_bf16 v[48:51], v[200:203], v[64:67], v[48:51]
    ds_read_b128 v[124:127], v11 offset:2816
    v_mfma_f32_16x16x32_bf16 v[52:55], v[232:235], v[64:67], v[52:55]
    s_waitcnt lgkmcnt(6)
    v_mfma_f32_16x16x32_bf16 v[48:51], v[168:171], v[68:71], v[48:51]
    ds_read_b128 v[64:67], v11 offset:704
    v_mfma_f32_16x16x32_bf16 v[52:55], v[200:203], v[68:71], v[52:55]
    ds_read_b128 v[68:71], v11 offset:1216
    v_mfma_f32_16x16x32_bf16 v[48:51], v[136:139], v[72:75], v[48:51]
    v_mfma_f32_16x16x32_bf16 v[52:55], v[168:171], v[72:75], v[52:55]
    ds_read_b128 v[72:75], v11 offset:1728
    s_waitcnt lgkmcnt(6)
    v_mfma_f32_16x16x32_bf16 v[52:55], v[136:139], v[76:79], v[52:55]
    ds_read_b128 v[76:79], v11 offset:2240
    v_cvt_pk_bf16_f32 v92, v84, v80
    v_mfma_f32_16x16x32_bf16 v[48:51], v[236:239], v[108:111], v[48:51]
    v_cvt_pk_bf16_f32 v93, v85, v81
    v_cvt_pk_bf16_f32 v94, v86, v82
    v_mfma_f32_16x16x32_bf16 v[48:51], v[204:207], v[112:115], v[48:51]
    ds_read_b128 v[108:111], v11 offset:2752
    v_cvt_pk_bf16_f32 v95, v87, v83
    v_mfma_f32_16x16x32_bf16 v[52:55], v[236:239], v[112:115], v[52:55]
    ds_read2_b32 v[16:17], v4 offset0:48 offset1:49
    s_waitcnt lgkmcnt(7)
    v_mfma_f32_16x16x32_bf16 v[48:51], v[172:175], v[116:119], v[48:51]
    ds_read2_b32 v[18:19], v4 offset0:50 offset1:51
    v_mfma_f32_16x16x32_bf16 v[52:55], v[204:207], v[116:119], v[52:55]
    ds_read2_b32 v[20:21], v4 offset0:32 offset1:33
    v_mfma_f32_16x16x32_bf16 v[48:51], v[140:143], v[120:123], v[48:51]
    ds_read2_b32 v[22:23], v4 offset0:34 offset1:35
    v_mfma_f32_16x16x32_bf16 v[52:55], v[172:175], v[120:123], v[52:55]
    ds_read_b128 v[112:115], v11 offset:640
    s_waitcnt lgkmcnt(8)
    v_mfma_f32_16x16x32_bf16 v[52:55], v[140:143], v[124:127], v[52:55]
    ds_read_b128 v[116:119], v11 offset:1152
    v_cvt_pk_bf16_f32 v96, v36, v32
    v_mfma_f32_16x16x32_bf16 v[48:51], v[240:243], v[64:67], v[48:51]
    ds_read_b128 v[120:123], v11 offset:1664
    v_cvt_pk_bf16_f32 v97, v37, v33
    v_mfma_f32_16x16x32_bf16 v[48:51], v[208:211], v[68:71], v[48:51]
    ds_read_b128 v[124:127], v11 offset:2176
    v_cvt_pk_bf16_f32 v98, v38, v34
    v_mfma_f32_16x16x32_bf16 v[52:55], v[240:243], v[68:71], v[52:55]
    s_waitcnt lgkmcnt(9)
    v_cvt_pk_bf16_f32 v99, v39, v35
    v_mfma_f32_16x16x32_bf16 v[48:51], v[176:179], v[72:75], v[48:51]
    ds_read_b128 v[64:67], v11 offset:2688
    v_mfma_f32_16x16x32_bf16 v[52:55], v[208:211], v[72:75], v[52:55]
    ds_read_b128 v[68:71], v11 offset:576
    v_mfma_f32_16x16x32_bf16 v[48:51], v[144:147], v[76:79], v[48:51]
    ds_read_b128 v[72:75], v11 offset:1088
    v_mfma_f32_16x16x32_bf16 v[52:55], v[176:179], v[76:79], v[52:55]
    s_waitcnt lgkmcnt(7)
    v_mfma_f32_16x16x32_bf16 v[52:55], v[144:147], v[108:111], v[52:55]
    ds_read_b128 v[76:79], v11 offset:1600
    v_mfma_f32_16x16x32_bf16 v[48:51], v[92:95], v[16:19], v[48:51]
    v_mfma_f32_16x16x32_bf16 v[52:55], v[96:99], v[16:19], v[52:55]
    ds_read_b128 v[108:111], v11 offset:2112
    v_mfma_f32_16x16x32_bf16 v[52:55], v[92:95], v[20:23], v[52:55]
    s_waitcnt lgkmcnt(6)
    v_mfma_f32_16x16x32_bf16 v[48:51], v[244:247], v[112:115], v[48:51]
    ds_read_b128 v[112:115], v11 offset:2624
    v_mfma_f32_16x16x32_bf16 v[48:51], v[212:215], v[116:119], v[48:51]
    v_mfma_f32_16x16x32_bf16 v[52:55], v[244:247], v[116:119], v[52:55]
    ds_read_b128 v[116:119], v11 offset:512
    v_mfma_f32_16x16x32_bf16 v[48:51], v[180:183], v[120:123], v[48:51]
    v_mfma_f32_16x16x32_bf16 v[52:55], v[212:215], v[120:123], v[52:55]
    ds_read_b128 v[120:123], v11 offset:1024
    s_waitcnt lgkmcnt(6)
    v_mfma_f32_16x16x32_bf16 v[48:51], v[148:151], v[124:127], v[48:51]
    v_mfma_f32_16x16x32_bf16 v[52:55], v[180:183], v[124:127], v[52:55]
    ds_read_b128 v[124:127], v11 offset:1536
    v_mfma_f32_16x16x32_bf16 v[52:55], v[148:151], v[64:67], v[52:55]
    ds_read_b128 v[64:67], v11 offset:2048
    v_mfma_f32_16x16x32_bf16 v[48:51], v[248:251], v[68:71], v[48:51]
    ds_read_b128 v[68:71], v11 offset:2560
    s_waitcnt lgkmcnt(7)
    v_mfma_f32_16x16x32_bf16 v[48:51], v[216:219], v[72:75], v[48:51]
    v_mfma_f32_16x16x32_bf16 v[52:55], v[248:251], v[72:75], v[52:55]
    ds_read_b128 v[72:75], v11 offset:1984
    v_mfma_f32_16x16x32_bf16 v[48:51], v[184:187], v[76:79], v[48:51]
    v_mfma_f32_16x16x32_bf16 v[52:55], v[216:219], v[76:79], v[52:55]
    ds_read_b128 v[76:79], v11 offset:2496
    s_waitcnt lgkmcnt(6)
    v_mfma_f32_16x16x32_bf16 v[48:51], v[152:155], v[108:111], v[48:51]
    v_mfma_f32_16x16x32_bf16 v[52:55], v[184:187], v[108:111], v[52:55]
    ds_read_b128 v[108:111], v11 offset:3008
    v_mfma_f32_16x16x32_bf16 v[52:55], v[152:155], v[112:115], v[52:55]
    v_mfma_f32_16x16x32_bf16 v[48:51], v[252:255], v[116:119], v[48:51]
    ds_read_b128 v[112:115], v11 offset:3520
    s_waitcnt lgkmcnt(6)
    v_mfma_f32_16x16x32_bf16 v[48:51], v[220:223], v[120:123], v[48:51]
    v_mfma_f32_16x16x32_bf16 v[52:55], v[252:255], v[120:123], v[52:55]
    ds_read_b128 v[116:119], v11 offset:4032
    v_mfma_f32_16x16x32_bf16 v[48:51], v[188:191], v[124:127], v[48:51]
    v_mfma_f32_16x16x32_bf16 v[52:55], v[220:223], v[124:127], v[52:55]
    ds_read_b128 v[120:123], v11 offset:1472
    s_waitcnt lgkmcnt(5)
    v_mfma_f32_16x16x32_bf16 v[48:51], v[156:159], v[64:67], v[48:51]
    v_mfma_f32_16x16x32_bf16 v[52:55], v[188:191], v[64:67], v[52:55]
    ds_read_b128 v[124:127], v11 offset:1456
    v_mfma_f32_16x16x32_bf16 v[52:55], v[156:159], v[68:71], v[52:55]
    ds_read_b128 v[64:67], v11 offset:1984
    v_mfma_f32_16x16x32_bf16 v[56:59], v[224:227], v[72:75], 0
    s_waitcnt lgkmcnt(5)
    v_mfma_f32_16x16x32_bf16 v[56:59], v[192:195], v[76:79], v[56:59]
    ds_read_b128 v[68:71], v11 offset:1968
    v_mfma_f32_16x16x32_bf16 v[60:63], v[224:227], v[76:79], 0
    ds_read_b128 v[72:75], v11 offset:1920
    v_cvt_pk_bf16_f32 v48, v48, v49
    v_mfma_f32_16x16x32_bf16 v[56:59], v[160:163], v[108:111], v[56:59]
    ds_read_b128 v[76:79], v11 offset:2432
    v_cvt_pk_bf16_f32 v49, v50, v51
    v_mfma_f32_16x16x32_bf16 v[60:63], v[192:195], v[108:111], v[60:63]
    ds_read_b128 v[108:111], v11 offset:2944
    s_waitcnt lgkmcnt(7)
    ds_write_b64 v7, v[48:49] offset:2048
    v_mfma_f32_16x16x32_bf16 v[56:59], v[128:131], v[112:115], v[56:59]
    v_cvt_pk_bf16_f32 v52, v52, v53
    v_cvt_pk_bf16_f32 v53, v54, v55
    v_mfma_f32_16x16x32_bf16 v[60:63], v[160:163], v[112:115], v[60:63]
    ds_read_b128 v[112:115], v11 offset:3456
    ds_write_b64 v7, v[52:53] offset:2560
    v_mfma_f32_16x16x32_bf16 v[60:63], v[128:131], v[116:119], v[60:63]
    ds_write_b32 v88, v88 offset:32
    ds_read_b128 v[116:119], v11 offset:3968
    s_waitcnt lgkmcnt(9)
    v_mfma_f32_16x16x32_bf16 v[80:83], v[120:123], v[40:43], 0
    v_mfma_f32_16x16x32_bf16 v[56:59], v[12:15], v[120:123], v[56:59]
    ds_read2_b32 v[24:25], v4 offset0:16 offset1:17
    v_mfma_f32_16x16x32_bf16 v[84:87], v[124:127], v[44:47], 0
    ds_read2_b32 v[26:27], v4 offset0:18 offset1:19
    v_mfma_f32_16x16x32_bf16 v[32:35], v[64:67], v[40:43], 0
    ds_read_b128 v[120:123], v11 offset:1856
    v_mfma_f32_16x16x32_bf16 v[60:63], v[12:15], v[64:67], v[60:63]
    ds_read_b128 v[124:127], v11 offset:2368
    s_waitcnt lgkmcnt(10)
    v_mfma_f32_16x16x32_bf16 v[36:39], v[68:71], v[44:47], 0
    ds_read_b128 v[64:67], v11 offset:2880
    v_mfma_f32_16x16x32_bf16 v[56:59], v[228:231], v[72:75], v[56:59]
    v_mfma_f32_16x16x32_bf16 v[56:59], v[196:199], v[76:79], v[56:59]
    ds_read_b128 v[68:71], v11 offset:3392
    v_mfma_f32_16x16x32_bf16 v[60:63], v[228:231], v[76:79], v[60:63]
    s_waitcnt lgkmcnt(9)
    v_mfma_f32_16x16x32_bf16 v[56:59], v[164:167], v[108:111], v[56:59]
    ds_read_b128 v[72:75], v11 offset:3904
    v_mfma_f32_16x16x32_bf16 v[60:63], v[196:199], v[108:111], v[60:63]
    v_mfma_f32_16x16x32_bf16 v[56:59], v[132:135], v[112:115], v[56:59]
    v_mfma_f32_16x16x32_bf16 v[60:63], v[164:167], v[112:115], v[60:63]
    ds_read2_b32 v[28:29], v4 offset0:0 offset1:1
    s_waitcnt lgkmcnt(6)
    v_mfma_f32_16x16x32_bf16 v[60:63], v[132:135], v[116:119], v[60:63]
    ds_read2_b32 v[30:31], v4 offset0:2 offset1:3
    v_cvt_pk_bf16_f32 v100, v84, v80
    v_mfma_f32_16x16x32_bf16 v[56:59], v[96:99], v[20:23], v[56:59]
    ds_read_b128 v[76:79], v11 offset:1792
    v_cvt_pk_bf16_f32 v101, v85, v81
    v_mfma_f32_16x16x32_bf16 v[60:63], v[96:99], v[24:27], v[60:63]
    ds_read_b128 v[108:111], v11 offset:2304
    s_waitcnt lgkmcnt(6)
    v_cvt_pk_bf16_f32 v102, v86, v82
    v_mfma_f32_16x16x32_bf16 v[56:59], v[232:235], v[120:123], v[56:59]
    ds_read_b128 v[112:115], v11 offset:2816
    v_cvt_pk_bf16_f32 v103, v87, v83
    v_mfma_f32_16x16x32_bf16 v[56:59], v[200:203], v[124:127], v[56:59]
    ds_read_b128 v[116:119], v11 offset:3328
    v_mfma_f32_16x16x32_bf16 v[60:63], v[232:235], v[124:127], v[60:63]
    v_mfma_f32_16x16x32_bf16 v[56:59], v[168:171], v[64:67], v[56:59]
    ds_read_b128 v[120:123], v11 offset:3840
    v_mfma_f32_16x16x32_bf16 v[60:63], v[200:203], v[64:67], v[60:63]
    s_waitcnt lgkmcnt(7)
    v_mfma_f32_16x16x32_bf16 v[56:59], v[136:139], v[68:71], v[56:59]
    v_mfma_f32_16x16x32_bf16 v[60:63], v[168:171], v[68:71], v[60:63]
    v_mfma_f32_16x16x32_bf16 v[60:63], v[136:139], v[72:75], v[60:63]
    ds_read_b128 v[124:127], v11 offset:1728
    v_cvt_pk_bf16_f32 v104, v36, v32
    v_mfma_f32_16x16x32_bf16 v[56:59], v[92:95], v[24:27], v[56:59]
    ds_read_b128 v[64:67], v11 offset:2240
    s_waitcnt lgkmcnt(5)
    v_cvt_pk_bf16_f32 v105, v37, v33
    v_mfma_f32_16x16x32_bf16 v[60:63], v[92:95], v[28:31], v[60:63]
    ds_read_b128 v[68:71], v11 offset:2752
    v_cvt_pk_bf16_f32 v106, v38, v34
    v_mfma_f32_16x16x32_bf16 v[56:59], v[236:239], v[76:79], v[56:59]
    v_cvt_pk_bf16_f32 v107, v39, v35
    v_mfma_f32_16x16x32_bf16 v[56:59], v[204:207], v[108:111], v[56:59]
    ds_read_b128 v[72:75], v11 offset:3264
    v_mfma_f32_16x16x32_bf16 v[60:63], v[236:239], v[108:111], v[60:63]
    s_waitcnt lgkmcnt(5)
    v_mfma_f32_16x16x32_bf16 v[56:59], v[172:175], v[112:115], v[56:59]
    ds_read_b128 v[76:79], v11 offset:3776
    v_mfma_f32_16x16x32_bf16 v[60:63], v[204:207], v[112:115], v[60:63]
    ds_read_b128 v[108:111], v11 offset:1664
    v_mfma_f32_16x16x32_bf16 v[56:59], v[140:143], v[116:119], v[56:59]
    ds_read_b128 v[112:115], v11 offset:2176
    v_mfma_f32_16x16x32_bf16 v[60:63], v[172:175], v[116:119], v[60:63]
    s_waitcnt lgkmcnt(7)
    v_mfma_f32_16x16x32_bf16 v[60:63], v[140:143], v[120:123], v[60:63]
    ds_read_b128 v[116:119], v11 offset:2688
    v_mfma_f32_16x16x32_bf16 v[56:59], v[100:103], v[16:19], v[56:59]
    v_mfma_f32_16x16x32_bf16 v[60:63], v[104:107], v[16:19], v[60:63]
    ds_read_b128 v[120:123], v11 offset:3200
    v_mfma_f32_16x16x32_bf16 v[60:63], v[100:103], v[20:23], v[60:63]
    s_waitcnt lgkmcnt(6)
    v_mfma_f32_16x16x32_bf16 v[56:59], v[240:243], v[124:127], v[56:59]
    ds_read_b128 v[124:127], v11 offset:3712
    v_mfma_f32_16x16x32_bf16 v[56:59], v[208:211], v[64:67], v[56:59]
    v_mfma_f32_16x16x32_bf16 v[60:63], v[240:243], v[64:67], v[60:63]
    ds_read_b128 v[64:67], v11 offset:1600
    v_mfma_f32_16x16x32_bf16 v[56:59], v[176:179], v[68:71], v[56:59]
    v_mfma_f32_16x16x32_bf16 v[60:63], v[208:211], v[68:71], v[60:63]
    ds_read_b128 v[68:71], v11 offset:2112
    s_waitcnt lgkmcnt(6)
    v_mfma_f32_16x16x32_bf16 v[56:59], v[144:147], v[72:75], v[56:59]
    v_mfma_f32_16x16x32_bf16 v[60:63], v[176:179], v[72:75], v[60:63]
    ds_read_b128 v[72:75], v11 offset:2624
    v_mfma_f32_16x16x32_bf16 v[60:63], v[144:147], v[76:79], v[60:63]
    ds_read_b128 v[76:79], v11 offset:3136
    v_mfma_f32_16x16x32_bf16 v[56:59], v[244:247], v[108:111], v[56:59]
    ds_read_b128 v[108:111], v11 offset:3648
    s_waitcnt lgkmcnt(7)
    v_mfma_f32_16x16x32_bf16 v[56:59], v[212:215], v[112:115], v[56:59]
    v_mfma_f32_16x16x32_bf16 v[60:63], v[244:247], v[112:115], v[60:63]
    ds_read_b128 v[112:115], v11 offset:1536
    v_mfma_f32_16x16x32_bf16 v[56:59], v[180:183], v[116:119], v[56:59]
    v_mfma_f32_16x16x32_bf16 v[60:63], v[212:215], v[116:119], v[60:63]
    ds_read_b128 v[116:119], v11 offset:2048
    s_waitcnt lgkmcnt(6)
    v_mfma_f32_16x16x32_bf16 v[56:59], v[148:151], v[120:123], v[56:59]
    v_mfma_f32_16x16x32_bf16 v[60:63], v[180:183], v[120:123], v[60:63]
    ds_read_b128 v[120:123], v11 offset:2560
    v_mfma_f32_16x16x32_bf16 v[60:63], v[148:151], v[124:127], v[60:63]
    ds_read_b128 v[124:127], v11 offset:3072
    v_mfma_f32_16x16x32_bf16 v[56:59], v[248:251], v[64:67], v[56:59]
    ds_read_b128 v[64:67], v11 offset:3584
    s_waitcnt lgkmcnt(7)
    v_mfma_f32_16x16x32_bf16 v[56:59], v[216:219], v[68:71], v[56:59]
    v_mfma_f32_16x16x32_bf16 v[60:63], v[248:251], v[68:71], v[60:63]
    v_mfma_f32_16x16x32_bf16 v[56:59], v[184:187], v[72:75], v[56:59]
    v_mfma_f32_16x16x32_bf16 v[60:63], v[216:219], v[72:75], v[60:63]
    s_waitcnt lgkmcnt(4)
    v_mfma_f32_16x16x32_bf16 v[56:59], v[152:155], v[76:79], v[56:59]
    v_mfma_f32_16x16x32_bf16 v[60:63], v[184:187], v[76:79], v[60:63]
    v_mfma_f32_16x16x32_bf16 v[60:63], v[152:155], v[108:111], v[60:63]
    v_mfma_f32_16x16x32_bf16 v[56:59], v[252:255], v[112:115], v[56:59]
    s_waitcnt lgkmcnt(2)
    v_mfma_f32_16x16x32_bf16 v[56:59], v[220:223], v[116:119], v[56:59]
    v_mfma_f32_16x16x32_bf16 v[60:63], v[252:255], v[116:119], v[60:63]
    v_mfma_f32_16x16x32_bf16 v[56:59], v[188:191], v[120:123], v[56:59]
    v_mfma_f32_16x16x32_bf16 v[60:63], v[220:223], v[120:123], v[60:63]
    s_waitcnt lgkmcnt(0)
    v_mfma_f32_16x16x32_bf16 v[56:59], v[156:159], v[124:127], v[56:59]
    v_mfma_f32_16x16x32_bf16 v[60:63], v[188:191], v[124:127], v[60:63]
    v_mfma_f32_16x16x32_bf16 v[60:63], v[156:159], v[64:67], v[60:63]
    s_nop 5
    v_cvt_pk_bf16_f32 v56, v56, v57
    v_cvt_pk_bf16_f32 v57, v58, v59
    ds_write_b64 v7, v[56:57] offset:3072
    v_cvt_pk_bf16_f32 v60, v60, v61
    v_cvt_pk_bf16_f32 v61, v62, v63
    ds_write_b64 v7, v[60:61] offset:3584
    ds_write_b32 v88, v88 offset:48
    s_cmp_lg_u32 s39, 0
    s_cbranch_scc1 L_mw_end
    s_mul_i32 s42, s50, 9344
    s_add_u32 s42, s42, 69632
    v_add_u32 v18, s42, v3
    v_add_u32 v20, 4096, v18
    v_and_b32 v21, 0x70, v3
    s_add_u32 s42, s42, 5120
    v_add_u32 v21, s42, v21
    s_movk_i32 s61, 4096
    v_lshl_add_u32 v24, v9, 1, s54
    v_mov_b32 v35, s45
L_part_poll:
    global_load_dwordx4 v[164:167], v21, s[36:37] sc1
    global_load_dwordx4 v[128:131], v18, s[36:37] offset:-4096 sc1
    global_load_dwordx4 v[132:135], v18, s[36:37] offset:-3072 sc1
    global_load_dwordx4 v[136:139], v18, s[36:37] offset:-2048 sc1
    global_load_dwordx4 v[140:143], v18, s[36:37] offset:-1024 sc1
    global_load_dwordx4 v[144:147], v18, s[36:37] offset:0 sc1
    global_load_dwordx4 v[148:151], v18, s[36:37] offset:1024 sc1
    global_load_dwordx4 v[152:155], v18, s[36:37] offset:2048 sc1
    global_load_dwordx4 v[156:159], v18, s[36:37] offset:3072 sc1
    global_load_dwordx4 v[160:163], v20, s[36:37] offset:0 sc1
    v_mul_u32_u24 v26, 4640, v9
    v_add_u32 v26, 135648, v26
    v_lshlrev_b32 v27, 12, v9
    s_waitcnt vmcnt(9)
    v_bfe_u32 v28, v164, 8, 11
    v_lshl_add_u32 v29, v28, 1, v26
    v_lshl_add_u32 v30, v28, 1, v27
    ds_read_b128 v[36:39], v88 offset:48
    ds_read_u16_d16_hi v31, v29
    ds_read_u16_d16_hi v32, v30 offset:37120
    v_mul_u32_u24 v28, 1152, v28
    v_add_u32 v28, v28, v24
    v_xor_b32 v22, v35, v164
    s_waitcnt vmcnt(8)
    v_xor_b32 v128, v35, v128
    v_or_b32 v22, v22, v128
    s_waitcnt vmcnt(7)
    v_xor_b32 v132, v35, v132
    v_pk_add_f32 v[130:131], v[130:131], v[134:135]
    v_pk_add_f32 v[128:129], v[128:129], v[132:133]
    s_waitcnt vmcnt(6)
    v_xor_b32 v136, v35, v136
    v_pk_add_f32 v[130:131], v[130:131], v[138:139]
    v_pk_add_f32 v[128:129], v[128:129], v[136:137]
    v_bitop3_b32 v22, v22, v132, v136 bitop3:0xfe
    s_waitcnt vmcnt(5)
    v_xor_b32 v140, v35, v140
    v_pk_add_f32 v[130:131], v[130:131], v[142:143]
    v_pk_add_f32 v[128:129], v[128:129], v[140:141]
    s_waitcnt vmcnt(4)
    v_xor_b32 v144, v35, v144
    v_pk_add_f32 v[130:131], v[130:131], v[146:147]
    v_pk_add_f32 v[128:129], v[128:129], v[144:145]
    v_bitop3_b32 v22, v22, v140, v144 bitop3:0xfe
    s_waitcnt vmcnt(3)
    v_xor_b32 v148, v35, v148
    v_pk_add_f32 v[130:131], v[130:131], v[150:151]
    v_pk_add_f32 v[128:129], v[128:129], v[148:149]
    s_waitcnt vmcnt(2)
    v_xor_b32 v152, v35, v152
    v_pk_add_f32 v[130:131], v[130:131], v[154:155]
    v_pk_add_f32 v[128:129], v[128:129], v[152:153]
    v_bitop3_b32 v22, v22, v148, v152 bitop3:0xfe
    s_waitcnt vmcnt(1)
    v_xor_b32 v156, v35, v156
    v_pk_add_f32 v[130:131], v[130:131], v[158:159]
    v_pk_add_f32 v[128:129], v[128:129], v[156:157]
    s_waitcnt vmcnt(0)
    v_xor_b32 v160, v35, v160
    v_pk_add_f32 v[130:131], v[130:131], v[162:163]
    v_pk_add_f32 v[128:129], v[128:129], v[160:161]
    v_bitop3_b32 v22, v22, v156, v160 bitop3:0xfe
    s_waitcnt lgkmcnt(0)
    v_bitop3_b32 v36, v37, v38, v39 bitop3:0x7f
    v_and_b32 v36, 128, v36
    v_or_b32 v22, v22, v36
    v_and_b32 v22, 0xff, v22
    v_cmp_ne_u32 vcc, 0, v22
    v_permlane32_swap_b32 v128, v130
    s_sub_u32 s61, s61, 1
    s_cselect_b64 vcc, 0, vcc
    s_cbranch_vccnz L_part_poll
    v_permlane32_swap_b32 v129, v131
    v_add_f32 v128, v128, v130
    v_add_f32 v129, v129, v131
    v_and_b32 v31, 0xffff0000, v31
    v_and_b32 v32, 0xffff0000, v32
    v_permlane16_swap_b32 v128, v129
    v_add_f32 v128, v128, v129
    v_mul_f32 v31, 0x42000000, v31
    v_mul_f32 v32, 0x3d000000, v32
    v_add_f32_dpp v128, v128, v128 row_ror:8 row_mask:0xf bank_mask:0xf
    v_fma_f32 v128, v128, v165, v31
    v_mul_f32 v33, 0xbfb8aa3b, v128
    v_exp_f32 v33, v33
    v_fma_f32 v34, v31, v167, v166
    v_add_f32 v33, 1.0, v33
    v_rcp_f32 v33, v33
    v_mul_f32 v128, v128, v32
    v_fmac_f32 v34, v128, v33
    v_cvt_pk_bf16_f32 v34, v34, v34
    s_barrier
    global_store_short v28, v34, s[32:33]
L_mw_end:
    s_endpgm
L_helper:
    ds_read_b128 v[128:131], v79 offset:0
    ds_read_b128 v[160:163], v78 offset:16896
    ds_read_b128 v[192:195], v80 offset:25344
    ds_read_b128 v[132:135], v79 offset:16
    ds_read_b128 v[164:167], v78 offset:16912
    ds_read_b128 v[196:199], v80 offset:25360
    ds_read_b128 v[136:139], v79 offset:32
    ds_read_b128 v[168:171], v78 offset:16928
    ds_read_b128 v[200:203], v80 offset:25376
    ds_read_b128 v[140:143], v79 offset:48
    ds_read_b128 v[172:175], v78 offset:16944
    ds_read_b128 v[204:207], v80 offset:25392
    v_and_b32 v62, 255, v0
    v_lshlrev_b32 v4, 4, v62
    v_add_u32 v4, 20480, v4
    v_add_u32 v7, 8192, v4
    global_load_dwordx4 v[224:227], v4, s[36:37] offset:-4096 sc1
    global_load_dwordx4 v[228:231], v4, s[36:37] offset:0 sc1
    global_load_dwordx4 v[232:235], v7, s[36:37] offset:-4096 sc1
    global_load_dwordx4 v[236:239], v7, s[36:37] offset:0 sc1
    ds_read_b128 v[144:147], v79 offset:64
    ds_read_b128 v[176:179], v78 offset:16960
    ds_read_b128 v[208:211], v80 offset:25408
    s_waitcnt lgkmcnt(12)
    v_mfma_f32_16x16x32_bf16 v[20:23], v[160:163], v[128:131], 0
    v_mfma_f32_16x16x32_bf16 v[24:27], v[192:195], v[128:131], 0
    v_and_b32 v5, 3, v0
    v_mul_u32_u24 v5, 4640, v5
    v_lshl_add_u32 v5, v12, 4, v5
    v_add_u32 v5, 135648, v5
    ds_read_b128 v[148:151], v79 offset:80
    ds_read_b128 v[180:183], v78 offset:16976
    ds_read_b128 v[212:215], v80 offset:25424
    s_waitcnt lgkmcnt(12)
    v_mfma_f32_16x16x32_bf16 v[20:23], v[164:167], v[132:135], v[20:23]
    v_mfma_f32_16x16x32_bf16 v[24:27], v[196:199], v[132:135], v[24:27]
    v_mov_b32 v56, s4
    v_mov_b32 v57, s5
    v_mov_b32 v58, s6
    v_mov_b32 v59, s7
    ds_read_b128 v[152:155], v79 offset:96
    ds_read_b128 v[184:187], v78 offset:16992
    ds_read_b128 v[216:219], v80 offset:25440
    s_waitcnt lgkmcnt(12)
    v_mfma_f32_16x16x32_bf16 v[20:23], v[168:171], v[136:139], v[20:23]
    v_mfma_f32_16x16x32_bf16 v[24:27], v[200:203], v[136:139], v[24:27]
    v_add_u32 v14, 1, v9
    v_and_b32 v14, 6, v14
    v_add_u32 v14, v14, v14
    v_sub_u32 v14, 2112, v14
    ds_read_b128 v[156:159], v79 offset:112
    ds_read_b128 v[188:191], v78 offset:17008
    ds_read_b128 v[220:223], v80 offset:25456
    s_waitcnt lgkmcnt(12)
    v_mfma_f32_16x16x32_bf16 v[20:23], v[172:175], v[140:143], v[20:23]
    v_mfma_f32_16x16x32_bf16 v[24:27], v[204:207], v[140:143], v[24:27]
    v_and_b32 v14, s8, v14
    v_lshl_add_u32 v17, v8, 2, s62
    v_mul_u32_u24 v18, 2240, v9
    v_add3_u32 v14, v14, v18, v17
    s_waitcnt lgkmcnt(9)
    v_mfma_f32_16x16x32_bf16 v[20:23], v[176:179], v[144:147], v[20:23]
    v_mfma_f32_16x16x32_bf16 v[24:27], v[208:211], v[144:147], v[24:27]
    v_min_u32 v15, s9, v8
    v_sub_u32 v15, v15, v9
    v_lshl_add_u32 v15, v15, 1, v18
    v_add_u32 v15, s10, v15
    s_waitcnt lgkmcnt(6)
    v_mfma_f32_16x16x32_bf16 v[20:23], v[180:183], v[148:151], v[20:23]
    v_mfma_f32_16x16x32_bf16 v[24:27], v[212:215], v[148:151], v[24:27]
    v_and_b32 v18, 32, v0
    v_add_u32 v18, v18, v8
    v_bfe_i32 v19, v0, 4, 1
    v_add_u32 v18, v18, v18
    s_waitcnt lgkmcnt(3)
    v_mfma_f32_16x16x32_bf16 v[20:23], v[184:187], v[152:155], v[20:23]
    v_mfma_f32_16x16x32_bf16 v[24:27], v[216:219], v[152:155], v[24:27]
    v_sub_u32 v18, v19, v18
    v_lshl_add_u32 v18, v18, 1, s11
    s_waitcnt lgkmcnt(0)
    v_mfma_f32_16x16x32_bf16 v[20:23], v[188:191], v[156:159], v[20:23]
    v_mfma_f32_16x16x32_bf16 v[24:27], v[220:223], v[156:159], v[24:27]
    s_barrier
    ds_write_b32 v14, v84
    ds_write_b32 v17, v84 offset:9216
    s_nop 4
    v_readlane_b32 s42, v26, 63
    v_bitop3_b32 v19, v19, v26, v25 bitop3:0xca
    v_cvt_pk_bf16_f32 v28, v24, v22
    v_cvt_pk_bf16_f32 v29, v20, v20
    ds_write_b32 v81, v28 offset:1024
    v_cvt_pk_bf16_f32 v30, v24, v24
    ds_write_b32 v81, v29 offset:1028
    v_cvt_pk_bf16_f32 v31, v22, v20
    ds_write_b32 v82, v28 offset:1024
    v_cvt_pk_bf16_f32 v32, v26, v19
    ds_write_b32 v82, v29 offset:1028
    v_cvt_pk_bf16_f32 v33, v25, v25
    ds_write_b32 v81, v30 offset:3260
    v_cvt_pk_bf16_f32 v34, v26, v26
    ds_write_b32 v81, v31 offset:3264
    v_cvt_pk_bf16_f32 v35, v19, v25
    ds_write_b32 v82, v30 offset:3260
    v_cvt_pk_bf16_f32 v27, v27, s42
    ds_write_b32 v82, v31 offset:3264
    v_mov_b32 v63, 0x40004000
    v_and_b32 v88, 3, v0
    v_lshlrev_b32 v88, 2, v88
    ds_write_b32 v81, v32 offset:0
    v_add_u32 v88, 153728, v88
    s_movk_i32 s61, 4096
    v_lshlrev_b32 v37, 2, v62
    ds_write_b32 v81, v33 offset:4
    v_add_u32 v64, 135648, v37
    v_add_u32 v65, 140288, v37
    v_add_u32 v66, 144928, v37
    ds_write_b32 v82, v32 offset:0
    v_add_u32 v67, 149568, v37
    v_add_u32 v37, 37120, v37
    v_mul_u32_u24 v36, 2304, v62
    ds_write_b32 v82, v33 offset:4
    v_add_u32 v36, s54, v36
    v_mov_b32 v8, 0xc238aa3b
    v_mov_b32 v9, 0xffff0000
    ds_write_b32 v81, v34 offset:2236
    v_mov_b32 v10, 0x42000000
    v_lshlrev_b32 v62, 6, v62
    v_xor_b32 v62, s44, v62
    ds_write_b32 v81, v35 offset:2240
    ds_write_b32 v82, v34 offset:2236
    ds_write_b32 v82, v35 offset:2240
    ds_write_b16_d16_hi v15, v27
    ds_write_b16 v18, v27
    s_waitcnt vmcnt(4)
    v_xor_b32 v40, v56, v40
    v_xor_b32 v41, v57, v41
    v_xor_b32 v42, v58, v42
    v_xor_b32 v43, v59, v43
    ds_write_b128 v5, v[40:43] offset:0
    v_xor_b32 v44, v56, v44
    v_xor_b32 v45, v57, v45
    v_xor_b32 v46, v58, v46
    v_xor_b32 v47, v59, v47
    ds_write_b128 v5, v[44:47] offset:1024
    v_xor_b32 v48, v56, v48
    v_xor_b32 v49, v57, v49
    v_xor_b32 v50, v58, v50
    v_xor_b32 v51, v59, v51
    ds_write_b128 v5, v[48:51] offset:2048
    v_xor_b32 v52, v56, v52
    v_xor_b32 v53, v57, v53
    v_xor_b32 v54, v58, v54
    v_xor_b32 v55, v59, v55
    ds_write_b128 v5, v[52:55] offset:3072
    v_bitop3_b32 v38, v40, v41, v42 bitop3:0xfe
    v_bitop3_b32 v38, v38, v43, v44 bitop3:0xfe
    v_bitop3_b32 v38, v38, v45, v46 bitop3:0xfe
    v_bitop3_b32 v38, v38, v47, v48 bitop3:0xfe
    v_bitop3_b32 v38, v38, v49, v50 bitop3:0xfe
    v_bitop3_b32 v38, v38, v51, v52 bitop3:0xfe
    v_bitop3_b32 v38, v38, v53, v54 bitop3:0xfe
    v_bitop3_b32 v38, v38, v55, v63 bitop3:0xa8
    v_cmp_ne_u32 vcc, 0, v38
    s_cbranch_vccz L_tile_ok
L_tile_chk:
    global_load_dwordx4 v[40:43], v6, s[12:13] sc1
    global_load_dwordx4 v[44:47], v6, s[14:15] sc1
    global_load_dwordx4 v[48:51], v6, s[16:17] sc1
    global_load_dwordx4 v[52:55], v6, s[18:19] sc1
    s_waitcnt vmcnt(0)
    v_xor_b32 v40, v56, v40
    v_xor_b32 v41, v57, v41
    v_xor_b32 v42, v58, v42
    v_xor_b32 v43, v59, v43
    ds_write_b128 v5, v[40:43] offset:0
    v_xor_b32 v44, v56, v44
    v_xor_b32 v45, v57, v45
    v_xor_b32 v46, v58, v46
    v_xor_b32 v47, v59, v47
    ds_write_b128 v5, v[44:47] offset:1024
    v_xor_b32 v48, v56, v48
    v_xor_b32 v49, v57, v49
    v_xor_b32 v50, v58, v50
    v_xor_b32 v51, v59, v51
    ds_write_b128 v5, v[48:51] offset:2048
    v_xor_b32 v52, v56, v52
    v_xor_b32 v53, v57, v53
    v_xor_b32 v54, v58, v54
    v_xor_b32 v55, v59, v55
    ds_write_b128 v5, v[52:55] offset:3072
    v_bitop3_b32 v38, v40, v41, v42 bitop3:0xfe
    v_bitop3_b32 v38, v38, v43, v44 bitop3:0xfe
    v_bitop3_b32 v38, v38, v45, v46 bitop3:0xfe
    v_bitop3_b32 v38, v38, v47, v48 bitop3:0xfe
    v_bitop3_b32 v38, v38, v49, v50 bitop3:0xfe
    v_bitop3_b32 v38, v38, v51, v52 bitop3:0xfe
    v_bitop3_b32 v38, v38, v53, v54 bitop3:0xfe
    v_bitop3_b32 v38, v38, v55, v63 bitop3:0xa8
    v_cmp_ne_u32 vcc, 0, v38
    s_sub_u32 s61, s61, 1
    s_cselect_b64 vcc, 0, vcc
    s_cbranch_vccnz L_tile_chk
L_tile_ok:
    s_mov_b32 s61, 262144
    s_waitcnt vmcnt(0)
L_h_poll:
    v_mov_b32 v41, 0
    v_xor_b32 v42, 65504, v225
    v_bitop3_b32 v41, v41, v42, v62 bitop3:0xf6
    v_xor_b32 v42, 65472, v227
    v_bitop3_b32 v41, v41, v42, v62 bitop3:0xf6
    v_xor_b32 v42, 49120, v229
    v_bitop3_b32 v41, v41, v42, v62 bitop3:0xf6
    v_xor_b32 v42, 49088, v231
    v_bitop3_b32 v41, v41, v42, v62 bitop3:0xf6
    v_xor_b32 v42, 32736, v233
    v_bitop3_b32 v41, v41, v42, v62 bitop3:0xf6
    v_xor_b32 v42, 32704, v235
    v_bitop3_b32 v41, v41, v42, v62 bitop3:0xf6
    v_xor_b32 v42, 16352, v237
    v_bitop3_b32 v41, v41, v42, v62 bitop3:0xf6
    v_xor_b32 v42, 16320, v239
    v_bitop3_b32 v41, v41, v42, v62 bitop3:0xf6
    v_and_b32 v41, 0xffff, v41
    v_cmp_ne_u32 vcc, 0, v41
    s_cbranch_vccz L_h_ok
    global_load_dwordx4 v[224:227], v4, s[36:37] offset:-4096 sc1
    global_load_dwordx4 v[228:231], v4, s[36:37] offset:0 sc1
    global_load_dwordx4 v[232:235], v7, s[36:37] offset:-4096 sc1
    global_load_dwordx4 v[236:239], v7, s[36:37] offset:0 sc1
    s_waitcnt vmcnt(0)
    s_sub_u32 s61, s61, 64
    s_cbranch_scc0 L_h_poll
L_h_ok:
    s_setprio 2
    s_waitcnt lgkmcnt(0)
    s_barrier
    ds_read2st64_b32 v[16:17], v64 offset0:0 offset1:4
    ds_read2st64_b32 v[18:19], v65 offset0:0 offset1:4
    ds_read2st64_b32 v[20:21], v66 offset0:0 offset1:4
    ds_read2st64_b32 v[22:23], v67 offset0:0 offset1:4
    ds_read2st64_b32 v[24:25], v64 offset0:8 offset1:12
    ds_read2st64_b32 v[26:27], v65 offset0:8 offset1:12
    ds_read2st64_b32 v[28:29], v66 offset0:8 offset1:12
    ds_read2st64_b32 v[30:31], v67 offset0:8 offset1:12
    s_waitcnt lgkmcnt(4)
    s_setprio 0
    v_lshlrev_b32 v96, 16, v16
    v_lshlrev_b32 v97, 16, v18
    v_lshlrev_b32 v98, 16, v20
    v_lshlrev_b32 v99, 16, v22
    v_mul_f32 v104, v8, v96
    v_mul_f32 v105, v8, v97
    v_mul_f32 v106, v8, v98
    v_mul_f32 v107, v8, v99
    v_exp_f32 v104, v104
    v_exp_f32 v105, v105
    v_exp_f32 v106, v106
    v_exp_f32 v107, v107
    v_and_b32 v121, v9, v224
    v_add_f32 v104, 1.0, v104
    v_add_f32 v105, 1.0, v105
    v_add_f32 v106, 1.0, v106
    v_add_f32 v107, 1.0, v107
    v_rcp_f32 v104, v104
    v_rcp_f32 v105, v105
    v_rcp_f32 v106, v106
    v_rcp_f32 v107, v107
    v_lshlrev_b32 v120, 16, v224
    v_mul_f32 v121, v10, v121
    v_and_b32 v100, v9, v16
    v_and_b32 v101, v9, v18
    v_and_b32 v102, v9, v20
    v_and_b32 v103, v9, v22
    v_mul_f32 v108, v8, v100
    v_mul_f32 v109, v8, v101
    v_mul_f32 v110, v8, v102
    v_mul_f32 v111, v8, v103
    v_exp_f32 v108, v108
    v_exp_f32 v109, v109
    v_exp_f32 v110, v110
    v_exp_f32 v111, v111
    v_and_b32 v123, v9, v226
    v_add_f32 v108, 1.0, v108
    v_add_f32 v109, 1.0, v109
    v_add_f32 v110, 1.0, v110
    v_add_f32 v111, 1.0, v111
    v_rcp_f32 v108, v108
    v_rcp_f32 v109, v109
    v_rcp_f32 v110, v110
    v_rcp_f32 v111, v111
    v_lshlrev_b32 v122, 16, v226
    v_mul_f32 v123, v10, v123
    v_lshlrev_b32 v128, 16, v17
    v_lshlrev_b32 v129, 16, v19
    v_lshlrev_b32 v130, 16, v21
    v_lshlrev_b32 v131, 16, v23
    v_mul_f32 v136, v8, v128
    v_mul_f32 v137, v8, v129
    v_mul_f32 v138, v8, v130
    v_mul_f32 v139, v8, v131
    v_exp_f32 v136, v136
    v_exp_f32 v137, v137
    v_exp_f32 v138, v138
    v_exp_f32 v139, v139
    v_and_b32 v153, v9, v228
    v_add_f32 v136, 1.0, v136
    v_add_f32 v137, 1.0, v137
    v_add_f32 v138, 1.0, v138
    v_add_f32 v139, 1.0, v139
    v_rcp_f32 v136, v136
    v_rcp_f32 v137, v137
    v_rcp_f32 v138, v138
    v_rcp_f32 v139, v139
    v_lshlrev_b32 v152, 16, v228
    v_mul_f32 v153, v10, v153
    s_setprio 2
L_w0:
    ds_read_b32 v41, v88 offset:0
    s_waitcnt lgkmcnt(0)
    v_cmp_eq_u32 vcc, 0, v41
    s_cbranch_vccz L_w0_ok
    s_sleep 2
    s_sub_u32 s61, s61, 1
    s_cbranch_scc0 L_w0
L_w0_ok:
    ds_read2st64_b32 v[32:33], v37 offset0:0 offset1:16
    ds_read2st64_b32 v[34:35], v37 offset0:32 offset1:48
    s_setprio 0
    s_waitcnt lgkmcnt(0)
    v_lshlrev_b32 v112, 16, v32
    v_lshlrev_b32 v113, 16, v33
    v_lshlrev_b32 v114, 16, v34
    v_lshlrev_b32 v115, 16, v35
    v_fma_f32 v112, v112, v104, v121
    v_fma_f32 v113, v113, v105, v121
    v_fma_f32 v114, v114, v106, v121
    v_fma_f32 v115, v115, v107, v121
    v_fma_f32 v96, v96, v112, v120
    v_fma_f32 v97, v97, v113, v120
    v_fma_f32 v98, v98, v114, v120
    v_fma_f32 v99, v99, v115, v120
    v_cvt_pk_bf16_f32 v104, v96, v97
    v_cvt_pk_bf16_f32 v105, v98, v99
    global_store_dwordx2 v36, v[104:105], s[32:33] offset:0
    v_and_b32 v116, v9, v32
    v_and_b32 v117, v9, v33
    v_and_b32 v118, v9, v34
    v_and_b32 v119, v9, v35
    v_fma_f32 v116, v116, v108, v123
    v_fma_f32 v117, v117, v109, v123
    v_fma_f32 v118, v118, v110, v123
    v_fma_f32 v119, v119, v111, v123
    v_fma_f32 v100, v100, v116, v122
    v_fma_f32 v101, v101, v117, v122
    v_fma_f32 v102, v102, v118, v122
    v_fma_f32 v103, v103, v119, v122
    v_cvt_pk_bf16_f32 v108, v100, v101
    v_cvt_pk_bf16_f32 v109, v102, v103
    v_and_b32 v132, v9, v17
    v_and_b32 v133, v9, v19
    v_and_b32 v134, v9, v21
    v_and_b32 v135, v9, v23
    v_mul_f32 v140, v8, v132
    v_mul_f32 v141, v8, v133
    v_mul_f32 v142, v8, v134
    v_mul_f32 v143, v8, v135
    v_exp_f32 v140, v140
    v_exp_f32 v141, v141
    v_exp_f32 v142, v142
    v_exp_f32 v143, v143
    v_and_b32 v155, v9, v230
    v_add_f32 v140, 1.0, v140
    v_add_f32 v141, 1.0, v141
    v_add_f32 v142, 1.0, v142
    v_add_f32 v143, 1.0, v143
    v_rcp_f32 v140, v140
    v_rcp_f32 v141, v141
    v_rcp_f32 v142, v142
    v_rcp_f32 v143, v143
    v_lshlrev_b32 v154, 16, v230
    v_mul_f32 v155, v10, v155
    global_store_dwordx2 v36, v[108:109], s[32:33] offset:1152
    v_add_u32 v36, 589824, v36
    v_lshlrev_b32 v160, 16, v24
    v_lshlrev_b32 v161, 16, v26
    v_lshlrev_b32 v162, 16, v28
    v_lshlrev_b32 v163, 16, v30
    v_mul_f32 v168, v8, v160
    v_mul_f32 v169, v8, v161
    v_mul_f32 v170, v8, v162
    v_mul_f32 v171, v8, v163
    v_exp_f32 v168, v168
    v_exp_f32 v169, v169
    v_exp_f32 v170, v170
    v_exp_f32 v171, v171
    v_and_b32 v185, v9, v232
    v_add_f32 v168, 1.0, v168
    v_add_f32 v169, 1.0, v169
    v_add_f32 v170, 1.0, v170
    v_add_f32 v171, 1.0, v171
    v_rcp_f32 v168, v168
    v_rcp_f32 v169, v169
    v_rcp_f32 v170, v170
    v_rcp_f32 v171, v171
    v_lshlrev_b32 v184, 16, v232
    v_mul_f32 v185, v10, v185
    s_setprio 2
L_w1:
    ds_read_b32 v41, v88 offset:16
    s_waitcnt lgkmcnt(0)
    v_cmp_eq_u32 vcc, 0, v41
    s_cbranch_vccz L_w1_ok
    s_sleep 2
    s_sub_u32 s61, s61, 1
    s_cbranch_scc0 L_w1
L_w1_ok:
    ds_read2st64_b32 v[32:33], v37 offset0:4 offset1:20
    ds_read2st64_b32 v[34:35], v37 offset0:36 offset1:52
    s_setprio 0
    s_waitcnt lgkmcnt(0)
    v_lshlrev_b32 v144, 16, v32
    v_lshlrev_b32 v145, 16, v33
    v_lshlrev_b32 v146, 16, v34
    v_lshlrev_b32 v147, 16, v35
    v_fma_f32 v144, v144, v136, v153
    v_fma_f32 v145, v145, v137, v153
    v_fma_f32 v146, v146, v138, v153
    v_fma_f32 v147, v147, v139, v153
    v_fma_f32 v128, v128, v144, v152
    v_fma_f32 v129, v129, v145, v152
    v_fma_f32 v130, v130, v146, v152
    v_fma_f32 v131, v131, v147, v152
    v_cvt_pk_bf16_f32 v136, v128, v129
    v_cvt_pk_bf16_f32 v137, v130, v131
    global_store_dwordx2 v36, v[136:137], s[32:33] offset:0
    v_and_b32 v148, v9, v32
    v_and_b32 v149, v9, v33
    v_and_b32 v150, v9, v34
    v_and_b32 v151, v9, v35
    v_fma_f32 v148, v148, v140, v155
    v_fma_f32 v149, v149, v141, v155
    v_fma_f32 v150, v150, v142, v155
    v_fma_f32 v151, v151, v143, v155
    v_fma_f32 v132, v132, v148, v154
    v_fma_f32 v133, v133, v149, v154
    v_fma_f32 v134, v134, v150, v154
    v_fma_f32 v135, v135, v151, v154
    v_cvt_pk_bf16_f32 v140, v132, v133
    v_cvt_pk_bf16_f32 v141, v134, v135
    v_and_b32 v164, v9, v24
    v_and_b32 v165, v9, v26
    v_and_b32 v166, v9, v28
    v_and_b32 v167, v9, v30
    v_mul_f32 v172, v8, v164
    v_mul_f32 v173, v8, v165
    v_mul_f32 v174, v8, v166
    v_mul_f32 v175, v8, v167
    v_exp_f32 v172, v172
    v_exp_f32 v173, v173
    v_exp_f32 v174, v174
    v_exp_f32 v175, v175
    v_and_b32 v187, v9, v234
    v_add_f32 v172, 1.0, v172
    v_add_f32 v173, 1.0, v173
    v_add_f32 v174, 1.0, v174
    v_add_f32 v175, 1.0, v175
    v_rcp_f32 v172, v172
    v_rcp_f32 v173, v173
    v_rcp_f32 v174, v174
    v_rcp_f32 v175, v175
    v_lshlrev_b32 v186, 16, v234
    v_mul_f32 v187, v10, v187
    global_store_dwordx2 v36, v[140:141], s[32:33] offset:1152
    v_add_u32 v36, 589824, v36
    v_lshlrev_b32 v192, 16, v25
    v_lshlrev_b32 v193, 16, v27
    v_lshlrev_b32 v194, 16, v29
    v_lshlrev_b32 v195, 16, v31
    v_mul_f32 v200, v8, v192
    v_mul_f32 v201, v8, v193
    v_mul_f32 v202, v8, v194
    v_mul_f32 v203, v8, v195
    v_exp_f32 v200, v200
    v_exp_f32 v201, v201
    v_exp_f32 v202, v202
    v_exp_f32 v203, v203
    v_and_b32 v217, v9, v236
    v_add_f32 v200, 1.0, v200
    v_add_f32 v201, 1.0, v201
    v_add_f32 v202, 1.0, v202
    v_add_f32 v203, 1.0, v203
    v_rcp_f32 v200, v200
    v_rcp_f32 v201, v201
    v_rcp_f32 v202, v202
    v_rcp_f32 v203, v203
    v_lshlrev_b32 v216, 16, v236
    v_mul_f32 v217, v10, v217
    s_setprio 2
L_w2:
    ds_read_b32 v41, v88 offset:32
    s_waitcnt lgkmcnt(0)
    v_cmp_eq_u32 vcc, 0, v41
    s_cbranch_vccz L_w2_ok
    s_sleep 2
    s_sub_u32 s61, s61, 1
    s_cbranch_scc0 L_w2
L_w2_ok:
    ds_read2st64_b32 v[32:33], v37 offset0:8 offset1:24
    ds_read2st64_b32 v[34:35], v37 offset0:40 offset1:56
    s_setprio 0
    s_waitcnt lgkmcnt(0)
    v_lshlrev_b32 v176, 16, v32
    v_lshlrev_b32 v177, 16, v33
    v_lshlrev_b32 v178, 16, v34
    v_lshlrev_b32 v179, 16, v35
    v_fma_f32 v176, v176, v168, v185
    v_fma_f32 v177, v177, v169, v185
    v_fma_f32 v178, v178, v170, v185
    v_fma_f32 v179, v179, v171, v185
    v_fma_f32 v160, v160, v176, v184
    v_fma_f32 v161, v161, v177, v184
    v_fma_f32 v162, v162, v178, v184
    v_fma_f32 v163, v163, v179, v184
    v_cvt_pk_bf16_f32 v168, v160, v161
    v_cvt_pk_bf16_f32 v169, v162, v163
    global_store_dwordx2 v36, v[168:169], s[32:33] offset:0
    v_and_b32 v180, v9, v32
    v_and_b32 v181, v9, v33
    v_and_b32 v182, v9, v34
    v_and_b32 v183, v9, v35
    v_fma_f32 v180, v180, v172, v187
    v_fma_f32 v181, v181, v173, v187
    v_fma_f32 v182, v182, v174, v187
    v_fma_f32 v183, v183, v175, v187
    v_fma_f32 v164, v164, v180, v186
    v_fma_f32 v165, v165, v181, v186
    v_fma_f32 v166, v166, v182, v186
    v_fma_f32 v167, v167, v183, v186
    v_cvt_pk_bf16_f32 v172, v164, v165
    v_cvt_pk_bf16_f32 v173, v166, v167
    v_and_b32 v196, v9, v25
    v_and_b32 v197, v9, v27
    v_and_b32 v198, v9, v29
    v_and_b32 v199, v9, v31
    v_mul_f32 v204, v8, v196
    v_mul_f32 v205, v8, v197
    v_mul_f32 v206, v8, v198
    v_mul_f32 v207, v8, v199
    v_exp_f32 v204, v204
    v_exp_f32 v205, v205
    v_exp_f32 v206, v206
    v_exp_f32 v207, v207
    v_and_b32 v219, v9, v238
    v_add_f32 v204, 1.0, v204
    v_add_f32 v205, 1.0, v205
    v_add_f32 v206, 1.0, v206
    v_add_f32 v207, 1.0, v207
    v_rcp_f32 v204, v204
    v_rcp_f32 v205, v205
    v_rcp_f32 v206, v206
    v_rcp_f32 v207, v207
    v_lshlrev_b32 v218, 16, v238
    v_mul_f32 v219, v10, v219
    global_store_dwordx2 v36, v[172:173], s[32:33] offset:1152
    v_add_u32 v36, 589824, v36
    s_setprio 2
L_w3:
    ds_read_b32 v41, v88 offset:48
    ds_read2st64_b32 v[32:33], v37 offset0:12 offset1:28
    ds_read2st64_b32 v[34:35], v37 offset0:44 offset1:60
    s_waitcnt lgkmcnt(0)
    v_cmp_eq_u32 vcc, 0, v41
    s_cbranch_vccz L_w3_ok
    s_sleep 1
    s_sub_u32 s61, s61, 1
    s_cbranch_scc0 L_w3
L_w3_ok:
    v_lshlrev_b32 v208, 16, v32
    v_lshlrev_b32 v209, 16, v33
    v_lshlrev_b32 v210, 16, v34
    v_lshlrev_b32 v211, 16, v35
    v_fma_f32 v208, v208, v200, v217
    v_fma_f32 v209, v209, v201, v217
    v_fma_f32 v210, v210, v202, v217
    v_fma_f32 v211, v211, v203, v217
    v_fma_f32 v192, v192, v208, v216
    v_fma_f32 v193, v193, v209, v216
    v_fma_f32 v194, v194, v210, v216
    v_fma_f32 v195, v195, v211, v216
    v_cvt_pk_bf16_f32 v200, v192, v193
    v_cvt_pk_bf16_f32 v201, v194, v195
    global_store_dwordx2 v36, v[200:201], s[32:33] offset:0
    v_and_b32 v212, v9, v32
    v_and_b32 v213, v9, v33
    v_and_b32 v214, v9, v34
    v_and_b32 v215, v9, v35
    v_fma_f32 v212, v212, v204, v219
    v_fma_f32 v213, v213, v205, v219
    v_fma_f32 v214, v214, v206, v219
    v_fma_f32 v215, v215, v207, v219
    v_fma_f32 v196, v196, v212, v218
    v_fma_f32 v197, v197, v213, v218
    v_fma_f32 v198, v198, v214, v218
    v_fma_f32 v199, v199, v215, v218
    v_cvt_pk_bf16_f32 v204, v196, v197
    v_cvt_pk_bf16_f32 v205, v198, v199
    global_store_dwordx2 v36, v[204:205], s[32:33] offset:1152
    s_waitcnt vmcnt(0)
    s_barrier
L_end:
    s_endpgm
.section .rodata,"a"
.p2align 6
.amdhsa_kernel recurrent_scan__ssm_conv_s4__moe_arch_mod__prompt_kernel
  .amdhsa_next_free_vgpr 256
  .amdhsa_next_free_sgpr 102
  .amdhsa_accum_offset 256
  .amdhsa_group_segment_fixed_size 0
  .amdhsa_kernarg_size 136
  .amdhsa_user_sgpr_count 2
  .amdhsa_user_sgpr_kernarg_segment_ptr 1
  .amdhsa_system_sgpr_workgroup_id_x 1
  .amdhsa_float_denorm_mode_32 3
.end_amdhsa_kernel
```

```asm
; @launch grid=(256,1,1) block=(512,1,1) lds=163840
.amdgcn_target "amdgcn-amd-amdhsa--gfx950"
.text
.globl recurrent_scan__ssm_conv_s4__moe_arch_mod__prompt_kernel
.p2align 8
.type recurrent_scan__ssm_conv_s4__moe_arch_mod__prompt_kernel,@function
recurrent_scan__ssm_conv_s4__moe_arch_mod__prompt_kernel:
    s_load_dwordx16 s[4:19], s[0:1], 0
    s_load_dwordx16 s[20:35], s[0:1], 64
    s_load_dwordx2 s[36:37], s[0:1], 128
    s_cmp_ge_u32 s2, 256
    s_cbranch_scc1 L_end
    s_lshr_b32 s41, s2, 3
    s_getpc_b64 s[42:43]
L_pc:
    s_mul_i32 s47, s41, 768
    s_add_u32 s42, s42, s47
    s_addc_u32 s43, s43, 0
    v_lshlrev_b32 v4, 7, v0
    v_mov_b32 v5, s43
    v_add_co_u32 v4, vcc, s42, v4
    v_lshrrev_b32 v1, 6, v0
    v_and_b32 v2, 63, v0
    v_addc_co_u32 v5, vcc, 0, v5, vcc
    s_sub_u32 s47, L_end - L_pc - 4, s47
    s_ashr_i32 s47, s47, 7
    s_min_i32 s47, s47, 5
    v_cmp_ge_i32 vcc, s47, v0
    s_nop 0
    s_and_saveexec_b64 s[48:49], vcc
    s_cbranch_execz L_nopf
    global_load_dword v255, v[4:5], off
L_nopf:
    s_mov_b64 exec, -1
    v_readfirstlane_b32 s39, v1
    s_and_b32 s40, s2, 7
    s_mul_i32 s42, s2, 9216
    v_lshlrev_b32 v3, 4, v2
    v_lshlrev_b32 v4, 1, v2
    v_mul_u32_u24 v5, 1152, v1
    v_add3_u32 v6, v5, v3, s42
    v_add3_u32 v7, v5, v4, s42
    s_waitcnt lgkmcnt(0)
    global_load_dwordx4 v[12:15], v6, s[4:5]
    global_load_ushort v16, v7, s[4:5] offset:1024
    s_load_dword s38, s[36:37], 0
    global_load_dwordx4 v[20:23], v3, s[24:25]
    global_load_ushort v24, v4, s[24:25] offset:1024
    s_and_b32 s51, s39, 3
    s_lshr_b32 s52, s39, 2
    s_cmp_lt_u32 s41, 18
    s_cbranch_scc1 L_conv_pre
    s_cmp_lt_u32 s41, 27
    s_cbranch_scc1 L_ffn_pre
    s_sub_u32 s53, s41, 27
    s_and_b32 s58, s39, 1
    s_lshr_b32 s43, s39, 1
    s_mul_i32 s42, s43, 320
    s_add_u32 s42, s42, 1152
    s_cmp_eq_u32 s43, 0
    s_cmovk_i32 s42, 1152
    s_cmp_eq_u32 s43, 1
    s_cselect_b32 s48, 1, 0
    s_mul_i32 s59, s58, 320
    s_cmp_eq_u32 s43, 3
    s_cselect_b32 s42, s59, s42
    s_cmovk_i32 s58, 2
    s_lshl_b32 s53, s53, 6
    s_add_u32 s42, s42, s53
    s_mul_i32 s43, s40, 1152
    s_add_u32 s43, s43, 884736
    s_mul_i32 s59, s40, 663552
    s_cmp_eq_u32 s58, 0
    s_cselect_b32 s56, s26, s28
    s_cselect_b32 s57, s27, s29
    s_cmp_eq_u32 s58, 2
    s_cselect_b32 s56, s30, s56
    s_cselect_b32 s57, s31, s57
    s_cselect_b32 s43, s59, s43
    s_movk_i32 s58, 128
    s_movk_i32 s59, 8064
    s_movk_i32 s60, 4319
    s_cmov_b32 s58, 73728
    s_cmov_b32 s59, -663424
    s_cmovk_i32 s60, 5183
    v_add_u32 v76, s42, v2
    v_min_u32 v76, s60, v76
    v_mul_u32_u24 v63, 7282, v76
    v_lshrrev_b32 v63, 16, v63
    v_mul_u32_u24 v76, s58, v76
    v_mad_i32_i24 v76, v63, s59, v76
    v_add_u32 v76, s43, v76
    s_mov_b32 s49, 0
    s_branch L_lnp
L_ffn_pre:
    s_sub_u32 s54, s41, 18
    s_mul_i32 s50, s40, 9
    s_add_u32 s50, s50, s54
    v_bfe_u32 v76, v0, 3, 5
    v_bfe_u32 v61, v0, 4, 1
    v_bfe_u32 v62, v0, 6, 1
    v_lshl_add_u32 v61, v62, 1, v61
    v_lshlrev_b32 v61, 1, v61
    v_and_b32 v62, 7, v0
    v_xor_b32 v61, v61, v62
    v_mul_u32_u24 v76, 9216, v76
    v_lshlrev_b32 v61, 4, v61
    s_lshl_b32 s42, s50, 7
    v_add3_u32 v76, v76, v61, s42
    s_lshl_b32 s53, s51, 10
    s_cmp_eq_u32 s52, 0
    s_cselect_b32 s56, s26, s28
    s_cselect_b32 s57, s27, s29
    s_cselect_b32 s42, 0, 73728
    s_add_u32 s42, s53, s42
    s_mov_b32 s49, s42
    v_mov_b32 v62, 0
    v_mov_b32 v63, 0
    v_lshrrev_b32 v61, 1, v3
    v_add_u32 v61, 147456, v61
    ds_write_b64 v61, v[62:63]
    s_mov_b32 s47, 3
    s_mov_b32 s48, 0
    s_branch L_lnp
L_conv_pre:
    s_mul_i32 s50, s40, 18
    s_add_u32 s50, s50, s41
    s_lshl_b32 s53, s50, 2
    s_add_u32 s53, s53, s51
    s_lshl_b32 s42, s53, 8
    s_lshl_b32 s43, s52, 7
    s_add_u32 s42, s42, s43
    v_add_u32 v60, s42, v4
    s_lshl_b32 s54, s50, 3
    s_lshl_b32 s42, s53, 1
    v_mov_b32 v61, s42
    v_mov_b64 v[64:65], 0
    v_mov_b64 v[66:67], 0
    v_mov_b64 v[68:69], 0
    v_mov_b64 v[70:71], 0
    s_barrier
    global_load_short_d16_hi v70, v61, s[18:19]
    global_load_short_d16_hi v64, v60, s[6:7]
    global_load_short_d16_hi v65, v60, s[8:9]
    global_load_short_d16_hi v66, v60, s[10:11]
    global_load_short_d16_hi v67, v60, s[12:13]
    global_load_short_d16_hi v68, v60, s[14:15]
    global_load_short_d16_hi v69, v60, s[16:17]
    global_load_short_d16_hi v71, v61, s[20:21]
    s_lshr_b32 s42, s51, 1
    s_mul_i32 s42, s42, 2112
    s_and_b32 s58, s51, 1
    s_mul_i32 s43, s51, 1152
    s_add_u32 s43, s43, 576
    s_cmp_eq_u32 s52, 0
    s_cmovk_i32 s42, 3168
    s_lshl_b32 s43, s41, 6
    s_add_u32 s42, s42, s43
    s_mul_i32 s43, s40, 1152
    s_add_u32 s43, s43, 884736
    s_mul_i32 s59, s40, 663552
    s_cmp_eq_u32 s58, 0
    s_cselect_b32 s56, s26, s28
    s_cselect_b32 s57, s27, s29
    s_cmp_eq_u32 s58, 2
    s_cselect_b32 s56, s30, s56
    s_cselect_b32 s57, s31, s57
    s_cselect_b32 s43, s59, s43
    s_movk_i32 s58, 128
    s_movk_i32 s59, 8064
    s_movk_i32 s60, 4319
    s_cmov_b32 s58, 73728
    s_cmov_b32 s59, -663424
    s_cmovk_i32 s60, 5183
    v_add_u32 v76, s42, v2
    v_min_u32 v76, s60, v76
    v_mul_u32_u24 v63, 7282, v76
    v_lshrrev_b32 v63, 16, v63
    v_mul_u32_u24 v76, s58, v76
    v_mad_i32_i24 v76, v63, s59, v76
    v_add_u32 v76, s43, v76
    s_lshr_b32 s47, s39, 1
    s_mul_i32 s55, s51, 33792
    s_lshl_b32 s42, s52, 8
    s_add_u32 m0, s55, s42
    s_mul_i32 s63, s51, 4640
    s_add_u32 s63, s63, 135168
    v_mov_b64 v[84:85], 0
    v_mov_b64 v[86:87], 0
    s_cmp_eq_u32 s52, 0
    s_cbranch_scc1 L_cp_m
    s_setprio 1
    v_min_u32 v83, 29, v2
    v_lshl_add_u32 v83, v83, 4, s63
    ds_write_b128 v83, v[84:87]
    v_and_b32 v88, 0x30, v3
    v_add_u32 v88, 153728, v88
    ds_write_b128 v88, v[84:87]
    s_branch L_cp_e
L_cp_m:
    v_and_b32 v8, 15, v0
    v_bfe_u32 v9, v0, 4, 2
    v_and_b32 v10, 31, v0
    v_and_b32 v11, 32, v0
    v_mul_u32_u24 v78, 528, v10
    v_lshl_add_u32 v78, v11, 3, v78
    v_add_u32 v78, s55, v78
    v_lshrrev_b32 v11, 1, v11
    v_lshl_add_u32 v10, v10, 5, v11
    s_add_u32 s42, s55, 1072
    v_sub_u32 v81, s42, v10
    v_bfe_i32 v79, v0, 4, 1
    v_sub_u32 v80, 495, v10
    v_ashrrev_i32 v80, 31, v80
    v_sub_u32 v82, 1007, v10
    v_ashrrev_i32 v82, 31, v82
    v_bfe_u32 v10, v0, 3, 2
    v_and_b32 v11, 7, v0
    v_mul_u32_u24 v73, 2240, v10
    v_and_b32 v83, 4, v0
    v_lshl_add_u32 v83, v83, 5, v11
    v_lshl_add_u32 v83, v83, 4, v73
    v_lshlrev_b32 v72, 4, v10
    v_add_u32 v72, 9216, v72
    v_sub_u32 v74, 5, v11
    v_ashrrev_i32 v74, 31, v74
    v_bfi_b32 v83, v74, v72, v83
    v_add_u32 v83, s55, v83
    v_sub_u32 v74, 4, v11
    v_ashrrev_i32 v74, 31, v74
    v_and_b32 v74, 1021, v74
    v_add_u32 v74, v74, v11
    v_sub_u32 v74, v74, v10
    v_lshl_add_u32 v73, v74, 1, v73
    v_min_u32 v74, 1, v10
    v_lshl_add_u32 v73, v74, 3, v73
    s_add_u32 s42, s55, 54
    v_add_u32 v73, s42, v73
    v_max_u32 v72, 4, v11
    v_mul_u32_u24 v72, 0x202, v72
    v_add_u32 v72, 1284, v72
    v_and_b32 v72, 0x707, v72
L_cp_e:
L_clnp:
    s_mul_i32 s43, s39, 1216
    s_add_u32 s43, s43, 154048
    v_add_u32 v52, s43, v3
    v_add_u32 v53, s43, v4
    s_lshl_b32 s43, s39, 3
    s_add_u32 s43, s43, 163776
    v_mov_b32 v54, s43
    v_bfe_u32 v55, v0, 2, 2
    v_mul_u32_u24 v55, 1216, v55
    v_and_b32 v56, 3, v0
    v_lshl_add_u32 v55, v56, 3, v55
    v_lshrrev_b32 v56, 4, v0
    v_lshl_add_u32 v55, v56, 5, v55
    v_add_u32 v55, 154048, v55
    v_lshrrev_b32 v56, 3, v0
    v_lshlrev_b32 v56, 15, v56
    v_and_b32 v57, 112, v3
    s_lshl_b32 s43, s2, 7
    s_add_u32 s43, s43, 2097152
    v_add3_u32 v56, v56, v57, s43
    v_mov_b32 v40, 0
    v_mov_b32 v41, 0
    v_mov_b32 v42, 0
    v_mov_b32 v43, 0
    v_mov_b32 v44, 0x3ae38e39
    v_mov_b32 v38, 0xbfffbfff
    v_mov_b32 v37, 0xffff
    s_lshl_b32 s58, s2, 3
    s_add_u32 s58, s58, s39
    s_xor_b32 s58, s58, 0x7ff
    s_lshl_b32 s58, s58, 5
    s_waitcnt lgkmcnt(0)
    s_add_u32 s38, s38, 0x9e370001
    s_lshr_b32 s44, s38, 16
    s_and_b32 s45, s38, 0xff
    s_and_b32 s46, s38, 0xfb
    s_bitcmp0_b32 s38, 0
    s_cselect_b32 s43, 4, 0
    s_or_b32 s46, s46, s43
    s_bitcmp1_b32 s46, s39
    s_cselect_b32 s43, 0x40004000, 0
    v_mov_b32 v39, s43
    s_xor_b32 s58, s58, s44
    v_mov_b32 v57, s58
    s_mov_b32 s42, 0x3f803f80
    s_cmp_eq_u32 s47, 2
    s_cbranch_scc0 L_clw
    global_load_dword v1, v76, s[56:57]
    s_waitcnt vmcnt(9)
    s_branch L_cln
L_clw:
    s_waitcnt vmcnt(8)
L_cln:
    v_dot2c_f32_bf16 v40, s42, v12
    v_dot2c_f32_bf16 v41, v12, v12
    v_dot2c_f32_bf16 v42, v12, v20
    v_dot2c_f32_bf16 v43, s42, v20
    v_dot2c_f32_bf16 v40, s42, v13
    v_dot2c_f32_bf16 v41, v13, v13
    v_dot2c_f32_bf16 v42, v13, v21
    v_dot2c_f32_bf16 v43, s42, v21
    v_dot2c_f32_bf16 v40, s42, v14
    v_dot2c_f32_bf16 v41, v14, v14
    v_dot2c_f32_bf16 v42, v14, v22
    v_dot2c_f32_bf16 v43, s42, v22
    v_dot2c_f32_bf16 v40, s42, v15
    v_dot2c_f32_bf16 v41, v15, v15
    v_dot2c_f32_bf16 v42, v15, v23
    v_dot2c_f32_bf16 v43, s42, v23
    v_dot2c_f32_bf16 v40, s42, v16
    v_dot2c_f32_bf16 v41, v16, v16
    v_dot2c_f32_bf16 v42, v16, v24
    v_dot2c_f32_bf16 v43, s42, v24
    v_lshlrev_b32 v36, 16, v16
    v_lshlrev_b32 v28, 16, v12
    v_and_b32 v29, 0xffff0000, v12
    v_permlane32_swap_b32 v40, v42
    v_permlane32_swap_b32 v41, v43
    v_add_f32 v40, v40, v42
    v_add_f32 v41, v41, v43
    v_lshlrev_b32 v30, 16, v13
    v_and_b32 v31, 0xffff0000, v13
    v_permlane16_swap_b32 v40, v41
    v_add_f32 v40, v40, v41
    v_lshlrev_b32 v32, 16, v14
    v_and_b32 v33, 0xffff0000, v14
    v_add_f32_dpp v40, v40, v40 row_ror:8 row_mask:0xf bank_mask:0xf
    v_lshlrev_b32 v34, 16, v15
    v_and_b32 v35, 0xffff0000, v15
    v_add_f32_dpp v40, v40, v40 row_ror:4 row_mask:0xf bank_mask:0xf
    s_nop 1
    v_add_f32_dpp v40, v40, v40 row_ror:2 row_mask:0xf bank_mask:0xf
    s_nop 1
    v_add_f32_dpp v40, v40, v40 row_ror:1 row_mask:0xf bank_mask:0xf
    s_nop 0
    v_readlane_b32 s58, v40, 0
    v_readlane_b32 s59, v40, 16
    v_readlane_b32 s60, v40, 32
    v_readlane_b32 s61, v40, 48
    v_mul_f32 v40, s58, v44
    v_mul_f32 v41, s59, v44
    v_fma_f32 v41, -v40, v40, v41
    v_max_f32 v41, 0, v41
    v_cvt_pk_bf16_f32 v44, v41, v40
    v_lshlrev_b32 v41, 16, v44
    v_add_f32 v41, 0x3727c5ac, v41
    v_cvt_pk_bf16_f32 v41, v41, v41
    v_and_b32 v41, 0xffff0000, v41
    v_sqrt_f32 v41, v41
    v_and_b32 v49, 0xffff0000, v44
    v_cvt_pk_bf16_f32 v50, v49, v41
    v_and_b32 v41, 0xffff0000, v50
    v_rcp_f32 v48, v41
    v_mul_f32 v42, s61, v49
    v_mul_f32 v46, 0x3d000000, v48
    v_mul_f32 v47, v49, v46
    v_fma_f32 v28, v28, v46, -v47
    v_fma_f32 v29, v29, v46, -v47
    v_fma_f32 v30, v30, v46, -v47
    v_fma_f32 v31, v31, v46, -v47
    v_fma_f32 v32, v32, v46, -v47
    v_fma_f32 v33, v33, v46, -v47
    v_fma_f32 v34, v34, v46, -v47
    v_fma_f32 v35, v35, v46, -v47
    v_fma_f32 v36, v36, v46, -v47
    v_cvt_pk_bf16_f32 v28, v28, v29
    v_cvt_pk_bf16_f32 v29, v30, v31
    v_cvt_pk_bf16_f32 v30, v32, v33
    v_cvt_pk_bf16_f32 v31, v34, v35
    v_cvt_pk_bf16_f32 v32, v36, v36
    v_bitop3_b32 v28, v28, v38, v39 bitop3:0xea
    v_bitop3_b32 v29, v29, v38, v39 bitop3:0xea
    v_bitop3_b32 v30, v30, v38, v39 bitop3:0xea
    v_bitop3_b32 v31, v31, v38, v39 bitop3:0xea
    v_bitop3_b32 v32, v32, v38, v39 bitop3:0xea
    ds_write_b128 v52, v[28:31]
    ds_write_b16 v53, v32 offset:1024
    v_sub_f32 v42, s60, v42
    v_mul_f32 v42, v42, v48
    v_cvt_pk_bf16_f32 v42, v42, v42
    v_ashrrev_i32 v43, 31, v42
    v_or_b32 v43, 0x80000000, v43
    v_xor_b32 v42, v42, v43
    v_bitop3_b32 v51, v37, v57, v42 bitop3:0xca
    s_mov_b64 exec, 1
    ds_write_b64 v54, v[50:51]
    s_mov_b64 exec, -1
    s_waitcnt lgkmcnt(0)
    s_barrier
    s_cmp_eq_u32 s39, 1
    s_cbranch_scc1 L_cln_stat
    ds_read_b64_tr_b16 v[28:29], v55
    ds_read_b64_tr_b16 v[30:31], v55 offset:4864
    s_cmp_eq_u32 s39, 0
    s_cbranch_scc0 L_cln_st
    ds_read_b64_tr_b16 v[32:33], v55 offset:1024
    ds_read_b64_tr_b16 v[34:35], v55 offset:5888
    v_add_u32 v38, 2097152, v56
    s_waitcnt lgkmcnt(0)
    global_store_dwordx4 v38, v[32:35], s[36:37] sc1
    s_branch L_cln_st
L_cln_stat:
    v_and_b32 v41, 0x30, v3
    v_add_u32 v40, 163776, v41
    ds_read_b128 v[48:51], v40
    ds_read_b64_tr_b16 v[28:29], v55
    ds_read_b64_tr_b16 v[30:31], v55 offset:4864
    s_lshl_b32 s43, s2, 6
    s_add_u32 s43, s43, 16384
    v_add_u32 v41, s43, v41
    s_mov_b64 exec, 15
    s_waitcnt lgkmcnt(2)
    global_store_dwordx4 v41, v[48:51], s[36:37] sc1
    s_mov_b64 exec, -1
L_cln_st:
    s_waitcnt lgkmcnt(0)
    global_store_dwordx4 v56, v[28:31], s[36:37] sc1
    s_waitcnt vmcnt(2)
    s_cmp_eq_u32 s47, 3
    s_cbranch_scc0 L_ct1
    global_load_dword v1, v76, s[56:57]
L_ct1:
    v_mul_f32 v70, 0x3fb8aa3b, v70
    v_exp_f32 v70, v70
    v_mov_b32 v34, 0x3f80
    ds_write_addtid_b32 v34
    v_cvt_pk_bf16_f32 v70, v70, v70
    v_and_b32 v70, 0xffff0000, v70
    v_mul_f32 v64, v70, v64
    v_mul_f32 v65, v70, v65
    v_mul_f32 v70, 0x44800000, v70
    v_mul_f32 v64, 0x3fb8aa3b, v64
    v_mul_f32 v65, 0x3e22f983, v65
    v_mul_f32 v66, v70, v66
    v_mul_f32 v67, v70, v67
    v_mul_f32 v13, 0x41800000, v64
    v_mul_f32 v17, 0x41800000, v65
    v_mul_f32 v14, 0x44000000, v64
    v_mul_f32 v18, 0x44000000, v65
    v_exp_f32 v12, v64
    v_fract_f32 v16, v65
    v_exp_f32 v13, v13
    v_fract_f32 v17, v17
    v_exp_f32 v14, v14
    v_fract_f32 v18, v18
    v_pk_mul_f32 v[20:21], v[68:69], v[66:67] op_sel:[0,0] op_sel_hi:[0,1] neg_hi:[0,1]
    v_pk_fma_f32 v[90:91], v[68:69], v[66:67], v[20:21] op_sel:[1,1,0] op_sel_hi:[1,0,1] neg_lo:[0,1,0] neg_hi:[0,1,0]
    v_cos_f32 v22, v16
    v_sin_f32 v23, v16
    v_cos_f32 v24, v17
    v_sin_f32 v25, v17
    v_cos_f32 v26, v18
    v_sin_f32 v27, v18
    v_cvt_pk_bf16_f32 v35, v90, v91
    ds_write_addtid_b32 v35 offset:16896
    v_mul_f32 v22, v12, v22
    v_mul_f32 v23, -v12, v23
    v_mul_f32 v24, v13, v24
    v_mul_f32 v25, v13, v25
    v_mul_f32 v26, v14, v26
    v_mul_f32 v27, -v14, v27
    v_cvt_pk_bf16_f32 v36, v24, v25
    ds_write_addtid_b32 v36 offset:528
L_cs2:
    v_pk_mul_f32 v[30:31], v[24:25], v[24:25] op_sel:[0,0] op_sel_hi:[0,1]
    v_pk_fma_f32 v[28:29], v[24:25], v[24:25], v[30:31] op_sel:[1,1,0] op_sel_hi:[1,0,1] neg_lo:[0,1,0]
    v_cvt_pk_bf16_f32 v34, v28, v29
    ds_write_addtid_b32 v34 offset:1056
    v_pk_mul_f32 v[32:33], v[90:91], v[22:23] op_sel:[0,0] op_sel_hi:[0,1]
    v_pk_fma_f32 v[92:93], v[90:91], v[22:23], v[32:33] op_sel:[1,1,0] op_sel_hi:[1,0,1] neg_lo:[0,1,0]
    v_cvt_pk_bf16_f32 v35, v92, v93
    ds_write_addtid_b32 v35 offset:17424
    v_pk_mul_f32 v[30:31], v[28:29], v[24:25] op_sel:[0,0] op_sel_hi:[0,1]
    v_pk_fma_f32 v[28:29], v[28:29], v[24:25], v[30:31] op_sel:[1,1,0] op_sel_hi:[1,0,1] neg_lo:[0,1,0]
    v_cvt_pk_bf16_f32 v36, v28, v29
    ds_write_addtid_b32 v36 offset:1584
    v_pk_mul_f32 v[32:33], v[92:93], v[22:23] op_sel:[0,0] op_sel_hi:[0,1]
    v_pk_fma_f32 v[94:95], v[92:93], v[22:23], v[32:33] op_sel:[1,1,0] op_sel_hi:[1,0,1] neg_lo:[0,1,0]
    v_cvt_pk_bf16_f32 v37, v94, v95
    ds_write_addtid_b32 v37 offset:17952
    v_pk_mul_f32 v[30:31], v[28:29], v[24:25] op_sel:[0,0] op_sel_hi:[0,1]
    v_pk_fma_f32 v[28:29], v[28:29], v[24:25], v[30:31] op_sel:[1,1,0] op_sel_hi:[1,0,1] neg_lo:[0,1,0]
    v_cvt_pk_bf16_f32 v34, v28, v29
    ds_write_addtid_b32 v34 offset:2112
    v_pk_mul_f32 v[32:33], v[94:95], v[22:23] op_sel:[0,0] op_sel_hi:[0,1]
    v_pk_fma_f32 v[96:97], v[94:95], v[22:23], v[32:33] op_sel:[1,1,0] op_sel_hi:[1,0,1] neg_lo:[0,1,0]
    v_cvt_pk_bf16_f32 v35, v96, v97
    ds_write_addtid_b32 v35 offset:18480
    v_pk_mul_f32 v[30:31], v[28:29], v[24:25] op_sel:[0,0] op_sel_hi:[0,1]
    v_pk_fma_f32 v[28:29], v[28:29], v[24:25], v[30:31] op_sel:[1,1,0] op_sel_hi:[1,0,1] neg_lo:[0,1,0]
    v_cvt_pk_bf16_f32 v36, v28, v29
    ds_write_addtid_b32 v36 offset:2640
    v_pk_mul_f32 v[32:33], v[96:97], v[22:23] op_sel:[0,0] op_sel_hi:[0,1]
    v_pk_fma_f32 v[98:99], v[96:97], v[22:23], v[32:33] op_sel:[1,1,0] op_sel_hi:[1,0,1] neg_lo:[0,1,0]
    v_cvt_pk_bf16_f32 v37, v98, v99
    ds_write_addtid_b32 v37 offset:21120
    v_pk_mul_f32 v[30:31], v[28:29], v[24:25] op_sel:[0,0] op_sel_hi:[0,1]
    v_pk_fma_f32 v[28:29], v[28:29], v[24:25], v[30:31] op_sel:[1,1,0] op_sel_hi:[1,0,1] neg_lo:[0,1,0]
    v_cvt_pk_bf16_f32 v34, v28, v29
    ds_write_addtid_b32 v34 offset:3168
    v_pk_mul_f32 v[32:33], v[98:99], v[22:23] op_sel:[0,0] op_sel_hi:[0,1]
    v_pk_fma_f32 v[100:101], v[98:99], v[22:23], v[32:33] op_sel:[1,1,0] op_sel_hi:[1,0,1] neg_lo:[0,1,0]
    v_cvt_pk_bf16_f32 v35, v100, v101
    ds_write_addtid_b32 v35 offset:21648
    v_pk_mul_f32 v[30:31], v[28:29], v[24:25] op_sel:[0,0] op_sel_hi:[0,1]
    v_pk_fma_f32 v[28:29], v[28:29], v[24:25], v[30:31] op_sel:[1,1,0] op_sel_hi:[1,0,1] neg_lo:[0,1,0]
    v_cvt_pk_bf16_f32 v36, v28, v29
    ds_write_addtid_b32 v36 offset:3696
    v_pk_mul_f32 v[32:33], v[100:101], v[22:23] op_sel:[0,0] op_sel_hi:[0,1]
    v_pk_fma_f32 v[102:103], v[100:101], v[22:23], v[32:33] op_sel:[1,1,0] op_sel_hi:[1,0,1] neg_lo:[0,1,0]
    v_cvt_pk_bf16_f32 v37, v102, v103
    ds_write_addtid_b32 v37 offset:22176
    v_pk_mul_f32 v[30:31], v[28:29], v[24:25] op_sel:[0,0] op_sel_hi:[0,1]
    v_pk_fma_f32 v[28:29], v[28:29], v[24:25], v[30:31] op_sel:[1,1,0] op_sel_hi:[1,0,1] neg_lo:[0,1,0]
    v_cvt_pk_bf16_f32 v34, v28, v29
    ds_write_addtid_b32 v34 offset:4224
    v_pk_mul_f32 v[32:33], v[102:103], v[22:23] op_sel:[0,0] op_sel_hi:[0,1]
    v_pk_fma_f32 v[104:105], v[102:103], v[22:23], v[32:33] op_sel:[1,1,0] op_sel_hi:[1,0,1] neg_lo:[0,1,0]
    v_cvt_pk_bf16_f32 v35, v104, v105
    ds_write_addtid_b32 v35 offset:22704
    v_pk_mul_f32 v[30:31], v[28:29], v[24:25] op_sel:[0,0] op_sel_hi:[0,1]
    v_pk_fma_f32 v[28:29], v[28:29], v[24:25], v[30:31] op_sel:[1,1,0] op_sel_hi:[1,0,1] neg_lo:[0,1,0]
    v_cvt_pk_bf16_f32 v36, v28, v29
    ds_write_addtid_b32 v36 offset:4752
    v_pk_mul_f32 v[32:33], v[104:105], v[22:23] op_sel:[0,0] op_sel_hi:[0,1]
    v_pk_fma_f32 v[106:107], v[104:105], v[22:23], v[32:33] op_sel:[1,1,0] op_sel_hi:[1,0,1] neg_lo:[0,1,0]
    v_cvt_pk_bf16_f32 v12, v106, v107
    ds_write_addtid_b32 v12 offset:19008
    v_pk_mul_f32 v[30:31], v[28:29], v[24:25] op_sel:[0,0] op_sel_hi:[0,1]
    v_pk_fma_f32 v[28:29], v[28:29], v[24:25], v[30:31] op_sel:[1,1,0] op_sel_hi:[1,0,1] neg_lo:[0,1,0]
    v_cvt_pk_bf16_f32 v34, v28, v29
    ds_write_addtid_b32 v34 offset:5280
    v_pk_mul_f32 v[32:33], v[106:107], v[22:23] op_sel:[0,0] op_sel_hi:[0,1]
    v_pk_fma_f32 v[108:109], v[106:107], v[22:23], v[32:33] op_sel:[1,1,0] op_sel_hi:[1,0,1] neg_lo:[0,1,0]
    v_cvt_pk_bf16_f32 v13, v108, v109
    ds_write_addtid_b32 v13 offset:19536
    v_pk_mul_f32 v[30:31], v[28:29], v[24:25] op_sel:[0,0] op_sel_hi:[0,1]
    v_pk_fma_f32 v[28:29], v[28:29], v[24:25], v[30:31] op_sel:[1,1,0] op_sel_hi:[1,0,1] neg_lo:[0,1,0]
    v_cvt_pk_bf16_f32 v36, v28, v29
    ds_write_addtid_b32 v36 offset:5808
    v_pk_mul_f32 v[32:33], v[108:109], v[22:23] op_sel:[0,0] op_sel_hi:[0,1]
    v_pk_fma_f32 v[110:111], v[108:109], v[22:23], v[32:33] op_sel:[1,1,0] op_sel_hi:[1,0,1] neg_lo:[0,1,0]
    v_cvt_pk_bf16_f32 v14, v110, v111
    ds_write_addtid_b32 v14 offset:20064
    v_pk_mul_f32 v[30:31], v[28:29], v[24:25] op_sel:[0,0] op_sel_hi:[0,1]
    v_pk_fma_f32 v[28:29], v[28:29], v[24:25], v[30:31] op_sel:[1,1,0] op_sel_hi:[1,0,1] neg_lo:[0,1,0]
    v_cvt_pk_bf16_f32 v34, v28, v29
    ds_write_addtid_b32 v34 offset:6336
    v_pk_mul_f32 v[32:33], v[110:111], v[22:23] op_sel:[0,0] op_sel_hi:[0,1]
    v_pk_fma_f32 v[112:113], v[110:111], v[22:23], v[32:33] op_sel:[1,1,0] op_sel_hi:[1,0,1] neg_lo:[0,1,0]
    v_cvt_pk_bf16_f32 v35, v112, v113
    ds_write_addtid_b32 v35 offset:20592
    v_pk_mul_f32 v[30:31], v[28:29], v[24:25] op_sel:[0,0] op_sel_hi:[0,1]
    v_pk_fma_f32 v[28:29], v[28:29], v[24:25], v[30:31] op_sel:[1,1,0] op_sel_hi:[1,0,1] neg_lo:[0,1,0]
    v_cvt_pk_bf16_f32 v36, v28, v29
    ds_write_addtid_b32 v36 offset:6864
    v_pk_mul_f32 v[32:33], v[112:113], v[22:23] op_sel:[0,0] op_sel_hi:[0,1]
    v_pk_fma_f32 v[114:115], v[112:113], v[22:23], v[32:33] op_sel:[1,1,0] op_sel_hi:[1,0,1] neg_lo:[0,1,0]
    v_cvt_pk_bf16_f32 v37, v114, v115
    ds_write_addtid_b32 v37 offset:23232
    v_pk_mul_f32 v[30:31], v[28:29], v[24:25] op_sel:[0,0] op_sel_hi:[0,1]
    v_pk_fma_f32 v[28:29], v[28:29], v[24:25], v[30:31] op_sel:[1,1,0] op_sel_hi:[1,0,1] neg_lo:[0,1,0]
    v_cvt_pk_bf16_f32 v34, v28, v29
    ds_write_addtid_b32 v34 offset:7392
    v_pk_mul_f32 v[32:33], v[114:115], v[22:23] op_sel:[0,0] op_sel_hi:[0,1]
    v_pk_fma_f32 v[116:117], v[114:115], v[22:23], v[32:33] op_sel:[1,1,0] op_sel_hi:[1,0,1] neg_lo:[0,1,0]
    v_cvt_pk_bf16_f32 v35, v116, v117
    ds_write_addtid_b32 v35 offset:23760
    v_pk_mul_f32 v[30:31], v[28:29], v[24:25] op_sel:[0,0] op_sel_hi:[0,1]
    v_pk_fma_f32 v[28:29], v[28:29], v[24:25], v[30:31] op_sel:[1,1,0] op_sel_hi:[1,0,1] neg_lo:[0,1,0]
    v_cvt_pk_bf16_f32 v36, v28, v29
    ds_write_addtid_b32 v36 offset:7920
    v_pk_mul_f32 v[32:33], v[116:117], v[22:23] op_sel:[0,0] op_sel_hi:[0,1]
    v_pk_fma_f32 v[118:119], v[116:117], v[22:23], v[32:33] op_sel:[1,1,0] op_sel_hi:[1,0,1] neg_lo:[0,1,0]
    v_cvt_pk_bf16_f32 v37, v118, v119
    ds_write_addtid_b32 v37 offset:24288
    v_pk_mul_f32 v[30:31], v[28:29], v[24:25] op_sel:[0,0] op_sel_hi:[0,1]
    v_pk_fma_f32 v[28:29], v[28:29], v[24:25], v[30:31] op_sel:[1,1,0] op_sel_hi:[1,0,1] neg_lo:[0,1,0]
    v_cvt_pk_bf16_f32 v34, v28, v29
    ds_write_addtid_b32 v34 offset:8448
    v_pk_mul_f32 v[32:33], v[118:119], v[22:23] op_sel:[0,0] op_sel_hi:[0,1]
    v_pk_fma_f32 v[120:121], v[118:119], v[22:23], v[32:33] op_sel:[1,1,0] op_sel_hi:[1,0,1] neg_lo:[0,1,0]
    v_cvt_pk_bf16_f32 v35, v120, v121
    ds_write_addtid_b32 v35 offset:24816
    v_pk_mul_f32 v[30:31], v[28:29], v[24:25] op_sel:[0,0] op_sel_hi:[0,1]
    v_pk_fma_f32 v[28:29], v[28:29], v[24:25], v[30:31] op_sel:[1,1,0] op_sel_hi:[1,0,1] neg_lo:[0,1,0]
    v_cvt_pk_bf16_f32 v36, v28, v29
    ds_write_addtid_b32 v36 offset:8976
    v_pk_mul_f32 v[32:33], v[120:121], v[22:23] op_sel:[0,0] op_sel_hi:[0,1]
    v_pk_fma_f32 v[122:123], v[120:121], v[22:23], v[32:33] op_sel:[1,1,0] op_sel_hi:[1,0,1] neg_lo:[0,1,0]
    v_cvt_pk_bf16_f32 v37, v122, v123
    ds_write_addtid_b32 v37 offset:27456
    v_pk_mul_f32 v[30:31], v[28:29], v[24:25] op_sel:[0,0] op_sel_hi:[0,1]
    v_pk_fma_f32 v[28:29], v[28:29], v[24:25], v[30:31] op_sel:[1,1,0] op_sel_hi:[1,0,1] neg_lo:[0,1,0]
    v_cvt_pk_bf16_f32 v34, v28, v29
    ds_write_addtid_b32 v34 offset:9504
    v_pk_mul_f32 v[32:33], v[122:123], v[22:23] op_sel:[0,0] op_sel_hi:[0,1]
    v_pk_fma_f32 v[124:125], v[122:123], v[22:23], v[32:33] op_sel:[1,1,0] op_sel_hi:[1,0,1] neg_lo:[0,1,0]
    v_cvt_pk_bf16_f32 v35, v124, v125
    ds_write_addtid_b32 v35 offset:27984
    v_pk_mul_f32 v[30:31], v[28:29], v[24:25] op_sel:[0,0] op_sel_hi:[0,1]
    v_pk_fma_f32 v[28:29], v[28:29], v[24:25], v[30:31] op_sel:[1,1,0] op_sel_hi:[1,0,1] neg_lo:[0,1,0]
    v_cvt_pk_bf16_f32 v36, v28, v29
    ds_write_addtid_b32 v36 offset:10032
    v_pk_mul_f32 v[32:33], v[124:125], v[22:23] op_sel:[0,0] op_sel_hi:[0,1]
    v_pk_fma_f32 v[126:127], v[124:125], v[22:23], v[32:33] op_sel:[1,1,0] op_sel_hi:[1,0,1] neg_lo:[0,1,0]
    v_cvt_pk_bf16_f32 v37, v126, v127
    ds_write_addtid_b32 v37 offset:28512
    v_pk_mul_f32 v[30:31], v[28:29], v[24:25] op_sel:[0,0] op_sel_hi:[0,1]
    v_pk_fma_f32 v[28:29], v[28:29], v[24:25], v[30:31] op_sel:[1,1,0] op_sel_hi:[1,0,1] neg_lo:[0,1,0]
    v_cvt_pk_bf16_f32 v34, v28, v29
    ds_write_addtid_b32 v34 offset:10560
    v_pk_mul_f32 v[32:33], v[90:91], v[26:27] op_sel:[0,0] op_sel_hi:[0,1]
    v_pk_fma_f32 v[90:91], v[90:91], v[26:27], v[32:33] op_sel:[1,1,0] op_sel_hi:[1,0,1] neg_lo:[0,1,0]
    v_cvt_pk_bf16_f32 v35, v90, v91
    ds_write_addtid_b32 v35 offset:26928
    v_pk_mul_f32 v[30:31], v[28:29], v[24:25] op_sel:[0,0] op_sel_hi:[0,1]
    v_pk_fma_f32 v[28:29], v[28:29], v[24:25], v[30:31] op_sel:[1,1,0] op_sel_hi:[1,0,1] neg_lo:[0,1,0]
    v_cvt_pk_bf16_f32 v36, v28, v29
    ds_write_addtid_b32 v36 offset:11088
    v_pk_mul_f32 v[32:33], v[98:99], v[26:27] op_sel:[0,0] op_sel_hi:[0,1]
    v_pk_fma_f32 v[98:99], v[98:99], v[26:27], v[32:33] op_sel:[1,1,0] op_sel_hi:[1,0,1] neg_lo:[0,1,0]
    v_cvt_pk_bf16_f32 v37, v98, v99
    ds_write_addtid_b32 v37 offset:29568
    v_pk_mul_f32 v[30:31], v[28:29], v[24:25] op_sel:[0,0] op_sel_hi:[0,1]
    v_pk_fma_f32 v[28:29], v[28:29], v[24:25], v[30:31] op_sel:[1,1,0] op_sel_hi:[1,0,1] neg_lo:[0,1,0]
    v_cvt_pk_bf16_f32 v34, v28, v29
    ds_write_addtid_b32 v34 offset:11616
    v_pk_mul_f32 v[32:33], v[106:107], v[26:27] op_sel:[0,0] op_sel_hi:[0,1]
    v_pk_fma_f32 v[106:107], v[106:107], v[26:27], v[32:33] op_sel:[1,1,0] op_sel_hi:[1,0,1] neg_lo:[0,1,0]
    v_cvt_pk_bf16_f32 v15, v106, v107
    ds_write_addtid_b32 v15 offset:29040
    v_pk_mul_f32 v[30:31], v[28:29], v[24:25] op_sel:[0,0] op_sel_hi:[0,1]
    v_pk_fma_f32 v[28:29], v[28:29], v[24:25], v[30:31] op_sel:[1,1,0] op_sel_hi:[1,0,1] neg_lo:[0,1,0]
    v_cvt_pk_bf16_f32 v36, v28, v29
    ds_write_addtid_b32 v36 offset:12144
    v_pk_mul_f32 v[32:33], v[114:115], v[26:27] op_sel:[0,0] op_sel_hi:[0,1]
    v_pk_fma_f32 v[114:115], v[114:115], v[26:27], v[32:33] op_sel:[1,1,0] op_sel_hi:[1,0,1] neg_lo:[0,1,0]
    v_cvt_pk_bf16_f32 v37, v114, v115
    ds_write_addtid_b32 v37 offset:31680
    v_pk_mul_f32 v[30:31], v[28:29], v[24:25] op_sel:[0,0] op_sel_hi:[0,1]
    v_pk_fma_f32 v[28:29], v[28:29], v[24:25], v[30:31] op_sel:[1,1,0] op_sel_hi:[1,0,1] neg_lo:[0,1,0]
    v_cvt_pk_bf16_f32 v34, v28, v29
    ds_write_addtid_b32 v34 offset:12672
    v_pk_mul_f32 v[32:33], v[122:123], v[26:27] op_sel:[0,0] op_sel_hi:[0,1]
    v_pk_fma_f32 v[122:123], v[122:123], v[26:27], v[32:33] op_sel:[1,1,0] op_sel_hi:[1,0,1] neg_lo:[0,1,0]
    v_cvt_pk_bf16_f32 v35, v122, v123
    ds_write_addtid_b32 v35 offset:32208
    v_pk_mul_f32 v[30:31], v[28:29], v[24:25] op_sel:[0,0] op_sel_hi:[0,1]
    v_pk_fma_f32 v[28:29], v[28:29], v[24:25], v[30:31] op_sel:[1,1,0] op_sel_hi:[1,0,1] neg_lo:[0,1,0]
    v_cvt_pk_bf16_f32 v36, v28, v29
    ds_write_addtid_b32 v36 offset:13200
    v_pk_mul_f32 v[32:33], v[106:107], v[26:27] op_sel:[0,0] op_sel_hi:[0,1]
    v_pk_fma_f32 v[106:107], v[106:107], v[26:27], v[32:33] op_sel:[1,1,0] op_sel_hi:[1,0,1] neg_lo:[0,1,0]
    v_cvt_pk_bf16_f32 v37, v106, v107
    ds_write_addtid_b32 v37 offset:30624
    v_pk_mul_f32 v[30:31], v[28:29], v[24:25] op_sel:[0,0] op_sel_hi:[0,1]
    v_pk_fma_f32 v[28:29], v[28:29], v[24:25], v[30:31] op_sel:[1,1,0] op_sel_hi:[1,0,1] neg_lo:[0,1,0]
    v_cvt_pk_bf16_f32 v34, v28, v29
    ds_write_addtid_b32 v34 offset:13728
    v_pk_mul_f32 v[32:33], v[122:123], v[26:27] op_sel:[0,0] op_sel_hi:[0,1]
    v_pk_fma_f32 v[122:123], v[122:123], v[26:27], v[32:33] op_sel:[1,1,0] op_sel_hi:[1,0,1] neg_lo:[0,1,0]
    v_cvt_pk_bf16_f32 v35, v122, v123
    ds_write_addtid_b32 v35 offset:31152
    v_pk_mul_f32 v[30:31], v[28:29], v[24:25] op_sel:[0,0] op_sel_hi:[0,1]
    v_pk_fma_f32 v[28:29], v[28:29], v[24:25], v[30:31] op_sel:[1,1,0] op_sel_hi:[1,0,1] neg_lo:[0,1,0]
    v_cvt_pk_bf16_f32 v36, v28, v29
    ds_write_addtid_b32 v36 offset:14256
    v_pk_mul_f32 v[32:33], v[106:107], v[26:27] op_sel:[0,0] op_sel_hi:[0,1]
    v_pk_fma_f32 v[106:107], v[106:107], v[26:27], v[32:33] op_sel:[1,1,0] op_sel_hi:[1,0,1] neg_lo:[0,1,0]
    v_cvt_pk_bf16_f32 v37, v106, v107
    ds_write_addtid_b32 v37 offset:32736
    v_pk_mul_f32 v[30:31], v[28:29], v[24:25] op_sel:[0,0] op_sel_hi:[0,1]
    v_pk_fma_f32 v[28:29], v[28:29], v[24:25], v[30:31] op_sel:[1,1,0] op_sel_hi:[1,0,1] neg_lo:[0,1,0]
    v_cvt_pk_bf16_f32 v34, v28, v29
    ds_write_addtid_b32 v34 offset:14784
    v_pk_mul_f32 v[32:33], v[122:123], v[26:27] op_sel:[0,0] op_sel_hi:[0,1]
    v_pk_fma_f32 v[122:123], v[122:123], v[26:27], v[32:33] op_sel:[1,1,0] op_sel_hi:[1,0,1] neg_lo:[0,1,0]
    v_cvt_pk_bf16_f32 v35, v122, v123
    ds_write_addtid_b32 v35 offset:33264
    v_pk_mul_f32 v[30:31], v[28:29], v[24:25] op_sel:[0,0] op_sel_hi:[0,1]
    v_pk_fma_f32 v[28:29], v[28:29], v[24:25], v[30:31] op_sel:[1,1,0] op_sel_hi:[1,0,1] neg_lo:[0,1,0]
    v_cvt_pk_bf16_f32 v36, v28, v29
    ds_write_addtid_b32 v36 offset:15312
    v_pk_mul_f32 v[30:31], v[28:29], v[24:25] op_sel:[0,0] op_sel_hi:[0,1]
    v_pk_fma_f32 v[28:29], v[28:29], v[24:25], v[30:31] op_sel:[1,1,0] op_sel_hi:[1,0,1] neg_lo:[0,1,0]
    v_cvt_pk_bf16_f32 v34, v28, v29
    ds_write_addtid_b32 v34 offset:15840
    v_pk_mul_f32 v[30:31], v[28:29], v[24:25] op_sel:[0,0] op_sel_hi:[0,1]
    v_pk_fma_f32 v[28:29], v[28:29], v[24:25], v[30:31] op_sel:[1,1,0] op_sel_hi:[1,0,1] neg_lo:[0,1,0]
    v_cvt_pk_bf16_f32 v36, v28, v29
    ds_write_addtid_b32 v36 offset:16368
    ds_write_addtid_b32 v12 offset:25344
    ds_write_addtid_b32 v13 offset:25872
    ds_write_addtid_b32 v14 offset:26400
    ds_write_addtid_b32 v15 offset:30096
    s_cmp_eq_u32 s52, 0
    s_cbranch_scc0 L_helper
    s_setprio 2
    s_waitcnt lgkmcnt(0)
    s_barrier
    ds_read_b128 v[128:131], v78 offset:16896
    ds_read_b128 v[132:135], v78 offset:0
    ds_read_b128 v[136:139], v78 offset:16912
    ds_read_b128 v[140:143], v78 offset:16
    ds_read_b128 v[144:147], v78 offset:16928
    ds_read_b128 v[148:151], v78 offset:32
    ds_read_b128 v[152:155], v78 offset:16944
    ds_read_b128 v[156:159], v78 offset:48
    ds_read_b128 v[160:163], v78 offset:16960
    ds_read_b128 v[164:167], v78 offset:64
    ds_read_b128 v[168:171], v78 offset:16976
    ds_read_b128 v[172:175], v78 offset:80
    v_add_u32 v74, -1, v2
    s_waitcnt vmcnt(0)
    v_and_b32 v71, v71, v74
    v_mul_f32 v71, 0x44800000, v71
    v_and_b32 v10, 3, v8
    v_add_u32 v5, 1, v10
    s_waitcnt lgkmcnt(10)
    v_mfma_f32_32x32x16_bf16 v[48:63], v[128:131], v[132:135], 0
    ds_read_b128 v[176:179], v78 offset:16992
    ds_read_b128 v[180:183], v78 offset:96
    v_mul_u32_u24 v10, 2238, v10
    s_waitcnt lgkmcnt(10)
    v_mfma_f32_32x32x16_bf16 v[48:63], v[136:139], v[140:143], v[48:63]
    ds_read_b128 v[184:187], v78 offset:17008
    ds_read_b128 v[188:191], v78 offset:112
    v_lshl_add_u32 v11, v8, 1, v9
    s_waitcnt lgkmcnt(10)
    v_mfma_f32_32x32x16_bf16 v[48:63], v[144:147], v[148:151], v[48:63]
    ds_read_b128 v[192:195], v78 offset:17024
    ds_read_b128 v[196:199], v78 offset:128
    v_mul_u32_u24 v4, 17, v9
    s_waitcnt lgkmcnt(10)
    v_mfma_f32_32x32x16_bf16 v[48:63], v[152:155], v[156:159], v[48:63]
    ds_read_b128 v[200:203], v78 offset:17040
    ds_read_b128 v[204:207], v78 offset:144
    v_sub_u32 v4, v4, v11
    s_waitcnt lgkmcnt(10)
    v_mfma_f32_32x32x16_bf16 v[48:63], v[160:163], v[164:167], v[48:63]
    ds_read_b128 v[208:211], v78 offset:17056
    ds_read_b128 v[212:215], v78 offset:160
    v_and_b32 v5, 4, v5
    s_waitcnt lgkmcnt(10)
    v_mfma_f32_32x32x16_bf16 v[48:63], v[168:171], v[172:175], v[48:63]
    ds_read_b128 v[216:219], v78 offset:17072
    ds_read_b128 v[220:223], v78 offset:176
    s_add_u32 s43, s55, 6752
    s_waitcnt lgkmcnt(10)
    v_mfma_f32_32x32x16_bf16 v[48:63], v[176:179], v[180:183], v[48:63]
    ds_read_b128 v[224:227], v78 offset:17088
    ds_read_b128 v[228:231], v78 offset:192
    v_lshl_add_u32 v10, v5, 1, v10
    s_waitcnt lgkmcnt(10)
    v_mfma_f32_32x32x16_bf16 v[48:63], v[184:187], v[188:191], v[48:63]
    ds_read_b128 v[232:235], v78 offset:17104
    ds_read_b128 v[236:239], v78 offset:208
    v_sub_u32 v10, v4, v10
    s_waitcnt lgkmcnt(10)
    v_mfma_f32_32x32x16_bf16 v[48:63], v[192:195], v[196:199], v[48:63]
    ds_read_b128 v[240:243], v78 offset:17120
    ds_read_b128 v[244:247], v78 offset:224
    v_add_u32 v10, s43, v10
    s_waitcnt lgkmcnt(10)
    v_mfma_f32_32x32x16_bf16 v[48:63], v[200:203], v[204:207], v[48:63]
    ds_read_b128 v[248:251], v78 offset:17136
    ds_read_b128 v[252:255], v78 offset:240
    v_lshl_add_u32 v11, v11, 4, s63
    s_waitcnt lgkmcnt(10)
    v_mfma_f32_32x32x16_bf16 v[48:63], v[208:211], v[212:215], v[48:63]
    s_add_u32 s43, s55, 9212
    v_lshrrev_b32 v75, 2, v3
    v_sub_u32 v75, s43, v75
    v_lshlrev_b32 v7, 5, v8
    s_waitcnt lgkmcnt(8)
    v_mfma_f32_32x32x16_bf16 v[48:63], v[216:219], v[220:223], v[48:63]
    v_lshl_add_u32 v7, v9, 3, v7
    v_add_u32 v7, s55, v7
    v_lshlrev_b32 v4, 2, v9
    v_sub_u32 v4, v4, v8
    s_waitcnt lgkmcnt(6)
    v_mfma_f32_32x32x16_bf16 v[48:63], v[224:227], v[228:231], v[48:63]
    s_add_u32 s43, s55, 9020
    v_lshl_add_u32 v4, v4, 2, s43
    s_lshl_b32 s43, s51, 2
    s_add_u32 s43, s43, 153728
    s_waitcnt lgkmcnt(4)
    v_mfma_f32_32x32x16_bf16 v[48:63], v[232:235], v[236:239], v[48:63]
    v_mov_b32 v88, s43
    v_lshlrev_b32 v5, 3, v9
    v_mov_b32 v6, 4064
    v_lshlrev_b32 v6, v8, v6
    s_waitcnt lgkmcnt(2)
    v_mfma_f32_32x32x16_bf16 v[48:63], v[240:243], v[244:247], v[48:63]
    v_bfe_u32 v6, v6, v5, 8
    v_lshl_or_b32 v6, v6, 15, v6
    v_and_b32 v40, 65537, v6
    v_mul_u32_u24 v40, 16256, v40
    s_waitcnt lgkmcnt(0)
    v_mfma_f32_32x32x16_bf16 v[48:63], v[248:251], v[252:255], v[48:63]
    v_and_b32 v41, 262148, v6
    v_mul_u32_u24 v41, 4064, v41
    v_and_b32 v42, 1048592, v6
    v_mul_u32_u24 v42, 1016, v42
    ds_write_b128 v83, v[84:87]
    v_and_b32 v43, 4194368, v6
    v_mul_u32_u24 v43, 254, v43
    v_mov_b32 v6, 8176
    v_lshlrev_b32 v6, v8, v6
    v_bfe_u32 v6, v6, v5, 8
    v_lshl_or_b32 v6, v6, 15, v6
    v_and_b32 v44, 65537, v6
    v_mul_u32_u24 v44, 16256, v44
    v_and_b32 v45, 262148, v6
    v_mul_u32_u24 v45, 4064, v45
    v_and_b32 v46, 1048592, v6
    v_mul_u32_u24 v46, 1016, v46
    v_and_b32 v47, 4194368, v6
    v_mul_u32_u24 v47, 254, v47
    v_add_f32 v48, v48, v71
    v_bitop3_b32 v49, v79, v48, v49 bitop3:0xca
    v_bitop3_b32 v51, v79, v52, v51 bitop3:0xca
    v_bitop3_b32 v53, v79, v52, v53 bitop3:0xca
    v_bitop3_b32 v55, v79, v56, v55 bitop3:0xca
    v_cvt_pk_bf16_f32 v128, v55, v54
    v_cvt_pk_bf16_f32 v129, v53, v52
    v_cvt_pk_bf16_f32 v130, v51, v50
    v_cvt_pk_bf16_f32 v131, v49, v48
    ds_write_b128 v81, v[128:131] offset:1024
    v_bitop3_b32 v57, v80, v56, v57 bitop3:0xca
    v_bitop3_b32 v58, v82, v56, v58 bitop3:0xca
    v_cvt_pk_bf16_f32 v132, v56, v55
    v_cvt_pk_bf16_f32 v133, v54, v53
    v_cvt_pk_bf16_f32 v134, v52, v51
    v_cvt_pk_bf16_f32 v135, v50, v49
    ds_write_b128 v81, v[132:135] offset:7744
    v_readlane_b32 s42, v130, 0
    v_readlane_b32 s43, v131, 0
    v_cvt_pk_bf16_f32 v136, v57, v56
    v_cvt_pk_bf16_f32 v137, v55, v54
    v_cvt_pk_bf16_f32 v138, v53, v52
    v_cvt_pk_bf16_f32 v139, v51, v50
    ds_write_b128 v81, v[136:139] offset:5504
    v_cvt_pk_bf16_f32 v144, v61, v61
    v_cvt_pk_bf16_f32 v140, v58, v57
    v_cvt_pk_bf16_f32 v141, v56, v55
    v_cvt_pk_bf16_f32 v142, v54, v53
    v_cvt_pk_bf16_f32 v143, v52, v51
    ds_write_b128 v81, v[140:143] offset:3264
    v_readlane_b32 s58, v144, 63
    v_cvt_pk_bf16_f32 v74, v63, v62
    s_pack_lh_b32_b16 s42, s58, s42
    v_mov_b32 v71, s42
    v_perm_b32 v71, v71, s43, v72
    ds_write_b16 v73, v71
    v_cvt_pk_bf16_f32 v145, v60, v60
    v_cvt_pk_bf16_f32 v146, v60, v59
    v_cvt_pk_bf16_f32 v147, v59, v59
    ds_write_b128 v81, v[144:147] offset:0
    v_cvt_pk_bf16_f32 v148, v61, v61
    v_cvt_pk_bf16_f32 v149, v61, v60
    v_cvt_pk_bf16_f32 v150, v60, v60
    v_cvt_pk_bf16_f32 v151, v59, v59
    ds_write_b128 v81, v[148:151] offset:6720
    v_cvt_pk_bf16_f32 v152, v61, v61
    v_cvt_pk_bf16_f32 v153, v61, v61
    v_cvt_pk_bf16_f32 v154, v60, v60
    v_cvt_pk_bf16_f32 v155, v60, v59
    ds_write_b128 v81, v[152:155] offset:4480
    v_cvt_pk_bf16_f32 v156, v61, v61
    v_cvt_pk_bf16_f32 v157, v61, v61
    v_cvt_pk_bf16_f32 v158, v61, v60
    v_cvt_pk_bf16_f32 v159, v60, v60
    ds_write_b128 v81, v[156:159] offset:2240
    ds_write_b32 v75, v74
    s_cmp_lt_u32 s39, 2
    s_cbranch_scc0 L_ct3
    global_load_dword v1, v76, s[56:57]
L_ct3:
    ds_read_b64 v[128:129], v10 offset:2048
    ds_read_b64 v[130:131], v10 offset:2056
    ds_read_b64 v[160:161], v10 offset:1536
    ds_read_b64 v[162:163], v10 offset:1544
    ds_read_b64 v[132:133], v10 offset:1984
    ds_read_b64 v[134:135], v10 offset:1992
    ds_read_b64 v[164:165], v10 offset:1472
    ds_read_b64 v[166:167], v10 offset:1480
    ds_read_b64 v[136:137], v10 offset:1920
    ds_read_b64 v[138:139], v10 offset:1928
    ds_read_b64 v[168:169], v10 offset:1408
    ds_read_b64 v[170:171], v10 offset:1416
    ds_read_b64 v[140:141], v10 offset:1856
    ds_read_b64 v[142:143], v10 offset:1864
    ds_read_b64 v[172:173], v10 offset:1344
    ds_read_b64 v[174:175], v10 offset:1352
    s_waitcnt lgkmcnt(6)
    s_barrier
    s_setprio 1
    ds_read_b128 v[48:51], v11 offset:448
    ds_read_b128 v[52:55], v11 offset:960
    ds_read_b128 v[12:15], v11 offset:384
    ds_read_b128 v[56:59], v11 offset:896
    ds_read_b128 v[60:63], v11 offset:320
    ds_read_b128 v[16:19], v11 offset:832
    ds_read_b128 v[20:23], v11 offset:256
    ds_read_b128 v[24:27], v11 offset:768
    ds_read_b64 v[144:145], v10 offset:1792
    s_waitcnt lgkmcnt(8)
    v_mfma_f32_16x16x32_bf16 v[80:83], v[128:131], v[48:51], 0
    ds_read_b64 v[146:147], v10 offset:1800
    v_mfma_f32_16x16x32_bf16 v[84:87], v[160:163], v[48:51], 0
    ds_read_b128 v[28:31], v11 offset:192
    s_waitcnt lgkmcnt(7)
    v_mfma_f32_16x16x32_bf16 v[84:87], v[128:131], v[52:55], v[84:87]
    ds_read_b64 v[176:177], v10 offset:1280
    v_mfma_f32_16x16x32_bf16 v[80:83], v[132:135], v[12:15], v[80:83]
    ds_read_b64 v[178:179], v10 offset:1288
    v_mfma_f32_16x16x32_bf16 v[84:87], v[164:167], v[12:15], v[84:87]
    ds_read_b128 v[92:95], v11 offset:704
    v_mfma_f32_16x16x32_bf16 v[84:87], v[132:135], v[56:59], v[84:87]
    ds_read_b64 v[148:149], v10 offset:1728
    ds_read_b64 v[150:151], v10 offset:1736
    s_waitcnt lgkmcnt(9)
    v_mfma_f32_16x16x32_bf16 v[80:83], v[136:139], v[60:63], v[80:83]
    ds_read_b128 v[96:99], v11 offset:128
    ds_read_b64 v[180:181], v10 offset:1216
    v_mfma_f32_16x16x32_bf16 v[84:87], v[168:171], v[60:63], v[84:87]
    ds_read_b64 v[182:183], v10 offset:1224
    ds_read_b128 v[100:103], v11 offset:640
    v_mfma_f32_16x16x32_bf16 v[84:87], v[136:139], v[16:19], v[84:87]
    ds_read_b64 v[152:153], v10 offset:1664
    ds_read_b64 v[154:155], v10 offset:1672
    v_mfma_f32_16x16x32_bf16 v[80:83], v[140:143], v[20:23], v[80:83]
    v_mfma_f32_16x16x32_bf16 v[84:87], v[172:175], v[20:23], v[84:87]
    s_waitcnt lgkmcnt(8)
    v_mfma_f32_16x16x32_bf16 v[84:87], v[140:143], v[24:27], v[84:87]
    ds_read_b128 v[104:107], v11 offset:64
    ds_read_b64 v[184:185], v10 offset:1152
    v_mfma_f32_16x16x32_bf16 v[80:83], v[144:147], v[28:31], v[80:83]
    ds_read_b64 v[186:187], v10 offset:1160
    ds_read_b128 v[64:67], v11 offset:576
    v_mfma_f32_16x16x32_bf16 v[84:87], v[176:179], v[28:31], v[84:87]
    ds_read_b64 v[156:157], v10 offset:1600
    ds_read_b64 v[158:159], v10 offset:1608
    v_mfma_f32_16x16x32_bf16 v[84:87], v[144:147], v[92:95], v[84:87]
    ds_read_b128 v[68:71], v11 offset:0
    s_waitcnt lgkmcnt(6)
    v_mfma_f32_16x16x32_bf16 v[80:83], v[148:151], v[96:99], v[80:83]
    ds_read_b64 v[188:189], v10 offset:1088
    ds_read_b64 v[190:191], v10 offset:1096
    v_mfma_f32_16x16x32_bf16 v[84:87], v[180:183], v[96:99], v[84:87]
    ds_read_b128 v[72:75], v11 offset:512
    ds_read_b64 v[192:193], v10 offset:1024
    v_mfma_f32_16x16x32_bf16 v[84:87], v[148:151], v[100:103], v[84:87]
    ds_read_b64 v[194:195], v10 offset:1032
    ds_read_b64 v[224:225], v10 offset:512
    v_mfma_f32_16x16x32_bf16 v[80:83], v[152:155], v[104:107], v[80:83]
    ds_read_b64 v[226:227], v10 offset:520
    s_waitcnt lgkmcnt(5)
    v_mfma_f32_16x16x32_bf16 v[84:87], v[184:187], v[104:107], v[84:87]
    ds_read_b128 v[76:79], v11 offset:1472
    v_mfma_f32_16x16x32_bf16 v[84:87], v[152:155], v[64:67], v[84:87]
    ds_read_b128 v[108:111], v11 offset:1984
    v_mfma_f32_16x16x32_bf16 v[80:83], v[156:159], v[68:71], v[80:83]
    ds_read_b64 v[196:197], v10 offset:960
    v_mfma_f32_16x16x32_bf16 v[84:87], v[188:191], v[68:71], v[84:87]
    ds_read_b64 v[198:199], v10 offset:968
    s_waitcnt lgkmcnt(4)
    v_mfma_f32_16x16x32_bf16 v[84:87], v[156:159], v[72:75], v[84:87]
    ds_read_b64 v[228:229], v10 offset:448
    v_mfma_f32_16x16x32_bf16 v[32:35], v[192:195], v[48:51], 0
    ds_read_b64 v[230:231], v10 offset:456
    v_mfma_f32_16x16x32_bf16 v[36:39], v[224:227], v[48:51], 0
    ds_read_b128 v[112:115], v11 offset:1408
    v_mfma_f32_16x16x32_bf16 v[32:35], v[160:163], v[52:55], v[32:35]
    ds_read_b128 v[116:119], v11 offset:1920
    v_cvt_pk_bf16_f32 v80, v80, v81
    v_mfma_f32_16x16x32_bf16 v[36:39], v[192:195], v[52:55], v[36:39]
    ds_read_b64 v[200:201], v10 offset:896
    s_waitcnt lgkmcnt(7)
    v_cvt_pk_bf16_f32 v81, v82, v83
    v_mfma_f32_16x16x32_bf16 v[32:35], v[128:131], v[76:79], v[32:35]
    ds_read_b64 v[202:203], v10 offset:904
    ds_write_b64 v7, v[80:81] offset:9472
    v_mfma_f32_16x16x32_bf16 v[36:39], v[160:163], v[76:79], v[36:39]
    ds_read_b64 v[232:233], v10 offset:384
    v_cvt_pk_bf16_f32 v84, v84, v85
    v_mfma_f32_16x16x32_bf16 v[36:39], v[128:131], v[108:111], v[36:39]
    ds_read_b64 v[234:235], v10 offset:392
    s_waitcnt lgkmcnt(7)
    v_cvt_pk_bf16_f32 v85, v86, v87
    v_mfma_f32_16x16x32_bf16 v[32:35], v[196:199], v[12:15], v[32:35]
    ds_read_b128 v[120:123], v11 offset:1344
    ds_write_b64 v7, v[84:85] offset:9984
    v_mfma_f32_16x16x32_bf16 v[36:39], v[228:231], v[12:15], v[36:39]
    ds_read_b128 v[124:127], v11 offset:1856
    ds_write_b32 v88, v88 offset:0
    v_mfma_f32_16x16x32_bf16 v[32:35], v[164:167], v[56:59], v[32:35]
    ds_read_b64 v[204:205], v10 offset:832
    v_mfma_f32_16x16x32_bf16 v[36:39], v[196:199], v[56:59], v[36:39]
    ds_read_b64 v[206:207], v10 offset:840
    s_waitcnt lgkmcnt(9)
    v_mfma_f32_16x16x32_bf16 v[32:35], v[132:135], v[112:115], v[32:35]
    ds_read_b64 v[236:237], v10 offset:320
    v_mfma_f32_16x16x32_bf16 v[36:39], v[164:167], v[112:115], v[36:39]
    ds_read_b64 v[238:239], v10 offset:328
    v_mfma_f32_16x16x32_bf16 v[36:39], v[132:135], v[116:119], v[36:39]
    ds_read_b128 v[76:79], v11 offset:1280
    v_mfma_f32_16x16x32_bf16 v[32:35], v[200:203], v[60:63], v[32:35]
    ds_read_b128 v[108:111], v11 offset:1792
    s_waitcnt lgkmcnt(9)
    v_mfma_f32_16x16x32_bf16 v[36:39], v[232:235], v[60:63], v[36:39]
    ds_read_b64 v[208:209], v10 offset:768
    v_mfma_f32_16x16x32_bf16 v[32:35], v[168:171], v[16:19], v[32:35]
    ds_read_b64 v[210:211], v10 offset:776
    v_mfma_f32_16x16x32_bf16 v[36:39], v[200:203], v[16:19], v[36:39]
    ds_read_b64 v[240:241], v10 offset:256
    v_mfma_f32_16x16x32_bf16 v[32:35], v[136:139], v[120:123], v[32:35]
    ds_read_b64 v[242:243], v10 offset:264
    v_mfma_f32_16x16x32_bf16 v[36:39], v[168:171], v[120:123], v[36:39]
    ds_read_b128 v[112:115], v11 offset:1216
    s_waitcnt lgkmcnt(7)
    v_mfma_f32_16x16x32_bf16 v[36:39], v[136:139], v[124:127], v[36:39]
    ds_read_b128 v[116:119], v11 offset:1728
    v_mfma_f32_16x16x32_bf16 v[32:35], v[204:207], v[20:23], v[32:35]
    ds_read_b64 v[212:213], v10 offset:704
    v_mfma_f32_16x16x32_bf16 v[36:39], v[236:239], v[20:23], v[36:39]
    ds_read_b64 v[214:215], v10 offset:712
    v_mfma_f32_16x16x32_bf16 v[32:35], v[172:175], v[24:27], v[32:35]
    ds_read_b64 v[244:245], v10 offset:192
    v_mfma_f32_16x16x32_bf16 v[36:39], v[204:207], v[24:27], v[36:39]
    ds_read_b64 v[246:247], v10 offset:200
    s_waitcnt lgkmcnt(8)
    v_mfma_f32_16x16x32_bf16 v[32:35], v[140:143], v[76:79], v[32:35]
    ds_read_b128 v[120:123], v11 offset:1152
    v_mfma_f32_16x16x32_bf16 v[36:39], v[172:175], v[76:79], v[36:39]
    ds_read_b128 v[124:127], v11 offset:1664
    v_mfma_f32_16x16x32_bf16 v[36:39], v[140:143], v[108:111], v[36:39]
    ds_read_b64 v[216:217], v10 offset:640
    v_mfma_f32_16x16x32_bf16 v[32:35], v[208:211], v[28:31], v[32:35]
    ds_read_b64 v[218:219], v10 offset:648
    s_waitcnt lgkmcnt(9)
    v_mfma_f32_16x16x32_bf16 v[36:39], v[240:243], v[28:31], v[36:39]
    ds_read_b64 v[248:249], v10 offset:128
    v_mfma_f32_16x16x32_bf16 v[32:35], v[176:179], v[92:95], v[32:35]
    ds_read_b64 v[250:251], v10 offset:136
    v_mfma_f32_16x16x32_bf16 v[36:39], v[208:211], v[92:95], v[36:39]
    ds_read_b128 v[76:79], v11 offset:1088
    v_mfma_f32_16x16x32_bf16 v[32:35], v[144:147], v[112:115], v[32:35]
    v_mfma_f32_16x16x32_bf16 v[36:39], v[176:179], v[112:115], v[36:39]
    ds_read_b128 v[108:111], v11 offset:1600
    s_waitcnt lgkmcnt(8)
    v_mfma_f32_16x16x32_bf16 v[36:39], v[144:147], v[116:119], v[36:39]
    ds_read_b64 v[220:221], v10 offset:576
    v_mfma_f32_16x16x32_bf16 v[32:35], v[212:215], v[96:99], v[32:35]
    ds_read_b64 v[222:223], v10 offset:584
    v_mfma_f32_16x16x32_bf16 v[36:39], v[244:247], v[96:99], v[36:39]
    ds_read_b64 v[252:253], v10 offset:64
    v_mfma_f32_16x16x32_bf16 v[32:35], v[180:183], v[100:103], v[32:35]
    ds_read_b64 v[254:255], v10 offset:72
    v_mfma_f32_16x16x32_bf16 v[36:39], v[212:215], v[100:103], v[36:39]
    ds_read_b128 v[112:115], v11 offset:1024
    s_waitcnt lgkmcnt(9)
    v_mfma_f32_16x16x32_bf16 v[32:35], v[148:151], v[120:123], v[32:35]
    v_mfma_f32_16x16x32_bf16 v[36:39], v[180:183], v[120:123], v[36:39]
    ds_read_b128 v[116:119], v11 offset:1536
    v_mfma_f32_16x16x32_bf16 v[36:39], v[148:151], v[124:127], v[36:39]
    ds_read_b128 v[120:123], v11 offset:960
    v_mfma_f32_16x16x32_bf16 v[32:35], v[216:219], v[104:107], v[32:35]
    ds_read_b128 v[124:127], v11 offset:1472
    s_waitcnt lgkmcnt(9)
    v_mfma_f32_16x16x32_bf16 v[36:39], v[248:251], v[104:107], v[36:39]
    v_mfma_f32_16x16x32_bf16 v[32:35], v[184:187], v[64:67], v[32:35]
    v_mfma_f32_16x16x32_bf16 v[36:39], v[216:219], v[64:67], v[36:39]
    ds_read_b128 v[64:67], v11 offset:1984
    v_mfma_f32_16x16x32_bf16 v[32:35], v[152:155], v[76:79], v[32:35]
    v_mfma_f32_16x16x32_bf16 v[36:39], v[184:187], v[76:79], v[36:39]
    s_waitcnt lgkmcnt(5)
    v_mfma_f32_16x16x32_bf16 v[36:39], v[152:155], v[108:111], v[36:39]
    ds_read_b128 v[76:79], v11 offset:2496
    v_mfma_f32_16x16x32_bf16 v[32:35], v[220:223], v[68:71], v[32:35]
    v_mfma_f32_16x16x32_bf16 v[36:39], v[252:255], v[68:71], v[36:39]
    ds_read_b128 v[108:111], v11 offset:3008
    v_mfma_f32_16x16x32_bf16 v[32:35], v[188:191], v[72:75], v[32:35]
    v_mfma_f32_16x16x32_bf16 v[36:39], v[220:223], v[72:75], v[36:39]
    ds_read_b128 v[68:71], v11 offset:896
    s_waitcnt lgkmcnt(5)
    v_mfma_f32_16x16x32_bf16 v[32:35], v[156:159], v[112:115], v[32:35]
    ds_read_b128 v[72:75], v11 offset:1408
    v_mfma_f32_16x16x32_bf16 v[36:39], v[188:191], v[112:115], v[36:39]
    v_mfma_f32_16x16x32_bf16 v[36:39], v[156:159], v[116:119], v[36:39]
    ds_read_b128 v[112:115], v11 offset:1920
    v_mfma_f32_16x16x32_bf16 v[48:51], v[224:227], v[120:123], 0
    s_waitcnt lgkmcnt(5)
    v_mfma_f32_16x16x32_bf16 v[48:51], v[192:195], v[124:127], v[48:51]
    ds_read_b128 v[116:119], v11 offset:2432
    v_mfma_f32_16x16x32_bf16 v[52:55], v[224:227], v[124:127], 0
    ds_read_b128 v[120:123], v11 offset:2944
    v_cvt_pk_bf16_f32 v32, v32, v33
    v_mfma_f32_16x16x32_bf16 v[48:51], v[160:163], v[64:67], v[48:51]
    ds_read_b128 v[124:127], v11 offset:448
    v_cvt_pk_bf16_f32 v33, v34, v35
    v_mfma_f32_16x16x32_bf16 v[52:55], v[192:195], v[64:67], v[52:55]
    ds_read_b64 v[12:13], v10 offset:0
    s_waitcnt lgkmcnt(7)
    ds_write_b64 v7, v[32:33] offset:10496
    v_mfma_f32_16x16x32_bf16 v[48:51], v[128:131], v[76:79], v[48:51]
    ds_read_b64 v[14:15], v10 offset:8
    v_cvt_pk_bf16_f32 v36, v36, v37
    v_mfma_f32_16x16x32_bf16 v[52:55], v[160:163], v[76:79], v[52:55]
    ds_read_b128 v[64:67], v11 offset:432
    v_cvt_pk_bf16_f32 v37, v38, v39
    v_mfma_f32_16x16x32_bf16 v[52:55], v[128:131], v[108:111], v[52:55]
    ds_read_b128 v[76:79], v11 offset:960
    s_waitcnt lgkmcnt(8)
    ds_write_b64 v7, v[36:37] offset:11008
    v_mfma_f32_16x16x32_bf16 v[48:51], v[228:231], v[68:71], v[48:51]
    ds_read_b128 v[108:111], v11 offset:944
    ds_write_b32 v88, v88 offset:16
    v_mfma_f32_16x16x32_bf16 v[48:51], v[196:199], v[72:75], v[48:51]
    ds_read_b128 v[68:71], v11 offset:832
    v_mfma_f32_16x16x32_bf16 v[52:55], v[228:231], v[72:75], v[52:55]
    ds_read_b128 v[72:75], v11 offset:1344
    v_mfma_f32_16x16x32_bf16 v[48:51], v[164:167], v[112:115], v[48:51]
    v_mfma_f32_16x16x32_bf16 v[52:55], v[196:199], v[112:115], v[52:55]
    ds_read_b128 v[112:115], v11 offset:1856
    s_waitcnt lgkmcnt(11)
    v_mfma_f32_16x16x32_bf16 v[48:51], v[132:135], v[116:119], v[48:51]
    v_mfma_f32_16x16x32_bf16 v[52:55], v[164:167], v[116:119], v[52:55]
    ds_read_b128 v[116:119], v11 offset:2368
    v_mfma_f32_16x16x32_bf16 v[52:55], v[132:135], v[120:123], v[52:55]
    ds_read_b128 v[120:123], v11 offset:2880
    v_mfma_f32_16x16x32_bf16 v[80:83], v[124:127], v[40:43], 0
    s_waitcnt lgkmcnt(8)
    v_mfma_f32_16x16x32_bf16 v[48:51], v[12:15], v[124:127], v[48:51]
    ds_read_b128 v[124:127], v11 offset:768
    v_mfma_f32_16x16x32_bf16 v[84:87], v[64:67], v[44:47], 0
    ds_read_b128 v[64:67], v11 offset:1280
    v_mfma_f32_16x16x32_bf16 v[32:35], v[76:79], v[40:43], 0
    v_mfma_f32_16x16x32_bf16 v[52:55], v[12:15], v[76:79], v[52:55]
    ds_read_b128 v[76:79], v11 offset:1792
    s_waitcnt lgkmcnt(6)
    v_mfma_f32_16x16x32_bf16 v[36:39], v[108:111], v[44:47], 0
    ds_read_b128 v[108:111], v11 offset:2304
    v_mfma_f32_16x16x32_bf16 v[48:51], v[232:235], v[68:71], v[48:51]
    v_mfma_f32_16x16x32_bf16 v[48:51], v[200:203], v[72:75], v[48:51]
    ds_read_b128 v[68:71], v11 offset:2816
    v_mfma_f32_16x16x32_bf16 v[52:55], v[232:235], v[72:75], v[52:55]
    s_waitcnt lgkmcnt(6)
    v_mfma_f32_16x16x32_bf16 v[48:51], v[168:171], v[112:115], v[48:51]
    ds_read_b128 v[72:75], v11 offset:704
    v_mfma_f32_16x16x32_bf16 v[52:55], v[200:203], v[112:115], v[52:55]
    ds_read_b128 v[112:115], v11 offset:1216
    v_mfma_f32_16x16x32_bf16 v[48:51], v[136:139], v[116:119], v[48:51]
    v_mfma_f32_16x16x32_bf16 v[52:55], v[168:171], v[116:119], v[52:55]
    ds_read_b128 v[116:119], v11 offset:1728
    s_waitcnt lgkmcnt(6)
    v_mfma_f32_16x16x32_bf16 v[52:55], v[136:139], v[120:123], v[52:55]
    ds_read_b128 v[120:123], v11 offset:2240
    v_cvt_pk_bf16_f32 v92, v84, v80
    v_mfma_f32_16x16x32_bf16 v[48:51], v[236:239], v[124:127], v[48:51]
    v_cvt_pk_bf16_f32 v93, v85, v81
    v_cvt_pk_bf16_f32 v94, v86, v82
    v_mfma_f32_16x16x32_bf16 v[48:51], v[204:207], v[64:67], v[48:51]
    ds_read_b128 v[124:127], v11 offset:2752
    v_cvt_pk_bf16_f32 v95, v87, v83
    v_mfma_f32_16x16x32_bf16 v[52:55], v[236:239], v[64:67], v[52:55]
    ds_read2_b32 v[16:17], v4 offset0:48 offset1:49
    s_waitcnt lgkmcnt(7)
    v_mfma_f32_16x16x32_bf16 v[48:51], v[172:175], v[76:79], v[48:51]
    ds_read2_b32 v[18:19], v4 offset0:50 offset1:51
    v_mfma_f32_16x16x32_bf16 v[52:55], v[204:207], v[76:79], v[52:55]
    ds_read2_b32 v[20:21], v4 offset0:32 offset1:33
    v_mfma_f32_16x16x32_bf16 v[48:51], v[140:143], v[108:111], v[48:51]
    ds_read2_b32 v[22:23], v4 offset0:34 offset1:35
    v_mfma_f32_16x16x32_bf16 v[52:55], v[172:175], v[108:111], v[52:55]
    ds_read_b128 v[64:67], v11 offset:640
    s_waitcnt lgkmcnt(8)
    v_mfma_f32_16x16x32_bf16 v[52:55], v[140:143], v[68:71], v[52:55]
    ds_read_b128 v[76:79], v11 offset:1152
    v_cvt_pk_bf16_f32 v96, v36, v32
    v_mfma_f32_16x16x32_bf16 v[48:51], v[240:243], v[72:75], v[48:51]
    ds_read_b128 v[108:111], v11 offset:1664
    v_cvt_pk_bf16_f32 v97, v37, v33
    v_mfma_f32_16x16x32_bf16 v[48:51], v[208:211], v[112:115], v[48:51]
    ds_read_b128 v[68:71], v11 offset:2176
    v_cvt_pk_bf16_f32 v98, v38, v34
    v_mfma_f32_16x16x32_bf16 v[52:55], v[240:243], v[112:115], v[52:55]
    s_waitcnt lgkmcnt(9)
    v_cvt_pk_bf16_f32 v99, v39, v35
    v_mfma_f32_16x16x32_bf16 v[48:51], v[176:179], v[116:119], v[48:51]
    ds_read_b128 v[72:75], v11 offset:2688
    v_mfma_f32_16x16x32_bf16 v[52:55], v[208:211], v[116:119], v[52:55]
    ds_read_b128 v[112:115], v11 offset:576
    v_mfma_f32_16x16x32_bf16 v[48:51], v[144:147], v[120:123], v[48:51]
    ds_read_b128 v[116:119], v11 offset:1088
    v_mfma_f32_16x16x32_bf16 v[52:55], v[176:179], v[120:123], v[52:55]
    s_waitcnt lgkmcnt(7)
    v_mfma_f32_16x16x32_bf16 v[52:55], v[144:147], v[124:127], v[52:55]
    ds_read_b128 v[120:123], v11 offset:1600
    v_mfma_f32_16x16x32_bf16 v[48:51], v[92:95], v[16:19], v[48:51]
    v_mfma_f32_16x16x32_bf16 v[52:55], v[96:99], v[16:19], v[52:55]
    ds_read_b128 v[124:127], v11 offset:2112
    v_mfma_f32_16x16x32_bf16 v[52:55], v[92:95], v[20:23], v[52:55]
    s_waitcnt lgkmcnt(6)
    v_mfma_f32_16x16x32_bf16 v[48:51], v[244:247], v[64:67], v[48:51]
    ds_read_b128 v[64:67], v11 offset:2624
    v_mfma_f32_16x16x32_bf16 v[48:51], v[212:215], v[76:79], v[48:51]
    v_mfma_f32_16x16x32_bf16 v[52:55], v[244:247], v[76:79], v[52:55]
    ds_read_b128 v[76:79], v11 offset:512
    v_mfma_f32_16x16x32_bf16 v[48:51], v[180:183], v[108:111], v[48:51]
    v_mfma_f32_16x16x32_bf16 v[52:55], v[212:215], v[108:111], v[52:55]
    ds_read_b128 v[108:111], v11 offset:1024
    s_waitcnt lgkmcnt(6)
    v_mfma_f32_16x16x32_bf16 v[48:51], v[148:151], v[68:71], v[48:51]
    v_mfma_f32_16x16x32_bf16 v[52:55], v[180:183], v[68:71], v[52:55]
    ds_read_b128 v[68:71], v11 offset:1536
    v_mfma_f32_16x16x32_bf16 v[52:55], v[148:151], v[72:75], v[52:55]
    ds_read_b128 v[72:75], v11 offset:2048
    v_mfma_f32_16x16x32_bf16 v[48:51], v[248:251], v[112:115], v[48:51]
    ds_read_b128 v[112:115], v11 offset:2560
    s_waitcnt lgkmcnt(7)
    v_mfma_f32_16x16x32_bf16 v[48:51], v[216:219], v[116:119], v[48:51]
    v_mfma_f32_16x16x32_bf16 v[52:55], v[248:251], v[116:119], v[52:55]
    ds_read_b128 v[116:119], v11 offset:1984
    v_mfma_f32_16x16x32_bf16 v[48:51], v[184:187], v[120:123], v[48:51]
    v_mfma_f32_16x16x32_bf16 v[52:55], v[216:219], v[120:123], v[52:55]
    ds_read_b128 v[120:123], v11 offset:2496
    s_waitcnt lgkmcnt(6)
    v_mfma_f32_16x16x32_bf16 v[48:51], v[152:155], v[124:127], v[48:51]
    v_mfma_f32_16x16x32_bf16 v[52:55], v[184:187], v[124:127], v[52:55]
    ds_read_b128 v[124:127], v11 offset:3008
    v_mfma_f32_16x16x32_bf16 v[52:55], v[152:155], v[64:67], v[52:55]
    v_mfma_f32_16x16x32_bf16 v[48:51], v[252:255], v[76:79], v[48:51]
    ds_read_b128 v[64:67], v11 offset:3520
    s_waitcnt lgkmcnt(6)
    v_mfma_f32_16x16x32_bf16 v[48:51], v[220:223], v[108:111], v[48:51]
    v_mfma_f32_16x16x32_bf16 v[52:55], v[252:255], v[108:111], v[52:55]
    ds_read_b128 v[76:79], v11 offset:4032
    v_mfma_f32_16x16x32_bf16 v[48:51], v[188:191], v[68:71], v[48:51]
    v_mfma_f32_16x16x32_bf16 v[52:55], v[220:223], v[68:71], v[52:55]
    ds_read_b128 v[108:111], v11 offset:1472
    s_waitcnt lgkmcnt(5)
    v_mfma_f32_16x16x32_bf16 v[48:51], v[156:159], v[72:75], v[48:51]
    v_mfma_f32_16x16x32_bf16 v[52:55], v[188:191], v[72:75], v[52:55]
    ds_read_b128 v[68:71], v11 offset:1456
    v_mfma_f32_16x16x32_bf16 v[52:55], v[156:159], v[112:115], v[52:55]
    ds_read_b128 v[72:75], v11 offset:1984
    v_mfma_f32_16x16x32_bf16 v[56:59], v[224:227], v[116:119], 0
    s_waitcnt lgkmcnt(5)
    v_mfma_f32_16x16x32_bf16 v[56:59], v[192:195], v[120:123], v[56:59]
    ds_read_b128 v[112:115], v11 offset:1968
    v_mfma_f32_16x16x32_bf16 v[60:63], v[224:227], v[120:123], 0
    ds_read_b128 v[116:119], v11 offset:1920
    v_cvt_pk_bf16_f32 v48, v48, v49
    v_mfma_f32_16x16x32_bf16 v[56:59], v[160:163], v[124:127], v[56:59]
    ds_read_b128 v[120:123], v11 offset:2432
    v_cvt_pk_bf16_f32 v49, v50, v51
    v_mfma_f32_16x16x32_bf16 v[60:63], v[192:195], v[124:127], v[60:63]
    ds_read_b128 v[124:127], v11 offset:2944
    s_waitcnt lgkmcnt(7)
    ds_write_b64 v7, v[48:49] offset:11520
    v_mfma_f32_16x16x32_bf16 v[56:59], v[128:131], v[64:67], v[56:59]
    v_cvt_pk_bf16_f32 v52, v52, v53
    v_cvt_pk_bf16_f32 v53, v54, v55
    v_mfma_f32_16x16x32_bf16 v[60:63], v[160:163], v[64:67], v[60:63]
    ds_read_b128 v[64:67], v11 offset:3456
    ds_write_b64 v7, v[52:53] offset:12032
    v_mfma_f32_16x16x32_bf16 v[60:63], v[128:131], v[76:79], v[60:63]
    ds_write_b32 v88, v88 offset:32
    ds_read_b128 v[76:79], v11 offset:3968
    s_waitcnt lgkmcnt(9)
    v_mfma_f32_16x16x32_bf16 v[80:83], v[108:111], v[40:43], 0
    v_mfma_f32_16x16x32_bf16 v[56:59], v[12:15], v[108:111], v[56:59]
    ds_read2_b32 v[24:25], v4 offset0:16 offset1:17
    v_mfma_f32_16x16x32_bf16 v[84:87], v[68:71], v[44:47], 0
    ds_read2_b32 v[26:27], v4 offset0:18 offset1:19
    v_mfma_f32_16x16x32_bf16 v[32:35], v[72:75], v[40:43], 0
    ds_read_b128 v[108:111], v11 offset:1856
    v_mfma_f32_16x16x32_bf16 v[60:63], v[12:15], v[72:75], v[60:63]
    ds_read_b128 v[68:71], v11 offset:2368
    s_waitcnt lgkmcnt(10)
    v_mfma_f32_16x16x32_bf16 v[36:39], v[112:115], v[44:47], 0
    ds_read_b128 v[72:75], v11 offset:2880
    v_mfma_f32_16x16x32_bf16 v[56:59], v[228:231], v[116:119], v[56:59]
    v_mfma_f32_16x16x32_bf16 v[56:59], v[196:199], v[120:123], v[56:59]
    ds_read_b128 v[112:115], v11 offset:3392
    v_mfma_f32_16x16x32_bf16 v[60:63], v[228:231], v[120:123], v[60:63]
    s_waitcnt lgkmcnt(9)
    v_mfma_f32_16x16x32_bf16 v[56:59], v[164:167], v[124:127], v[56:59]
    ds_read_b128 v[116:119], v11 offset:3904
    v_mfma_f32_16x16x32_bf16 v[60:63], v[196:199], v[124:127], v[60:63]
    v_mfma_f32_16x16x32_bf16 v[56:59], v[132:135], v[64:67], v[56:59]
    v_mfma_f32_16x16x32_bf16 v[60:63], v[164:167], v[64:67], v[60:63]
    ds_read2_b32 v[28:29], v4 offset0:0 offset1:1
    s_waitcnt lgkmcnt(6)
    v_mfma_f32_16x16x32_bf16 v[60:63], v[132:135], v[76:79], v[60:63]
    ds_read2_b32 v[30:31], v4 offset0:2 offset1:3
    v_cvt_pk_bf16_f32 v100, v84, v80
    v_mfma_f32_16x16x32_bf16 v[56:59], v[96:99], v[20:23], v[56:59]
    ds_read_b128 v[120:123], v11 offset:1792
    v_cvt_pk_bf16_f32 v101, v85, v81
    v_mfma_f32_16x16x32_bf16 v[60:63], v[96:99], v[24:27], v[60:63]
    ds_read_b128 v[124:127], v11 offset:2304
    s_waitcnt lgkmcnt(6)
    v_cvt_pk_bf16_f32 v102, v86, v82
    v_mfma_f32_16x16x32_bf16 v[56:59], v[232:235], v[108:111], v[56:59]
    ds_read_b128 v[64:67], v11 offset:2816
    v_cvt_pk_bf16_f32 v103, v87, v83
    v_mfma_f32_16x16x32_bf16 v[56:59], v[200:203], v[68:71], v[56:59]
    ds_read_b128 v[76:79], v11 offset:3328
    v_mfma_f32_16x16x32_bf16 v[60:63], v[232:235], v[68:71], v[60:63]
    v_mfma_f32_16x16x32_bf16 v[56:59], v[168:171], v[72:75], v[56:59]
    ds_read_b128 v[108:111], v11 offset:3840
    v_mfma_f32_16x16x32_bf16 v[60:63], v[200:203], v[72:75], v[60:63]
    s_waitcnt lgkmcnt(7)
    v_mfma_f32_16x16x32_bf16 v[56:59], v[136:139], v[112:115], v[56:59]
    v_mfma_f32_16x16x32_bf16 v[60:63], v[168:171], v[112:115], v[60:63]
    v_mfma_f32_16x16x32_bf16 v[60:63], v[136:139], v[116:119], v[60:63]
    ds_read_b128 v[68:71], v11 offset:1728
    v_cvt_pk_bf16_f32 v104, v36, v32
    v_mfma_f32_16x16x32_bf16 v[56:59], v[92:95], v[24:27], v[56:59]
    ds_read_b128 v[72:75], v11 offset:2240
    s_waitcnt lgkmcnt(5)
    v_cvt_pk_bf16_f32 v105, v37, v33
    v_mfma_f32_16x16x32_bf16 v[60:63], v[92:95], v[28:31], v[60:63]
    ds_read_b128 v[112:115], v11 offset:2752
    v_cvt_pk_bf16_f32 v106, v38, v34
    v_mfma_f32_16x16x32_bf16 v[56:59], v[236:239], v[120:123], v[56:59]
    v_cvt_pk_bf16_f32 v107, v39, v35
    v_mfma_f32_16x16x32_bf16 v[56:59], v[204:207], v[124:127], v[56:59]
    ds_read_b128 v[116:119], v11 offset:3264
    v_mfma_f32_16x16x32_bf16 v[60:63], v[236:239], v[124:127], v[60:63]
    s_waitcnt lgkmcnt(5)
    v_mfma_f32_16x16x32_bf16 v[56:59], v[172:175], v[64:67], v[56:59]
    ds_read_b128 v[120:123], v11 offset:3776
    v_mfma_f32_16x16x32_bf16 v[60:63], v[204:207], v[64:67], v[60:63]
    ds_read_b128 v[124:127], v11 offset:1664
    v_mfma_f32_16x16x32_bf16 v[56:59], v[140:143], v[76:79], v[56:59]
    ds_read_b128 v[64:67], v11 offset:2176
    v_mfma_f32_16x16x32_bf16 v[60:63], v[172:175], v[76:79], v[60:63]
    s_waitcnt lgkmcnt(7)
    v_mfma_f32_16x16x32_bf16 v[60:63], v[140:143], v[108:111], v[60:63]
    ds_read_b128 v[76:79], v11 offset:2688
    v_mfma_f32_16x16x32_bf16 v[56:59], v[100:103], v[16:19], v[56:59]
    v_mfma_f32_16x16x32_bf16 v[60:63], v[104:107], v[16:19], v[60:63]
    ds_read_b128 v[108:111], v11 offset:3200
    v_mfma_f32_16x16x32_bf16 v[60:63], v[100:103], v[20:23], v[60:63]
    s_waitcnt lgkmcnt(6)
    v_mfma_f32_16x16x32_bf16 v[56:59], v[240:243], v[68:71], v[56:59]
    ds_read_b128 v[68:71], v11 offset:3712
    v_mfma_f32_16x16x32_bf16 v[56:59], v[208:211], v[72:75], v[56:59]
    v_mfma_f32_16x16x32_bf16 v[60:63], v[240:243], v[72:75], v[60:63]
    ds_read_b128 v[72:75], v11 offset:1600
    v_mfma_f32_16x16x32_bf16 v[56:59], v[176:179], v[112:115], v[56:59]
    v_mfma_f32_16x16x32_bf16 v[60:63], v[208:211], v[112:115], v[60:63]
    ds_read_b128 v[112:115], v11 offset:2112
    s_waitcnt lgkmcnt(6)
    v_mfma_f32_16x16x32_bf16 v[56:59], v[144:147], v[116:119], v[56:59]
    v_mfma_f32_16x16x32_bf16 v[60:63], v[176:179], v[116:119], v[60:63]
    ds_read_b128 v[116:119], v11 offset:2624
    v_mfma_f32_16x16x32_bf16 v[60:63], v[144:147], v[120:123], v[60:63]
    ds_read_b128 v[120:123], v11 offset:3136
    v_mfma_f32_16x16x32_bf16 v[56:59], v[244:247], v[124:127], v[56:59]
    ds_read_b128 v[124:127], v11 offset:3648
    s_waitcnt lgkmcnt(7)
    v_mfma_f32_16x16x32_bf16 v[56:59], v[212:215], v[64:67], v[56:59]
    v_mfma_f32_16x16x32_bf16 v[60:63], v[244:247], v[64:67], v[60:63]
    ds_read_b128 v[64:67], v11 offset:1536
    v_mfma_f32_16x16x32_bf16 v[56:59], v[180:183], v[76:79], v[56:59]
    v_mfma_f32_16x16x32_bf16 v[60:63], v[212:215], v[76:79], v[60:63]
    ds_read_b128 v[76:79], v11 offset:2048
    s_waitcnt lgkmcnt(6)
    v_mfma_f32_16x16x32_bf16 v[56:59], v[148:151], v[108:111], v[56:59]
    v_mfma_f32_16x16x32_bf16 v[60:63], v[180:183], v[108:111], v[60:63]
    ds_read_b128 v[108:111], v11 offset:2560
    v_mfma_f32_16x16x32_bf16 v[60:63], v[148:151], v[68:71], v[60:63]
    ds_read_b128 v[68:71], v11 offset:3072
    v_mfma_f32_16x16x32_bf16 v[56:59], v[248:251], v[72:75], v[56:59]
    ds_read_b128 v[72:75], v11 offset:3584
    s_waitcnt lgkmcnt(7)
    v_mfma_f32_16x16x32_bf16 v[56:59], v[216:219], v[112:115], v[56:59]
    v_mfma_f32_16x16x32_bf16 v[60:63], v[248:251], v[112:115], v[60:63]
    v_mfma_f32_16x16x32_bf16 v[56:59], v[184:187], v[116:119], v[56:59]
    v_mfma_f32_16x16x32_bf16 v[60:63], v[216:219], v[116:119], v[60:63]
    s_waitcnt lgkmcnt(4)
    v_mfma_f32_16x16x32_bf16 v[56:59], v[152:155], v[120:123], v[56:59]
    v_mfma_f32_16x16x32_bf16 v[60:63], v[184:187], v[120:123], v[60:63]
    v_mfma_f32_16x16x32_bf16 v[60:63], v[152:155], v[124:127], v[60:63]
    v_mfma_f32_16x16x32_bf16 v[56:59], v[252:255], v[64:67], v[56:59]
    s_waitcnt lgkmcnt(2)
    v_mfma_f32_16x16x32_bf16 v[56:59], v[220:223], v[76:79], v[56:59]
    v_mfma_f32_16x16x32_bf16 v[60:63], v[252:255], v[76:79], v[60:63]
    v_mfma_f32_16x16x32_bf16 v[56:59], v[188:191], v[108:111], v[56:59]
    v_mfma_f32_16x16x32_bf16 v[60:63], v[220:223], v[108:111], v[60:63]
    s_waitcnt lgkmcnt(0)
    v_mfma_f32_16x16x32_bf16 v[56:59], v[156:159], v[68:71], v[56:59]
    v_mfma_f32_16x16x32_bf16 v[60:63], v[188:191], v[68:71], v[60:63]
    v_mfma_f32_16x16x32_bf16 v[60:63], v[156:159], v[72:75], v[60:63]
    s_nop 5
    v_cvt_pk_bf16_f32 v56, v56, v57
    v_cvt_pk_bf16_f32 v57, v58, v59
    ds_write_b64 v7, v[56:57] offset:12544
    v_cvt_pk_bf16_f32 v60, v60, v61
    v_cvt_pk_bf16_f32 v61, v62, v63
    ds_write_b64 v7, v[60:61] offset:13056
    ds_write_b32 v88, v88 offset:48
    s_cmp_lg_u32 s39, 0
    s_cbranch_scc1 L_mw_end
    s_mul_i32 s42, s50, 9344
    s_add_u32 s42, s42, 69632
    v_add_u32 v18, s42, v3
    v_add_u32 v20, 4096, v18
    v_and_b32 v21, 0x70, v3
    s_add_u32 s42, s42, 5120
    v_add_u32 v21, s42, v21
    s_movk_i32 s61, 4096
    v_lshl_add_u32 v24, v9, 1, s54
    v_mov_b32 v35, s45
    s_barrier
L_part_poll:
    global_load_dwordx4 v[164:167], v21, s[36:37] sc1
    global_load_dwordx4 v[128:131], v18, s[36:37] offset:-4096 sc1
    global_load_dwordx4 v[132:135], v18, s[36:37] offset:-3072 sc1
    global_load_dwordx4 v[136:139], v18, s[36:37] offset:-2048 sc1
    global_load_dwordx4 v[140:143], v18, s[36:37] offset:-1024 sc1
    global_load_dwordx4 v[144:147], v18, s[36:37] offset:0 sc1
    global_load_dwordx4 v[148:151], v18, s[36:37] offset:1024 sc1
    global_load_dwordx4 v[152:155], v18, s[36:37] offset:2048 sc1
    global_load_dwordx4 v[156:159], v18, s[36:37] offset:3072 sc1
    global_load_dwordx4 v[160:163], v20, s[36:37] offset:0 sc1
    v_mul_u32_u24 v26, 4640, v9
    v_add_u32 v26, 135648, v26
    v_mul_u32_u24 v27, 33792, v9
    s_waitcnt vmcnt(9)
    v_bfe_u32 v28, v164, 8, 11
    v_lshl_add_u32 v29, v28, 1, v26
    v_lshl_add_u32 v30, v28, 1, v27
    ds_read_b128 v[36:39], v88 offset:48
    ds_read_u16_d16_hi v31, v29
    ds_read_u16_d16_hi v32, v30 offset:9472
    v_mul_u32_u24 v28, 1152, v28
    v_add_u32 v28, v28, v24
    v_xor_b32 v22, v35, v164
    s_waitcnt vmcnt(8)
    v_xor_b32 v128, v35, v128
    v_or_b32 v22, v22, v128
    s_waitcnt vmcnt(7)
    v_xor_b32 v132, v35, v132
    v_pk_add_f32 v[130:131], v[130:131], v[134:135]
    v_pk_add_f32 v[128:129], v[128:129], v[132:133]
    s_waitcnt vmcnt(6)
    v_xor_b32 v136, v35, v136
    v_pk_add_f32 v[130:131], v[130:131], v[138:139]
    v_pk_add_f32 v[128:129], v[128:129], v[136:137]
    v_bitop3_b32 v22, v22, v132, v136 bitop3:0xfe
    s_waitcnt vmcnt(5)
    v_xor_b32 v140, v35, v140
    v_pk_add_f32 v[130:131], v[130:131], v[142:143]
    v_pk_add_f32 v[128:129], v[128:129], v[140:141]
    s_waitcnt vmcnt(4)
    v_xor_b32 v144, v35, v144
    v_pk_add_f32 v[130:131], v[130:131], v[146:147]
    v_pk_add_f32 v[128:129], v[128:129], v[144:145]
    v_bitop3_b32 v22, v22, v140, v144 bitop3:0xfe
    s_waitcnt vmcnt(3)
    v_xor_b32 v148, v35, v148
    v_pk_add_f32 v[130:131], v[130:131], v[150:151]
    v_pk_add_f32 v[128:129], v[128:129], v[148:149]
    s_waitcnt vmcnt(2)
    v_xor_b32 v152, v35, v152
    v_pk_add_f32 v[130:131], v[130:131], v[154:155]
    v_pk_add_f32 v[128:129], v[128:129], v[152:153]
    v_bitop3_b32 v22, v22, v148, v152 bitop3:0xfe
    s_waitcnt vmcnt(1)
    v_xor_b32 v156, v35, v156
    v_pk_add_f32 v[130:131], v[130:131], v[158:159]
    v_pk_add_f32 v[128:129], v[128:129], v[156:157]
    s_waitcnt vmcnt(0)
    v_xor_b32 v160, v35, v160
    v_pk_add_f32 v[130:131], v[130:131], v[162:163]
    v_pk_add_f32 v[128:129], v[128:129], v[160:161]
    v_bitop3_b32 v22, v22, v156, v160 bitop3:0xfe
    s_waitcnt lgkmcnt(0)
    v_bitop3_b32 v36, v37, v38, v39 bitop3:0x7f
    v_and_b32 v36, 128, v36
    v_or_b32 v22, v22, v36
    v_and_b32 v22, 0xff, v22
    v_cmp_ne_u32 vcc, 0, v22
    v_permlane32_swap_b32 v128, v130
    s_sub_u32 s61, s61, 1
    s_cselect_b64 vcc, 0, vcc
    s_cbranch_vccnz L_part_poll
    v_permlane32_swap_b32 v129, v131
    v_add_f32 v128, v128, v130
    v_add_f32 v129, v129, v131
    v_and_b32 v31, 0xffff0000, v31
    v_and_b32 v32, 0xffff0000, v32
    v_permlane16_swap_b32 v128, v129
    v_add_f32 v128, v128, v129
    v_mul_f32 v31, 0x42000000, v31
    v_mul_f32 v32, 0x3d000000, v32
    v_add_f32_dpp v128, v128, v128 row_ror:8 row_mask:0xf bank_mask:0xf
    v_fma_f32 v128, v128, v165, v31
    v_mul_f32 v33, 0xbfb8aa3b, v128
    v_exp_f32 v33, v33
    v_fma_f32 v34, v31, v167, v166
    v_add_f32 v33, 1.0, v33
    v_rcp_f32 v33, v33
    v_mul_f32 v128, v128, v32
    v_fmac_f32 v34, v128, v33
    v_cvt_pk_bf16_f32 v34, v34, v34
    global_store_short v28, v34, s[32:33]
L_mw_end:
    s_endpgm
L_helper:
    s_waitcnt lgkmcnt(0)
    s_barrier
    s_setprio 0
    s_lshr_b32 s42, s50, 1
    s_lshl_b32 s42, s42, 15
    s_and_b32 s43, s50, 1
    s_lshl_b32 s43, s43, 6
    s_add_u32 s42, s42, s43
    s_add_u32 s42, s42, 2097152
    s_add_u32 s12, s36, s42
    s_addc_u32 s13, s37, 0
    s_add_u32 s14, s12, 8192
    s_addc_u32 s15, s13, 0
    s_add_u32 s16, s12, 16384
    s_addc_u32 s17, s13, 0
    s_add_u32 s18, s12, 24576
    s_addc_u32 s19, s13, 0
    v_bfe_u32 v63, v0, 2, 6
    v_and_b32 v6, 0x30, v3
    v_lshl_add_u32 v6, v63, 7, v6
    global_load_dwordx4 v[40:43], v6, s[12:13] sc1
    global_load_dwordx4 v[44:47], v6, s[14:15] sc1
    global_load_dwordx4 v[48:51], v6, s[16:17] sc1
    global_load_dwordx4 v[52:55], v6, s[18:19] sc1
    v_and_b32 v62, 255, v0
    v_lshlrev_b32 v4, 4, v62
    v_add_u32 v4, 20480, v4
    v_add_u32 v7, 8192, v4
    v_mov_b32 v38, v63
    s_mul_i32 s42, s51, 1152
    s_lshl_b32 s43, s41, 6
    s_add_u32 s42, s42, s43
    s_add_u32 s42, s42, 2880
    s_mov_b32 s58, 2
    s_mul_i32 s43, s40, 1152
    s_add_u32 s43, s43, 884736
    s_mul_i32 s59, s40, 663552
    s_cmp_eq_u32 s58, 0
    s_cselect_b32 s56, s26, s28
    s_cselect_b32 s57, s27, s29
    s_cmp_eq_u32 s58, 2
    s_cselect_b32 s56, s30, s56
    s_cselect_b32 s57, s31, s57
    s_cselect_b32 s43, s59, s43
    s_movk_i32 s58, 128
    s_movk_i32 s59, 8064
    s_movk_i32 s60, 4319
    s_cmov_b32 s58, 73728
    s_cmov_b32 s59, -663424
    s_cmovk_i32 s60, 5183
    v_add_u32 v76, s42, v2
    v_min_u32 v76, s60, v76
    v_mul_u32_u24 v63, 7282, v76
    v_lshrrev_b32 v63, 16, v63
    v_mul_u32_u24 v76, s58, v76
    v_mad_i32_i24 v76, v63, s59, v76
    v_add_u32 v76, s43, v76
    v_mov_b32 v63, v38
    s_bfe_u32 s43, s46, 131072
    s_mul_i32 s43, s43, 0x20004000
    s_and_b32 s43, s43, 0x40004000
    v_mov_b32 v56, s43
    s_bfe_u32 s43, s46, 131074
    s_mul_i32 s43, s43, 0x20004000
    s_and_b32 s43, s43, 0x40004000
    v_mov_b32 v57, s43
    s_bfe_u32 s43, s46, 131076
    s_mul_i32 s43, s43, 0x20004000
    s_and_b32 s43, s43, 0x40004000
    v_mov_b32 v58, s43
    s_bfe_u32 s43, s46, 131078
    s_mul_i32 s43, s43, 0x20004000
    s_and_b32 s43, s43, 0x40004000
    v_mov_b32 v59, s43
    v_and_b32 v88, 3, v0
    v_mul_u32_u24 v5, 4640, v88
    v_lshl_add_u32 v5, v63, 4, v5
    v_add_u32 v5, 135648, v5
    v_mov_b32 v63, 0x40004000
    v_lshlrev_b32 v88, 2, v88
    v_add_u32 v88, 153728, v88
    s_movk_i32 s61, 4096
    v_lshlrev_b32 v37, 2, v62
    v_add_u32 v64, 135648, v37
    v_add_u32 v65, 140288, v37
    v_add_u32 v66, 144928, v37
    v_add_u32 v67, 149568, v37
    v_add_u32 v37, 9472, v37
    v_add_u32 v39, 67584, v37
    v_mul_u32_u24 v36, 2304, v62
    v_add_u32 v36, s54, v36
    v_mov_b32 v8, 0xc238aa3b
    v_mov_b32 v9, 0xffff0000
    v_mov_b32 v10, 0x42000000
    v_lshlrev_b32 v62, 6, v62
    v_xor_b32 v62, s44, v62
    s_waitcnt vmcnt(0)
    s_setprio 3
L_tile_chk:
    v_xor_b32 v40, v56, v40
    v_xor_b32 v41, v57, v41
    v_xor_b32 v42, v58, v42
    v_xor_b32 v43, v59, v43
    ds_write_b128 v5, v[40:43] offset:0
    v_xor_b32 v44, v56, v44
    v_xor_b32 v45, v57, v45
    v_xor_b32 v46, v58, v46
    v_xor_b32 v47, v59, v47
    ds_write_b128 v5, v[44:47] offset:1024
    v_xor_b32 v48, v56, v48
    v_xor_b32 v49, v57, v49
    v_xor_b32 v50, v58, v50
    v_xor_b32 v51, v59, v51
    ds_write_b128 v5, v[48:51] offset:2048
    v_xor_b32 v52, v56, v52
    v_xor_b32 v53, v57, v53
    v_xor_b32 v54, v58, v54
    v_xor_b32 v55, v59, v55
    ds_write_b128 v5, v[52:55] offset:3072
    v_bitop3_b32 v38, v40, v41, v42 bitop3:0xfe
    v_bitop3_b32 v38, v38, v43, v44 bitop3:0xfe
    v_bitop3_b32 v38, v38, v45, v46 bitop3:0xfe
    v_bitop3_b32 v38, v38, v47, v48 bitop3:0xfe
    v_bitop3_b32 v38, v38, v49, v50 bitop3:0xfe
    v_bitop3_b32 v38, v38, v51, v52 bitop3:0xfe
    v_bitop3_b32 v38, v38, v53, v54 bitop3:0xfe
    v_bitop3_b32 v38, v38, v55, v63 bitop3:0xa8
    v_cmp_ne_u32 vcc, 0, v38
    s_cbranch_vccz L_tile_ok
    global_load_dwordx4 v[40:43], v6, s[12:13] sc1
    global_load_dwordx4 v[44:47], v6, s[14:15] sc1
    global_load_dwordx4 v[48:51], v6, s[16:17] sc1
    global_load_dwordx4 v[52:55], v6, s[18:19] sc1
    s_waitcnt vmcnt(0)
    s_sub_u32 s61, s61, 1
    s_cbranch_scc0 L_tile_chk
L_tile_ok:
    global_load_dwordx4 v[224:227], v4, s[36:37] offset:-4096 sc1
    global_load_dwordx4 v[228:231], v4, s[36:37] offset:0 sc1
    global_load_dwordx4 v[232:235], v7, s[36:37] offset:-4096 sc1
    global_load_dwordx4 v[236:239], v7, s[36:37] offset:0 sc1
    s_waitcnt lgkmcnt(0)
    s_barrier
    ds_read2st64_b32 v[16:17], v64 offset0:0 offset1:4
    ds_read2st64_b32 v[18:19], v65 offset0:0 offset1:4
    ds_read2st64_b32 v[20:21], v66 offset0:0 offset1:4
    ds_read2st64_b32 v[22:23], v67 offset0:0 offset1:4
    ds_read2st64_b32 v[24:25], v64 offset0:8 offset1:12
    ds_read2st64_b32 v[26:27], v65 offset0:8 offset1:12
    ds_read2st64_b32 v[28:29], v66 offset0:8 offset1:12
    ds_read2st64_b32 v[30:31], v67 offset0:8 offset1:12
    s_setprio 0
    s_mov_b32 s61, 262144
    s_cmp_eq_u32 s47, 2
    s_cbranch_scc0 L_ct2
    global_load_dword v1, v76, s[56:57]
    s_waitcnt vmcnt(1)
    s_branch L_h_poll
L_ct2:
    s_waitcnt vmcnt(0)
L_h_poll:
    v_mov_b32 v41, 0
    v_xor_b32 v42, 65504, v225
    v_bitop3_b32 v41, v41, v42, v62 bitop3:0xf6
    v_xor_b32 v42, 65472, v227
    v_bitop3_b32 v41, v41, v42, v62 bitop3:0xf6
    v_xor_b32 v42, 49120, v229
    v_bitop3_b32 v41, v41, v42, v62 bitop3:0xf6
    v_xor_b32 v42, 49088, v231
    v_bitop3_b32 v41, v41, v42, v62 bitop3:0xf6
    v_xor_b32 v42, 32736, v233
    v_bitop3_b32 v41, v41, v42, v62 bitop3:0xf6
    v_xor_b32 v42, 32704, v235
    v_bitop3_b32 v41, v41, v42, v62 bitop3:0xf6
    v_xor_b32 v42, 16352, v237
    v_bitop3_b32 v41, v41, v42, v62 bitop3:0xf6
    v_xor_b32 v42, 16320, v239
    v_bitop3_b32 v41, v41, v42, v62 bitop3:0xf6
    v_and_b32 v41, 0xffff, v41
    v_cmp_ne_u32 vcc, 0, v41
    s_cbranch_vccz L_h_ok
    global_load_dwordx4 v[224:227], v4, s[36:37] offset:-4096 sc1
    global_load_dwordx4 v[228:231], v4, s[36:37] offset:0 sc1
    global_load_dwordx4 v[232:235], v7, s[36:37] offset:-4096 sc1
    global_load_dwordx4 v[236:239], v7, s[36:37] offset:0 sc1
    s_waitcnt vmcnt(0)
    s_sub_u32 s61, s61, 64
    s_cbranch_scc0 L_h_poll
L_h_ok:
    s_waitcnt lgkmcnt(0)
    v_lshlrev_b32 v96, 16, v16
    v_lshlrev_b32 v97, 16, v18
    v_lshlrev_b32 v98, 16, v20
    v_lshlrev_b32 v99, 16, v22
    v_mul_f32 v104, v8, v96
    v_mul_f32 v105, v8, v97
    v_mul_f32 v106, v8, v98
    v_mul_f32 v107, v8, v99
    v_exp_f32 v104, v104
    v_exp_f32 v105, v105
    v_exp_f32 v106, v106
    v_exp_f32 v107, v107
    v_and_b32 v121, v9, v224
    v_add_f32 v104, 1.0, v104
    v_add_f32 v105, 1.0, v105
    v_add_f32 v106, 1.0, v106
    v_add_f32 v107, 1.0, v107
    v_rcp_f32 v104, v104
    v_rcp_f32 v105, v105
    v_rcp_f32 v106, v106
    v_rcp_f32 v107, v107
    v_lshlrev_b32 v120, 16, v224
    v_mul_f32 v121, v10, v121
    v_and_b32 v100, v9, v16
    v_and_b32 v101, v9, v18
    v_and_b32 v102, v9, v20
    v_and_b32 v103, v9, v22
    v_mul_f32 v108, v8, v100
    v_mul_f32 v109, v8, v101
    v_mul_f32 v110, v8, v102
    v_mul_f32 v111, v8, v103
    v_exp_f32 v108, v108
    v_exp_f32 v109, v109
    v_exp_f32 v110, v110
    v_exp_f32 v111, v111
    v_and_b32 v123, v9, v226
    v_add_f32 v108, 1.0, v108
    v_add_f32 v109, 1.0, v109
    v_add_f32 v110, 1.0, v110
    v_add_f32 v111, 1.0, v111
    v_rcp_f32 v108, v108
    v_rcp_f32 v109, v109
    v_rcp_f32 v110, v110
    v_rcp_f32 v111, v111
    v_lshlrev_b32 v122, 16, v226
    v_mul_f32 v123, v10, v123
    s_setprio 2
L_w0:
    ds_read_b32 v41, v88 offset:0
    s_waitcnt lgkmcnt(0)
    v_cmp_eq_u32 vcc, 0, v41
    s_cbranch_vccz L_w0_ok
    s_sleep 2
    s_sub_u32 s61, s61, 1
    s_cbranch_scc0 L_w0
L_w0_ok:
    ds_read2st64_b32 v[32:33], v37 offset0:0 offset1:132
    ds_read2st64_b32 v[34:35], v39 offset0:0 offset1:132
    s_setprio 0
    s_waitcnt lgkmcnt(0)
    v_lshlrev_b32 v112, 16, v32
    v_lshlrev_b32 v113, 16, v33
    v_lshlrev_b32 v114, 16, v34
    v_lshlrev_b32 v115, 16, v35
    v_fma_f32 v112, v112, v104, v121
    v_fma_f32 v113, v113, v105, v121
    v_fma_f32 v114, v114, v106, v121
    v_fma_f32 v115, v115, v107, v121
    v_fma_f32 v96, v96, v112, v120
    v_fma_f32 v97, v97, v113, v120
    v_fma_f32 v98, v98, v114, v120
    v_fma_f32 v99, v99, v115, v120
    v_cvt_pk_bf16_f32 v104, v96, v97
    v_cvt_pk_bf16_f32 v105, v98, v99
    global_store_dwordx2 v36, v[104:105], s[32:33] offset:0
    v_and_b32 v116, v9, v32
    v_and_b32 v117, v9, v33
    v_and_b32 v118, v9, v34
    v_and_b32 v119, v9, v35
    v_fma_f32 v116, v116, v108, v123
    v_fma_f32 v117, v117, v109, v123
    v_fma_f32 v118, v118, v110, v123
    v_fma_f32 v119, v119, v111, v123
    v_fma_f32 v100, v100, v116, v122
    v_fma_f32 v101, v101, v117, v122
    v_fma_f32 v102, v102, v118, v122
    v_fma_f32 v103, v103, v119, v122
    v_cvt_pk_bf16_f32 v108, v100, v101
    v_cvt_pk_bf16_f32 v109, v102, v103
    v_lshlrev_b32 v128, 16, v17
    v_lshlrev_b32 v129, 16, v19
    v_lshlrev_b32 v130, 16, v21
    v_lshlrev_b32 v131, 16, v23
    v_mul_f32 v136, v8, v128
    v_mul_f32 v137, v8, v129
    v_mul_f32 v138, v8, v130
    v_mul_f32 v139, v8, v131
    v_exp_f32 v136, v136
    v_exp_f32 v137, v137
    v_exp_f32 v138, v138
    v_exp_f32 v139, v139
    v_and_b32 v153, v9, v228
    v_add_f32 v136, 1.0, v136
    v_add_f32 v137, 1.0, v137
    v_add_f32 v138, 1.0, v138
    v_add_f32 v139, 1.0, v139
    v_rcp_f32 v136, v136
    v_rcp_f32 v137, v137
    v_rcp_f32 v138, v138
    v_rcp_f32 v139, v139
    v_lshlrev_b32 v152, 16, v228
    v_mul_f32 v153, v10, v153
    global_store_dwordx2 v36, v[108:109], s[32:33] offset:1152
    v_add_u32 v36, 589824, v36
    v_and_b32 v132, v9, v17
    v_and_b32 v133, v9, v19
    v_and_b32 v134, v9, v21
    v_and_b32 v135, v9, v23
    v_mul_f32 v140, v8, v132
    v_mul_f32 v141, v8, v133
    v_mul_f32 v142, v8, v134
    v_mul_f32 v143, v8, v135
    v_exp_f32 v140, v140
    v_exp_f32 v141, v141
    v_exp_f32 v142, v142
    v_exp_f32 v143, v143
    v_and_b32 v155, v9, v230
    v_add_f32 v140, 1.0, v140
    v_add_f32 v141, 1.0, v141
    v_add_f32 v142, 1.0, v142
    v_add_f32 v143, 1.0, v143
    v_rcp_f32 v140, v140
    v_rcp_f32 v141, v141
    v_rcp_f32 v142, v142
    v_rcp_f32 v143, v143
    v_lshlrev_b32 v154, 16, v230
    v_mul_f32 v155, v10, v155
    s_setprio 2
L_w1:
    ds_read_b32 v41, v88 offset:16
    s_waitcnt lgkmcnt(0)
    v_cmp_eq_u32 vcc, 0, v41
    s_cbranch_vccz L_w1_ok
    s_sleep 2
    s_sub_u32 s61, s61, 1
    s_cbranch_scc0 L_w1
L_w1_ok:
    ds_read2st64_b32 v[32:33], v37 offset0:4 offset1:136
    ds_read2st64_b32 v[34:35], v39 offset0:4 offset1:136
    s_setprio 0
    s_waitcnt lgkmcnt(0)
    v_lshlrev_b32 v144, 16, v32
    v_lshlrev_b32 v145, 16, v33
    v_lshlrev_b32 v146, 16, v34
    v_lshlrev_b32 v147, 16, v35
    v_fma_f32 v144, v144, v136, v153
    v_fma_f32 v145, v145, v137, v153
    v_fma_f32 v146, v146, v138, v153
    v_fma_f32 v147, v147, v139, v153
    v_fma_f32 v128, v128, v144, v152
    v_fma_f32 v129, v129, v145, v152
    v_fma_f32 v130, v130, v146, v152
    v_fma_f32 v131, v131, v147, v152
    v_cvt_pk_bf16_f32 v136, v128, v129
    v_cvt_pk_bf16_f32 v137, v130, v131
    global_store_dwordx2 v36, v[136:137], s[32:33] offset:0
    v_and_b32 v148, v9, v32
    v_and_b32 v149, v9, v33
    v_and_b32 v150, v9, v34
    v_and_b32 v151, v9, v35
    v_fma_f32 v148, v148, v140, v155
    v_fma_f32 v149, v149, v141, v155
    v_fma_f32 v150, v150, v142, v155
    v_fma_f32 v151, v151, v143, v155
    v_fma_f32 v132, v132, v148, v154
    v_fma_f32 v133, v133, v149, v154
    v_fma_f32 v134, v134, v150, v154
    v_fma_f32 v135, v135, v151, v154
    v_cvt_pk_bf16_f32 v140, v132, v133
    v_cvt_pk_bf16_f32 v141, v134, v135
    v_lshlrev_b32 v160, 16, v24
    v_lshlrev_b32 v161, 16, v26
    v_lshlrev_b32 v162, 16, v28
    v_lshlrev_b32 v163, 16, v30
    v_mul_f32 v168, v8, v160
    v_mul_f32 v169, v8, v161
    v_mul_f32 v170, v8, v162
    v_mul_f32 v171, v8, v163
    v_exp_f32 v168, v168
    v_exp_f32 v169, v169
    v_exp_f32 v170, v170
    v_exp_f32 v171, v171
    v_and_b32 v185, v9, v232
    v_add_f32 v168, 1.0, v168
    v_add_f32 v169, 1.0, v169
    v_add_f32 v170, 1.0, v170
    v_add_f32 v171, 1.0, v171
    v_rcp_f32 v168, v168
    v_rcp_f32 v169, v169
    v_rcp_f32 v170, v170
    v_rcp_f32 v171, v171
    v_lshlrev_b32 v184, 16, v232
    v_mul_f32 v185, v10, v185
    global_store_dwordx2 v36, v[140:141], s[32:33] offset:1152
    v_add_u32 v36, 589824, v36
    v_and_b32 v164, v9, v24
    v_and_b32 v165, v9, v26
    v_and_b32 v166, v9, v28
    v_and_b32 v167, v9, v30
    v_mul_f32 v172, v8, v164
    v_mul_f32 v173, v8, v165
    v_mul_f32 v174, v8, v166
    v_mul_f32 v175, v8, v167
    v_exp_f32 v172, v172
    v_exp_f32 v173, v173
    v_exp_f32 v174, v174
    v_exp_f32 v175, v175
    v_and_b32 v187, v9, v234
    v_add_f32 v172, 1.0, v172
    v_add_f32 v173, 1.0, v173
    v_add_f32 v174, 1.0, v174
    v_add_f32 v175, 1.0, v175
    v_rcp_f32 v172, v172
    v_rcp_f32 v173, v173
    v_rcp_f32 v174, v174
    v_rcp_f32 v175, v175
    v_lshlrev_b32 v186, 16, v234
    v_mul_f32 v187, v10, v187
    s_setprio 2
L_w2:
    ds_read_b32 v41, v88 offset:32
    s_waitcnt lgkmcnt(0)
    v_cmp_eq_u32 vcc, 0, v41
    s_cbranch_vccz L_w2_ok
    s_sleep 2
    s_sub_u32 s61, s61, 1
    s_cbranch_scc0 L_w2
L_w2_ok:
    ds_read2st64_b32 v[32:33], v37 offset0:8 offset1:140
    ds_read2st64_b32 v[34:35], v39 offset0:8 offset1:140
    s_setprio 0
    s_waitcnt lgkmcnt(0)
    v_lshlrev_b32 v176, 16, v32
    v_lshlrev_b32 v177, 16, v33
    v_lshlrev_b32 v178, 16, v34
    v_lshlrev_b32 v179, 16, v35
    v_fma_f32 v176, v176, v168, v185
    v_fma_f32 v177, v177, v169, v185
    v_fma_f32 v178, v178, v170, v185
    v_fma_f32 v179, v179, v171, v185
    v_fma_f32 v160, v160, v176, v184
    v_fma_f32 v161, v161, v177, v184
    v_fma_f32 v162, v162, v178, v184
    v_fma_f32 v163, v163, v179, v184
    v_cvt_pk_bf16_f32 v168, v160, v161
    v_cvt_pk_bf16_f32 v169, v162, v163
    global_store_dwordx2 v36, v[168:169], s[32:33] offset:0
    v_and_b32 v180, v9, v32
    v_and_b32 v181, v9, v33
    v_and_b32 v182, v9, v34
    v_and_b32 v183, v9, v35
    v_fma_f32 v180, v180, v172, v187
    v_fma_f32 v181, v181, v173, v187
    v_fma_f32 v182, v182, v174, v187
    v_fma_f32 v183, v183, v175, v187
    v_fma_f32 v164, v164, v180, v186
    v_fma_f32 v165, v165, v181, v186
    v_fma_f32 v166, v166, v182, v186
    v_fma_f32 v167, v167, v183, v186
    v_cvt_pk_bf16_f32 v172, v164, v165
    v_cvt_pk_bf16_f32 v173, v166, v167
    v_lshlrev_b32 v192, 16, v25
    v_lshlrev_b32 v193, 16, v27
    v_lshlrev_b32 v194, 16, v29
    v_lshlrev_b32 v195, 16, v31
    v_mul_f32 v200, v8, v192
    v_mul_f32 v201, v8, v193
    v_mul_f32 v202, v8, v194
    v_mul_f32 v203, v8, v195
    v_exp_f32 v200, v200
    v_exp_f32 v201, v201
    v_exp_f32 v202, v202
    v_exp_f32 v203, v203
    v_and_b32 v217, v9, v236
    v_add_f32 v200, 1.0, v200
    v_add_f32 v201, 1.0, v201
    v_add_f32 v202, 1.0, v202
    v_add_f32 v203, 1.0, v203
    v_rcp_f32 v200, v200
    v_rcp_f32 v201, v201
    v_rcp_f32 v202, v202
    v_rcp_f32 v203, v203
    v_lshlrev_b32 v216, 16, v236
    v_mul_f32 v217, v10, v217
    global_store_dwordx2 v36, v[172:173], s[32:33] offset:1152
    v_add_u32 v36, 589824, v36
    v_and_b32 v196, v9, v25
    v_and_b32 v197, v9, v27
    v_and_b32 v198, v9, v29
    v_and_b32 v199, v9, v31
    v_mul_f32 v204, v8, v196
    v_mul_f32 v205, v8, v197
    v_mul_f32 v206, v8, v198
    v_mul_f32 v207, v8, v199
    v_exp_f32 v204, v204
    v_exp_f32 v205, v205
    v_exp_f32 v206, v206
    v_exp_f32 v207, v207
    v_and_b32 v219, v9, v238
    v_add_f32 v204, 1.0, v204
    v_add_f32 v205, 1.0, v205
    v_add_f32 v206, 1.0, v206
    v_add_f32 v207, 1.0, v207
    v_rcp_f32 v204, v204
    v_rcp_f32 v205, v205
    v_rcp_f32 v206, v206
    v_rcp_f32 v207, v207
    v_lshlrev_b32 v218, 16, v238
    v_mul_f32 v219, v10, v219
    s_setprio 2
L_w3:
    ds_read_b32 v41, v88 offset:48
    ds_read2st64_b32 v[32:33], v37 offset0:12 offset1:144
    ds_read2st64_b32 v[34:35], v39 offset0:12 offset1:144
    s_waitcnt lgkmcnt(0)
    v_cmp_eq_u32 vcc, 0, v41
    s_cbranch_vccz L_w3_ok
    s_sleep 1
    s_sub_u32 s61, s61, 1
    s_cbranch_scc0 L_w3
L_w3_ok:
    v_lshlrev_b32 v208, 16, v32
    v_lshlrev_b32 v209, 16, v33
    v_lshlrev_b32 v210, 16, v34
    v_lshlrev_b32 v211, 16, v35
    v_fma_f32 v208, v208, v200, v217
    v_fma_f32 v209, v209, v201, v217
    v_fma_f32 v210, v210, v202, v217
    v_fma_f32 v211, v211, v203, v217
    v_fma_f32 v192, v192, v208, v216
    v_fma_f32 v193, v193, v209, v216
    v_fma_f32 v194, v194, v210, v216
    v_fma_f32 v195, v195, v211, v216
    v_cvt_pk_bf16_f32 v200, v192, v193
    v_cvt_pk_bf16_f32 v201, v194, v195
    global_store_dwordx2 v36, v[200:201], s[32:33] offset:0
    v_and_b32 v212, v9, v32
    v_and_b32 v213, v9, v33
    v_and_b32 v214, v9, v34
    v_and_b32 v215, v9, v35
    v_fma_f32 v212, v212, v204, v219
    v_fma_f32 v213, v213, v205, v219
    v_fma_f32 v214, v214, v206, v219
    v_fma_f32 v215, v215, v207, v219
    v_fma_f32 v196, v196, v212, v218
    v_fma_f32 v197, v197, v213, v218
    v_fma_f32 v198, v198, v214, v218
    v_fma_f32 v199, v199, v215, v218
    v_cvt_pk_bf16_f32 v204, v196, v197
    v_cvt_pk_bf16_f32 v205, v198, v199
    global_store_dwordx2 v36, v[204:205], s[32:33] offset:1152
    s_waitcnt vmcnt(0)
    s_barrier
    s_endpgm
L_lnp:
    s_mul_i32 s43, s39, 1216
    s_add_u32 s43, s43, 154048
    v_add_u32 v52, s43, v3
    v_add_u32 v53, s43, v4
    s_lshl_b32 s43, s39, 3
    s_add_u32 s43, s43, 163776
    v_mov_b32 v54, s43
    v_bfe_u32 v55, v0, 2, 2
    v_mul_u32_u24 v55, 1216, v55
    v_and_b32 v56, 3, v0
    v_lshl_add_u32 v55, v56, 3, v55
    v_lshrrev_b32 v56, 4, v0
    v_lshl_add_u32 v55, v56, 5, v55
    v_add_u32 v55, 154048, v55
    v_lshrrev_b32 v56, 3, v0
    v_lshlrev_b32 v56, 15, v56
    v_and_b32 v57, 112, v3
    s_lshl_b32 s43, s2, 7
    s_add_u32 s43, s43, 2097152
    v_add3_u32 v56, v56, v57, s43
    v_mov_b32 v40, 0
    v_mov_b32 v41, 0
    v_mov_b32 v42, 0
    v_mov_b32 v43, 0
    v_mov_b32 v44, 0x3ae38e39
    v_mov_b32 v38, 0xbfffbfff
    v_mov_b32 v37, 0xffff
    s_lshl_b32 s58, s2, 3
    s_add_u32 s58, s58, s39
    s_xor_b32 s58, s58, 0x7ff
    s_lshl_b32 s58, s58, 5
    s_waitcnt lgkmcnt(0)
    s_add_u32 s38, s38, 0x9e370001
    s_lshr_b32 s44, s38, 16
    s_and_b32 s45, s38, 0xff
    s_and_b32 s46, s38, 0xfb
    s_bitcmp0_b32 s38, 0
    s_cselect_b32 s43, 4, 0
    s_or_b32 s46, s46, s43
    s_bitcmp1_b32 s46, s39
    s_cselect_b32 s43, 0x40004000, 0
    v_mov_b32 v39, s43
    s_xor_b32 s58, s58, s44
    v_mov_b32 v57, s58
    s_mov_b32 s42, 0x3f803f80
    s_cmp_lt_u32 s41, 27
    s_cbranch_scc1 L_lw2
    s_cmp_lt_u32 s39, 2
    s_cbranch_scc0 L_lw1
    global_load_dword v1, v76, s[56:57]
    s_waitcnt vmcnt(1)
    s_branch L_ln
L_lw1:
    s_waitcnt vmcnt(0)
    s_branch L_ln
L_lw2:
    s_add_u32 m0, s49, 0
    s_nop 0
    global_load_lds_dwordx4 v76, s[56:57]
    v_add_u32 v76, 294912, v76
    s_add_u32 m0, s49, 4096
    s_nop 0
    global_load_lds_dwordx4 v76, s[56:57]
    v_add_u32 v76, 294912, v76
    s_add_u32 m0, s49, 8192
    s_nop 0
    global_load_lds_dwordx4 v76, s[56:57]
    v_add_u32 v76, 294912, v76
    s_waitcnt vmcnt(3)
L_ln:
    v_dot2c_f32_bf16 v40, s42, v12
    v_dot2c_f32_bf16 v41, v12, v12
    v_dot2c_f32_bf16 v42, v12, v20
    v_dot2c_f32_bf16 v43, s42, v20
    v_dot2c_f32_bf16 v40, s42, v13
    v_dot2c_f32_bf16 v41, v13, v13
    v_dot2c_f32_bf16 v42, v13, v21
    v_dot2c_f32_bf16 v43, s42, v21
    v_dot2c_f32_bf16 v40, s42, v14
    v_dot2c_f32_bf16 v41, v14, v14
    v_dot2c_f32_bf16 v42, v14, v22
    v_dot2c_f32_bf16 v43, s42, v22
    v_dot2c_f32_bf16 v40, s42, v15
    v_dot2c_f32_bf16 v41, v15, v15
    v_dot2c_f32_bf16 v42, v15, v23
    v_dot2c_f32_bf16 v43, s42, v23
    v_dot2c_f32_bf16 v40, s42, v16
    v_dot2c_f32_bf16 v41, v16, v16
    v_dot2c_f32_bf16 v42, v16, v24
    v_dot2c_f32_bf16 v43, s42, v24
    v_lshlrev_b32 v36, 16, v16
    v_lshlrev_b32 v28, 16, v12
    v_and_b32 v29, 0xffff0000, v12
    v_permlane32_swap_b32 v40, v42
    v_permlane32_swap_b32 v41, v43
    v_add_f32 v40, v40, v42
    v_add_f32 v41, v41, v43
    v_lshlrev_b32 v30, 16, v13
    v_and_b32 v31, 0xffff0000, v13
    v_permlane16_swap_b32 v40, v41
    v_add_f32 v40, v40, v41
    v_lshlrev_b32 v32, 16, v14
    v_and_b32 v33, 0xffff0000, v14
    v_add_f32_dpp v40, v40, v40 row_ror:8 row_mask:0xf bank_mask:0xf
    v_lshlrev_b32 v34, 16, v15
    v_and_b32 v35, 0xffff0000, v15
    v_add_f32_dpp v40, v40, v40 row_ror:4 row_mask:0xf bank_mask:0xf
    s_nop 1
    v_add_f32_dpp v40, v40, v40 row_ror:2 row_mask:0xf bank_mask:0xf
    s_nop 1
    v_add_f32_dpp v40, v40, v40 row_ror:1 row_mask:0xf bank_mask:0xf
    s_nop 0
    v_readlane_b32 s58, v40, 0
    v_readlane_b32 s59, v40, 16
    v_readlane_b32 s60, v40, 32
    v_readlane_b32 s61, v40, 48
    v_mul_f32 v40, s58, v44
    v_mul_f32 v41, s59, v44
    v_fma_f32 v41, -v40, v40, v41
    v_max_f32 v41, 0, v41
    v_cvt_pk_bf16_f32 v44, v41, v40
    v_lshlrev_b32 v41, 16, v44
    v_add_f32 v41, 0x3727c5ac, v41
    v_cvt_pk_bf16_f32 v41, v41, v41
    v_and_b32 v41, 0xffff0000, v41
    v_sqrt_f32 v41, v41
    v_and_b32 v49, 0xffff0000, v44
    v_cvt_pk_bf16_f32 v50, v49, v41
    v_and_b32 v41, 0xffff0000, v50
    v_rcp_f32 v48, v41
    v_mul_f32 v42, s61, v49
    v_mul_f32 v46, 0x3d000000, v48
    v_mul_f32 v47, v49, v46
    v_fma_f32 v28, v28, v46, -v47
    v_fma_f32 v29, v29, v46, -v47
    v_fma_f32 v30, v30, v46, -v47
    v_fma_f32 v31, v31, v46, -v47
    v_fma_f32 v32, v32, v46, -v47
    v_fma_f32 v33, v33, v46, -v47
    v_fma_f32 v34, v34, v46, -v47
    v_fma_f32 v35, v35, v46, -v47
    v_fma_f32 v36, v36, v46, -v47
    v_cvt_pk_bf16_f32 v28, v28, v29
    v_cvt_pk_bf16_f32 v29, v30, v31
    v_cvt_pk_bf16_f32 v30, v32, v33
    v_cvt_pk_bf16_f32 v31, v34, v35
    v_cvt_pk_bf16_f32 v32, v36, v36
    v_bitop3_b32 v28, v28, v38, v39 bitop3:0xea
    v_bitop3_b32 v29, v29, v38, v39 bitop3:0xea
    v_bitop3_b32 v30, v30, v38, v39 bitop3:0xea
    v_bitop3_b32 v31, v31, v38, v39 bitop3:0xea
    v_bitop3_b32 v32, v32, v38, v39 bitop3:0xea
    ds_write_b128 v52, v[28:31]
    ds_write_b16 v53, v32 offset:1024
    v_sub_f32 v42, s60, v42
    v_mul_f32 v42, v42, v48
    v_cvt_pk_bf16_f32 v42, v42, v42
    v_ashrrev_i32 v43, 31, v42
    v_or_b32 v43, 0x80000000, v43
    v_xor_b32 v42, v42, v43
    v_bitop3_b32 v51, v37, v57, v42 bitop3:0xca
    s_mov_b64 exec, 1
    ds_write_b64 v54, v[50:51]
    s_mov_b64 exec, -1
    s_waitcnt lgkmcnt(0)
    s_barrier
    s_cmp_eq_u32 s39, 1
    s_cbranch_scc1 L_ln_stat
    ds_read_b64_tr_b16 v[28:29], v55
    ds_read_b64_tr_b16 v[30:31], v55 offset:4864
    s_cmp_eq_u32 s39, 0
    s_cbranch_scc0 L_ln_st
    ds_read_b64_tr_b16 v[32:33], v55 offset:1024
    ds_read_b64_tr_b16 v[34:35], v55 offset:5888
    v_add_u32 v38, 2097152, v56
    s_waitcnt lgkmcnt(0)
    global_store_dwordx4 v38, v[32:35], s[36:37] sc1
    s_branch L_ln_st
L_ln_stat:
    v_and_b32 v41, 0x30, v3
    v_add_u32 v40, 163776, v41
    ds_read_b128 v[48:51], v40
    ds_read_b64_tr_b16 v[28:29], v55
    ds_read_b64_tr_b16 v[30:31], v55 offset:4864
    s_lshl_b32 s43, s2, 6
    s_add_u32 s43, s43, 16384
    v_add_u32 v41, s43, v41
    s_mov_b64 exec, 15
    s_waitcnt lgkmcnt(2)
    global_store_dwordx4 v41, v[48:51], s[36:37] sc1
    s_mov_b64 exec, -1
L_ln_st:
    s_waitcnt lgkmcnt(0)
    global_store_dwordx4 v56, v[28:31], s[36:37] sc1
    s_barrier
    s_cmp_lt_u32 s41, 27
    s_cbranch_scc1 L_ffn
    s_cmp_lt_u32 s39, 2
    s_cbranch_scc1 L_sp2
    global_load_dword v1, v76, s[56:57]
L_sp2:
    s_mul_i32 s42, s39, 320
    s_add_u32 s42, s42, s53
    s_add_u32 s42, s42, 640
    s_mov_b32 s58, 2
    s_mul_i32 s43, s40, 1152
    s_add_u32 s43, s43, 884736
    s_mul_i32 s59, s40, 663552
    s_cmp_eq_u32 s58, 0
    s_cselect_b32 s56, s26, s28
    s_cselect_b32 s57, s27, s29
    s_cmp_eq_u32 s58, 2
    s_cselect_b32 s56, s30, s56
    s_cselect_b32 s57, s31, s57
    s_cselect_b32 s43, s59, s43
    s_movk_i32 s58, 128
    s_movk_i32 s59, 8064
    s_movk_i32 s60, 4319
    s_cmov_b32 s58, 73728
    s_cmov_b32 s59, -663424
    s_cmovk_i32 s60, 5183
    v_add_u32 v76, s42, v2
    v_min_u32 v76, s60, v76
    v_mul_u32_u24 v63, 7282, v76
    v_lshrrev_b32 v63, 16, v63
    v_mul_u32_u24 v76, s58, v76
    v_mad_i32_i24 v76, v63, s59, v76
    v_add_u32 v76, s43, v76
    s_barrier
    global_load_dword v1, v76, s[56:57]
    s_waitcnt vmcnt(0)
    s_endpgm
L_ffn:
    v_bfe_u32 v14, v0, 4, 2
    v_and_b32 v11, 7, v0
    v_mov_b32 v26, 147456
    v_mov_b32 v27, 4
    s_cmp_eq_u32 s52, 0
    s_cbranch_scc0 L_gu
    s_setprio 1
    v_lshlrev_b32 v8, 4, v0
    v_add_u32 v9, 20480, v8
    v_add_u32 v10, 8192, v9
    v_lshlrev_b32 v13, 6, v0
    v_xor_b32 v128, 65504, v13
    v_xor_b32 v129, 65472, v13
    v_xor_b32 v130, 49120, v13
    v_xor_b32 v131, 49088, v13
    v_xor_b32 v132, 32736, v13
    v_xor_b32 v133, 32704, v13
    v_xor_b32 v134, 16352, v13
    v_xor_b32 v135, 16320, v13
    v_mov_b32 v36, s44
    v_lshrrev_b32 v25, 5, v0
    v_lshl_add_u32 v25, v25, 2, v26
    s_mul_i32 s62, s39, 80
    s_add_u32 s62, s62, 147584
    v_and_b32 v15, 0x3c, v0
    v_add_u32 v15, s62, v15
    v_and_b32 v16, 3, v0
    v_mul_u32_u24 v16, 80, v16
    v_add_u32 v16, 147584, v16
    v_lshrrev_b32 v12, 3, v2
    v_lshl_add_u32 v17, v12, 2, v26
    v_lshl_add_u32 v18, v11, 2, v26
    v_and_b32 v12, 6, v12
    v_xor_b32 v12, v12, v11
    v_lshlrev_b32 v12, 4, v12
    v_lshl_add_u32 v12, v1, 7, v12
    v_add_u32 v12, 2358144, v12
    s_lshl_b32 s63, s54, 7
    s_add_u32 s63, s63, 2358144
    v_mov_b32 v37, s63
    s_movk_i32 s63, -1152
    s_mul_i32 s64, s39, 1056
    s_mul_i32 s42, s50, 73728
    s_add_u32 s12, s30, s42
    s_addc_u32 s13, s31, 0
    s_add_u32 s14, s12, 18432
    s_addc_u32 s15, s13, 0
    s_add_u32 s16, s12, 36864
    s_addc_u32 s17, s13, 0
    s_add_u32 s18, s12, 55296
    s_addc_u32 s19, s13, 0
    v_mul_u32_u24 v19, 4608, v14
    v_and_b32 v20, 0xf0, v3
    s_lshl_b32 s42, s51, 8
    v_add3_u32 v19, v19, v20, s42
    v_lshrrev_b32 v20, 1, v2
    v_mul_u32_u24 v20, 1152, v20
    v_and_b32 v21, 16, v3
    s_lshl_b32 s42, s51, 5
    v_add3_u32 v20, v20, v21, s42
    v_bfe_i32 v232, v0, 3, 1
    v_mul_u32_u24 v4, 74752, v14
    v_lshl_add_u32 v4, v11, 4, v4
    v_and_b32 v5, 9344, v232
    s_lshl_b32 s43, s50, 7
    s_add_u32 s43, s43, 65536
    s_mul_i32 s42, s51, 299008
    s_add_u32 s42, s42, s43
    v_add3_u32 v4, v4, v5, s42
    v_add_u32 v5, 18688, v4
    v_add_u32 v6, 37376, v4
    v_add_u32 v7, 56064, v4
    v_mul_u32_u24 v8, 9344, v14
    v_lshl_add_u32 v8, v11, 4, v8
    s_mul_i32 s42, s51, 37376
    s_add_u32 s42, s42, s43
    s_add_u32 s42, s42, 1196032
    v_add_u32 v8, s42, v8
    v_mov_b32 v233, s45
    v_mov_b32 v234, 0xff
    v_and_b32 v235, 0x370, v3
    v_add_u32 v235, 147968, v235
    s_lshl_b32 s42, s51, 10
    s_add_u32 s42, s42, 159520
    v_add_u32 v236, s42, v3
    v_lshl_add_u32 v237, v2, 3, s42
    s_mov_b32 s66, 0x05040100
    s_mov_b32 s67, 0x07060302
    s_movk_i32 s55, 4096
    s_waitcnt vmcnt(0)
    s_barrier
    global_load_dwordx4 v[112:115], v9, s[36:37] offset:-4096 sc1
    global_load_dwordx4 v[116:119], v9, s[36:37] offset:0 sc1
    global_load_dwordx4 v[120:123], v10, s[36:37] offset:-4096 sc1
    global_load_dwordx4 v[124:127], v10, s[36:37] offset:0 sc1
L_ffn_poll:
    v_mov_b32 v24, 0
    s_waitcnt vmcnt(3)
    v_xor_b32 v28, v36, v113
    v_bitop3_b32 v24, v24, v28, v128 bitop3:0xf6
    v_xor_b32 v29, v36, v115
    v_bitop3_b32 v24, v24, v29, v129 bitop3:0xf6
    s_waitcnt vmcnt(2)
    v_xor_b32 v30, v36, v117
    v_bitop3_b32 v24, v24, v30, v130 bitop3:0xf6
    v_xor_b32 v31, v36, v119
    v_bitop3_b32 v24, v24, v31, v131 bitop3:0xf6
    s_waitcnt vmcnt(1)
    v_xor_b32 v32, v36, v121
    v_bitop3_b32 v24, v24, v32, v132 bitop3:0xf6
    v_xor_b32 v33, v36, v123
    v_bitop3_b32 v24, v24, v33, v133 bitop3:0xf6
    s_waitcnt vmcnt(0)
    v_xor_b32 v34, v36, v125
    v_bitop3_b32 v24, v24, v34, v134 bitop3:0xf6
    v_xor_b32 v35, v36, v127
    v_bitop3_b32 v24, v24, v35, v135 bitop3:0xf6
    v_and_b32 v24, 0xffff, v24
    v_cmp_ne_u32 vcc, 0, v24
    v_max3_u32 v38, v28, v29, v30
    v_max3_u32 v39, v31, v32, v33
    s_cbranch_vccz L_ffn_go
    global_load_dwordx4 v[112:115], v9, s[36:37] offset:-4096 sc1
    global_load_dwordx4 v[116:119], v9, s[36:37] offset:0 sc1
    global_load_dwordx4 v[120:123], v10, s[36:37] offset:-4096 sc1
    global_load_dwordx4 v[124:127], v10, s[36:37] offset:0 sc1
    s_sub_u32 s55, s55, 1
    s_cbranch_scc0 L_ffn_poll
    s_waitcnt vmcnt(0)
L_ffn_go:
    s_barrier
    v_max3_u32 v38, v38, v34, v35
    v_max_u32 v38, v38, v39
    v_alignbit_b32 v24, 1, v38, 5
    v_sub_u32 v128, v28, v38
    v_sub_u32 v129, v29, v38
    v_max_u32_dpp v21, v24, v24 row_ror:1 row_mask:0xf bank_mask:0xf
    v_sub_u32 v130, v30, v38
    v_sub_u32 v131, v31, v38
    v_max_u32_dpp v21, v21, v21 row_ror:2 row_mask:0xf bank_mask:0xf
    v_sub_u32 v132, v32, v38
    v_sub_u32 v133, v33, v38
    v_max_u32_dpp v21, v21, v21 row_ror:4 row_mask:0xf bank_mask:0xf
    v_sub_u32 v134, v34, v38
    v_sub_u32 v135, v35, v38
    v_max_u32_dpp v21, v21, v21 row_ror:8 row_mask:0xf bank_mask:0xf
    v_max3_u32 v39, v128, v129, v130
    v_max3_u32 v22, v131, v132, v133
    v_max_u32_dpp v21, v21, v21 row_bcast:15 row_mask:0xa bank_mask:0xf
    s_mov_b32 exec_lo, 0x80000000
    s_mov_b32 exec_hi, 0x80000000
    ds_write_b32 v25, v21
    s_mov_b64 exec, -1
    s_mov_b32 s55, 262144
    ds_read_b128 v[112:115], v26
    ds_read_b128 v[116:119], v26 offset:16
    v_max3_u32 v39, v39, v134, v135
    v_max_u32 v39, v39, v22
    v_add_u32 v39, v39, v38
    v_alignbit_b32 v23, 1, v39, 5
L_s1:
    s_waitcnt lgkmcnt(0)
    v_min3_u32 v21, v112, v113, v114
    v_min3_u32 v22, v115, v116, v117
    v_min3_u32 v21, v21, v118, v119
    v_min_u32 v21, v21, v22
    v_cmp_eq_u32 vcc, 0, v21
    v_cmp_ge_u32 s[6:7], v24, v21
    v_cmp_ge_u32 s[8:9], v23, v21
    s_cbranch_vccz L_s1_ok
    ds_read_b128 v[112:115], v26
    ds_read_b128 v[116:119], v26 offset:16
    s_sub_u32 s55, s55, 1
    s_cbranch_scc0 L_s1
L_s1_ok:
    s_bcnt1_i32_b64 s10, s[6:7]
    v_mbcnt_lo_u32_b32 v22, s6, 0
    v_mbcnt_lo_u32_b32 v13, s8, 0
    v_mbcnt_hi_u32_b32 v22, s7, v22
    v_mbcnt_hi_u32_b32 v13, s9, v13
    v_min_u32 v22, 16, v22
    v_add_u32 v13, s10, v13
    v_lshl_add_u32 v22, v22, 2, s62
    v_min_u32 v13, 16, v13
    s_mov_b64 exec, s[6:7]
    ds_write_b32 v22, v24
    v_lshl_add_u32 v13, v13, 2, s62
    s_mov_b64 exec, s[8:9]
    ds_write_b32 v13, v23
    s_mov_b64 exec, 1
    ds_add_u32 v26, v27 offset:32
    s_mov_b64 exec, -1
    ds_read_b32 v22, v26 offset:32
    ds_read_b32 v13, v15
    ds_read_b128 v[112:115], v16 offset:0
    ds_read_b128 v[116:119], v16 offset:16
    ds_read_b128 v[120:123], v16 offset:32
    ds_read_b128 v[124:127], v16 offset:48
    v_and_b32 v24, 0x7ff, v24
    v_and_b32 v23, 0x7ff, v23
    v_mad_i32_i24 v24, v24, s63, v37
    v_mad_i32_i24 v23, v23, s63, v37
    s_mov_b64 exec, s[6:7]
    global_load_dword v239, v24, s[4:5]
    s_cmp_eq_u64 s[8:9], 0
    s_cbranch_scc1 L_no2
    s_mov_b64 exec, s[8:9]
    global_load_dword v239, v23, s[4:5]
L_no2:
    s_mov_b64 exec, -1
L_s2:
    s_waitcnt lgkmcnt(0)
    v_cmp_ne_u32 vcc, 16, v22
    v_mov_b32 v24, 0
    s_cbranch_vccz L_s2_ok
    ds_read_b32 v22, v26 offset:32
    ds_read_b32 v13, v15
    ds_read_b128 v[112:115], v16 offset:0
    ds_read_b128 v[116:119], v16 offset:16
    ds_read_b128 v[120:123], v16 offset:32
    ds_read_b128 v[124:127], v16 offset:48
    s_sub_u32 s55, s55, 1
    s_cbranch_scc0 L_s2
L_s2_ok:
    v_sub_u32 v112, v13, v112
    v_alignbit_b32 v24, v24, v112, 31
    v_sub_u32 v113, v13, v113
    v_alignbit_b32 v24, v24, v113, 31
    v_sub_u32 v114, v13, v114
    v_alignbit_b32 v24, v24, v114, 31
    v_sub_u32 v115, v13, v115
    v_alignbit_b32 v24, v24, v115, 31
    v_sub_u32 v116, v13, v116
    v_alignbit_b32 v24, v24, v116, 31
    v_sub_u32 v117, v13, v117
    v_alignbit_b32 v24, v24, v117, 31
    v_sub_u32 v118, v13, v118
    v_alignbit_b32 v24, v24, v118, 31
    v_sub_u32 v119, v13, v119
    v_alignbit_b32 v24, v24, v119, 31
    v_sub_u32 v120, v13, v120
    v_alignbit_b32 v24, v24, v120, 31
    v_sub_u32 v121, v13, v121
    v_alignbit_b32 v24, v24, v121, 31
    v_sub_u32 v122, v13, v122
    v_alignbit_b32 v24, v24, v122, 31
    v_sub_u32 v123, v13, v123
    v_alignbit_b32 v24, v24, v123, 31
    v_sub_u32 v124, v13, v124
    v_alignbit_b32 v24, v24, v124, 31
    v_sub_u32 v125, v13, v125
    v_alignbit_b32 v24, v24, v125, 31
    v_sub_u32 v126, v13, v126
    v_alignbit_b32 v24, v24, v126, 31
    v_sub_u32 v127, v13, v127
    v_alignbit_b32 v24, v24, v127, 31
    v_bcnt_u32_b32 v24, v24, 0
    s_nop 1
    v_add_u32_dpp v24, v24, v24 quad_perm:[1,0,3,2] row_mask:0xf bank_mask:0xf
    s_nop 1
    v_add_u32_dpp v24, v24, v24 quad_perm:[2,3,0,1] row_mask:0xf bank_mask:0xf
    v_cmp_gt_u32 vcc, 8, v24
    v_lshl_add_u32 v24, v24, 2, v26
    s_mov_b64 exec, vcc
    ds_write_b32 v24, v13 offset:64
    s_mov_b64 exec, -1
L_s3:
    ds_read_b32 v23, v17 offset:64
    ds_read_b32 v13, v18 offset:64
    s_add_u32 m0, s64, 150016
    s_waitcnt lgkmcnt(0)
    v_cmp_eq_u32 vcc, 0, v23
    v_and_b32 v23, 0x7ff, v23
    s_sub_u32 s55, s55, 1
    s_cselect_b64 vcc, 0, vcc
    s_cbranch_vccnz L_s3
    v_mad_i32_i24 v23, v23, s63, v12
    global_load_lds_dwordx4 v23, s[4:5]
    s_add_u32 m0, s64, 153728
    v_and_b32 v22, 0x7ff, v13
    global_load_lds_dwordx4 v23, s[4:5] offset:512
    v_sub_u32 v22, 2047, v22
    s_cmp_lg_u32 s39, 0
    s_cbranch_scc1 L_nox9
    s_mov_b32 m0, 157440
    s_nop 0
    global_load_lds_dwordx4 v23, s[4:5] offset:1024
    s_branch L_x3
L_nox9:
    v_lshlrev_b32 v24, 3, v22
    v_add_u32 v24, 16384, v24
    global_load_dword v25, v24, s[36:37] sc1
L_x3:
    s_barrier
    v_readlane_b32 s10, v13, 7
    s_mov_b32 s11, 0
    s_lshl_b32 s10, s10, 5
    v_cmp_le_u32 vcc, s10, v28
    s_nop 0
    s_bcnt1_i32_b64 s56, vcc
    s_add_u32 s11, s11, s56
    v_cmp_le_u32 vcc, s10, v29
    s_nop 0
    s_bcnt1_i32_b64 s56, vcc
    s_add_u32 s11, s11, s56
    v_cmp_le_u32 vcc, s10, v30
    s_nop 0
    s_bcnt1_i32_b64 s56, vcc
    s_add_u32 s11, s11, s56
    v_cmp_le_u32 vcc, s10, v31
    s_nop 0
    s_bcnt1_i32_b64 s56, vcc
    s_add_u32 s11, s11, s56
    v_cmp_le_u32 vcc, s10, v32
    s_nop 0
    s_bcnt1_i32_b64 s56, vcc
    s_add_u32 s11, s11, s56
    v_cmp_le_u32 vcc, s10, v33
    s_nop 0
    s_bcnt1_i32_b64 s56, vcc
    s_add_u32 s11, s11, s56
    v_cmp_le_u32 vcc, s10, v34
    s_nop 0
    s_bcnt1_i32_b64 s56, vcc
    s_add_u32 s11, s11, s56
    v_cmp_le_u32 vcc, s10, v35
    s_nop 0
    s_bcnt1_i32_b64 s56, vcc
    s_add_u32 s11, s11, s56
    s_lshl_b32 s11, s11, 16
    s_or_b32 s11, s11, 4
    v_mov_b32 v36, s11
    s_barrier
    global_load_dwordx4 v[40:43], v19, s[12:13] offset:0
    global_load_dwordx4 v[44:47], v19, s[12:13] offset:1152
    s_waitcnt vmcnt(2)
    s_cmp_lg_u32 s39, 1
    s_cbranch_scc1 L_nost
    ds_write_b32 v18, v25 offset:448
L_nost:
    s_mov_b64 exec, 1
    ds_add_u32 v26, v36 offset:36
    s_mov_b64 exec, -1
    s_setprio 0
    global_load_dwordx4 v[48:51], v19, s[12:13] offset:2304
    global_load_dwordx4 v[52:55], v19, s[12:13] offset:3456
    global_load_dwordx4 v[56:59], v19, s[14:15] offset:0
    global_load_dwordx4 v[60:63], v19, s[14:15] offset:1152
    global_load_dwordx4 v[64:67], v19, s[14:15] offset:2304
    global_load_dwordx4 v[68:71], v19, s[14:15] offset:3456
    global_load_dwordx4 v[216:219], v20, s[12:13] offset:1024
    global_load_dwordx4 v[220:223], v20, s[16:17] offset:1024
L_s4:
    ds_read_b32 v24, v26 offset:36
    s_waitcnt lgkmcnt(0)
    v_readfirstlane_b32 s61, v24
    s_nop 0
    s_and_b32 s60, s61, 255
    s_cmp_ge_u32 s60, 16
    s_cbranch_scc1 L_s4_ok
    s_sub_u32 s55, s55, 1
    s_cbranch_scc0 L_s4
L_s4_ok:
    s_lshr_b32 s61, s61, 16
    s_cmp_eq_u32 s61, 8
    s_cbranch_scc0 L_slow
L_dgo:
    global_load_dwordx4 v[72:75], v19, s[16:17] offset:0
    s_waitcnt vmcnt(9)
    v_perm_b32 v112, v44, v40, s66
    v_perm_b32 v116, v44, v40, s67
    v_perm_b32 v120, v45, v41, s66
    v_perm_b32 v124, v45, v41, s67
    v_perm_b32 v128, v46, v42, s66
    v_perm_b32 v132, v46, v42, s67
    v_perm_b32 v136, v47, v43, s66
    v_perm_b32 v140, v47, v43, s67
    global_load_dwordx4 v[76:79], v19, s[16:17] offset:1152
    s_waitcnt vmcnt(8)
    v_perm_b32 v113, v52, v48, s66
    v_perm_b32 v117, v52, v48, s67
    v_perm_b32 v121, v53, v49, s66
    v_perm_b32 v125, v53, v49, s67
    v_perm_b32 v129, v54, v50, s66
    v_perm_b32 v133, v54, v50, s67
    v_perm_b32 v137, v55, v51, s66
    v_perm_b32 v141, v55, v51, s67
    global_load_dwordx4 v[80:83], v19, s[16:17] offset:2304
    global_load_dwordx4 v[84:87], v19, s[16:17] offset:3456
    s_waitcnt vmcnt(8)
    v_perm_b32 v114, v60, v56, s66
    v_perm_b32 v118, v60, v56, s67
    v_perm_b32 v122, v61, v57, s66
    v_perm_b32 v126, v61, v57, s67
    v_perm_b32 v130, v62, v58, s66
    v_perm_b32 v134, v62, v58, s67
    v_perm_b32 v138, v63, v59, s66
    v_perm_b32 v142, v63, v59, s67
    global_load_dwordx4 v[88:91], v19, s[18:19] offset:0
    global_load_dwordx4 v[92:95], v19, s[18:19] offset:1152
    s_waitcnt vmcnt(8)
    v_perm_b32 v115, v68, v64, s66
    v_perm_b32 v119, v68, v64, s67
    v_perm_b32 v123, v69, v65, s66
    v_perm_b32 v127, v69, v65, s67
    v_perm_b32 v131, v70, v66, s66
    v_perm_b32 v135, v70, v66, s67
    v_perm_b32 v139, v71, v67, s66
    v_perm_b32 v143, v71, v67, s67
    global_load_dwordx4 v[96:99], v19, s[18:19] offset:2304
    global_load_dwordx4 v[100:103], v19, s[18:19] offset:3456
    s_waitcnt vmcnt(6)
    ds_write_b128 v236, v[216:219]
    ds_read_b64_tr_b16 v[104:105], v237
    ds_read_b64_tr_b16 v[106:107], v237 offset:512
    ds_write_b128 v236, v[220:223]
    ds_read_b64_tr_b16 v[108:109], v237
    ds_read_b64_tr_b16 v[110:111], v237 offset:512
    v_perm_b32 v144, v76, v72, s66
    v_perm_b32 v148, v76, v72, s67
    v_perm_b32 v152, v77, v73, s66
    v_perm_b32 v156, v77, v73, s67
    v_perm_b32 v160, v78, v74, s66
    v_perm_b32 v164, v78, v74, s67
    v_perm_b32 v168, v79, v75, s66
    v_perm_b32 v172, v79, v75, s67
    s_waitcnt vmcnt(4)
    v_perm_b32 v145, v84, v80, s66
    v_perm_b32 v149, v84, v80, s67
    v_perm_b32 v153, v85, v81, s66
    v_perm_b32 v157, v85, v81, s67
    v_perm_b32 v161, v86, v82, s66
    v_perm_b32 v165, v86, v82, s67
    v_perm_b32 v169, v87, v83, s66
    v_perm_b32 v173, v87, v83, s67
    s_waitcnt vmcnt(2)
    v_perm_b32 v146, v92, v88, s66
    v_perm_b32 v150, v92, v88, s67
    v_perm_b32 v154, v93, v89, s66
    v_perm_b32 v158, v93, v89, s67
    v_perm_b32 v162, v94, v90, s66
    v_perm_b32 v166, v94, v90, s67
    v_perm_b32 v170, v95, v91, s66
    v_perm_b32 v174, v95, v91, s67
    s_waitcnt vmcnt(0)
    v_perm_b32 v147, v100, v96, s66
    v_perm_b32 v151, v100, v96, s67
    v_perm_b32 v155, v101, v97, s66
    v_perm_b32 v159, v101, v97, s67
    v_perm_b32 v163, v102, v98, s66
    v_perm_b32 v167, v102, v98, s67
    v_perm_b32 v171, v103, v99, s66
    v_perm_b32 v175, v103, v99, s67
    s_barrier
    ds_read_b128 v[28:31], v235
    ds_read_b128 v[32:35], v235 offset:1024
    s_mov_b32 s58, 0x00ff00ff
    s_mov_b32 s59, 0x00ff00ff
    s_waitcnt lgkmcnt(0)
    v_mfma_f32_16x16x32_bf16 v[208:211], v[104:107], v[28:31], 0
    v_mfma_f32_16x16x32_bf16 v[208:211], v[108:111], v[32:35], v[208:211]
    v_mfma_f32_16x16x32_bf16 v[176:179], v[112:115], v[28:31], 0
    v_mfma_f32_16x16x32_bf16 v[176:179], v[144:147], v[32:35], v[176:179]
    v_mfma_f32_16x16x32_bf16 v[192:195], v[128:131], v[28:31], 0
    v_mfma_f32_16x16x32_bf16 v[192:195], v[160:163], v[32:35], v[192:195]
    v_mfma_f32_16x16x32_bf16 v[180:183], v[116:119], v[28:31], 0
    v_mfma_f32_16x16x32_bf16 v[180:183], v[148:151], v[32:35], v[180:183]
    v_mfma_f32_16x16x32_bf16 v[196:199], v[132:135], v[28:31], 0
    v_mfma_f32_16x16x32_bf16 v[196:199], v[164:167], v[32:35], v[196:199]
    v_bitop3_b32 v208, v234, v233, v208 bitop3:0xca
    s_mov_b64 exec, s[58:59]
    global_store_dwordx4 v8, v[208:211], s[36:37] sc1
    s_mov_b64 exec, -1
    v_mfma_f32_16x16x32_bf16 v[184:187], v[120:123], v[28:31], 0
    v_bitop3_b32 v40, v232, v192, v176 bitop3:0xca
    v_bitop3_b32 v44, v232, v193, v177 bitop3:0xca
    v_mfma_f32_16x16x32_bf16 v[184:187], v[152:155], v[32:35], v[184:187]
    v_bitop3_b32 v48, v232, v194, v178 bitop3:0xca
    v_bitop3_b32 v52, v232, v195, v179 bitop3:0xca
    v_mfma_f32_16x16x32_bf16 v[200:203], v[136:139], v[28:31], 0
    v_bitop3_b32 v40, v234, v233, v40 bitop3:0xca
    v_bitop3_b32 v44, v234, v233, v44 bitop3:0xca
    v_mfma_f32_16x16x32_bf16 v[200:203], v[168:171], v[32:35], v[200:203]
    v_bitop3_b32 v48, v234, v233, v48 bitop3:0xca
    v_bitop3_b32 v52, v234, v233, v52 bitop3:0xca
    v_mfma_f32_16x16x32_bf16 v[188:191], v[124:127], v[28:31], 0
    v_bitop3_b32 v41, v232, v196, v180 bitop3:0xca
    v_bitop3_b32 v45, v232, v197, v181 bitop3:0xca
    v_mfma_f32_16x16x32_bf16 v[188:191], v[156:159], v[32:35], v[188:191]
    v_bitop3_b32 v49, v232, v198, v182 bitop3:0xca
    v_bitop3_b32 v53, v232, v199, v183 bitop3:0xca
    v_mfma_f32_16x16x32_bf16 v[204:207], v[140:143], v[28:31], 0
    v_mfma_f32_16x16x32_bf16 v[204:207], v[172:175], v[32:35], v[204:207]
    v_bitop3_b32 v42, v232, v200, v184 bitop3:0xca
    v_bitop3_b32 v46, v232, v201, v185 bitop3:0xca
    v_bitop3_b32 v50, v232, v202, v186 bitop3:0xca
    v_bitop3_b32 v54, v232, v203, v187 bitop3:0xca
    s_nop 3
    v_bitop3_b32 v43, v232, v204, v188 bitop3:0xca
    global_store_dwordx4 v4, v[40:43], s[36:37] sc1
    v_bitop3_b32 v47, v232, v205, v189 bitop3:0xca
    global_store_dwordx4 v5, v[44:47], s[36:37] sc1
    v_bitop3_b32 v51, v232, v206, v190 bitop3:0xca
    global_store_dwordx4 v6, v[48:51], s[36:37] sc1
    v_bitop3_b32 v55, v232, v207, v191 bitop3:0xca
    global_store_dwordx4 v7, v[52:55], s[36:37] sc1
    s_endpgm
L_slow:
    v_mov_b32 v21, 0
    v_mov_b32 v38, v26
    s_mov_b32 s10, 16
L_slow_r:
    v_sub_u32 v176, v28, v21
    v_sub_u32 v177, v29, v21
    v_sub_u32 v178, v30, v21
    v_sub_u32 v179, v31, v21
    v_sub_u32 v180, v32, v21
    v_sub_u32 v181, v33, v21
    v_sub_u32 v182, v34, v21
    v_sub_u32 v183, v35, v21
    v_max3_u32 v24, v176, v177, v178
    v_max3_u32 v24, v24, v179, v180
    v_max3_u32 v24, v24, v181, v182
    v_max_u32 v24, v24, v183
    ds_max_u32 v38, v24 offset:96
    s_mov_b64 exec, 1
    ds_add_u32 v26, v27 offset:40
    s_mov_b64 exec, -1
L_slow_s:
    ds_read_b32 v24, v26 offset:40
    ds_read_b32 v39, v38 offset:96
    s_waitcnt lgkmcnt(0)
    v_readfirstlane_b32 s11, v24
    s_nop 0
    s_cmp_ge_u32 s11, s10
    s_cbranch_scc1 L_slow_ok
    s_sub_u32 s55, s55, 1
    s_cbranch_scc0 L_slow_s
L_slow_ok:
    v_add_u32 v21, v21, v39
    v_alignbit_b32 v24, 1, v21, 5
    ds_write_b32 v38, v24 offset:64
    v_add_u32 v38, 4, v38
    s_add_u32 s10, s10, 16
    s_cmp_le_u32 s10, 128
    s_cbranch_scc1 L_slow_r
    ds_read_b32 v23, v17 offset:64
    ds_read_b32 v13, v18 offset:64
    s_add_u32 m0, s64, 150016
    s_waitcnt lgkmcnt(0)
    v_and_b32 v23, 0x7ff, v23
    v_mad_i32_i24 v23, v23, s63, v12
    global_load_lds_dwordx4 v23, s[4:5]
    s_add_u32 m0, s64, 153728
    v_and_b32 v22, 0x7ff, v13
    global_load_lds_dwordx4 v23, s[4:5] offset:512
    v_sub_u32 v22, 2047, v22
    s_cmp_lg_u32 s39, 0
    s_cbranch_scc1 L_nox9b
    s_mov_b32 m0, 157440
    s_nop 0
    global_load_lds_dwordx4 v23, s[4:5] offset:1024
    s_branch L_x3b
L_nox9b:
    v_lshlrev_b32 v24, 3, v22
    v_add_u32 v24, 16384, v24
    global_load_dword v25, v24, s[36:37] sc1
L_x3b:
    v_mov_b32 v36, 4
    s_waitcnt vmcnt(0)
    s_cmp_lg_u32 s39, 1
    s_cbranch_scc1 L_nostb
    ds_write_b32 v18, v25 offset:448
L_nostb:
    s_mov_b64 exec, 1
    ds_add_u32 v26, v36 offset:36
    s_mov_b64 exec, -1
    s_branch L_dgo
L_gu:
    s_add_u32 s53, s53, 12288
    v_mov_b32 v1, v76
    s_movk_i32 s55, 7
L_dma1:
    s_mov_b32 m0, s53
    s_add_u32 s42, s53, 73728
    global_load_lds_dwordx4 v1, s[26:27]
    s_mov_b32 m0, s42
    s_add_u32 s53, s53, 4096
    global_load_lds_dwordx4 v1, s[28:29]
    v_add_u32 v1, 294912, v1
    s_sub_u32 s55, s55, 1
    s_cmp_lg_u32 s55, 0
    s_cbranch_scc1 L_dma1
    v_lshrrev_b32 v12, 1, v2
    v_min_u32 v12, 8, v12
    v_mul_u32_u24 v12, 1056, v12
    v_and_b32 v13, 16, v3
    v_add_u32 v12, v12, v13
    v_add_u32 v12, 151040, v12
    v_mov_b32 v20, 0x3f803f80
    v_mov_b32 v21, v20
    v_mov_b32 v22, v20
    v_mov_b32 v23, v20
    ds_write_b128 v12, v[20:23]
    v_bfe_u32 v15, v0, 2, 2
    v_and_b32 v16, 3, v0
    v_lshl_add_u32 v17, v14, 3, v15
    v_bfe_u32 v18, v0, 3, 2
    v_xor_b32 v18, s51, v18
    v_lshlrev_b32 v18, 5, v18
    v_lshl_add_u32 v18, v16, 3, v18
    v_lshl_add_u32 v4, v17, 7, v18
    v_add_u32 v5, 36864, v4
    v_add_u32 v6, 73728, v4
    v_add_u32 v7, 110592, v4
    v_and_b32 v19, 6, v11
    v_xor_b32 v19, v19, v14
    v_lshlrev_b32 v19, 4, v19
    v_lshl_add_u32 v19, v11, 7, v19
    v_xor_b32 v20, 64, v19
    v_bfe_i32 v21, v0, 3, 1
    v_lshlrev_b32 v22, 2, v0
    v_xor_b32 v22, v22, v0
    v_and_b32 v22, 16, v22
    v_or_b32 v22, 1024, v22
    v_bfi_b32 v19, v21, v22, v19
    v_xor_b32 v22, 16, v22
    v_bfi_b32 v20, v21, v22, v20
    v_add_u32 v19, 150016, v19
    v_add_u32 v20, 150016, v20
    v_lshl_add_u32 v18, v11, 2, v26
    s_lshr_b32 s42, s51, 1
    s_lshl_b32 s42, s42, 10
    s_and_b32 s43, s51, 1
    s_lshl_b32 s43, s43, 3
    s_add_u32 s42, s42, s43
    s_add_u32 s42, s42, 147968
    v_add_u32 v27, s42, v3
    v_and_b32 v8, 9344, v21
    v_lshl_add_u32 v8, v11, 4, v8
    s_mul_i32 s42, s50, 18688
    s_add_u32 s42, s42, 74752
    v_add_u32 v8, s42, v8
    s_waitcnt vmcnt(4)
    s_barrier
    ds_read_b64_tr_b16 v[112:113], v4 offset:0
    ds_read_b64_tr_b16 v[114:115], v4 offset:512
    ds_read_b64_tr_b16 v[184:185], v6 offset:0
    ds_read_b64_tr_b16 v[186:187], v6 offset:512
    ds_read_b64_tr_b16 v[116:117], v4 offset:4096
    ds_read_b64_tr_b16 v[118:119], v4 offset:4608
    ds_read_b64_tr_b16 v[188:189], v6 offset:4096
    ds_read_b64_tr_b16 v[190:191], v6 offset:4608
    ds_read_b64_tr_b16 v[120:121], v4 offset:8192
    ds_read_b64_tr_b16 v[122:123], v4 offset:8704
    ds_read_b64_tr_b16 v[192:193], v6 offset:8192
    ds_read_b64_tr_b16 v[194:195], v6 offset:8704
    ds_read_b64_tr_b16 v[124:125], v4 offset:12288
    ds_read_b64_tr_b16 v[126:127], v4 offset:12800
    ds_read_b64_tr_b16 v[196:197], v6 offset:12288
    ds_read_b64_tr_b16 v[198:199], v6 offset:12800
    ds_read_b64_tr_b16 v[128:129], v4 offset:16384
    ds_read_b64_tr_b16 v[130:131], v4 offset:16896
    ds_read_b64_tr_b16 v[200:201], v6 offset:16384
    ds_read_b64_tr_b16 v[202:203], v6 offset:16896
    ds_read_b64_tr_b16 v[132:133], v4 offset:20480
    ds_read_b64_tr_b16 v[134:135], v4 offset:20992
    ds_read_b64_tr_b16 v[204:205], v6 offset:20480
    ds_read_b64_tr_b16 v[206:207], v6 offset:20992
    ds_read_b64_tr_b16 v[136:137], v4 offset:24576
    ds_read_b64_tr_b16 v[138:139], v4 offset:25088
    ds_read_b64_tr_b16 v[208:209], v6 offset:24576
    ds_read_b64_tr_b16 v[210:211], v6 offset:25088
    ds_read_b64_tr_b16 v[140:141], v4 offset:28672
    ds_read_b64_tr_b16 v[142:143], v4 offset:29184
    ds_read_b64_tr_b16 v[212:213], v6 offset:28672
    ds_read_b64_tr_b16 v[214:215], v6 offset:29184
    s_barrier
    s_movk_i32 s55, 6
L_dma4:
    s_mov_b32 m0, s53
    s_add_u32 s42, s53, 73728
    global_load_lds_dwordx4 v1, s[26:27]
    s_mov_b32 m0, s42
    s_add_u32 s53, s53, 4096
    global_load_lds_dwordx4 v1, s[28:29]
    v_add_u32 v1, 294912, v1
    s_waitcnt vmcnt(4)
    s_sub_u32 s55, s55, 1
    s_cmp_lg_u32 s55, 0
    s_cbranch_scc1 L_dma4
    s_mov_b32 s55, 262144
    v_mov_b32 v23, 0x100
    s_waitcnt vmcnt(0)
    s_barrier
    s_setprio 2
    s_add_u32 m0, s53, 0
    s_nop 0
    global_load_lds_dwordx4 v1, s[26:27]
    ds_read_b64_tr_b16 v[144:145], v4 offset:32768
    ds_read_b64_tr_b16 v[146:147], v4 offset:33280
    ds_read_b64_tr_b16 v[216:217], v6 offset:32768
    ds_read_b64_tr_b16 v[218:219], v6 offset:33280
    ds_read_b64_tr_b16 v[148:149], v5 offset:0
    ds_read_b64_tr_b16 v[150:151], v5 offset:512
    ds_read_b64_tr_b16 v[220:221], v7 offset:0
    ds_read_b64_tr_b16 v[222:223], v7 offset:512
    s_add_u32 m0, s53, 73728
    s_nop 0
    global_load_lds_dwordx4 v1, s[28:29]
    ds_read_b64_tr_b16 v[152:153], v5 offset:4096
    ds_read_b64_tr_b16 v[154:155], v5 offset:4608
    ds_read_b64_tr_b16 v[224:225], v7 offset:4096
    ds_read_b64_tr_b16 v[226:227], v7 offset:4608
    ds_read_b64_tr_b16 v[156:157], v5 offset:8192
    ds_read_b64_tr_b16 v[158:159], v5 offset:8704
    ds_read_b64_tr_b16 v[228:229], v7 offset:8192
    ds_read_b64_tr_b16 v[230:231], v7 offset:8704
    v_add_u32 v1, 294912, v1
    s_add_u32 m0, s53, 4096
    s_nop 0
    global_load_lds_dwordx4 v1, s[26:27]
    ds_read_b64_tr_b16 v[160:161], v5 offset:12288
    ds_read_b64_tr_b16 v[162:163], v5 offset:12800
    ds_read_b64_tr_b16 v[232:233], v7 offset:12288
    ds_read_b64_tr_b16 v[234:235], v7 offset:12800
    ds_read_b64_tr_b16 v[164:165], v5 offset:16384
    ds_read_b64_tr_b16 v[166:167], v5 offset:16896
    ds_read_b64_tr_b16 v[236:237], v7 offset:16384
    ds_read_b64_tr_b16 v[238:239], v7 offset:16896
    s_add_u32 m0, s53, 77824
    s_nop 0
    global_load_lds_dwordx4 v1, s[28:29]
    ds_read_b64_tr_b16 v[168:169], v5 offset:20480
    ds_read_b64_tr_b16 v[170:171], v5 offset:20992
    ds_read_b64_tr_b16 v[240:241], v7 offset:20480
    ds_read_b64_tr_b16 v[242:243], v7 offset:20992
    ds_read_b64_tr_b16 v[172:173], v5 offset:24576
    ds_read_b64_tr_b16 v[174:175], v5 offset:25088
    ds_read_b64_tr_b16 v[244:245], v7 offset:24576
    ds_read_b64_tr_b16 v[246:247], v7 offset:25088
    v_add_u32 v1, 294912, v1
    s_barrier
    s_waitcnt vmcnt(0)
    s_mov_b64 exec, 1
    ds_add_u32 v26, v23 offset:36
    s_mov_b64 exec, -1
L_s6:
    ds_read_b32 v24, v26 offset:36
    s_waitcnt lgkmcnt(0)
    v_readfirstlane_b32 s61, v24
    s_nop 0
    s_cmp_eq_u32 s61, 0x80410
    s_cbranch_scc1 L_s6_ok
    s_and_b32 s60, s61, 0xffff
    s_cmp_eq_u32 s60, 0x420
    s_cbranch_scc1 L_s6_ok
    s_sub_u32 s55, s55, 1
    s_cbranch_scc0 L_s6
L_s6_ok:
    ds_read_b128 v[40:43], v19 offset:0
    ds_read_b128 v[44:47], v20 offset:0
    ds_read_b128 v[48:51], v19 offset:1056
    ds_read_b128 v[52:55], v20 offset:1056
    ds_read_b128 v[56:59], v19 offset:2112
    ds_read_b128 v[60:63], v20 offset:2112
    s_waitcnt lgkmcnt(5)
    v_mfma_f32_16x16x32_bf16 v[28:31], v[112:115], v[40:43], 0
    ds_read_b128 v[64:67], v19 offset:3168
    v_mfma_f32_16x16x32_bf16 v[32:35], v[184:187], v[40:43], 0
    ds_read_b128 v[68:71], v20 offset:3168
    s_waitcnt lgkmcnt(5)
    v_mfma_f32_16x16x32_bf16 v[28:31], v[116:119], v[44:47], v[28:31]
    ds_read_b128 v[72:75], v19 offset:4224
    v_mfma_f32_16x16x32_bf16 v[32:35], v[188:191], v[44:47], v[32:35]
    ds_read_b128 v[76:79], v20 offset:4224
    v_mfma_f32_16x16x32_bf16 v[28:31], v[120:123], v[48:51], v[28:31]
    ds_read_b32 v25, v18 offset:448
    v_mfma_f32_16x16x32_bf16 v[32:35], v[192:195], v[48:51], v[32:35]
    ds_read_b32 v13, v18 offset:64
    s_waitcnt lgkmcnt(7)
    v_mfma_f32_16x16x32_bf16 v[28:31], v[124:127], v[52:55], v[28:31]
    ds_read_b128 v[80:83], v19 offset:5280
    v_mfma_f32_16x16x32_bf16 v[32:35], v[196:199], v[52:55], v[32:35]
    ds_read_b128 v[84:87], v20 offset:5280
    v_mfma_f32_16x16x32_bf16 v[28:31], v[128:131], v[56:59], v[28:31]
    ds_read_b128 v[88:91], v19 offset:6336
    v_mfma_f32_16x16x32_bf16 v[32:35], v[200:203], v[56:59], v[32:35]
    ds_read_b128 v[92:95], v20 offset:6336
    s_waitcnt lgkmcnt(8)
    v_mfma_f32_16x16x32_bf16 v[28:31], v[132:135], v[60:63], v[28:31]
    ds_read_b128 v[96:99], v19 offset:7392
    v_mfma_f32_16x16x32_bf16 v[28:31], v[136:139], v[64:67], v[28:31]
    ds_read_b128 v[100:103], v20 offset:7392
    v_mfma_f32_16x16x32_bf16 v[28:31], v[140:143], v[68:71], v[28:31]
    ds_read_b128 v[104:107], v19 offset:8448
    ds_read_b64_tr_b16 v[176:177], v5 offset:28672
    s_waitcnt lgkmcnt(7)
    v_mfma_f32_16x16x32_bf16 v[28:31], v[144:147], v[72:75], v[28:31]
    ds_read_b64_tr_b16 v[178:179], v5 offset:29184
    ds_read_b128 v[108:111], v20 offset:8448
    v_mfma_f32_16x16x32_bf16 v[28:31], v[148:151], v[76:79], v[28:31]
    ds_read_b64_tr_b16 v[180:181], v5 offset:32768
    ds_read_b64_tr_b16 v[182:183], v5 offset:33280
    v_mfma_f32_16x16x32_bf16 v[28:31], v[152:155], v[80:83], v[28:31]
    ds_read_b64_tr_b16 v[248:249], v7 offset:28672
    v_and_b32 v15, 0xffff0000, v25
    s_waitcnt lgkmcnt(9)
    v_mfma_f32_16x16x32_bf16 v[28:31], v[156:159], v[84:87], v[28:31]
    ds_read_b64_tr_b16 v[250:251], v7 offset:29184
    v_rcp_f32 v16, v15
    v_mfma_f32_16x16x32_bf16 v[28:31], v[160:163], v[88:91], v[28:31]
    ds_read_b64_tr_b16 v[252:253], v7 offset:32768
    v_lshlrev_b32 v12, 16, v25
    v_mfma_f32_16x16x32_bf16 v[28:31], v[164:167], v[92:95], v[28:31]
    ds_read_b64_tr_b16 v[254:255], v7 offset:33280
    v_xor_b32 v25, 0x80000000, v12
    s_waitcnt lgkmcnt(7)
    v_mfma_f32_16x16x32_bf16 v[28:31], v[168:171], v[96:99], v[28:31]
    v_mul_f32 v9, 0xbfb8aa3b, v16
    v_mul_f32 v10, v16, v16
    v_mfma_f32_16x16x32_bf16 v[28:31], v[172:175], v[100:103], v[28:31]
    v_mfma_f32_16x16x32_bf16 v[28:31], v[176:179], v[104:107], v[28:31]
    s_waitcnt lgkmcnt(4)
    v_mfma_f32_16x16x32_bf16 v[28:31], v[180:183], v[108:111], v[28:31]
    v_mfma_f32_16x16x32_bf16 v[32:35], v[204:207], v[60:63], v[32:35]
    v_mfma_f32_16x16x32_bf16 v[32:35], v[208:211], v[64:67], v[32:35]
    v_mfma_f32_16x16x32_bf16 v[32:35], v[212:215], v[68:71], v[32:35]
    v_mfma_f32_16x16x32_bf16 v[32:35], v[216:219], v[72:75], v[32:35]
    s_nop 3
    v_fmac_f32_dpp v28, v28, v25 row_newbcast:8 row_mask:0xf bank_mask:0xf
    v_fmac_f32_dpp v29, v29, v25 row_newbcast:8 row_mask:0xf bank_mask:0xf
    v_mfma_f32_16x16x32_bf16 v[32:35], v[220:223], v[76:79], v[32:35]
    v_fmac_f32_dpp v30, v30, v25 row_newbcast:8 row_mask:0xf bank_mask:0xf
    v_fmac_f32_dpp v31, v31, v25 row_newbcast:8 row_mask:0xf bank_mask:0xf
    v_mfma_f32_16x16x32_bf16 v[32:35], v[224:227], v[80:83], v[32:35]
    v_mul_f32 v36, v9, v28
    v_mul_f32 v37, v9, v29
    v_mfma_f32_16x16x32_bf16 v[32:35], v[228:231], v[84:87], v[32:35]
    v_mul_f32 v38, v9, v30
    v_mul_f32 v39, v9, v31
    v_mfma_f32_16x16x32_bf16 v[32:35], v[232:235], v[88:91], v[32:35]
    v_exp_f32 v36, v36
    v_exp_f32 v37, v37
    v_mfma_f32_16x16x32_bf16 v[32:35], v[236:239], v[92:95], v[32:35]
    v_exp_f32 v38, v38
    v_exp_f32 v39, v39
    v_mfma_f32_16x16x32_bf16 v[32:35], v[240:243], v[96:99], v[32:35]
    v_mul_f32 v28, v28, v10
    v_mul_f32 v29, v29, v10
    v_mfma_f32_16x16x32_bf16 v[32:35], v[244:247], v[100:103], v[32:35]
    v_mul_f32 v30, v30, v10
    v_mul_f32 v31, v31, v10
    s_waitcnt lgkmcnt(0)
    v_mfma_f32_16x16x32_bf16 v[32:35], v[248:251], v[104:107], v[32:35]
    v_add_f32 v36, 1.0, v36
    v_add_f32 v37, 1.0, v37
    v_mfma_f32_16x16x32_bf16 v[32:35], v[252:255], v[108:111], v[32:35]
    v_add_f32 v38, 1.0, v38
    v_add_f32 v39, 1.0, v39
    v_rcp_f32 v36, v36
    v_rcp_f32 v37, v37
    v_rcp_f32 v38, v38
    v_rcp_f32 v39, v39
    v_mul_f32 v28, v28, v36
    v_mul_f32 v29, v29, v37
    v_mul_f32 v30, v30, v38
    v_mul_f32 v31, v31, v39
    v_fmac_f32_dpp v32, v32, v25 row_newbcast:8 row_mask:0xf bank_mask:0xf
    v_fmac_f32_dpp v33, v33, v25 row_newbcast:8 row_mask:0xf bank_mask:0xf
    v_fmac_f32_dpp v34, v34, v25 row_newbcast:8 row_mask:0xf bank_mask:0xf
    v_fmac_f32_dpp v35, v35, v25 row_newbcast:8 row_mask:0xf bank_mask:0xf
    v_mul_f32 v28, v28, v32
    v_mul_f32 v29, v29, v33
    v_mul_f32 v30, v30, v34
    v_mul_f32 v31, v31, v35
    v_cvt_pk_bf16_f32 v28, v28, v29
    v_cvt_pk_bf16_f32 v29, v30, v31
    ds_write_b64 v27, v[28:29]
    s_waitcnt lgkmcnt(0)
    s_barrier
    s_cmp_lg_u32 s39, 4
    s_cbranch_scc1 L_gu_end
    v_lshlrev_b32 v36, 5, v13
    v_not_b32 v37, v36
    v_ashrrev_i32 v38, 31, v37
    v_or_b32 v38, 0x80000000, v38
    v_xor_b32 v36, v36, v38
    v_and_b32 v36, 0xffff0000, v36
    v_mul_f32 v36, 0xbfb8aa3b, v36
    v_exp_f32 v36, v36
    v_bfe_u32 v4, v37, 5, 11
    v_mov_b32 v6, v12
    v_mov_b32 v7, v15
    v_add_f32 v36, 1.0, v36
    v_rcp_f32 v5, v36
    v_lshl_or_b32 v4, v4, 8, s45
    s_mov_b64 exec, 0xffff
    global_store_dwordx4 v8, v[4:7], s[36:37] sc1
    s_cmp_lg_u32 s50, 0
    s_cbranch_scc1 L_gu_end
    v_mov_b32 v9, 0
    v_mov_b32 v10, s38
    s_mov_b64 exec, 1
    global_store_dword v9, v10, s[36:37]
L_gu_end:
    s_endpgm
L_end:
    s_endpgm
.section .rodata,"a"
.p2align 6
.amdhsa_kernel recurrent_scan__ssm_conv_s4__moe_arch_mod__prompt_kernel
  .amdhsa_next_free_vgpr 256
  .amdhsa_next_free_sgpr 102
  .amdhsa_accum_offset 256
  .amdhsa_group_segment_fixed_size 0
  .amdhsa_kernarg_size 136
  .amdhsa_user_sgpr_count 2
  .amdhsa_user_sgpr_kernarg_segment_ptr 1
  .amdhsa_system_sgpr_workgroup_id_x 1
  .amdhsa_float_denorm_mode_32 3
.end_amdhsa_kernel
```

```asm
; @launch grid=(256,1,1) block=(512,1,1) lds=163840
.amdgcn_target "amdgcn-amd-amdhsa--gfx950"
.text
.globl recurrent_scan__ssm_conv_s4__moe_arch_mod__prompt_kernel
.p2align 8
.type recurrent_scan__ssm_conv_s4__moe_arch_mod__prompt_kernel,@function
recurrent_scan__ssm_conv_s4__moe_arch_mod__prompt_kernel:
    s_load_dwordx16 s[4:19], s[0:1], 0
    s_load_dwordx16 s[20:35], s[0:1], 64
    s_load_dwordx2 s[36:37], s[0:1], 128
    s_cmp_ge_u32 s2, 256
    s_cbranch_scc1 L_end
    s_lshr_b32 s41, s2, 3
    s_getpc_b64 s[42:43]
L_pc:
    s_mul_i32 s47, s41, 768
    s_add_u32 s42, s42, s47
    s_addc_u32 s43, s43, 0
    v_lshlrev_b32 v4, 7, v0
    v_mov_b32 v5, s43
    v_add_co_u32 v4, vcc, s42, v4
    v_lshrrev_b32 v1, 6, v0
    v_and_b32 v2, 63, v0
    v_addc_co_u32 v5, vcc, 0, v5, vcc
    s_sub_u32 s47, L_last - L_pc - 4, s47
    s_ashr_i32 s47, s47, 7
    s_min_i32 s47, s47, 5
    v_cmp_ge_i32 vcc, s47, v0
    s_nop 0
    s_and_saveexec_b64 s[48:49], vcc
    s_cbranch_execz L_nopf
    global_load_dword v255, v[4:5], off
L_nopf:
    s_mov_b64 exec, -1
    v_readfirstlane_b32 s39, v1
    s_and_b32 s40, s2, 7
    s_mul_i32 s42, s2, 9216
    v_lshlrev_b32 v3, 4, v2
    v_lshlrev_b32 v4, 1, v2
    v_mul_u32_u24 v5, 1152, v1
    v_add3_u32 v6, v5, v3, s42
    v_add3_u32 v7, v5, v4, s42
    s_waitcnt lgkmcnt(0)
    global_load_dwordx4 v[12:15], v6, s[4:5]
    global_load_ushort v16, v7, s[4:5] offset:1024
    s_load_dword s38, s[36:37], 0
    global_load_dwordx4 v[20:23], v3, s[24:25]
    global_load_ushort v24, v4, s[24:25] offset:1024
    s_and_b32 s51, s39, 3
    s_lshr_b32 s52, s39, 2
    s_cmp_lt_u32 s41, 18
    s_cbranch_scc1 L_conv_pre
    s_cmp_lt_u32 s41, 27
    s_cbranch_scc1 L_ffn_pre
    s_sub_u32 s53, s41, 27
    s_and_b32 s58, s39, 1
    s_lshr_b32 s43, s39, 1
    s_mul_i32 s42, s43, 320
    s_add_u32 s42, s42, 1152
    s_cmp_eq_u32 s43, 0
    s_cmovk_i32 s42, 1152
    s_cmp_eq_u32 s43, 1
    s_cselect_b32 s48, 1, 0
    s_mul_i32 s59, s58, 320
    s_cmp_eq_u32 s43, 3
    s_cselect_b32 s42, s59, s42
    s_cmovk_i32 s58, 2
    s_lshl_b32 s53, s53, 6
    s_add_u32 s42, s42, s53
    s_mul_i32 s43, s40, 1152
    s_add_u32 s43, s43, 884736
    s_mul_i32 s59, s40, 663552
    s_cmp_eq_u32 s58, 0
    s_cselect_b32 s56, s26, s28
    s_cselect_b32 s57, s27, s29
    s_cmp_eq_u32 s58, 2
    s_cselect_b32 s56, s30, s56
    s_cselect_b32 s57, s31, s57
    s_cselect_b32 s43, s59, s43
    s_movk_i32 s58, 128
    s_movk_i32 s59, 8064
    s_movk_i32 s60, 4319
    s_cmov_b32 s58, 73728
    s_cmov_b32 s59, -663424
    s_cmovk_i32 s60, 5183
    v_add_u32 v76, s42, v2
    v_min_u32 v76, s60, v76
    v_mul_u32_u24 v63, 7282, v76
    v_lshrrev_b32 v63, 16, v63
    v_mul_u32_u24 v76, s58, v76
    v_mad_i32_i24 v76, v63, s59, v76
    v_add_u32 v76, s43, v76
    s_mov_b32 s49, 0
    s_branch L_lnp
L_ffn_pre:
    s_sub_u32 s54, s41, 18
    s_mul_i32 s50, s40, 9
    s_add_u32 s50, s50, s54
    v_bfe_u32 v76, v0, 3, 5
    v_bfe_u32 v61, v0, 4, 1
    v_bfe_u32 v62, v0, 6, 1
    v_lshl_add_u32 v61, v62, 1, v61
    v_lshlrev_b32 v61, 1, v61
    v_and_b32 v62, 7, v0
    v_xor_b32 v61, v61, v62
    v_mul_u32_u24 v76, 9216, v76
    v_lshlrev_b32 v61, 4, v61
    s_lshl_b32 s42, s50, 7
    v_add3_u32 v76, v76, v61, s42
    s_lshl_b32 s53, s51, 10
    s_cmp_eq_u32 s52, 0
    s_cselect_b32 s56, s26, s28
    s_cselect_b32 s57, s27, s29
    s_cselect_b32 s42, 0, 73728
    s_add_u32 s42, s53, s42
    s_mov_b32 s49, s42
    v_mov_b32 v62, 0
    v_mov_b32 v63, 0
    v_lshrrev_b32 v61, 1, v3
    v_add_u32 v61, 147456, v61
    ds_write_b64 v61, v[62:63]
    s_mov_b32 s47, 3
    s_mov_b32 s48, 0
    s_branch L_lnp
L_conv_pre:
    s_mul_i32 s50, s40, 18
    s_add_u32 s50, s50, s41
    s_lshl_b32 s53, s50, 2
    s_add_u32 s53, s53, s51
    s_lshl_b32 s42, s53, 8
    s_lshl_b32 s43, s52, 7
    s_add_u32 s42, s42, s43
    v_add_u32 v60, s42, v4
    s_lshl_b32 s54, s50, 3
    s_lshl_b32 s42, s53, 1
    v_mov_b32 v61, s42
    v_mov_b64 v[64:65], 0
    v_mov_b64 v[66:67], 0
    v_mov_b64 v[68:69], 0
    v_mov_b64 v[70:71], 0
    s_barrier
    global_load_short_d16_hi v70, v61, s[18:19]
    global_load_short_d16_hi v64, v60, s[6:7]
    global_load_short_d16_hi v65, v60, s[8:9]
    global_load_short_d16_hi v66, v60, s[10:11]
    global_load_short_d16_hi v67, v60, s[12:13]
    global_load_short_d16_hi v68, v60, s[14:15]
    global_load_short_d16_hi v69, v60, s[16:17]
    global_load_short_d16_hi v71, v61, s[20:21]
    s_lshr_b32 s42, s51, 1
    s_mul_i32 s42, s42, 2112
    s_and_b32 s58, s51, 1
    s_mul_i32 s43, s51, 1152
    s_add_u32 s43, s43, 576
    s_cmp_eq_u32 s52, 0
    s_cmovk_i32 s42, 3168
    s_lshl_b32 s43, s41, 6
    s_add_u32 s42, s42, s43
    s_mul_i32 s43, s40, 1152
    s_add_u32 s43, s43, 884736
    s_mul_i32 s59, s40, 663552
    s_cmp_eq_u32 s58, 0
    s_cselect_b32 s56, s26, s28
    s_cselect_b32 s57, s27, s29
    s_cmp_eq_u32 s58, 2
    s_cselect_b32 s56, s30, s56
    s_cselect_b32 s57, s31, s57
    s_cselect_b32 s43, s59, s43
    s_movk_i32 s58, 128
    s_movk_i32 s59, 8064
    s_movk_i32 s60, 4319
    s_cmov_b32 s58, 73728
    s_cmov_b32 s59, -663424
    s_cmovk_i32 s60, 5183
    v_add_u32 v76, s42, v2
    v_min_u32 v76, s60, v76
    v_mul_u32_u24 v63, 7282, v76
    v_lshrrev_b32 v63, 16, v63
    v_mul_u32_u24 v76, s58, v76
    v_mad_i32_i24 v76, v63, s59, v76
    v_add_u32 v76, s43, v76
    s_lshr_b32 s47, s39, 1
    s_mul_i32 s55, s51, 33792
    s_lshl_b32 s42, s52, 8
    s_add_u32 m0, s55, s42
    s_mul_i32 s63, s51, 4640
    s_add_u32 s63, s63, 135168
    v_mov_b64 v[84:85], 0
    v_mov_b64 v[86:87], 0
    s_cmp_eq_u32 s52, 0
    s_cbranch_scc1 L_cp_m
    s_setprio 1
    v_min_u32 v83, 29, v2
    v_lshl_add_u32 v83, v83, 4, s63
    ds_write_b128 v83, v[84:87]
    v_and_b32 v88, 0x70, v3
    v_add_u32 v88, 153728, v88
    ds_write_b128 v88, v[84:87]
    s_branch L_cp_e
L_cp_m:
    v_and_b32 v8, 15, v0
    v_bfe_u32 v9, v0, 4, 2
    v_and_b32 v10, 31, v0
    v_and_b32 v11, 32, v0
    v_mul_u32_u24 v78, 528, v10
    v_lshl_add_u32 v78, v11, 3, v78
    v_add_u32 v78, s55, v78
    v_lshrrev_b32 v11, 1, v11
    v_lshl_add_u32 v10, v10, 5, v11
    s_add_u32 s42, s55, 1072
    v_sub_u32 v81, s42, v10
    v_lshrrev_b32 v77, 2, v10
    s_add_u32 s42, s55, 5564
    v_sub_u32 v77, s42, v77
    v_bfe_i32 v79, v0, 4, 1
    v_sub_u32 v80, 495, v10
    v_ashrrev_i32 v80, 31, v80
    v_sub_u32 v82, 1007, v10
    v_ashrrev_i32 v82, 31, v82
    v_bfe_u32 v10, v0, 3, 2
    v_and_b32 v11, 7, v0
    v_mul_u32_u24 v73, 1216, v10
    v_and_b32 v83, 4, v0
    v_lshl_add_u32 v83, v83, 4, v11
    v_lshl_add_u32 v83, v83, 4, v73
    v_lshlrev_b32 v72, 4, v10
    v_add_u32 v72, 5120, v72
    v_sub_u32 v74, 5, v11
    v_ashrrev_i32 v74, 31, v74
    v_bfi_b32 v83, v74, v72, v83
    v_and_b32 v72, 8, v0
    v_mad_u32_u24 v72, v72, 3, v11
    v_lshlrev_b32 v72, 4, v72
    v_add_u32 v72, 5184, v72
    v_bfe_i32 v74, v0, 5, 1
    v_bfi_b32 v83, v74, v72, v83
    v_add_u32 v83, s55, v83
    v_sub_u32 v74, 4, v11
    v_ashrrev_i32 v74, 31, v74
    v_add_u32 v72, 507, v11
    v_min_u32 v75, 2, v11
    v_bfi_b32 v74, v74, v72, v75
    v_sub_u32 v74, v74, v10
    v_lshl_add_u32 v73, v74, 1, v73
    v_min_u32 v74, 1, v10
    v_lshl_add_u32 v73, v74, 3, v73
    s_add_u32 s42, s55, 58
    v_add_u32 v73, s42, v73
    v_max_u32 v72, 4, v11
    v_mul_u32_u24 v72, 0x202, v72
    v_add_u32 v72, 1284, v72
    v_and_b32 v72, 0x707, v72
L_cp_e:
L_clnp:
    s_mul_i32 s43, s39, 1216
    s_add_u32 s43, s43, 154048
    v_add_u32 v52, s43, v3
    v_add_u32 v53, s43, v4
    s_lshl_b32 s43, s39, 3
    s_add_u32 s43, s43, 163776
    v_mov_b32 v54, s43
    v_bfe_u32 v55, v0, 2, 2
    v_mul_u32_u24 v55, 1216, v55
    v_and_b32 v56, 3, v0
    v_lshl_add_u32 v55, v56, 3, v55
    v_lshrrev_b32 v56, 4, v0
    v_lshl_add_u32 v55, v56, 5, v55
    v_add_u32 v55, 154048, v55
    v_lshrrev_b32 v56, 3, v0
    v_lshlrev_b32 v56, 15, v56
    v_and_b32 v57, 112, v3
    s_lshl_b32 s43, s2, 7
    s_add_u32 s43, s43, 2097152
    v_add3_u32 v56, v56, v57, s43
    v_mov_b32 v40, 0
    v_mov_b32 v41, 0
    v_mov_b32 v42, 0
    v_mov_b32 v43, 0
    v_mov_b32 v44, 0x3ae38e39
    v_mov_b32 v38, 0xbfffbfff
    v_mov_b32 v37, 0xffff
    s_lshl_b32 s58, s2, 3
    s_add_u32 s58, s58, s39
    s_xor_b32 s58, s58, 0x7ff
    s_lshl_b32 s58, s58, 5
    s_waitcnt lgkmcnt(0)
    s_add_u32 s38, s38, 0x9e370001
    s_lshr_b32 s44, s38, 16
    s_and_b32 s45, s38, 0xff
    s_and_b32 s46, s38, 0xfb
    s_bitcmp0_b32 s38, 0
    s_cselect_b32 s43, 4, 0
    s_or_b32 s46, s46, s43
    s_bitcmp1_b32 s46, s39
    s_cselect_b32 s43, 0x40004000, 0
    v_mov_b32 v39, s43
    s_xor_b32 s58, s58, s44
    v_mov_b32 v57, s58
    s_mov_b32 s42, 0x3f803f80
    s_cmp_eq_u32 s47, 2
    s_cbranch_scc0 L_clw
    global_load_dword v1, v76, s[56:57]
    s_waitcnt vmcnt(9)
    s_branch L_cln
L_clw:
    s_waitcnt vmcnt(8)
L_cln:
    v_dot2c_f32_bf16 v40, s42, v12
    v_dot2c_f32_bf16 v41, v12, v12
    v_dot2c_f32_bf16 v42, v12, v20
    v_dot2c_f32_bf16 v43, s42, v20
    v_dot2c_f32_bf16 v40, s42, v13
    v_dot2c_f32_bf16 v41, v13, v13
    v_dot2c_f32_bf16 v42, v13, v21
    v_dot2c_f32_bf16 v43, s42, v21
    v_dot2c_f32_bf16 v40, s42, v14
    v_dot2c_f32_bf16 v41, v14, v14
    v_dot2c_f32_bf16 v42, v14, v22
    v_dot2c_f32_bf16 v43, s42, v22
    v_dot2c_f32_bf16 v40, s42, v15
    v_dot2c_f32_bf16 v41, v15, v15
    v_dot2c_f32_bf16 v42, v15, v23
    v_dot2c_f32_bf16 v43, s42, v23
    v_dot2c_f32_bf16 v40, s42, v16
    v_dot2c_f32_bf16 v41, v16, v16
    v_dot2c_f32_bf16 v42, v16, v24
    v_dot2c_f32_bf16 v43, s42, v24
    v_lshlrev_b32 v36, 16, v16
    v_lshlrev_b32 v28, 16, v12
    v_and_b32 v29, 0xffff0000, v12
    v_permlane32_swap_b32 v40, v42
    v_permlane32_swap_b32 v41, v43
    v_add_f32 v40, v40, v42
    v_add_f32 v41, v41, v43
    v_lshlrev_b32 v30, 16, v13
    v_and_b32 v31, 0xffff0000, v13
    v_permlane16_swap_b32 v40, v41
    v_add_f32 v40, v40, v41
    v_lshlrev_b32 v32, 16, v14
    v_and_b32 v33, 0xffff0000, v14
    v_add_f32_dpp v40, v40, v40 row_ror:8 row_mask:0xf bank_mask:0xf
    v_lshlrev_b32 v34, 16, v15
    v_and_b32 v35, 0xffff0000, v15
    v_add_f32_dpp v40, v40, v40 row_ror:4 row_mask:0xf bank_mask:0xf
    s_nop 1
    v_add_f32_dpp v40, v40, v40 row_ror:2 row_mask:0xf bank_mask:0xf
    s_nop 1
    v_add_f32_dpp v40, v40, v40 row_ror:1 row_mask:0xf bank_mask:0xf
    s_nop 0
    v_readlane_b32 s58, v40, 0
    v_readlane_b32 s59, v40, 16
    v_readlane_b32 s60, v40, 32
    v_readlane_b32 s61, v40, 48
    v_mul_f32 v40, s58, v44
    v_mul_f32 v41, s59, v44
    v_fma_f32 v41, -v40, v40, v41
    v_max_f32 v41, 0, v41
    v_cvt_pk_bf16_f32 v44, v41, v40
    v_lshlrev_b32 v41, 16, v44
    v_add_f32 v41, 0x3727c5ac, v41
    v_cvt_pk_bf16_f32 v41, v41, v41
    v_and_b32 v41, 0xffff0000, v41
    v_mul_f32 v41, 0x44800000, v41
    v_sqrt_f32 v41, v41
    v_and_b32 v49, 0xffff0000, v44
    v_cvt_pk_bf16_f32 v50, v49, v41
    v_and_b32 v41, 0xffff0000, v50
    v_rcp_f32 v46, v41
    v_mul_f32 v42, s61, v49
    v_mul_f32 v47, v49, v46
    v_fma_f32 v28, v28, v46, -v47
    v_fma_f32 v29, v29, v46, -v47
    v_fma_f32 v30, v30, v46, -v47
    v_fma_f32 v31, v31, v46, -v47
    v_fma_f32 v32, v32, v46, -v47
    v_fma_f32 v33, v33, v46, -v47
    v_fma_f32 v34, v34, v46, -v47
    v_fma_f32 v35, v35, v46, -v47
    v_fma_f32 v36, v36, v46, -v47
    v_cvt_pk_bf16_f32 v28, v28, v29
    v_cvt_pk_bf16_f32 v29, v30, v31
    v_cvt_pk_bf16_f32 v30, v32, v33
    v_cvt_pk_bf16_f32 v31, v34, v35
    v_cvt_pk_bf16_f32 v32, v36, v36
    v_bitop3_b32 v28, v28, v38, v39 bitop3:0xea
    v_bitop3_b32 v29, v29, v38, v39 bitop3:0xea
    v_bitop3_b32 v30, v30, v38, v39 bitop3:0xea
    v_bitop3_b32 v31, v31, v38, v39 bitop3:0xea
    v_bitop3_b32 v32, v32, v38, v39 bitop3:0xea
    ds_write_b128 v52, v[28:31]
    ds_write_b16 v53, v32 offset:1024
    v_sub_f32 v42, s60, v42
    v_mul_f32 v42, 0x42000000, v42
    v_mul_f32 v42, v42, v46
    v_cvt_pk_bf16_f32 v42, v42, v42
    v_ashrrev_i32 v43, 31, v42
    v_or_b32 v43, 0x80000000, v43
    v_xor_b32 v42, v42, v43
    v_bitop3_b32 v51, v37, v57, v42 bitop3:0xca
    s_mov_b64 exec, 1
    ds_write_b64 v54, v[50:51]
    s_mov_b64 exec, -1
    s_waitcnt lgkmcnt(0)
    s_barrier
    s_cmp_eq_u32 s39, 1
    s_cbranch_scc1 L_cln_stat
    ds_read_b64_tr_b16 v[28:29], v55
    ds_read_b64_tr_b16 v[30:31], v55 offset:4864
    s_cmp_eq_u32 s39, 0
    s_cbranch_scc0 L_cln_st
    ds_read_b64_tr_b16 v[32:33], v55 offset:1024
    ds_read_b64_tr_b16 v[34:35], v55 offset:5888
    v_add_u32 v38, 2097152, v56
    s_waitcnt lgkmcnt(0)
    global_store_dwordx4 v38, v[32:35], s[36:37] sc1
    s_branch L_cln_st
L_cln_stat:
    v_and_b32 v41, 0x30, v3
    v_add_u32 v40, 163776, v41
    ds_read_b128 v[48:51], v40
    ds_read_b64_tr_b16 v[28:29], v55
    ds_read_b64_tr_b16 v[30:31], v55 offset:4864
    s_lshl_b32 s43, s2, 6
    s_add_u32 s43, s43, 16384
    v_add_u32 v41, s43, v41
    s_mov_b64 exec, 15
    s_waitcnt lgkmcnt(2)
    global_store_dwordx4 v41, v[48:51], s[36:37] sc1
    s_mov_b64 exec, -1
L_cln_st:
    s_waitcnt lgkmcnt(0)
    global_store_dwordx4 v56, v[28:31], s[36:37] sc1
    s_waitcnt vmcnt(2)
    s_cmp_eq_u32 s47, 3
    s_cbranch_scc0 L_ct1
    global_load_dword v1, v76, s[56:57]
L_ct1:
    v_mul_f32 v70, 0x3fb8aa3b, v70
    v_exp_f32 v70, v70
    v_mov_b32 v34, 0x3f80
    ds_write_addtid_b32 v34
    v_cvt_pk_bf16_f32 v70, v70, v70
    v_and_b32 v70, 0xffff0000, v70
    v_mul_f32 v64, v70, v64
    v_mul_f32 v65, v70, v65
    v_mul_f32 v70, 0x44800000, v70
    v_mul_f32 v64, 0x3fb8aa3b, v64
    v_mul_f32 v65, 0x3e22f983, v65
    v_mul_f32 v66, v70, v66
    v_mul_f32 v67, v70, v67
    v_mul_f32 v13, 0x41800000, v64
    v_mul_f32 v17, 0x41800000, v65
    v_mul_f32 v14, 0x44000000, v64
    v_mul_f32 v18, 0x44000000, v65
    v_exp_f32 v12, v64
    v_fract_f32 v16, v65
    v_exp_f32 v13, v13
    v_fract_f32 v17, v17
    v_exp_f32 v14, v14
    v_fract_f32 v18, v18
    v_pk_mul_f32 v[20:21], v[68:69], v[66:67] op_sel:[0,0] op_sel_hi:[0,1] neg_hi:[0,1]
    v_pk_fma_f32 v[90:91], v[68:69], v[66:67], v[20:21] op_sel:[1,1,0] op_sel_hi:[1,0,1] neg_lo:[0,1,0] neg_hi:[0,1,0]
    v_cos_f32 v22, v16
    v_sin_f32 v23, v16
    v_cos_f32 v24, v17
    v_sin_f32 v25, v17
    v_cos_f32 v26, v18
    v_sin_f32 v27, v18
    v_cvt_pk_bf16_f32 v35, v90, v91
    ds_write_addtid_b32 v35 offset:16896
    v_mul_f32 v22, v12, v22
    v_mul_f32 v23, -v12, v23
    v_mul_f32 v24, v13, v24
    v_mul_f32 v25, v13, v25
    v_mul_f32 v26, v14, v26
    v_mul_f32 v27, -v14, v27
    v_cvt_pk_bf16_f32 v36, v24, v25
    ds_write_addtid_b32 v36 offset:528
L_cs2:
    v_pk_mul_f32 v[30:31], v[24:25], v[24:25] op_sel:[0,0] op_sel_hi:[0,1]
    v_pk_fma_f32 v[28:29], v[24:25], v[24:25], v[30:31] op_sel:[1,1,0] op_sel_hi:[1,0,1] neg_lo:[0,1,0]
    v_cvt_pk_bf16_f32 v34, v28, v29
    ds_write_addtid_b32 v34 offset:1056
    v_pk_mul_f32 v[32:33], v[90:91], v[22:23] op_sel:[0,0] op_sel_hi:[0,1]
    v_pk_fma_f32 v[92:93], v[90:91], v[22:23], v[32:33] op_sel:[1,1,0] op_sel_hi:[1,0,1] neg_lo:[0,1,0]
    v_cvt_pk_bf16_f32 v35, v92, v93
    ds_write_addtid_b32 v35 offset:17424
    v_pk_mul_f32 v[30:31], v[28:29], v[24:25] op_sel:[0,0] op_sel_hi:[0,1]
    v_pk_fma_f32 v[28:29], v[28:29], v[24:25], v[30:31] op_sel:[1,1,0] op_sel_hi:[1,0,1] neg_lo:[0,1,0]
    v_cvt_pk_bf16_f32 v36, v28, v29
    ds_write_addtid_b32 v36 offset:1584
    v_pk_mul_f32 v[32:33], v[92:93], v[22:23] op_sel:[0,0] op_sel_hi:[0,1]
    v_pk_fma_f32 v[94:95], v[92:93], v[22:23], v[32:33] op_sel:[1,1,0] op_sel_hi:[1,0,1] neg_lo:[0,1,0]
    v_cvt_pk_bf16_f32 v37, v94, v95
    ds_write_addtid_b32 v37 offset:17952
    v_pk_mul_f32 v[30:31], v[28:29], v[24:25] op_sel:[0,0] op_sel_hi:[0,1]
    v_pk_fma_f32 v[28:29], v[28:29], v[24:25], v[30:31] op_sel:[1,1,0] op_sel_hi:[1,0,1] neg_lo:[0,1,0]
    v_cvt_pk_bf16_f32 v34, v28, v29
    ds_write_addtid_b32 v34 offset:2112
    v_pk_mul_f32 v[32:33], v[94:95], v[22:23] op_sel:[0,0] op_sel_hi:[0,1]
    v_pk_fma_f32 v[96:97], v[94:95], v[22:23], v[32:33] op_sel:[1,1,0] op_sel_hi:[1,0,1] neg_lo:[0,1,0]
    v_cvt_pk_bf16_f32 v35, v96, v97
    ds_write_addtid_b32 v35 offset:18480
    v_pk_mul_f32 v[30:31], v[28:29], v[24:25] op_sel:[0,0] op_sel_hi:[0,1]
    v_pk_fma_f32 v[28:29], v[28:29], v[24:25], v[30:31] op_sel:[1,1,0] op_sel_hi:[1,0,1] neg_lo:[0,1,0]
    v_cvt_pk_bf16_f32 v36, v28, v29
    ds_write_addtid_b32 v36 offset:2640
    v_pk_mul_f32 v[32:33], v[96:97], v[22:23] op_sel:[0,0] op_sel_hi:[0,1]
    v_pk_fma_f32 v[98:99], v[96:97], v[22:23], v[32:33] op_sel:[1,1,0] op_sel_hi:[1,0,1] neg_lo:[0,1,0]
    v_cvt_pk_bf16_f32 v37, v98, v99
    ds_write_addtid_b32 v37 offset:21120
    v_pk_mul_f32 v[30:31], v[28:29], v[24:25] op_sel:[0,0] op_sel_hi:[0,1]
    v_pk_fma_f32 v[28:29], v[28:29], v[24:25], v[30:31] op_sel:[1,1,0] op_sel_hi:[1,0,1] neg_lo:[0,1,0]
    v_cvt_pk_bf16_f32 v34, v28, v29
    ds_write_addtid_b32 v34 offset:3168
    v_pk_mul_f32 v[32:33], v[98:99], v[22:23] op_sel:[0,0] op_sel_hi:[0,1]
    v_pk_fma_f32 v[100:101], v[98:99], v[22:23], v[32:33] op_sel:[1,1,0] op_sel_hi:[1,0,1] neg_lo:[0,1,0]
    v_cvt_pk_bf16_f32 v35, v100, v101
    ds_write_addtid_b32 v35 offset:21648
    v_pk_mul_f32 v[30:31], v[28:29], v[24:25] op_sel:[0,0] op_sel_hi:[0,1]
    v_pk_fma_f32 v[28:29], v[28:29], v[24:25], v[30:31] op_sel:[1,1,0] op_sel_hi:[1,0,1] neg_lo:[0,1,0]
    v_cvt_pk_bf16_f32 v36, v28, v29
    ds_write_addtid_b32 v36 offset:3696
    v_pk_mul_f32 v[32:33], v[100:101], v[22:23] op_sel:[0,0] op_sel_hi:[0,1]
    v_pk_fma_f32 v[102:103], v[100:101], v[22:23], v[32:33] op_sel:[1,1,0] op_sel_hi:[1,0,1] neg_lo:[0,1,0]
    v_cvt_pk_bf16_f32 v37, v102, v103
    ds_write_addtid_b32 v37 offset:22176
    v_pk_mul_f32 v[30:31], v[28:29], v[24:25] op_sel:[0,0] op_sel_hi:[0,1]
    v_pk_fma_f32 v[28:29], v[28:29], v[24:25], v[30:31] op_sel:[1,1,0] op_sel_hi:[1,0,1] neg_lo:[0,1,0]
    v_cvt_pk_bf16_f32 v34, v28, v29
    ds_write_addtid_b32 v34 offset:4224
    v_pk_mul_f32 v[32:33], v[102:103], v[22:23] op_sel:[0,0] op_sel_hi:[0,1]
    v_pk_fma_f32 v[104:105], v[102:103], v[22:23], v[32:33] op_sel:[1,1,0] op_sel_hi:[1,0,1] neg_lo:[0,1,0]
    v_cvt_pk_bf16_f32 v35, v104, v105
    ds_write_addtid_b32 v35 offset:22704
    v_pk_mul_f32 v[30:31], v[28:29], v[24:25] op_sel:[0,0] op_sel_hi:[0,1]
    v_pk_fma_f32 v[28:29], v[28:29], v[24:25], v[30:31] op_sel:[1,1,0] op_sel_hi:[1,0,1] neg_lo:[0,1,0]
    v_cvt_pk_bf16_f32 v36, v28, v29
    ds_write_addtid_b32 v36 offset:4752
    v_pk_mul_f32 v[32:33], v[104:105], v[22:23] op_sel:[0,0] op_sel_hi:[0,1]
    v_pk_fma_f32 v[106:107], v[104:105], v[22:23], v[32:33] op_sel:[1,1,0] op_sel_hi:[1,0,1] neg_lo:[0,1,0]
    v_cvt_pk_bf16_f32 v12, v106, v107
    ds_write_addtid_b32 v12 offset:19008
    v_pk_mul_f32 v[30:31], v[28:29], v[24:25] op_sel:[0,0] op_sel_hi:[0,1]
    v_pk_fma_f32 v[28:29], v[28:29], v[24:25], v[30:31] op_sel:[1,1,0] op_sel_hi:[1,0,1] neg_lo:[0,1,0]
    v_cvt_pk_bf16_f32 v34, v28, v29
    ds_write_addtid_b32 v34 offset:5280
    v_pk_mul_f32 v[32:33], v[106:107], v[22:23] op_sel:[0,0] op_sel_hi:[0,1]
    v_pk_fma_f32 v[108:109], v[106:107], v[22:23], v[32:33] op_sel:[1,1,0] op_sel_hi:[1,0,1] neg_lo:[0,1,0]
    v_cvt_pk_bf16_f32 v13, v108, v109
    ds_write_addtid_b32 v13 offset:19536
    v_pk_mul_f32 v[30:31], v[28:29], v[24:25] op_sel:[0,0] op_sel_hi:[0,1]
    v_pk_fma_f32 v[28:29], v[28:29], v[24:25], v[30:31] op_sel:[1,1,0] op_sel_hi:[1,0,1] neg_lo:[0,1,0]
    v_cvt_pk_bf16_f32 v36, v28, v29
    ds_write_addtid_b32 v36 offset:5808
    v_pk_mul_f32 v[32:33], v[108:109], v[22:23] op_sel:[0,0] op_sel_hi:[0,1]
    v_pk_fma_f32 v[110:111], v[108:109], v[22:23], v[32:33] op_sel:[1,1,0] op_sel_hi:[1,0,1] neg_lo:[0,1,0]
    v_cvt_pk_bf16_f32 v14, v110, v111
    ds_write_addtid_b32 v14 offset:20064
    v_pk_mul_f32 v[30:31], v[28:29], v[24:25] op_sel:[0,0] op_sel_hi:[0,1]
    v_pk_fma_f32 v[28:29], v[28:29], v[24:25], v[30:31] op_sel:[1,1,0] op_sel_hi:[1,0,1] neg_lo:[0,1,0]
    v_cvt_pk_bf16_f32 v34, v28, v29
    ds_write_addtid_b32 v34 offset:6336
    v_pk_mul_f32 v[32:33], v[110:111], v[22:23] op_sel:[0,0] op_sel_hi:[0,1]
    v_pk_fma_f32 v[112:113], v[110:111], v[22:23], v[32:33] op_sel:[1,1,0] op_sel_hi:[1,0,1] neg_lo:[0,1,0]
    v_cvt_pk_bf16_f32 v35, v112, v113
    ds_write_addtid_b32 v35 offset:20592
    v_pk_mul_f32 v[30:31], v[28:29], v[24:25] op_sel:[0,0] op_sel_hi:[0,1]
    v_pk_fma_f32 v[28:29], v[28:29], v[24:25], v[30:31] op_sel:[1,1,0] op_sel_hi:[1,0,1] neg_lo:[0,1,0]
    v_cvt_pk_bf16_f32 v36, v28, v29
    ds_write_addtid_b32 v36 offset:6864
    v_pk_mul_f32 v[32:33], v[112:113], v[22:23] op_sel:[0,0] op_sel_hi:[0,1]
    v_pk_fma_f32 v[114:115], v[112:113], v[22:23], v[32:33] op_sel:[1,1,0] op_sel_hi:[1,0,1] neg_lo:[0,1,0]
    v_cvt_pk_bf16_f32 v37, v114, v115
    ds_write_addtid_b32 v37 offset:23232
    v_pk_mul_f32 v[30:31], v[28:29], v[24:25] op_sel:[0,0] op_sel_hi:[0,1]
    v_pk_fma_f32 v[28:29], v[28:29], v[24:25], v[30:31] op_sel:[1,1,0] op_sel_hi:[1,0,1] neg_lo:[0,1,0]
    v_cvt_pk_bf16_f32 v34, v28, v29
    ds_write_addtid_b32 v34 offset:7392
    v_pk_mul_f32 v[32:33], v[114:115], v[22:23] op_sel:[0,0] op_sel_hi:[0,1]
    v_pk_fma_f32 v[116:117], v[114:115], v[22:23], v[32:33] op_sel:[1,1,0] op_sel_hi:[1,0,1] neg_lo:[0,1,0]
    v_cvt_pk_bf16_f32 v35, v116, v117
    ds_write_addtid_b32 v35 offset:23760
    v_pk_mul_f32 v[30:31], v[28:29], v[24:25] op_sel:[0,0] op_sel_hi:[0,1]
    v_pk_fma_f32 v[28:29], v[28:29], v[24:25], v[30:31] op_sel:[1,1,0] op_sel_hi:[1,0,1] neg_lo:[0,1,0]
    v_cvt_pk_bf16_f32 v36, v28, v29
    ds_write_addtid_b32 v36 offset:7920
    v_pk_mul_f32 v[32:33], v[116:117], v[22:23] op_sel:[0,0] op_sel_hi:[0,1]
    v_pk_fma_f32 v[118:119], v[116:117], v[22:23], v[32:33] op_sel:[1,1,0] op_sel_hi:[1,0,1] neg_lo:[0,1,0]
    v_cvt_pk_bf16_f32 v37, v118, v119
    ds_write_addtid_b32 v37 offset:24288
    v_pk_mul_f32 v[30:31], v[28:29], v[24:25] op_sel:[0,0] op_sel_hi:[0,1]
    v_pk_fma_f32 v[28:29], v[28:29], v[24:25], v[30:31] op_sel:[1,1,0] op_sel_hi:[1,0,1] neg_lo:[0,1,0]
    v_cvt_pk_bf16_f32 v34, v28, v29
    ds_write_addtid_b32 v34 offset:8448
    v_pk_mul_f32 v[32:33], v[118:119], v[22:23] op_sel:[0,0] op_sel_hi:[0,1]
    v_pk_fma_f32 v[120:121], v[118:119], v[22:23], v[32:33] op_sel:[1,1,0] op_sel_hi:[1,0,1] neg_lo:[0,1,0]
    v_cvt_pk_bf16_f32 v35, v120, v121
    ds_write_addtid_b32 v35 offset:24816
    v_pk_mul_f32 v[30:31], v[28:29], v[24:25] op_sel:[0,0] op_sel_hi:[0,1]
    v_pk_fma_f32 v[28:29], v[28:29], v[24:25], v[30:31] op_sel:[1,1,0] op_sel_hi:[1,0,1] neg_lo:[0,1,0]
    v_cvt_pk_bf16_f32 v36, v28, v29
    ds_write_addtid_b32 v36 offset:8976
    v_pk_mul_f32 v[32:33], v[120:121], v[22:23] op_sel:[0,0] op_sel_hi:[0,1]
    v_pk_fma_f32 v[122:123], v[120:121], v[22:23], v[32:33] op_sel:[1,1,0] op_sel_hi:[1,0,1] neg_lo:[0,1,0]
    v_cvt_pk_bf16_f32 v37, v122, v123
    ds_write_addtid_b32 v37 offset:27456
    v_pk_mul_f32 v[30:31], v[28:29], v[24:25] op_sel:[0,0] op_sel_hi:[0,1]
    v_pk_fma_f32 v[28:29], v[28:29], v[24:25], v[30:31] op_sel:[1,1,0] op_sel_hi:[1,0,1] neg_lo:[0,1,0]
    v_cvt_pk_bf16_f32 v34, v28, v29
    ds_write_addtid_b32 v34 offset:9504
    v_pk_mul_f32 v[32:33], v[122:123], v[22:23] op_sel:[0,0] op_sel_hi:[0,1]
    v_pk_fma_f32 v[124:125], v[122:123], v[22:23], v[32:33] op_sel:[1,1,0] op_sel_hi:[1,0,1] neg_lo:[0,1,0]
    v_cvt_pk_bf16_f32 v35, v124, v125
    ds_write_addtid_b32 v35 offset:27984
    v_pk_mul_f32 v[30:31], v[28:29], v[24:25] op_sel:[0,0] op_sel_hi:[0,1]
    v_pk_fma_f32 v[28:29], v[28:29], v[24:25], v[30:31] op_sel:[1,1,0] op_sel_hi:[1,0,1] neg_lo:[0,1,0]
    v_cvt_pk_bf16_f32 v36, v28, v29
    ds_write_addtid_b32 v36 offset:10032
    v_pk_mul_f32 v[32:33], v[124:125], v[22:23] op_sel:[0,0] op_sel_hi:[0,1]
    v_pk_fma_f32 v[126:127], v[124:125], v[22:23], v[32:33] op_sel:[1,1,0] op_sel_hi:[1,0,1] neg_lo:[0,1,0]
    v_cvt_pk_bf16_f32 v37, v126, v127
    ds_write_addtid_b32 v37 offset:28512
    v_pk_mul_f32 v[30:31], v[28:29], v[24:25] op_sel:[0,0] op_sel_hi:[0,1]
    v_pk_fma_f32 v[28:29], v[28:29], v[24:25], v[30:31] op_sel:[1,1,0] op_sel_hi:[1,0,1] neg_lo:[0,1,0]
    v_cvt_pk_bf16_f32 v34, v28, v29
    ds_write_addtid_b32 v34 offset:10560
    v_pk_mul_f32 v[32:33], v[98:99], v[26:27] op_sel:[0,0] op_sel_hi:[0,1]
    v_pk_fma_f32 v[98:99], v[98:99], v[26:27], v[32:33] op_sel:[1,1,0] op_sel_hi:[1,0,1] neg_lo:[0,1,0]
    v_cvt_pk_bf16_f32 v35, v98, v99
    ds_write_addtid_b32 v35 offset:29568
    v_pk_mul_f32 v[30:31], v[28:29], v[24:25] op_sel:[0,0] op_sel_hi:[0,1]
    v_pk_fma_f32 v[28:29], v[28:29], v[24:25], v[30:31] op_sel:[1,1,0] op_sel_hi:[1,0,1] neg_lo:[0,1,0]
    v_cvt_pk_bf16_f32 v36, v28, v29
    ds_write_addtid_b32 v36 offset:11088
    v_pk_mul_f32 v[32:33], v[106:107], v[26:27] op_sel:[0,0] op_sel_hi:[0,1]
    v_pk_fma_f32 v[106:107], v[106:107], v[26:27], v[32:33] op_sel:[1,1,0] op_sel_hi:[1,0,1] neg_lo:[0,1,0]
    v_cvt_pk_bf16_f32 v37, v106, v107
    ds_write_addtid_b32 v37 offset:30096
    v_pk_mul_f32 v[30:31], v[28:29], v[24:25] op_sel:[0,0] op_sel_hi:[0,1]
    v_pk_fma_f32 v[28:29], v[28:29], v[24:25], v[30:31] op_sel:[1,1,0] op_sel_hi:[1,0,1] neg_lo:[0,1,0]
    v_cvt_pk_bf16_f32 v34, v28, v29
    ds_write_addtid_b32 v34 offset:11616
    v_pk_mul_f32 v[32:33], v[114:115], v[26:27] op_sel:[0,0] op_sel_hi:[0,1]
    v_pk_fma_f32 v[114:115], v[114:115], v[26:27], v[32:33] op_sel:[1,1,0] op_sel_hi:[1,0,1] neg_lo:[0,1,0]
    v_cvt_pk_bf16_f32 v35, v114, v115
    ds_write_addtid_b32 v35 offset:31680
    v_pk_mul_f32 v[30:31], v[28:29], v[24:25] op_sel:[0,0] op_sel_hi:[0,1]
    v_pk_fma_f32 v[28:29], v[28:29], v[24:25], v[30:31] op_sel:[1,1,0] op_sel_hi:[1,0,1] neg_lo:[0,1,0]
    v_cvt_pk_bf16_f32 v36, v28, v29
    ds_write_addtid_b32 v36 offset:12144
    v_pk_mul_f32 v[32:33], v[122:123], v[26:27] op_sel:[0,0] op_sel_hi:[0,1]
    v_pk_fma_f32 v[122:123], v[122:123], v[26:27], v[32:33] op_sel:[1,1,0] op_sel_hi:[1,0,1] neg_lo:[0,1,0]
    v_cvt_pk_bf16_f32 v37, v122, v123
    ds_write_addtid_b32 v37 offset:32208
    v_pk_mul_f32 v[30:31], v[28:29], v[24:25] op_sel:[0,0] op_sel_hi:[0,1]
    v_pk_fma_f32 v[28:29], v[28:29], v[24:25], v[30:31] op_sel:[1,1,0] op_sel_hi:[1,0,1] neg_lo:[0,1,0]
    v_cvt_pk_bf16_f32 v34, v28, v29
    ds_write_addtid_b32 v34 offset:12672
    v_pk_mul_f32 v[32:33], v[106:107], v[26:27] op_sel:[0,0] op_sel_hi:[0,1]
    v_pk_fma_f32 v[106:107], v[106:107], v[26:27], v[32:33] op_sel:[1,1,0] op_sel_hi:[1,0,1] neg_lo:[0,1,0]
    v_cvt_pk_bf16_f32 v35, v106, v107
    ds_write_addtid_b32 v35 offset:30624
    v_pk_mul_f32 v[30:31], v[28:29], v[24:25] op_sel:[0,0] op_sel_hi:[0,1]
    v_pk_fma_f32 v[28:29], v[28:29], v[24:25], v[30:31] op_sel:[1,1,0] op_sel_hi:[1,0,1] neg_lo:[0,1,0]
    v_cvt_pk_bf16_f32 v36, v28, v29
    ds_write_addtid_b32 v36 offset:13200
    v_pk_mul_f32 v[32:33], v[122:123], v[26:27] op_sel:[0,0] op_sel_hi:[0,1]
    v_pk_fma_f32 v[122:123], v[122:123], v[26:27], v[32:33] op_sel:[1,1,0] op_sel_hi:[1,0,1] neg_lo:[0,1,0]
    v_cvt_pk_bf16_f32 v37, v122, v123
    ds_write_addtid_b32 v37 offset:31152
    v_pk_mul_f32 v[30:31], v[28:29], v[24:25] op_sel:[0,0] op_sel_hi:[0,1]
    v_pk_fma_f32 v[28:29], v[28:29], v[24:25], v[30:31] op_sel:[1,1,0] op_sel_hi:[1,0,1] neg_lo:[0,1,0]
    v_cvt_pk_bf16_f32 v34, v28, v29
    ds_write_addtid_b32 v34 offset:13728
    v_pk_mul_f32 v[32:33], v[106:107], v[26:27] op_sel:[0,0] op_sel_hi:[0,1]
    v_pk_fma_f32 v[106:107], v[106:107], v[26:27], v[32:33] op_sel:[1,1,0] op_sel_hi:[1,0,1] neg_lo:[0,1,0]
    v_cvt_pk_bf16_f32 v35, v106, v107
    ds_write_addtid_b32 v35 offset:32736
    v_pk_mul_f32 v[30:31], v[28:29], v[24:25] op_sel:[0,0] op_sel_hi:[0,1]
    v_pk_fma_f32 v[28:29], v[28:29], v[24:25], v[30:31] op_sel:[1,1,0] op_sel_hi:[1,0,1] neg_lo:[0,1,0]
    v_cvt_pk_bf16_f32 v36, v28, v29
    ds_write_addtid_b32 v36 offset:14256
    v_pk_mul_f32 v[32:33], v[122:123], v[26:27] op_sel:[0,0] op_sel_hi:[0,1]
    v_pk_fma_f32 v[122:123], v[122:123], v[26:27], v[32:33] op_sel:[1,1,0] op_sel_hi:[1,0,1] neg_lo:[0,1,0]
    v_cvt_pk_bf16_f32 v37, v122, v123
    ds_write_addtid_b32 v37 offset:33264
    v_pk_mul_f32 v[30:31], v[28:29], v[24:25] op_sel:[0,0] op_sel_hi:[0,1]
    v_pk_fma_f32 v[28:29], v[28:29], v[24:25], v[30:31] op_sel:[1,1,0] op_sel_hi:[1,0,1] neg_lo:[0,1,0]
    v_cvt_pk_bf16_f32 v34, v28, v29
    ds_write_addtid_b32 v34 offset:14784
    v_pk_mul_f32 v[30:31], v[28:29], v[24:25] op_sel:[0,0] op_sel_hi:[0,1]
    v_pk_fma_f32 v[28:29], v[28:29], v[24:25], v[30:31] op_sel:[1,1,0] op_sel_hi:[1,0,1] neg_lo:[0,1,0]
    v_cvt_pk_bf16_f32 v36, v28, v29
    ds_write_addtid_b32 v36 offset:15312
    v_pk_mul_f32 v[30:31], v[28:29], v[24:25] op_sel:[0,0] op_sel_hi:[0,1]
    v_pk_fma_f32 v[28:29], v[28:29], v[24:25], v[30:31] op_sel:[1,1,0] op_sel_hi:[1,0,1] neg_lo:[0,1,0]
    v_cvt_pk_bf16_f32 v34, v28, v29
    ds_write_addtid_b32 v34 offset:15840
    v_pk_mul_f32 v[30:31], v[28:29], v[24:25] op_sel:[0,0] op_sel_hi:[0,1]
    v_pk_fma_f32 v[28:29], v[28:29], v[24:25], v[30:31] op_sel:[1,1,0] op_sel_hi:[1,0,1] neg_lo:[0,1,0]
    v_cvt_pk_bf16_f32 v36, v28, v29
    ds_write_addtid_b32 v36 offset:16368
    ds_write_addtid_b32 v12 offset:25344
    ds_write_addtid_b32 v13 offset:25872
    ds_write_addtid_b32 v14 offset:26400
    s_cmp_eq_u32 s52, 0
    s_cbranch_scc0 L_helper
    s_setprio 2
    s_waitcnt lgkmcnt(0)
    s_barrier
    ds_read_b128 v[128:131], v78 offset:16896
    ds_read_b128 v[132:135], v78 offset:0
    ds_read_b128 v[136:139], v78 offset:16912
    ds_read_b128 v[140:143], v78 offset:16
    ds_read_b128 v[144:147], v78 offset:16928
    ds_read_b128 v[148:151], v78 offset:32
    ds_read_b128 v[152:155], v78 offset:16944
    ds_read_b128 v[156:159], v78 offset:48
    ds_read_b128 v[160:163], v78 offset:16960
    ds_read_b128 v[164:167], v78 offset:64
    ds_read_b128 v[168:171], v78 offset:16976
    ds_read_b128 v[172:175], v78 offset:80
    v_add_u32 v74, -1, v2
    s_waitcnt vmcnt(0)
    v_and_b32 v71, v71, v74
    v_mul_f32 v71, 0x44800000, v71
    v_and_b32 v10, 3, v8
    v_add_u32 v5, 1, v10
    s_waitcnt lgkmcnt(10)
    v_mfma_f32_32x32x16_bf16 v[48:63], v[128:131], v[132:135], 0
    ds_read_b128 v[176:179], v78 offset:16992
    ds_read_b128 v[180:183], v78 offset:96
    v_mul_u32_u24 v10, 1214, v10
    s_waitcnt lgkmcnt(10)
    v_mfma_f32_32x32x16_bf16 v[48:63], v[136:139], v[140:143], v[48:63]
    ds_read_b128 v[184:187], v78 offset:17008
    ds_read_b128 v[188:191], v78 offset:112
    v_lshl_add_u32 v11, v8, 1, v9
    s_waitcnt lgkmcnt(10)
    v_mfma_f32_32x32x16_bf16 v[48:63], v[144:147], v[148:151], v[48:63]
    ds_read_b128 v[192:195], v78 offset:17024
    ds_read_b128 v[196:199], v78 offset:128
    v_mul_u32_u24 v4, 17, v9
    s_waitcnt lgkmcnt(10)
    v_mfma_f32_32x32x16_bf16 v[48:63], v[152:155], v[156:159], v[48:63]
    ds_read_b128 v[200:203], v78 offset:17040
    ds_read_b128 v[204:207], v78 offset:144
    v_sub_u32 v4, v4, v11
    s_waitcnt lgkmcnt(10)
    v_mfma_f32_32x32x16_bf16 v[48:63], v[160:163], v[164:167], v[48:63]
    ds_read_b128 v[208:211], v78 offset:17056
    ds_read_b128 v[212:215], v78 offset:160
    v_and_b32 v5, 4, v5
    s_waitcnt lgkmcnt(10)
    v_mfma_f32_32x32x16_bf16 v[48:63], v[168:171], v[172:175], v[48:63]
    ds_read_b128 v[216:219], v78 offset:17072
    ds_read_b128 v[220:223], v78 offset:176
    s_add_u32 s43, s55, 3680
    s_waitcnt lgkmcnt(10)
    v_mfma_f32_32x32x16_bf16 v[48:63], v[176:179], v[180:183], v[48:63]
    ds_read_b128 v[224:227], v78 offset:17088
    ds_read_b128 v[228:231], v78 offset:192
    v_lshl_add_u32 v10, v5, 1, v10
    s_waitcnt lgkmcnt(10)
    v_mfma_f32_32x32x16_bf16 v[48:63], v[184:187], v[188:191], v[48:63]
    ds_read_b128 v[232:235], v78 offset:17104
    ds_read_b128 v[236:239], v78 offset:208
    v_sub_u32 v10, v4, v10
    s_waitcnt lgkmcnt(10)
    v_mfma_f32_32x32x16_bf16 v[48:63], v[192:195], v[196:199], v[48:63]
    ds_read_b128 v[240:243], v78 offset:17120
    ds_read_b128 v[244:247], v78 offset:224
    v_add_u32 v10, s43, v10
    s_waitcnt lgkmcnt(10)
    v_mfma_f32_32x32x16_bf16 v[48:63], v[200:203], v[204:207], v[48:63]
    ds_read_b128 v[248:251], v78 offset:17136
    ds_read_b128 v[252:255], v78 offset:240
    v_lshl_add_u32 v11, v11, 4, s63
    s_waitcnt lgkmcnt(10)
    v_mfma_f32_32x32x16_bf16 v[48:63], v[208:211], v[212:215], v[48:63]
    s_add_u32 s43, s55, 5116
    s_waitcnt lgkmcnt(8)
    v_mfma_f32_32x32x16_bf16 v[48:63], v[216:219], v[220:223], v[48:63]
    v_lshrrev_b32 v75, 2, v3
    s_waitcnt lgkmcnt(6)
    v_mfma_f32_32x32x16_bf16 v[48:63], v[224:227], v[228:231], v[48:63]
    v_sub_u32 v75, s43, v75
    s_waitcnt lgkmcnt(4)
    v_mfma_f32_32x32x16_bf16 v[48:63], v[232:235], v[236:239], v[48:63]
    v_lshl_add_u32 v7, v9, 6, v3
    s_waitcnt lgkmcnt(2)
    v_mfma_f32_32x32x16_bf16 v[48:63], v[240:243], v[244:247], v[48:63]
    v_add_u32 v7, s55, v7
    s_waitcnt lgkmcnt(0)
    v_mfma_f32_32x32x16_bf16 v[48:63], v[248:251], v[252:255], v[48:63]
    v_lshlrev_b32 v4, 2, v9
    ds_write_b128 v83, v[84:87]
    v_sub_u32 v4, v4, v8
    s_add_u32 s43, s55, 5304
    v_lshl_add_u32 v89, v4, 3, s43
    s_add_u32 s43, s55, 4924
    v_lshl_add_u32 v4, v4, 2, s43
    s_lshl_b32 s43, s51, 2
    s_add_u32 s43, s43, 153728
    v_mov_b32 v88, s43
    v_add_u32 v5, 154048, v3
    s_nop 0
    v_add_f32 v48, v48, v71
    v_bitop3_b32 v49, v79, v48, v49 bitop3:0xca
    v_bitop3_b32 v51, v79, v52, v51 bitop3:0xca
    v_bitop3_b32 v53, v79, v52, v53 bitop3:0xca
    v_bitop3_b32 v55, v79, v56, v55 bitop3:0xca
    v_cvt_pk_bf16_f32 v128, v55, v54
    v_cvt_pk_bf16_f32 v129, v53, v52
    v_cvt_pk_bf16_f32 v130, v51, v50
    v_cvt_pk_bf16_f32 v131, v49, v48
    ds_write_b128 v81, v[128:131] offset:0
    v_bitop3_b32 v57, v80, v56, v57 bitop3:0xca
    v_bitop3_b32 v58, v82, v56, v58 bitop3:0xca
    v_cvt_pk_bf16_f32 v132, v56, v55
    v_cvt_pk_bf16_f32 v133, v54, v53
    v_cvt_pk_bf16_f32 v134, v52, v51
    v_cvt_pk_bf16_f32 v135, v50, v49
    ds_write_b128 v81, v[132:135] offset:3648
    v_readlane_b32 s42, v130, 0
    v_readlane_b32 s43, v131, 0
    v_readlane_b32 s58, v128, 63
    v_cvt_pk_bf16_f32 v136, v57, v56
    v_cvt_pk_bf16_f32 v137, v55, v54
    v_cvt_pk_bf16_f32 v138, v53, v52
    v_cvt_pk_bf16_f32 v139, v51, v50
    ds_write_b128 v81, v[136:139] offset:2432
    s_pack_lh_b32_b16 s42, s58, s42
    v_mov_b32 v71, s42
    v_perm_b32 v71, v71, s43, v72
    v_cvt_pk_bf16_f32 v140, v58, v57
    v_cvt_pk_bf16_f32 v141, v56, v55
    v_cvt_pk_bf16_f32 v142, v54, v53
    v_cvt_pk_bf16_f32 v143, v52, v51
    ds_write_b128 v81, v[140:143] offset:1216
    ds_write_b16 v73, v71
    v_cvt_pk_bf16_f32 v72, v61, v60
    v_cvt_pk_bf16_f32 v74, v63, v62
    ds_write_b32 v77, v72
    v_readlane_b32 s59, v72, 63
    ds_write_b32 v75, v74
    s_and_b32 s59, s59, 0xffff
    s_cmp_lt_u32 s39, 2
    s_cbranch_scc0 L_ct3
    global_load_dword v1, v76, s[56:57]
L_ct3:
    ds_read_b64 v[220:221], v10 offset:576
    ds_read_b64 v[222:223], v10 offset:584
    ds_read_b64 v[252:253], v10 offset:64
    ds_read_b64 v[254:255], v10 offset:72
    ds_read_b64 v[216:217], v10 offset:640
    ds_read_b64 v[218:219], v10 offset:648
    ds_read_b64 v[248:249], v10 offset:128
    ds_read_b64 v[250:251], v10 offset:136
    ds_read_b64 v[212:213], v10 offset:704
    ds_read_b64 v[214:215], v10 offset:712
    ds_read_b64 v[244:245], v10 offset:192
    ds_read_b64 v[246:247], v10 offset:200
    ds_read_b64 v[208:209], v10 offset:768
    ds_read_b64 v[210:211], v10 offset:776
    ds_read_b64 v[240:241], v10 offset:256
    ds_read_b64 v[242:243], v10 offset:264
    ds_read_b64 v[204:205], v10 offset:832
    ds_read_b64 v[206:207], v10 offset:840
    ds_read_b64 v[236:237], v10 offset:320
    ds_read_b64 v[238:239], v10 offset:328
    ds_read_b64 v[200:201], v10 offset:896
    ds_read_b64 v[202:203], v10 offset:904
    ds_read_b64 v[232:233], v10 offset:384
    ds_read_b64 v[234:235], v10 offset:392
    ds_read_b64 v[196:197], v10 offset:960
    ds_read_b64 v[198:199], v10 offset:968
    ds_read_b64 v[228:229], v10 offset:448
    ds_read_b64 v[230:231], v10 offset:456
    ds_read_b64 v[192:193], v10 offset:1024
    ds_read_b64 v[194:195], v10 offset:1032
    ds_read_b64 v[224:225], v10 offset:512
    ds_read_b64 v[226:227], v10 offset:520
    s_waitcnt lgkmcnt(6)
    s_barrier
    s_setprio 1
    ds_read_b128 v[68:71], v11 offset:0
    ds_read_b128 v[72:75], v11 offset:64
    ds_read_b128 v[76:79], v11 offset:128
    ds_read_b128 v[80:83], v11 offset:192
    ds_read_b128 v[16:19], v5 offset:0
    ds_read_b128 v[84:87], v11 offset:256
    ds_read_b128 v[132:135], v11 offset:320
    s_waitcnt lgkmcnt(6)
    v_mfma_f32_16x16x32_bf16 v[44:47], v[220:223], v[68:71], 0
    v_mfma_f32_16x16x32_bf16 v[48:51], v[252:255], v[68:71], 0
    ds_read_b128 v[68:71], v11 offset:384
    s_waitcnt lgkmcnt(5)
    v_mfma_f32_16x16x32_bf16 v[44:47], v[216:219], v[72:75], v[44:47]
    v_mfma_f32_16x16x32_bf16 v[48:51], v[248:251], v[72:75], v[48:51]
    ds_read_b128 v[72:75], v11 offset:448
    v_mfma_f32_16x16x32_bf16 v[44:47], v[212:215], v[76:79], v[44:47]
    ds_read_b128 v[28:31], v5 offset:1024
    v_mfma_f32_16x16x32_bf16 v[48:51], v[244:247], v[76:79], v[48:51]
    ds_read_b128 v[32:35], v5 offset:2048
    ds_read_b128 v[36:39], v5 offset:3072
    s_waitcnt lgkmcnt(6)
    v_mfma_f32_16x16x32_bf16 v[44:47], v[208:211], v[80:83], v[44:47]
    ds_read_b128 v[20:23], v5 offset:4096
    ds_read_b128 v[24:27], v5 offset:5120
    v_mfma_f32_16x16x32_bf16 v[48:51], v[240:243], v[80:83], v[48:51]
    ds_read_b64 v[12:13], v10 offset:0
    v_lshrrev_b32 v16, 7, v16
    v_mfma_f32_16x16x32_bf16 v[44:47], v[204:207], v[84:87], v[44:47]
    ds_read_b64 v[14:15], v10 offset:8
    v_and_b32 v16, 0x10001, v16
    v_mfma_f32_16x16x32_bf16 v[48:51], v[236:239], v[84:87], v[48:51]
    ds_read_b128 v[76:79], v11 offset:432
    s_waitcnt lgkmcnt(9)
    v_mfma_f32_16x16x32_bf16 v[44:47], v[200:203], v[132:135], v[44:47]
    ds_read_b128 v[80:83], v11 offset:512
    v_mul_u32_u24 v16, s59, v16
    v_mfma_f32_16x16x32_bf16 v[48:51], v[232:235], v[132:135], v[48:51]
    ds_read_b128 v[84:87], v11 offset:576
    v_lshrrev_b32 v17, 7, v17
    v_mfma_f32_16x16x32_bf16 v[44:47], v[196:199], v[68:71], v[44:47]
    v_and_b32 v17, 0x10001, v17
    v_mfma_f32_16x16x32_bf16 v[48:51], v[228:231], v[68:71], v[48:51]
    s_waitcnt lgkmcnt(10)
    v_mul_u32_u24 v17, s59, v17
    v_mfma_f32_16x16x32_bf16 v[44:47], v[192:195], v[72:75], v[44:47]
    ds_read_b128 v[132:135], v11 offset:640
    v_lshrrev_b32 v18, 7, v18
    v_mfma_f32_16x16x32_bf16 v[48:51], v[224:227], v[72:75], v[48:51]
    s_waitcnt lgkmcnt(6)
    v_and_b32 v18, 0x10001, v18
    v_mfma_f32_16x16x32_bf16 v[108:111], v[72:75], v[28:31], 0
    ds_read_b128 v[68:71], v11 offset:704
    v_mul_u32_u24 v18, s59, v18
    v_mfma_f32_16x16x32_bf16 v[112:115], v[72:75], v[32:35], 0
    s_waitcnt lgkmcnt(5)
    v_lshrrev_b32 v19, 7, v19
    v_mfma_f32_16x16x32_bf16 v[52:55], v[12:15], v[72:75], 0
    v_and_b32 v19, 0x10001, v19
    v_mfma_f32_16x16x32_bf16 v[116:119], v[72:75], v[36:39], 0
    ds_write_b128 v7, v[44:47] offset:9472
    v_mfma_f32_16x16x32_bf16 v[124:127], v[72:75], v[20:23], 0
    v_mul_u32_u24 v19, s59, v19
    s_nop 1
    v_mfma_f32_16x16x32_bf16 v[60:63], v[16:19], v[72:75], 0
    ds_read_b128 v[72:75], v11 offset:768
    s_waitcnt lgkmcnt(5)
    v_mfma_f32_16x16x32_bf16 v[120:123], v[76:79], v[32:35], 0
    ds_write_b32 v88, v88 offset:0
    v_mfma_f32_16x16x32_bf16 v[128:131], v[76:79], v[24:27], 0
    ds_read_b128 v[76:79], v11 offset:832
    v_mfma_f32_16x16x32_bf16 v[48:51], v[220:223], v[80:83], v[48:51]
    v_mfma_f32_16x16x32_bf16 v[52:55], v[252:255], v[80:83], v[52:55]
    ds_read_b128 v[80:83], v11 offset:896
    s_waitcnt lgkmcnt(6)
    v_mfma_f32_16x16x32_bf16 v[48:51], v[216:219], v[84:87], v[48:51]
    v_mfma_f32_16x16x32_bf16 v[52:55], v[248:251], v[84:87], v[52:55]
    ds_read_b128 v[84:87], v11 offset:960
    v_cvt_pk_bf16_f32 v136, v120, v116
    v_mfma_f32_16x16x32_bf16 v[48:51], v[212:215], v[132:135], v[48:51]
    v_cvt_pk_bf16_f32 v137, v112, v108
    v_mfma_f32_16x16x32_bf16 v[52:55], v[244:247], v[132:135], v[52:55]
    s_waitcnt lgkmcnt(4)
    v_cvt_pk_bf16_f32 v138, v121, v117
    v_mfma_f32_16x16x32_bf16 v[48:51], v[208:211], v[68:71], v[48:51]
    v_cvt_pk_bf16_f32 v139, v113, v109
    v_mfma_f32_16x16x32_bf16 v[52:55], v[240:243], v[68:71], v[52:55]
    ds_read_b128 v[132:135], v11 offset:944
    v_cvt_pk_bf16_f32 v140, v122, v118
    v_mfma_f32_16x16x32_bf16 v[48:51], v[204:207], v[72:75], v[48:51]
    v_cvt_pk_bf16_f32 v141, v114, v110
    v_mfma_f32_16x16x32_bf16 v[52:55], v[236:239], v[72:75], v[52:55]
    ds_read_b128 v[68:71], v11 offset:1024
    s_waitcnt lgkmcnt(3)
    v_mfma_f32_16x16x32_bf16 v[48:51], v[200:203], v[76:79], v[48:51]
    v_cvt_pk_bf16_f32 v142, v123, v119
    v_mfma_f32_16x16x32_bf16 v[52:55], v[232:235], v[76:79], v[52:55]
    ds_read_b64 v[168:169], v89 offset:256
    v_cvt_pk_bf16_f32 v143, v115, v111
    v_mfma_f32_16x16x32_bf16 v[48:51], v[196:199], v[80:83], v[48:51]
    ds_read_b64 v[170:171], v89 offset:264
    v_cvt_pk_bf16_f32 v92, v128, v124
    v_mfma_f32_16x16x32_bf16 v[52:55], v[228:231], v[80:83], v[52:55]
    ds_read_b128 v[72:75], v11 offset:1088
    s_waitcnt lgkmcnt(5)
    v_mfma_f32_16x16x32_bf16 v[48:51], v[192:195], v[84:87], v[48:51]
    ds_read_b64 v[172:173], v89 offset:272
    v_cvt_pk_bf16_f32 v93, v129, v125
    v_mfma_f32_16x16x32_bf16 v[52:55], v[224:227], v[84:87], v[52:55]
    ds_read_b64 v[174:175], v89 offset:280
    v_cvt_pk_bf16_f32 v94, v130, v126
    v_mfma_f32_16x16x32_bf16 v[108:111], v[84:87], v[28:31], 0
    ds_read_b128 v[76:79], v11 offset:1152
    v_cvt_pk_bf16_f32 v95, v131, v127
    v_mfma_f32_16x16x32_bf16 v[112:115], v[84:87], v[32:35], 0
    v_mfma_f32_16x16x32_bf16 v[56:59], v[12:15], v[84:87], 0
    ds_read_b128 v[80:83], v11 offset:1216
    v_mfma_f32_16x16x32_bf16 v[116:119], v[84:87], v[36:39], 0
    ds_write_b128 v7, v[48:51] offset:10752
    v_mfma_f32_16x16x32_bf16 v[124:127], v[84:87], v[20:23], 0
    v_mfma_f32_16x16x32_bf16 v[64:67], v[16:19], v[84:87], 0
    ds_read_b128 v[84:87], v11 offset:1280
    s_waitcnt lgkmcnt(9)
    v_mfma_f32_16x16x32_bf16 v[120:123], v[132:135], v[32:35], 0
    ds_write_b32 v88, v88 offset:16
    v_mfma_f32_16x16x32_bf16 v[128:131], v[132:135], v[24:27], 0
    ds_read_b128 v[132:135], v11 offset:1344
    v_mfma_f32_16x16x32_bf16 v[52:55], v[220:223], v[68:71], v[52:55]
    v_mfma_f32_16x16x32_bf16 v[56:59], v[252:255], v[68:71], v[56:59]
    ds_read_b128 v[68:71], v11 offset:1408
    s_waitcnt lgkmcnt(7)
    v_mfma_f32_16x16x32_bf16 v[52:55], v[136:139], v[168:171], v[52:55]
    v_mfma_f32_16x16x32_bf16 v[52:55], v[216:219], v[72:75], v[52:55]
    v_mfma_f32_16x16x32_bf16 v[56:59], v[248:251], v[72:75], v[56:59]
    ds_read_b128 v[72:75], v11 offset:1472
    v_mfma_f32_16x16x32_bf16 v[52:55], v[140:143], v[172:175], v[52:55]
    s_waitcnt lgkmcnt(6)
    v_cvt_pk_bf16_f32 v144, v120, v116
    v_mfma_f32_16x16x32_bf16 v[52:55], v[212:215], v[76:79], v[52:55]
    v_cvt_pk_bf16_f32 v145, v112, v108
    v_mfma_f32_16x16x32_bf16 v[56:59], v[244:247], v[76:79], v[56:59]
    v_cvt_pk_bf16_f32 v146, v121, v117
    v_mfma_f32_16x16x32_bf16 v[52:55], v[208:211], v[80:83], v[52:55]
    v_cvt_pk_bf16_f32 v147, v113, v109
    v_mfma_f32_16x16x32_bf16 v[56:59], v[240:243], v[80:83], v[56:59]
    ds_read_b128 v[76:79], v11 offset:1456
    s_waitcnt lgkmcnt(3)
    v_mfma_f32_16x16x32_bf16 v[52:55], v[204:207], v[84:87], v[52:55]
    v_cvt_pk_bf16_f32 v148, v122, v118
    v_mfma_f32_16x16x32_bf16 v[56:59], v[236:239], v[84:87], v[56:59]
    ds_read_b128 v[80:83], v11 offset:1536
    v_cvt_pk_bf16_f32 v149, v114, v110
    v_mfma_f32_16x16x32_bf16 v[52:55], v[200:203], v[132:135], v[52:55]
    v_cvt_pk_bf16_f32 v150, v123, v119
    v_mfma_f32_16x16x32_bf16 v[56:59], v[232:235], v[132:135], v[56:59]
    ds_read_b64 v[176:177], v89 offset:128
    s_waitcnt lgkmcnt(3)
    v_mfma_f32_16x16x32_bf16 v[52:55], v[196:199], v[68:71], v[52:55]
    ds_read_b64 v[178:179], v89 offset:136
    v_cvt_pk_bf16_f32 v151, v115, v111
    v_mfma_f32_16x16x32_bf16 v[56:59], v[228:231], v[68:71], v[56:59]
    ds_read_b128 v[84:87], v11 offset:1600
    v_cvt_pk_bf16_f32 v96, v128, v124
    v_mfma_f32_16x16x32_bf16 v[52:55], v[192:195], v[72:75], v[52:55]
    ds_read_b64 v[180:181], v89 offset:144
    v_cvt_pk_bf16_f32 v97, v129, v125
    v_mfma_f32_16x16x32_bf16 v[56:59], v[224:227], v[72:75], v[56:59]
    ds_read_b64 v[182:183], v89 offset:152
    v_cvt_pk_bf16_f32 v98, v130, v126
    v_mfma_f32_16x16x32_bf16 v[108:111], v[72:75], v[28:31], 0
    ds_read_b128 v[132:135], v11 offset:1664
    v_cvt_pk_bf16_f32 v99, v131, v127
    v_mfma_f32_16x16x32_bf16 v[112:115], v[72:75], v[32:35], 0
    v_mfma_f32_16x16x32_bf16 v[60:63], v[12:15], v[72:75], v[60:63]
    v_mfma_f32_16x16x32_bf16 v[116:119], v[72:75], v[36:39], 0
    ds_read_b128 v[68:71], v11 offset:1728
    ds_write_b128 v7, v[52:55] offset:12032
    v_mfma_f32_16x16x32_bf16 v[124:127], v[72:75], v[20:23], 0
    v_mfma_f32_16x16x32_bf16 v[44:47], v[16:19], v[72:75], 0
    ds_read_b128 v[72:75], v11 offset:1792
    s_waitcnt lgkmcnt(9)
    v_mfma_f32_16x16x32_bf16 v[120:123], v[76:79], v[32:35], 0
    ds_write_b32 v88, v88 offset:32
    v_mfma_f32_16x16x32_bf16 v[128:131], v[76:79], v[24:27], 0
    ds_read_b128 v[76:79], v11 offset:1856
    v_mfma_f32_16x16x32_bf16 v[56:59], v[220:223], v[80:83], v[56:59]
    v_mfma_f32_16x16x32_bf16 v[60:63], v[252:255], v[80:83], v[60:63]
    ds_read_b128 v[80:83], v11 offset:1920
    s_waitcnt lgkmcnt(7)
    v_mfma_f32_16x16x32_bf16 v[56:59], v[136:139], v[176:179], v[56:59]
    v_mfma_f32_16x16x32_bf16 v[56:59], v[216:219], v[84:87], v[56:59]
    v_mfma_f32_16x16x32_bf16 v[60:63], v[248:251], v[84:87], v[60:63]
    ds_read_b128 v[84:87], v11 offset:1984
    v_mfma_f32_16x16x32_bf16 v[56:59], v[140:143], v[180:183], v[56:59]
    s_waitcnt lgkmcnt(6)
    v_cvt_pk_bf16_f32 v152, v120, v116
    v_mfma_f32_16x16x32_bf16 v[56:59], v[212:215], v[132:135], v[56:59]
    v_cvt_pk_bf16_f32 v153, v112, v108
    v_mfma_f32_16x16x32_bf16 v[60:63], v[244:247], v[132:135], v[60:63]
    v_cvt_pk_bf16_f32 v154, v121, v117
    v_mfma_f32_16x16x32_bf16 v[56:59], v[144:147], v[168:171], v[56:59]
    v_cvt_pk_bf16_f32 v155, v113, v109
    v_mfma_f32_16x16x32_bf16 v[56:59], v[208:211], v[68:71], v[56:59]
    v_cvt_pk_bf16_f32 v156, v122, v118
    v_mfma_f32_16x16x32_bf16 v[60:63], v[240:243], v[68:71], v[60:63]
    v_cvt_pk_bf16_f32 v157, v114, v110
    v_mfma_f32_16x16x32_bf16 v[56:59], v[148:151], v[172:175], v[56:59]
    ds_read_b128 v[132:135], v11 offset:1968
    s_waitcnt lgkmcnt(3)
    v_mfma_f32_16x16x32_bf16 v[56:59], v[204:207], v[72:75], v[56:59]
    v_cvt_pk_bf16_f32 v158, v123, v119
    v_mfma_f32_16x16x32_bf16 v[60:63], v[236:239], v[72:75], v[60:63]
    ds_read_b128 v[68:71], v11 offset:2048
    v_cvt_pk_bf16_f32 v159, v115, v111
    v_mfma_f32_16x16x32_bf16 v[56:59], v[200:203], v[76:79], v[56:59]
    v_cvt_pk_bf16_f32 v100, v128, v124
    v_mfma_f32_16x16x32_bf16 v[60:63], v[232:235], v[76:79], v[60:63]
    ds_read2_b32 v[40:41], v4 offset0:48 offset1:49
    s_waitcnt lgkmcnt(3)
    v_mfma_f32_16x16x32_bf16 v[56:59], v[196:199], v[80:83], v[56:59]
    ds_read2_b32 v[42:43], v4 offset0:50 offset1:51
    v_cvt_pk_bf16_f32 v101, v129, v125
    v_mfma_f32_16x16x32_bf16 v[60:63], v[228:231], v[80:83], v[60:63]
    ds_read_b128 v[72:75], v11 offset:2112
    v_cvt_pk_bf16_f32 v102, v130, v126
    v_mfma_f32_16x16x32_bf16 v[56:59], v[192:195], v[84:87], v[56:59]
    ds_read_b64 v[184:185], v89 offset:0
    v_cvt_pk_bf16_f32 v103, v131, v127
    v_mfma_f32_16x16x32_bf16 v[60:63], v[224:227], v[84:87], v[60:63]
    ds_read_b64 v[186:187], v89 offset:8
    v_mfma_f32_16x16x32_bf16 v[108:111], v[84:87], v[28:31], 0
    ds_read_b128 v[76:79], v11 offset:2176
    v_mfma_f32_16x16x32_bf16 v[112:115], v[84:87], v[32:35], 0
    v_mfma_f32_16x16x32_bf16 v[64:67], v[12:15], v[84:87], v[64:67]
    ds_read_b64 v[188:189], v89 offset:16
    v_mfma_f32_16x16x32_bf16 v[116:119], v[84:87], v[36:39], 0
    ds_read_b64 v[190:191], v89 offset:24
    ds_write_b128 v7, v[56:59] offset:13312
    v_mfma_f32_16x16x32_bf16 v[124:127], v[84:87], v[20:23], 0
    ds_read_b128 v[80:83], v11 offset:2240
    v_mfma_f32_16x16x32_bf16 v[48:51], v[16:19], v[84:87], 0
    ds_read_b128 v[84:87], v11 offset:2304
    s_waitcnt lgkmcnt(11)
    v_mfma_f32_16x16x32_bf16 v[120:123], v[132:135], v[32:35], 0
    ds_write_b32 v88, v88 offset:48
    v_mfma_f32_16x16x32_bf16 v[128:131], v[132:135], v[24:27], 0
    ds_read_b128 v[132:135], v11 offset:2368
    v_mfma_f32_16x16x32_bf16 v[60:63], v[220:223], v[68:71], v[60:63]
    v_mfma_f32_16x16x32_bf16 v[64:67], v[252:255], v[68:71], v[64:67]
    s_waitcnt lgkmcnt(8)
    v_mfma_f32_16x16x32_bf16 v[60:63], v[92:95], v[40:43], v[60:63]
    ds_read_b128 v[68:71], v11 offset:2432
    v_mfma_f32_16x16x32_bf16 v[60:63], v[216:219], v[72:75], v[60:63]
    v_mfma_f32_16x16x32_bf16 v[64:67], v[248:251], v[72:75], v[64:67]
    v_mfma_f32_16x16x32_bf16 v[60:63], v[136:139], v[184:187], v[60:63]
    ds_read_b128 v[72:75], v11 offset:2496
    s_waitcnt lgkmcnt(5)
    v_mfma_f32_16x16x32_bf16 v[60:63], v[212:215], v[76:79], v[60:63]
    v_cvt_pk_bf16_f32 v160, v120, v116
    v_mfma_f32_16x16x32_bf16 v[64:67], v[244:247], v[76:79], v[64:67]
    v_cvt_pk_bf16_f32 v161, v112, v108
    v_mfma_f32_16x16x32_bf16 v[60:63], v[140:143], v[188:191], v[60:63]
    v_cvt_pk_bf16_f32 v162, v121, v117
    v_mfma_f32_16x16x32_bf16 v[60:63], v[208:211], v[80:83], v[60:63]
    v_cvt_pk_bf16_f32 v163, v113, v109
    v_mfma_f32_16x16x32_bf16 v[64:67], v[240:243], v[80:83], v[64:67]
    v_cvt_pk_bf16_f32 v164, v122, v118
    v_mfma_f32_16x16x32_bf16 v[60:63], v[144:147], v[176:179], v[60:63]
    s_waitcnt lgkmcnt(2)
    v_cvt_pk_bf16_f32 v165, v114, v110
    v_mfma_f32_16x16x32_bf16 v[60:63], v[204:207], v[84:87], v[60:63]
    ds_read_b128 v[76:79], v11 offset:2480
    v_cvt_pk_bf16_f32 v166, v123, v119
    v_mfma_f32_16x16x32_bf16 v[64:67], v[236:239], v[84:87], v[64:67]
    ds_read_b128 v[80:83], v11 offset:2560
    v_cvt_pk_bf16_f32 v167, v115, v111
    v_mfma_f32_16x16x32_bf16 v[60:63], v[148:151], v[180:183], v[60:63]
    v_cvt_pk_bf16_f32 v104, v128, v124
    v_mfma_f32_16x16x32_bf16 v[60:63], v[200:203], v[132:135], v[60:63]
    v_cvt_pk_bf16_f32 v105, v129, v125
    v_mfma_f32_16x16x32_bf16 v[64:67], v[232:235], v[132:135], v[64:67]
    ds_read2_b32 v[16:17], v4 offset0:32 offset1:33
    v_cvt_pk_bf16_f32 v106, v130, v126
    v_mfma_f32_16x16x32_bf16 v[60:63], v[152:155], v[168:171], v[60:63]
    ds_read2_b32 v[18:19], v4 offset0:34 offset1:35
    s_waitcnt lgkmcnt(4)
    v_mfma_f32_16x16x32_bf16 v[60:63], v[196:199], v[68:71], v[60:63]
    ds_read_b128 v[84:87], v11 offset:2624
    v_cvt_pk_bf16_f32 v107, v131, v127
    v_mfma_f32_16x16x32_bf16 v[64:67], v[228:231], v[68:71], v[64:67]
    v_mfma_f32_16x16x32_bf16 v[60:63], v[156:159], v[172:175], v[60:63]
    v_mfma_f32_16x16x32_bf16 v[60:63], v[192:195], v[72:75], v[60:63]
    ds_read_b128 v[132:135], v11 offset:2688
    v_mfma_f32_16x16x32_bf16 v[64:67], v[224:227], v[72:75], v[64:67]
    v_mfma_f32_16x16x32_bf16 v[108:111], v[72:75], v[28:31], 0
    v_mfma_f32_16x16x32_bf16 v[112:115], v[72:75], v[32:35], 0
    ds_read_b128 v[68:71], v11 offset:2752
    v_mfma_f32_16x16x32_bf16 v[44:47], v[12:15], v[72:75], v[44:47]
    v_mfma_f32_16x16x32_bf16 v[116:119], v[72:75], v[36:39], 0
    ds_read_b128 v[72:75], v11 offset:2816
    s_waitcnt lgkmcnt(6)
    v_mfma_f32_16x16x32_bf16 v[120:123], v[76:79], v[32:35], 0
    ds_write_b128 v7, v[60:63] offset:14592
    v_mfma_f32_16x16x32_bf16 v[64:67], v[220:223], v[80:83], v[64:67]
    ds_read_b128 v[76:79], v11 offset:2880
    ds_write_b32 v88, v88 offset:64
    v_mfma_f32_16x16x32_bf16 v[44:47], v[252:255], v[80:83], v[44:47]
    v_mfma_f32_16x16x32_bf16 v[64:67], v[96:99], v[40:43], v[64:67]
    s_waitcnt lgkmcnt(6)
    v_mfma_f32_16x16x32_bf16 v[64:67], v[92:95], v[16:19], v[64:67]
    ds_read_b128 v[80:83], v11 offset:2944
    v_mfma_f32_16x16x32_bf16 v[64:67], v[216:219], v[84:87], v[64:67]
    v_mfma_f32_16x16x32_bf16 v[44:47], v[248:251], v[84:87], v[44:47]
    v_mfma_f32_16x16x32_bf16 v[64:67], v[144:147], v[184:187], v[64:67]
    ds_read_b128 v[84:87], v11 offset:3008
    s_waitcnt lgkmcnt(6)
    v_mfma_f32_16x16x32_bf16 v[64:67], v[212:215], v[132:135], v[64:67]
    v_cvt_pk_bf16_f32 v136, v120, v116
    v_mfma_f32_16x16x32_bf16 v[44:47], v[244:247], v[132:135], v[44:47]
    v_cvt_pk_bf16_f32 v137, v112, v108
    v_mfma_f32_16x16x32_bf16 v[64:67], v[148:151], v[188:191], v[64:67]
    v_cvt_pk_bf16_f32 v138, v121, v117
    v_mfma_f32_16x16x32_bf16 v[64:67], v[208:211], v[68:71], v[64:67]
    v_cvt_pk_bf16_f32 v139, v113, v109
    v_mfma_f32_16x16x32_bf16 v[44:47], v[240:243], v[68:71], v[44:47]
    v_cvt_pk_bf16_f32 v140, v122, v118
    v_mfma_f32_16x16x32_bf16 v[64:67], v[152:155], v[176:179], v[64:67]
    s_waitcnt lgkmcnt(3)
    v_cvt_pk_bf16_f32 v141, v114, v110
    v_mfma_f32_16x16x32_bf16 v[64:67], v[204:207], v[72:75], v[64:67]
    ds_read_b128 v[132:135], v11 offset:2992
    v_cvt_pk_bf16_f32 v142, v123, v119
    v_mfma_f32_16x16x32_bf16 v[44:47], v[236:239], v[72:75], v[44:47]
    ds_read_b128 v[68:71], v11 offset:3072
    v_cvt_pk_bf16_f32 v143, v115, v111
    v_mfma_f32_16x16x32_bf16 v[64:67], v[156:159], v[180:183], v[64:67]
    v_mfma_f32_16x16x32_bf16 v[64:67], v[200:203], v[76:79], v[64:67]
    v_mfma_f32_16x16x32_bf16 v[44:47], v[232:235], v[76:79], v[44:47]
    v_mfma_f32_16x16x32_bf16 v[64:67], v[160:163], v[168:171], v[64:67]
    ds_read_b128 v[72:75], v11 offset:3136
    s_waitcnt lgkmcnt(3)
    v_mfma_f32_16x16x32_bf16 v[64:67], v[196:199], v[80:83], v[64:67]
    v_mfma_f32_16x16x32_bf16 v[44:47], v[228:231], v[80:83], v[44:47]
    ds_read2_b32 v[20:21], v4 offset0:16 offset1:17
    v_mfma_f32_16x16x32_bf16 v[64:67], v[164:167], v[172:175], v[64:67]
    ds_read2_b32 v[22:23], v4 offset0:18 offset1:19
    v_mfma_f32_16x16x32_bf16 v[64:67], v[192:195], v[84:87], v[64:67]
    v_mfma_f32_16x16x32_bf16 v[44:47], v[224:227], v[84:87], v[44:47]
    ds_read_b128 v[76:79], v11 offset:3200
    v_mfma_f32_16x16x32_bf16 v[108:111], v[84:87], v[28:31], 0
    v_mfma_f32_16x16x32_bf16 v[112:115], v[84:87], v[32:35], 0
    v_mfma_f32_16x16x32_bf16 v[48:51], v[12:15], v[84:87], v[48:51]
    ds_read_b128 v[80:83], v11 offset:3264
    v_mfma_f32_16x16x32_bf16 v[116:119], v[84:87], v[36:39], 0
    ds_read_b128 v[84:87], v11 offset:3328
    s_waitcnt lgkmcnt(6)
    v_mfma_f32_16x16x32_bf16 v[120:123], v[132:135], v[32:35], 0
    ds_write_b128 v7, v[64:67] offset:15872
    v_mfma_f32_16x16x32_bf16 v[44:47], v[220:223], v[68:71], v[44:47]
    ds_write_b32 v88, v88 offset:80
    v_mfma_f32_16x16x32_bf16 v[48:51], v[252:255], v[68:71], v[48:51]
    ds_read_b128 v[132:135], v11 offset:3392
    v_mfma_f32_16x16x32_bf16 v[44:47], v[100:103], v[40:43], v[44:47]
    v_mfma_f32_16x16x32_bf16 v[44:47], v[96:99], v[16:19], v[44:47]
    s_waitcnt lgkmcnt(6)
    v_mfma_f32_16x16x32_bf16 v[44:47], v[216:219], v[72:75], v[44:47]
    ds_read_b128 v[68:71], v11 offset:3456
    v_mfma_f32_16x16x32_bf16 v[48:51], v[248:251], v[72:75], v[48:51]
    v_mfma_f32_16x16x32_bf16 v[44:47], v[92:95], v[20:23], v[44:47]
    v_mfma_f32_16x16x32_bf16 v[44:47], v[152:155], v[184:187], v[44:47]
    ds_read_b128 v[72:75], v11 offset:3520
    s_waitcnt lgkmcnt(6)
    v_mfma_f32_16x16x32_bf16 v[44:47], v[212:215], v[76:79], v[44:47]
    v_cvt_pk_bf16_f32 v144, v120, v116
    v_mfma_f32_16x16x32_bf16 v[48:51], v[244:247], v[76:79], v[48:51]
    ds_read_b128 v[76:79], v11 offset:3584
    v_cvt_pk_bf16_f32 v145, v112, v108
    v_mfma_f32_16x16x32_bf16 v[44:47], v[156:159], v[188:191], v[44:47]
    v_cvt_pk_bf16_f32 v146, v121, v117
    v_mfma_f32_16x16x32_bf16 v[44:47], v[208:211], v[80:83], v[44:47]
    v_cvt_pk_bf16_f32 v147, v113, v109
    v_mfma_f32_16x16x32_bf16 v[48:51], v[240:243], v[80:83], v[48:51]
    ds_read_b128 v[80:83], v11 offset:3648
    v_cvt_pk_bf16_f32 v148, v122, v118
    v_mfma_f32_16x16x32_bf16 v[44:47], v[160:163], v[176:179], v[44:47]
    ds_read2_b32 v[24:25], v4 offset0:0 offset1:1
    s_waitcnt lgkmcnt(5)
    v_mfma_f32_16x16x32_bf16 v[44:47], v[204:207], v[84:87], v[44:47]
    ds_read2_b32 v[26:27], v4 offset0:2 offset1:3
    v_cvt_pk_bf16_f32 v149, v114, v110
    v_mfma_f32_16x16x32_bf16 v[48:51], v[236:239], v[84:87], v[48:51]
    ds_read_b128 v[84:87], v11 offset:3712
    v_cvt_pk_bf16_f32 v150, v123, v119
    v_mfma_f32_16x16x32_bf16 v[44:47], v[164:167], v[180:183], v[44:47]
    v_cvt_pk_bf16_f32 v151, v115, v111
    v_mfma_f32_16x16x32_bf16 v[44:47], v[200:203], v[132:135], v[44:47]
    v_mfma_f32_16x16x32_bf16 v[48:51], v[232:235], v[132:135], v[48:51]
    v_mfma_f32_16x16x32_bf16 v[44:47], v[136:139], v[168:171], v[44:47]
    ds_read_b128 v[132:135], v11 offset:3776
    s_waitcnt lgkmcnt(6)
    v_mfma_f32_16x16x32_bf16 v[44:47], v[196:199], v[68:71], v[44:47]
    v_mfma_f32_16x16x32_bf16 v[48:51], v[228:231], v[68:71], v[48:51]
    ds_read_b128 v[68:71], v11 offset:3840
    v_mfma_f32_16x16x32_bf16 v[44:47], v[140:143], v[172:175], v[44:47]
    v_mfma_f32_16x16x32_bf16 v[44:47], v[192:195], v[72:75], v[44:47]
    v_mfma_f32_16x16x32_bf16 v[48:51], v[224:227], v[72:75], v[48:51]
    ds_read_b128 v[72:75], v11 offset:3904
    s_waitcnt lgkmcnt(6)
    v_mfma_f32_16x16x32_bf16 v[48:51], v[220:223], v[76:79], v[48:51]
    ds_read_b128 v[76:79], v11 offset:3968
    v_mfma_f32_16x16x32_bf16 v[48:51], v[104:107], v[40:43], v[48:51]
    v_mfma_f32_16x16x32_bf16 v[48:51], v[100:103], v[16:19], v[48:51]
    v_mfma_f32_16x16x32_bf16 v[48:51], v[216:219], v[80:83], v[48:51]
    ds_read_b128 v[80:83], v11 offset:4032
    v_mfma_f32_16x16x32_bf16 v[48:51], v[96:99], v[20:23], v[48:51]
    s_waitcnt lgkmcnt(5)
    v_mfma_f32_16x16x32_bf16 v[48:51], v[92:95], v[24:27], v[48:51]
    v_mfma_f32_16x16x32_bf16 v[48:51], v[212:215], v[84:87], v[48:51]
    v_mfma_f32_16x16x32_bf16 v[48:51], v[160:163], v[184:187], v[48:51]
    v_mfma_f32_16x16x32_bf16 v[48:51], v[164:167], v[188:191], v[48:51]
    s_waitcnt lgkmcnt(3)
    ds_write_b128 v7, v[44:47] offset:17152
    v_mfma_f32_16x16x32_bf16 v[48:51], v[208:211], v[132:135], v[48:51]
    ds_write_b32 v88, v88 offset:96
    v_mfma_f32_16x16x32_bf16 v[48:51], v[136:139], v[176:179], v[48:51]
    v_mfma_f32_16x16x32_bf16 v[48:51], v[204:207], v[68:71], v[48:51]
    v_mfma_f32_16x16x32_bf16 v[48:51], v[140:143], v[180:183], v[48:51]
    s_waitcnt lgkmcnt(3)
    v_mfma_f32_16x16x32_bf16 v[48:51], v[200:203], v[72:75], v[48:51]
    v_mfma_f32_16x16x32_bf16 v[48:51], v[144:147], v[168:171], v[48:51]
    v_mfma_f32_16x16x32_bf16 v[48:51], v[196:199], v[76:79], v[48:51]
    v_mfma_f32_16x16x32_bf16 v[48:51], v[148:151], v[172:175], v[48:51]
    s_waitcnt lgkmcnt(2)
    v_mfma_f32_16x16x32_bf16 v[48:51], v[192:195], v[80:83], v[48:51]
    s_nop 7
    ds_write_b128 v7, v[48:51] offset:18432
    ds_write_b32 v88, v88 offset:112
    s_cmp_lg_u32 s39, 0
    s_cbranch_scc1 L_mw_end
    s_mul_i32 s42, s50, 9344
    s_add_u32 s42, s42, 69632
    v_add_u32 v18, s42, v3
    v_add_u32 v20, 4096, v18
    v_and_b32 v21, 0x70, v3
    s_add_u32 s42, s42, 5120
    v_add_u32 v21, s42, v21
    s_movk_i32 s61, 4096
    v_lshl_add_u32 v24, v9, 1, s54
    v_mov_b32 v35, s45
    s_barrier
L_part_poll:
    global_load_dwordx4 v[164:167], v21, s[36:37] sc1
    global_load_dwordx4 v[128:131], v18, s[36:37] offset:-4096 sc1
    global_load_dwordx4 v[132:135], v18, s[36:37] offset:-3072 sc1
    global_load_dwordx4 v[136:139], v18, s[36:37] offset:-2048 sc1
    global_load_dwordx4 v[140:143], v18, s[36:37] offset:-1024 sc1
    global_load_dwordx4 v[144:147], v18, s[36:37] offset:0 sc1
    global_load_dwordx4 v[148:151], v18, s[36:37] offset:1024 sc1
    global_load_dwordx4 v[152:155], v18, s[36:37] offset:2048 sc1
    global_load_dwordx4 v[156:159], v18, s[36:37] offset:3072 sc1
    global_load_dwordx4 v[160:163], v20, s[36:37] offset:0 sc1
    v_mul_u32_u24 v26, 4640, v9
    v_add_u32 v26, 135648, v26
    v_mul_u32_u24 v27, 33792, v9
    v_mov_b32 v25, 1280
    s_waitcnt vmcnt(9)
    v_bfe_u32 v28, v164, 8, 11
    v_lshl_add_u32 v29, v28, 1, v26
    v_lshrrev_b32 v30, 8, v28
    v_mad_u32_u24 v27, v30, v25, v27
    v_bfe_u32 v30, v28, 2, 2
    v_mul_u32_u24 v30, 320, v30
    v_and_b32 v33, 0xf0, v28
    v_add3_u32 v27, v27, v30, v33
    v_and_b32 v33, 3, v28
    v_lshl_add_u32 v30, v33, 2, v27
    ds_read_b128 v[36:39], v88 offset:112
    ds_read_u16_d16_hi v31, v29
    ds_read_b32 v32, v30 offset:9472
    v_mul_u32_u24 v28, 1152, v28
    v_add_u32 v28, v28, v24
    v_xor_b32 v22, v35, v164
    s_waitcnt vmcnt(8)
    v_xor_b32 v128, v35, v128
    v_or_b32 v22, v22, v128
    s_waitcnt vmcnt(7)
    v_xor_b32 v132, v35, v132
    v_pk_add_f32 v[130:131], v[130:131], v[134:135]
    v_pk_add_f32 v[128:129], v[128:129], v[132:133]
    s_waitcnt vmcnt(6)
    v_xor_b32 v136, v35, v136
    v_pk_add_f32 v[130:131], v[130:131], v[138:139]
    v_pk_add_f32 v[128:129], v[128:129], v[136:137]
    v_bitop3_b32 v22, v22, v132, v136 bitop3:0xfe
    s_waitcnt vmcnt(5)
    v_xor_b32 v140, v35, v140
    v_pk_add_f32 v[130:131], v[130:131], v[142:143]
    v_pk_add_f32 v[128:129], v[128:129], v[140:141]
    s_waitcnt vmcnt(4)
    v_xor_b32 v144, v35, v144
    v_pk_add_f32 v[130:131], v[130:131], v[146:147]
    v_pk_add_f32 v[128:129], v[128:129], v[144:145]
    v_bitop3_b32 v22, v22, v140, v144 bitop3:0xfe
    s_waitcnt vmcnt(3)
    v_xor_b32 v148, v35, v148
    v_pk_add_f32 v[130:131], v[130:131], v[150:151]
    v_pk_add_f32 v[128:129], v[128:129], v[148:149]
    s_waitcnt vmcnt(2)
    v_xor_b32 v152, v35, v152
    v_pk_add_f32 v[130:131], v[130:131], v[154:155]
    v_pk_add_f32 v[128:129], v[128:129], v[152:153]
    v_bitop3_b32 v22, v22, v148, v152 bitop3:0xfe
    s_waitcnt vmcnt(1)
    v_xor_b32 v156, v35, v156
    v_pk_add_f32 v[130:131], v[130:131], v[158:159]
    v_pk_add_f32 v[128:129], v[128:129], v[156:157]
    s_waitcnt vmcnt(0)
    v_xor_b32 v160, v35, v160
    v_pk_add_f32 v[130:131], v[130:131], v[162:163]
    v_pk_add_f32 v[128:129], v[128:129], v[160:161]
    v_bitop3_b32 v22, v22, v156, v160 bitop3:0xfe
    s_waitcnt lgkmcnt(0)
    v_bitop3_b32 v36, v37, v38, v39 bitop3:0x7f
    v_and_b32 v36, 128, v36
    v_or_b32 v22, v22, v36
    v_and_b32 v22, 0xff, v22
    v_cmp_ne_u32 vcc, 0, v22
    v_permlane32_swap_b32 v128, v130
    s_sub_u32 s61, s61, 1
    s_cselect_b64 vcc, 0, vcc
    s_cbranch_vccnz L_part_poll
    v_permlane32_swap_b32 v129, v131
    v_add_f32 v128, v128, v130
    v_add_f32 v129, v129, v131
    v_and_b32 v31, 0xffff0000, v31
    v_fma_f32 v34, v31, v167, v166
    v_permlane16_swap_b32 v128, v129
    v_add_f32 v128, v128, v129
    v_mul_f32 v31, 0x42000000, v31
    v_mul_f32 v32, 0x3d000000, v32
    v_add_f32_dpp v128, v128, v128 row_ror:8 row_mask:0xf bank_mask:0xf
    v_fma_f32 v128, v128, v165, v31
    v_mul_f32 v33, 0xbfb8aa3b, v128
    v_exp_f32 v33, v33
    v_mul_f32 v128, v128, v32
    v_add_f32 v33, 1.0, v33
    v_rcp_f32 v33, v33
    s_nop 0
    v_fmac_f32 v34, v128, v33
    v_cvt_pk_bf16_f32 v34, v34, v34
    global_store_short v28, v34, s[32:33]
L_mw_end:
    s_endpgm
L_helper:
    s_waitcnt lgkmcnt(0)
    s_barrier
    s_setprio 0
    s_lshr_b32 s42, s50, 1
    s_lshl_b32 s42, s42, 15
    s_and_b32 s43, s50, 1
    s_lshl_b32 s43, s43, 6
    s_add_u32 s42, s42, s43
    s_add_u32 s42, s42, 2097152
    s_add_u32 s12, s36, s42
    s_addc_u32 s13, s37, 0
    s_add_u32 s14, s12, 8192
    s_addc_u32 s15, s13, 0
    s_add_u32 s16, s12, 16384
    s_addc_u32 s17, s13, 0
    s_add_u32 s18, s12, 24576
    s_addc_u32 s19, s13, 0
    v_bfe_u32 v63, v0, 2, 6
    v_and_b32 v6, 0x30, v3
    v_lshl_add_u32 v6, v63, 7, v6
    global_load_dwordx4 v[40:43], v6, s[12:13] sc1
    global_load_dwordx4 v[44:47], v6, s[14:15] sc1
    global_load_dwordx4 v[48:51], v6, s[16:17] sc1
    global_load_dwordx4 v[52:55], v6, s[18:19] sc1
    v_and_b32 v62, 255, v0
    v_lshlrev_b32 v4, 4, v62
    v_add_u32 v4, 20480, v4
    v_add_u32 v7, 8192, v4
    global_load_dwordx4 v[224:227], v4, s[36:37] offset:-4096 sc1
    global_load_dwordx4 v[228:231], v4, s[36:37] offset:0 sc1
    global_load_dwordx4 v[232:235], v7, s[36:37] offset:-4096 sc1
    global_load_dwordx4 v[236:239], v7, s[36:37] offset:0 sc1
    v_mov_b32 v38, v63
    s_mul_i32 s42, s51, 1152
    s_lshl_b32 s43, s41, 6
    s_add_u32 s42, s42, s43
    s_add_u32 s42, s42, 2880
    s_mov_b32 s58, 2
    s_mul_i32 s43, s40, 1152
    s_add_u32 s43, s43, 884736
    s_mul_i32 s59, s40, 663552
    s_cmp_eq_u32 s58, 0
    s_cselect_b32 s56, s26, s28
    s_cselect_b32 s57, s27, s29
    s_cmp_eq_u32 s58, 2
    s_cselect_b32 s56, s30, s56
    s_cselect_b32 s57, s31, s57
    s_cselect_b32 s43, s59, s43
    s_movk_i32 s58, 128
    s_movk_i32 s59, 8064
    s_movk_i32 s60, 4319
    s_cmov_b32 s58, 73728
    s_cmov_b32 s59, -663424
    s_cmovk_i32 s60, 5183
    v_add_u32 v76, s42, v2
    v_min_u32 v76, s60, v76
    v_mul_u32_u24 v63, 7282, v76
    v_lshrrev_b32 v63, 16, v63
    v_mul_u32_u24 v76, s58, v76
    v_mad_i32_i24 v76, v63, s59, v76
    v_add_u32 v76, s43, v76
    v_mov_b32 v63, v38
    s_bfe_u32 s43, s46, 131072
    s_mul_i32 s43, s43, 0x20004000
    s_and_b32 s43, s43, 0x40004000
    v_mov_b32 v56, s43
    s_bfe_u32 s43, s46, 131074
    s_mul_i32 s43, s43, 0x20004000
    s_and_b32 s43, s43, 0x40004000
    v_mov_b32 v57, s43
    s_bfe_u32 s43, s46, 131076
    s_mul_i32 s43, s43, 0x20004000
    s_and_b32 s43, s43, 0x40004000
    v_mov_b32 v58, s43
    s_bfe_u32 s43, s46, 131078
    s_mul_i32 s43, s43, 0x20004000
    s_and_b32 s43, s43, 0x40004000
    v_mov_b32 v59, s43
    v_and_b32 v88, 3, v0
    v_mul_u32_u24 v5, 4640, v88
    v_lshl_add_u32 v5, v63, 4, v5
    v_add_u32 v5, 135648, v5
    v_mov_b32 v63, 0x40004000
    s_lshr_b32 s43, s51, 1
    s_lshl_b32 s43, s43, 4
    s_add_u32 s43, s43, 153728
    v_lshl_add_u32 v88, v88, 2, s43
    s_movk_i32 s61, 4096
    v_lshlrev_b32 v37, 2, v62
    v_add_u32 v64, 135648, v37
    v_add_u32 v65, 140288, v37
    v_add_u32 v66, 144928, v37
    v_add_u32 v67, 149568, v37
    v_bfe_u32 v37, v0, 1, 2
    v_mul_u32_u24 v37, 320, v37
    v_and_b32 v39, 0x78, v0
    v_lshl_add_u32 v37, v39, 1, v37
    v_and_b32 v39, 1, v0
    v_lshl_add_u32 v37, v39, 3, v37
    s_lshr_b32 s43, s51, 1
    s_mul_i32 s43, s43, 1280
    s_add_u32 s43, s43, 9472
    v_add_u32 v37, s43, v37
    v_add_u32 v39, 67584, v37
    v_mul_u32_u24 v36, 2304, v62
    v_add_u32 v36, s54, v36
    v_mov_b32 v8, 0xc238aa3b
    v_mov_b32 v9, 0xffff0000
    v_lshlrev_b32 v62, 6, v62
    v_xor_b32 v62, s44, v62
    v_and_b32 v10, 15, v0
    v_lshrrev_b32 v11, 1, v0
    v_and_b32 v11, 24, v11
    s_lshl_b32 s42, s51, 4
    s_mov_b32 s58, 939536384
    s_mov_b32 s59, 3672000
    s_lshr_b64 s[58:59], s[58:59], s42
    s_and_b32 s58, s58, 0xffff
    s_lshr_b32 s59, 535826400, s42
    s_and_b32 s59, s59, 0xffff
    s_lshl_b32 s42, s51, 10
    s_add_u32 s42, s42, 154048
    v_add_u32 v12, s42, v3
    v_lshlrev_b32 v13, v10, s58
    v_bfe_u32 v13, v13, v11, 8
    v_lshl_or_b32 v13, v13, 15, v13
    v_and_b32 v16, 65537, v13
    v_mul_u32_u24 v16, 16256, v16
    v_and_b32 v17, 262148, v13
    v_mul_u32_u24 v17, 4064, v17
    v_and_b32 v18, 1048592, v13
    v_mul_u32_u24 v18, 1016, v18
    v_and_b32 v19, 4194368, v13
    v_mul_u32_u24 v19, 254, v19
    ds_write_b128 v12, v[16:19] offset:0
    v_lshlrev_b32 v13, v10, s59
    v_bfe_u32 v13, v13, v11, 8
    v_lshl_or_b32 v13, v13, 15, v13
    v_and_b32 v20, 65537, v13
    v_mul_u32_u24 v20, 16256, v20
    v_and_b32 v21, 262148, v13
    v_mul_u32_u24 v21, 4064, v21
    v_and_b32 v22, 1048592, v13
    v_mul_u32_u24 v22, 1016, v22
    v_and_b32 v23, 4194368, v13
    v_mul_u32_u24 v23, 254, v23
    ds_write_b128 v12, v[20:23] offset:4096
    s_waitcnt vmcnt(4)
    s_setprio 3
L_tile_chk:
    v_xor_b32 v40, v56, v40
    v_xor_b32 v41, v57, v41
    v_xor_b32 v42, v58, v42
    v_xor_b32 v43, v59, v43
    ds_write_b128 v5, v[40:43] offset:0
    v_xor_b32 v44, v56, v44
    v_xor_b32 v45, v57, v45
    v_xor_b32 v46, v58, v46
    v_xor_b32 v47, v59, v47
    ds_write_b128 v5, v[44:47] offset:1024
    v_xor_b32 v48, v56, v48
    v_xor_b32 v49, v57, v49
    v_xor_b32 v50, v58, v50
    v_xor_b32 v51, v59, v51
    ds_write_b128 v5, v[48:51] offset:2048
    v_xor_b32 v52, v56, v52
    v_xor_b32 v53, v57, v53
    v_xor_b32 v54, v58, v54
    v_xor_b32 v55, v59, v55
    ds_write_b128 v5, v[52:55] offset:3072
    v_bitop3_b32 v38, v40, v41, v42 bitop3:0xfe
    v_bitop3_b32 v38, v38, v43, v44 bitop3:0xfe
    v_bitop3_b32 v38, v38, v45, v46 bitop3:0xfe
    v_bitop3_b32 v38, v38, v47, v48 bitop3:0xfe
    v_bitop3_b32 v38, v38, v49, v50 bitop3:0xfe
    v_bitop3_b32 v38, v38, v51, v52 bitop3:0xfe
    v_bitop3_b32 v38, v38, v53, v54 bitop3:0xfe
    v_bitop3_b32 v38, v38, v55, v63 bitop3:0xa8
    v_cmp_ne_u32 vcc, 0, v38
    s_cbranch_vccz L_tile_ok
    global_load_dwordx4 v[40:43], v6, s[12:13] sc1
    global_load_dwordx4 v[44:47], v6, s[14:15] sc1
    global_load_dwordx4 v[48:51], v6, s[16:17] sc1
    global_load_dwordx4 v[52:55], v6, s[18:19] sc1
    s_waitcnt vmcnt(0)
    s_sub_u32 s61, s61, 1
    s_cbranch_scc0 L_tile_chk
L_tile_ok:
    s_mov_b32 s61, 262144
    s_waitcnt vmcnt(0)
L_h_poll:
    v_mov_b32 v38, 0
    v_xor_b32 v13, 65504, v225
    v_bitop3_b32 v38, v38, v13, v62 bitop3:0xf6
    v_xor_b32 v13, 65472, v227
    v_bitop3_b32 v38, v38, v13, v62 bitop3:0xf6
    v_xor_b32 v13, 49120, v229
    v_bitop3_b32 v38, v38, v13, v62 bitop3:0xf6
    v_xor_b32 v13, 49088, v231
    v_bitop3_b32 v38, v38, v13, v62 bitop3:0xf6
    v_xor_b32 v13, 32736, v233
    v_bitop3_b32 v38, v38, v13, v62 bitop3:0xf6
    v_xor_b32 v13, 32704, v235
    v_bitop3_b32 v38, v38, v13, v62 bitop3:0xf6
    v_xor_b32 v13, 16352, v237
    v_bitop3_b32 v38, v38, v13, v62 bitop3:0xf6
    v_xor_b32 v13, 16320, v239
    v_bitop3_b32 v38, v38, v13, v62 bitop3:0xf6
    v_and_b32 v38, 0xffff, v38
    v_cmp_ne_u32 vcc, 0, v38
    s_cbranch_vccz L_h_ok
    global_load_dwordx4 v[224:227], v4, s[36:37] offset:-4096 sc1
    global_load_dwordx4 v[228:231], v4, s[36:37] offset:0 sc1
    global_load_dwordx4 v[232:235], v7, s[36:37] offset:-4096 sc1
    global_load_dwordx4 v[236:239], v7, s[36:37] offset:0 sc1
    s_waitcnt vmcnt(0)
    s_sub_u32 s61, s61, 64
    s_cbranch_scc0 L_h_poll
L_h_ok:
    s_waitcnt lgkmcnt(0)
    s_barrier
    ds_read2st64_b32 v[16:17], v64 offset0:0 offset1:4
    ds_read2st64_b32 v[18:19], v65 offset0:0 offset1:4
    ds_read2st64_b32 v[20:21], v66 offset0:0 offset1:4
    ds_read2st64_b32 v[22:23], v67 offset0:0 offset1:4
    ds_read2st64_b32 v[24:25], v64 offset0:8 offset1:12
    ds_read2st64_b32 v[26:27], v65 offset0:8 offset1:12
    ds_read2st64_b32 v[28:29], v66 offset0:8 offset1:12
    ds_read2st64_b32 v[30:31], v67 offset0:8 offset1:12
    s_setprio 0
    s_cmp_eq_u32 s47, 2
    s_cbranch_scc0 L_ct2
    global_load_dword v1, v76, s[56:57]
L_ct2:
    s_waitcnt lgkmcnt(4)
    v_lshlrev_b32 v96, 16, v16
    v_lshlrev_b32 v97, 16, v18
    v_lshlrev_b32 v98, 16, v20
    v_lshlrev_b32 v99, 16, v22
    v_mul_f32 v104, v8, v96
    v_mul_f32 v105, v8, v97
    v_mul_f32 v106, v8, v98
    v_mul_f32 v107, v8, v99
    v_exp_f32 v104, v104
    v_exp_f32 v105, v105
    v_exp_f32 v106, v106
    v_exp_f32 v107, v107
    v_and_b32 v121, v9, v224
    v_add_f32 v104, 1.0, v104
    v_add_f32 v105, 1.0, v105
    v_add_f32 v106, 1.0, v106
    v_add_f32 v107, 1.0, v107
    v_rcp_f32 v104, v104
    v_rcp_f32 v105, v105
    v_rcp_f32 v106, v106
    v_rcp_f32 v107, v107
    v_lshlrev_b32 v120, 16, v224
    v_and_b32 v100, v9, v16
    v_and_b32 v101, v9, v18
    v_and_b32 v102, v9, v20
    v_and_b32 v103, v9, v22
    v_mul_f32 v108, v8, v100
    v_mul_f32 v109, v8, v101
    v_mul_f32 v110, v8, v102
    v_mul_f32 v111, v8, v103
    v_exp_f32 v108, v108
    v_exp_f32 v109, v109
    v_exp_f32 v110, v110
    v_exp_f32 v111, v111
    v_and_b32 v123, v9, v226
    v_add_f32 v108, 1.0, v108
    v_add_f32 v109, 1.0, v109
    v_add_f32 v110, 1.0, v110
    v_add_f32 v111, 1.0, v111
    v_rcp_f32 v108, v108
    v_rcp_f32 v109, v109
    v_rcp_f32 v110, v110
    v_rcp_f32 v111, v111
    v_lshlrev_b32 v122, 16, v226
    s_setprio 2
L_w0:
    ds_read_b32 v41, v88 offset:0
    s_waitcnt lgkmcnt(0)
    v_cmp_eq_u32 vcc, 0, v41
    s_cbranch_vccz L_w0_ok
    s_sleep 2
    s_sub_u32 s61, s61, 1
    s_cbranch_scc0 L_w0
L_w0_ok:
    ds_read_b64 v[44:45], v37 offset:0
    ds_read_b64 v[46:47], v37 offset:33792
    ds_read_b64 v[48:49], v39 offset:0
    ds_read_b64 v[50:51], v39 offset:33792
    s_setprio 0
    s_waitcnt lgkmcnt(0)
    v_fma_f32 v112, v44, v104, v121
    v_fma_f32 v113, v46, v105, v121
    v_fma_f32 v114, v48, v106, v121
    v_fma_f32 v115, v50, v107, v121
    v_fma_f32 v96, v96, v112, v120
    v_fma_f32 v97, v97, v113, v120
    v_fma_f32 v98, v98, v114, v120
    v_fma_f32 v99, v99, v115, v120
    v_cvt_pk_bf16_f32 v104, v96, v97
    v_cvt_pk_bf16_f32 v105, v98, v99
    global_store_dwordx2 v36, v[104:105], s[32:33] offset:0
    v_fma_f32 v116, v45, v108, v123
    v_fma_f32 v117, v47, v109, v123
    v_fma_f32 v118, v49, v110, v123
    v_fma_f32 v119, v51, v111, v123
    v_fma_f32 v100, v100, v116, v122
    v_fma_f32 v101, v101, v117, v122
    v_fma_f32 v102, v102, v118, v122
    v_fma_f32 v103, v103, v119, v122
    v_cvt_pk_bf16_f32 v108, v100, v101
    v_cvt_pk_bf16_f32 v109, v102, v103
    v_lshlrev_b32 v128, 16, v17
    v_lshlrev_b32 v129, 16, v19
    v_lshlrev_b32 v130, 16, v21
    v_lshlrev_b32 v131, 16, v23
    v_mul_f32 v136, v8, v128
    v_mul_f32 v137, v8, v129
    v_mul_f32 v138, v8, v130
    v_mul_f32 v139, v8, v131
    v_exp_f32 v136, v136
    v_exp_f32 v137, v137
    v_exp_f32 v138, v138
    v_exp_f32 v139, v139
    v_and_b32 v153, v9, v228
    v_add_f32 v136, 1.0, v136
    v_add_f32 v137, 1.0, v137
    v_add_f32 v138, 1.0, v138
    v_add_f32 v139, 1.0, v139
    v_rcp_f32 v136, v136
    v_rcp_f32 v137, v137
    v_rcp_f32 v138, v138
    v_rcp_f32 v139, v139
    v_lshlrev_b32 v152, 16, v228
    global_store_dwordx2 v36, v[108:109], s[32:33] offset:1152
    v_add_u32 v36, 589824, v36
    v_and_b32 v132, v9, v17
    v_and_b32 v133, v9, v19
    v_and_b32 v134, v9, v21
    v_and_b32 v135, v9, v23
    v_mul_f32 v140, v8, v132
    v_mul_f32 v141, v8, v133
    v_mul_f32 v142, v8, v134
    v_mul_f32 v143, v8, v135
    v_exp_f32 v140, v140
    v_exp_f32 v141, v141
    v_exp_f32 v142, v142
    v_exp_f32 v143, v143
    v_and_b32 v155, v9, v230
    v_add_f32 v140, 1.0, v140
    v_add_f32 v141, 1.0, v141
    v_add_f32 v142, 1.0, v142
    v_add_f32 v143, 1.0, v143
    v_rcp_f32 v140, v140
    v_rcp_f32 v141, v141
    v_rcp_f32 v142, v142
    v_rcp_f32 v143, v143
    v_lshlrev_b32 v154, 16, v230
    s_setprio 2
L_w1:
    ds_read_b32 v41, v88 offset:32
    s_waitcnt lgkmcnt(0)
    v_cmp_eq_u32 vcc, 0, v41
    s_cbranch_vccz L_w1_ok
    s_sleep 2
    s_sub_u32 s61, s61, 1
    s_cbranch_scc0 L_w1
L_w1_ok:
    ds_read_b64 v[44:45], v37 offset:2560
    ds_read_b64 v[46:47], v37 offset:36352
    ds_read_b64 v[48:49], v39 offset:2560
    ds_read_b64 v[50:51], v39 offset:36352
    s_setprio 0
    s_waitcnt lgkmcnt(0)
    v_fma_f32 v144, v44, v136, v153
    v_fma_f32 v145, v46, v137, v153
    v_fma_f32 v146, v48, v138, v153
    v_fma_f32 v147, v50, v139, v153
    v_fma_f32 v128, v128, v144, v152
    v_fma_f32 v129, v129, v145, v152
    v_fma_f32 v130, v130, v146, v152
    v_fma_f32 v131, v131, v147, v152
    v_cvt_pk_bf16_f32 v136, v128, v129
    v_cvt_pk_bf16_f32 v137, v130, v131
    global_store_dwordx2 v36, v[136:137], s[32:33] offset:0
    v_fma_f32 v148, v45, v140, v155
    v_fma_f32 v149, v47, v141, v155
    v_fma_f32 v150, v49, v142, v155
    v_fma_f32 v151, v51, v143, v155
    v_fma_f32 v132, v132, v148, v154
    v_fma_f32 v133, v133, v149, v154
    v_fma_f32 v134, v134, v150, v154
    v_fma_f32 v135, v135, v151, v154
    v_cvt_pk_bf16_f32 v140, v132, v133
    v_cvt_pk_bf16_f32 v141, v134, v135
    v_lshlrev_b32 v160, 16, v24
    v_lshlrev_b32 v161, 16, v26
    v_lshlrev_b32 v162, 16, v28
    v_lshlrev_b32 v163, 16, v30
    v_mul_f32 v168, v8, v160
    v_mul_f32 v169, v8, v161
    v_mul_f32 v170, v8, v162
    v_mul_f32 v171, v8, v163
    v_exp_f32 v168, v168
    v_exp_f32 v169, v169
    v_exp_f32 v170, v170
    v_exp_f32 v171, v171
    v_and_b32 v185, v9, v232
    v_add_f32 v168, 1.0, v168
    v_add_f32 v169, 1.0, v169
    v_add_f32 v170, 1.0, v170
    v_add_f32 v171, 1.0, v171
    v_rcp_f32 v168, v168
    v_rcp_f32 v169, v169
    v_rcp_f32 v170, v170
    v_rcp_f32 v171, v171
    v_lshlrev_b32 v184, 16, v232
    global_store_dwordx2 v36, v[140:141], s[32:33] offset:1152
    v_add_u32 v36, 589824, v36
    v_and_b32 v164, v9, v24
    v_and_b32 v165, v9, v26
    v_and_b32 v166, v9, v28
    v_and_b32 v167, v9, v30
    v_mul_f32 v172, v8, v164
    v_mul_f32 v173, v8, v165
    v_mul_f32 v174, v8, v166
    v_mul_f32 v175, v8, v167
    v_exp_f32 v172, v172
    v_exp_f32 v173, v173
    v_exp_f32 v174, v174
    v_exp_f32 v175, v175
    v_and_b32 v187, v9, v234
    v_add_f32 v172, 1.0, v172
    v_add_f32 v173, 1.0, v173
    v_add_f32 v174, 1.0, v174
    v_add_f32 v175, 1.0, v175
    v_rcp_f32 v172, v172
    v_rcp_f32 v173, v173
    v_rcp_f32 v174, v174
    v_rcp_f32 v175, v175
    v_lshlrev_b32 v186, 16, v234
    s_setprio 2
L_w2:
    ds_read_b32 v41, v88 offset:64
    s_waitcnt lgkmcnt(0)
    v_cmp_eq_u32 vcc, 0, v41
    s_cbranch_vccz L_w2_ok
    s_sleep 2
    s_sub_u32 s61, s61, 1
    s_cbranch_scc0 L_w2
L_w2_ok:
    ds_read_b64 v[44:45], v37 offset:5120
    ds_read_b64 v[46:47], v37 offset:38912
    ds_read_b64 v[48:49], v39 offset:5120
    ds_read_b64 v[50:51], v39 offset:38912
    s_setprio 0
    s_waitcnt lgkmcnt(0)
    v_fma_f32 v176, v44, v168, v185
    v_fma_f32 v177, v46, v169, v185
    v_fma_f32 v178, v48, v170, v185
    v_fma_f32 v179, v50, v171, v185
    v_fma_f32 v160, v160, v176, v184
    v_fma_f32 v161, v161, v177, v184
    v_fma_f32 v162, v162, v178, v184
    v_fma_f32 v163, v163, v179, v184
    v_cvt_pk_bf16_f32 v168, v160, v161
    v_cvt_pk_bf16_f32 v169, v162, v163
    global_store_dwordx2 v36, v[168:169], s[32:33] offset:0
    v_fma_f32 v180, v45, v172, v187
    v_fma_f32 v181, v47, v173, v187
    v_fma_f32 v182, v49, v174, v187
    v_fma_f32 v183, v51, v175, v187
    v_fma_f32 v164, v164, v180, v186
    v_fma_f32 v165, v165, v181, v186
    v_fma_f32 v166, v166, v182, v186
    v_fma_f32 v167, v167, v183, v186
    v_cvt_pk_bf16_f32 v172, v164, v165
    v_cvt_pk_bf16_f32 v173, v166, v167
    v_lshlrev_b32 v192, 16, v25
    v_lshlrev_b32 v193, 16, v27
    v_lshlrev_b32 v194, 16, v29
    v_lshlrev_b32 v195, 16, v31
    v_mul_f32 v200, v8, v192
    v_mul_f32 v201, v8, v193
    v_mul_f32 v202, v8, v194
    v_mul_f32 v203, v8, v195
    v_exp_f32 v200, v200
    v_exp_f32 v201, v201
    v_exp_f32 v202, v202
    v_exp_f32 v203, v203
    v_and_b32 v217, v9, v236
    v_add_f32 v200, 1.0, v200
    v_add_f32 v201, 1.0, v201
    v_add_f32 v202, 1.0, v202
    v_add_f32 v203, 1.0, v203
    v_rcp_f32 v200, v200
    v_rcp_f32 v201, v201
    v_rcp_f32 v202, v202
    v_rcp_f32 v203, v203
    v_lshlrev_b32 v216, 16, v236
    global_store_dwordx2 v36, v[172:173], s[32:33] offset:1152
    v_add_u32 v36, 589824, v36
    v_and_b32 v196, v9, v25
    v_and_b32 v197, v9, v27
    v_and_b32 v198, v9, v29
    v_and_b32 v199, v9, v31
    v_mul_f32 v204, v8, v196
    v_mul_f32 v205, v8, v197
    v_mul_f32 v206, v8, v198
    v_mul_f32 v207, v8, v199
    v_exp_f32 v204, v204
    v_exp_f32 v205, v205
    v_exp_f32 v206, v206
    v_exp_f32 v207, v207
    v_and_b32 v219, v9, v238
    v_add_f32 v204, 1.0, v204
    v_add_f32 v205, 1.0, v205
    v_add_f32 v206, 1.0, v206
    v_add_f32 v207, 1.0, v207
    v_rcp_f32 v204, v204
    v_rcp_f32 v205, v205
    v_rcp_f32 v206, v206
    v_rcp_f32 v207, v207
    v_lshlrev_b32 v218, 16, v238
    s_setprio 2
L_w3:
    ds_read_b32 v41, v88 offset:96
    ds_read_b64 v[44:45], v37 offset:7680
    ds_read_b64 v[46:47], v37 offset:41472
    ds_read_b64 v[48:49], v39 offset:7680
    ds_read_b64 v[50:51], v39 offset:41472
    s_waitcnt lgkmcnt(0)
    v_cmp_eq_u32 vcc, 0, v41
    s_cbranch_vccz L_w3_ok
    s_sleep 1
    s_sub_u32 s61, s61, 1
    s_cbranch_scc0 L_w3
L_w3_ok:
    v_fma_f32 v208, v44, v200, v217
    v_fma_f32 v209, v46, v201, v217
    v_fma_f32 v210, v48, v202, v217
    v_fma_f32 v211, v50, v203, v217
    v_fma_f32 v192, v192, v208, v216
    v_fma_f32 v193, v193, v209, v216
    v_fma_f32 v194, v194, v210, v216
    v_fma_f32 v195, v195, v211, v216
    v_cvt_pk_bf16_f32 v200, v192, v193
    v_cvt_pk_bf16_f32 v201, v194, v195
    global_store_dwordx2 v36, v[200:201], s[32:33] offset:0
    v_fma_f32 v212, v45, v204, v219
    v_fma_f32 v213, v47, v205, v219
    v_fma_f32 v214, v49, v206, v219
    v_fma_f32 v215, v51, v207, v219
    v_fma_f32 v196, v196, v212, v218
    v_fma_f32 v197, v197, v213, v218
    v_fma_f32 v198, v198, v214, v218
    v_fma_f32 v199, v199, v215, v218
    v_cvt_pk_bf16_f32 v204, v196, v197
    v_cvt_pk_bf16_f32 v205, v198, v199
    global_store_dwordx2 v36, v[204:205], s[32:33] offset:1152
    s_waitcnt vmcnt(0)
    s_barrier
    s_endpgm
L_lnp:
    s_mul_i32 s43, s39, 1216
    s_add_u32 s43, s43, 154048
    v_add_u32 v52, s43, v3
    v_add_u32 v53, s43, v4
    s_lshl_b32 s43, s39, 3
    s_add_u32 s43, s43, 163776
    v_mov_b32 v54, s43
    v_bfe_u32 v55, v0, 2, 2
    v_mul_u32_u24 v55, 1216, v55
    v_and_b32 v56, 3, v0
    v_lshl_add_u32 v55, v56, 3, v55
    v_lshrrev_b32 v56, 4, v0
    v_lshl_add_u32 v55, v56, 5, v55
    v_add_u32 v55, 154048, v55
    v_lshrrev_b32 v56, 3, v0
    v_lshlrev_b32 v56, 15, v56
    v_and_b32 v57, 112, v3
    s_lshl_b32 s43, s2, 7
    s_add_u32 s43, s43, 2097152
    v_add3_u32 v56, v56, v57, s43
    v_mov_b32 v40, 0
    v_mov_b32 v41, 0
    v_mov_b32 v42, 0
    v_mov_b32 v43, 0
    v_mov_b32 v44, 0x3ae38e39
    v_mov_b32 v38, 0xbfffbfff
    v_mov_b32 v37, 0xffff
    s_lshl_b32 s58, s2, 3
    s_add_u32 s58, s58, s39
    s_xor_b32 s58, s58, 0x7ff
    s_lshl_b32 s58, s58, 5
    s_waitcnt lgkmcnt(0)
    s_add_u32 s38, s38, 0x9e370001
    s_lshr_b32 s44, s38, 16
    s_and_b32 s45, s38, 0xff
    s_and_b32 s46, s38, 0xfb
    s_bitcmp0_b32 s38, 0
    s_cselect_b32 s43, 4, 0
    s_or_b32 s46, s46, s43
    s_bitcmp1_b32 s46, s39
    s_cselect_b32 s43, 0x40004000, 0
    v_mov_b32 v39, s43
    s_xor_b32 s58, s58, s44
    v_mov_b32 v57, s58
    s_mov_b32 s42, 0x3f803f80
    s_cmp_lt_u32 s41, 27
    s_cbranch_scc1 L_lw2
    s_cmp_lt_u32 s39, 2
    s_cbranch_scc0 L_lw1
    global_load_dword v1, v76, s[56:57]
    s_waitcnt vmcnt(1)
    s_branch L_ln
L_lw1:
    s_waitcnt vmcnt(0)
    s_branch L_ln
L_lw2:
    s_add_u32 m0, s49, 0
    s_nop 0
    global_load_lds_dwordx4 v76, s[56:57]
    v_add_u32 v76, 294912, v76
    s_add_u32 m0, s49, 4096
    s_nop 0
    global_load_lds_dwordx4 v76, s[56:57]
    v_add_u32 v76, 294912, v76
    s_add_u32 m0, s49, 8192
    s_nop 0
    global_load_lds_dwordx4 v76, s[56:57]
    v_add_u32 v76, 294912, v76
    s_waitcnt vmcnt(3)
L_ln:
    v_dot2c_f32_bf16 v40, s42, v12
    v_dot2c_f32_bf16 v41, v12, v12
    v_dot2c_f32_bf16 v42, v12, v20
    v_dot2c_f32_bf16 v43, s42, v20
    v_dot2c_f32_bf16 v40, s42, v13
    v_dot2c_f32_bf16 v41, v13, v13
    v_dot2c_f32_bf16 v42, v13, v21
    v_dot2c_f32_bf16 v43, s42, v21
    v_dot2c_f32_bf16 v40, s42, v14
    v_dot2c_f32_bf16 v41, v14, v14
    v_dot2c_f32_bf16 v42, v14, v22
    v_dot2c_f32_bf16 v43, s42, v22
    v_dot2c_f32_bf16 v40, s42, v15
    v_dot2c_f32_bf16 v41, v15, v15
    v_dot2c_f32_bf16 v42, v15, v23
    v_dot2c_f32_bf16 v43, s42, v23
    v_dot2c_f32_bf16 v40, s42, v16
    v_dot2c_f32_bf16 v41, v16, v16
    v_dot2c_f32_bf16 v42, v16, v24
    v_dot2c_f32_bf16 v43, s42, v24
    v_lshlrev_b32 v36, 16, v16
    v_lshlrev_b32 v28, 16, v12
    v_and_b32 v29, 0xffff0000, v12
    v_permlane32_swap_b32 v40, v42
    v_permlane32_swap_b32 v41, v43
    v_add_f32 v40, v40, v42
    v_add_f32 v41, v41, v43
    v_lshlrev_b32 v30, 16, v13
    v_and_b32 v31, 0xffff0000, v13
    v_permlane16_swap_b32 v40, v41
    v_add_f32 v40, v40, v41
    v_lshlrev_b32 v32, 16, v14
    v_and_b32 v33, 0xffff0000, v14
    v_add_f32_dpp v40, v40, v40 row_ror:8 row_mask:0xf bank_mask:0xf
    v_lshlrev_b32 v34, 16, v15
    v_and_b32 v35, 0xffff0000, v15
    v_add_f32_dpp v40, v40, v40 row_ror:4 row_mask:0xf bank_mask:0xf
    s_nop 1
    v_add_f32_dpp v40, v40, v40 row_ror:2 row_mask:0xf bank_mask:0xf
    s_nop 1
    v_add_f32_dpp v40, v40, v40 row_ror:1 row_mask:0xf bank_mask:0xf
    s_nop 0
    v_readlane_b32 s58, v40, 0
    v_readlane_b32 s59, v40, 16
    v_readlane_b32 s60, v40, 32
    v_readlane_b32 s61, v40, 48
    v_mul_f32 v40, s58, v44
    v_mul_f32 v41, s59, v44
    v_fma_f32 v41, -v40, v40, v41
    v_max_f32 v41, 0, v41
    v_cvt_pk_bf16_f32 v44, v41, v40
    v_lshlrev_b32 v41, 16, v44
    v_add_f32 v41, 0x3727c5ac, v41
    v_cvt_pk_bf16_f32 v41, v41, v41
    v_and_b32 v41, 0xffff0000, v41
    v_mul_f32 v41, 0x44800000, v41
    v_sqrt_f32 v41, v41
    v_and_b32 v49, 0xffff0000, v44
    v_cvt_pk_bf16_f32 v50, v49, v41
    v_and_b32 v41, 0xffff0000, v50
    v_rcp_f32 v46, v41
    v_mul_f32 v42, s61, v49
    v_mul_f32 v47, v49, v46
    v_fma_f32 v28, v28, v46, -v47
    v_fma_f32 v29, v29, v46, -v47
    v_fma_f32 v30, v30, v46, -v47
    v_fma_f32 v31, v31, v46, -v47
    v_fma_f32 v32, v32, v46, -v47
    v_fma_f32 v33, v33, v46, -v47
    v_fma_f32 v34, v34, v46, -v47
    v_fma_f32 v35, v35, v46, -v47
    v_fma_f32 v36, v36, v46, -v47
    v_cvt_pk_bf16_f32 v28, v28, v29
    v_cvt_pk_bf16_f32 v29, v30, v31
    v_cvt_pk_bf16_f32 v30, v32, v33
    v_cvt_pk_bf16_f32 v31, v34, v35
    v_cvt_pk_bf16_f32 v32, v36, v36
    v_bitop3_b32 v28, v28, v38, v39 bitop3:0xea
    v_bitop3_b32 v29, v29, v38, v39 bitop3:0xea
    v_bitop3_b32 v30, v30, v38, v39 bitop3:0xea
    v_bitop3_b32 v31, v31, v38, v39 bitop3:0xea
    v_bitop3_b32 v32, v32, v38, v39 bitop3:0xea
    ds_write_b128 v52, v[28:31]
    ds_write_b16 v53, v32 offset:1024
    v_sub_f32 v42, s60, v42
    v_mul_f32 v42, 0x42000000, v42
    v_mul_f32 v42, v42, v46
    v_cvt_pk_bf16_f32 v42, v42, v42
    v_ashrrev_i32 v43, 31, v42
    v_or_b32 v43, 0x80000000, v43
    v_xor_b32 v42, v42, v43
    v_bitop3_b32 v51, v37, v57, v42 bitop3:0xca
    s_mov_b64 exec, 1
    ds_write_b64 v54, v[50:51]
    s_mov_b64 exec, -1
    s_waitcnt lgkmcnt(0)
    s_barrier
    s_cmp_eq_u32 s39, 1
    s_cbranch_scc1 L_ln_stat
    ds_read_b64_tr_b16 v[28:29], v55
    ds_read_b64_tr_b16 v[30:31], v55 offset:4864
    s_cmp_eq_u32 s39, 0
    s_cbranch_scc0 L_ln_st
    ds_read_b64_tr_b16 v[32:33], v55 offset:1024
    ds_read_b64_tr_b16 v[34:35], v55 offset:5888
    v_add_u32 v38, 2097152, v56
    s_waitcnt lgkmcnt(0)
    global_store_dwordx4 v38, v[32:35], s[36:37] sc1
    s_branch L_ln_st
L_ln_stat:
    v_and_b32 v41, 0x30, v3
    v_add_u32 v40, 163776, v41
    ds_read_b128 v[48:51], v40
    ds_read_b64_tr_b16 v[28:29], v55
    ds_read_b64_tr_b16 v[30:31], v55 offset:4864
    s_lshl_b32 s43, s2, 6
    s_add_u32 s43, s43, 16384
    v_add_u32 v41, s43, v41
    s_mov_b64 exec, 15
    s_waitcnt lgkmcnt(2)
    global_store_dwordx4 v41, v[48:51], s[36:37] sc1
    s_mov_b64 exec, -1
L_ln_st:
    s_waitcnt lgkmcnt(0)
    global_store_dwordx4 v56, v[28:31], s[36:37] sc1
    s_barrier
    s_cmp_lt_u32 s41, 27
    s_cbranch_scc1 L_ffn
    s_cmp_lt_u32 s39, 2
    s_cbranch_scc1 L_sp2
    global_load_dword v1, v76, s[56:57]
L_sp2:
    s_mul_i32 s42, s39, 320
    s_add_u32 s42, s42, s53
    s_add_u32 s42, s42, 640
    s_mov_b32 s58, 2
    s_mul_i32 s43, s40, 1152
    s_add_u32 s43, s43, 884736
    s_mul_i32 s59, s40, 663552
    s_cmp_eq_u32 s58, 0
    s_cselect_b32 s56, s26, s28
    s_cselect_b32 s57, s27, s29
    s_cmp_eq_u32 s58, 2
    s_cselect_b32 s56, s30, s56
    s_cselect_b32 s57, s31, s57
    s_cselect_b32 s43, s59, s43
    s_movk_i32 s58, 128
    s_movk_i32 s59, 8064
    s_movk_i32 s60, 4319
    s_cmov_b32 s58, 73728
    s_cmov_b32 s59, -663424
    s_cmovk_i32 s60, 5183
    v_add_u32 v76, s42, v2
    v_min_u32 v76, s60, v76
    v_mul_u32_u24 v63, 7282, v76
    v_lshrrev_b32 v63, 16, v63
    v_mul_u32_u24 v76, s58, v76
    v_mad_i32_i24 v76, v63, s59, v76
    v_add_u32 v76, s43, v76
    s_barrier
    global_load_dword v1, v76, s[56:57]
    s_waitcnt vmcnt(0)
    s_endpgm
L_ffn:
    v_bfe_u32 v14, v0, 4, 2
    v_and_b32 v11, 7, v0
    v_mov_b32 v26, 147456
    v_mov_b32 v27, 4
    s_cmp_eq_u32 s52, 0
    s_cbranch_scc0 L_gu
    s_setprio 1
    v_lshlrev_b32 v8, 4, v0
    v_add_u32 v9, 20480, v8
    v_add_u32 v10, 8192, v9
    v_lshlrev_b32 v13, 6, v0
    v_xor_b32 v128, 65504, v13
    v_xor_b32 v129, 65472, v13
    v_xor_b32 v130, 49120, v13
    v_xor_b32 v131, 49088, v13
    v_xor_b32 v132, 32736, v13
    v_xor_b32 v133, 32704, v13
    v_xor_b32 v134, 16352, v13
    v_xor_b32 v135, 16320, v13
    v_mov_b32 v36, s44
    v_lshrrev_b32 v25, 5, v0
    v_lshl_add_u32 v25, v25, 2, v26
    s_mul_i32 s62, s39, 80
    s_add_u32 s62, s62, 147584
    v_and_b32 v15, 0x3c, v0
    v_add_u32 v15, s62, v15
    v_and_b32 v16, 3, v0
    v_mul_u32_u24 v16, 80, v16
    v_add_u32 v16, 147584, v16
    v_lshrrev_b32 v12, 3, v2
    v_lshl_add_u32 v17, v12, 2, v26
    v_lshl_add_u32 v18, v11, 2, v26
    v_and_b32 v12, 6, v12
    v_xor_b32 v12, v12, v11
    v_lshlrev_b32 v12, 4, v12
    v_lshl_add_u32 v12, v1, 7, v12
    v_add_u32 v12, 2358144, v12
    s_lshl_b32 s63, s54, 7
    s_add_u32 s63, s63, 2358144
    v_mov_b32 v37, s63
    s_movk_i32 s63, -1152
    s_mul_i32 s64, s39, 1056
    s_mul_i32 s42, s50, 73728
    s_add_u32 s12, s30, s42
    s_addc_u32 s13, s31, 0
    s_add_u32 s14, s12, 18432
    s_addc_u32 s15, s13, 0
    s_add_u32 s16, s12, 36864
    s_addc_u32 s17, s13, 0
    s_add_u32 s18, s12, 55296
    s_addc_u32 s19, s13, 0
    v_mul_u32_u24 v19, 4608, v14
    v_and_b32 v20, 0xf0, v3
    s_lshl_b32 s42, s51, 8
    v_add3_u32 v19, v19, v20, s42
    v_lshrrev_b32 v20, 1, v2
    v_mul_u32_u24 v20, 1152, v20
    v_and_b32 v21, 16, v3
    s_lshl_b32 s42, s51, 5
    v_add3_u32 v20, v20, v21, s42
    v_bfe_i32 v232, v0, 3, 1
    v_mul_u32_u24 v4, 74752, v14
    v_lshl_add_u32 v4, v11, 4, v4
    v_and_b32 v5, 37376, v232
    s_lshl_b32 s43, s50, 7
    s_add_u32 s43, s43, 65536
    s_mul_i32 s42, s51, 299008
    s_add_u32 s42, s42, s43
    v_add3_u32 v4, v4, v5, s42
    v_add_u32 v5, 18688, v4
    v_add_u32 v6, 9344, v4
    v_add_u32 v7, 28032, v4
    v_mul_u32_u24 v8, 9344, v14
    v_lshl_add_u32 v8, v11, 4, v8
    s_mul_i32 s42, s51, 37376
    s_add_u32 s42, s42, s43
    s_add_u32 s42, s42, 1196032
    v_add_u32 v8, s42, v8
    v_mov_b32 v233, s45
    v_mov_b32 v234, 0xff
    v_and_b32 v235, 0x370, v3
    v_add_u32 v235, 147968, v235
    s_lshl_b32 s42, s51, 10
    s_add_u32 s42, s42, 159520
    v_add_u32 v236, s42, v3
    v_lshl_add_u32 v237, v2, 3, s42
    s_mov_b32 s66, 0x05040100
    s_mov_b32 s67, 0x07060302
    s_movk_i32 s55, 4096
    s_waitcnt vmcnt(0)
    s_barrier
    global_load_dwordx4 v[112:115], v9, s[36:37] offset:-4096 sc1
    global_load_dwordx4 v[116:119], v9, s[36:37] offset:0 sc1
    global_load_dwordx4 v[120:123], v10, s[36:37] offset:-4096 sc1
    global_load_dwordx4 v[124:127], v10, s[36:37] offset:0 sc1
L_ffn_poll:
    v_mov_b32 v24, 0
    s_waitcnt vmcnt(3)
    v_xor_b32 v28, v36, v113
    v_bitop3_b32 v24, v24, v28, v128 bitop3:0xf6
    v_xor_b32 v29, v36, v115
    v_bitop3_b32 v24, v24, v29, v129 bitop3:0xf6
    s_waitcnt vmcnt(2)
    v_xor_b32 v30, v36, v117
    v_bitop3_b32 v24, v24, v30, v130 bitop3:0xf6
    v_xor_b32 v31, v36, v119
    v_bitop3_b32 v24, v24, v31, v131 bitop3:0xf6
    s_waitcnt vmcnt(1)
    v_xor_b32 v32, v36, v121
    v_bitop3_b32 v24, v24, v32, v132 bitop3:0xf6
    v_xor_b32 v33, v36, v123
    v_bitop3_b32 v24, v24, v33, v133 bitop3:0xf6
    s_waitcnt vmcnt(0)
    v_xor_b32 v34, v36, v125
    v_bitop3_b32 v24, v24, v34, v134 bitop3:0xf6
    v_xor_b32 v35, v36, v127
    v_bitop3_b32 v24, v24, v35, v135 bitop3:0xf6
    v_and_b32 v24, 0xffff, v24
    v_cmp_ne_u32 vcc, 0, v24
    v_max3_u32 v38, v28, v29, v30
    v_max3_u32 v39, v31, v32, v33
    s_cbranch_vccz L_ffn_go
    global_load_dwordx4 v[112:115], v9, s[36:37] offset:-4096 sc1
    global_load_dwordx4 v[116:119], v9, s[36:37] offset:0 sc1
    global_load_dwordx4 v[120:123], v10, s[36:37] offset:-4096 sc1
    global_load_dwordx4 v[124:127], v10, s[36:37] offset:0 sc1
    s_sub_u32 s55, s55, 1
    s_cbranch_scc0 L_ffn_poll
    s_waitcnt vmcnt(0)
L_ffn_go:
    s_barrier
    v_max3_u32 v38, v38, v34, v35
    v_max_u32 v38, v38, v39
    v_alignbit_b32 v24, 1, v38, 5
    v_sub_u32 v128, v28, v38
    v_sub_u32 v129, v29, v38
    v_max_u32_dpp v21, v24, v24 row_ror:1 row_mask:0xf bank_mask:0xf
    v_sub_u32 v130, v30, v38
    v_sub_u32 v131, v31, v38
    v_max_u32_dpp v21, v21, v21 row_ror:2 row_mask:0xf bank_mask:0xf
    v_sub_u32 v132, v32, v38
    v_sub_u32 v133, v33, v38
    v_max_u32_dpp v21, v21, v21 row_ror:4 row_mask:0xf bank_mask:0xf
    v_sub_u32 v134, v34, v38
    v_sub_u32 v135, v35, v38
    v_max_u32_dpp v21, v21, v21 row_ror:8 row_mask:0xf bank_mask:0xf
    v_max3_u32 v39, v128, v129, v130
    v_max3_u32 v22, v131, v132, v133
    v_max_u32_dpp v21, v21, v21 row_bcast:15 row_mask:0xa bank_mask:0xf
    s_mov_b32 exec_lo, 0x80000000
    s_mov_b32 exec_hi, 0x80000000
    ds_write_b32 v25, v21
    s_mov_b64 exec, -1
    s_mov_b32 s55, 262144
    ds_read_b128 v[112:115], v26
    ds_read_b128 v[116:119], v26 offset:16
    v_max3_u32 v39, v39, v134, v135
    v_max_u32 v39, v39, v22
    v_add_u32 v39, v39, v38
    v_alignbit_b32 v23, 1, v39, 5
L_s1:
    s_waitcnt lgkmcnt(0)
    v_min3_u32 v21, v112, v113, v114
    v_min3_u32 v22, v115, v116, v117
    v_min3_u32 v21, v21, v118, v119
    v_min_u32 v21, v21, v22
    v_cmp_eq_u32 vcc, 0, v21
    v_cmp_ge_u32 s[6:7], v24, v21
    v_cmp_ge_u32 s[8:9], v23, v21
    s_cbranch_vccz L_s1_ok
    ds_read_b128 v[112:115], v26
    ds_read_b128 v[116:119], v26 offset:16
    s_sub_u32 s55, s55, 1
    s_cbranch_scc0 L_s1
L_s1_ok:
    s_bcnt1_i32_b64 s10, s[6:7]
    v_mbcnt_lo_u32_b32 v22, s6, 0
    v_mbcnt_lo_u32_b32 v13, s8, 0
    v_mbcnt_hi_u32_b32 v22, s7, v22
    v_mbcnt_hi_u32_b32 v13, s9, v13
    v_min_u32 v22, 16, v22
    v_add_u32 v13, s10, v13
    v_lshl_add_u32 v22, v22, 2, s62
    v_min_u32 v13, 16, v13
    s_mov_b64 exec, s[6:7]
    ds_write_b32 v22, v24
    v_lshl_add_u32 v13, v13, 2, s62
    s_mov_b64 exec, s[8:9]
    ds_write_b32 v13, v23
    s_mov_b64 exec, 1
    ds_add_u32 v26, v27 offset:32
    s_mov_b64 exec, -1
    ds_read_b32 v22, v26 offset:32
    ds_read_b32 v13, v15
    ds_read_b128 v[112:115], v16 offset:0
    ds_read_b128 v[116:119], v16 offset:16
    ds_read_b128 v[120:123], v16 offset:32
    ds_read_b128 v[124:127], v16 offset:48
    v_and_b32 v24, 0x7ff, v24
    v_and_b32 v23, 0x7ff, v23
    v_mad_i32_i24 v24, v24, s63, v37
    v_mad_i32_i24 v23, v23, s63, v37
    s_mov_b64 exec, s[6:7]
    global_load_dword v239, v24, s[4:5]
    s_cmp_eq_u64 s[8:9], 0
    s_cbranch_scc1 L_no2
    s_mov_b64 exec, s[8:9]
    global_load_dword v239, v23, s[4:5]
L_no2:
    s_mov_b64 exec, -1
L_s2:
    s_waitcnt lgkmcnt(0)
    v_cmp_ne_u32 vcc, 16, v22
    v_mov_b32 v24, 0
    s_cbranch_vccz L_s2_ok
    ds_read_b32 v22, v26 offset:32
    ds_read_b32 v13, v15
    ds_read_b128 v[112:115], v16 offset:0
    ds_read_b128 v[116:119], v16 offset:16
    ds_read_b128 v[120:123], v16 offset:32
    ds_read_b128 v[124:127], v16 offset:48
    s_sub_u32 s55, s55, 1
    s_cbranch_scc0 L_s2
L_s2_ok:
    v_sub_u32 v112, v13, v112
    v_alignbit_b32 v24, v24, v112, 31
    v_sub_u32 v113, v13, v113
    v_alignbit_b32 v24, v24, v113, 31
    v_sub_u32 v114, v13, v114
    v_alignbit_b32 v24, v24, v114, 31
    v_sub_u32 v115, v13, v115
    v_alignbit_b32 v24, v24, v115, 31
    v_sub_u32 v116, v13, v116
    v_alignbit_b32 v24, v24, v116, 31
    v_sub_u32 v117, v13, v117
    v_alignbit_b32 v24, v24, v117, 31
    v_sub_u32 v118, v13, v118
    v_alignbit_b32 v24, v24, v118, 31
    v_sub_u32 v119, v13, v119
    v_alignbit_b32 v24, v24, v119, 31
    v_sub_u32 v120, v13, v120
    v_alignbit_b32 v24, v24, v120, 31
    v_sub_u32 v121, v13, v121
    v_alignbit_b32 v24, v24, v121, 31
    v_sub_u32 v122, v13, v122
    v_alignbit_b32 v24, v24, v122, 31
    v_sub_u32 v123, v13, v123
    v_alignbit_b32 v24, v24, v123, 31
    v_sub_u32 v124, v13, v124
    v_alignbit_b32 v24, v24, v124, 31
    v_sub_u32 v125, v13, v125
    v_alignbit_b32 v24, v24, v125, 31
    v_sub_u32 v126, v13, v126
    v_alignbit_b32 v24, v24, v126, 31
    v_sub_u32 v127, v13, v127
    v_alignbit_b32 v24, v24, v127, 31
    v_bcnt_u32_b32 v24, v24, 0
    s_nop 1
    v_add_u32_dpp v24, v24, v24 quad_perm:[1,0,3,2] row_mask:0xf bank_mask:0xf
    s_nop 1
    v_add_u32_dpp v24, v24, v24 quad_perm:[2,3,0,1] row_mask:0xf bank_mask:0xf
    v_cmp_gt_u32 vcc, 8, v24
    v_lshl_add_u32 v24, v24, 2, v26
    s_mov_b64 exec, vcc
    ds_write_b32 v24, v13 offset:64
    s_mov_b64 exec, -1
L_s3:
    ds_read_b32 v23, v17 offset:64
    ds_read_b32 v13, v18 offset:64
    s_add_u32 m0, s64, 150016
    s_waitcnt lgkmcnt(0)
    v_cmp_eq_u32 vcc, 0, v23
    v_and_b32 v23, 0x7ff, v23
    s_sub_u32 s55, s55, 1
    s_cselect_b64 vcc, 0, vcc
    s_cbranch_vccnz L_s3
    v_mad_i32_i24 v23, v23, s63, v12
    global_load_lds_dwordx4 v23, s[4:5]
    s_add_u32 m0, s64, 153728
    v_and_b32 v22, 0x7ff, v13
    global_load_lds_dwordx4 v23, s[4:5] offset:512
    v_sub_u32 v22, 2047, v22
    s_cmp_lg_u32 s39, 0
    s_cbranch_scc1 L_nox9
    s_mov_b32 m0, 157440
    s_nop 0
    global_load_lds_dwordx4 v23, s[4:5] offset:1024
    s_branch L_x3
L_nox9:
    v_lshlrev_b32 v24, 3, v22
    v_add_u32 v24, 16384, v24
    global_load_dword v25, v24, s[36:37] sc1
L_x3:
    s_barrier
    v_readlane_b32 s10, v13, 7
    s_mov_b32 s11, 0
    s_lshl_b32 s10, s10, 5
    v_cmp_le_u32 vcc, s10, v28
    s_nop 0
    s_bcnt1_i32_b64 s56, vcc
    s_add_u32 s11, s11, s56
    v_cmp_le_u32 vcc, s10, v29
    s_nop 0
    s_bcnt1_i32_b64 s56, vcc
    s_add_u32 s11, s11, s56
    v_cmp_le_u32 vcc, s10, v30
    s_nop 0
    s_bcnt1_i32_b64 s56, vcc
    s_add_u32 s11, s11, s56
    v_cmp_le_u32 vcc, s10, v31
    s_nop 0
    s_bcnt1_i32_b64 s56, vcc
    s_add_u32 s11, s11, s56
    v_cmp_le_u32 vcc, s10, v32
    s_nop 0
    s_bcnt1_i32_b64 s56, vcc
    s_add_u32 s11, s11, s56
    v_cmp_le_u32 vcc, s10, v33
    s_nop 0
    s_bcnt1_i32_b64 s56, vcc
    s_add_u32 s11, s11, s56
    v_cmp_le_u32 vcc, s10, v34
    s_nop 0
    s_bcnt1_i32_b64 s56, vcc
    s_add_u32 s11, s11, s56
    v_cmp_le_u32 vcc, s10, v35
    s_nop 0
    s_bcnt1_i32_b64 s56, vcc
    s_add_u32 s11, s11, s56
    s_lshl_b32 s11, s11, 16
    s_or_b32 s11, s11, 4
    v_mov_b32 v36, s11
    s_barrier
    global_load_dwordx4 v[40:43], v19, s[12:13] offset:0
    global_load_dwordx4 v[44:47], v19, s[12:13] offset:1152
    s_waitcnt vmcnt(2)
    s_cmp_lg_u32 s39, 1
    s_cbranch_scc1 L_nost
    ds_write_b32 v18, v25 offset:448
L_nost:
    s_mov_b64 exec, 1
    ds_add_u32 v26, v36 offset:36
    s_mov_b64 exec, -1
    s_setprio 0
    global_load_dwordx4 v[48:51], v19, s[12:13] offset:2304
    global_load_dwordx4 v[52:55], v19, s[12:13] offset:3456
    global_load_dwordx4 v[56:59], v19, s[14:15] offset:0
    global_load_dwordx4 v[60:63], v19, s[14:15] offset:1152
    global_load_dwordx4 v[64:67], v19, s[14:15] offset:2304
    global_load_dwordx4 v[68:71], v19, s[14:15] offset:3456
    global_load_dwordx4 v[216:219], v20, s[12:13] offset:1024
    global_load_dwordx4 v[220:223], v20, s[16:17] offset:1024
L_s4:
    ds_read_b32 v24, v26 offset:36
    s_waitcnt lgkmcnt(0)
    v_readfirstlane_b32 s61, v24
    s_nop 0
    s_and_b32 s60, s61, 255
    s_cmp_ge_u32 s60, 16
    s_cbranch_scc1 L_s4_ok
    s_sub_u32 s55, s55, 1
    s_cbranch_scc0 L_s4
L_s4_ok:
    s_lshr_b32 s61, s61, 16
    s_cmp_eq_u32 s61, 8
    s_cbranch_scc0 L_slow
L_dgo:
    global_load_dwordx4 v[72:75], v19, s[16:17] offset:0
    s_waitcnt vmcnt(9)
    v_perm_b32 v112, v44, v40, s66
    v_perm_b32 v116, v44, v40, s67
    v_perm_b32 v120, v45, v41, s66
    v_perm_b32 v124, v45, v41, s67
    v_perm_b32 v128, v46, v42, s66
    v_perm_b32 v132, v46, v42, s67
    v_perm_b32 v136, v47, v43, s66
    v_perm_b32 v140, v47, v43, s67
    global_load_dwordx4 v[76:79], v19, s[16:17] offset:1152
    s_waitcnt vmcnt(8)
    v_perm_b32 v113, v52, v48, s66
    v_perm_b32 v117, v52, v48, s67
    v_perm_b32 v121, v53, v49, s66
    v_perm_b32 v125, v53, v49, s67
    v_perm_b32 v129, v54, v50, s66
    v_perm_b32 v133, v54, v50, s67
    v_perm_b32 v137, v55, v51, s66
    v_perm_b32 v141, v55, v51, s67
    global_load_dwordx4 v[80:83], v19, s[16:17] offset:2304
    global_load_dwordx4 v[84:87], v19, s[16:17] offset:3456
    s_waitcnt vmcnt(8)
    v_perm_b32 v114, v60, v56, s66
    v_perm_b32 v118, v60, v56, s67
    v_perm_b32 v122, v61, v57, s66
    v_perm_b32 v126, v61, v57, s67
    v_perm_b32 v130, v62, v58, s66
    v_perm_b32 v134, v62, v58, s67
    v_perm_b32 v138, v63, v59, s66
    v_perm_b32 v142, v63, v59, s67
    global_load_dwordx4 v[88:91], v19, s[18:19] offset:0
    global_load_dwordx4 v[92:95], v19, s[18:19] offset:1152
    s_waitcnt vmcnt(8)
    v_perm_b32 v115, v68, v64, s66
    v_perm_b32 v119, v68, v64, s67
    v_perm_b32 v123, v69, v65, s66
    v_perm_b32 v127, v69, v65, s67
    v_perm_b32 v131, v70, v66, s66
    v_perm_b32 v135, v70, v66, s67
    v_perm_b32 v139, v71, v67, s66
    v_perm_b32 v143, v71, v67, s67
    global_load_dwordx4 v[96:99], v19, s[18:19] offset:2304
    global_load_dwordx4 v[100:103], v19, s[18:19] offset:3456
    s_waitcnt vmcnt(6)
    ds_write_b128 v236, v[216:219]
    ds_read_b64_tr_b16 v[104:105], v237
    ds_read_b64_tr_b16 v[106:107], v237 offset:512
    ds_write_b128 v236, v[220:223]
    ds_read_b64_tr_b16 v[108:109], v237
    ds_read_b64_tr_b16 v[110:111], v237 offset:512
    v_perm_b32 v144, v76, v72, s66
    v_perm_b32 v148, v76, v72, s67
    v_perm_b32 v152, v77, v73, s66
    v_perm_b32 v156, v77, v73, s67
    v_perm_b32 v160, v78, v74, s66
    v_perm_b32 v164, v78, v74, s67
    v_perm_b32 v168, v79, v75, s66
    v_perm_b32 v172, v79, v75, s67
    s_waitcnt vmcnt(4)
    v_perm_b32 v145, v84, v80, s66
    v_perm_b32 v149, v84, v80, s67
    v_perm_b32 v153, v85, v81, s66
    v_perm_b32 v157, v85, v81, s67
    v_perm_b32 v161, v86, v82, s66
    v_perm_b32 v165, v86, v82, s67
    v_perm_b32 v169, v87, v83, s66
    v_perm_b32 v173, v87, v83, s67
    s_barrier
    ds_read_b128 v[28:31], v235
    ds_read_b128 v[32:35], v235 offset:1024
    s_mov_b32 s58, 0x00ff00ff
    s_mov_b32 s59, 0x00ff00ff
    s_waitcnt vmcnt(2)
    v_perm_b32 v146, v92, v88, s66
    v_perm_b32 v150, v92, v88, s67
    v_perm_b32 v154, v93, v89, s66
    v_perm_b32 v158, v93, v89, s67
    v_perm_b32 v162, v94, v90, s66
    v_perm_b32 v166, v94, v90, s67
    v_perm_b32 v170, v95, v91, s66
    v_perm_b32 v174, v95, v91, s67
    s_waitcnt lgkmcnt(0)
    v_mfma_f32_16x16x32_bf16 v[208:211], v[104:107], v[28:31], 0
    s_waitcnt vmcnt(0)
    v_perm_b32 v147, v100, v96, s66
    v_mfma_f32_16x16x32_bf16 v[208:211], v[108:111], v[32:35], v[208:211]
    v_perm_b32 v151, v100, v96, s67
    v_perm_b32 v155, v101, v97, s66
    v_mfma_f32_16x16x32_bf16 v[176:179], v[112:115], v[28:31], 0
    v_perm_b32 v159, v101, v97, s67
    v_perm_b32 v163, v102, v98, s66
    v_mfma_f32_16x16x32_bf16 v[180:183], v[116:119], v[28:31], 0
    v_perm_b32 v167, v102, v98, s67
    v_perm_b32 v171, v103, v99, s66
    v_mfma_f32_16x16x32_bf16 v[184:187], v[120:123], v[28:31], 0
    v_perm_b32 v175, v103, v99, s67
    v_mfma_f32_16x16x32_bf16 v[188:191], v[124:127], v[28:31], 0
    v_mfma_f32_16x16x32_bf16 v[176:179], v[144:147], v[32:35], v[176:179]
    v_mfma_f32_16x16x32_bf16 v[180:183], v[148:151], v[32:35], v[180:183]
    v_bitop3_b32 v208, v234, v233, v208 bitop3:0xca
    s_mov_b64 exec, s[58:59]
    global_store_dwordx4 v8, v[208:211], s[36:37] sc1
    s_mov_b64 exec, -1
    v_mfma_f32_16x16x32_bf16 v[184:187], v[152:155], v[32:35], v[184:187]
    v_mfma_f32_16x16x32_bf16 v[188:191], v[156:159], v[32:35], v[188:191]
    v_mfma_f32_16x16x32_bf16 v[192:195], v[128:131], v[28:31], 0
    v_mfma_f32_16x16x32_bf16 v[196:199], v[132:135], v[28:31], 0
    v_mfma_f32_16x16x32_bf16 v[200:203], v[136:139], v[28:31], 0
    v_bitop3_b32 v212, v232, v178, v176 bitop3:0xca
    v_bitop3_b32 v213, v232, v182, v180 bitop3:0xca
    v_mfma_f32_16x16x32_bf16 v[204:207], v[140:143], v[28:31], 0
    s_nop 0
    v_bitop3_b32 v214, v232, v186, v184 bitop3:0xca
    v_bitop3_b32 v215, v232, v190, v188 bitop3:0xca
    v_mfma_f32_16x16x32_bf16 v[192:195], v[160:163], v[32:35], v[192:195]
    v_bitop3_b32 v212, v234, v233, v212 bitop3:0xca
    global_store_dwordx4 v4, v[212:215], s[36:37] sc1
    v_mfma_f32_16x16x32_bf16 v[196:199], v[164:167], v[32:35], v[196:199]
    v_bitop3_b32 v216, v232, v179, v177 bitop3:0xca
    v_bitop3_b32 v217, v232, v183, v181 bitop3:0xca
    v_mfma_f32_16x16x32_bf16 v[200:203], v[168:171], v[32:35], v[200:203]
    v_bitop3_b32 v218, v232, v187, v185 bitop3:0xca
    v_bitop3_b32 v219, v232, v191, v189 bitop3:0xca
    v_mfma_f32_16x16x32_bf16 v[204:207], v[172:175], v[32:35], v[204:207]
    v_bitop3_b32 v216, v234, v233, v216 bitop3:0xca
    global_store_dwordx4 v5, v[216:219], s[36:37] sc1
    v_bitop3_b32 v220, v232, v194, v192 bitop3:0xca
    v_bitop3_b32 v221, v232, v198, v196 bitop3:0xca
    s_nop 0
    v_bitop3_b32 v222, v232, v202, v200 bitop3:0xca
    s_nop 1
    v_bitop3_b32 v223, v232, v206, v204 bitop3:0xca
    v_bitop3_b32 v220, v234, v233, v220 bitop3:0xca
    global_store_dwordx4 v6, v[220:223], s[36:37] sc1
    v_bitop3_b32 v224, v232, v195, v193 bitop3:0xca
    v_bitop3_b32 v225, v232, v199, v197 bitop3:0xca
    v_bitop3_b32 v226, v232, v203, v201 bitop3:0xca
    v_bitop3_b32 v227, v232, v207, v205 bitop3:0xca
    v_bitop3_b32 v224, v234, v233, v224 bitop3:0xca
    global_store_dwordx4 v7, v[224:227], s[36:37] sc1
    s_endpgm
L_slow:
    v_mov_b32 v21, 0
    v_mov_b32 v38, v26
    s_mov_b32 s10, 16
L_slow_r:
    v_sub_u32 v176, v28, v21
    v_sub_u32 v177, v29, v21
    v_sub_u32 v178, v30, v21
    v_sub_u32 v179, v31, v21
    v_sub_u32 v180, v32, v21
    v_sub_u32 v181, v33, v21
    v_sub_u32 v182, v34, v21
    v_sub_u32 v183, v35, v21
    v_max3_u32 v24, v176, v177, v178
    v_max3_u32 v24, v24, v179, v180
    v_max3_u32 v24, v24, v181, v182
    v_max_u32 v24, v24, v183
    ds_max_u32 v38, v24 offset:96
    s_mov_b64 exec, 1
    ds_add_u32 v26, v27 offset:40
    s_mov_b64 exec, -1
L_slow_s:
    ds_read_b32 v24, v26 offset:40
    ds_read_b32 v39, v38 offset:96
    s_waitcnt lgkmcnt(0)
    v_readfirstlane_b32 s11, v24
    s_nop 0
    s_cmp_ge_u32 s11, s10
    s_cbranch_scc1 L_slow_ok
    s_sub_u32 s55, s55, 1
    s_cbranch_scc0 L_slow_s
L_slow_ok:
    v_add_u32 v21, v21, v39
    v_alignbit_b32 v24, 1, v21, 5
    ds_write_b32 v38, v24 offset:64
    v_add_u32 v38, 4, v38
    s_add_u32 s10, s10, 16
    s_cmp_le_u32 s10, 128
    s_cbranch_scc1 L_slow_r
    ds_read_b32 v23, v17 offset:64
    ds_read_b32 v13, v18 offset:64
    s_add_u32 m0, s64, 150016
    s_waitcnt lgkmcnt(0)
    v_and_b32 v23, 0x7ff, v23
    v_mad_i32_i24 v23, v23, s63, v12
    global_load_lds_dwordx4 v23, s[4:5]
    s_add_u32 m0, s64, 153728
    v_and_b32 v22, 0x7ff, v13
    global_load_lds_dwordx4 v23, s[4:5] offset:512
    v_sub_u32 v22, 2047, v22
    s_cmp_lg_u32 s39, 0
    s_cbranch_scc1 L_nox9b
    s_mov_b32 m0, 157440
    s_nop 0
    global_load_lds_dwordx4 v23, s[4:5] offset:1024
    s_branch L_x3b
L_nox9b:
    v_lshlrev_b32 v24, 3, v22
    v_add_u32 v24, 16384, v24
    global_load_dword v25, v24, s[36:37] sc1
L_x3b:
    v_mov_b32 v36, 4
    s_waitcnt vmcnt(0)
    s_cmp_lg_u32 s39, 1
    s_cbranch_scc1 L_nostb
    ds_write_b32 v18, v25 offset:448
L_nostb:
    s_mov_b64 exec, 1
    ds_add_u32 v26, v36 offset:36
    s_mov_b64 exec, -1
    s_branch L_dgo
L_gu:
    s_add_u32 s53, s53, 12288
    v_mov_b32 v1, v76
    s_movk_i32 s55, 7
L_dma1:
    s_mov_b32 m0, s53
    s_add_u32 s42, s53, 73728
    global_load_lds_dwordx4 v1, s[26:27]
    s_mov_b32 m0, s42
    s_add_u32 s53, s53, 4096
    global_load_lds_dwordx4 v1, s[28:29]
    v_add_u32 v1, 294912, v1
    s_sub_u32 s55, s55, 1
    s_cmp_lg_u32 s55, 0
    s_cbranch_scc1 L_dma1
    v_lshrrev_b32 v12, 1, v2
    v_min_u32 v12, 8, v12
    v_mul_u32_u24 v12, 1056, v12
    v_and_b32 v13, 16, v3
    v_add_u32 v12, v12, v13
    v_add_u32 v12, 151040, v12
    v_mov_b32 v20, 0x3f803f80
    v_mov_b32 v21, v20
    v_mov_b32 v22, v20
    v_mov_b32 v23, v20
    ds_write_b128 v12, v[20:23]
    v_bfe_u32 v15, v0, 2, 2
    v_and_b32 v16, 3, v0
    v_lshl_add_u32 v17, v14, 3, v15
    v_bfe_u32 v18, v0, 3, 2
    v_xor_b32 v18, s51, v18
    v_lshlrev_b32 v18, 5, v18
    v_lshl_add_u32 v18, v16, 3, v18
    v_lshl_add_u32 v4, v17, 7, v18
    v_add_u32 v5, 36864, v4
    v_add_u32 v6, 73728, v4
    v_add_u32 v7, 110592, v4
    v_and_b32 v19, 6, v11
    v_xor_b32 v19, v19, v14
    v_lshlrev_b32 v19, 4, v19
    v_lshl_add_u32 v19, v11, 7, v19
    v_xor_b32 v20, 64, v19
    v_bfe_i32 v21, v0, 3, 1
    v_lshlrev_b32 v22, 2, v0
    v_xor_b32 v22, v22, v0
    v_and_b32 v22, 16, v22
    v_or_b32 v22, 1024, v22
    v_bfi_b32 v19, v21, v22, v19
    v_xor_b32 v22, 16, v22
    v_bfi_b32 v20, v21, v22, v20
    v_add_u32 v19, 150016, v19
    v_add_u32 v20, 150016, v20
    v_lshl_add_u32 v18, v11, 2, v26
    s_lshr_b32 s42, s51, 1
    s_lshl_b32 s42, s42, 10
    s_and_b32 s43, s51, 1
    s_lshl_b32 s43, s43, 3
    s_add_u32 s42, s42, s43
    s_add_u32 s42, s42, 147968
    v_add_u32 v27, s42, v3
    v_and_b32 v8, 9344, v21
    v_lshl_add_u32 v8, v11, 4, v8
    s_mul_i32 s42, s50, 18688
    s_add_u32 s42, s42, 74752
    v_add_u32 v8, s42, v8
    s_waitcnt vmcnt(4)
    s_barrier
    ds_read_b64_tr_b16 v[112:113], v4 offset:0
    ds_read_b64_tr_b16 v[114:115], v4 offset:512
    ds_read_b64_tr_b16 v[184:185], v6 offset:0
    ds_read_b64_tr_b16 v[186:187], v6 offset:512
    ds_read_b64_tr_b16 v[116:117], v4 offset:4096
    ds_read_b64_tr_b16 v[118:119], v4 offset:4608
    ds_read_b64_tr_b16 v[188:189], v6 offset:4096
    ds_read_b64_tr_b16 v[190:191], v6 offset:4608
    ds_read_b64_tr_b16 v[120:121], v4 offset:8192
    ds_read_b64_tr_b16 v[122:123], v4 offset:8704
    ds_read_b64_tr_b16 v[192:193], v6 offset:8192
    ds_read_b64_tr_b16 v[194:195], v6 offset:8704
    ds_read_b64_tr_b16 v[124:125], v4 offset:12288
    ds_read_b64_tr_b16 v[126:127], v4 offset:12800
    ds_read_b64_tr_b16 v[196:197], v6 offset:12288
    ds_read_b64_tr_b16 v[198:199], v6 offset:12800
    ds_read_b64_tr_b16 v[128:129], v4 offset:16384
    ds_read_b64_tr_b16 v[130:131], v4 offset:16896
    ds_read_b64_tr_b16 v[200:201], v6 offset:16384
    ds_read_b64_tr_b16 v[202:203], v6 offset:16896
    ds_read_b64_tr_b16 v[132:133], v4 offset:20480
    ds_read_b64_tr_b16 v[134:135], v4 offset:20992
    ds_read_b64_tr_b16 v[204:205], v6 offset:20480
    ds_read_b64_tr_b16 v[206:207], v6 offset:20992
    ds_read_b64_tr_b16 v[136:137], v4 offset:24576
    ds_read_b64_tr_b16 v[138:139], v4 offset:25088
    ds_read_b64_tr_b16 v[208:209], v6 offset:24576
    ds_read_b64_tr_b16 v[210:211], v6 offset:25088
    ds_read_b64_tr_b16 v[140:141], v4 offset:28672
    ds_read_b64_tr_b16 v[142:143], v4 offset:29184
    ds_read_b64_tr_b16 v[212:213], v6 offset:28672
    ds_read_b64_tr_b16 v[214:215], v6 offset:29184
    s_barrier
    s_movk_i32 s55, 6
L_dma4:
    s_mov_b32 m0, s53
    s_add_u32 s42, s53, 73728
    global_load_lds_dwordx4 v1, s[26:27]
    s_mov_b32 m0, s42
    s_add_u32 s53, s53, 4096
    global_load_lds_dwordx4 v1, s[28:29]
    v_add_u32 v1, 294912, v1
    s_waitcnt vmcnt(4)
    s_sub_u32 s55, s55, 1
    s_cmp_lg_u32 s55, 0
    s_cbranch_scc1 L_dma4
    s_mov_b32 s55, 262144
    v_mov_b32 v23, 0x100
    s_waitcnt vmcnt(0)
    s_barrier
    s_setprio 2
    s_add_u32 m0, s53, 0
    s_nop 0
    global_load_lds_dwordx4 v1, s[26:27]
    ds_read_b64_tr_b16 v[144:145], v4 offset:32768
    ds_read_b64_tr_b16 v[146:147], v4 offset:33280
    ds_read_b64_tr_b16 v[216:217], v6 offset:32768
    ds_read_b64_tr_b16 v[218:219], v6 offset:33280
    ds_read_b64_tr_b16 v[148:149], v5 offset:0
    ds_read_b64_tr_b16 v[150:151], v5 offset:512
    ds_read_b64_tr_b16 v[220:221], v7 offset:0
    ds_read_b64_tr_b16 v[222:223], v7 offset:512
    s_add_u32 m0, s53, 73728
    s_nop 0
    global_load_lds_dwordx4 v1, s[28:29]
    ds_read_b64_tr_b16 v[152:153], v5 offset:4096
    ds_read_b64_tr_b16 v[154:155], v5 offset:4608
    ds_read_b64_tr_b16 v[224:225], v7 offset:4096
    ds_read_b64_tr_b16 v[226:227], v7 offset:4608
    ds_read_b64_tr_b16 v[156:157], v5 offset:8192
    ds_read_b64_tr_b16 v[158:159], v5 offset:8704
    ds_read_b64_tr_b16 v[228:229], v7 offset:8192
    ds_read_b64_tr_b16 v[230:231], v7 offset:8704
    v_add_u32 v1, 294912, v1
    s_add_u32 m0, s53, 4096
    s_nop 0
    global_load_lds_dwordx4 v1, s[26:27]
    ds_read_b64_tr_b16 v[160:161], v5 offset:12288
    ds_read_b64_tr_b16 v[162:163], v5 offset:12800
    ds_read_b64_tr_b16 v[232:233], v7 offset:12288
    ds_read_b64_tr_b16 v[234:235], v7 offset:12800
    ds_read_b64_tr_b16 v[164:165], v5 offset:16384
    ds_read_b64_tr_b16 v[166:167], v5 offset:16896
    ds_read_b64_tr_b16 v[236:237], v7 offset:16384
    ds_read_b64_tr_b16 v[238:239], v7 offset:16896
    s_add_u32 m0, s53, 77824
    s_nop 0
    global_load_lds_dwordx4 v1, s[28:29]
    ds_read_b64_tr_b16 v[168:169], v5 offset:20480
    ds_read_b64_tr_b16 v[170:171], v5 offset:20992
    ds_read_b64_tr_b16 v[240:241], v7 offset:20480
    ds_read_b64_tr_b16 v[242:243], v7 offset:20992
    ds_read_b64_tr_b16 v[172:173], v5 offset:24576
    ds_read_b64_tr_b16 v[174:175], v5 offset:25088
    ds_read_b64_tr_b16 v[244:245], v7 offset:24576
    ds_read_b64_tr_b16 v[246:247], v7 offset:25088
    v_add_u32 v1, 294912, v1
    s_barrier
    s_waitcnt vmcnt(0)
    s_mov_b64 exec, 1
    ds_add_u32 v26, v23 offset:36
    s_mov_b64 exec, -1
L_s6:
    ds_read_b32 v24, v26 offset:36
    s_waitcnt lgkmcnt(0)
    v_readfirstlane_b32 s61, v24
    s_nop 0
    s_cmp_eq_u32 s61, 0x80410
    s_cbranch_scc1 L_s6_ok
    s_and_b32 s60, s61, 0xffff
    s_cmp_eq_u32 s60, 0x420
    s_cbranch_scc1 L_s6_ok
    s_sub_u32 s55, s55, 1
    s_cbranch_scc0 L_s6
L_s6_ok:
    ds_read_b128 v[40:43], v19 offset:0
    ds_read_b128 v[44:47], v20 offset:0
    ds_read_b128 v[48:51], v19 offset:1056
    ds_read_b128 v[52:55], v20 offset:1056
    ds_read_b128 v[56:59], v19 offset:2112
    ds_read_b128 v[60:63], v20 offset:2112
    s_waitcnt lgkmcnt(5)
    v_mfma_f32_16x16x32_bf16 v[28:31], v[112:115], v[40:43], 0
    ds_read_b128 v[64:67], v19 offset:3168
    v_mfma_f32_16x16x32_bf16 v[32:35], v[184:187], v[40:43], 0
    ds_read_b128 v[68:71], v20 offset:3168
    s_waitcnt lgkmcnt(5)
    v_mfma_f32_16x16x32_bf16 v[28:31], v[116:119], v[44:47], v[28:31]
    ds_read_b128 v[72:75], v19 offset:4224
    v_mfma_f32_16x16x32_bf16 v[32:35], v[188:191], v[44:47], v[32:35]
    ds_read_b128 v[76:79], v20 offset:4224
    v_mfma_f32_16x16x32_bf16 v[28:31], v[120:123], v[48:51], v[28:31]
    ds_read_b32 v25, v18 offset:448
    v_mfma_f32_16x16x32_bf16 v[32:35], v[192:195], v[48:51], v[32:35]
    ds_read_b32 v13, v18 offset:64
    s_waitcnt lgkmcnt(7)
    v_mfma_f32_16x16x32_bf16 v[28:31], v[124:127], v[52:55], v[28:31]
    ds_read_b128 v[80:83], v19 offset:5280
    v_mfma_f32_16x16x32_bf16 v[32:35], v[196:199], v[52:55], v[32:35]
    ds_read_b128 v[84:87], v20 offset:5280
    v_mfma_f32_16x16x32_bf16 v[28:31], v[128:131], v[56:59], v[28:31]
    ds_read_b128 v[88:91], v19 offset:6336
    v_mfma_f32_16x16x32_bf16 v[32:35], v[200:203], v[56:59], v[32:35]
    ds_read_b128 v[92:95], v20 offset:6336
    s_waitcnt lgkmcnt(8)
    v_mfma_f32_16x16x32_bf16 v[28:31], v[132:135], v[60:63], v[28:31]
    ds_read_b128 v[96:99], v19 offset:7392
    v_mfma_f32_16x16x32_bf16 v[28:31], v[136:139], v[64:67], v[28:31]
    ds_read_b128 v[100:103], v20 offset:7392
    v_mfma_f32_16x16x32_bf16 v[28:31], v[140:143], v[68:71], v[28:31]
    ds_read_b128 v[104:107], v19 offset:8448
    ds_read_b64_tr_b16 v[176:177], v5 offset:28672
    s_waitcnt lgkmcnt(7)
    v_mfma_f32_16x16x32_bf16 v[28:31], v[144:147], v[72:75], v[28:31]
    ds_read_b64_tr_b16 v[178:179], v5 offset:29184
    ds_read_b128 v[108:111], v20 offset:8448
    v_mfma_f32_16x16x32_bf16 v[28:31], v[148:151], v[76:79], v[28:31]
    ds_read_b64_tr_b16 v[180:181], v5 offset:32768
    ds_read_b64_tr_b16 v[182:183], v5 offset:33280
    v_mfma_f32_16x16x32_bf16 v[28:31], v[152:155], v[80:83], v[28:31]
    ds_read_b64_tr_b16 v[248:249], v7 offset:28672
    v_and_b32 v15, 0xffff0000, v25
    s_waitcnt lgkmcnt(9)
    v_mfma_f32_16x16x32_bf16 v[28:31], v[156:159], v[84:87], v[28:31]
    ds_read_b64_tr_b16 v[250:251], v7 offset:29184
    v_rcp_f32 v16, v15
    v_mfma_f32_16x16x32_bf16 v[28:31], v[160:163], v[88:91], v[28:31]
    ds_read_b64_tr_b16 v[252:253], v7 offset:32768
    v_lshlrev_b32 v12, 16, v25
    v_mfma_f32_16x16x32_bf16 v[28:31], v[164:167], v[92:95], v[28:31]
    ds_read_b64_tr_b16 v[254:255], v7 offset:33280
    v_xor_b32 v25, 0x80000000, v12
    s_waitcnt lgkmcnt(7)
    v_mfma_f32_16x16x32_bf16 v[28:31], v[168:171], v[96:99], v[28:31]
    v_mul_f32 v16, 0x42000000, v16
    v_mul_f32 v9, 0xbfb8aa3b, v16
    v_mfma_f32_16x16x32_bf16 v[28:31], v[172:175], v[100:103], v[28:31]
    v_mul_f32 v10, v16, v16
    v_mfma_f32_16x16x32_bf16 v[28:31], v[176:179], v[104:107], v[28:31]
    s_waitcnt lgkmcnt(4)
    v_mfma_f32_16x16x32_bf16 v[28:31], v[180:183], v[108:111], v[28:31]
    v_mfma_f32_16x16x32_bf16 v[32:35], v[204:207], v[60:63], v[32:35]
    v_mfma_f32_16x16x32_bf16 v[32:35], v[208:211], v[64:67], v[32:35]
    v_mfma_f32_16x16x32_bf16 v[32:35], v[212:215], v[68:71], v[32:35]
    v_mfma_f32_16x16x32_bf16 v[32:35], v[216:219], v[72:75], v[32:35]
    s_nop 3
    v_fmac_f32_dpp v28, v28, v25 row_newbcast:8 row_mask:0xf bank_mask:0xf
    v_fmac_f32_dpp v29, v29, v25 row_newbcast:8 row_mask:0xf bank_mask:0xf
    v_mfma_f32_16x16x32_bf16 v[32:35], v[220:223], v[76:79], v[32:35]
    v_fmac_f32_dpp v30, v30, v25 row_newbcast:8 row_mask:0xf bank_mask:0xf
    v_fmac_f32_dpp v31, v31, v25 row_newbcast:8 row_mask:0xf bank_mask:0xf
    v_mfma_f32_16x16x32_bf16 v[32:35], v[224:227], v[80:83], v[32:35]
    v_mul_f32 v36, v9, v28
    v_mul_f32 v37, v9, v29
    v_mfma_f32_16x16x32_bf16 v[32:35], v[228:231], v[84:87], v[32:35]
    v_mul_f32 v38, v9, v30
    v_mul_f32 v39, v9, v31
    v_mfma_f32_16x16x32_bf16 v[32:35], v[232:235], v[88:91], v[32:35]
    v_exp_f32 v36, v36
    v_exp_f32 v37, v37
    v_mfma_f32_16x16x32_bf16 v[32:35], v[236:239], v[92:95], v[32:35]
    v_exp_f32 v38, v38
    v_exp_f32 v39, v39
    v_mfma_f32_16x16x32_bf16 v[32:35], v[240:243], v[96:99], v[32:35]
    v_mul_f32 v28, v28, v10
    v_mul_f32 v29, v29, v10
    v_mfma_f32_16x16x32_bf16 v[32:35], v[244:247], v[100:103], v[32:35]
    v_mul_f32 v30, v30, v10
    v_mul_f32 v31, v31, v10
    s_waitcnt lgkmcnt(0)
    v_mfma_f32_16x16x32_bf16 v[32:35], v[248:251], v[104:107], v[32:35]
    v_add_f32 v36, 1.0, v36
    v_add_f32 v37, 1.0, v37
    v_mfma_f32_16x16x32_bf16 v[32:35], v[252:255], v[108:111], v[32:35]
    v_add_f32 v38, 1.0, v38
    v_add_f32 v39, 1.0, v39
    v_rcp_f32 v36, v36
    v_rcp_f32 v37, v37
    v_rcp_f32 v38, v38
    v_rcp_f32 v39, v39
    v_mul_f32 v28, v28, v36
    v_mul_f32 v29, v29, v37
    v_mul_f32 v30, v30, v38
    v_mul_f32 v31, v31, v39
    v_fmac_f32_dpp v32, v32, v25 row_newbcast:8 row_mask:0xf bank_mask:0xf
    v_fmac_f32_dpp v33, v33, v25 row_newbcast:8 row_mask:0xf bank_mask:0xf
    v_fmac_f32_dpp v34, v34, v25 row_newbcast:8 row_mask:0xf bank_mask:0xf
    v_fmac_f32_dpp v35, v35, v25 row_newbcast:8 row_mask:0xf bank_mask:0xf
    v_mul_f32 v28, v28, v32
    v_mul_f32 v29, v29, v33
    v_mul_f32 v30, v30, v34
    v_mul_f32 v31, v31, v35
    v_cvt_pk_bf16_f32 v28, v28, v29
    v_cvt_pk_bf16_f32 v29, v30, v31
    ds_write_b64 v27, v[28:29]
    s_waitcnt lgkmcnt(0)
    s_barrier
    s_cmp_lg_u32 s39, 4
    s_cbranch_scc1 L_gu_end
    v_lshlrev_b32 v36, 5, v13
    v_not_b32 v37, v36
    v_ashrrev_i32 v38, 31, v37
    v_or_b32 v38, 0x80000000, v38
    v_xor_b32 v36, v36, v38
    v_and_b32 v36, 0xffff0000, v36
    v_mul_f32 v36, 0xbfb8aa3b, v36
    v_exp_f32 v36, v36
    v_bfe_u32 v4, v37, 5, 11
    v_mov_b32 v6, v12
    v_mov_b32 v7, v15
    v_add_f32 v36, 1.0, v36
    v_rcp_f32 v5, v36
    v_lshl_or_b32 v4, v4, 8, s45
    s_mov_b64 exec, 0xffff
    global_store_dwordx4 v8, v[4:7], s[36:37] sc1
    s_cmp_lg_u32 s50, 0
    s_cbranch_scc1 L_gu_end
    v_mov_b32 v9, 0
    v_mov_b32 v10, s38
    s_mov_b64 exec, 1
    global_store_dword v9, v10, s[36:37]
L_gu_end:
    s_endpgm
L_end:
    s_endpgm
.fill 96, 4, 0xbf810000
L_last:
.section .rodata,"a"
.p2align 6
.amdhsa_kernel recurrent_scan__ssm_conv_s4__moe_arch_mod__prompt_kernel
  .amdhsa_next_free_vgpr 256
  .amdhsa_next_free_sgpr 102
  .amdhsa_accum_offset 256
  .amdhsa_group_segment_fixed_size 0
  .amdhsa_kernarg_size 136
  .amdhsa_user_sgpr_count 2
  .amdhsa_user_sgpr_kernarg_segment_ptr 1
  .amdhsa_system_sgpr_workgroup_id_x 1
  .amdhsa_float_denorm_mode_32 3
.end_amdhsa_kernel
```

```asm
; @launch grid=(256,1,1) block=(512,1,1) lds=163840
.amdgcn_target "amdgcn-amd-amdhsa--gfx950"
.text
.globl recurrent_scan__ssm_conv_s4__moe_arch_mod__prompt_kernel
.p2align 8
.type recurrent_scan__ssm_conv_s4__moe_arch_mod__prompt_kernel,@function
recurrent_scan__ssm_conv_s4__moe_arch_mod__prompt_kernel:
    s_load_dwordx16 s[4:19], s[0:1], 0
    s_load_dwordx16 s[20:35], s[0:1], 64
    s_load_dwordx2 s[36:37], s[0:1], 128
    s_cmp_ge_u32 s2, 256
    s_cbranch_scc1 L_end
    s_lshr_b32 s41, s2, 3
    s_getpc_b64 s[42:43]
L_pc:
    s_mul_i32 s47, s41, 768
    s_add_u32 s42, s42, s47
    s_addc_u32 s43, s43, 0
    v_lshlrev_b32 v4, 7, v0
    v_mov_b32 v5, s43
    v_add_co_u32 v4, vcc, s42, v4
    v_lshrrev_b32 v1, 6, v0
    v_and_b32 v2, 63, v0
    v_addc_co_u32 v5, vcc, 0, v5, vcc
    s_sub_u32 s47, L_last - L_pc - 4, s47
    s_ashr_i32 s47, s47, 7
    s_min_i32 s47, s47, 5
    v_cmp_ge_i32 vcc, s47, v0
    s_nop 0
    s_and_saveexec_b64 s[48:49], vcc
    s_cbranch_execz L_nopf
    global_load_dword v255, v[4:5], off
L_nopf:
    s_mov_b64 exec, -1
    v_readfirstlane_b32 s39, v1
    s_and_b32 s40, s2, 7
    s_mul_i32 s42, s2, 9216
    v_lshlrev_b32 v3, 4, v2
    v_lshlrev_b32 v4, 1, v2
    v_mul_u32_u24 v5, 1152, v1
    v_add3_u32 v6, v5, v3, s42
    v_add3_u32 v7, v5, v4, s42
    s_waitcnt lgkmcnt(0)
    global_load_dwordx4 v[12:15], v6, s[4:5]
    global_load_ushort v16, v7, s[4:5] offset:1024
    s_load_dword s38, s[36:37], 0
    global_load_dwordx4 v[20:23], v3, s[24:25]
    global_load_ushort v24, v4, s[24:25] offset:1024
    s_and_b32 s51, s39, 3
    s_lshr_b32 s52, s39, 2
    s_cmp_lt_u32 s41, 18
    s_cbranch_scc1 L_conv_pre
    s_cmp_lt_u32 s41, 27
    s_cbranch_scc1 L_ffn_pre
    s_sub_u32 s53, s41, 27
    s_and_b32 s58, s39, 1
    s_lshr_b32 s43, s39, 1
    s_mul_i32 s42, s43, 320
    s_add_u32 s42, s42, 1152
    s_cmp_eq_u32 s43, 0
    s_cmovk_i32 s42, 1152
    s_cmp_eq_u32 s43, 1
    s_cselect_b32 s48, 1, 0
    s_mul_i32 s59, s58, 320
    s_cmp_eq_u32 s43, 3
    s_cselect_b32 s42, s59, s42
    s_cmovk_i32 s58, 2
    s_lshl_b32 s53, s53, 6
    s_add_u32 s42, s42, s53
    s_mul_i32 s43, s40, 1152
    s_add_u32 s43, s43, 884736
    s_mul_i32 s59, s40, 663552
    s_cmp_eq_u32 s58, 0
    s_cselect_b32 s56, s26, s28
    s_cselect_b32 s57, s27, s29
    s_cmp_eq_u32 s58, 2
    s_cselect_b32 s56, s30, s56
    s_cselect_b32 s57, s31, s57
    s_cselect_b32 s43, s59, s43
    s_movk_i32 s58, 128
    s_movk_i32 s59, 8064
    s_movk_i32 s60, 4319
    s_cmov_b32 s58, 73728
    s_cmov_b32 s59, -663424
    s_cmovk_i32 s60, 5183
    v_add_u32 v76, s42, v2
    v_min_u32 v76, s60, v76
    v_mul_u32_u24 v63, 7282, v76
    v_lshrrev_b32 v63, 16, v63
    v_mul_u32_u24 v76, s58, v76
    v_mad_i32_i24 v76, v63, s59, v76
    v_add_u32 v76, s43, v76
    s_mov_b32 s49, 0
    s_branch L_lnp
L_ffn_pre:
    s_sub_u32 s54, s41, 18
    s_mul_i32 s50, s40, 9
    s_add_u32 s50, s50, s54
    v_bfe_u32 v76, v0, 3, 5
    v_bfe_u32 v61, v0, 4, 1
    v_bfe_u32 v62, v0, 6, 1
    v_lshl_add_u32 v61, v62, 1, v61
    v_lshlrev_b32 v61, 1, v61
    v_and_b32 v62, 7, v0
    v_xor_b32 v61, v61, v62
    v_mul_u32_u24 v76, 9216, v76
    v_lshlrev_b32 v61, 4, v61
    s_lshl_b32 s42, s50, 7
    v_add3_u32 v76, v76, v61, s42
    s_lshl_b32 s53, s51, 10
    s_cmp_eq_u32 s52, 0
    s_cselect_b32 s56, s26, s28
    s_cselect_b32 s57, s27, s29
    s_cselect_b32 s42, 0, 73728
    s_add_u32 s42, s53, s42
    s_mov_b32 s49, s42
    v_mov_b32 v62, 0
    v_mov_b32 v63, 0
    v_lshrrev_b32 v61, 1, v3
    v_add_u32 v61, 147456, v61
    ds_write_b64 v61, v[62:63]
    s_mov_b32 s47, 3
    s_mov_b32 s48, 0
    s_branch L_lnp
L_conv_pre:
    s_lshl_b32 s50, s40, 4
    s_lshl_b32 s42, s40, 1
    s_add_u32 s42, s42, 112
    s_cmp_ge_u32 s41, 16
    s_cselect_b32 s50, s42, s50
    s_add_u32 s50, s50, s41
    s_lshl_b32 s53, s50, 2
    s_add_u32 s53, s53, s51
    s_lshl_b32 s42, s53, 8
    s_lshl_b32 s43, s52, 7
    s_add_u32 s42, s42, s43
    v_add_u32 v60, s42, v4
    s_lshl_b32 s54, s50, 3
    s_lshl_b32 s42, s53, 1
    v_mov_b32 v61, s42
    v_mov_b64 v[64:65], 0
    v_mov_b64 v[66:67], 0
    v_mov_b64 v[68:69], 0
    v_mov_b64 v[70:71], 0
    s_barrier
    global_load_short_d16_hi v70, v61, s[18:19]
    global_load_short_d16_hi v64, v60, s[6:7]
    global_load_short_d16_hi v65, v60, s[8:9]
    global_load_short_d16_hi v66, v60, s[10:11]
    global_load_short_d16_hi v67, v60, s[12:13]
    global_load_short_d16_hi v68, v60, s[14:15]
    global_load_short_d16_hi v69, v60, s[16:17]
    global_load_short_d16_hi v71, v61, s[20:21]
    s_lshr_b32 s42, s51, 1
    s_mul_i32 s42, s42, 2112
    s_and_b32 s58, s51, 1
    s_mul_i32 s43, s58, 1152
    s_add_u32 s43, s43, 640
    s_lshr_b32 s47, s39, 1
    s_cmp_eq_u32 s47, 0
    s_cmovk_i32 s42, 3168
    s_cmp_eq_u32 s47, 1
    s_cselect_b32 s42, s43, s42
    s_cmovk_i32 s58, 2
    s_lshl_b32 s43, s41, 6
    s_add_u32 s42, s42, s43
    s_mul_i32 s43, s40, 1152
    s_add_u32 s43, s43, 884736
    s_mul_i32 s59, s40, 663552
    s_cmp_eq_u32 s58, 0
    s_cselect_b32 s56, s26, s28
    s_cselect_b32 s57, s27, s29
    s_cmp_eq_u32 s58, 2
    s_cselect_b32 s56, s30, s56
    s_cselect_b32 s57, s31, s57
    s_cselect_b32 s43, s59, s43
    s_movk_i32 s58, 128
    s_movk_i32 s59, 8064
    s_movk_i32 s60, 4319
    s_cmov_b32 s58, 73728
    s_cmov_b32 s59, -663424
    s_cmovk_i32 s60, 5183
    v_add_u32 v76, s42, v2
    v_min_u32 v76, s60, v76
    v_mul_u32_u24 v63, 7282, v76
    v_lshrrev_b32 v63, 16, v63
    v_mul_u32_u24 v76, s58, v76
    v_mad_i32_i24 v76, v63, s59, v76
    v_add_u32 v76, s43, v76
    s_mul_i32 s55, s51, 33792
    s_lshl_b32 s42, s52, 8
    s_add_u32 m0, s55, s42
    s_mul_i32 s63, s51, 4640
    s_add_u32 s63, s63, 135168
    v_mov_b64 v[84:85], 0
    v_mov_b64 v[86:87], 0
    s_cmp_eq_u32 s52, 0
    s_cbranch_scc1 L_cp_m
    s_setprio 1
    v_min_u32 v83, 29, v2
    v_lshl_add_u32 v83, v83, 4, s63
    ds_write_b128 v83, v[84:87]
    v_and_b32 v88, 0x70, v3
    v_add_u32 v88, 153728, v88
    ds_write_b128 v88, v[84:87]
    s_branch L_cp_e
L_cp_m:
    v_and_b32 v8, 15, v0
    v_bfe_u32 v9, v0, 4, 2
    v_and_b32 v10, 31, v0
    v_and_b32 v11, 32, v0
    v_mul_u32_u24 v78, 528, v10
    v_lshl_add_u32 v78, v11, 3, v78
    v_add_u32 v78, s55, v78
    v_lshrrev_b32 v11, 1, v11
    v_lshl_add_u32 v10, v10, 5, v11
    s_add_u32 s42, s55, 1072
    v_sub_u32 v81, s42, v10
    v_lshrrev_b32 v77, 2, v10
    s_add_u32 s42, s55, 5564
    v_sub_u32 v77, s42, v77
    v_bfe_i32 v79, v0, 4, 1
    v_sub_u32 v80, 495, v10
    v_ashrrev_i32 v80, 31, v80
    v_sub_u32 v82, 1007, v10
    v_ashrrev_i32 v82, 31, v82
    v_bfe_u32 v10, v0, 3, 2
    v_and_b32 v11, 7, v0
    v_mul_u32_u24 v73, 1216, v10
    v_and_b32 v83, 4, v0
    v_lshl_add_u32 v83, v83, 4, v11
    v_lshl_add_u32 v83, v83, 4, v73
    v_lshlrev_b32 v72, 4, v10
    v_add_u32 v72, 5120, v72
    v_sub_u32 v74, 5, v11
    v_ashrrev_i32 v74, 31, v74
    v_bfi_b32 v83, v74, v72, v83
    v_and_b32 v72, 8, v0
    v_mad_u32_u24 v72, v72, 3, v11
    v_lshlrev_b32 v72, 4, v72
    v_add_u32 v72, 5184, v72
    v_bfe_i32 v74, v0, 5, 1
    v_bfi_b32 v83, v74, v72, v83
    v_add_u32 v83, s55, v83
    v_sub_u32 v74, 4, v11
    v_ashrrev_i32 v74, 31, v74
    v_add_u32 v72, 507, v11
    v_min_u32 v75, 2, v11
    v_bfi_b32 v74, v74, v72, v75
    v_sub_u32 v74, v74, v10
    v_lshl_add_u32 v73, v74, 1, v73
    v_min_u32 v74, 1, v10
    v_lshl_add_u32 v73, v74, 3, v73
    s_add_u32 s42, s55, 58
    v_add_u32 v73, s42, v73
    v_max_u32 v72, 4, v11
    v_mul_u32_u24 v72, 0x202, v72
    v_add_u32 v72, 1284, v72
    v_and_b32 v72, 0x707, v72
L_cp_e:
L_clnp:
    s_mul_i32 s43, s39, 1216
    s_add_u32 s43, s43, 154048
    v_add_u32 v52, s43, v3
    v_add_u32 v53, s43, v4
    s_lshl_b32 s43, s39, 3
    s_add_u32 s43, s43, 163776
    v_mov_b32 v54, s43
    v_bfe_u32 v55, v0, 2, 2
    v_mul_u32_u24 v55, 1216, v55
    v_and_b32 v56, 3, v0
    v_lshl_add_u32 v55, v56, 3, v55
    v_lshrrev_b32 v56, 4, v0
    v_lshl_add_u32 v55, v56, 5, v55
    v_add_u32 v55, 154048, v55
    v_lshrrev_b32 v56, 3, v0
    v_lshlrev_b32 v56, 15, v56
    v_and_b32 v57, 112, v3
    s_lshl_b32 s43, s2, 7
    s_add_u32 s43, s43, 2097152
    v_add3_u32 v56, v56, v57, s43
    v_mov_b32 v40, 0
    v_mov_b32 v41, 0
    v_mov_b32 v42, 0
    v_mov_b32 v43, 0
    v_mov_b32 v44, 0x3ae38e39
    v_mov_b32 v38, 0xbfffbfff
    v_mov_b32 v37, 0xffff
    s_lshl_b32 s58, s2, 3
    s_add_u32 s58, s58, s39
    s_xor_b32 s58, s58, 0x7ff
    s_lshl_b32 s58, s58, 5
    s_waitcnt lgkmcnt(0)
    s_add_u32 s38, s38, 0x9e370001
    s_lshr_b32 s44, s38, 16
    s_and_b32 s45, s38, 0xff
    s_and_b32 s46, s38, 0xfb
    s_bitcmp0_b32 s38, 0
    s_cselect_b32 s43, 4, 0
    s_or_b32 s46, s46, s43
    s_bitcmp1_b32 s46, s39
    s_cselect_b32 s43, 0x40004000, 0
    v_mov_b32 v39, s43
    s_xor_b32 s58, s58, s44
    v_mov_b32 v57, s58
    s_mov_b32 s42, 0x3f803f80
    s_cmp_eq_u32 s47, 2
    s_cbranch_scc0 L_clw
    global_load_dword v1, v76, s[56:57]
    s_waitcnt vmcnt(9)
    s_branch L_cln
L_clw:
    s_waitcnt vmcnt(8)
L_cln:
    v_dot2c_f32_bf16 v40, s42, v12
    v_dot2c_f32_bf16 v41, v12, v12
    v_dot2c_f32_bf16 v42, v12, v20
    v_dot2c_f32_bf16 v43, s42, v20
    v_dot2c_f32_bf16 v40, s42, v13
    v_dot2c_f32_bf16 v41, v13, v13
    v_dot2c_f32_bf16 v42, v13, v21
    v_dot2c_f32_bf16 v43, s42, v21
    v_dot2c_f32_bf16 v40, s42, v14
    v_dot2c_f32_bf16 v41, v14, v14
    v_dot2c_f32_bf16 v42, v14, v22
    v_dot2c_f32_bf16 v43, s42, v22
    v_dot2c_f32_bf16 v40, s42, v15
    v_dot2c_f32_bf16 v41, v15, v15
    v_dot2c_f32_bf16 v42, v15, v23
    v_dot2c_f32_bf16 v43, s42, v23
    v_dot2c_f32_bf16 v40, s42, v16
    v_dot2c_f32_bf16 v41, v16, v16
    v_dot2c_f32_bf16 v42, v16, v24
    v_dot2c_f32_bf16 v43, s42, v24
    v_lshlrev_b32 v36, 16, v16
    v_lshlrev_b32 v28, 16, v12
    v_and_b32 v29, 0xffff0000, v12
    v_permlane32_swap_b32 v40, v42
    v_permlane32_swap_b32 v41, v43
    v_add_f32 v40, v40, v42
    v_add_f32 v41, v41, v43
    v_lshlrev_b32 v30, 16, v13
    v_and_b32 v31, 0xffff0000, v13
    v_permlane16_swap_b32 v40, v41
    v_add_f32 v40, v40, v41
    v_lshlrev_b32 v32, 16, v14
    v_and_b32 v33, 0xffff0000, v14
    v_add_f32_dpp v40, v40, v40 row_ror:8 row_mask:0xf bank_mask:0xf
    v_lshlrev_b32 v34, 16, v15
    v_and_b32 v35, 0xffff0000, v15
    v_add_f32_dpp v40, v40, v40 row_ror:4 row_mask:0xf bank_mask:0xf
    s_nop 1
    v_add_f32_dpp v40, v40, v40 row_ror:2 row_mask:0xf bank_mask:0xf
    s_nop 1
    v_add_f32_dpp v40, v40, v40 row_ror:1 row_mask:0xf bank_mask:0xf
    s_nop 0
    v_readlane_b32 s58, v40, 0
    v_readlane_b32 s59, v40, 16
    v_readlane_b32 s60, v40, 32
    v_readlane_b32 s61, v40, 48
    v_mul_f32 v40, s58, v44
    v_mul_f32 v41, s59, v44
    v_fma_f32 v41, -v40, v40, v41
    v_max_f32 v41, 0, v41
    v_cvt_pk_bf16_f32 v44, v41, v40
    v_lshlrev_b32 v41, 16, v44
    v_add_f32 v41, 0x3727c5ac, v41
    v_cvt_pk_bf16_f32 v41, v41, v41
    v_and_b32 v41, 0xffff0000, v41
    v_mul_f32 v41, 0x44800000, v41
    v_sqrt_f32 v41, v41
    v_and_b32 v49, 0xffff0000, v44
    v_cvt_pk_bf16_f32 v50, v49, v41
    v_and_b32 v41, 0xffff0000, v50
    v_rcp_f32 v46, v41
    v_mul_f32 v42, s61, v49
    v_mul_f32 v47, v49, v46
    v_fma_f32 v28, v28, v46, -v47
    v_fma_f32 v29, v29, v46, -v47
    v_fma_f32 v30, v30, v46, -v47
    v_fma_f32 v31, v31, v46, -v47
    v_fma_f32 v32, v32, v46, -v47
    v_fma_f32 v33, v33, v46, -v47
    v_fma_f32 v34, v34, v46, -v47
    v_fma_f32 v35, v35, v46, -v47
    v_fma_f32 v36, v36, v46, -v47
    v_cvt_pk_bf16_f32 v28, v28, v29
    v_cvt_pk_bf16_f32 v29, v30, v31
    v_cvt_pk_bf16_f32 v30, v32, v33
    v_cvt_pk_bf16_f32 v31, v34, v35
    v_cvt_pk_bf16_f32 v32, v36, v36
    v_bitop3_b32 v28, v28, v38, v39 bitop3:0xea
    v_bitop3_b32 v29, v29, v38, v39 bitop3:0xea
    v_bitop3_b32 v30, v30, v38, v39 bitop3:0xea
    v_bitop3_b32 v31, v31, v38, v39 bitop3:0xea
    v_bitop3_b32 v32, v32, v38, v39 bitop3:0xea
    ds_write_b128 v52, v[28:31]
    ds_write_b16 v53, v32 offset:1024
    v_sub_f32 v42, s60, v42
    v_mul_f32 v42, 0x42000000, v42
    v_mul_f32 v42, v42, v46
    v_cvt_pk_bf16_f32 v42, v42, v42
    v_ashrrev_i32 v43, 31, v42
    v_or_b32 v43, 0x80000000, v43
    v_xor_b32 v42, v42, v43
    v_bitop3_b32 v51, v37, v57, v42 bitop3:0xca
    s_mov_b64 exec, 1
    ds_write_b64 v54, v[50:51]
    s_mov_b64 exec, -1
    s_waitcnt lgkmcnt(0)
    s_barrier
    s_cmp_eq_u32 s39, 1
    s_cbranch_scc1 L_cln_stat
    ds_read_b64_tr_b16 v[28:29], v55
    ds_read_b64_tr_b16 v[30:31], v55 offset:4864
    s_cmp_eq_u32 s39, 0
    s_cbranch_scc0 L_cln_st
    ds_read_b64_tr_b16 v[32:33], v55 offset:1024
    ds_read_b64_tr_b16 v[34:35], v55 offset:5888
    v_add_u32 v38, 2097152, v56
    s_waitcnt lgkmcnt(0)
    global_store_dwordx4 v38, v[32:35], s[36:37] sc1
    s_branch L_cln_st
L_cln_stat:
    v_and_b32 v41, 0x30, v3
    v_add_u32 v40, 163776, v41
    ds_read_b128 v[48:51], v40
    ds_read_b64_tr_b16 v[28:29], v55
    ds_read_b64_tr_b16 v[30:31], v55 offset:4864
    s_lshl_b32 s43, s2, 6
    s_add_u32 s43, s43, 16384
    v_add_u32 v41, s43, v41
    s_mov_b64 exec, 15
    s_waitcnt lgkmcnt(2)
    global_store_dwordx4 v41, v[48:51], s[36:37] sc1
    s_mov_b64 exec, -1
L_cln_st:
    s_waitcnt lgkmcnt(0)
    global_store_dwordx4 v56, v[28:31], s[36:37] sc1
    s_waitcnt vmcnt(2)
    s_cmp_eq_u32 s47, 3
    s_cbranch_scc0 L_ct1
    global_load_dword v1, v76, s[56:57]
L_ct1:
    v_mul_f32 v70, 0x3fb8aa3b, v70
    v_exp_f32 v70, v70
    v_mov_b32 v34, 0x3f80
    ds_write_addtid_b32 v34
    v_cvt_pk_bf16_f32 v70, v70, v70
    v_and_b32 v70, 0xffff0000, v70
    v_mul_f32 v64, v70, v64
    v_mul_f32 v65, v70, v65
    v_mul_f32 v70, 0x44800000, v70
    v_mul_f32 v64, 0x3fb8aa3b, v64
    v_mul_f32 v65, 0x3e22f983, v65
    v_mul_f32 v66, v70, v66
    v_mul_f32 v67, v70, v67
    v_mul_f32 v13, 0x41800000, v64
    v_mul_f32 v17, 0x41800000, v65
    v_mul_f32 v14, 0x44000000, v64
    v_mul_f32 v18, 0x44000000, v65
    v_exp_f32 v12, v64
    v_fract_f32 v16, v65
    v_exp_f32 v13, v13
    v_fract_f32 v17, v17
    v_exp_f32 v14, v14
    v_fract_f32 v18, v18
    v_pk_mul_f32 v[20:21], v[68:69], v[66:67] op_sel:[0,0] op_sel_hi:[0,1] neg_hi:[0,1]
    v_pk_fma_f32 v[90:91], v[68:69], v[66:67], v[20:21] op_sel:[1,1,0] op_sel_hi:[1,0,1] neg_lo:[0,1,0] neg_hi:[0,1,0]
    v_cos_f32 v22, v16
    v_sin_f32 v23, v16
    v_cos_f32 v24, v17
    v_sin_f32 v25, v17
    v_cos_f32 v26, v18
    v_sin_f32 v27, v18
    v_cvt_pk_bf16_f32 v35, v90, v91
    ds_write_addtid_b32 v35 offset:16896
    v_mul_f32 v22, v12, v22
    v_mul_f32 v23, -v12, v23
    v_mul_f32 v24, v13, v24
    v_mul_f32 v25, v13, v25
    v_mul_f32 v26, v14, v26
    v_mul_f32 v27, -v14, v27
    v_cvt_pk_bf16_f32 v36, v24, v25
    ds_write_addtid_b32 v36 offset:528
L_cs2:
    v_pk_mul_f32 v[30:31], v[24:25], v[24:25] op_sel:[0,0] op_sel_hi:[0,1]
    v_pk_fma_f32 v[28:29], v[24:25], v[24:25], v[30:31] op_sel:[1,1,0] op_sel_hi:[1,0,1] neg_lo:[0,1,0]
    v_cvt_pk_bf16_f32 v34, v28, v29
    ds_write_addtid_b32 v34 offset:1056
    v_pk_mul_f32 v[32:33], v[90:91], v[22:23] op_sel:[0,0] op_sel_hi:[0,1]
    v_pk_fma_f32 v[92:93], v[90:91], v[22:23], v[32:33] op_sel:[1,1,0] op_sel_hi:[1,0,1] neg_lo:[0,1,0]
    v_cvt_pk_bf16_f32 v35, v92, v93
    ds_write_addtid_b32 v35 offset:17424
    v_pk_mul_f32 v[30:31], v[28:29], v[24:25] op_sel:[0,0] op_sel_hi:[0,1]
    v_pk_fma_f32 v[28:29], v[28:29], v[24:25], v[30:31] op_sel:[1,1,0] op_sel_hi:[1,0,1] neg_lo:[0,1,0]
    v_cvt_pk_bf16_f32 v36, v28, v29
    ds_write_addtid_b32 v36 offset:1584
    v_pk_mul_f32 v[32:33], v[92:93], v[22:23] op_sel:[0,0] op_sel_hi:[0,1]
    v_pk_fma_f32 v[94:95], v[92:93], v[22:23], v[32:33] op_sel:[1,1,0] op_sel_hi:[1,0,1] neg_lo:[0,1,0]
    v_cvt_pk_bf16_f32 v37, v94, v95
    ds_write_addtid_b32 v37 offset:17952
    v_pk_mul_f32 v[30:31], v[28:29], v[24:25] op_sel:[0,0] op_sel_hi:[0,1]
    v_pk_fma_f32 v[28:29], v[28:29], v[24:25], v[30:31] op_sel:[1,1,0] op_sel_hi:[1,0,1] neg_lo:[0,1,0]
    v_cvt_pk_bf16_f32 v34, v28, v29
    ds_write_addtid_b32 v34 offset:2112
    v_pk_mul_f32 v[32:33], v[94:95], v[22:23] op_sel:[0,0] op_sel_hi:[0,1]
    v_pk_fma_f32 v[96:97], v[94:95], v[22:23], v[32:33] op_sel:[1,1,0] op_sel_hi:[1,0,1] neg_lo:[0,1,0]
    v_cvt_pk_bf16_f32 v35, v96, v97
    ds_write_addtid_b32 v35 offset:18480
    v_pk_mul_f32 v[30:31], v[28:29], v[24:25] op_sel:[0,0] op_sel_hi:[0,1]
    v_pk_fma_f32 v[28:29], v[28:29], v[24:25], v[30:31] op_sel:[1,1,0] op_sel_hi:[1,0,1] neg_lo:[0,1,0]
    v_cvt_pk_bf16_f32 v36, v28, v29
    ds_write_addtid_b32 v36 offset:2640
    v_pk_mul_f32 v[32:33], v[96:97], v[22:23] op_sel:[0,0] op_sel_hi:[0,1]
    v_pk_fma_f32 v[98:99], v[96:97], v[22:23], v[32:33] op_sel:[1,1,0] op_sel_hi:[1,0,1] neg_lo:[0,1,0]
    v_cvt_pk_bf16_f32 v37, v98, v99
    ds_write_addtid_b32 v37 offset:21120
    v_pk_mul_f32 v[30:31], v[28:29], v[24:25] op_sel:[0,0] op_sel_hi:[0,1]
    v_pk_fma_f32 v[28:29], v[28:29], v[24:25], v[30:31] op_sel:[1,1,0] op_sel_hi:[1,0,1] neg_lo:[0,1,0]
    v_cvt_pk_bf16_f32 v34, v28, v29
    ds_write_addtid_b32 v34 offset:3168
    v_pk_mul_f32 v[32:33], v[98:99], v[22:23] op_sel:[0,0] op_sel_hi:[0,1]
    v_pk_fma_f32 v[100:101], v[98:99], v[22:23], v[32:33] op_sel:[1,1,0] op_sel_hi:[1,0,1] neg_lo:[0,1,0]
    v_cvt_pk_bf16_f32 v35, v100, v101
    ds_write_addtid_b32 v35 offset:21648
    v_pk_mul_f32 v[30:31], v[28:29], v[24:25] op_sel:[0,0] op_sel_hi:[0,1]
    v_pk_fma_f32 v[28:29], v[28:29], v[24:25], v[30:31] op_sel:[1,1,0] op_sel_hi:[1,0,1] neg_lo:[0,1,0]
    v_cvt_pk_bf16_f32 v36, v28, v29
    ds_write_addtid_b32 v36 offset:3696
    v_pk_mul_f32 v[32:33], v[100:101], v[22:23] op_sel:[0,0] op_sel_hi:[0,1]
    v_pk_fma_f32 v[102:103], v[100:101], v[22:23], v[32:33] op_sel:[1,1,0] op_sel_hi:[1,0,1] neg_lo:[0,1,0]
    v_cvt_pk_bf16_f32 v37, v102, v103
    ds_write_addtid_b32 v37 offset:22176
    v_pk_mul_f32 v[30:31], v[28:29], v[24:25] op_sel:[0,0] op_sel_hi:[0,1]
    v_pk_fma_f32 v[28:29], v[28:29], v[24:25], v[30:31] op_sel:[1,1,0] op_sel_hi:[1,0,1] neg_lo:[0,1,0]
    v_cvt_pk_bf16_f32 v34, v28, v29
    ds_write_addtid_b32 v34 offset:4224
    v_pk_mul_f32 v[32:33], v[102:103], v[22:23] op_sel:[0,0] op_sel_hi:[0,1]
    v_pk_fma_f32 v[104:105], v[102:103], v[22:23], v[32:33] op_sel:[1,1,0] op_sel_hi:[1,0,1] neg_lo:[0,1,0]
    v_cvt_pk_bf16_f32 v35, v104, v105
    ds_write_addtid_b32 v35 offset:22704
    v_pk_mul_f32 v[30:31], v[28:29], v[24:25] op_sel:[0,0] op_sel_hi:[0,1]
    v_pk_fma_f32 v[28:29], v[28:29], v[24:25], v[30:31] op_sel:[1,1,0] op_sel_hi:[1,0,1] neg_lo:[0,1,0]
    v_cvt_pk_bf16_f32 v36, v28, v29
    ds_write_addtid_b32 v36 offset:4752
    v_pk_mul_f32 v[32:33], v[104:105], v[22:23] op_sel:[0,0] op_sel_hi:[0,1]
    v_pk_fma_f32 v[106:107], v[104:105], v[22:23], v[32:33] op_sel:[1,1,0] op_sel_hi:[1,0,1] neg_lo:[0,1,0]
    v_cvt_pk_bf16_f32 v12, v106, v107
    ds_write_addtid_b32 v12 offset:19008
    v_pk_mul_f32 v[30:31], v[28:29], v[24:25] op_sel:[0,0] op_sel_hi:[0,1]
    v_pk_fma_f32 v[28:29], v[28:29], v[24:25], v[30:31] op_sel:[1,1,0] op_sel_hi:[1,0,1] neg_lo:[0,1,0]
    v_cvt_pk_bf16_f32 v34, v28, v29
    ds_write_addtid_b32 v34 offset:5280
    v_pk_mul_f32 v[32:33], v[106:107], v[22:23] op_sel:[0,0] op_sel_hi:[0,1]
    v_pk_fma_f32 v[108:109], v[106:107], v[22:23], v[32:33] op_sel:[1,1,0] op_sel_hi:[1,0,1] neg_lo:[0,1,0]
    v_cvt_pk_bf16_f32 v13, v108, v109
    ds_write_addtid_b32 v13 offset:19536
    v_pk_mul_f32 v[30:31], v[28:29], v[24:25] op_sel:[0,0] op_sel_hi:[0,1]
    v_pk_fma_f32 v[28:29], v[28:29], v[24:25], v[30:31] op_sel:[1,1,0] op_sel_hi:[1,0,1] neg_lo:[0,1,0]
    v_cvt_pk_bf16_f32 v36, v28, v29
    ds_write_addtid_b32 v36 offset:5808
    v_pk_mul_f32 v[32:33], v[108:109], v[22:23] op_sel:[0,0] op_sel_hi:[0,1]
    v_pk_fma_f32 v[110:111], v[108:109], v[22:23], v[32:33] op_sel:[1,1,0] op_sel_hi:[1,0,1] neg_lo:[0,1,0]
    v_cvt_pk_bf16_f32 v14, v110, v111
    ds_write_addtid_b32 v14 offset:20064
    v_pk_mul_f32 v[30:31], v[28:29], v[24:25] op_sel:[0,0] op_sel_hi:[0,1]
    v_pk_fma_f32 v[28:29], v[28:29], v[24:25], v[30:31] op_sel:[1,1,0] op_sel_hi:[1,0,1] neg_lo:[0,1,0]
    v_cvt_pk_bf16_f32 v34, v28, v29
    ds_write_addtid_b32 v34 offset:6336
    v_pk_mul_f32 v[32:33], v[110:111], v[22:23] op_sel:[0,0] op_sel_hi:[0,1]
    v_pk_fma_f32 v[112:113], v[110:111], v[22:23], v[32:33] op_sel:[1,1,0] op_sel_hi:[1,0,1] neg_lo:[0,1,0]
    v_cvt_pk_bf16_f32 v35, v112, v113
    ds_write_addtid_b32 v35 offset:20592
    v_pk_mul_f32 v[30:31], v[28:29], v[24:25] op_sel:[0,0] op_sel_hi:[0,1]
    v_pk_fma_f32 v[28:29], v[28:29], v[24:25], v[30:31] op_sel:[1,1,0] op_sel_hi:[1,0,1] neg_lo:[0,1,0]
    v_cvt_pk_bf16_f32 v36, v28, v29
    ds_write_addtid_b32 v36 offset:6864
    v_pk_mul_f32 v[32:33], v[112:113], v[22:23] op_sel:[0,0] op_sel_hi:[0,1]
    v_pk_fma_f32 v[114:115], v[112:113], v[22:23], v[32:33] op_sel:[1,1,0] op_sel_hi:[1,0,1] neg_lo:[0,1,0]
    v_cvt_pk_bf16_f32 v37, v114, v115
    ds_write_addtid_b32 v37 offset:23232
    v_pk_mul_f32 v[30:31], v[28:29], v[24:25] op_sel:[0,0] op_sel_hi:[0,1]
    v_pk_fma_f32 v[28:29], v[28:29], v[24:25], v[30:31] op_sel:[1,1,0] op_sel_hi:[1,0,1] neg_lo:[0,1,0]
    v_cvt_pk_bf16_f32 v34, v28, v29
    ds_write_addtid_b32 v34 offset:7392
    v_pk_mul_f32 v[32:33], v[114:115], v[22:23] op_sel:[0,0] op_sel_hi:[0,1]
    v_pk_fma_f32 v[116:117], v[114:115], v[22:23], v[32:33] op_sel:[1,1,0] op_sel_hi:[1,0,1] neg_lo:[0,1,0]
    v_cvt_pk_bf16_f32 v35, v116, v117
    ds_write_addtid_b32 v35 offset:23760
    v_pk_mul_f32 v[30:31], v[28:29], v[24:25] op_sel:[0,0] op_sel_hi:[0,1]
    v_pk_fma_f32 v[28:29], v[28:29], v[24:25], v[30:31] op_sel:[1,1,0] op_sel_hi:[1,0,1] neg_lo:[0,1,0]
    v_cvt_pk_bf16_f32 v36, v28, v29
    ds_write_addtid_b32 v36 offset:7920
    v_pk_mul_f32 v[32:33], v[116:117], v[22:23] op_sel:[0,0] op_sel_hi:[0,1]
    v_pk_fma_f32 v[118:119], v[116:117], v[22:23], v[32:33] op_sel:[1,1,0] op_sel_hi:[1,0,1] neg_lo:[0,1,0]
    v_cvt_pk_bf16_f32 v37, v118, v119
    ds_write_addtid_b32 v37 offset:24288
    v_pk_mul_f32 v[30:31], v[28:29], v[24:25] op_sel:[0,0] op_sel_hi:[0,1]
    v_pk_fma_f32 v[28:29], v[28:29], v[24:25], v[30:31] op_sel:[1,1,0] op_sel_hi:[1,0,1] neg_lo:[0,1,0]
    v_cvt_pk_bf16_f32 v34, v28, v29
    ds_write_addtid_b32 v34 offset:8448
    v_pk_mul_f32 v[32:33], v[118:119], v[22:23] op_sel:[0,0] op_sel_hi:[0,1]
    v_pk_fma_f32 v[120:121], v[118:119], v[22:23], v[32:33] op_sel:[1,1,0] op_sel_hi:[1,0,1] neg_lo:[0,1,0]
    v_cvt_pk_bf16_f32 v35, v120, v121
    ds_write_addtid_b32 v35 offset:24816
    v_pk_mul_f32 v[30:31], v[28:29], v[24:25] op_sel:[0,0] op_sel_hi:[0,1]
    v_pk_fma_f32 v[28:29], v[28:29], v[24:25], v[30:31] op_sel:[1,1,0] op_sel_hi:[1,0,1] neg_lo:[0,1,0]
    v_cvt_pk_bf16_f32 v36, v28, v29
    ds_write_addtid_b32 v36 offset:8976
    v_pk_mul_f32 v[32:33], v[120:121], v[22:23] op_sel:[0,0] op_sel_hi:[0,1]
    v_pk_fma_f32 v[122:123], v[120:121], v[22:23], v[32:33] op_sel:[1,1,0] op_sel_hi:[1,0,1] neg_lo:[0,1,0]
    v_cvt_pk_bf16_f32 v37, v122, v123
    ds_write_addtid_b32 v37 offset:27456
    v_pk_mul_f32 v[30:31], v[28:29], v[24:25] op_sel:[0,0] op_sel_hi:[0,1]
    v_pk_fma_f32 v[28:29], v[28:29], v[24:25], v[30:31] op_sel:[1,1,0] op_sel_hi:[1,0,1] neg_lo:[0,1,0]
    v_cvt_pk_bf16_f32 v34, v28, v29
    ds_write_addtid_b32 v34 offset:9504
    v_pk_mul_f32 v[32:33], v[122:123], v[22:23] op_sel:[0,0] op_sel_hi:[0,1]
    v_pk_fma_f32 v[124:125], v[122:123], v[22:23], v[32:33] op_sel:[1,1,0] op_sel_hi:[1,0,1] neg_lo:[0,1,0]
    v_cvt_pk_bf16_f32 v35, v124, v125
    ds_write_addtid_b32 v35 offset:27984
    v_pk_mul_f32 v[30:31], v[28:29], v[24:25] op_sel:[0,0] op_sel_hi:[0,1]
    v_pk_fma_f32 v[28:29], v[28:29], v[24:25], v[30:31] op_sel:[1,1,0] op_sel_hi:[1,0,1] neg_lo:[0,1,0]
    v_cvt_pk_bf16_f32 v36, v28, v29
    ds_write_addtid_b32 v36 offset:10032
    v_pk_mul_f32 v[32:33], v[124:125], v[22:23] op_sel:[0,0] op_sel_hi:[0,1]
    v_pk_fma_f32 v[126:127], v[124:125], v[22:23], v[32:33] op_sel:[1,1,0] op_sel_hi:[1,0,1] neg_lo:[0,1,0]
    v_cvt_pk_bf16_f32 v37, v126, v127
    ds_write_addtid_b32 v37 offset:28512
    v_pk_mul_f32 v[30:31], v[28:29], v[24:25] op_sel:[0,0] op_sel_hi:[0,1]
    v_pk_fma_f32 v[28:29], v[28:29], v[24:25], v[30:31] op_sel:[1,1,0] op_sel_hi:[1,0,1] neg_lo:[0,1,0]
    v_cvt_pk_bf16_f32 v34, v28, v29
    ds_write_addtid_b32 v34 offset:10560
    v_pk_mul_f32 v[32:33], v[98:99], v[26:27] op_sel:[0,0] op_sel_hi:[0,1]
    v_pk_fma_f32 v[98:99], v[98:99], v[26:27], v[32:33] op_sel:[1,1,0] op_sel_hi:[1,0,1] neg_lo:[0,1,0]
    v_cvt_pk_bf16_f32 v35, v98, v99
    ds_write_addtid_b32 v35 offset:29568
    v_pk_mul_f32 v[30:31], v[28:29], v[24:25] op_sel:[0,0] op_sel_hi:[0,1]
    v_pk_fma_f32 v[28:29], v[28:29], v[24:25], v[30:31] op_sel:[1,1,0] op_sel_hi:[1,0,1] neg_lo:[0,1,0]
    v_cvt_pk_bf16_f32 v36, v28, v29
    ds_write_addtid_b32 v36 offset:11088
    v_pk_mul_f32 v[32:33], v[106:107], v[26:27] op_sel:[0,0] op_sel_hi:[0,1]
    v_pk_fma_f32 v[106:107], v[106:107], v[26:27], v[32:33] op_sel:[1,1,0] op_sel_hi:[1,0,1] neg_lo:[0,1,0]
    v_cvt_pk_bf16_f32 v37, v106, v107
    ds_write_addtid_b32 v37 offset:30096
    v_pk_mul_f32 v[30:31], v[28:29], v[24:25] op_sel:[0,0] op_sel_hi:[0,1]
    v_pk_fma_f32 v[28:29], v[28:29], v[24:25], v[30:31] op_sel:[1,1,0] op_sel_hi:[1,0,1] neg_lo:[0,1,0]
    v_cvt_pk_bf16_f32 v34, v28, v29
    ds_write_addtid_b32 v34 offset:11616
    v_pk_mul_f32 v[32:33], v[114:115], v[26:27] op_sel:[0,0] op_sel_hi:[0,1]
    v_pk_fma_f32 v[114:115], v[114:115], v[26:27], v[32:33] op_sel:[1,1,0] op_sel_hi:[1,0,1] neg_lo:[0,1,0]
    v_cvt_pk_bf16_f32 v35, v114, v115
    ds_write_addtid_b32 v35 offset:31680
    v_pk_mul_f32 v[30:31], v[28:29], v[24:25] op_sel:[0,0] op_sel_hi:[0,1]
    v_pk_fma_f32 v[28:29], v[28:29], v[24:25], v[30:31] op_sel:[1,1,0] op_sel_hi:[1,0,1] neg_lo:[0,1,0]
    v_cvt_pk_bf16_f32 v36, v28, v29
    ds_write_addtid_b32 v36 offset:12144
    v_pk_mul_f32 v[32:33], v[122:123], v[26:27] op_sel:[0,0] op_sel_hi:[0,1]
    v_pk_fma_f32 v[122:123], v[122:123], v[26:27], v[32:33] op_sel:[1,1,0] op_sel_hi:[1,0,1] neg_lo:[0,1,0]
    v_cvt_pk_bf16_f32 v37, v122, v123
    ds_write_addtid_b32 v37 offset:32208
    v_pk_mul_f32 v[30:31], v[28:29], v[24:25] op_sel:[0,0] op_sel_hi:[0,1]
    v_pk_fma_f32 v[28:29], v[28:29], v[24:25], v[30:31] op_sel:[1,1,0] op_sel_hi:[1,0,1] neg_lo:[0,1,0]
    v_cvt_pk_bf16_f32 v34, v28, v29
    ds_write_addtid_b32 v34 offset:12672
    v_pk_mul_f32 v[32:33], v[106:107], v[26:27] op_sel:[0,0] op_sel_hi:[0,1]
    v_pk_fma_f32 v[106:107], v[106:107], v[26:27], v[32:33] op_sel:[1,1,0] op_sel_hi:[1,0,1] neg_lo:[0,1,0]
    v_cvt_pk_bf16_f32 v35, v106, v107
    ds_write_addtid_b32 v35 offset:30624
    v_pk_mul_f32 v[30:31], v[28:29], v[24:25] op_sel:[0,0] op_sel_hi:[0,1]
    v_pk_fma_f32 v[28:29], v[28:29], v[24:25], v[30:31] op_sel:[1,1,0] op_sel_hi:[1,0,1] neg_lo:[0,1,0]
    v_cvt_pk_bf16_f32 v36, v28, v29
    ds_write_addtid_b32 v36 offset:13200
    v_pk_mul_f32 v[32:33], v[122:123], v[26:27] op_sel:[0,0] op_sel_hi:[0,1]
    v_pk_fma_f32 v[122:123], v[122:123], v[26:27], v[32:33] op_sel:[1,1,0] op_sel_hi:[1,0,1] neg_lo:[0,1,0]
    v_cvt_pk_bf16_f32 v37, v122, v123
    ds_write_addtid_b32 v37 offset:31152
    v_pk_mul_f32 v[30:31], v[28:29], v[24:25] op_sel:[0,0] op_sel_hi:[0,1]
    v_pk_fma_f32 v[28:29], v[28:29], v[24:25], v[30:31] op_sel:[1,1,0] op_sel_hi:[1,0,1] neg_lo:[0,1,0]
    v_cvt_pk_bf16_f32 v34, v28, v29
    ds_write_addtid_b32 v34 offset:13728
    v_pk_mul_f32 v[32:33], v[106:107], v[26:27] op_sel:[0,0] op_sel_hi:[0,1]
    v_pk_fma_f32 v[106:107], v[106:107], v[26:27], v[32:33] op_sel:[1,1,0] op_sel_hi:[1,0,1] neg_lo:[0,1,0]
    v_cvt_pk_bf16_f32 v35, v106, v107
    ds_write_addtid_b32 v35 offset:32736
    v_pk_mul_f32 v[30:31], v[28:29], v[24:25] op_sel:[0,0] op_sel_hi:[0,1]
    v_pk_fma_f32 v[28:29], v[28:29], v[24:25], v[30:31] op_sel:[1,1,0] op_sel_hi:[1,0,1] neg_lo:[0,1,0]
    v_cvt_pk_bf16_f32 v36, v28, v29
    ds_write_addtid_b32 v36 offset:14256
    v_pk_mul_f32 v[32:33], v[122:123], v[26:27] op_sel:[0,0] op_sel_hi:[0,1]
    v_pk_fma_f32 v[122:123], v[122:123], v[26:27], v[32:33] op_sel:[1,1,0] op_sel_hi:[1,0,1] neg_lo:[0,1,0]
    v_cvt_pk_bf16_f32 v37, v122, v123
    ds_write_addtid_b32 v37 offset:33264
    v_pk_mul_f32 v[30:31], v[28:29], v[24:25] op_sel:[0,0] op_sel_hi:[0,1]
    v_pk_fma_f32 v[28:29], v[28:29], v[24:25], v[30:31] op_sel:[1,1,0] op_sel_hi:[1,0,1] neg_lo:[0,1,0]
    v_cvt_pk_bf16_f32 v34, v28, v29
    ds_write_addtid_b32 v34 offset:14784
    v_pk_mul_f32 v[30:31], v[28:29], v[24:25] op_sel:[0,0] op_sel_hi:[0,1]
    v_pk_fma_f32 v[28:29], v[28:29], v[24:25], v[30:31] op_sel:[1,1,0] op_sel_hi:[1,0,1] neg_lo:[0,1,0]
    v_cvt_pk_bf16_f32 v36, v28, v29
    ds_write_addtid_b32 v36 offset:15312
    v_pk_mul_f32 v[30:31], v[28:29], v[24:25] op_sel:[0,0] op_sel_hi:[0,1]
    v_pk_fma_f32 v[28:29], v[28:29], v[24:25], v[30:31] op_sel:[1,1,0] op_sel_hi:[1,0,1] neg_lo:[0,1,0]
    v_cvt_pk_bf16_f32 v34, v28, v29
    ds_write_addtid_b32 v34 offset:15840
    v_pk_mul_f32 v[30:31], v[28:29], v[24:25] op_sel:[0,0] op_sel_hi:[0,1]
    v_pk_fma_f32 v[28:29], v[28:29], v[24:25], v[30:31] op_sel:[1,1,0] op_sel_hi:[1,0,1] neg_lo:[0,1,0]
    v_cvt_pk_bf16_f32 v36, v28, v29
    ds_write_addtid_b32 v36 offset:16368
    ds_write_addtid_b32 v12 offset:25344
    ds_write_addtid_b32 v13 offset:25872
    ds_write_addtid_b32 v14 offset:26400
    s_cmp_eq_u32 s52, 0
    s_cbranch_scc0 L_helper
    s_setprio 2
    s_waitcnt lgkmcnt(0)
    s_barrier
    ds_read_b128 v[128:131], v78 offset:16896
    ds_read_b128 v[132:135], v78 offset:0
    ds_read_b128 v[136:139], v78 offset:16912
    ds_read_b128 v[140:143], v78 offset:16
    ds_read_b128 v[144:147], v78 offset:16928
    ds_read_b128 v[148:151], v78 offset:32
    ds_read_b128 v[152:155], v78 offset:16944
    ds_read_b128 v[156:159], v78 offset:48
    ds_read_b128 v[160:163], v78 offset:16960
    ds_read_b128 v[164:167], v78 offset:64
    ds_read_b128 v[168:171], v78 offset:16976
    ds_read_b128 v[172:175], v78 offset:80
    v_add_u32 v74, -1, v2
    s_waitcnt vmcnt(0)
    v_and_b32 v71, v71, v74
    v_mul_f32 v71, 0x44800000, v71
    v_and_b32 v10, 3, v8
    v_add_u32 v5, 1, v10
    s_waitcnt lgkmcnt(10)
    v_mfma_f32_32x32x16_bf16 v[48:63], v[128:131], v[132:135], 0
    ds_read_b128 v[176:179], v78 offset:16992
    ds_read_b128 v[180:183], v78 offset:96
    v_mul_u32_u24 v10, 1214, v10
    s_waitcnt lgkmcnt(10)
    v_mfma_f32_32x32x16_bf16 v[48:63], v[136:139], v[140:143], v[48:63]
    ds_read_b128 v[184:187], v78 offset:17008
    ds_read_b128 v[188:191], v78 offset:112
    v_lshl_add_u32 v11, v8, 1, v9
    s_waitcnt lgkmcnt(10)
    v_mfma_f32_32x32x16_bf16 v[48:63], v[144:147], v[148:151], v[48:63]
    ds_read_b128 v[192:195], v78 offset:17024
    ds_read_b128 v[196:199], v78 offset:128
    v_mul_u32_u24 v4, 17, v9
    s_waitcnt lgkmcnt(10)
    v_mfma_f32_32x32x16_bf16 v[48:63], v[152:155], v[156:159], v[48:63]
    ds_read_b128 v[200:203], v78 offset:17040
    ds_read_b128 v[204:207], v78 offset:144
    v_sub_u32 v4, v4, v11
    s_waitcnt lgkmcnt(10)
    v_mfma_f32_32x32x16_bf16 v[48:63], v[160:163], v[164:167], v[48:63]
    ds_read_b128 v[208:211], v78 offset:17056
    ds_read_b128 v[212:215], v78 offset:160
    v_and_b32 v5, 4, v5
    s_waitcnt lgkmcnt(10)
    v_mfma_f32_32x32x16_bf16 v[48:63], v[168:171], v[172:175], v[48:63]
    ds_read_b128 v[216:219], v78 offset:17072
    ds_read_b128 v[220:223], v78 offset:176
    s_add_u32 s43, s55, 3680
    s_waitcnt lgkmcnt(10)
    v_mfma_f32_32x32x16_bf16 v[48:63], v[176:179], v[180:183], v[48:63]
    ds_read_b128 v[224:227], v78 offset:17088
    ds_read_b128 v[228:231], v78 offset:192
    v_lshl_add_u32 v10, v5, 1, v10
    s_waitcnt lgkmcnt(10)
    v_mfma_f32_32x32x16_bf16 v[48:63], v[184:187], v[188:191], v[48:63]
    ds_read_b128 v[232:235], v78 offset:17104
    ds_read_b128 v[236:239], v78 offset:208
    v_sub_u32 v10, v4, v10
    s_waitcnt lgkmcnt(10)
    v_mfma_f32_32x32x16_bf16 v[48:63], v[192:195], v[196:199], v[48:63]
    ds_read_b128 v[240:243], v78 offset:17120
    ds_read_b128 v[244:247], v78 offset:224
    v_add_u32 v10, s43, v10
    s_waitcnt lgkmcnt(10)
    v_mfma_f32_32x32x16_bf16 v[48:63], v[200:203], v[204:207], v[48:63]
    ds_read_b128 v[248:251], v78 offset:17136
    ds_read_b128 v[252:255], v78 offset:240
    v_lshl_add_u32 v11, v11, 4, s63
    s_waitcnt lgkmcnt(10)
    v_mfma_f32_32x32x16_bf16 v[48:63], v[208:211], v[212:215], v[48:63]
    s_add_u32 s43, s55, 5116
    s_waitcnt lgkmcnt(8)
    v_mfma_f32_32x32x16_bf16 v[48:63], v[216:219], v[220:223], v[48:63]
    v_lshrrev_b32 v75, 2, v3
    s_waitcnt lgkmcnt(6)
    v_mfma_f32_32x32x16_bf16 v[48:63], v[224:227], v[228:231], v[48:63]
    v_sub_u32 v75, s43, v75
    s_waitcnt lgkmcnt(4)
    v_mfma_f32_32x32x16_bf16 v[48:63], v[232:235], v[236:239], v[48:63]
    v_lshl_add_u32 v7, v9, 6, v3
    s_waitcnt lgkmcnt(2)
    v_mfma_f32_32x32x16_bf16 v[48:63], v[240:243], v[244:247], v[48:63]
    v_add_u32 v7, s55, v7
    s_waitcnt lgkmcnt(0)
    v_mfma_f32_32x32x16_bf16 v[48:63], v[248:251], v[252:255], v[48:63]
    v_lshlrev_b32 v4, 2, v9
    ds_write_b128 v83, v[84:87]
    v_sub_u32 v4, v4, v8
    s_add_u32 s43, s55, 5304
    v_lshl_add_u32 v89, v4, 3, s43
    s_add_u32 s43, s55, 4924
    v_lshl_add_u32 v4, v4, 2, s43
    s_lshl_b32 s43, s51, 2
    s_add_u32 s43, s43, 153728
    v_mov_b32 v88, s43
    v_add_u32 v5, 154048, v3
    s_nop 0
    v_add_f32 v48, v48, v71
    v_bitop3_b32 v49, v79, v48, v49 bitop3:0xca
    v_bitop3_b32 v51, v79, v52, v51 bitop3:0xca
    v_bitop3_b32 v53, v79, v52, v53 bitop3:0xca
    v_bitop3_b32 v55, v79, v56, v55 bitop3:0xca
    v_cvt_pk_bf16_f32 v128, v55, v54
    v_cvt_pk_bf16_f32 v129, v53, v52
    v_cvt_pk_bf16_f32 v130, v51, v50
    v_cvt_pk_bf16_f32 v131, v49, v48
    ds_write_b128 v81, v[128:131] offset:0
    v_bitop3_b32 v57, v80, v56, v57 bitop3:0xca
    v_bitop3_b32 v58, v82, v56, v58 bitop3:0xca
    v_cvt_pk_bf16_f32 v132, v56, v55
    v_cvt_pk_bf16_f32 v133, v54, v53
    v_cvt_pk_bf16_f32 v134, v52, v51
    v_cvt_pk_bf16_f32 v135, v50, v49
    ds_write_b128 v81, v[132:135] offset:3648
    v_readlane_b32 s42, v130, 0
    v_readlane_b32 s43, v131, 0
    v_readlane_b32 s58, v128, 63
    v_cvt_pk_bf16_f32 v136, v57, v56
    v_cvt_pk_bf16_f32 v137, v55, v54
    v_cvt_pk_bf16_f32 v138, v53, v52
    v_cvt_pk_bf16_f32 v139, v51, v50
    ds_write_b128 v81, v[136:139] offset:2432
    s_pack_lh_b32_b16 s42, s58, s42
    v_mov_b32 v71, s42
    v_perm_b32 v71, v71, s43, v72
    v_cvt_pk_bf16_f32 v140, v58, v57
    v_cvt_pk_bf16_f32 v141, v56, v55
    v_cvt_pk_bf16_f32 v142, v54, v53
    v_cvt_pk_bf16_f32 v143, v52, v51
    ds_write_b128 v81, v[140:143] offset:1216
    ds_write_b16 v73, v71
    v_cvt_pk_bf16_f32 v72, v61, v60
    v_cvt_pk_bf16_f32 v74, v63, v62
    ds_write_b32 v77, v72
    v_readlane_b32 s59, v72, 63
    ds_write_b32 v75, v74
    s_and_b32 s59, s59, 0xffff
    s_cmp_lt_u32 s39, 2
    s_cbranch_scc0 L_ct3
    global_load_dword v1, v76, s[56:57]
L_ct3:
    ds_read_b64 v[220:221], v10 offset:576
    ds_read_b64 v[222:223], v10 offset:584
    ds_read_b64 v[252:253], v10 offset:64
    ds_read_b64 v[254:255], v10 offset:72
    ds_read_b64 v[216:217], v10 offset:640
    ds_read_b64 v[218:219], v10 offset:648
    ds_read_b64 v[248:249], v10 offset:128
    ds_read_b64 v[250:251], v10 offset:136
    ds_read_b64 v[212:213], v10 offset:704
    ds_read_b64 v[214:215], v10 offset:712
    ds_read_b64 v[244:245], v10 offset:192
    ds_read_b64 v[246:247], v10 offset:200
    ds_read_b64 v[208:209], v10 offset:768
    ds_read_b64 v[210:211], v10 offset:776
    ds_read_b64 v[240:241], v10 offset:256
    ds_read_b64 v[242:243], v10 offset:264
    ds_read_b64 v[204:205], v10 offset:832
    ds_read_b64 v[206:207], v10 offset:840
    ds_read_b64 v[236:237], v10 offset:320
    ds_read_b64 v[238:239], v10 offset:328
    ds_read_b64 v[200:201], v10 offset:896
    ds_read_b64 v[202:203], v10 offset:904
    ds_read_b64 v[232:233], v10 offset:384
    ds_read_b64 v[234:235], v10 offset:392
    ds_read_b64 v[196:197], v10 offset:960
    ds_read_b64 v[198:199], v10 offset:968
    ds_read_b64 v[228:229], v10 offset:448
    ds_read_b64 v[230:231], v10 offset:456
    ds_read_b64 v[192:193], v10 offset:1024
    ds_read_b64 v[194:195], v10 offset:1032
    ds_read_b64 v[224:225], v10 offset:512
    ds_read_b64 v[226:227], v10 offset:520
    s_waitcnt lgkmcnt(6)
    s_barrier
    s_setprio 1
    ds_read_b128 v[68:71], v11 offset:0
    ds_read_b128 v[72:75], v11 offset:64
    ds_read_b128 v[76:79], v11 offset:128
    ds_read_b128 v[80:83], v11 offset:192
    ds_read_b128 v[16:19], v5 offset:0
    ds_read_b128 v[84:87], v11 offset:256
    ds_read_b128 v[132:135], v11 offset:320
    s_waitcnt lgkmcnt(6)
    v_mfma_f32_16x16x32_bf16 v[44:47], v[220:223], v[68:71], 0
    v_mfma_f32_16x16x32_bf16 v[48:51], v[252:255], v[68:71], 0
    ds_read_b128 v[68:71], v11 offset:384
    s_waitcnt lgkmcnt(5)
    v_mfma_f32_16x16x32_bf16 v[44:47], v[216:219], v[72:75], v[44:47]
    v_mfma_f32_16x16x32_bf16 v[48:51], v[248:251], v[72:75], v[48:51]
    ds_read_b128 v[72:75], v11 offset:448
    v_mfma_f32_16x16x32_bf16 v[44:47], v[212:215], v[76:79], v[44:47]
    ds_read_b128 v[28:31], v5 offset:1024
    v_mfma_f32_16x16x32_bf16 v[48:51], v[244:247], v[76:79], v[48:51]
    ds_read_b128 v[32:35], v5 offset:2048
    ds_read_b128 v[36:39], v5 offset:3072
    s_waitcnt lgkmcnt(6)
    v_mfma_f32_16x16x32_bf16 v[44:47], v[208:211], v[80:83], v[44:47]
    ds_read_b128 v[20:23], v5 offset:4096
    ds_read_b128 v[24:27], v5 offset:5120
    v_mfma_f32_16x16x32_bf16 v[48:51], v[240:243], v[80:83], v[48:51]
    ds_read_b64 v[12:13], v10 offset:0
    v_lshrrev_b32 v16, 7, v16
    v_mfma_f32_16x16x32_bf16 v[44:47], v[204:207], v[84:87], v[44:47]
    ds_read_b64 v[14:15], v10 offset:8
    v_and_b32 v16, 0x10001, v16
    v_mfma_f32_16x16x32_bf16 v[48:51], v[236:239], v[84:87], v[48:51]
    ds_read_b128 v[76:79], v11 offset:432
    s_waitcnt lgkmcnt(9)
    v_mfma_f32_16x16x32_bf16 v[44:47], v[200:203], v[132:135], v[44:47]
    ds_read_b128 v[80:83], v11 offset:512
    v_mul_u32_u24 v16, s59, v16
    v_mfma_f32_16x16x32_bf16 v[48:51], v[232:235], v[132:135], v[48:51]
    ds_read_b128 v[84:87], v11 offset:576
    v_lshrrev_b32 v17, 7, v17
    v_mfma_f32_16x16x32_bf16 v[44:47], v[196:199], v[68:71], v[44:47]
    v_and_b32 v17, 0x10001, v17
    v_mfma_f32_16x16x32_bf16 v[48:51], v[228:231], v[68:71], v[48:51]
    s_waitcnt lgkmcnt(10)
    v_mul_u32_u24 v17, s59, v17
    v_mfma_f32_16x16x32_bf16 v[44:47], v[192:195], v[72:75], v[44:47]
    ds_read_b128 v[132:135], v11 offset:640
    v_lshrrev_b32 v18, 7, v18
    v_mfma_f32_16x16x32_bf16 v[48:51], v[224:227], v[72:75], v[48:51]
    s_waitcnt lgkmcnt(6)
    v_and_b32 v18, 0x10001, v18
    v_mfma_f32_16x16x32_bf16 v[108:111], v[72:75], v[28:31], 0
    ds_read_b128 v[68:71], v11 offset:704
    v_mul_u32_u24 v18, s59, v18
    v_mfma_f32_16x16x32_bf16 v[112:115], v[72:75], v[32:35], 0
    s_waitcnt lgkmcnt(5)
    v_lshrrev_b32 v19, 7, v19
    v_mfma_f32_16x16x32_bf16 v[52:55], v[12:15], v[72:75], 0
    v_and_b32 v19, 0x10001, v19
    v_mfma_f32_16x16x32_bf16 v[116:119], v[72:75], v[36:39], 0
    ds_write_b128 v7, v[44:47] offset:9472
    v_mfma_f32_16x16x32_bf16 v[124:127], v[72:75], v[20:23], 0
    v_mul_u32_u24 v19, s59, v19
    s_nop 1
    v_mfma_f32_16x16x32_bf16 v[60:63], v[16:19], v[72:75], 0
    ds_read_b128 v[72:75], v11 offset:768
    s_waitcnt lgkmcnt(5)
    v_mfma_f32_16x16x32_bf16 v[120:123], v[76:79], v[32:35], 0
    ds_write_b32 v88, v88 offset:0
    v_mfma_f32_16x16x32_bf16 v[128:131], v[76:79], v[24:27], 0
    ds_read_b128 v[76:79], v11 offset:832
    v_mfma_f32_16x16x32_bf16 v[48:51], v[220:223], v[80:83], v[48:51]
    v_mfma_f32_16x16x32_bf16 v[52:55], v[252:255], v[80:83], v[52:55]
    ds_read_b128 v[80:83], v11 offset:896
    s_waitcnt lgkmcnt(6)
    v_mfma_f32_16x16x32_bf16 v[48:51], v[216:219], v[84:87], v[48:51]
    v_mfma_f32_16x16x32_bf16 v[52:55], v[248:251], v[84:87], v[52:55]
    ds_read_b128 v[84:87], v11 offset:960
    v_cvt_pk_bf16_f32 v136, v120, v116
    v_mfma_f32_16x16x32_bf16 v[48:51], v[212:215], v[132:135], v[48:51]
    v_cvt_pk_bf16_f32 v137, v112, v108
    v_mfma_f32_16x16x32_bf16 v[52:55], v[244:247], v[132:135], v[52:55]
    s_waitcnt lgkmcnt(4)
    v_cvt_pk_bf16_f32 v138, v121, v117
    v_mfma_f32_16x16x32_bf16 v[48:51], v[208:211], v[68:71], v[48:51]
    v_cvt_pk_bf16_f32 v139, v113, v109
    v_mfma_f32_16x16x32_bf16 v[52:55], v[240:243], v[68:71], v[52:55]
    ds_read_b128 v[132:135], v11 offset:944
    v_cvt_pk_bf16_f32 v140, v122, v118
    v_mfma_f32_16x16x32_bf16 v[48:51], v[204:207], v[72:75], v[48:51]
    v_cvt_pk_bf16_f32 v141, v114, v110
    v_mfma_f32_16x16x32_bf16 v[52:55], v[236:239], v[72:75], v[52:55]
    ds_read_b128 v[68:71], v11 offset:1024
    s_waitcnt lgkmcnt(3)
    v_mfma_f32_16x16x32_bf16 v[48:51], v[200:203], v[76:79], v[48:51]
    v_cvt_pk_bf16_f32 v142, v123, v119
    v_mfma_f32_16x16x32_bf16 v[52:55], v[232:235], v[76:79], v[52:55]
    ds_read_b64 v[168:169], v89 offset:256
    v_cvt_pk_bf16_f32 v143, v115, v111
    v_mfma_f32_16x16x32_bf16 v[48:51], v[196:199], v[80:83], v[48:51]
    ds_read_b64 v[170:171], v89 offset:264
    v_cvt_pk_bf16_f32 v92, v128, v124
    v_mfma_f32_16x16x32_bf16 v[52:55], v[228:231], v[80:83], v[52:55]
    ds_read_b128 v[72:75], v11 offset:1088
    s_waitcnt lgkmcnt(5)
    v_mfma_f32_16x16x32_bf16 v[48:51], v[192:195], v[84:87], v[48:51]
    ds_read_b64 v[172:173], v89 offset:272
    v_cvt_pk_bf16_f32 v93, v129, v125
    v_mfma_f32_16x16x32_bf16 v[52:55], v[224:227], v[84:87], v[52:55]
    ds_read_b64 v[174:175], v89 offset:280
    v_cvt_pk_bf16_f32 v94, v130, v126
    v_mfma_f32_16x16x32_bf16 v[108:111], v[84:87], v[28:31], 0
    ds_read_b128 v[76:79], v11 offset:1152
    v_cvt_pk_bf16_f32 v95, v131, v127
    v_mfma_f32_16x16x32_bf16 v[112:115], v[84:87], v[32:35], 0
    v_mfma_f32_16x16x32_bf16 v[56:59], v[12:15], v[84:87], 0
    ds_read_b128 v[80:83], v11 offset:1216
    v_mfma_f32_16x16x32_bf16 v[116:119], v[84:87], v[36:39], 0
    ds_write_b128 v7, v[48:51] offset:10752
    v_mfma_f32_16x16x32_bf16 v[124:127], v[84:87], v[20:23], 0
    v_mfma_f32_16x16x32_bf16 v[64:67], v[16:19], v[84:87], 0
    ds_read_b128 v[84:87], v11 offset:1280
    s_waitcnt lgkmcnt(9)
    v_mfma_f32_16x16x32_bf16 v[120:123], v[132:135], v[32:35], 0
    ds_write_b32 v88, v88 offset:16
    v_mfma_f32_16x16x32_bf16 v[128:131], v[132:135], v[24:27], 0
    ds_read_b128 v[132:135], v11 offset:1344
    v_mfma_f32_16x16x32_bf16 v[52:55], v[220:223], v[68:71], v[52:55]
    v_mfma_f32_16x16x32_bf16 v[56:59], v[252:255], v[68:71], v[56:59]
    ds_read_b128 v[68:71], v11 offset:1408
    s_waitcnt lgkmcnt(7)
    v_mfma_f32_16x16x32_bf16 v[52:55], v[136:139], v[168:171], v[52:55]
    v_mfma_f32_16x16x32_bf16 v[52:55], v[216:219], v[72:75], v[52:55]
    v_mfma_f32_16x16x32_bf16 v[56:59], v[248:251], v[72:75], v[56:59]
    ds_read_b128 v[72:75], v11 offset:1472
    v_mfma_f32_16x16x32_bf16 v[52:55], v[140:143], v[172:175], v[52:55]
    s_waitcnt lgkmcnt(6)
    v_cvt_pk_bf16_f32 v144, v120, v116
    v_mfma_f32_16x16x32_bf16 v[52:55], v[212:215], v[76:79], v[52:55]
    v_cvt_pk_bf16_f32 v145, v112, v108
    v_mfma_f32_16x16x32_bf16 v[56:59], v[244:247], v[76:79], v[56:59]
    v_cvt_pk_bf16_f32 v146, v121, v117
    v_mfma_f32_16x16x32_bf16 v[52:55], v[208:211], v[80:83], v[52:55]
    v_cvt_pk_bf16_f32 v147, v113, v109
    v_mfma_f32_16x16x32_bf16 v[56:59], v[240:243], v[80:83], v[56:59]
    ds_read_b128 v[76:79], v11 offset:1456
    s_waitcnt lgkmcnt(3)
    v_mfma_f32_16x16x32_bf16 v[52:55], v[204:207], v[84:87], v[52:55]
    v_cvt_pk_bf16_f32 v148, v122, v118
    v_mfma_f32_16x16x32_bf16 v[56:59], v[236:239], v[84:87], v[56:59]
    ds_read_b128 v[80:83], v11 offset:1536
    v_cvt_pk_bf16_f32 v149, v114, v110
    v_mfma_f32_16x16x32_bf16 v[52:55], v[200:203], v[132:135], v[52:55]
    v_cvt_pk_bf16_f32 v150, v123, v119
    v_mfma_f32_16x16x32_bf16 v[56:59], v[232:235], v[132:135], v[56:59]
    ds_read_b64 v[176:177], v89 offset:128
    s_waitcnt lgkmcnt(3)
    v_mfma_f32_16x16x32_bf16 v[52:55], v[196:199], v[68:71], v[52:55]
    ds_read_b64 v[178:179], v89 offset:136
    v_cvt_pk_bf16_f32 v151, v115, v111
    v_mfma_f32_16x16x32_bf16 v[56:59], v[228:231], v[68:71], v[56:59]
    ds_read_b128 v[84:87], v11 offset:1600
    v_cvt_pk_bf16_f32 v96, v128, v124
    v_mfma_f32_16x16x32_bf16 v[52:55], v[192:195], v[72:75], v[52:55]
    ds_read_b64 v[180:181], v89 offset:144
    v_cvt_pk_bf16_f32 v97, v129, v125
    v_mfma_f32_16x16x32_bf16 v[56:59], v[224:227], v[72:75], v[56:59]
    ds_read_b64 v[182:183], v89 offset:152
    v_cvt_pk_bf16_f32 v98, v130, v126
    v_mfma_f32_16x16x32_bf16 v[108:111], v[72:75], v[28:31], 0
    ds_read_b128 v[132:135], v11 offset:1664
    v_cvt_pk_bf16_f32 v99, v131, v127
    v_mfma_f32_16x16x32_bf16 v[112:115], v[72:75], v[32:35], 0
    v_mfma_f32_16x16x32_bf16 v[60:63], v[12:15], v[72:75], v[60:63]
    v_mfma_f32_16x16x32_bf16 v[116:119], v[72:75], v[36:39], 0
    ds_read_b128 v[68:71], v11 offset:1728
    ds_write_b128 v7, v[52:55] offset:12032
    v_mfma_f32_16x16x32_bf16 v[124:127], v[72:75], v[20:23], 0
    v_mfma_f32_16x16x32_bf16 v[44:47], v[16:19], v[72:75], 0
    ds_read_b128 v[72:75], v11 offset:1792
    s_waitcnt lgkmcnt(9)
    v_mfma_f32_16x16x32_bf16 v[120:123], v[76:79], v[32:35], 0
    ds_write_b32 v88, v88 offset:32
    v_mfma_f32_16x16x32_bf16 v[128:131], v[76:79], v[24:27], 0
    ds_read_b128 v[76:79], v11 offset:1856
    v_mfma_f32_16x16x32_bf16 v[56:59], v[220:223], v[80:83], v[56:59]
    v_mfma_f32_16x16x32_bf16 v[60:63], v[252:255], v[80:83], v[60:63]
    ds_read_b128 v[80:83], v11 offset:1920
    s_waitcnt lgkmcnt(7)
    v_mfma_f32_16x16x32_bf16 v[56:59], v[136:139], v[176:179], v[56:59]
    v_mfma_f32_16x16x32_bf16 v[56:59], v[216:219], v[84:87], v[56:59]
    v_mfma_f32_16x16x32_bf16 v[60:63], v[248:251], v[84:87], v[60:63]
    ds_read_b128 v[84:87], v11 offset:1984
    v_mfma_f32_16x16x32_bf16 v[56:59], v[140:143], v[180:183], v[56:59]
    s_waitcnt lgkmcnt(6)
    v_cvt_pk_bf16_f32 v152, v120, v116
    v_mfma_f32_16x16x32_bf16 v[56:59], v[212:215], v[132:135], v[56:59]
    v_cvt_pk_bf16_f32 v153, v112, v108
    v_mfma_f32_16x16x32_bf16 v[60:63], v[244:247], v[132:135], v[60:63]
    v_cvt_pk_bf16_f32 v154, v121, v117
    v_mfma_f32_16x16x32_bf16 v[56:59], v[144:147], v[168:171], v[56:59]
    v_cvt_pk_bf16_f32 v155, v113, v109
    v_mfma_f32_16x16x32_bf16 v[56:59], v[208:211], v[68:71], v[56:59]
    v_cvt_pk_bf16_f32 v156, v122, v118
    v_mfma_f32_16x16x32_bf16 v[60:63], v[240:243], v[68:71], v[60:63]
    v_cvt_pk_bf16_f32 v157, v114, v110
    v_mfma_f32_16x16x32_bf16 v[56:59], v[148:151], v[172:175], v[56:59]
    ds_read_b128 v[132:135], v11 offset:1968
    s_waitcnt lgkmcnt(3)
    v_mfma_f32_16x16x32_bf16 v[56:59], v[204:207], v[72:75], v[56:59]
    v_cvt_pk_bf16_f32 v158, v123, v119
    v_mfma_f32_16x16x32_bf16 v[60:63], v[236:239], v[72:75], v[60:63]
    ds_read_b128 v[68:71], v11 offset:2048
    v_cvt_pk_bf16_f32 v159, v115, v111
    v_mfma_f32_16x16x32_bf16 v[56:59], v[200:203], v[76:79], v[56:59]
    v_cvt_pk_bf16_f32 v100, v128, v124
    v_mfma_f32_16x16x32_bf16 v[60:63], v[232:235], v[76:79], v[60:63]
    ds_read2_b32 v[40:41], v4 offset0:48 offset1:49
    s_waitcnt lgkmcnt(3)
    v_mfma_f32_16x16x32_bf16 v[56:59], v[196:199], v[80:83], v[56:59]
    ds_read2_b32 v[42:43], v4 offset0:50 offset1:51
    v_cvt_pk_bf16_f32 v101, v129, v125
    v_mfma_f32_16x16x32_bf16 v[60:63], v[228:231], v[80:83], v[60:63]
    ds_read_b128 v[72:75], v11 offset:2112
    v_cvt_pk_bf16_f32 v102, v130, v126
    v_mfma_f32_16x16x32_bf16 v[56:59], v[192:195], v[84:87], v[56:59]
    ds_read_b64 v[184:185], v89 offset:0
    v_cvt_pk_bf16_f32 v103, v131, v127
    v_mfma_f32_16x16x32_bf16 v[60:63], v[224:227], v[84:87], v[60:63]
    ds_read_b64 v[186:187], v89 offset:8
    v_mfma_f32_16x16x32_bf16 v[108:111], v[84:87], v[28:31], 0
    ds_read_b128 v[76:79], v11 offset:2176
    v_mfma_f32_16x16x32_bf16 v[112:115], v[84:87], v[32:35], 0
    v_mfma_f32_16x16x32_bf16 v[64:67], v[12:15], v[84:87], v[64:67]
    ds_read_b64 v[188:189], v89 offset:16
    v_mfma_f32_16x16x32_bf16 v[116:119], v[84:87], v[36:39], 0
    ds_read_b64 v[190:191], v89 offset:24
    ds_write_b128 v7, v[56:59] offset:13312
    v_mfma_f32_16x16x32_bf16 v[124:127], v[84:87], v[20:23], 0
    ds_read_b128 v[80:83], v11 offset:2240
    v_mfma_f32_16x16x32_bf16 v[48:51], v[16:19], v[84:87], 0
    ds_read_b128 v[84:87], v11 offset:2304
    s_waitcnt lgkmcnt(11)
    v_mfma_f32_16x16x32_bf16 v[120:123], v[132:135], v[32:35], 0
    ds_write_b32 v88, v88 offset:48
    v_mfma_f32_16x16x32_bf16 v[128:131], v[132:135], v[24:27], 0
    ds_read_b128 v[132:135], v11 offset:2368
    v_mfma_f32_16x16x32_bf16 v[60:63], v[220:223], v[68:71], v[60:63]
    v_mfma_f32_16x16x32_bf16 v[64:67], v[252:255], v[68:71], v[64:67]
    s_waitcnt lgkmcnt(8)
    v_mfma_f32_16x16x32_bf16 v[60:63], v[92:95], v[40:43], v[60:63]
    ds_read_b128 v[68:71], v11 offset:2432
    v_mfma_f32_16x16x32_bf16 v[60:63], v[216:219], v[72:75], v[60:63]
    v_mfma_f32_16x16x32_bf16 v[64:67], v[248:251], v[72:75], v[64:67]
    v_mfma_f32_16x16x32_bf16 v[60:63], v[136:139], v[184:187], v[60:63]
    ds_read_b128 v[72:75], v11 offset:2496
    s_waitcnt lgkmcnt(5)
    v_mfma_f32_16x16x32_bf16 v[60:63], v[212:215], v[76:79], v[60:63]
    v_cvt_pk_bf16_f32 v160, v120, v116
    v_mfma_f32_16x16x32_bf16 v[64:67], v[244:247], v[76:79], v[64:67]
    v_cvt_pk_bf16_f32 v161, v112, v108
    v_mfma_f32_16x16x32_bf16 v[60:63], v[140:143], v[188:191], v[60:63]
    v_cvt_pk_bf16_f32 v162, v121, v117
    v_mfma_f32_16x16x32_bf16 v[60:63], v[208:211], v[80:83], v[60:63]
    v_cvt_pk_bf16_f32 v163, v113, v109
    v_mfma_f32_16x16x32_bf16 v[64:67], v[240:243], v[80:83], v[64:67]
    v_cvt_pk_bf16_f32 v164, v122, v118
    v_mfma_f32_16x16x32_bf16 v[60:63], v[144:147], v[176:179], v[60:63]
    s_waitcnt lgkmcnt(2)
    v_cvt_pk_bf16_f32 v165, v114, v110
    v_mfma_f32_16x16x32_bf16 v[60:63], v[204:207], v[84:87], v[60:63]
    ds_read_b128 v[76:79], v11 offset:2480
    v_cvt_pk_bf16_f32 v166, v123, v119
    v_mfma_f32_16x16x32_bf16 v[64:67], v[236:239], v[84:87], v[64:67]
    ds_read_b128 v[80:83], v11 offset:2560
    v_cvt_pk_bf16_f32 v167, v115, v111
    v_mfma_f32_16x16x32_bf16 v[60:63], v[148:151], v[180:183], v[60:63]
    v_cvt_pk_bf16_f32 v104, v128, v124
    v_mfma_f32_16x16x32_bf16 v[60:63], v[200:203], v[132:135], v[60:63]
    v_cvt_pk_bf16_f32 v105, v129, v125
    v_mfma_f32_16x16x32_bf16 v[64:67], v[232:235], v[132:135], v[64:67]
    ds_read2_b32 v[16:17], v4 offset0:32 offset1:33
    v_cvt_pk_bf16_f32 v106, v130, v126
    v_mfma_f32_16x16x32_bf16 v[60:63], v[152:155], v[168:171], v[60:63]
    ds_read2_b32 v[18:19], v4 offset0:34 offset1:35
    s_waitcnt lgkmcnt(4)
    v_mfma_f32_16x16x32_bf16 v[60:63], v[196:199], v[68:71], v[60:63]
    ds_read_b128 v[84:87], v11 offset:2624
    v_cvt_pk_bf16_f32 v107, v131, v127
    v_mfma_f32_16x16x32_bf16 v[64:67], v[228:231], v[68:71], v[64:67]
    v_mfma_f32_16x16x32_bf16 v[60:63], v[156:159], v[172:175], v[60:63]
    v_mfma_f32_16x16x32_bf16 v[60:63], v[192:195], v[72:75], v[60:63]
    ds_read_b128 v[132:135], v11 offset:2688
    v_mfma_f32_16x16x32_bf16 v[64:67], v[224:227], v[72:75], v[64:67]
    v_mfma_f32_16x16x32_bf16 v[108:111], v[72:75], v[28:31], 0
    v_mfma_f32_16x16x32_bf16 v[112:115], v[72:75], v[32:35], 0
    ds_read_b128 v[68:71], v11 offset:2752
    v_mfma_f32_16x16x32_bf16 v[44:47], v[12:15], v[72:75], v[44:47]
    v_mfma_f32_16x16x32_bf16 v[116:119], v[72:75], v[36:39], 0
    ds_read_b128 v[72:75], v11 offset:2816
    s_waitcnt lgkmcnt(6)
    v_mfma_f32_16x16x32_bf16 v[120:123], v[76:79], v[32:35], 0
    ds_write_b128 v7, v[60:63] offset:14592
    v_mfma_f32_16x16x32_bf16 v[64:67], v[220:223], v[80:83], v[64:67]
    ds_read_b128 v[76:79], v11 offset:2880
    ds_write_b32 v88, v88 offset:64
    v_mfma_f32_16x16x32_bf16 v[44:47], v[252:255], v[80:83], v[44:47]
    v_mfma_f32_16x16x32_bf16 v[64:67], v[96:99], v[40:43], v[64:67]
    s_waitcnt lgkmcnt(6)
    v_mfma_f32_16x16x32_bf16 v[64:67], v[92:95], v[16:19], v[64:67]
    ds_read_b128 v[80:83], v11 offset:2944
    v_mfma_f32_16x16x32_bf16 v[64:67], v[216:219], v[84:87], v[64:67]
    v_mfma_f32_16x16x32_bf16 v[44:47], v[248:251], v[84:87], v[44:47]
    v_mfma_f32_16x16x32_bf16 v[64:67], v[144:147], v[184:187], v[64:67]
    ds_read_b128 v[84:87], v11 offset:3008
    s_waitcnt lgkmcnt(6)
    v_mfma_f32_16x16x32_bf16 v[64:67], v[212:215], v[132:135], v[64:67]
    v_cvt_pk_bf16_f32 v136, v120, v116
    v_mfma_f32_16x16x32_bf16 v[44:47], v[244:247], v[132:135], v[44:47]
    v_cvt_pk_bf16_f32 v137, v112, v108
    v_mfma_f32_16x16x32_bf16 v[64:67], v[148:151], v[188:191], v[64:67]
    v_cvt_pk_bf16_f32 v138, v121, v117
    v_mfma_f32_16x16x32_bf16 v[64:67], v[208:211], v[68:71], v[64:67]
    v_cvt_pk_bf16_f32 v139, v113, v109
    v_mfma_f32_16x16x32_bf16 v[44:47], v[240:243], v[68:71], v[44:47]
    v_cvt_pk_bf16_f32 v140, v122, v118
    v_mfma_f32_16x16x32_bf16 v[64:67], v[152:155], v[176:179], v[64:67]
    s_waitcnt lgkmcnt(3)
    v_cvt_pk_bf16_f32 v141, v114, v110
    v_mfma_f32_16x16x32_bf16 v[64:67], v[204:207], v[72:75], v[64:67]
    ds_read_b128 v[132:135], v11 offset:2992
    v_cvt_pk_bf16_f32 v142, v123, v119
    v_mfma_f32_16x16x32_bf16 v[44:47], v[236:239], v[72:75], v[44:47]
    ds_read_b128 v[68:71], v11 offset:3072
    v_cvt_pk_bf16_f32 v143, v115, v111
    v_mfma_f32_16x16x32_bf16 v[64:67], v[156:159], v[180:183], v[64:67]
    v_mfma_f32_16x16x32_bf16 v[64:67], v[200:203], v[76:79], v[64:67]
    v_mfma_f32_16x16x32_bf16 v[44:47], v[232:235], v[76:79], v[44:47]
    v_mfma_f32_16x16x32_bf16 v[64:67], v[160:163], v[168:171], v[64:67]
    ds_read_b128 v[72:75], v11 offset:3136
    s_waitcnt lgkmcnt(3)
    v_mfma_f32_16x16x32_bf16 v[64:67], v[196:199], v[80:83], v[64:67]
    v_mfma_f32_16x16x32_bf16 v[44:47], v[228:231], v[80:83], v[44:47]
    ds_read2_b32 v[20:21], v4 offset0:16 offset1:17
    v_mfma_f32_16x16x32_bf16 v[64:67], v[164:167], v[172:175], v[64:67]
    ds_read2_b32 v[22:23], v4 offset0:18 offset1:19
    v_mfma_f32_16x16x32_bf16 v[64:67], v[192:195], v[84:87], v[64:67]
    v_mfma_f32_16x16x32_bf16 v[44:47], v[224:227], v[84:87], v[44:47]
    ds_read_b128 v[76:79], v11 offset:3200
    v_mfma_f32_16x16x32_bf16 v[108:111], v[84:87], v[28:31], 0
    v_mfma_f32_16x16x32_bf16 v[112:115], v[84:87], v[32:35], 0
    v_mfma_f32_16x16x32_bf16 v[48:51], v[12:15], v[84:87], v[48:51]
    ds_read_b128 v[80:83], v11 offset:3264
    v_mfma_f32_16x16x32_bf16 v[116:119], v[84:87], v[36:39], 0
    ds_read_b128 v[84:87], v11 offset:3328
    s_waitcnt lgkmcnt(6)
    v_mfma_f32_16x16x32_bf16 v[120:123], v[132:135], v[32:35], 0
    ds_write_b128 v7, v[64:67] offset:15872
    v_mfma_f32_16x16x32_bf16 v[44:47], v[220:223], v[68:71], v[44:47]
    ds_write_b32 v88, v88 offset:80
    v_mfma_f32_16x16x32_bf16 v[48:51], v[252:255], v[68:71], v[48:51]
    ds_read_b128 v[132:135], v11 offset:3392
    v_mfma_f32_16x16x32_bf16 v[44:47], v[100:103], v[40:43], v[44:47]
    v_mfma_f32_16x16x32_bf16 v[44:47], v[96:99], v[16:19], v[44:47]
    s_waitcnt lgkmcnt(6)
    v_mfma_f32_16x16x32_bf16 v[44:47], v[216:219], v[72:75], v[44:47]
    ds_read_b128 v[68:71], v11 offset:3456
    v_mfma_f32_16x16x32_bf16 v[48:51], v[248:251], v[72:75], v[48:51]
    v_mfma_f32_16x16x32_bf16 v[44:47], v[92:95], v[20:23], v[44:47]
    v_mfma_f32_16x16x32_bf16 v[44:47], v[152:155], v[184:187], v[44:47]
    ds_read_b128 v[72:75], v11 offset:3520
    s_waitcnt lgkmcnt(6)
    v_mfma_f32_16x16x32_bf16 v[44:47], v[212:215], v[76:79], v[44:47]
    v_cvt_pk_bf16_f32 v144, v120, v116
    v_mfma_f32_16x16x32_bf16 v[48:51], v[244:247], v[76:79], v[48:51]
    ds_read_b128 v[76:79], v11 offset:3584
    v_cvt_pk_bf16_f32 v145, v112, v108
    v_mfma_f32_16x16x32_bf16 v[44:47], v[156:159], v[188:191], v[44:47]
    v_cvt_pk_bf16_f32 v146, v121, v117
    v_mfma_f32_16x16x32_bf16 v[44:47], v[208:211], v[80:83], v[44:47]
    v_cvt_pk_bf16_f32 v147, v113, v109
    v_mfma_f32_16x16x32_bf16 v[48:51], v[240:243], v[80:83], v[48:51]
    ds_read_b128 v[80:83], v11 offset:3648
    v_cvt_pk_bf16_f32 v148, v122, v118
    v_mfma_f32_16x16x32_bf16 v[44:47], v[160:163], v[176:179], v[44:47]
    ds_read2_b32 v[24:25], v4 offset0:0 offset1:1
    s_waitcnt lgkmcnt(5)
    v_mfma_f32_16x16x32_bf16 v[44:47], v[204:207], v[84:87], v[44:47]
    ds_read2_b32 v[26:27], v4 offset0:2 offset1:3
    v_cvt_pk_bf16_f32 v149, v114, v110
    v_mfma_f32_16x16x32_bf16 v[48:51], v[236:239], v[84:87], v[48:51]
    ds_read_b128 v[84:87], v11 offset:3712
    v_cvt_pk_bf16_f32 v150, v123, v119
    v_mfma_f32_16x16x32_bf16 v[44:47], v[164:167], v[180:183], v[44:47]
    v_cvt_pk_bf16_f32 v151, v115, v111
    v_mfma_f32_16x16x32_bf16 v[44:47], v[200:203], v[132:135], v[44:47]
    v_mfma_f32_16x16x32_bf16 v[48:51], v[232:235], v[132:135], v[48:51]
    v_mfma_f32_16x16x32_bf16 v[44:47], v[136:139], v[168:171], v[44:47]
    ds_read_b128 v[132:135], v11 offset:3776
    s_waitcnt lgkmcnt(6)
    v_mfma_f32_16x16x32_bf16 v[44:47], v[196:199], v[68:71], v[44:47]
    v_mfma_f32_16x16x32_bf16 v[48:51], v[228:231], v[68:71], v[48:51]
    ds_read_b128 v[68:71], v11 offset:3840
    v_mfma_f32_16x16x32_bf16 v[44:47], v[140:143], v[172:175], v[44:47]
    v_mfma_f32_16x16x32_bf16 v[44:47], v[192:195], v[72:75], v[44:47]
    v_mfma_f32_16x16x32_bf16 v[48:51], v[224:227], v[72:75], v[48:51]
    ds_read_b128 v[72:75], v11 offset:3904
    s_waitcnt lgkmcnt(6)
    v_mfma_f32_16x16x32_bf16 v[48:51], v[220:223], v[76:79], v[48:51]
    ds_read_b128 v[76:79], v11 offset:3968
    v_mfma_f32_16x16x32_bf16 v[48:51], v[104:107], v[40:43], v[48:51]
    v_mfma_f32_16x16x32_bf16 v[48:51], v[100:103], v[16:19], v[48:51]
    v_mfma_f32_16x16x32_bf16 v[48:51], v[216:219], v[80:83], v[48:51]
    ds_read_b128 v[80:83], v11 offset:4032
    v_mfma_f32_16x16x32_bf16 v[48:51], v[96:99], v[20:23], v[48:51]
    s_waitcnt lgkmcnt(5)
    v_mfma_f32_16x16x32_bf16 v[48:51], v[92:95], v[24:27], v[48:51]
    v_mfma_f32_16x16x32_bf16 v[48:51], v[212:215], v[84:87], v[48:51]
    v_mfma_f32_16x16x32_bf16 v[48:51], v[160:163], v[184:187], v[48:51]
    v_mfma_f32_16x16x32_bf16 v[48:51], v[164:167], v[188:191], v[48:51]
    s_waitcnt lgkmcnt(3)
    ds_write_b128 v7, v[44:47] offset:17152
    v_mfma_f32_16x16x32_bf16 v[48:51], v[208:211], v[132:135], v[48:51]
    ds_write_b32 v88, v88 offset:96
    v_mfma_f32_16x16x32_bf16 v[48:51], v[136:139], v[176:179], v[48:51]
    v_mfma_f32_16x16x32_bf16 v[48:51], v[204:207], v[68:71], v[48:51]
    v_mfma_f32_16x16x32_bf16 v[48:51], v[140:143], v[180:183], v[48:51]
    s_waitcnt lgkmcnt(3)
    v_mfma_f32_16x16x32_bf16 v[48:51], v[200:203], v[72:75], v[48:51]
    v_mfma_f32_16x16x32_bf16 v[48:51], v[144:147], v[168:171], v[48:51]
    v_mfma_f32_16x16x32_bf16 v[48:51], v[196:199], v[76:79], v[48:51]
    v_mfma_f32_16x16x32_bf16 v[48:51], v[148:151], v[172:175], v[48:51]
    s_waitcnt lgkmcnt(2)
    v_mfma_f32_16x16x32_bf16 v[48:51], v[192:195], v[80:83], v[48:51]
    s_nop 7
    ds_write_b128 v7, v[48:51] offset:18432
    ds_write_b32 v88, v88 offset:112
    s_cmp_lg_u32 s39, 0
    s_cbranch_scc1 L_mw_end
    s_mul_i32 s42, s50, 9344
    s_add_u32 s42, s42, 69632
    v_add_u32 v18, s42, v3
    v_add_u32 v20, 4096, v18
    v_and_b32 v21, 0x70, v3
    s_add_u32 s42, s42, 5120
    v_add_u32 v21, s42, v21
    s_movk_i32 s61, 4096
    v_lshl_add_u32 v24, v9, 1, s54
    v_mov_b32 v35, s45
    s_barrier
L_part_poll:
    global_load_dwordx4 v[164:167], v21, s[36:37] sc1
    global_load_dwordx4 v[128:131], v18, s[36:37] offset:-4096 sc1
    global_load_dwordx4 v[132:135], v18, s[36:37] offset:-3072 sc1
    global_load_dwordx4 v[136:139], v18, s[36:37] offset:-2048 sc1
    global_load_dwordx4 v[140:143], v18, s[36:37] offset:-1024 sc1
    global_load_dwordx4 v[144:147], v18, s[36:37] offset:0 sc1
    global_load_dwordx4 v[148:151], v18, s[36:37] offset:1024 sc1
    global_load_dwordx4 v[152:155], v18, s[36:37] offset:2048 sc1
    global_load_dwordx4 v[156:159], v18, s[36:37] offset:3072 sc1
    global_load_dwordx4 v[160:163], v20, s[36:37] offset:0 sc1
    v_mul_u32_u24 v26, 4640, v9
    v_add_u32 v26, 135648, v26
    v_mul_u32_u24 v27, 33792, v9
    v_mov_b32 v25, 1280
    s_waitcnt vmcnt(9)
    v_bfe_u32 v28, v164, 8, 11
    v_lshl_add_u32 v29, v28, 1, v26
    v_lshrrev_b32 v30, 8, v28
    v_mad_u32_u24 v27, v30, v25, v27
    v_bfe_u32 v30, v28, 2, 2
    v_mul_u32_u24 v30, 320, v30
    v_and_b32 v33, 0xf0, v28
    v_add3_u32 v27, v27, v30, v33
    v_and_b32 v33, 3, v28
    v_lshl_add_u32 v30, v33, 2, v27
    ds_read_b128 v[36:39], v88 offset:112
    ds_read_u16_d16_hi v31, v29
    ds_read_b32 v32, v30 offset:9472
    v_mul_u32_u24 v28, 1152, v28
    v_add_u32 v28, v28, v24
    v_xor_b32 v22, v35, v164
    s_waitcnt vmcnt(8)
    v_xor_b32 v128, v35, v128
    v_or_b32 v22, v22, v128
    s_waitcnt vmcnt(7)
    v_xor_b32 v132, v35, v132
    v_pk_add_f32 v[130:131], v[130:131], v[134:135]
    v_pk_add_f32 v[128:129], v[128:129], v[132:133]
    s_waitcnt vmcnt(6)
    v_xor_b32 v136, v35, v136
    v_pk_add_f32 v[130:131], v[130:131], v[138:139]
    v_pk_add_f32 v[128:129], v[128:129], v[136:137]
    v_bitop3_b32 v22, v22, v132, v136 bitop3:0xfe
    s_waitcnt vmcnt(5)
    v_xor_b32 v140, v35, v140
    v_pk_add_f32 v[130:131], v[130:131], v[142:143]
    v_pk_add_f32 v[128:129], v[128:129], v[140:141]
    s_waitcnt vmcnt(4)
    v_xor_b32 v144, v35, v144
    v_pk_add_f32 v[130:131], v[130:131], v[146:147]
    v_pk_add_f32 v[128:129], v[128:129], v[144:145]
    v_bitop3_b32 v22, v22, v140, v144 bitop3:0xfe
    s_waitcnt vmcnt(3)
    v_xor_b32 v148, v35, v148
    v_pk_add_f32 v[130:131], v[130:131], v[150:151]
    v_pk_add_f32 v[128:129], v[128:129], v[148:149]
    s_waitcnt vmcnt(2)
    v_xor_b32 v152, v35, v152
    v_pk_add_f32 v[130:131], v[130:131], v[154:155]
    v_pk_add_f32 v[128:129], v[128:129], v[152:153]
    v_bitop3_b32 v22, v22, v148, v152 bitop3:0xfe
    s_waitcnt vmcnt(1)
    v_xor_b32 v156, v35, v156
    v_pk_add_f32 v[130:131], v[130:131], v[158:159]
    v_pk_add_f32 v[128:129], v[128:129], v[156:157]
    s_waitcnt vmcnt(0)
    v_xor_b32 v160, v35, v160
    v_pk_add_f32 v[130:131], v[130:131], v[162:163]
    v_pk_add_f32 v[128:129], v[128:129], v[160:161]
    v_bitop3_b32 v22, v22, v156, v160 bitop3:0xfe
    s_waitcnt lgkmcnt(0)
    v_bitop3_b32 v36, v37, v38, v39 bitop3:0x7f
    v_and_b32 v36, 128, v36
    v_or_b32 v22, v22, v36
    v_and_b32 v22, 0xff, v22
    v_cmp_ne_u32 vcc, 0, v22
    v_permlane32_swap_b32 v128, v130
    s_sub_u32 s61, s61, 1
    s_cselect_b64 vcc, 0, vcc
    s_cbranch_vccnz L_part_poll
    v_permlane32_swap_b32 v129, v131
    v_add_f32 v128, v128, v130
    v_add_f32 v129, v129, v131
    v_and_b32 v31, 0xffff0000, v31
    v_fma_f32 v34, v31, v167, v166
    v_permlane16_swap_b32 v128, v129
    v_add_f32 v128, v128, v129
    v_mul_f32 v31, 0x42000000, v31
    v_mul_f32 v32, 0x3d000000, v32
    v_add_f32_dpp v128, v128, v128 row_ror:8 row_mask:0xf bank_mask:0xf
    v_fma_f32 v128, v128, v165, v31
    v_mul_f32 v33, 0xbfb8aa3b, v128
    v_exp_f32 v33, v33
    v_mul_f32 v128, v128, v32
    v_add_f32 v33, 1.0, v33
    v_rcp_f32 v33, v33
    s_nop 0
    v_fmac_f32 v34, v128, v33
    v_cvt_pk_bf16_f32 v34, v34, v34
    global_store_short v28, v34, s[32:33]
L_mw_end:
    s_endpgm
L_helper:
    s_waitcnt lgkmcnt(0)
    s_barrier
    s_setprio 0
    s_lshr_b32 s42, s50, 1
    s_lshl_b32 s42, s42, 15
    s_and_b32 s43, s50, 1
    s_lshl_b32 s43, s43, 6
    s_add_u32 s42, s42, s43
    s_add_u32 s42, s42, 2097152
    s_add_u32 s12, s36, s42
    s_addc_u32 s13, s37, 0
    s_add_u32 s14, s12, 8192
    s_addc_u32 s15, s13, 0
    s_add_u32 s16, s12, 16384
    s_addc_u32 s17, s13, 0
    s_add_u32 s18, s12, 24576
    s_addc_u32 s19, s13, 0
    v_bfe_u32 v63, v0, 2, 6
    v_and_b32 v6, 0x30, v3
    v_lshl_add_u32 v6, v63, 7, v6
    global_load_dwordx4 v[40:43], v6, s[12:13] sc1
    global_load_dwordx4 v[44:47], v6, s[14:15] sc1
    global_load_dwordx4 v[48:51], v6, s[16:17] sc1
    global_load_dwordx4 v[52:55], v6, s[18:19] sc1
    v_and_b32 v62, 255, v0
    v_lshlrev_b32 v4, 4, v62
    v_add_u32 v4, 20480, v4
    v_add_u32 v7, 8192, v4
    global_load_dwordx4 v[224:227], v4, s[36:37] offset:-4096 sc1
    global_load_dwordx4 v[228:231], v4, s[36:37] offset:0 sc1
    global_load_dwordx4 v[232:235], v7, s[36:37] offset:-4096 sc1
    global_load_dwordx4 v[236:239], v7, s[36:37] offset:0 sc1
    v_mov_b32 v38, v63
    s_mul_i32 s42, s51, 1152
    s_lshl_b32 s43, s41, 6
    s_add_u32 s42, s42, s43
    s_add_u32 s42, s42, 640
    s_mov_b32 s58, 2
    s_mul_i32 s43, s40, 1152
    s_add_u32 s43, s43, 884736
    s_mul_i32 s59, s40, 663552
    s_cmp_eq_u32 s58, 0
    s_cselect_b32 s56, s26, s28
    s_cselect_b32 s57, s27, s29
    s_cmp_eq_u32 s58, 2
    s_cselect_b32 s56, s30, s56
    s_cselect_b32 s57, s31, s57
    s_cselect_b32 s43, s59, s43
    s_movk_i32 s58, 128
    s_movk_i32 s59, 8064
    s_movk_i32 s60, 4319
    s_cmov_b32 s58, 73728
    s_cmov_b32 s59, -663424
    s_cmovk_i32 s60, 5183
    v_add_u32 v76, s42, v2
    v_min_u32 v76, s60, v76
    v_mul_u32_u24 v63, 7282, v76
    v_lshrrev_b32 v63, 16, v63
    v_mul_u32_u24 v76, s58, v76
    v_mad_i32_i24 v76, v63, s59, v76
    v_add_u32 v76, s43, v76
    v_mov_b32 v63, v38
    s_bfe_u32 s43, s46, 131072
    s_mul_i32 s43, s43, 0x20004000
    s_and_b32 s43, s43, 0x40004000
    v_mov_b32 v56, s43
    s_bfe_u32 s43, s46, 131074
    s_mul_i32 s43, s43, 0x20004000
    s_and_b32 s43, s43, 0x40004000
    v_mov_b32 v57, s43
    s_bfe_u32 s43, s46, 131076
    s_mul_i32 s43, s43, 0x20004000
    s_and_b32 s43, s43, 0x40004000
    v_mov_b32 v58, s43
    s_bfe_u32 s43, s46, 131078
    s_mul_i32 s43, s43, 0x20004000
    s_and_b32 s43, s43, 0x40004000
    v_mov_b32 v59, s43
    v_and_b32 v88, 3, v0
    v_mul_u32_u24 v5, 4640, v88
    v_lshl_add_u32 v5, v63, 4, v5
    v_add_u32 v5, 135648, v5
    v_mov_b32 v63, 0x40004000
    s_lshr_b32 s43, s51, 1
    s_lshl_b32 s43, s43, 4
    s_add_u32 s43, s43, 153728
    v_lshl_add_u32 v88, v88, 2, s43
    s_movk_i32 s61, 4096
    v_lshlrev_b32 v37, 2, v62
    v_add_u32 v64, 135648, v37
    v_add_u32 v65, 140288, v37
    v_add_u32 v66, 144928, v37
    v_add_u32 v67, 149568, v37
    v_bfe_u32 v37, v0, 1, 2
    v_mul_u32_u24 v37, 320, v37
    v_and_b32 v39, 0x78, v0
    v_lshl_add_u32 v37, v39, 1, v37
    v_and_b32 v39, 1, v0
    v_lshl_add_u32 v37, v39, 3, v37
    s_lshr_b32 s43, s51, 1
    s_mul_i32 s43, s43, 1280
    s_add_u32 s43, s43, 9472
    v_add_u32 v37, s43, v37
    v_add_u32 v39, 67584, v37
    v_mul_u32_u24 v36, 2304, v62
    v_add_u32 v36, s54, v36
    v_mov_b32 v8, 0xc238aa3b
    v_mov_b32 v9, 0xffff0000
    v_lshlrev_b32 v62, 6, v62
    v_xor_b32 v62, s44, v62
    v_and_b32 v10, 15, v0
    v_lshrrev_b32 v11, 1, v0
    v_and_b32 v11, 24, v11
    s_lshl_b32 s42, s51, 4
    s_mov_b32 s58, 939536384
    s_mov_b32 s59, 3672000
    s_lshr_b64 s[58:59], s[58:59], s42
    s_and_b32 s58, s58, 0xffff
    s_lshr_b32 s59, 535826400, s42
    s_and_b32 s59, s59, 0xffff
    s_lshl_b32 s42, s51, 10
    s_add_u32 s42, s42, 154048
    v_add_u32 v12, s42, v3
    v_lshlrev_b32 v13, v10, s58
    v_bfe_u32 v13, v13, v11, 8
    v_lshl_or_b32 v13, v13, 15, v13
    v_and_b32 v16, 65537, v13
    v_mul_u32_u24 v16, 16256, v16
    v_and_b32 v17, 262148, v13
    v_mul_u32_u24 v17, 4064, v17
    v_and_b32 v18, 1048592, v13
    v_mul_u32_u24 v18, 1016, v18
    v_and_b32 v19, 4194368, v13
    v_mul_u32_u24 v19, 254, v19
    ds_write_b128 v12, v[16:19] offset:0
    v_lshlrev_b32 v13, v10, s59
    v_bfe_u32 v13, v13, v11, 8
    v_lshl_or_b32 v13, v13, 15, v13
    v_and_b32 v20, 65537, v13
    v_mul_u32_u24 v20, 16256, v20
    v_and_b32 v21, 262148, v13
    v_mul_u32_u24 v21, 4064, v21
    v_and_b32 v22, 1048592, v13
    v_mul_u32_u24 v22, 1016, v22
    v_and_b32 v23, 4194368, v13
    v_mul_u32_u24 v23, 254, v23
    ds_write_b128 v12, v[20:23] offset:4096
    s_waitcnt vmcnt(4)
    s_setprio 3
L_tile_chk:
    v_xor_b32 v40, v56, v40
    v_xor_b32 v41, v57, v41
    v_xor_b32 v42, v58, v42
    v_xor_b32 v43, v59, v43
    ds_write_b128 v5, v[40:43] offset:0
    v_xor_b32 v44, v56, v44
    v_xor_b32 v45, v57, v45
    v_xor_b32 v46, v58, v46
    v_xor_b32 v47, v59, v47
    ds_write_b128 v5, v[44:47] offset:1024
    v_xor_b32 v48, v56, v48
    v_xor_b32 v49, v57, v49
    v_xor_b32 v50, v58, v50
    v_xor_b32 v51, v59, v51
    ds_write_b128 v5, v[48:51] offset:2048
    v_xor_b32 v52, v56, v52
    v_xor_b32 v53, v57, v53
    v_xor_b32 v54, v58, v54
    v_xor_b32 v55, v59, v55
    ds_write_b128 v5, v[52:55] offset:3072
    v_bitop3_b32 v38, v40, v41, v42 bitop3:0xfe
    v_bitop3_b32 v38, v38, v43, v44 bitop3:0xfe
    v_bitop3_b32 v38, v38, v45, v46 bitop3:0xfe
    v_bitop3_b32 v38, v38, v47, v48 bitop3:0xfe
    v_bitop3_b32 v38, v38, v49, v50 bitop3:0xfe
    v_bitop3_b32 v38, v38, v51, v52 bitop3:0xfe
    v_bitop3_b32 v38, v38, v53, v54 bitop3:0xfe
    v_bitop3_b32 v38, v38, v55, v63 bitop3:0xa8
    v_cmp_ne_u32 vcc, 0, v38
    s_cbranch_vccz L_tile_ok
    global_load_dwordx4 v[40:43], v6, s[12:13] sc1
    global_load_dwordx4 v[44:47], v6, s[14:15] sc1
    global_load_dwordx4 v[48:51], v6, s[16:17] sc1
    global_load_dwordx4 v[52:55], v6, s[18:19] sc1
    s_waitcnt vmcnt(0)
    s_sub_u32 s61, s61, 1
    s_cbranch_scc0 L_tile_chk
L_tile_ok:
    s_mov_b32 s61, 262144
    s_waitcnt vmcnt(0)
L_h_poll:
    v_mov_b32 v38, 0
    v_xor_b32 v13, 65504, v225
    v_bitop3_b32 v38, v38, v13, v62 bitop3:0xf6
    v_xor_b32 v13, 65472, v227
    v_bitop3_b32 v38, v38, v13, v62 bitop3:0xf6
    v_xor_b32 v13, 49120, v229
    v_bitop3_b32 v38, v38, v13, v62 bitop3:0xf6
    v_xor_b32 v13, 49088, v231
    v_bitop3_b32 v38, v38, v13, v62 bitop3:0xf6
    v_xor_b32 v13, 32736, v233
    v_bitop3_b32 v38, v38, v13, v62 bitop3:0xf6
    v_xor_b32 v13, 32704, v235
    v_bitop3_b32 v38, v38, v13, v62 bitop3:0xf6
    v_xor_b32 v13, 16352, v237
    v_bitop3_b32 v38, v38, v13, v62 bitop3:0xf6
    v_xor_b32 v13, 16320, v239
    v_bitop3_b32 v38, v38, v13, v62 bitop3:0xf6
    v_and_b32 v38, 0xffff, v38
    v_cmp_ne_u32 vcc, 0, v38
    s_cbranch_vccz L_h_ok
    global_load_dwordx4 v[224:227], v4, s[36:37] offset:-4096 sc1
    global_load_dwordx4 v[228:231], v4, s[36:37] offset:0 sc1
    global_load_dwordx4 v[232:235], v7, s[36:37] offset:-4096 sc1
    global_load_dwordx4 v[236:239], v7, s[36:37] offset:0 sc1
    s_waitcnt vmcnt(0)
    s_sub_u32 s61, s61, 64
    s_cbranch_scc0 L_h_poll
L_h_ok:
    s_waitcnt lgkmcnt(0)
    s_barrier
    ds_read2st64_b32 v[16:17], v64 offset0:0 offset1:4
    ds_read2st64_b32 v[18:19], v65 offset0:0 offset1:4
    ds_read2st64_b32 v[20:21], v66 offset0:0 offset1:4
    ds_read2st64_b32 v[22:23], v67 offset0:0 offset1:4
    ds_read2st64_b32 v[24:25], v64 offset0:8 offset1:12
    ds_read2st64_b32 v[26:27], v65 offset0:8 offset1:12
    ds_read2st64_b32 v[28:29], v66 offset0:8 offset1:12
    ds_read2st64_b32 v[30:31], v67 offset0:8 offset1:12
    s_setprio 0
    s_cmp_lt_u32 s51, 2
    s_cbranch_scc0 L_ct2
    global_load_dword v1, v76, s[56:57]
L_ct2:
    s_waitcnt lgkmcnt(4)
    v_lshlrev_b32 v96, 16, v16
    v_lshlrev_b32 v97, 16, v18
    v_lshlrev_b32 v98, 16, v20
    v_lshlrev_b32 v99, 16, v22
    v_mul_f32 v104, v8, v96
    v_mul_f32 v105, v8, v97
    v_mul_f32 v106, v8, v98
    v_mul_f32 v107, v8, v99
    v_exp_f32 v104, v104
    v_exp_f32 v105, v105
    v_exp_f32 v106, v106
    v_exp_f32 v107, v107
    v_and_b32 v121, v9, v224
    v_add_f32 v104, 1.0, v104
    v_add_f32 v105, 1.0, v105
    v_add_f32 v106, 1.0, v106
    v_add_f32 v107, 1.0, v107
    v_rcp_f32 v104, v104
    v_rcp_f32 v105, v105
    v_rcp_f32 v106, v106
    v_rcp_f32 v107, v107
    v_lshlrev_b32 v120, 16, v224
    v_and_b32 v100, v9, v16
    v_and_b32 v101, v9, v18
    v_and_b32 v102, v9, v20
    v_and_b32 v103, v9, v22
    v_mul_f32 v108, v8, v100
    v_mul_f32 v109, v8, v101
    v_mul_f32 v110, v8, v102
    v_mul_f32 v111, v8, v103
    v_exp_f32 v108, v108
    v_exp_f32 v109, v109
    v_exp_f32 v110, v110
    v_exp_f32 v111, v111
    v_and_b32 v123, v9, v226
    v_add_f32 v108, 1.0, v108
    v_add_f32 v109, 1.0, v109
    v_add_f32 v110, 1.0, v110
    v_add_f32 v111, 1.0, v111
    v_rcp_f32 v108, v108
    v_rcp_f32 v109, v109
    v_rcp_f32 v110, v110
    v_rcp_f32 v111, v111
    v_lshlrev_b32 v122, 16, v226
    s_setprio 2
L_w0:
    ds_read_b32 v41, v88 offset:0
    s_waitcnt lgkmcnt(0)
    v_cmp_eq_u32 vcc, 0, v41
    s_cbranch_vccz L_w0_ok
    s_sleep 2
    s_sub_u32 s61, s61, 1
    s_cbranch_scc0 L_w0
L_w0_ok:
    ds_read_b64 v[44:45], v37 offset:0
    ds_read_b64 v[46:47], v37 offset:33792
    ds_read_b64 v[48:49], v39 offset:0
    ds_read_b64 v[50:51], v39 offset:33792
    s_setprio 0
    s_waitcnt lgkmcnt(0)
    v_fma_f32 v112, v44, v104, v121
    v_fma_f32 v113, v46, v105, v121
    v_fma_f32 v114, v48, v106, v121
    v_fma_f32 v115, v50, v107, v121
    v_fma_f32 v96, v96, v112, v120
    v_fma_f32 v97, v97, v113, v120
    v_fma_f32 v98, v98, v114, v120
    v_fma_f32 v99, v99, v115, v120
    v_cvt_pk_bf16_f32 v104, v96, v97
    v_cvt_pk_bf16_f32 v105, v98, v99
    global_store_dwordx2 v36, v[104:105], s[32:33] offset:0
    v_fma_f32 v116, v45, v108, v123
    v_fma_f32 v117, v47, v109, v123
    v_fma_f32 v118, v49, v110, v123
    v_fma_f32 v119, v51, v111, v123
    v_fma_f32 v100, v100, v116, v122
    v_fma_f32 v101, v101, v117, v122
    v_fma_f32 v102, v102, v118, v122
    v_fma_f32 v103, v103, v119, v122
    v_cvt_pk_bf16_f32 v108, v100, v101
    v_cvt_pk_bf16_f32 v109, v102, v103
    v_lshlrev_b32 v128, 16, v17
    v_lshlrev_b32 v129, 16, v19
    v_lshlrev_b32 v130, 16, v21
    v_lshlrev_b32 v131, 16, v23
    v_mul_f32 v136, v8, v128
    v_mul_f32 v137, v8, v129
    v_mul_f32 v138, v8, v130
    v_mul_f32 v139, v8, v131
    v_exp_f32 v136, v136
    v_exp_f32 v137, v137
    v_exp_f32 v138, v138
    v_exp_f32 v139, v139
    v_and_b32 v153, v9, v228
    v_add_f32 v136, 1.0, v136
    v_add_f32 v137, 1.0, v137
    v_add_f32 v138, 1.0, v138
    v_add_f32 v139, 1.0, v139
    v_rcp_f32 v136, v136
    v_rcp_f32 v137, v137
    v_rcp_f32 v138, v138
    v_rcp_f32 v139, v139
    v_lshlrev_b32 v152, 16, v228
    global_store_dwordx2 v36, v[108:109], s[32:33] offset:1152
    v_add_u32 v36, 589824, v36
    v_and_b32 v132, v9, v17
    v_and_b32 v133, v9, v19
    v_and_b32 v134, v9, v21
    v_and_b32 v135, v9, v23
    v_mul_f32 v140, v8, v132
    v_mul_f32 v141, v8, v133
    v_mul_f32 v142, v8, v134
    v_mul_f32 v143, v8, v135
    v_exp_f32 v140, v140
    v_exp_f32 v141, v141
    v_exp_f32 v142, v142
    v_exp_f32 v143, v143
    v_and_b32 v155, v9, v230
    v_add_f32 v140, 1.0, v140
    v_add_f32 v141, 1.0, v141
    v_add_f32 v142, 1.0, v142
    v_add_f32 v143, 1.0, v143
    v_rcp_f32 v140, v140
    v_rcp_f32 v141, v141
    v_rcp_f32 v142, v142
    v_rcp_f32 v143, v143
    v_lshlrev_b32 v154, 16, v230
    s_setprio 2
L_w1:
    ds_read_b32 v41, v88 offset:32
    s_waitcnt lgkmcnt(0)
    v_cmp_eq_u32 vcc, 0, v41
    s_cbranch_vccz L_w1_ok
    s_sleep 2
    s_sub_u32 s61, s61, 1
    s_cbranch_scc0 L_w1
L_w1_ok:
    ds_read_b64 v[44:45], v37 offset:2560
    ds_read_b64 v[46:47], v37 offset:36352
    ds_read_b64 v[48:49], v39 offset:2560
    ds_read_b64 v[50:51], v39 offset:36352
    s_setprio 0
    s_waitcnt lgkmcnt(0)
    v_fma_f32 v144, v44, v136, v153
    v_fma_f32 v145, v46, v137, v153
    v_fma_f32 v146, v48, v138, v153
    v_fma_f32 v147, v50, v139, v153
    v_fma_f32 v128, v128, v144, v152
    v_fma_f32 v129, v129, v145, v152
    v_fma_f32 v130, v130, v146, v152
    v_fma_f32 v131, v131, v147, v152
    v_cvt_pk_bf16_f32 v136, v128, v129
    v_cvt_pk_bf16_f32 v137, v130, v131
    global_store_dwordx2 v36, v[136:137], s[32:33] offset:0
    v_fma_f32 v148, v45, v140, v155
    v_fma_f32 v149, v47, v141, v155
    v_fma_f32 v150, v49, v142, v155
    v_fma_f32 v151, v51, v143, v155
    v_fma_f32 v132, v132, v148, v154
    v_fma_f32 v133, v133, v149, v154
    v_fma_f32 v134, v134, v150, v154
    v_fma_f32 v135, v135, v151, v154
    v_cvt_pk_bf16_f32 v140, v132, v133
    v_cvt_pk_bf16_f32 v141, v134, v135
    v_lshlrev_b32 v160, 16, v24
    v_lshlrev_b32 v161, 16, v26
    v_lshlrev_b32 v162, 16, v28
    v_lshlrev_b32 v163, 16, v30
    v_mul_f32 v168, v8, v160
    v_mul_f32 v169, v8, v161
    v_mul_f32 v170, v8, v162
    v_mul_f32 v171, v8, v163
    v_exp_f32 v168, v168
    v_exp_f32 v169, v169
    v_exp_f32 v170, v170
    v_exp_f32 v171, v171
    v_and_b32 v185, v9, v232
    v_add_f32 v168, 1.0, v168
    v_add_f32 v169, 1.0, v169
    v_add_f32 v170, 1.0, v170
    v_add_f32 v171, 1.0, v171
    v_rcp_f32 v168, v168
    v_rcp_f32 v169, v169
    v_rcp_f32 v170, v170
    v_rcp_f32 v171, v171
    v_lshlrev_b32 v184, 16, v232
    global_store_dwordx2 v36, v[140:141], s[32:33] offset:1152
    v_add_u32 v36, 589824, v36
    v_and_b32 v164, v9, v24
    v_and_b32 v165, v9, v26
    v_and_b32 v166, v9, v28
    v_and_b32 v167, v9, v30
    v_mul_f32 v172, v8, v164
    v_mul_f32 v173, v8, v165
    v_mul_f32 v174, v8, v166
    v_mul_f32 v175, v8, v167
    v_exp_f32 v172, v172
    v_exp_f32 v173, v173
    v_exp_f32 v174, v174
    v_exp_f32 v175, v175
    v_and_b32 v187, v9, v234
    v_add_f32 v172, 1.0, v172
    v_add_f32 v173, 1.0, v173
    v_add_f32 v174, 1.0, v174
    v_add_f32 v175, 1.0, v175
    v_rcp_f32 v172, v172
    v_rcp_f32 v173, v173
    v_rcp_f32 v174, v174
    v_rcp_f32 v175, v175
    v_lshlrev_b32 v186, 16, v234
    s_setprio 2
L_w2:
    ds_read_b32 v41, v88 offset:64
    s_waitcnt lgkmcnt(0)
    v_cmp_eq_u32 vcc, 0, v41
    s_cbranch_vccz L_w2_ok
    s_sleep 2
    s_sub_u32 s61, s61, 1
    s_cbranch_scc0 L_w2
L_w2_ok:
    ds_read_b64 v[44:45], v37 offset:5120
    ds_read_b64 v[46:47], v37 offset:38912
    ds_read_b64 v[48:49], v39 offset:5120
    ds_read_b64 v[50:51], v39 offset:38912
    s_setprio 0
    s_waitcnt lgkmcnt(0)
    v_fma_f32 v176, v44, v168, v185
    v_fma_f32 v177, v46, v169, v185
    v_fma_f32 v178, v48, v170, v185
    v_fma_f32 v179, v50, v171, v185
    v_fma_f32 v160, v160, v176, v184
    v_fma_f32 v161, v161, v177, v184
    v_fma_f32 v162, v162, v178, v184
    v_fma_f32 v163, v163, v179, v184
    v_cvt_pk_bf16_f32 v168, v160, v161
    v_cvt_pk_bf16_f32 v169, v162, v163
    global_store_dwordx2 v36, v[168:169], s[32:33] offset:0
    v_fma_f32 v180, v45, v172, v187
    v_fma_f32 v181, v47, v173, v187
    v_fma_f32 v182, v49, v174, v187
    v_fma_f32 v183, v51, v175, v187
    v_fma_f32 v164, v164, v180, v186
    v_fma_f32 v165, v165, v181, v186
    v_fma_f32 v166, v166, v182, v186
    v_fma_f32 v167, v167, v183, v186
    v_cvt_pk_bf16_f32 v172, v164, v165
    v_cvt_pk_bf16_f32 v173, v166, v167
    v_lshlrev_b32 v192, 16, v25
    v_lshlrev_b32 v193, 16, v27
    v_lshlrev_b32 v194, 16, v29
    v_lshlrev_b32 v195, 16, v31
    v_mul_f32 v200, v8, v192
    v_mul_f32 v201, v8, v193
    v_mul_f32 v202, v8, v194
    v_mul_f32 v203, v8, v195
    v_exp_f32 v200, v200
    v_exp_f32 v201, v201
    v_exp_f32 v202, v202
    v_exp_f32 v203, v203
    v_and_b32 v217, v9, v236
    v_add_f32 v200, 1.0, v200
    v_add_f32 v201, 1.0, v201
    v_add_f32 v202, 1.0, v202
    v_add_f32 v203, 1.0, v203
    v_rcp_f32 v200, v200
    v_rcp_f32 v201, v201
    v_rcp_f32 v202, v202
    v_rcp_f32 v203, v203
    v_lshlrev_b32 v216, 16, v236
    global_store_dwordx2 v36, v[172:173], s[32:33] offset:1152
    v_add_u32 v36, 589824, v36
    v_and_b32 v196, v9, v25
    v_and_b32 v197, v9, v27
    v_and_b32 v198, v9, v29
    v_and_b32 v199, v9, v31
    v_mul_f32 v204, v8, v196
    v_mul_f32 v205, v8, v197
    v_mul_f32 v206, v8, v198
    v_mul_f32 v207, v8, v199
    v_exp_f32 v204, v204
    v_exp_f32 v205, v205
    v_exp_f32 v206, v206
    v_exp_f32 v207, v207
    v_and_b32 v219, v9, v238
    v_add_f32 v204, 1.0, v204
    v_add_f32 v205, 1.0, v205
    v_add_f32 v206, 1.0, v206
    v_add_f32 v207, 1.0, v207
    v_rcp_f32 v204, v204
    v_rcp_f32 v205, v205
    v_rcp_f32 v206, v206
    v_rcp_f32 v207, v207
    v_lshlrev_b32 v218, 16, v238
    s_setprio 2
L_w3:
    ds_read_b32 v41, v88 offset:96
    ds_read_b64 v[44:45], v37 offset:7680
    ds_read_b64 v[46:47], v37 offset:41472
    ds_read_b64 v[48:49], v39 offset:7680
    ds_read_b64 v[50:51], v39 offset:41472
    s_waitcnt lgkmcnt(0)
    v_cmp_eq_u32 vcc, 0, v41
    s_cbranch_vccz L_w3_ok
    s_sleep 1
    s_sub_u32 s61, s61, 1
    s_cbranch_scc0 L_w3
L_w3_ok:
    v_fma_f32 v208, v44, v200, v217
    v_fma_f32 v209, v46, v201, v217
    v_fma_f32 v210, v48, v202, v217
    v_fma_f32 v211, v50, v203, v217
    v_fma_f32 v192, v192, v208, v216
    v_fma_f32 v193, v193, v209, v216
    v_fma_f32 v194, v194, v210, v216
    v_fma_f32 v195, v195, v211, v216
    v_cvt_pk_bf16_f32 v200, v192, v193
    v_cvt_pk_bf16_f32 v201, v194, v195
    global_store_dwordx2 v36, v[200:201], s[32:33] offset:0
    v_fma_f32 v212, v45, v204, v219
    v_fma_f32 v213, v47, v205, v219
    v_fma_f32 v214, v49, v206, v219
    v_fma_f32 v215, v51, v207, v219
    v_fma_f32 v196, v196, v212, v218
    v_fma_f32 v197, v197, v213, v218
    v_fma_f32 v198, v198, v214, v218
    v_fma_f32 v199, v199, v215, v218
    v_cvt_pk_bf16_f32 v204, v196, v197
    v_cvt_pk_bf16_f32 v205, v198, v199
    global_store_dwordx2 v36, v[204:205], s[32:33] offset:1152
    s_waitcnt vmcnt(0)
    s_barrier
    s_endpgm
L_lnp:
    s_mul_i32 s43, s39, 1216
    s_add_u32 s43, s43, 154048
    v_add_u32 v52, s43, v3
    v_add_u32 v53, s43, v4
    s_lshl_b32 s43, s39, 3
    s_add_u32 s43, s43, 163776
    v_mov_b32 v54, s43
    v_bfe_u32 v55, v0, 2, 2
    v_mul_u32_u24 v55, 1216, v55
    v_and_b32 v56, 3, v0
    v_lshl_add_u32 v55, v56, 3, v55
    v_lshrrev_b32 v56, 4, v0
    v_lshl_add_u32 v55, v56, 5, v55
    v_add_u32 v55, 154048, v55
    v_lshrrev_b32 v56, 3, v0
    v_lshlrev_b32 v56, 15, v56
    v_and_b32 v57, 112, v3
    s_lshl_b32 s43, s2, 7
    s_add_u32 s43, s43, 2097152
    v_add3_u32 v56, v56, v57, s43
    v_mov_b32 v40, 0
    v_mov_b32 v41, 0
    v_mov_b32 v42, 0
    v_mov_b32 v43, 0
    v_mov_b32 v44, 0x3ae38e39
    v_mov_b32 v38, 0xbfffbfff
    v_mov_b32 v37, 0xffff
    s_lshl_b32 s58, s2, 3
    s_add_u32 s58, s58, s39
    s_xor_b32 s58, s58, 0x7ff
    s_lshl_b32 s58, s58, 5
    s_waitcnt lgkmcnt(0)
    s_add_u32 s38, s38, 0x9e370001
    s_lshr_b32 s44, s38, 16
    s_and_b32 s45, s38, 0xff
    s_and_b32 s46, s38, 0xfb
    s_bitcmp0_b32 s38, 0
    s_cselect_b32 s43, 4, 0
    s_or_b32 s46, s46, s43
    s_bitcmp1_b32 s46, s39
    s_cselect_b32 s43, 0x40004000, 0
    v_mov_b32 v39, s43
    s_xor_b32 s58, s58, s44
    v_mov_b32 v57, s58
    s_mov_b32 s42, 0x3f803f80
    s_cmp_lt_u32 s41, 27
    s_cbranch_scc1 L_lw2
    s_cmp_lt_u32 s39, 2
    s_cbranch_scc0 L_lw1
    global_load_dword v1, v76, s[56:57]
    s_waitcnt vmcnt(1)
    s_branch L_ln
L_lw1:
    s_waitcnt vmcnt(0)
    s_branch L_ln
L_lw2:
    s_add_u32 m0, s49, 0
    s_nop 0
    global_load_lds_dwordx4 v76, s[56:57]
    v_add_u32 v76, 294912, v76
    s_add_u32 m0, s49, 4096
    s_nop 0
    global_load_lds_dwordx4 v76, s[56:57]
    v_add_u32 v76, 294912, v76
    s_add_u32 m0, s49, 8192
    s_nop 0
    global_load_lds_dwordx4 v76, s[56:57]
    v_add_u32 v76, 294912, v76
    s_waitcnt vmcnt(3)
L_ln:
    v_dot2c_f32_bf16 v40, s42, v12
    v_dot2c_f32_bf16 v41, v12, v12
    v_dot2c_f32_bf16 v42, v12, v20
    v_dot2c_f32_bf16 v43, s42, v20
    v_dot2c_f32_bf16 v40, s42, v13
    v_dot2c_f32_bf16 v41, v13, v13
    v_dot2c_f32_bf16 v42, v13, v21
    v_dot2c_f32_bf16 v43, s42, v21
    v_dot2c_f32_bf16 v40, s42, v14
    v_dot2c_f32_bf16 v41, v14, v14
    v_dot2c_f32_bf16 v42, v14, v22
    v_dot2c_f32_bf16 v43, s42, v22
    v_dot2c_f32_bf16 v40, s42, v15
    v_dot2c_f32_bf16 v41, v15, v15
    v_dot2c_f32_bf16 v42, v15, v23
    v_dot2c_f32_bf16 v43, s42, v23
    v_dot2c_f32_bf16 v40, s42, v16
    v_dot2c_f32_bf16 v41, v16, v16
    v_dot2c_f32_bf16 v42, v16, v24
    v_dot2c_f32_bf16 v43, s42, v24
    v_lshlrev_b32 v36, 16, v16
    v_lshlrev_b32 v28, 16, v12
    v_and_b32 v29, 0xffff0000, v12
    v_permlane32_swap_b32 v40, v42
    v_permlane32_swap_b32 v41, v43
    v_add_f32 v40, v40, v42
    v_add_f32 v41, v41, v43
    v_lshlrev_b32 v30, 16, v13
    v_and_b32 v31, 0xffff0000, v13
    v_permlane16_swap_b32 v40, v41
    v_add_f32 v40, v40, v41
    v_lshlrev_b32 v32, 16, v14
    v_and_b32 v33, 0xffff0000, v14
    v_add_f32_dpp v40, v40, v40 row_ror:8 row_mask:0xf bank_mask:0xf
    v_lshlrev_b32 v34, 16, v15
    v_and_b32 v35, 0xffff0000, v15
    v_add_f32_dpp v40, v40, v40 row_ror:4 row_mask:0xf bank_mask:0xf
    s_nop 1
    v_add_f32_dpp v40, v40, v40 row_ror:2 row_mask:0xf bank_mask:0xf
    s_nop 1
    v_add_f32_dpp v40, v40, v40 row_ror:1 row_mask:0xf bank_mask:0xf
    s_nop 0
    v_readlane_b32 s58, v40, 0
    v_readlane_b32 s59, v40, 16
    v_readlane_b32 s60, v40, 32
    v_readlane_b32 s61, v40, 48
    v_mul_f32 v40, s58, v44
    v_mul_f32 v41, s59, v44
    v_fma_f32 v41, -v40, v40, v41
    v_max_f32 v41, 0, v41
    v_cvt_pk_bf16_f32 v44, v41, v40
    v_lshlrev_b32 v41, 16, v44
    v_add_f32 v41, 0x3727c5ac, v41
    v_cvt_pk_bf16_f32 v41, v41, v41
    v_and_b32 v41, 0xffff0000, v41
    v_mul_f32 v41, 0x44800000, v41
    v_sqrt_f32 v41, v41
    v_and_b32 v49, 0xffff0000, v44
    v_cvt_pk_bf16_f32 v50, v49, v41
    v_and_b32 v41, 0xffff0000, v50
    v_rcp_f32 v46, v41
    v_mul_f32 v42, s61, v49
    v_mul_f32 v47, v49, v46
    v_fma_f32 v28, v28, v46, -v47
    v_fma_f32 v29, v29, v46, -v47
    v_fma_f32 v30, v30, v46, -v47
    v_fma_f32 v31, v31, v46, -v47
    v_fma_f32 v32, v32, v46, -v47
    v_fma_f32 v33, v33, v46, -v47
    v_fma_f32 v34, v34, v46, -v47
    v_fma_f32 v35, v35, v46, -v47
    v_fma_f32 v36, v36, v46, -v47
    v_cvt_pk_bf16_f32 v28, v28, v29
    v_cvt_pk_bf16_f32 v29, v30, v31
    v_cvt_pk_bf16_f32 v30, v32, v33
    v_cvt_pk_bf16_f32 v31, v34, v35
    v_cvt_pk_bf16_f32 v32, v36, v36
    v_bitop3_b32 v28, v28, v38, v39 bitop3:0xea
    v_bitop3_b32 v29, v29, v38, v39 bitop3:0xea
    v_bitop3_b32 v30, v30, v38, v39 bitop3:0xea
    v_bitop3_b32 v31, v31, v38, v39 bitop3:0xea
    v_bitop3_b32 v32, v32, v38, v39 bitop3:0xea
    ds_write_b128 v52, v[28:31]
    ds_write_b16 v53, v32 offset:1024
    v_sub_f32 v42, s60, v42
    v_mul_f32 v42, 0x42000000, v42
    v_mul_f32 v42, v42, v46
    v_cvt_pk_bf16_f32 v42, v42, v42
    v_ashrrev_i32 v43, 31, v42
    v_or_b32 v43, 0x80000000, v43
    v_xor_b32 v42, v42, v43
    v_bitop3_b32 v51, v37, v57, v42 bitop3:0xca
    s_mov_b64 exec, 1
    ds_write_b64 v54, v[50:51]
    s_mov_b64 exec, -1
    s_waitcnt lgkmcnt(0)
    s_barrier
    s_cmp_eq_u32 s39, 1
    s_cbranch_scc1 L_ln_stat
    ds_read_b64_tr_b16 v[28:29], v55
    ds_read_b64_tr_b16 v[30:31], v55 offset:4864
    s_cmp_eq_u32 s39, 0
    s_cbranch_scc0 L_ln_st
    ds_read_b64_tr_b16 v[32:33], v55 offset:1024
    ds_read_b64_tr_b16 v[34:35], v55 offset:5888
    v_add_u32 v38, 2097152, v56
    s_waitcnt lgkmcnt(0)
    global_store_dwordx4 v38, v[32:35], s[36:37] sc1
    s_branch L_ln_st
L_ln_stat:
    v_and_b32 v41, 0x30, v3
    v_add_u32 v40, 163776, v41
    ds_read_b128 v[48:51], v40
    ds_read_b64_tr_b16 v[28:29], v55
    ds_read_b64_tr_b16 v[30:31], v55 offset:4864
    s_lshl_b32 s43, s2, 6
    s_add_u32 s43, s43, 16384
    v_add_u32 v41, s43, v41
    s_mov_b64 exec, 15
    s_waitcnt lgkmcnt(2)
    global_store_dwordx4 v41, v[48:51], s[36:37] sc1
    s_mov_b64 exec, -1
L_ln_st:
    s_waitcnt lgkmcnt(0)
    global_store_dwordx4 v56, v[28:31], s[36:37] sc1
    s_barrier
    s_cmp_lt_u32 s41, 27
    s_cbranch_scc1 L_ffn
    s_cmp_lt_u32 s39, 2
    s_cbranch_scc1 L_sp2
    global_load_dword v1, v76, s[56:57]
L_sp2:
    s_mul_i32 s42, s39, 320
    s_add_u32 s42, s42, s53
    s_add_u32 s42, s42, 2624
    s_mov_b32 s58, 2
    s_mul_i32 s43, s40, 1152
    s_add_u32 s43, s43, 884736
    s_mul_i32 s59, s40, 663552
    s_cmp_eq_u32 s58, 0
    s_cselect_b32 s56, s26, s28
    s_cselect_b32 s57, s27, s29
    s_cmp_eq_u32 s58, 2
    s_cselect_b32 s56, s30, s56
    s_cselect_b32 s57, s31, s57
    s_cselect_b32 s43, s59, s43
    s_movk_i32 s58, 128
    s_movk_i32 s59, 8064
    s_movk_i32 s60, 4319
    s_cmov_b32 s58, 73728
    s_cmov_b32 s59, -663424
    s_cmovk_i32 s60, 5183
    v_add_u32 v76, s42, v2
    v_min_u32 v76, s60, v76
    v_mul_u32_u24 v63, 7282, v76
    v_lshrrev_b32 v63, 16, v63
    v_mul_u32_u24 v76, s58, v76
    v_mad_i32_i24 v76, v63, s59, v76
    v_add_u32 v76, s43, v76
    s_barrier
    s_cmp_ge_u32 s39, 8
    s_cbranch_scc1 L_sp3
    global_load_dword v1, v76, s[56:57]
L_sp3:
    s_sub_u32 s42, s2, 216
    s_cmp_ge_u32 s42, 32
    s_cbranch_scc1 L_sp4
    s_cmp_ge_u32 s39, 1
    s_cbranch_scc1 L_sp4
    s_lshl_b32 s42, s42, 6
    v_add_u32 v76, s42, v2
    v_mul_u32_u24 v76, 1152, v76
    s_lshl_b32 s42, s39, 7
    v_subrev_u32 v76, s42, v76
    v_add_u32 v76, 1024, v76
    global_load_dword v1, v76, s[32:33]
L_sp4:
    s_waitcnt vmcnt(0)
    s_endpgm
L_ffn:
    v_bfe_u32 v14, v0, 4, 2
    v_and_b32 v11, 7, v0
    v_mov_b32 v26, 147456
    v_mov_b32 v27, 4
    s_cmp_eq_u32 s52, 0
    s_cbranch_scc0 L_gu
    s_setprio 1
    v_lshlrev_b32 v8, 4, v0
    v_add_u32 v9, 20480, v8
    v_add_u32 v10, 8192, v9
    v_lshlrev_b32 v13, 6, v0
    v_xor_b32 v128, 65504, v13
    v_xor_b32 v129, 65472, v13
    v_xor_b32 v130, 49120, v13
    v_xor_b32 v131, 49088, v13
    v_xor_b32 v132, 32736, v13
    v_xor_b32 v133, 32704, v13
    v_xor_b32 v134, 16352, v13
    v_xor_b32 v135, 16320, v13
    v_mov_b32 v36, s44
    v_lshrrev_b32 v25, 5, v0
    v_lshl_add_u32 v25, v25, 2, v26
    s_mul_i32 s62, s39, 80
    s_add_u32 s62, s62, 147584
    v_and_b32 v15, 0x3c, v0
    v_add_u32 v15, s62, v15
    v_and_b32 v16, 3, v0
    v_mul_u32_u24 v16, 80, v16
    v_add_u32 v16, 147584, v16
    v_lshrrev_b32 v12, 3, v2
    v_lshl_add_u32 v17, v12, 2, v26
    v_lshl_add_u32 v18, v11, 2, v26
    v_and_b32 v12, 6, v12
    v_xor_b32 v12, v12, v11
    v_lshlrev_b32 v12, 4, v12
    v_lshl_add_u32 v12, v1, 7, v12
    v_add_u32 v12, 2358144, v12
    s_lshl_b32 s63, s54, 7
    s_add_u32 s63, s63, 2358144
    v_mov_b32 v37, s63
    s_movk_i32 s63, -1152
    s_mul_i32 s64, s39, 1056
    s_mul_i32 s42, s50, 73728
    s_add_u32 s12, s30, s42
    s_addc_u32 s13, s31, 0
    s_add_u32 s14, s12, 18432
    s_addc_u32 s15, s13, 0
    s_add_u32 s16, s12, 36864
    s_addc_u32 s17, s13, 0
    s_add_u32 s18, s12, 55296
    s_addc_u32 s19, s13, 0
    v_mul_u32_u24 v19, 4608, v14
    v_and_b32 v20, 0xf0, v3
    s_lshl_b32 s42, s51, 8
    v_add3_u32 v19, v19, v20, s42
    v_lshrrev_b32 v20, 1, v2
    v_mul_u32_u24 v20, 1152, v20
    v_and_b32 v21, 16, v3
    s_lshl_b32 s42, s51, 5
    v_add3_u32 v20, v20, v21, s42
    v_bfe_i32 v232, v0, 3, 1
    v_mul_u32_u24 v4, 74752, v14
    v_lshl_add_u32 v4, v11, 4, v4
    v_and_b32 v5, 37376, v232
    s_lshl_b32 s43, s50, 7
    s_add_u32 s43, s43, 65536
    s_mul_i32 s42, s51, 299008
    s_add_u32 s42, s42, s43
    v_add3_u32 v4, v4, v5, s42
    v_add_u32 v5, 18688, v4
    v_add_u32 v6, 9344, v4
    v_add_u32 v7, 28032, v4
    v_mul_u32_u24 v8, 9344, v14
    v_lshl_add_u32 v8, v11, 4, v8
    s_mul_i32 s42, s51, 37376
    s_add_u32 s42, s42, s43
    s_add_u32 s42, s42, 1196032
    v_add_u32 v8, s42, v8
    v_mov_b32 v233, s45
    v_mov_b32 v234, 0xff
    v_and_b32 v235, 0x370, v3
    v_add_u32 v235, 147968, v235
    s_lshl_b32 s42, s51, 10
    s_add_u32 s42, s42, 159520
    v_add_u32 v236, s42, v3
    v_lshl_add_u32 v237, v2, 3, s42
    s_mov_b32 s66, 0x05040100
    s_mov_b32 s67, 0x07060302
    s_movk_i32 s55, 4096
    s_waitcnt vmcnt(0)
    s_barrier
    global_load_dwordx4 v[112:115], v9, s[36:37] offset:-4096 sc1
    global_load_dwordx4 v[116:119], v9, s[36:37] offset:0 sc1
    global_load_dwordx4 v[120:123], v10, s[36:37] offset:-4096 sc1
    global_load_dwordx4 v[124:127], v10, s[36:37] offset:0 sc1
L_ffn_poll:
    v_mov_b32 v24, 0
    s_waitcnt vmcnt(3)
    v_xor_b32 v28, v36, v113
    v_bitop3_b32 v24, v24, v28, v128 bitop3:0xf6
    v_xor_b32 v29, v36, v115
    v_bitop3_b32 v24, v24, v29, v129 bitop3:0xf6
    s_waitcnt vmcnt(2)
    v_xor_b32 v30, v36, v117
    v_bitop3_b32 v24, v24, v30, v130 bitop3:0xf6
    v_xor_b32 v31, v36, v119
    v_bitop3_b32 v24, v24, v31, v131 bitop3:0xf6
    s_waitcnt vmcnt(1)
    v_xor_b32 v32, v36, v121
    v_bitop3_b32 v24, v24, v32, v132 bitop3:0xf6
    v_xor_b32 v33, v36, v123
    v_bitop3_b32 v24, v24, v33, v133 bitop3:0xf6
    s_waitcnt vmcnt(0)
    v_xor_b32 v34, v36, v125
    v_bitop3_b32 v24, v24, v34, v134 bitop3:0xf6
    v_xor_b32 v35, v36, v127
    v_bitop3_b32 v24, v24, v35, v135 bitop3:0xf6
    v_and_b32 v24, 0xffff, v24
    v_cmp_ne_u32 vcc, 0, v24
    v_max3_u32 v38, v28, v29, v30
    v_max3_u32 v39, v31, v32, v33
    s_cbranch_vccz L_ffn_go
    global_load_dwordx4 v[112:115], v9, s[36:37] offset:-4096 sc1
    global_load_dwordx4 v[116:119], v9, s[36:37] offset:0 sc1
    global_load_dwordx4 v[120:123], v10, s[36:37] offset:-4096 sc1
    global_load_dwordx4 v[124:127], v10, s[36:37] offset:0 sc1
    s_sub_u32 s55, s55, 1
    s_cbranch_scc0 L_ffn_poll
    s_waitcnt vmcnt(0)
L_ffn_go:
    s_barrier
    v_max3_u32 v38, v38, v34, v35
    v_max_u32 v38, v38, v39
    v_alignbit_b32 v24, 1, v38, 5
    v_sub_u32 v128, v28, v38
    v_sub_u32 v129, v29, v38
    v_max_u32_dpp v21, v24, v24 row_ror:1 row_mask:0xf bank_mask:0xf
    v_sub_u32 v130, v30, v38
    v_sub_u32 v131, v31, v38
    v_max_u32_dpp v21, v21, v21 row_ror:2 row_mask:0xf bank_mask:0xf
    v_sub_u32 v132, v32, v38
    v_sub_u32 v133, v33, v38
    v_max_u32_dpp v21, v21, v21 row_ror:4 row_mask:0xf bank_mask:0xf
    v_sub_u32 v134, v34, v38
    v_sub_u32 v135, v35, v38
    v_max_u32_dpp v21, v21, v21 row_ror:8 row_mask:0xf bank_mask:0xf
    v_max3_u32 v39, v128, v129, v130
    v_max3_u32 v22, v131, v132, v133
    v_max_u32_dpp v21, v21, v21 row_bcast:15 row_mask:0xa bank_mask:0xf
    s_mov_b32 exec_lo, 0x80000000
    s_mov_b32 exec_hi, 0x80000000
    ds_write_b32 v25, v21
    s_mov_b64 exec, -1
    s_mov_b32 s55, 262144
    ds_read_b128 v[112:115], v26
    ds_read_b128 v[116:119], v26 offset:16
    v_max3_u32 v39, v39, v134, v135
    v_max_u32 v39, v39, v22
    v_add_u32 v39, v39, v38
    v_alignbit_b32 v23, 1, v39, 5
L_s1:
    s_waitcnt lgkmcnt(0)
    v_min3_u32 v21, v112, v113, v114
    v_min3_u32 v22, v115, v116, v117
    v_min3_u32 v21, v21, v118, v119
    v_min_u32 v21, v21, v22
    v_cmp_eq_u32 vcc, 0, v21
    v_cmp_ge_u32 s[6:7], v24, v21
    v_cmp_ge_u32 s[8:9], v23, v21
    s_cbranch_vccz L_s1_ok
    ds_read_b128 v[112:115], v26
    ds_read_b128 v[116:119], v26 offset:16
    s_sub_u32 s55, s55, 1
    s_cbranch_scc0 L_s1
L_s1_ok:
    s_bcnt1_i32_b64 s10, s[6:7]
    v_mbcnt_lo_u32_b32 v22, s6, 0
    v_mbcnt_lo_u32_b32 v13, s8, 0
    v_mbcnt_hi_u32_b32 v22, s7, v22
    v_mbcnt_hi_u32_b32 v13, s9, v13
    v_min_u32 v22, 16, v22
    v_add_u32 v13, s10, v13
    v_lshl_add_u32 v22, v22, 2, s62
    v_min_u32 v13, 16, v13
    s_mov_b64 exec, s[6:7]
    ds_write_b32 v22, v24
    v_lshl_add_u32 v13, v13, 2, s62
    s_mov_b64 exec, s[8:9]
    ds_write_b32 v13, v23
    s_mov_b64 exec, 1
    ds_add_u32 v26, v27 offset:32
    s_mov_b64 exec, -1
    ds_read_b32 v22, v26 offset:32
    ds_read_b32 v13, v15
    ds_read_b128 v[112:115], v16 offset:0
    ds_read_b128 v[116:119], v16 offset:16
    ds_read_b128 v[120:123], v16 offset:32
    ds_read_b128 v[124:127], v16 offset:48
    v_and_b32 v24, 0x7ff, v24
    v_and_b32 v23, 0x7ff, v23
    v_mad_i32_i24 v24, v24, s63, v37
    v_mad_i32_i24 v23, v23, s63, v37
    s_mov_b64 exec, s[6:7]
    global_load_dword v239, v24, s[4:5]
    s_cmp_eq_u64 s[8:9], 0
    s_cbranch_scc1 L_no2
    s_mov_b64 exec, s[8:9]
    global_load_dword v239, v23, s[4:5]
L_no2:
    s_mov_b64 exec, -1
L_s2:
    s_waitcnt lgkmcnt(0)
    v_cmp_ne_u32 vcc, 16, v22
    v_mov_b32 v24, 0
    s_cbranch_vccz L_s2_ok
    ds_read_b32 v22, v26 offset:32
    ds_read_b32 v13, v15
    ds_read_b128 v[112:115], v16 offset:0
    ds_read_b128 v[116:119], v16 offset:16
    ds_read_b128 v[120:123], v16 offset:32
    ds_read_b128 v[124:127], v16 offset:48
    s_sub_u32 s55, s55, 1
    s_cbranch_scc0 L_s2
L_s2_ok:
    v_sub_u32 v112, v13, v112
    v_alignbit_b32 v24, v24, v112, 31
    v_sub_u32 v113, v13, v113
    v_alignbit_b32 v24, v24, v113, 31
    v_sub_u32 v114, v13, v114
    v_alignbit_b32 v24, v24, v114, 31
    v_sub_u32 v115, v13, v115
    v_alignbit_b32 v24, v24, v115, 31
    v_sub_u32 v116, v13, v116
    v_alignbit_b32 v24, v24, v116, 31
    v_sub_u32 v117, v13, v117
    v_alignbit_b32 v24, v24, v117, 31
    v_sub_u32 v118, v13, v118
    v_alignbit_b32 v24, v24, v118, 31
    v_sub_u32 v119, v13, v119
    v_alignbit_b32 v24, v24, v119, 31
    v_sub_u32 v120, v13, v120
    v_alignbit_b32 v24, v24, v120, 31
    v_sub_u32 v121, v13, v121
    v_alignbit_b32 v24, v24, v121, 31
    v_sub_u32 v122, v13, v122
    v_alignbit_b32 v24, v24, v122, 31
    v_sub_u32 v123, v13, v123
    v_alignbit_b32 v24, v24, v123, 31
    v_sub_u32 v124, v13, v124
    v_alignbit_b32 v24, v24, v124, 31
    v_sub_u32 v125, v13, v125
    v_alignbit_b32 v24, v24, v125, 31
    v_sub_u32 v126, v13, v126
    v_alignbit_b32 v24, v24, v126, 31
    v_sub_u32 v127, v13, v127
    v_alignbit_b32 v24, v24, v127, 31
    v_bcnt_u32_b32 v24, v24, 0
    s_nop 1
    v_add_u32_dpp v24, v24, v24 quad_perm:[1,0,3,2] row_mask:0xf bank_mask:0xf
    s_nop 1
    v_add_u32_dpp v24, v24, v24 quad_perm:[2,3,0,1] row_mask:0xf bank_mask:0xf
    v_cmp_gt_u32 vcc, 8, v24
    v_lshl_add_u32 v24, v24, 2, v26
    s_mov_b64 exec, vcc
    ds_write_b32 v24, v13 offset:64
    s_mov_b64 exec, -1
L_s3:
    ds_read_b32 v23, v17 offset:64
    ds_read_b32 v13, v18 offset:64
    s_add_u32 m0, s64, 150016
    s_waitcnt lgkmcnt(0)
    v_cmp_eq_u32 vcc, 0, v23
    v_and_b32 v23, 0x7ff, v23
    s_sub_u32 s55, s55, 1
    s_cselect_b64 vcc, 0, vcc
    s_cbranch_vccnz L_s3
    v_mad_i32_i24 v23, v23, s63, v12
    global_load_lds_dwordx4 v23, s[4:5]
    s_add_u32 m0, s64, 153728
    v_and_b32 v22, 0x7ff, v13
    global_load_lds_dwordx4 v23, s[4:5] offset:512
    v_sub_u32 v22, 2047, v22
    s_cmp_lg_u32 s39, 0
    s_cbranch_scc1 L_nox9
    s_mov_b32 m0, 157440
    s_nop 0
    global_load_lds_dwordx4 v23, s[4:5] offset:1024
    s_branch L_x3
L_nox9:
    v_lshlrev_b32 v24, 3, v22
    v_add_u32 v24, 16384, v24
    global_load_dword v25, v24, s[36:37] sc1
L_x3:
    s_barrier
    v_readlane_b32 s10, v13, 7
    s_mov_b32 s11, 0
    s_lshl_b32 s10, s10, 5
    v_cmp_le_u32 vcc, s10, v28
    s_nop 0
    s_bcnt1_i32_b64 s56, vcc
    s_add_u32 s11, s11, s56
    v_cmp_le_u32 vcc, s10, v29
    s_nop 0
    s_bcnt1_i32_b64 s56, vcc
    s_add_u32 s11, s11, s56
    v_cmp_le_u32 vcc, s10, v30
    s_nop 0
    s_bcnt1_i32_b64 s56, vcc
    s_add_u32 s11, s11, s56
    v_cmp_le_u32 vcc, s10, v31
    s_nop 0
    s_bcnt1_i32_b64 s56, vcc
    s_add_u32 s11, s11, s56
    v_cmp_le_u32 vcc, s10, v32
    s_nop 0
    s_bcnt1_i32_b64 s56, vcc
    s_add_u32 s11, s11, s56
    v_cmp_le_u32 vcc, s10, v33
    s_nop 0
    s_bcnt1_i32_b64 s56, vcc
    s_add_u32 s11, s11, s56
    v_cmp_le_u32 vcc, s10, v34
    s_nop 0
    s_bcnt1_i32_b64 s56, vcc
    s_add_u32 s11, s11, s56
    v_cmp_le_u32 vcc, s10, v35
    s_nop 0
    s_bcnt1_i32_b64 s56, vcc
    s_add_u32 s11, s11, s56
    s_lshl_b32 s11, s11, 16
    s_or_b32 s11, s11, 4
    v_mov_b32 v36, s11
    s_barrier
    global_load_dwordx4 v[40:43], v19, s[12:13] offset:0
    global_load_dwordx4 v[44:47], v19, s[12:13] offset:1152
    s_waitcnt vmcnt(2)
    s_cmp_lg_u32 s39, 1
    s_cbranch_scc1 L_nost
    ds_write_b32 v18, v25 offset:448
L_nost:
    s_mov_b64 exec, 1
    ds_add_u32 v26, v36 offset:36
    s_mov_b64 exec, -1
    s_setprio 0
    global_load_dwordx4 v[48:51], v19, s[12:13] offset:2304
    global_load_dwordx4 v[52:55], v19, s[12:13] offset:3456
    global_load_dwordx4 v[56:59], v19, s[14:15] offset:0
    global_load_dwordx4 v[60:63], v19, s[14:15] offset:1152
    global_load_dwordx4 v[64:67], v19, s[14:15] offset:2304
    global_load_dwordx4 v[68:71], v19, s[14:15] offset:3456
    global_load_dwordx4 v[216:219], v20, s[12:13] offset:1024
    global_load_dwordx4 v[220:223], v20, s[16:17] offset:1024
L_s4:
    ds_read_b32 v24, v26 offset:36
    s_waitcnt lgkmcnt(0)
    v_readfirstlane_b32 s61, v24
    s_nop 0
    s_and_b32 s60, s61, 255
    s_cmp_ge_u32 s60, 16
    s_cbranch_scc1 L_s4_ok
    s_sub_u32 s55, s55, 1
    s_cbranch_scc0 L_s4
L_s4_ok:
    s_lshr_b32 s61, s61, 16
    s_cmp_eq_u32 s61, 8
    s_cbranch_scc0 L_slow
L_dgo:
    global_load_dwordx4 v[72:75], v19, s[16:17] offset:0
    s_waitcnt vmcnt(9)
    v_perm_b32 v112, v44, v40, s66
    v_perm_b32 v116, v44, v40, s67
    v_perm_b32 v120, v45, v41, s66
    v_perm_b32 v124, v45, v41, s67
    v_perm_b32 v128, v46, v42, s66
    v_perm_b32 v132, v46, v42, s67
    v_perm_b32 v136, v47, v43, s66
    v_perm_b32 v140, v47, v43, s67
    global_load_dwordx4 v[76:79], v19, s[16:17] offset:1152
    s_waitcnt vmcnt(8)
    v_perm_b32 v113, v52, v48, s66
    v_perm_b32 v117, v52, v48, s67
    v_perm_b32 v121, v53, v49, s66
    v_perm_b32 v125, v53, v49, s67
    v_perm_b32 v129, v54, v50, s66
    v_perm_b32 v133, v54, v50, s67
    v_perm_b32 v137, v55, v51, s66
    v_perm_b32 v141, v55, v51, s67
    global_load_dwordx4 v[80:83], v19, s[16:17] offset:2304
    global_load_dwordx4 v[84:87], v19, s[16:17] offset:3456
    s_waitcnt vmcnt(8)
    v_perm_b32 v114, v60, v56, s66
    v_perm_b32 v118, v60, v56, s67
    v_perm_b32 v122, v61, v57, s66
    v_perm_b32 v126, v61, v57, s67
    v_perm_b32 v130, v62, v58, s66
    v_perm_b32 v134, v62, v58, s67
    v_perm_b32 v138, v63, v59, s66
    v_perm_b32 v142, v63, v59, s67
    global_load_dwordx4 v[88:91], v19, s[18:19] offset:0
    global_load_dwordx4 v[92:95], v19, s[18:19] offset:1152
    s_waitcnt vmcnt(8)
    v_perm_b32 v115, v68, v64, s66
    v_perm_b32 v119, v68, v64, s67
    v_perm_b32 v123, v69, v65, s66
    v_perm_b32 v127, v69, v65, s67
    v_perm_b32 v131, v70, v66, s66
    v_perm_b32 v135, v70, v66, s67
    v_perm_b32 v139, v71, v67, s66
    v_perm_b32 v143, v71, v67, s67
    global_load_dwordx4 v[96:99], v19, s[18:19] offset:2304
    global_load_dwordx4 v[100:103], v19, s[18:19] offset:3456
    s_waitcnt vmcnt(6)
    ds_write_b128 v236, v[216:219]
    ds_read_b64_tr_b16 v[104:105], v237
    ds_read_b64_tr_b16 v[106:107], v237 offset:512
    ds_write_b128 v236, v[220:223]
    ds_read_b64_tr_b16 v[108:109], v237
    ds_read_b64_tr_b16 v[110:111], v237 offset:512
    v_perm_b32 v144, v76, v72, s66
    v_perm_b32 v148, v76, v72, s67
    v_perm_b32 v152, v77, v73, s66
    v_perm_b32 v156, v77, v73, s67
    v_perm_b32 v160, v78, v74, s66
    v_perm_b32 v164, v78, v74, s67
    v_perm_b32 v168, v79, v75, s66
    v_perm_b32 v172, v79, v75, s67
    s_waitcnt vmcnt(4)
    v_perm_b32 v145, v84, v80, s66
    v_perm_b32 v149, v84, v80, s67
    v_perm_b32 v153, v85, v81, s66
    v_perm_b32 v157, v85, v81, s67
    v_perm_b32 v161, v86, v82, s66
    v_perm_b32 v165, v86, v82, s67
    v_perm_b32 v169, v87, v83, s66
    v_perm_b32 v173, v87, v83, s67
    s_barrier
    ds_read_b128 v[28:31], v235
    ds_read_b128 v[32:35], v235 offset:1024
    s_mov_b32 s58, 0x00ff00ff
    s_mov_b32 s59, 0x00ff00ff
    s_waitcnt vmcnt(2)
    v_perm_b32 v146, v92, v88, s66
    v_perm_b32 v150, v92, v88, s67
    v_perm_b32 v154, v93, v89, s66
    v_perm_b32 v158, v93, v89, s67
    v_perm_b32 v162, v94, v90, s66
    v_perm_b32 v166, v94, v90, s67
    v_perm_b32 v170, v95, v91, s66
    v_perm_b32 v174, v95, v91, s67
    s_waitcnt lgkmcnt(0)
    v_mfma_f32_16x16x32_bf16 v[208:211], v[104:107], v[28:31], 0
    s_waitcnt vmcnt(0)
    v_perm_b32 v147, v100, v96, s66
    v_mfma_f32_16x16x32_bf16 v[208:211], v[108:111], v[32:35], v[208:211]
    v_perm_b32 v151, v100, v96, s67
    v_perm_b32 v155, v101, v97, s66
    v_mfma_f32_16x16x32_bf16 v[176:179], v[112:115], v[28:31], 0
    v_perm_b32 v159, v101, v97, s67
    v_perm_b32 v163, v102, v98, s66
    v_mfma_f32_16x16x32_bf16 v[180:183], v[116:119], v[28:31], 0
    v_perm_b32 v167, v102, v98, s67
    v_perm_b32 v171, v103, v99, s66
    v_mfma_f32_16x16x32_bf16 v[184:187], v[120:123], v[28:31], 0
    v_perm_b32 v175, v103, v99, s67
    v_mfma_f32_16x16x32_bf16 v[188:191], v[124:127], v[28:31], 0
    v_mfma_f32_16x16x32_bf16 v[176:179], v[144:147], v[32:35], v[176:179]
    v_mfma_f32_16x16x32_bf16 v[180:183], v[148:151], v[32:35], v[180:183]
    v_bitop3_b32 v208, v234, v233, v208 bitop3:0xca
    s_mov_b64 exec, s[58:59]
    global_store_dwordx4 v8, v[208:211], s[36:37] sc1
    s_mov_b64 exec, -1
    v_mfma_f32_16x16x32_bf16 v[184:187], v[152:155], v[32:35], v[184:187]
    v_mfma_f32_16x16x32_bf16 v[188:191], v[156:159], v[32:35], v[188:191]
    v_mfma_f32_16x16x32_bf16 v[192:195], v[128:131], v[28:31], 0
    v_mfma_f32_16x16x32_bf16 v[196:199], v[132:135], v[28:31], 0
    v_mfma_f32_16x16x32_bf16 v[200:203], v[136:139], v[28:31], 0
    v_bitop3_b32 v212, v232, v178, v176 bitop3:0xca
    v_bitop3_b32 v213, v232, v182, v180 bitop3:0xca
    v_mfma_f32_16x16x32_bf16 v[204:207], v[140:143], v[28:31], 0
    s_nop 0
    v_bitop3_b32 v214, v232, v186, v184 bitop3:0xca
    v_bitop3_b32 v215, v232, v190, v188 bitop3:0xca
    v_mfma_f32_16x16x32_bf16 v[192:195], v[160:163], v[32:35], v[192:195]
    v_bitop3_b32 v212, v234, v233, v212 bitop3:0xca
    global_store_dwordx4 v4, v[212:215], s[36:37] sc1
    v_mfma_f32_16x16x32_bf16 v[196:199], v[164:167], v[32:35], v[196:199]
    v_bitop3_b32 v216, v232, v179, v177 bitop3:0xca
    v_bitop3_b32 v217, v232, v183, v181 bitop3:0xca
    v_mfma_f32_16x16x32_bf16 v[200:203], v[168:171], v[32:35], v[200:203]
    v_bitop3_b32 v218, v232, v187, v185 bitop3:0xca
    v_bitop3_b32 v219, v232, v191, v189 bitop3:0xca
    v_mfma_f32_16x16x32_bf16 v[204:207], v[172:175], v[32:35], v[204:207]
    v_bitop3_b32 v216, v234, v233, v216 bitop3:0xca
    global_store_dwordx4 v5, v[216:219], s[36:37] sc1
    v_bitop3_b32 v220, v232, v194, v192 bitop3:0xca
    v_bitop3_b32 v221, v232, v198, v196 bitop3:0xca
    s_nop 0
    v_bitop3_b32 v222, v232, v202, v200 bitop3:0xca
    s_nop 1
    v_bitop3_b32 v223, v232, v206, v204 bitop3:0xca
    v_bitop3_b32 v220, v234, v233, v220 bitop3:0xca
    global_store_dwordx4 v6, v[220:223], s[36:37] sc1
    v_bitop3_b32 v224, v232, v195, v193 bitop3:0xca
    v_bitop3_b32 v225, v232, v199, v197 bitop3:0xca
    v_bitop3_b32 v226, v232, v203, v201 bitop3:0xca
    v_bitop3_b32 v227, v232, v207, v205 bitop3:0xca
    v_bitop3_b32 v224, v234, v233, v224 bitop3:0xca
    global_store_dwordx4 v7, v[224:227], s[36:37] sc1
    s_endpgm
L_slow:
    v_mov_b32 v21, 0
    v_mov_b32 v38, v26
    s_mov_b32 s10, 16
L_slow_r:
    v_sub_u32 v176, v28, v21
    v_sub_u32 v177, v29, v21
    v_sub_u32 v178, v30, v21
    v_sub_u32 v179, v31, v21
    v_sub_u32 v180, v32, v21
    v_sub_u32 v181, v33, v21
    v_sub_u32 v182, v34, v21
    v_sub_u32 v183, v35, v21
    v_max3_u32 v24, v176, v177, v178
    v_max3_u32 v24, v24, v179, v180
    v_max3_u32 v24, v24, v181, v182
    v_max_u32 v24, v24, v183
    ds_max_u32 v38, v24 offset:96
    s_mov_b64 exec, 1
    ds_add_u32 v26, v27 offset:40
    s_mov_b64 exec, -1
L_slow_s:
    ds_read_b32 v24, v26 offset:40
    ds_read_b32 v39, v38 offset:96
    s_waitcnt lgkmcnt(0)
    v_readfirstlane_b32 s11, v24
    s_nop 0
    s_cmp_ge_u32 s11, s10
    s_cbranch_scc1 L_slow_ok
    s_sub_u32 s55, s55, 1
    s_cbranch_scc0 L_slow_s
L_slow_ok:
    v_add_u32 v21, v21, v39
    v_alignbit_b32 v24, 1, v21, 5
    ds_write_b32 v38, v24 offset:64
    v_add_u32 v38, 4, v38
    s_add_u32 s10, s10, 16
    s_cmp_le_u32 s10, 128
    s_cbranch_scc1 L_slow_r
    ds_read_b32 v23, v17 offset:64
    ds_read_b32 v13, v18 offset:64
    s_add_u32 m0, s64, 150016
    s_waitcnt lgkmcnt(0)
    v_and_b32 v23, 0x7ff, v23
    v_mad_i32_i24 v23, v23, s63, v12
    global_load_lds_dwordx4 v23, s[4:5]
    s_add_u32 m0, s64, 153728
    v_and_b32 v22, 0x7ff, v13
    global_load_lds_dwordx4 v23, s[4:5] offset:512
    v_sub_u32 v22, 2047, v22
    s_cmp_lg_u32 s39, 0
    s_cbranch_scc1 L_nox9b
    s_mov_b32 m0, 157440
    s_nop 0
    global_load_lds_dwordx4 v23, s[4:5] offset:1024
    s_branch L_x3b
L_nox9b:
    v_lshlrev_b32 v24, 3, v22
    v_add_u32 v24, 16384, v24
    global_load_dword v25, v24, s[36:37] sc1
L_x3b:
    v_mov_b32 v36, 4
    s_waitcnt vmcnt(0)
    s_cmp_lg_u32 s39, 1
    s_cbranch_scc1 L_nostb
    ds_write_b32 v18, v25 offset:448
L_nostb:
    s_mov_b64 exec, 1
    ds_add_u32 v26, v36 offset:36
    s_mov_b64 exec, -1
    s_branch L_dgo
L_gu:
    s_add_u32 s53, s53, 12288
    v_mov_b32 v1, v76
    s_movk_i32 s55, 7
L_dma1:
    s_mov_b32 m0, s53
    s_add_u32 s42, s53, 73728
    global_load_lds_dwordx4 v1, s[26:27]
    s_mov_b32 m0, s42
    s_add_u32 s53, s53, 4096
    global_load_lds_dwordx4 v1, s[28:29]
    v_add_u32 v1, 294912, v1
    s_sub_u32 s55, s55, 1
    s_cmp_lg_u32 s55, 0
    s_cbranch_scc1 L_dma1
    v_lshrrev_b32 v12, 1, v2
    v_min_u32 v12, 8, v12
    v_mul_u32_u24 v12, 1056, v12
    v_and_b32 v13, 16, v3
    v_add_u32 v12, v12, v13
    v_add_u32 v12, 151040, v12
    v_mov_b32 v20, 0x3f803f80
    v_mov_b32 v21, v20
    v_mov_b32 v22, v20
    v_mov_b32 v23, v20
    ds_write_b128 v12, v[20:23]
    v_bfe_u32 v15, v0, 2, 2
    v_and_b32 v16, 3, v0
    v_lshl_add_u32 v17, v14, 3, v15
    v_bfe_u32 v18, v0, 3, 2
    v_xor_b32 v18, s51, v18
    v_lshlrev_b32 v18, 5, v18
    v_lshl_add_u32 v18, v16, 3, v18
    v_lshl_add_u32 v4, v17, 7, v18
    v_add_u32 v5, 36864, v4
    v_add_u32 v6, 73728, v4
    v_add_u32 v7, 110592, v4
    v_and_b32 v19, 6, v11
    v_xor_b32 v19, v19, v14
    v_lshlrev_b32 v19, 4, v19
    v_lshl_add_u32 v19, v11, 7, v19
    v_xor_b32 v20, 64, v19
    v_bfe_i32 v21, v0, 3, 1
    v_lshlrev_b32 v22, 2, v0
    v_xor_b32 v22, v22, v0
    v_and_b32 v22, 16, v22
    v_or_b32 v22, 1024, v22
    v_bfi_b32 v19, v21, v22, v19
    v_xor_b32 v22, 16, v22
    v_bfi_b32 v20, v21, v22, v20
    v_add_u32 v19, 150016, v19
    v_add_u32 v20, 150016, v20
    v_lshl_add_u32 v18, v11, 2, v26
    s_lshr_b32 s42, s51, 1
    s_lshl_b32 s42, s42, 10
    s_and_b32 s43, s51, 1
    s_lshl_b32 s43, s43, 3
    s_add_u32 s42, s42, s43
    s_add_u32 s42, s42, 147968
    v_add_u32 v27, s42, v3
    v_and_b32 v8, 9344, v21
    v_lshl_add_u32 v8, v11, 4, v8
    s_mul_i32 s42, s50, 18688
    s_add_u32 s42, s42, 74752
    v_add_u32 v8, s42, v8
    s_waitcnt vmcnt(4)
    s_barrier
    ds_read_b64_tr_b16 v[112:113], v4 offset:0
    ds_read_b64_tr_b16 v[114:115], v4 offset:512
    ds_read_b64_tr_b16 v[184:185], v6 offset:0
    ds_read_b64_tr_b16 v[186:187], v6 offset:512
    ds_read_b64_tr_b16 v[116:117], v4 offset:4096
    ds_read_b64_tr_b16 v[118:119], v4 offset:4608
    ds_read_b64_tr_b16 v[188:189], v6 offset:4096
    ds_read_b64_tr_b16 v[190:191], v6 offset:4608
    ds_read_b64_tr_b16 v[120:121], v4 offset:8192
    ds_read_b64_tr_b16 v[122:123], v4 offset:8704
    ds_read_b64_tr_b16 v[192:193], v6 offset:8192
    ds_read_b64_tr_b16 v[194:195], v6 offset:8704
    ds_read_b64_tr_b16 v[124:125], v4 offset:12288
    ds_read_b64_tr_b16 v[126:127], v4 offset:12800
    ds_read_b64_tr_b16 v[196:197], v6 offset:12288
    ds_read_b64_tr_b16 v[198:199], v6 offset:12800
    ds_read_b64_tr_b16 v[128:129], v4 offset:16384
    ds_read_b64_tr_b16 v[130:131], v4 offset:16896
    ds_read_b64_tr_b16 v[200:201], v6 offset:16384
    ds_read_b64_tr_b16 v[202:203], v6 offset:16896
    ds_read_b64_tr_b16 v[132:133], v4 offset:20480
    ds_read_b64_tr_b16 v[134:135], v4 offset:20992
    ds_read_b64_tr_b16 v[204:205], v6 offset:20480
    ds_read_b64_tr_b16 v[206:207], v6 offset:20992
    ds_read_b64_tr_b16 v[136:137], v4 offset:24576
    ds_read_b64_tr_b16 v[138:139], v4 offset:25088
    ds_read_b64_tr_b16 v[208:209], v6 offset:24576
    ds_read_b64_tr_b16 v[210:211], v6 offset:25088
    ds_read_b64_tr_b16 v[140:141], v4 offset:28672
    ds_read_b64_tr_b16 v[142:143], v4 offset:29184
    ds_read_b64_tr_b16 v[212:213], v6 offset:28672
    ds_read_b64_tr_b16 v[214:215], v6 offset:29184
    s_barrier
    s_movk_i32 s55, 6
L_dma4:
    s_mov_b32 m0, s53
    s_add_u32 s42, s53, 73728
    global_load_lds_dwordx4 v1, s[26:27]
    s_mov_b32 m0, s42
    s_add_u32 s53, s53, 4096
    global_load_lds_dwordx4 v1, s[28:29]
    v_add_u32 v1, 294912, v1
    s_waitcnt vmcnt(4)
    s_sub_u32 s55, s55, 1
    s_cmp_lg_u32 s55, 0
    s_cbranch_scc1 L_dma4
    s_mov_b32 s55, 262144
    v_mov_b32 v23, 0x100
    s_waitcnt vmcnt(0)
    s_barrier
    s_setprio 2
    s_add_u32 m0, s53, 0
    s_nop 0
    global_load_lds_dwordx4 v1, s[26:27]
    ds_read_b64_tr_b16 v[144:145], v4 offset:32768
    ds_read_b64_tr_b16 v[146:147], v4 offset:33280
    ds_read_b64_tr_b16 v[216:217], v6 offset:32768
    ds_read_b64_tr_b16 v[218:219], v6 offset:33280
    ds_read_b64_tr_b16 v[148:149], v5 offset:0
    ds_read_b64_tr_b16 v[150:151], v5 offset:512
    ds_read_b64_tr_b16 v[220:221], v7 offset:0
    ds_read_b64_tr_b16 v[222:223], v7 offset:512
    s_add_u32 m0, s53, 73728
    s_nop 0
    global_load_lds_dwordx4 v1, s[28:29]
    ds_read_b64_tr_b16 v[152:153], v5 offset:4096
    ds_read_b64_tr_b16 v[154:155], v5 offset:4608
    ds_read_b64_tr_b16 v[224:225], v7 offset:4096
    ds_read_b64_tr_b16 v[226:227], v7 offset:4608
    ds_read_b64_tr_b16 v[156:157], v5 offset:8192
    ds_read_b64_tr_b16 v[158:159], v5 offset:8704
    ds_read_b64_tr_b16 v[228:229], v7 offset:8192
    ds_read_b64_tr_b16 v[230:231], v7 offset:8704
    v_add_u32 v1, 294912, v1
    s_add_u32 m0, s53, 4096
    s_nop 0
    global_load_lds_dwordx4 v1, s[26:27]
    ds_read_b64_tr_b16 v[160:161], v5 offset:12288
    ds_read_b64_tr_b16 v[162:163], v5 offset:12800
    ds_read_b64_tr_b16 v[232:233], v7 offset:12288
    ds_read_b64_tr_b16 v[234:235], v7 offset:12800
    ds_read_b64_tr_b16 v[164:165], v5 offset:16384
    ds_read_b64_tr_b16 v[166:167], v5 offset:16896
    ds_read_b64_tr_b16 v[236:237], v7 offset:16384
    ds_read_b64_tr_b16 v[238:239], v7 offset:16896
    s_add_u32 m0, s53, 77824
    s_nop 0
    global_load_lds_dwordx4 v1, s[28:29]
    ds_read_b64_tr_b16 v[168:169], v5 offset:20480
    ds_read_b64_tr_b16 v[170:171], v5 offset:20992
    ds_read_b64_tr_b16 v[240:241], v7 offset:20480
    ds_read_b64_tr_b16 v[242:243], v7 offset:20992
    ds_read_b64_tr_b16 v[172:173], v5 offset:24576
    ds_read_b64_tr_b16 v[174:175], v5 offset:25088
    ds_read_b64_tr_b16 v[244:245], v7 offset:24576
    ds_read_b64_tr_b16 v[246:247], v7 offset:25088
    v_add_u32 v1, 294912, v1
    s_barrier
    s_waitcnt vmcnt(0)
    s_mov_b64 exec, 1
    ds_add_u32 v26, v23 offset:36
    s_mov_b64 exec, -1
L_s6:
    ds_read_b32 v24, v26 offset:36
    s_waitcnt lgkmcnt(0)
    v_readfirstlane_b32 s61, v24
    s_nop 0
    s_cmp_eq_u32 s61, 0x80410
    s_cbranch_scc1 L_s6_ok
    s_and_b32 s60, s61, 0xffff
    s_cmp_eq_u32 s60, 0x420
    s_cbranch_scc1 L_s6_ok
    s_sub_u32 s55, s55, 1
    s_cbranch_scc0 L_s6
L_s6_ok:
    ds_read_b128 v[40:43], v19 offset:0
    ds_read_b128 v[44:47], v20 offset:0
    ds_read_b128 v[48:51], v19 offset:1056
    ds_read_b128 v[52:55], v20 offset:1056
    ds_read_b128 v[56:59], v19 offset:2112
    ds_read_b128 v[60:63], v20 offset:2112
    s_waitcnt lgkmcnt(5)
    v_mfma_f32_16x16x32_bf16 v[28:31], v[112:115], v[40:43], 0
    ds_read_b128 v[64:67], v19 offset:3168
    v_mfma_f32_16x16x32_bf16 v[32:35], v[184:187], v[40:43], 0
    ds_read_b128 v[68:71], v20 offset:3168
    s_waitcnt lgkmcnt(5)
    v_mfma_f32_16x16x32_bf16 v[28:31], v[116:119], v[44:47], v[28:31]
    ds_read_b128 v[72:75], v19 offset:4224
    v_mfma_f32_16x16x32_bf16 v[32:35], v[188:191], v[44:47], v[32:35]
    ds_read_b128 v[76:79], v20 offset:4224
    v_mfma_f32_16x16x32_bf16 v[28:31], v[120:123], v[48:51], v[28:31]
    ds_read_b32 v25, v18 offset:448
    v_mfma_f32_16x16x32_bf16 v[32:35], v[192:195], v[48:51], v[32:35]
    ds_read_b32 v13, v18 offset:64
    s_waitcnt lgkmcnt(7)
    v_mfma_f32_16x16x32_bf16 v[28:31], v[124:127], v[52:55], v[28:31]
    ds_read_b128 v[80:83], v19 offset:5280
    v_mfma_f32_16x16x32_bf16 v[32:35], v[196:199], v[52:55], v[32:35]
    ds_read_b128 v[84:87], v20 offset:5280
    v_mfma_f32_16x16x32_bf16 v[28:31], v[128:131], v[56:59], v[28:31]
    ds_read_b128 v[88:91], v19 offset:6336
    v_mfma_f32_16x16x32_bf16 v[32:35], v[200:203], v[56:59], v[32:35]
    ds_read_b128 v[92:95], v20 offset:6336
    s_waitcnt lgkmcnt(8)
    v_mfma_f32_16x16x32_bf16 v[28:31], v[132:135], v[60:63], v[28:31]
    ds_read_b128 v[96:99], v19 offset:7392
    v_mfma_f32_16x16x32_bf16 v[28:31], v[136:139], v[64:67], v[28:31]
    ds_read_b128 v[100:103], v20 offset:7392
    v_mfma_f32_16x16x32_bf16 v[28:31], v[140:143], v[68:71], v[28:31]
    ds_read_b128 v[104:107], v19 offset:8448
    ds_read_b64_tr_b16 v[176:177], v5 offset:28672
    s_waitcnt lgkmcnt(7)
    v_mfma_f32_16x16x32_bf16 v[28:31], v[144:147], v[72:75], v[28:31]
    ds_read_b64_tr_b16 v[178:179], v5 offset:29184
    ds_read_b128 v[108:111], v20 offset:8448
    v_mfma_f32_16x16x32_bf16 v[28:31], v[148:151], v[76:79], v[28:31]
    ds_read_b64_tr_b16 v[180:181], v5 offset:32768
    ds_read_b64_tr_b16 v[182:183], v5 offset:33280
    v_mfma_f32_16x16x32_bf16 v[28:31], v[152:155], v[80:83], v[28:31]
    ds_read_b64_tr_b16 v[248:249], v7 offset:28672
    v_and_b32 v15, 0xffff0000, v25
    s_waitcnt lgkmcnt(9)
    v_mfma_f32_16x16x32_bf16 v[28:31], v[156:159], v[84:87], v[28:31]
    ds_read_b64_tr_b16 v[250:251], v7 offset:29184
    v_rcp_f32 v16, v15
    v_mfma_f32_16x16x32_bf16 v[28:31], v[160:163], v[88:91], v[28:31]
    ds_read_b64_tr_b16 v[252:253], v7 offset:32768
    v_lshlrev_b32 v12, 16, v25
    v_mfma_f32_16x16x32_bf16 v[28:31], v[164:167], v[92:95], v[28:31]
    ds_read_b64_tr_b16 v[254:255], v7 offset:33280
    v_xor_b32 v25, 0x80000000, v12
    s_waitcnt lgkmcnt(7)
    v_mfma_f32_16x16x32_bf16 v[28:31], v[168:171], v[96:99], v[28:31]
    v_mul_f32 v16, 0x42000000, v16
    v_mul_f32 v9, 0xbfb8aa3b, v16
    v_mfma_f32_16x16x32_bf16 v[28:31], v[172:175], v[100:103], v[28:31]
    v_mul_f32 v10, v16, v16
    v_mfma_f32_16x16x32_bf16 v[28:31], v[176:179], v[104:107], v[28:31]
    s_waitcnt lgkmcnt(4)
    v_mfma_f32_16x16x32_bf16 v[28:31], v[180:183], v[108:111], v[28:31]
    v_mfma_f32_16x16x32_bf16 v[32:35], v[204:207], v[60:63], v[32:35]
    v_mfma_f32_16x16x32_bf16 v[32:35], v[208:211], v[64:67], v[32:35]
    v_mfma_f32_16x16x32_bf16 v[32:35], v[212:215], v[68:71], v[32:35]
    v_mfma_f32_16x16x32_bf16 v[32:35], v[216:219], v[72:75], v[32:35]
    s_nop 3
    v_fmac_f32_dpp v28, v28, v25 row_newbcast:8 row_mask:0xf bank_mask:0xf
    v_fmac_f32_dpp v29, v29, v25 row_newbcast:8 row_mask:0xf bank_mask:0xf
    v_mfma_f32_16x16x32_bf16 v[32:35], v[220:223], v[76:79], v[32:35]
    v_fmac_f32_dpp v30, v30, v25 row_newbcast:8 row_mask:0xf bank_mask:0xf
    v_fmac_f32_dpp v31, v31, v25 row_newbcast:8 row_mask:0xf bank_mask:0xf
    v_mfma_f32_16x16x32_bf16 v[32:35], v[224:227], v[80:83], v[32:35]
    v_mul_f32 v36, v9, v28
    v_mul_f32 v37, v9, v29
    v_mfma_f32_16x16x32_bf16 v[32:35], v[228:231], v[84:87], v[32:35]
    v_mul_f32 v38, v9, v30
    v_mul_f32 v39, v9, v31
    v_mfma_f32_16x16x32_bf16 v[32:35], v[232:235], v[88:91], v[32:35]
    v_exp_f32 v36, v36
    v_exp_f32 v37, v37
    v_mfma_f32_16x16x32_bf16 v[32:35], v[236:239], v[92:95], v[32:35]
    v_exp_f32 v38, v38
    v_exp_f32 v39, v39
    v_mfma_f32_16x16x32_bf16 v[32:35], v[240:243], v[96:99], v[32:35]
    v_mul_f32 v28, v28, v10
    v_mul_f32 v29, v29, v10
    v_mfma_f32_16x16x32_bf16 v[32:35], v[244:247], v[100:103], v[32:35]
    v_mul_f32 v30, v30, v10
    v_mul_f32 v31, v31, v10
    s_waitcnt lgkmcnt(0)
    v_mfma_f32_16x16x32_bf16 v[32:35], v[248:251], v[104:107], v[32:35]
    v_add_f32 v36, 1.0, v36
    v_add_f32 v37, 1.0, v37
    v_mfma_f32_16x16x32_bf16 v[32:35], v[252:255], v[108:111], v[32:35]
    v_add_f32 v38, 1.0, v38
    v_add_f32 v39, 1.0, v39
    v_rcp_f32 v36, v36
    v_rcp_f32 v37, v37
    v_rcp_f32 v38, v38
    v_rcp_f32 v39, v39
    v_mul_f32 v28, v28, v36
    v_mul_f32 v29, v29, v37
    v_mul_f32 v30, v30, v38
    v_mul_f32 v31, v31, v39
    v_fmac_f32_dpp v32, v32, v25 row_newbcast:8 row_mask:0xf bank_mask:0xf
    v_fmac_f32_dpp v33, v33, v25 row_newbcast:8 row_mask:0xf bank_mask:0xf
    v_fmac_f32_dpp v34, v34, v25 row_newbcast:8 row_mask:0xf bank_mask:0xf
    v_fmac_f32_dpp v35, v35, v25 row_newbcast:8 row_mask:0xf bank_mask:0xf
    v_mul_f32 v28, v28, v32
    v_mul_f32 v29, v29, v33
    v_mul_f32 v30, v30, v34
    v_mul_f32 v31, v31, v35
    v_cvt_pk_bf16_f32 v28, v28, v29
    v_cvt_pk_bf16_f32 v29, v30, v31
    ds_write_b64 v27, v[28:29]
    s_waitcnt lgkmcnt(0)
    s_barrier
    s_cmp_lg_u32 s39, 4
    s_cbranch_scc1 L_gu_end
    v_lshlrev_b32 v36, 5, v13
    v_not_b32 v37, v36
    v_ashrrev_i32 v38, 31, v37
    v_or_b32 v38, 0x80000000, v38
    v_xor_b32 v36, v36, v38
    v_and_b32 v36, 0xffff0000, v36
    v_mul_f32 v36, 0xbfb8aa3b, v36
    v_exp_f32 v36, v36
    v_bfe_u32 v4, v37, 5, 11
    v_mov_b32 v6, v12
    v_mov_b32 v7, v15
    v_add_f32 v36, 1.0, v36
    v_rcp_f32 v5, v36
    v_lshl_or_b32 v4, v4, 8, s45
    s_mov_b64 exec, 0xffff
    global_store_dwordx4 v8, v[4:7], s[36:37] sc1
    s_cmp_lg_u32 s50, 0
    s_cbranch_scc1 L_gu_end
    v_mov_b32 v9, 0
    v_mov_b32 v10, s38
    s_mov_b64 exec, 1
    global_store_dword v9, v10, s[36:37]
L_gu_end:
    s_endpgm
L_end:
    s_endpgm
.fill 96, 4, 0xbf810000
L_last:
.section .rodata,"a"
.p2align 6
.amdhsa_kernel recurrent_scan__ssm_conv_s4__moe_arch_mod__prompt_kernel
  .amdhsa_next_free_vgpr 256
  .amdhsa_next_free_sgpr 102
  .amdhsa_accum_offset 256
  .amdhsa_group_segment_fixed_size 0
  .amdhsa_kernarg_size 136
  .amdhsa_user_sgpr_count 2
  .amdhsa_user_sgpr_kernarg_segment_ptr 1
  .amdhsa_system_sgpr_workgroup_id_x 1
  .amdhsa_float_denorm_mode_32 3
.end_amdhsa_kernel
```

```asm
; @launch grid=(256,1,1) block=(512,1,1) lds=163840
.amdgcn_target "amdgcn-amd-amdhsa--gfx950"
.text
.globl recurrent_scan__ssm_conv_s4__moe_arch_mod__prompt_kernel
.p2align 8
.type recurrent_scan__ssm_conv_s4__moe_arch_mod__prompt_kernel,@function
recurrent_scan__ssm_conv_s4__moe_arch_mod__prompt_kernel:
    s_load_dwordx16 s[4:19], s[0:1], 0
    s_load_dwordx16 s[20:35], s[0:1], 64
    s_load_dwordx2 s[36:37], s[0:1], 128
    s_cmp_ge_u32 s2, 256
    s_cbranch_scc1 L_end
    s_lshr_b32 s41, s2, 3
    s_getpc_b64 s[42:43]
L_pc:
    s_mul_i32 s47, s41, 768
    s_add_u32 s42, s42, s47
    s_addc_u32 s43, s43, 0
    v_lshlrev_b32 v4, 7, v0
    v_mov_b32 v5, s43
    v_add_co_u32 v4, vcc, s42, v4
    v_lshrrev_b32 v1, 6, v0
    v_and_b32 v2, 63, v0
    v_addc_co_u32 v5, vcc, 0, v5, vcc
    s_sub_u32 s47, L_last - L_pc - 4, s47
    s_ashr_i32 s47, s47, 7
    s_min_i32 s47, s47, 5
    v_cmp_ge_i32 vcc, s47, v0
    s_nop 0
    s_and_saveexec_b64 s[48:49], vcc
    s_cbranch_execz L_nopf
    global_load_dword v255, v[4:5], off
L_nopf:
    s_mov_b64 exec, -1
    v_readfirstlane_b32 s39, v1
    s_and_b32 s40, s2, 7
    s_mul_i32 s42, s2, 9216
    v_lshlrev_b32 v3, 4, v2
    v_lshlrev_b32 v4, 1, v2
    v_mul_u32_u24 v5, 1152, v1
    v_add3_u32 v6, v5, v3, s42
    v_add3_u32 v7, v5, v4, s42
    s_waitcnt lgkmcnt(0)
    global_load_dwordx4 v[12:15], v6, s[4:5]
    global_load_ushort v16, v7, s[4:5] offset:1024
    s_load_dword s38, s[36:37], 0
    global_load_dwordx4 v[20:23], v3, s[24:25]
    global_load_ushort v24, v4, s[24:25] offset:1024
    s_and_b32 s51, s39, 3
    s_lshr_b32 s52, s39, 2
    s_cmp_lt_u32 s41, 18
    s_cbranch_scc1 L_conv_pre
    s_cmp_lt_u32 s41, 27
    s_cbranch_scc1 L_ffn_pre
    s_sub_u32 s53, s41, 27
    s_and_b32 s58, s39, 1
    s_lshr_b32 s43, s39, 1
    s_mul_i32 s42, s43, 320
    s_add_u32 s42, s42, 1152
    s_cmp_eq_u32 s43, 0
    s_cmovk_i32 s42, 1152
    s_cmp_eq_u32 s43, 1
    s_cselect_b32 s48, 1, 0
    s_mul_i32 s59, s58, 320
    s_cmp_eq_u32 s43, 3
    s_cselect_b32 s42, s59, s42
    s_cmovk_i32 s58, 2
    s_lshl_b32 s53, s53, 6
    s_add_u32 s42, s42, s53
    s_mul_i32 s43, s40, 1152
    s_add_u32 s43, s43, 884736
    s_mul_i32 s59, s40, 663552
    s_cmp_eq_u32 s58, 0
    s_cselect_b32 s56, s26, s28
    s_cselect_b32 s57, s27, s29
    s_cmp_eq_u32 s58, 2
    s_cselect_b32 s56, s30, s56
    s_cselect_b32 s57, s31, s57
    s_cselect_b32 s43, s59, s43
    s_movk_i32 s58, 128
    s_movk_i32 s59, 8064
    s_movk_i32 s60, 4319
    s_cmov_b32 s58, 73728
    s_cmov_b32 s59, -663424
    s_cmovk_i32 s60, 5183
    v_add_u32 v76, s42, v2
    v_min_u32 v76, s60, v76
    v_mul_u32_u24 v63, 7282, v76
    v_lshrrev_b32 v63, 16, v63
    v_mul_u32_u24 v76, s58, v76
    v_mad_i32_i24 v76, v63, s59, v76
    v_add_u32 v76, s43, v76
    s_mov_b32 s49, 0
    s_branch L_lnp
L_ffn_pre:
    s_sub_u32 s54, s41, 18
    s_mul_i32 s50, s40, 9
    s_add_u32 s50, s50, s54
    v_bfe_u32 v76, v0, 3, 5
    v_bfe_u32 v61, v0, 4, 1
    v_bfe_u32 v62, v0, 6, 1
    v_lshl_add_u32 v61, v62, 1, v61
    v_lshlrev_b32 v61, 1, v61
    v_and_b32 v62, 7, v0
    v_xor_b32 v61, v61, v62
    v_mul_u32_u24 v76, 9216, v76
    v_lshlrev_b32 v61, 4, v61
    s_lshl_b32 s42, s50, 7
    v_add3_u32 v76, v76, v61, s42
    s_lshl_b32 s53, s51, 10
    s_cmp_eq_u32 s52, 0
    s_cselect_b32 s56, s26, s28
    s_cselect_b32 s57, s27, s29
    s_cselect_b32 s42, 0, 73728
    s_add_u32 s42, s53, s42
    s_mov_b32 s49, s42
    v_mov_b32 v62, 0
    v_mov_b32 v63, 0
    v_lshrrev_b32 v61, 1, v3
    v_add_u32 v61, 147456, v61
    ds_write_b64 v61, v[62:63]
    s_mov_b32 s47, 3
    s_mov_b32 s48, 0
    s_branch L_lnp
L_conv_pre:
    s_lshl_b32 s50, s40, 4
    s_lshl_b32 s42, s40, 1
    s_add_u32 s42, s42, 112
    s_cmp_ge_u32 s41, 16
    s_cselect_b32 s50, s42, s50
    s_add_u32 s50, s50, s41
    s_lshl_b32 s53, s50, 2
    s_add_u32 s53, s53, s51
    s_lshl_b32 s42, s53, 8
    s_lshl_b32 s43, s52, 7
    s_add_u32 s42, s42, s43
    v_add_u32 v60, s42, v4
    s_lshl_b32 s54, s50, 3
    s_lshl_b32 s42, s53, 1
    v_mov_b32 v61, s42
    v_mov_b64 v[64:65], 0
    v_mov_b64 v[66:67], 0
    v_mov_b64 v[68:69], 0
    v_mov_b64 v[70:71], 0
    s_barrier
    global_load_short_d16_hi v70, v61, s[18:19]
    global_load_short_d16_hi v64, v60, s[6:7]
    global_load_short_d16_hi v65, v60, s[8:9]
    global_load_short_d16_hi v66, v60, s[10:11]
    global_load_short_d16_hi v67, v60, s[12:13]
    global_load_short_d16_hi v68, v60, s[14:15]
    global_load_short_d16_hi v69, v60, s[16:17]
    global_load_short_d16_hi v71, v61, s[20:21]
    s_lshr_b32 s42, s51, 1
    s_mul_i32 s42, s42, 2112
    s_and_b32 s58, s51, 1
    s_mul_i32 s43, s58, 1152
    s_add_u32 s43, s43, 640
    s_lshr_b32 s47, s39, 1
    s_cmp_eq_u32 s47, 0
    s_cmovk_i32 s42, 3168
    s_cmp_eq_u32 s47, 1
    s_cselect_b32 s42, s43, s42
    s_cmovk_i32 s58, 2
    s_lshl_b32 s43, s41, 6
    s_add_u32 s42, s42, s43
    s_mul_i32 s43, s40, 1152
    s_add_u32 s43, s43, 884736
    s_mul_i32 s59, s40, 663552
    s_cmp_eq_u32 s58, 0
    s_cselect_b32 s56, s26, s28
    s_cselect_b32 s57, s27, s29
    s_cmp_eq_u32 s58, 2
    s_cselect_b32 s56, s30, s56
    s_cselect_b32 s57, s31, s57
    s_cselect_b32 s43, s59, s43
    s_movk_i32 s58, 128
    s_movk_i32 s59, 8064
    s_movk_i32 s60, 4319
    s_cmov_b32 s58, 73728
    s_cmov_b32 s59, -663424
    s_cmovk_i32 s60, 5183
    v_add_u32 v76, s42, v2
    v_min_u32 v76, s60, v76
    v_mul_u32_u24 v63, 7282, v76
    v_lshrrev_b32 v63, 16, v63
    v_mul_u32_u24 v76, s58, v76
    v_mad_i32_i24 v76, v63, s59, v76
    v_add_u32 v76, s43, v76
    s_mul_i32 s55, s51, 33792
    s_lshl_b32 s42, s52, 8
    s_add_u32 m0, s55, s42
    s_mul_i32 s63, s51, 4640
    s_add_u32 s63, s63, 135168
    v_mov_b64 v[84:85], 0
    v_mov_b64 v[86:87], 0
    s_cmp_eq_u32 s52, 0
    s_cbranch_scc1 L_cp_m
    s_setprio 1
    v_min_u32 v83, 29, v2
    v_lshl_add_u32 v83, v83, 4, s63
    ds_write_b128 v83, v[84:87]
    v_and_b32 v88, 0x70, v3
    v_add_u32 v88, 153728, v88
    ds_write_b128 v88, v[84:87]
    s_branch L_cp_e
L_cp_m:
    v_and_b32 v8, 15, v0
    v_bfe_u32 v9, v0, 4, 2
    v_and_b32 v10, 31, v0
    v_and_b32 v11, 32, v0
    v_mul_u32_u24 v78, 528, v10
    v_lshl_add_u32 v78, v11, 3, v78
    v_add_u32 v78, s55, v78
    v_lshrrev_b32 v11, 1, v11
    v_lshl_add_u32 v10, v10, 5, v11
    s_add_u32 s42, s55, 1072
    v_sub_u32 v81, s42, v10
    v_lshrrev_b32 v77, 2, v10
    s_add_u32 s42, s55, 5564
    v_sub_u32 v77, s42, v77
    v_bfe_i32 v79, v0, 4, 1
    v_sub_u32 v80, 495, v10
    v_ashrrev_i32 v80, 31, v80
    v_sub_u32 v82, 1007, v10
    v_ashrrev_i32 v82, 31, v82
    v_bfe_u32 v10, v0, 3, 2
    v_and_b32 v11, 7, v0
    v_mul_u32_u24 v73, 1216, v10
    v_and_b32 v83, 4, v0
    v_lshl_add_u32 v83, v83, 4, v11
    v_lshl_add_u32 v83, v83, 4, v73
    v_lshlrev_b32 v72, 4, v10
    v_add_u32 v72, 5120, v72
    v_sub_u32 v74, 5, v11
    v_ashrrev_i32 v74, 31, v74
    v_bfi_b32 v83, v74, v72, v83
    v_and_b32 v72, 8, v0
    v_mad_u32_u24 v72, v72, 3, v11
    v_lshlrev_b32 v72, 4, v72
    v_add_u32 v72, 5184, v72
    v_bfe_i32 v74, v0, 5, 1
    v_bfi_b32 v83, v74, v72, v83
    v_add_u32 v83, s55, v83
    v_sub_u32 v74, 4, v11
    v_ashrrev_i32 v74, 31, v74
    v_add_u32 v72, 507, v11
    v_min_u32 v75, 2, v11
    v_bfi_b32 v74, v74, v72, v75
    v_sub_u32 v74, v74, v10
    v_lshl_add_u32 v73, v74, 1, v73
    v_min_u32 v74, 1, v10
    v_lshl_add_u32 v73, v74, 3, v73
    s_add_u32 s42, s55, 58
    v_add_u32 v73, s42, v73
    v_max_u32 v72, 4, v11
    v_mul_u32_u24 v72, 0x202, v72
    v_add_u32 v72, 1284, v72
    v_and_b32 v72, 0x707, v72
L_cp_e:
L_clnp:
    s_mul_i32 s43, s39, 1216
    s_add_u32 s43, s43, 154048
    v_add_u32 v52, s43, v3
    v_add_u32 v53, s43, v4
    s_lshl_b32 s43, s39, 3
    s_add_u32 s43, s43, 163776
    v_mov_b32 v54, s43
    v_bfe_u32 v55, v0, 2, 2
    v_mul_u32_u24 v55, 1216, v55
    v_and_b32 v56, 3, v0
    v_lshl_add_u32 v55, v56, 3, v55
    v_lshrrev_b32 v56, 4, v0
    v_lshl_add_u32 v55, v56, 5, v55
    v_add_u32 v55, 154048, v55
    v_lshrrev_b32 v56, 3, v0
    v_lshlrev_b32 v56, 15, v56
    v_and_b32 v57, 112, v3
    s_lshl_b32 s43, s2, 7
    s_add_u32 s43, s43, 2097152
    v_add3_u32 v56, v56, v57, s43
    v_mov_b32 v40, 0
    v_mov_b32 v41, 0
    v_mov_b32 v42, 0
    v_mov_b32 v43, 0
    v_mov_b32 v44, 0x3ae38e39
    v_mov_b32 v38, 0xbfffbfff
    v_mov_b32 v37, 0xffff
    s_lshl_b32 s58, s2, 3
    s_add_u32 s58, s58, s39
    s_xor_b32 s58, s58, 0x7ff
    s_lshl_b32 s58, s58, 5
    s_waitcnt lgkmcnt(0)
    s_add_u32 s38, s38, 0x9e370001
    s_lshr_b32 s44, s38, 16
    s_and_b32 s45, s38, 0xff
    s_and_b32 s46, s38, 0xfb
    s_bitcmp0_b32 s38, 0
    s_cselect_b32 s43, 4, 0
    s_or_b32 s46, s46, s43
    s_bitcmp1_b32 s46, s39
    s_cselect_b32 s43, 0x40004000, 0
    v_mov_b32 v39, s43
    s_xor_b32 s58, s58, s44
    v_mov_b32 v57, s58
    s_mov_b32 s42, 0x3f803f80
    s_cmp_eq_u32 s47, 2
    s_cbranch_scc0 L_clw
    global_load_dword v1, v76, s[56:57]
    s_waitcnt vmcnt(9)
    s_branch L_cln
L_clw:
    s_waitcnt vmcnt(8)
L_cln:
    v_dot2c_f32_bf16 v40, s42, v12
    v_dot2c_f32_bf16 v41, v12, v12
    v_dot2c_f32_bf16 v42, v12, v20
    v_dot2c_f32_bf16 v43, s42, v20
    v_dot2c_f32_bf16 v40, s42, v13
    v_dot2c_f32_bf16 v41, v13, v13
    v_dot2c_f32_bf16 v42, v13, v21
    v_dot2c_f32_bf16 v43, s42, v21
    v_dot2c_f32_bf16 v40, s42, v14
    v_dot2c_f32_bf16 v41, v14, v14
    v_dot2c_f32_bf16 v42, v14, v22
    v_dot2c_f32_bf16 v43, s42, v22
    v_dot2c_f32_bf16 v40, s42, v15
    v_dot2c_f32_bf16 v41, v15, v15
    v_dot2c_f32_bf16 v42, v15, v23
    v_dot2c_f32_bf16 v43, s42, v23
    v_dot2c_f32_bf16 v40, s42, v16
    v_dot2c_f32_bf16 v41, v16, v16
    v_dot2c_f32_bf16 v42, v16, v24
    v_dot2c_f32_bf16 v43, s42, v24
    v_lshlrev_b32 v36, 16, v16
    v_lshlrev_b32 v28, 16, v12
    v_and_b32 v29, 0xffff0000, v12
    v_permlane32_swap_b32 v40, v42
    v_permlane32_swap_b32 v41, v43
    v_add_f32 v40, v40, v42
    v_add_f32 v41, v41, v43
    v_lshlrev_b32 v30, 16, v13
    v_and_b32 v31, 0xffff0000, v13
    v_permlane16_swap_b32 v40, v41
    v_add_f32 v40, v40, v41
    v_lshlrev_b32 v32, 16, v14
    v_and_b32 v33, 0xffff0000, v14
    v_add_f32_dpp v40, v40, v40 row_ror:8 row_mask:0xf bank_mask:0xf
    v_lshlrev_b32 v34, 16, v15
    v_and_b32 v35, 0xffff0000, v15
    v_add_f32_dpp v40, v40, v40 row_ror:4 row_mask:0xf bank_mask:0xf
    s_nop 1
    v_add_f32_dpp v40, v40, v40 row_ror:2 row_mask:0xf bank_mask:0xf
    s_nop 1
    v_add_f32_dpp v40, v40, v40 row_ror:1 row_mask:0xf bank_mask:0xf
    s_nop 0
    v_readlane_b32 s58, v40, 0
    v_readlane_b32 s59, v40, 16
    v_readlane_b32 s60, v40, 32
    v_readlane_b32 s61, v40, 48
    v_mul_f32 v40, s58, v44
    v_mul_f32 v41, s59, v44
    v_fma_f32 v41, -v40, v40, v41
    v_max_f32 v41, 0, v41
    v_cvt_pk_bf16_f32 v44, v41, v40
    v_lshlrev_b32 v41, 16, v44
    v_add_f32 v41, 0x3727c5ac, v41
    v_cvt_pk_bf16_f32 v41, v41, v41
    v_and_b32 v41, 0xffff0000, v41
    v_mul_f32 v41, 0x44800000, v41
    v_sqrt_f32 v41, v41
    v_and_b32 v49, 0xffff0000, v44
    v_cvt_pk_bf16_f32 v50, v49, v41
    v_and_b32 v41, 0xffff0000, v50
    v_rcp_f32 v46, v41
    v_mul_f32 v42, s61, v49
    v_mul_f32 v47, v49, v46
    v_fma_f32 v28, v28, v46, -v47
    v_fma_f32 v29, v29, v46, -v47
    v_fma_f32 v30, v30, v46, -v47
    v_fma_f32 v31, v31, v46, -v47
    v_fma_f32 v32, v32, v46, -v47
    v_fma_f32 v33, v33, v46, -v47
    v_fma_f32 v34, v34, v46, -v47
    v_fma_f32 v35, v35, v46, -v47
    v_fma_f32 v36, v36, v46, -v47
    v_cvt_pk_bf16_f32 v28, v28, v29
    v_cvt_pk_bf16_f32 v29, v30, v31
    v_cvt_pk_bf16_f32 v30, v32, v33
    v_cvt_pk_bf16_f32 v31, v34, v35
    v_cvt_pk_bf16_f32 v32, v36, v36
    v_bitop3_b32 v28, v28, v38, v39 bitop3:0xea
    v_bitop3_b32 v29, v29, v38, v39 bitop3:0xea
    v_bitop3_b32 v30, v30, v38, v39 bitop3:0xea
    v_bitop3_b32 v31, v31, v38, v39 bitop3:0xea
    v_bitop3_b32 v32, v32, v38, v39 bitop3:0xea
    ds_write_b128 v52, v[28:31]
    ds_write_b16 v53, v32 offset:1024
    v_sub_f32 v42, s60, v42
    v_mul_f32 v42, 0x42000000, v42
    v_mul_f32 v42, v42, v46
    v_cvt_pk_bf16_f32 v42, v42, v42
    v_ashrrev_i32 v43, 31, v42
    v_or_b32 v43, 0x80000000, v43
    v_xor_b32 v42, v42, v43
    v_bitop3_b32 v51, v37, v57, v42 bitop3:0xca
    s_mov_b64 exec, 1
    ds_write_b64 v54, v[50:51]
    s_mov_b64 exec, -1
    s_waitcnt lgkmcnt(0)
    s_barrier
    s_cmp_eq_u32 s39, 1
    s_cbranch_scc1 L_cln_stat
    ds_read_b64_tr_b16 v[28:29], v55
    ds_read_b64_tr_b16 v[30:31], v55 offset:4864
    s_cmp_eq_u32 s39, 0
    s_cbranch_scc0 L_cln_st
    ds_read_b64_tr_b16 v[32:33], v55 offset:1024
    ds_read_b64_tr_b16 v[34:35], v55 offset:5888
    v_add_u32 v38, 2097152, v56
    s_waitcnt lgkmcnt(0)
    global_store_dwordx4 v38, v[32:35], s[36:37] sc1
    s_branch L_cln_st
L_cln_stat:
    v_and_b32 v41, 0x30, v3
    v_add_u32 v40, 163776, v41
    ds_read_b128 v[48:51], v40
    ds_read_b64_tr_b16 v[28:29], v55
    ds_read_b64_tr_b16 v[30:31], v55 offset:4864
    s_lshl_b32 s43, s2, 6
    s_add_u32 s43, s43, 16384
    v_add_u32 v41, s43, v41
    s_mov_b64 exec, 15
    s_waitcnt lgkmcnt(2)
    global_store_dwordx4 v41, v[48:51], s[36:37] sc1
    s_mov_b64 exec, -1
L_cln_st:
    s_waitcnt lgkmcnt(0)
    global_store_dwordx4 v56, v[28:31], s[36:37] sc1
    s_waitcnt vmcnt(2)
    v_mul_f32 v70, 0x3fb8aa3b, v70
    v_exp_f32 v70, v70
    v_mov_b32 v34, 0x3f80
    ds_write_addtid_b32 v34
    v_cvt_pk_bf16_f32 v70, v70, v70
    v_and_b32 v70, 0xffff0000, v70
    v_mul_f32 v64, v70, v64
    v_mul_f32 v65, v70, v65
    v_mul_f32 v70, 0x44800000, v70
    v_mul_f32 v64, 0x3fb8aa3b, v64
    v_mul_f32 v65, 0x3e22f983, v65
    v_mul_f32 v66, v70, v66
    v_mul_f32 v67, v70, v67
    v_mul_f32 v13, 0x41800000, v64
    v_mul_f32 v17, 0x41800000, v65
    v_mul_f32 v14, 0x44000000, v64
    v_mul_f32 v18, 0x44000000, v65
    v_exp_f32 v12, v64
    v_fract_f32 v16, v65
    v_exp_f32 v13, v13
    v_fract_f32 v17, v17
    v_exp_f32 v14, v14
    v_fract_f32 v18, v18
    v_pk_mul_f32 v[20:21], v[68:69], v[66:67] op_sel:[0,0] op_sel_hi:[0,1] neg_hi:[0,1]
    v_pk_fma_f32 v[90:91], v[68:69], v[66:67], v[20:21] op_sel:[1,1,0] op_sel_hi:[1,0,1] neg_lo:[0,1,0] neg_hi:[0,1,0]
    v_cos_f32 v22, v16
    v_sin_f32 v23, v16
    v_cos_f32 v24, v17
    v_sin_f32 v25, v17
    v_cos_f32 v26, v18
    v_sin_f32 v27, v18
    v_cvt_pk_bf16_f32 v35, v90, v91
    ds_write_addtid_b32 v35 offset:16896
    v_mul_f32 v22, v12, v22
    v_mul_f32 v23, -v12, v23
    v_mul_f32 v24, v13, v24
    v_mul_f32 v25, v13, v25
    v_mul_f32 v26, v14, v26
    v_mul_f32 v27, -v14, v27
    v_cvt_pk_bf16_f32 v36, v24, v25
    ds_write_addtid_b32 v36 offset:528
L_cs2:
    v_pk_mul_f32 v[30:31], v[24:25], v[24:25] op_sel:[0,0] op_sel_hi:[0,1]
    v_pk_fma_f32 v[28:29], v[24:25], v[24:25], v[30:31] op_sel:[1,1,0] op_sel_hi:[1,0,1] neg_lo:[0,1,0]
    v_cvt_pk_bf16_f32 v34, v28, v29
    ds_write_addtid_b32 v34 offset:1056
    v_pk_mul_f32 v[32:33], v[90:91], v[22:23] op_sel:[0,0] op_sel_hi:[0,1]
    v_pk_fma_f32 v[92:93], v[90:91], v[22:23], v[32:33] op_sel:[1,1,0] op_sel_hi:[1,0,1] neg_lo:[0,1,0]
    v_cvt_pk_bf16_f32 v35, v92, v93
    ds_write_addtid_b32 v35 offset:17424
    v_pk_mul_f32 v[30:31], v[28:29], v[24:25] op_sel:[0,0] op_sel_hi:[0,1]
    v_pk_fma_f32 v[28:29], v[28:29], v[24:25], v[30:31] op_sel:[1,1,0] op_sel_hi:[1,0,1] neg_lo:[0,1,0]
    v_cvt_pk_bf16_f32 v36, v28, v29
    ds_write_addtid_b32 v36 offset:1584
    v_pk_mul_f32 v[32:33], v[92:93], v[22:23] op_sel:[0,0] op_sel_hi:[0,1]
    v_pk_fma_f32 v[94:95], v[92:93], v[22:23], v[32:33] op_sel:[1,1,0] op_sel_hi:[1,0,1] neg_lo:[0,1,0]
    v_cvt_pk_bf16_f32 v37, v94, v95
    ds_write_addtid_b32 v37 offset:17952
    s_cmp_eq_u32 s47, 3
    s_cbranch_scc0 L_ct1
    global_load_dword v1, v76, s[56:57]
L_ct1:
    v_pk_mul_f32 v[30:31], v[28:29], v[24:25] op_sel:[0,0] op_sel_hi:[0,1]
    v_pk_fma_f32 v[28:29], v[28:29], v[24:25], v[30:31] op_sel:[1,1,0] op_sel_hi:[1,0,1] neg_lo:[0,1,0]
    v_cvt_pk_bf16_f32 v34, v28, v29
    ds_write_addtid_b32 v34 offset:2112
    v_pk_mul_f32 v[32:33], v[94:95], v[22:23] op_sel:[0,0] op_sel_hi:[0,1]
    v_pk_fma_f32 v[96:97], v[94:95], v[22:23], v[32:33] op_sel:[1,1,0] op_sel_hi:[1,0,1] neg_lo:[0,1,0]
    v_cvt_pk_bf16_f32 v35, v96, v97
    ds_write_addtid_b32 v35 offset:18480
    v_pk_mul_f32 v[30:31], v[28:29], v[24:25] op_sel:[0,0] op_sel_hi:[0,1]
    v_pk_fma_f32 v[28:29], v[28:29], v[24:25], v[30:31] op_sel:[1,1,0] op_sel_hi:[1,0,1] neg_lo:[0,1,0]
    v_cvt_pk_bf16_f32 v36, v28, v29
    ds_write_addtid_b32 v36 offset:2640
    v_pk_mul_f32 v[32:33], v[96:97], v[22:23] op_sel:[0,0] op_sel_hi:[0,1]
    v_pk_fma_f32 v[98:99], v[96:97], v[22:23], v[32:33] op_sel:[1,1,0] op_sel_hi:[1,0,1] neg_lo:[0,1,0]
    v_cvt_pk_bf16_f32 v37, v98, v99
    ds_write_addtid_b32 v37 offset:21120
    v_pk_mul_f32 v[30:31], v[28:29], v[24:25] op_sel:[0,0] op_sel_hi:[0,1]
    v_pk_fma_f32 v[28:29], v[28:29], v[24:25], v[30:31] op_sel:[1,1,0] op_sel_hi:[1,0,1] neg_lo:[0,1,0]
    v_cvt_pk_bf16_f32 v34, v28, v29
    ds_write_addtid_b32 v34 offset:3168
    v_pk_mul_f32 v[32:33], v[98:99], v[22:23] op_sel:[0,0] op_sel_hi:[0,1]
    v_pk_fma_f32 v[100:101], v[98:99], v[22:23], v[32:33] op_sel:[1,1,0] op_sel_hi:[1,0,1] neg_lo:[0,1,0]
    v_cvt_pk_bf16_f32 v35, v100, v101
    ds_write_addtid_b32 v35 offset:21648
    v_pk_mul_f32 v[30:31], v[28:29], v[24:25] op_sel:[0,0] op_sel_hi:[0,1]
    v_pk_fma_f32 v[28:29], v[28:29], v[24:25], v[30:31] op_sel:[1,1,0] op_sel_hi:[1,0,1] neg_lo:[0,1,0]
    v_cvt_pk_bf16_f32 v36, v28, v29
    ds_write_addtid_b32 v36 offset:3696
    v_pk_mul_f32 v[32:33], v[100:101], v[22:23] op_sel:[0,0] op_sel_hi:[0,1]
    v_pk_fma_f32 v[102:103], v[100:101], v[22:23], v[32:33] op_sel:[1,1,0] op_sel_hi:[1,0,1] neg_lo:[0,1,0]
    v_cvt_pk_bf16_f32 v37, v102, v103
    ds_write_addtid_b32 v37 offset:22176
    v_pk_mul_f32 v[30:31], v[28:29], v[24:25] op_sel:[0,0] op_sel_hi:[0,1]
    v_pk_fma_f32 v[28:29], v[28:29], v[24:25], v[30:31] op_sel:[1,1,0] op_sel_hi:[1,0,1] neg_lo:[0,1,0]
    v_cvt_pk_bf16_f32 v34, v28, v29
    ds_write_addtid_b32 v34 offset:4224
    v_pk_mul_f32 v[32:33], v[102:103], v[22:23] op_sel:[0,0] op_sel_hi:[0,1]
    v_pk_fma_f32 v[104:105], v[102:103], v[22:23], v[32:33] op_sel:[1,1,0] op_sel_hi:[1,0,1] neg_lo:[0,1,0]
    v_cvt_pk_bf16_f32 v35, v104, v105
    ds_write_addtid_b32 v35 offset:22704
    v_pk_mul_f32 v[30:31], v[28:29], v[24:25] op_sel:[0,0] op_sel_hi:[0,1]
    v_pk_fma_f32 v[28:29], v[28:29], v[24:25], v[30:31] op_sel:[1,1,0] op_sel_hi:[1,0,1] neg_lo:[0,1,0]
    v_cvt_pk_bf16_f32 v36, v28, v29
    ds_write_addtid_b32 v36 offset:4752
    v_pk_mul_f32 v[32:33], v[104:105], v[22:23] op_sel:[0,0] op_sel_hi:[0,1]
    v_pk_fma_f32 v[106:107], v[104:105], v[22:23], v[32:33] op_sel:[1,1,0] op_sel_hi:[1,0,1] neg_lo:[0,1,0]
    v_cvt_pk_bf16_f32 v12, v106, v107
    ds_write_addtid_b32 v12 offset:19008
    v_pk_mul_f32 v[30:31], v[28:29], v[24:25] op_sel:[0,0] op_sel_hi:[0,1]
    v_pk_fma_f32 v[28:29], v[28:29], v[24:25], v[30:31] op_sel:[1,1,0] op_sel_hi:[1,0,1] neg_lo:[0,1,0]
    v_cvt_pk_bf16_f32 v34, v28, v29
    ds_write_addtid_b32 v34 offset:5280
    v_pk_mul_f32 v[32:33], v[106:107], v[22:23] op_sel:[0,0] op_sel_hi:[0,1]
    v_pk_fma_f32 v[108:109], v[106:107], v[22:23], v[32:33] op_sel:[1,1,0] op_sel_hi:[1,0,1] neg_lo:[0,1,0]
    v_cvt_pk_bf16_f32 v13, v108, v109
    ds_write_addtid_b32 v13 offset:19536
    v_pk_mul_f32 v[30:31], v[28:29], v[24:25] op_sel:[0,0] op_sel_hi:[0,1]
    v_pk_fma_f32 v[28:29], v[28:29], v[24:25], v[30:31] op_sel:[1,1,0] op_sel_hi:[1,0,1] neg_lo:[0,1,0]
    v_cvt_pk_bf16_f32 v36, v28, v29
    ds_write_addtid_b32 v36 offset:5808
    v_pk_mul_f32 v[32:33], v[108:109], v[22:23] op_sel:[0,0] op_sel_hi:[0,1]
    v_pk_fma_f32 v[110:111], v[108:109], v[22:23], v[32:33] op_sel:[1,1,0] op_sel_hi:[1,0,1] neg_lo:[0,1,0]
    v_cvt_pk_bf16_f32 v14, v110, v111
    ds_write_addtid_b32 v14 offset:20064
    v_pk_mul_f32 v[30:31], v[28:29], v[24:25] op_sel:[0,0] op_sel_hi:[0,1]
    v_pk_fma_f32 v[28:29], v[28:29], v[24:25], v[30:31] op_sel:[1,1,0] op_sel_hi:[1,0,1] neg_lo:[0,1,0]
    v_cvt_pk_bf16_f32 v34, v28, v29
    ds_write_addtid_b32 v34 offset:6336
    v_pk_mul_f32 v[32:33], v[110:111], v[22:23] op_sel:[0,0] op_sel_hi:[0,1]
    v_pk_fma_f32 v[112:113], v[110:111], v[22:23], v[32:33] op_sel:[1,1,0] op_sel_hi:[1,0,1] neg_lo:[0,1,0]
    v_cvt_pk_bf16_f32 v35, v112, v113
    ds_write_addtid_b32 v35 offset:20592
    v_pk_mul_f32 v[30:31], v[28:29], v[24:25] op_sel:[0,0] op_sel_hi:[0,1]
    v_pk_fma_f32 v[28:29], v[28:29], v[24:25], v[30:31] op_sel:[1,1,0] op_sel_hi:[1,0,1] neg_lo:[0,1,0]
    v_cvt_pk_bf16_f32 v36, v28, v29
    ds_write_addtid_b32 v36 offset:6864
    v_pk_mul_f32 v[32:33], v[112:113], v[22:23] op_sel:[0,0] op_sel_hi:[0,1]
    v_pk_fma_f32 v[114:115], v[112:113], v[22:23], v[32:33] op_sel:[1,1,0] op_sel_hi:[1,0,1] neg_lo:[0,1,0]
    v_cvt_pk_bf16_f32 v37, v114, v115
    ds_write_addtid_b32 v37 offset:23232
    v_pk_mul_f32 v[30:31], v[28:29], v[24:25] op_sel:[0,0] op_sel_hi:[0,1]
    v_pk_fma_f32 v[28:29], v[28:29], v[24:25], v[30:31] op_sel:[1,1,0] op_sel_hi:[1,0,1] neg_lo:[0,1,0]
    v_cvt_pk_bf16_f32 v34, v28, v29
    ds_write_addtid_b32 v34 offset:7392
    v_pk_mul_f32 v[32:33], v[114:115], v[22:23] op_sel:[0,0] op_sel_hi:[0,1]
    v_pk_fma_f32 v[116:117], v[114:115], v[22:23], v[32:33] op_sel:[1,1,0] op_sel_hi:[1,0,1] neg_lo:[0,1,0]
    v_cvt_pk_bf16_f32 v35, v116, v117
    ds_write_addtid_b32 v35 offset:23760
    v_pk_mul_f32 v[30:31], v[28:29], v[24:25] op_sel:[0,0] op_sel_hi:[0,1]
    v_pk_fma_f32 v[28:29], v[28:29], v[24:25], v[30:31] op_sel:[1,1,0] op_sel_hi:[1,0,1] neg_lo:[0,1,0]
    v_cvt_pk_bf16_f32 v36, v28, v29
    ds_write_addtid_b32 v36 offset:7920
    v_pk_mul_f32 v[32:33], v[116:117], v[22:23] op_sel:[0,0] op_sel_hi:[0,1]
    v_pk_fma_f32 v[118:119], v[116:117], v[22:23], v[32:33] op_sel:[1,1,0] op_sel_hi:[1,0,1] neg_lo:[0,1,0]
    v_cvt_pk_bf16_f32 v37, v118, v119
    ds_write_addtid_b32 v37 offset:24288
    v_pk_mul_f32 v[30:31], v[28:29], v[24:25] op_sel:[0,0] op_sel_hi:[0,1]
    v_pk_fma_f32 v[28:29], v[28:29], v[24:25], v[30:31] op_sel:[1,1,0] op_sel_hi:[1,0,1] neg_lo:[0,1,0]
    v_cvt_pk_bf16_f32 v34, v28, v29
    ds_write_addtid_b32 v34 offset:8448
    v_pk_mul_f32 v[32:33], v[118:119], v[22:23] op_sel:[0,0] op_sel_hi:[0,1]
    v_pk_fma_f32 v[120:121], v[118:119], v[22:23], v[32:33] op_sel:[1,1,0] op_sel_hi:[1,0,1] neg_lo:[0,1,0]
    v_cvt_pk_bf16_f32 v35, v120, v121
    ds_write_addtid_b32 v35 offset:24816
    v_pk_mul_f32 v[30:31], v[28:29], v[24:25] op_sel:[0,0] op_sel_hi:[0,1]
    v_pk_fma_f32 v[28:29], v[28:29], v[24:25], v[30:31] op_sel:[1,1,0] op_sel_hi:[1,0,1] neg_lo:[0,1,0]
    v_cvt_pk_bf16_f32 v36, v28, v29
    ds_write_addtid_b32 v36 offset:8976
    v_pk_mul_f32 v[32:33], v[120:121], v[22:23] op_sel:[0,0] op_sel_hi:[0,1]
    v_pk_fma_f32 v[122:123], v[120:121], v[22:23], v[32:33] op_sel:[1,1,0] op_sel_hi:[1,0,1] neg_lo:[0,1,0]
    v_cvt_pk_bf16_f32 v37, v122, v123
    ds_write_addtid_b32 v37 offset:27456
    v_pk_mul_f32 v[30:31], v[28:29], v[24:25] op_sel:[0,0] op_sel_hi:[0,1]
    v_pk_fma_f32 v[28:29], v[28:29], v[24:25], v[30:31] op_sel:[1,1,0] op_sel_hi:[1,0,1] neg_lo:[0,1,0]
    v_cvt_pk_bf16_f32 v34, v28, v29
    ds_write_addtid_b32 v34 offset:9504
    v_pk_mul_f32 v[32:33], v[122:123], v[22:23] op_sel:[0,0] op_sel_hi:[0,1]
    v_pk_fma_f32 v[124:125], v[122:123], v[22:23], v[32:33] op_sel:[1,1,0] op_sel_hi:[1,0,1] neg_lo:[0,1,0]
    v_cvt_pk_bf16_f32 v35, v124, v125
    ds_write_addtid_b32 v35 offset:27984
    v_pk_mul_f32 v[30:31], v[28:29], v[24:25] op_sel:[0,0] op_sel_hi:[0,1]
    v_pk_fma_f32 v[28:29], v[28:29], v[24:25], v[30:31] op_sel:[1,1,0] op_sel_hi:[1,0,1] neg_lo:[0,1,0]
    v_cvt_pk_bf16_f32 v36, v28, v29
    ds_write_addtid_b32 v36 offset:10032
    v_pk_mul_f32 v[32:33], v[124:125], v[22:23] op_sel:[0,0] op_sel_hi:[0,1]
    v_pk_fma_f32 v[126:127], v[124:125], v[22:23], v[32:33] op_sel:[1,1,0] op_sel_hi:[1,0,1] neg_lo:[0,1,0]
    v_cvt_pk_bf16_f32 v37, v126, v127
    ds_write_addtid_b32 v37 offset:28512
    v_pk_mul_f32 v[30:31], v[28:29], v[24:25] op_sel:[0,0] op_sel_hi:[0,1]
    v_pk_fma_f32 v[28:29], v[28:29], v[24:25], v[30:31] op_sel:[1,1,0] op_sel_hi:[1,0,1] neg_lo:[0,1,0]
    v_cvt_pk_bf16_f32 v34, v28, v29
    ds_write_addtid_b32 v34 offset:10560
    v_pk_mul_f32 v[32:33], v[98:99], v[26:27] op_sel:[0,0] op_sel_hi:[0,1]
    v_pk_fma_f32 v[98:99], v[98:99], v[26:27], v[32:33] op_sel:[1,1,0] op_sel_hi:[1,0,1] neg_lo:[0,1,0]
    v_cvt_pk_bf16_f32 v35, v98, v99
    ds_write_addtid_b32 v35 offset:29568
    v_pk_mul_f32 v[30:31], v[28:29], v[24:25] op_sel:[0,0] op_sel_hi:[0,1]
    v_pk_fma_f32 v[28:29], v[28:29], v[24:25], v[30:31] op_sel:[1,1,0] op_sel_hi:[1,0,1] neg_lo:[0,1,0]
    v_cvt_pk_bf16_f32 v36, v28, v29
    ds_write_addtid_b32 v36 offset:11088
    v_pk_mul_f32 v[32:33], v[106:107], v[26:27] op_sel:[0,0] op_sel_hi:[0,1]
    v_pk_fma_f32 v[106:107], v[106:107], v[26:27], v[32:33] op_sel:[1,1,0] op_sel_hi:[1,0,1] neg_lo:[0,1,0]
    v_cvt_pk_bf16_f32 v37, v106, v107
    ds_write_addtid_b32 v37 offset:30096
    v_pk_mul_f32 v[30:31], v[28:29], v[24:25] op_sel:[0,0] op_sel_hi:[0,1]
    v_pk_fma_f32 v[28:29], v[28:29], v[24:25], v[30:31] op_sel:[1,1,0] op_sel_hi:[1,0,1] neg_lo:[0,1,0]
    v_cvt_pk_bf16_f32 v34, v28, v29
    ds_write_addtid_b32 v34 offset:11616
    v_pk_mul_f32 v[32:33], v[114:115], v[26:27] op_sel:[0,0] op_sel_hi:[0,1]
    v_pk_fma_f32 v[114:115], v[114:115], v[26:27], v[32:33] op_sel:[1,1,0] op_sel_hi:[1,0,1] neg_lo:[0,1,0]
    v_cvt_pk_bf16_f32 v35, v114, v115
    ds_write_addtid_b32 v35 offset:31680
    v_pk_mul_f32 v[30:31], v[28:29], v[24:25] op_sel:[0,0] op_sel_hi:[0,1]
    v_pk_fma_f32 v[28:29], v[28:29], v[24:25], v[30:31] op_sel:[1,1,0] op_sel_hi:[1,0,1] neg_lo:[0,1,0]
    v_cvt_pk_bf16_f32 v36, v28, v29
    ds_write_addtid_b32 v36 offset:12144
    v_pk_mul_f32 v[32:33], v[122:123], v[26:27] op_sel:[0,0] op_sel_hi:[0,1]
    v_pk_fma_f32 v[122:123], v[122:123], v[26:27], v[32:33] op_sel:[1,1,0] op_sel_hi:[1,0,1] neg_lo:[0,1,0]
    v_cvt_pk_bf16_f32 v37, v122, v123
    ds_write_addtid_b32 v37 offset:32208
    v_pk_mul_f32 v[30:31], v[28:29], v[24:25] op_sel:[0,0] op_sel_hi:[0,1]
    v_pk_fma_f32 v[28:29], v[28:29], v[24:25], v[30:31] op_sel:[1,1,0] op_sel_hi:[1,0,1] neg_lo:[0,1,0]
    v_cvt_pk_bf16_f32 v34, v28, v29
    ds_write_addtid_b32 v34 offset:12672
    v_pk_mul_f32 v[32:33], v[106:107], v[26:27] op_sel:[0,0] op_sel_hi:[0,1]
    v_pk_fma_f32 v[106:107], v[106:107], v[26:27], v[32:33] op_sel:[1,1,0] op_sel_hi:[1,0,1] neg_lo:[0,1,0]
    v_cvt_pk_bf16_f32 v35, v106, v107
    ds_write_addtid_b32 v35 offset:30624
    v_pk_mul_f32 v[30:31], v[28:29], v[24:25] op_sel:[0,0] op_sel_hi:[0,1]
    v_pk_fma_f32 v[28:29], v[28:29], v[24:25], v[30:31] op_sel:[1,1,0] op_sel_hi:[1,0,1] neg_lo:[0,1,0]
    v_cvt_pk_bf16_f32 v36, v28, v29
    ds_write_addtid_b32 v36 offset:13200
    v_pk_mul_f32 v[32:33], v[122:123], v[26:27] op_sel:[0,0] op_sel_hi:[0,1]
    v_pk_fma_f32 v[122:123], v[122:123], v[26:27], v[32:33] op_sel:[1,1,0] op_sel_hi:[1,0,1] neg_lo:[0,1,0]
    v_cvt_pk_bf16_f32 v37, v122, v123
    ds_write_addtid_b32 v37 offset:31152
    v_pk_mul_f32 v[30:31], v[28:29], v[24:25] op_sel:[0,0] op_sel_hi:[0,1]
    v_pk_fma_f32 v[28:29], v[28:29], v[24:25], v[30:31] op_sel:[1,1,0] op_sel_hi:[1,0,1] neg_lo:[0,1,0]
    v_cvt_pk_bf16_f32 v34, v28, v29
    ds_write_addtid_b32 v34 offset:13728
    v_pk_mul_f32 v[32:33], v[106:107], v[26:27] op_sel:[0,0] op_sel_hi:[0,1]
    v_pk_fma_f32 v[106:107], v[106:107], v[26:27], v[32:33] op_sel:[1,1,0] op_sel_hi:[1,0,1] neg_lo:[0,1,0]
    v_cvt_pk_bf16_f32 v35, v106, v107
    ds_write_addtid_b32 v35 offset:32736
    v_pk_mul_f32 v[30:31], v[28:29], v[24:25] op_sel:[0,0] op_sel_hi:[0,1]
    v_pk_fma_f32 v[28:29], v[28:29], v[24:25], v[30:31] op_sel:[1,1,0] op_sel_hi:[1,0,1] neg_lo:[0,1,0]
    v_cvt_pk_bf16_f32 v36, v28, v29
    ds_write_addtid_b32 v36 offset:14256
    v_pk_mul_f32 v[32:33], v[122:123], v[26:27] op_sel:[0,0] op_sel_hi:[0,1]
    v_pk_fma_f32 v[122:123], v[122:123], v[26:27], v[32:33] op_sel:[1,1,0] op_sel_hi:[1,0,1] neg_lo:[0,1,0]
    v_cvt_pk_bf16_f32 v37, v122, v123
    ds_write_addtid_b32 v37 offset:33264
    v_pk_mul_f32 v[30:31], v[28:29], v[24:25] op_sel:[0,0] op_sel_hi:[0,1]
    v_pk_fma_f32 v[28:29], v[28:29], v[24:25], v[30:31] op_sel:[1,1,0] op_sel_hi:[1,0,1] neg_lo:[0,1,0]
    v_cvt_pk_bf16_f32 v34, v28, v29
    ds_write_addtid_b32 v34 offset:14784
    v_pk_mul_f32 v[30:31], v[28:29], v[24:25] op_sel:[0,0] op_sel_hi:[0,1]
    v_pk_fma_f32 v[28:29], v[28:29], v[24:25], v[30:31] op_sel:[1,1,0] op_sel_hi:[1,0,1] neg_lo:[0,1,0]
    v_cvt_pk_bf16_f32 v36, v28, v29
    ds_write_addtid_b32 v36 offset:15312
    v_pk_mul_f32 v[30:31], v[28:29], v[24:25] op_sel:[0,0] op_sel_hi:[0,1]
    v_pk_fma_f32 v[28:29], v[28:29], v[24:25], v[30:31] op_sel:[1,1,0] op_sel_hi:[1,0,1] neg_lo:[0,1,0]
    v_cvt_pk_bf16_f32 v34, v28, v29
    ds_write_addtid_b32 v34 offset:15840
    v_pk_mul_f32 v[30:31], v[28:29], v[24:25] op_sel:[0,0] op_sel_hi:[0,1]
    v_pk_fma_f32 v[28:29], v[28:29], v[24:25], v[30:31] op_sel:[1,1,0] op_sel_hi:[1,0,1] neg_lo:[0,1,0]
    v_cvt_pk_bf16_f32 v36, v28, v29
    ds_write_addtid_b32 v36 offset:16368
    ds_write_addtid_b32 v12 offset:25344
    ds_write_addtid_b32 v13 offset:25872
    ds_write_addtid_b32 v14 offset:26400
    s_cmp_eq_u32 s52, 0
    s_cbranch_scc0 L_helper
    s_setprio 2
    s_waitcnt lgkmcnt(0)
    s_barrier
    ds_read_b128 v[128:131], v78 offset:16896
    ds_read_b128 v[132:135], v78 offset:0
    ds_read_b128 v[136:139], v78 offset:16912
    ds_read_b128 v[140:143], v78 offset:16
    ds_read_b128 v[144:147], v78 offset:16928
    ds_read_b128 v[148:151], v78 offset:32
    ds_read_b128 v[152:155], v78 offset:16944
    ds_read_b128 v[156:159], v78 offset:48
    ds_read_b128 v[160:163], v78 offset:16960
    ds_read_b128 v[164:167], v78 offset:64
    ds_read_b128 v[168:171], v78 offset:16976
    ds_read_b128 v[172:175], v78 offset:80
    v_add_u32 v74, -1, v2
    s_waitcnt vmcnt(0)
    v_and_b32 v71, v71, v74
    v_mul_f32 v71, 0x44800000, v71
    v_and_b32 v10, 3, v8
    v_add_u32 v5, 1, v10
    s_waitcnt lgkmcnt(10)
    v_mfma_f32_32x32x16_bf16 v[48:63], v[128:131], v[132:135], 0
    ds_read_b128 v[176:179], v78 offset:16992
    ds_read_b128 v[180:183], v78 offset:96
    v_mul_u32_u24 v10, 1214, v10
    s_waitcnt lgkmcnt(10)
    v_mfma_f32_32x32x16_bf16 v[48:63], v[136:139], v[140:143], v[48:63]
    ds_read_b128 v[184:187], v78 offset:17008
    ds_read_b128 v[188:191], v78 offset:112
    v_lshl_add_u32 v11, v8, 1, v9
    s_waitcnt lgkmcnt(10)
    v_mfma_f32_32x32x16_bf16 v[48:63], v[144:147], v[148:151], v[48:63]
    ds_read_b128 v[192:195], v78 offset:17024
    ds_read_b128 v[196:199], v78 offset:128
    v_mul_u32_u24 v4, 17, v9
    s_waitcnt lgkmcnt(10)
    v_mfma_f32_32x32x16_bf16 v[48:63], v[152:155], v[156:159], v[48:63]
    ds_read_b128 v[200:203], v78 offset:17040
    ds_read_b128 v[204:207], v78 offset:144
    v_sub_u32 v4, v4, v11
    s_waitcnt lgkmcnt(10)
    v_mfma_f32_32x32x16_bf16 v[48:63], v[160:163], v[164:167], v[48:63]
    ds_read_b128 v[208:211], v78 offset:17056
    ds_read_b128 v[212:215], v78 offset:160
    v_and_b32 v5, 4, v5
    s_waitcnt lgkmcnt(10)
    v_mfma_f32_32x32x16_bf16 v[48:63], v[168:171], v[172:175], v[48:63]
    ds_read_b128 v[216:219], v78 offset:17072
    ds_read_b128 v[220:223], v78 offset:176
    s_add_u32 s43, s55, 3680
    s_waitcnt lgkmcnt(10)
    v_mfma_f32_32x32x16_bf16 v[48:63], v[176:179], v[180:183], v[48:63]
    ds_read_b128 v[224:227], v78 offset:17088
    ds_read_b128 v[228:231], v78 offset:192
    v_lshl_add_u32 v10, v5, 1, v10
    s_waitcnt lgkmcnt(10)
    v_mfma_f32_32x32x16_bf16 v[48:63], v[184:187], v[188:191], v[48:63]
    ds_read_b128 v[232:235], v78 offset:17104
    ds_read_b128 v[236:239], v78 offset:208
    v_sub_u32 v10, v4, v10
    s_waitcnt lgkmcnt(10)
    v_mfma_f32_32x32x16_bf16 v[48:63], v[192:195], v[196:199], v[48:63]
    ds_read_b128 v[240:243], v78 offset:17120
    ds_read_b128 v[244:247], v78 offset:224
    v_add_u32 v10, s43, v10
    s_waitcnt lgkmcnt(10)
    v_mfma_f32_32x32x16_bf16 v[48:63], v[200:203], v[204:207], v[48:63]
    ds_read_b128 v[248:251], v78 offset:17136
    ds_read_b128 v[252:255], v78 offset:240
    v_lshl_add_u32 v11, v11, 4, s63
    s_waitcnt lgkmcnt(10)
    v_mfma_f32_32x32x16_bf16 v[48:63], v[208:211], v[212:215], v[48:63]
    s_add_u32 s43, s55, 5116
    s_waitcnt lgkmcnt(8)
    v_mfma_f32_32x32x16_bf16 v[48:63], v[216:219], v[220:223], v[48:63]
    v_lshrrev_b32 v75, 2, v3
    s_waitcnt lgkmcnt(6)
    v_mfma_f32_32x32x16_bf16 v[48:63], v[224:227], v[228:231], v[48:63]
    v_sub_u32 v75, s43, v75
    s_waitcnt lgkmcnt(4)
    v_mfma_f32_32x32x16_bf16 v[48:63], v[232:235], v[236:239], v[48:63]
    v_lshl_add_u32 v7, v9, 6, v3
    s_waitcnt lgkmcnt(2)
    v_mfma_f32_32x32x16_bf16 v[48:63], v[240:243], v[244:247], v[48:63]
    v_add_u32 v7, s55, v7
    s_waitcnt lgkmcnt(0)
    v_mfma_f32_32x32x16_bf16 v[48:63], v[248:251], v[252:255], v[48:63]
    v_lshlrev_b32 v4, 2, v9
    ds_write_b128 v83, v[84:87]
    v_sub_u32 v4, v4, v8
    s_add_u32 s43, s55, 5304
    v_lshl_add_u32 v89, v4, 3, s43
    s_add_u32 s43, s55, 4924
    v_lshl_add_u32 v4, v4, 2, s43
    s_lshl_b32 s43, s51, 2
    s_add_u32 s43, s43, 153728
    v_mov_b32 v88, s43
    v_add_u32 v5, 154048, v3
    s_nop 0
    v_add_f32 v48, v48, v71
    v_bitop3_b32 v49, v79, v48, v49 bitop3:0xca
    v_bitop3_b32 v51, v79, v52, v51 bitop3:0xca
    v_bitop3_b32 v53, v79, v52, v53 bitop3:0xca
    v_bitop3_b32 v55, v79, v56, v55 bitop3:0xca
    v_cvt_pk_bf16_f32 v128, v55, v54
    v_cvt_pk_bf16_f32 v129, v53, v52
    v_cvt_pk_bf16_f32 v130, v51, v50
    v_cvt_pk_bf16_f32 v131, v49, v48
    ds_write_b128 v81, v[128:131] offset:0
    v_bitop3_b32 v57, v80, v56, v57 bitop3:0xca
    v_bitop3_b32 v58, v82, v56, v58 bitop3:0xca
    v_cvt_pk_bf16_f32 v132, v56, v55
    v_cvt_pk_bf16_f32 v133, v54, v53
    v_cvt_pk_bf16_f32 v134, v52, v51
    v_cvt_pk_bf16_f32 v135, v50, v49
    ds_write_b128 v81, v[132:135] offset:3648
    v_readlane_b32 s42, v130, 0
    v_readlane_b32 s43, v131, 0
    v_readlane_b32 s58, v128, 63
    v_cvt_pk_bf16_f32 v136, v57, v56
    v_cvt_pk_bf16_f32 v137, v55, v54
    v_cvt_pk_bf16_f32 v138, v53, v52
    v_cvt_pk_bf16_f32 v139, v51, v50
    ds_write_b128 v81, v[136:139] offset:2432
    s_pack_lh_b32_b16 s42, s58, s42
    v_mov_b32 v71, s42
    v_perm_b32 v71, v71, s43, v72
    v_cvt_pk_bf16_f32 v140, v58, v57
    v_cvt_pk_bf16_f32 v141, v56, v55
    v_cvt_pk_bf16_f32 v142, v54, v53
    v_cvt_pk_bf16_f32 v143, v52, v51
    ds_write_b128 v81, v[140:143] offset:1216
    ds_write_b16 v73, v71
    v_cvt_pk_bf16_f32 v72, v61, v60
    v_cvt_pk_bf16_f32 v74, v63, v62
    ds_write_b32 v77, v72
    v_readlane_b32 s59, v72, 63
    ds_write_b32 v75, v74
    s_and_b32 s59, s59, 0xffff
    s_cmp_lt_u32 s39, 2
    s_cbranch_scc0 L_ct3
    global_load_dword v1, v76, s[56:57]
L_ct3:
    ds_read_b64 v[220:221], v10 offset:576
    ds_read_b64 v[222:223], v10 offset:584
    ds_read_b64 v[252:253], v10 offset:64
    ds_read_b64 v[254:255], v10 offset:72
    ds_read_b64 v[216:217], v10 offset:640
    ds_read_b64 v[218:219], v10 offset:648
    ds_read_b64 v[248:249], v10 offset:128
    ds_read_b64 v[250:251], v10 offset:136
    ds_read_b64 v[212:213], v10 offset:704
    ds_read_b64 v[214:215], v10 offset:712
    ds_read_b64 v[244:245], v10 offset:192
    ds_read_b64 v[246:247], v10 offset:200
    ds_read_b64 v[208:209], v10 offset:768
    ds_read_b64 v[210:211], v10 offset:776
    ds_read_b64 v[240:241], v10 offset:256
    ds_read_b64 v[242:243], v10 offset:264
    ds_read_b64 v[204:205], v10 offset:832
    ds_read_b64 v[206:207], v10 offset:840
    ds_read_b64 v[236:237], v10 offset:320
    ds_read_b64 v[238:239], v10 offset:328
    ds_read_b64 v[200:201], v10 offset:896
    ds_read_b64 v[202:203], v10 offset:904
    ds_read_b64 v[232:233], v10 offset:384
    ds_read_b64 v[234:235], v10 offset:392
    ds_read_b64 v[196:197], v10 offset:960
    ds_read_b64 v[198:199], v10 offset:968
    ds_read_b64 v[228:229], v10 offset:448
    ds_read_b64 v[230:231], v10 offset:456
    ds_read_b64 v[192:193], v10 offset:1024
    ds_read_b64 v[194:195], v10 offset:1032
    ds_read_b64 v[224:225], v10 offset:512
    ds_read_b64 v[226:227], v10 offset:520
    s_waitcnt lgkmcnt(6)
    s_barrier
    s_setprio 1
    ds_read_b128 v[68:71], v11 offset:0
    ds_read_b128 v[72:75], v11 offset:64
    ds_read_b128 v[76:79], v11 offset:128
    ds_read_b128 v[80:83], v11 offset:192
    ds_read_b128 v[16:19], v5 offset:0
    ds_read_b128 v[84:87], v11 offset:256
    ds_read_b128 v[132:135], v11 offset:320
    s_waitcnt lgkmcnt(6)
    v_mfma_f32_16x16x32_bf16 v[44:47], v[220:223], v[68:71], 0
    v_mfma_f32_16x16x32_bf16 v[48:51], v[252:255], v[68:71], 0
    ds_read_b128 v[68:71], v11 offset:384
    s_waitcnt lgkmcnt(5)
    v_mfma_f32_16x16x32_bf16 v[44:47], v[216:219], v[72:75], v[44:47]
    v_mfma_f32_16x16x32_bf16 v[48:51], v[248:251], v[72:75], v[48:51]
    ds_read_b128 v[72:75], v11 offset:448
    v_mfma_f32_16x16x32_bf16 v[44:47], v[212:215], v[76:79], v[44:47]
    ds_read_b128 v[28:31], v5 offset:1024
    v_mfma_f32_16x16x32_bf16 v[48:51], v[244:247], v[76:79], v[48:51]
    ds_read_b128 v[32:35], v5 offset:2048
    ds_read_b128 v[36:39], v5 offset:3072
    s_waitcnt lgkmcnt(6)
    v_mfma_f32_16x16x32_bf16 v[44:47], v[208:211], v[80:83], v[44:47]
    ds_read_b128 v[20:23], v5 offset:4096
    ds_read_b128 v[24:27], v5 offset:5120
    v_mfma_f32_16x16x32_bf16 v[48:51], v[240:243], v[80:83], v[48:51]
    ds_read_b64 v[12:13], v10 offset:0
    v_lshrrev_b32 v16, 7, v16
    v_mfma_f32_16x16x32_bf16 v[44:47], v[204:207], v[84:87], v[44:47]
    ds_read_b64 v[14:15], v10 offset:8
    v_and_b32 v16, 0x10001, v16
    v_mfma_f32_16x16x32_bf16 v[48:51], v[236:239], v[84:87], v[48:51]
    ds_read_b128 v[76:79], v11 offset:432
    s_waitcnt lgkmcnt(9)
    v_mfma_f32_16x16x32_bf16 v[44:47], v[200:203], v[132:135], v[44:47]
    ds_read_b128 v[80:83], v11 offset:512
    v_mul_u32_u24 v16, s59, v16
    v_mfma_f32_16x16x32_bf16 v[48:51], v[232:235], v[132:135], v[48:51]
    ds_read_b128 v[84:87], v11 offset:576
    v_lshrrev_b32 v17, 7, v17
    v_mfma_f32_16x16x32_bf16 v[44:47], v[196:199], v[68:71], v[44:47]
    v_and_b32 v17, 0x10001, v17
    v_mfma_f32_16x16x32_bf16 v[48:51], v[228:231], v[68:71], v[48:51]
    s_waitcnt lgkmcnt(10)
    v_mul_u32_u24 v17, s59, v17
    v_mfma_f32_16x16x32_bf16 v[44:47], v[192:195], v[72:75], v[44:47]
    ds_read_b128 v[132:135], v11 offset:640
    v_lshrrev_b32 v18, 7, v18
    v_mfma_f32_16x16x32_bf16 v[48:51], v[224:227], v[72:75], v[48:51]
    s_waitcnt lgkmcnt(6)
    v_and_b32 v18, 0x10001, v18
    v_mfma_f32_16x16x32_bf16 v[108:111], v[72:75], v[28:31], 0
    ds_read_b128 v[68:71], v11 offset:704
    v_mul_u32_u24 v18, s59, v18
    v_mfma_f32_16x16x32_bf16 v[112:115], v[72:75], v[32:35], 0
    s_waitcnt lgkmcnt(5)
    v_lshrrev_b32 v19, 7, v19
    v_mfma_f32_16x16x32_bf16 v[52:55], v[12:15], v[72:75], 0
    v_and_b32 v19, 0x10001, v19
    v_mfma_f32_16x16x32_bf16 v[116:119], v[72:75], v[36:39], 0
    ds_write_b128 v7, v[44:47] offset:9472
    v_mfma_f32_16x16x32_bf16 v[124:127], v[72:75], v[20:23], 0
    v_mul_u32_u24 v19, s59, v19
    s_nop 1
    v_mfma_f32_16x16x32_bf16 v[60:63], v[16:19], v[72:75], 0
    ds_read_b128 v[72:75], v11 offset:768
    s_waitcnt lgkmcnt(5)
    v_mfma_f32_16x16x32_bf16 v[120:123], v[76:79], v[32:35], 0
    ds_write_b32 v88, v88 offset:0
    v_mfma_f32_16x16x32_bf16 v[128:131], v[76:79], v[24:27], 0
    ds_read_b128 v[76:79], v11 offset:832
    v_mfma_f32_16x16x32_bf16 v[48:51], v[220:223], v[80:83], v[48:51]
    v_mfma_f32_16x16x32_bf16 v[52:55], v[252:255], v[80:83], v[52:55]
    ds_read_b128 v[80:83], v11 offset:896
    s_waitcnt lgkmcnt(6)
    v_mfma_f32_16x16x32_bf16 v[48:51], v[216:219], v[84:87], v[48:51]
    v_mfma_f32_16x16x32_bf16 v[52:55], v[248:251], v[84:87], v[52:55]
    ds_read_b128 v[84:87], v11 offset:960
    v_cvt_pk_bf16_f32 v136, v120, v116
    v_mfma_f32_16x16x32_bf16 v[48:51], v[212:215], v[132:135], v[48:51]
    v_cvt_pk_bf16_f32 v137, v112, v108
    v_mfma_f32_16x16x32_bf16 v[52:55], v[244:247], v[132:135], v[52:55]
    s_waitcnt lgkmcnt(4)
    v_cvt_pk_bf16_f32 v138, v121, v117
    v_mfma_f32_16x16x32_bf16 v[48:51], v[208:211], v[68:71], v[48:51]
    v_cvt_pk_bf16_f32 v139, v113, v109
    v_mfma_f32_16x16x32_bf16 v[52:55], v[240:243], v[68:71], v[52:55]
    ds_read_b128 v[132:135], v11 offset:944
    v_cvt_pk_bf16_f32 v140, v122, v118
    v_mfma_f32_16x16x32_bf16 v[48:51], v[204:207], v[72:75], v[48:51]
    v_cvt_pk_bf16_f32 v141, v114, v110
    v_mfma_f32_16x16x32_bf16 v[52:55], v[236:239], v[72:75], v[52:55]
    ds_read_b128 v[68:71], v11 offset:1024
    s_waitcnt lgkmcnt(3)
    v_mfma_f32_16x16x32_bf16 v[48:51], v[200:203], v[76:79], v[48:51]
    v_cvt_pk_bf16_f32 v142, v123, v119
    v_mfma_f32_16x16x32_bf16 v[52:55], v[232:235], v[76:79], v[52:55]
    ds_read_b64 v[168:169], v89 offset:256
    v_cvt_pk_bf16_f32 v143, v115, v111
    v_mfma_f32_16x16x32_bf16 v[48:51], v[196:199], v[80:83], v[48:51]
    ds_read_b64 v[170:171], v89 offset:264
    v_cvt_pk_bf16_f32 v92, v128, v124
    v_mfma_f32_16x16x32_bf16 v[52:55], v[228:231], v[80:83], v[52:55]
    ds_read_b128 v[72:75], v11 offset:1088
    s_waitcnt lgkmcnt(5)
    v_mfma_f32_16x16x32_bf16 v[48:51], v[192:195], v[84:87], v[48:51]
    ds_read_b64 v[172:173], v89 offset:272
    v_cvt_pk_bf16_f32 v93, v129, v125
    v_mfma_f32_16x16x32_bf16 v[52:55], v[224:227], v[84:87], v[52:55]
    ds_read_b64 v[174:175], v89 offset:280
    v_cvt_pk_bf16_f32 v94, v130, v126
    v_mfma_f32_16x16x32_bf16 v[108:111], v[84:87], v[28:31], 0
    ds_read_b128 v[76:79], v11 offset:1152
    v_cvt_pk_bf16_f32 v95, v131, v127
    v_mfma_f32_16x16x32_bf16 v[112:115], v[84:87], v[32:35], 0
    v_mfma_f32_16x16x32_bf16 v[56:59], v[12:15], v[84:87], 0
    ds_read_b128 v[80:83], v11 offset:1216
    v_mfma_f32_16x16x32_bf16 v[116:119], v[84:87], v[36:39], 0
    ds_write_b128 v7, v[48:51] offset:10752
    v_mfma_f32_16x16x32_bf16 v[124:127], v[84:87], v[20:23], 0
    v_mfma_f32_16x16x32_bf16 v[64:67], v[16:19], v[84:87], 0
    ds_read_b128 v[84:87], v11 offset:1280
    s_waitcnt lgkmcnt(9)
    v_mfma_f32_16x16x32_bf16 v[120:123], v[132:135], v[32:35], 0
    ds_write_b32 v88, v88 offset:16
    v_mfma_f32_16x16x32_bf16 v[128:131], v[132:135], v[24:27], 0
    ds_read_b128 v[132:135], v11 offset:1344
    v_mfma_f32_16x16x32_bf16 v[52:55], v[220:223], v[68:71], v[52:55]
    v_mfma_f32_16x16x32_bf16 v[56:59], v[252:255], v[68:71], v[56:59]
    ds_read_b128 v[68:71], v11 offset:1408
    s_waitcnt lgkmcnt(7)
    v_mfma_f32_16x16x32_bf16 v[52:55], v[136:139], v[168:171], v[52:55]
    v_mfma_f32_16x16x32_bf16 v[52:55], v[216:219], v[72:75], v[52:55]
    v_mfma_f32_16x16x32_bf16 v[56:59], v[248:251], v[72:75], v[56:59]
    ds_read_b128 v[72:75], v11 offset:1472
    v_mfma_f32_16x16x32_bf16 v[52:55], v[140:143], v[172:175], v[52:55]
    s_waitcnt lgkmcnt(6)
    v_cvt_pk_bf16_f32 v144, v120, v116
    v_mfma_f32_16x16x32_bf16 v[52:55], v[212:215], v[76:79], v[52:55]
    v_cvt_pk_bf16_f32 v145, v112, v108
    v_mfma_f32_16x16x32_bf16 v[56:59], v[244:247], v[76:79], v[56:59]
    v_cvt_pk_bf16_f32 v146, v121, v117
    v_mfma_f32_16x16x32_bf16 v[52:55], v[208:211], v[80:83], v[52:55]
    v_cvt_pk_bf16_f32 v147, v113, v109
    v_mfma_f32_16x16x32_bf16 v[56:59], v[240:243], v[80:83], v[56:59]
    ds_read_b128 v[76:79], v11 offset:1456
    s_waitcnt lgkmcnt(3)
    v_mfma_f32_16x16x32_bf16 v[52:55], v[204:207], v[84:87], v[52:55]
    v_cvt_pk_bf16_f32 v148, v122, v118
    v_mfma_f32_16x16x32_bf16 v[56:59], v[236:239], v[84:87], v[56:59]
    ds_read_b128 v[80:83], v11 offset:1536
    v_cvt_pk_bf16_f32 v149, v114, v110
    v_mfma_f32_16x16x32_bf16 v[52:55], v[200:203], v[132:135], v[52:55]
    v_cvt_pk_bf16_f32 v150, v123, v119
    v_mfma_f32_16x16x32_bf16 v[56:59], v[232:235], v[132:135], v[56:59]
    ds_read_b64 v[176:177], v89 offset:128
    s_waitcnt lgkmcnt(3)
    v_mfma_f32_16x16x32_bf16 v[52:55], v[196:199], v[68:71], v[52:55]
    ds_read_b64 v[178:179], v89 offset:136
    v_cvt_pk_bf16_f32 v151, v115, v111
    v_mfma_f32_16x16x32_bf16 v[56:59], v[228:231], v[68:71], v[56:59]
    ds_read_b128 v[84:87], v11 offset:1600
    v_cvt_pk_bf16_f32 v96, v128, v124
    v_mfma_f32_16x16x32_bf16 v[52:55], v[192:195], v[72:75], v[52:55]
    ds_read_b64 v[180:181], v89 offset:144
    v_cvt_pk_bf16_f32 v97, v129, v125
    v_mfma_f32_16x16x32_bf16 v[56:59], v[224:227], v[72:75], v[56:59]
    ds_read_b64 v[182:183], v89 offset:152
    v_cvt_pk_bf16_f32 v98, v130, v126
    v_mfma_f32_16x16x32_bf16 v[108:111], v[72:75], v[28:31], 0
    ds_read_b128 v[132:135], v11 offset:1664
    v_cvt_pk_bf16_f32 v99, v131, v127
    v_mfma_f32_16x16x32_bf16 v[112:115], v[72:75], v[32:35], 0
    v_mfma_f32_16x16x32_bf16 v[60:63], v[12:15], v[72:75], v[60:63]
    v_mfma_f32_16x16x32_bf16 v[116:119], v[72:75], v[36:39], 0
    ds_read_b128 v[68:71], v11 offset:1728
    ds_write_b128 v7, v[52:55] offset:12032
    v_mfma_f32_16x16x32_bf16 v[124:127], v[72:75], v[20:23], 0
    v_mfma_f32_16x16x32_bf16 v[44:47], v[16:19], v[72:75], 0
    ds_read_b128 v[72:75], v11 offset:1792
    s_waitcnt lgkmcnt(9)
    v_mfma_f32_16x16x32_bf16 v[120:123], v[76:79], v[32:35], 0
    ds_write_b32 v88, v88 offset:32
    v_mfma_f32_16x16x32_bf16 v[128:131], v[76:79], v[24:27], 0
    ds_read_b128 v[76:79], v11 offset:1856
    v_mfma_f32_16x16x32_bf16 v[56:59], v[220:223], v[80:83], v[56:59]
    v_mfma_f32_16x16x32_bf16 v[60:63], v[252:255], v[80:83], v[60:63]
    ds_read_b128 v[80:83], v11 offset:1920
    s_waitcnt lgkmcnt(7)
    v_mfma_f32_16x16x32_bf16 v[56:59], v[136:139], v[176:179], v[56:59]
    v_mfma_f32_16x16x32_bf16 v[56:59], v[216:219], v[84:87], v[56:59]
    v_mfma_f32_16x16x32_bf16 v[60:63], v[248:251], v[84:87], v[60:63]
    ds_read_b128 v[84:87], v11 offset:1984
    v_mfma_f32_16x16x32_bf16 v[56:59], v[140:143], v[180:183], v[56:59]
    s_waitcnt lgkmcnt(6)
    v_cvt_pk_bf16_f32 v152, v120, v116
    v_mfma_f32_16x16x32_bf16 v[56:59], v[212:215], v[132:135], v[56:59]
    v_cvt_pk_bf16_f32 v153, v112, v108
    v_mfma_f32_16x16x32_bf16 v[60:63], v[244:247], v[132:135], v[60:63]
    v_cvt_pk_bf16_f32 v154, v121, v117
    v_mfma_f32_16x16x32_bf16 v[56:59], v[144:147], v[168:171], v[56:59]
    v_cvt_pk_bf16_f32 v155, v113, v109
    v_mfma_f32_16x16x32_bf16 v[56:59], v[208:211], v[68:71], v[56:59]
    v_cvt_pk_bf16_f32 v156, v122, v118
    v_mfma_f32_16x16x32_bf16 v[60:63], v[240:243], v[68:71], v[60:63]
    v_cvt_pk_bf16_f32 v157, v114, v110
    v_mfma_f32_16x16x32_bf16 v[56:59], v[148:151], v[172:175], v[56:59]
    ds_read_b128 v[132:135], v11 offset:1968
    s_waitcnt lgkmcnt(3)
    v_mfma_f32_16x16x32_bf16 v[56:59], v[204:207], v[72:75], v[56:59]
    v_cvt_pk_bf16_f32 v158, v123, v119
    v_mfma_f32_16x16x32_bf16 v[60:63], v[236:239], v[72:75], v[60:63]
    ds_read_b128 v[68:71], v11 offset:2048
    v_cvt_pk_bf16_f32 v159, v115, v111
    v_mfma_f32_16x16x32_bf16 v[56:59], v[200:203], v[76:79], v[56:59]
    v_cvt_pk_bf16_f32 v100, v128, v124
    v_mfma_f32_16x16x32_bf16 v[60:63], v[232:235], v[76:79], v[60:63]
    ds_read2_b32 v[40:41], v4 offset0:48 offset1:49
    s_waitcnt lgkmcnt(3)
    v_mfma_f32_16x16x32_bf16 v[56:59], v[196:199], v[80:83], v[56:59]
    ds_read2_b32 v[42:43], v4 offset0:50 offset1:51
    v_cvt_pk_bf16_f32 v101, v129, v125
    v_mfma_f32_16x16x32_bf16 v[60:63], v[228:231], v[80:83], v[60:63]
    ds_read_b128 v[72:75], v11 offset:2112
    v_cvt_pk_bf16_f32 v102, v130, v126
    v_mfma_f32_16x16x32_bf16 v[56:59], v[192:195], v[84:87], v[56:59]
    ds_read_b64 v[184:185], v89 offset:0
    v_cvt_pk_bf16_f32 v103, v131, v127
    v_mfma_f32_16x16x32_bf16 v[60:63], v[224:227], v[84:87], v[60:63]
    ds_read_b64 v[186:187], v89 offset:8
    v_mfma_f32_16x16x32_bf16 v[108:111], v[84:87], v[28:31], 0
    ds_read_b128 v[76:79], v11 offset:2176
    v_mfma_f32_16x16x32_bf16 v[112:115], v[84:87], v[32:35], 0
    v_mfma_f32_16x16x32_bf16 v[64:67], v[12:15], v[84:87], v[64:67]
    ds_read_b64 v[188:189], v89 offset:16
    v_mfma_f32_16x16x32_bf16 v[116:119], v[84:87], v[36:39], 0
    ds_read_b64 v[190:191], v89 offset:24
    ds_write_b128 v7, v[56:59] offset:13312
    v_mfma_f32_16x16x32_bf16 v[124:127], v[84:87], v[20:23], 0
    ds_read_b128 v[80:83], v11 offset:2240
    v_mfma_f32_16x16x32_bf16 v[48:51], v[16:19], v[84:87], 0
    ds_read_b128 v[84:87], v11 offset:2304
    s_waitcnt lgkmcnt(11)
    v_mfma_f32_16x16x32_bf16 v[120:123], v[132:135], v[32:35], 0
    ds_write_b32 v88, v88 offset:48
    v_mfma_f32_16x16x32_bf16 v[128:131], v[132:135], v[24:27], 0
    ds_read_b128 v[132:135], v11 offset:2368
    v_mfma_f32_16x16x32_bf16 v[60:63], v[220:223], v[68:71], v[60:63]
    v_mfma_f32_16x16x32_bf16 v[64:67], v[252:255], v[68:71], v[64:67]
    s_waitcnt lgkmcnt(8)
    v_mfma_f32_16x16x32_bf16 v[60:63], v[92:95], v[40:43], v[60:63]
    ds_read_b128 v[68:71], v11 offset:2432
    v_mfma_f32_16x16x32_bf16 v[60:63], v[216:219], v[72:75], v[60:63]
    v_mfma_f32_16x16x32_bf16 v[64:67], v[248:251], v[72:75], v[64:67]
    v_mfma_f32_16x16x32_bf16 v[60:63], v[136:139], v[184:187], v[60:63]
    ds_read_b128 v[72:75], v11 offset:2496
    s_waitcnt lgkmcnt(5)
    v_mfma_f32_16x16x32_bf16 v[60:63], v[212:215], v[76:79], v[60:63]
    v_cvt_pk_bf16_f32 v160, v120, v116
    v_mfma_f32_16x16x32_bf16 v[64:67], v[244:247], v[76:79], v[64:67]
    v_cvt_pk_bf16_f32 v161, v112, v108
    v_mfma_f32_16x16x32_bf16 v[60:63], v[140:143], v[188:191], v[60:63]
    v_cvt_pk_bf16_f32 v162, v121, v117
    v_mfma_f32_16x16x32_bf16 v[60:63], v[208:211], v[80:83], v[60:63]
    v_cvt_pk_bf16_f32 v163, v113, v109
    v_mfma_f32_16x16x32_bf16 v[64:67], v[240:243], v[80:83], v[64:67]
    v_cvt_pk_bf16_f32 v164, v122, v118
    v_mfma_f32_16x16x32_bf16 v[60:63], v[144:147], v[176:179], v[60:63]
    s_waitcnt lgkmcnt(2)
    v_cvt_pk_bf16_f32 v165, v114, v110
    v_mfma_f32_16x16x32_bf16 v[60:63], v[204:207], v[84:87], v[60:63]
    ds_read_b128 v[76:79], v11 offset:2480
    v_cvt_pk_bf16_f32 v166, v123, v119
    v_mfma_f32_16x16x32_bf16 v[64:67], v[236:239], v[84:87], v[64:67]
    ds_read_b128 v[80:83], v11 offset:2560
    v_cvt_pk_bf16_f32 v167, v115, v111
    v_mfma_f32_16x16x32_bf16 v[60:63], v[148:151], v[180:183], v[60:63]
    v_cvt_pk_bf16_f32 v104, v128, v124
    v_mfma_f32_16x16x32_bf16 v[60:63], v[200:203], v[132:135], v[60:63]
    v_cvt_pk_bf16_f32 v105, v129, v125
    v_mfma_f32_16x16x32_bf16 v[64:67], v[232:235], v[132:135], v[64:67]
    ds_read2_b32 v[16:17], v4 offset0:32 offset1:33
    v_cvt_pk_bf16_f32 v106, v130, v126
    v_mfma_f32_16x16x32_bf16 v[60:63], v[152:155], v[168:171], v[60:63]
    ds_read2_b32 v[18:19], v4 offset0:34 offset1:35
    s_waitcnt lgkmcnt(4)
    v_mfma_f32_16x16x32_bf16 v[60:63], v[196:199], v[68:71], v[60:63]
    ds_read_b128 v[84:87], v11 offset:2624
    v_cvt_pk_bf16_f32 v107, v131, v127
    v_mfma_f32_16x16x32_bf16 v[64:67], v[228:231], v[68:71], v[64:67]
    v_mfma_f32_16x16x32_bf16 v[60:63], v[156:159], v[172:175], v[60:63]
    v_mfma_f32_16x16x32_bf16 v[60:63], v[192:195], v[72:75], v[60:63]
    ds_read_b128 v[132:135], v11 offset:2688
    v_mfma_f32_16x16x32_bf16 v[64:67], v[224:227], v[72:75], v[64:67]
    v_mfma_f32_16x16x32_bf16 v[108:111], v[72:75], v[28:31], 0
    v_mfma_f32_16x16x32_bf16 v[112:115], v[72:75], v[32:35], 0
    ds_read_b128 v[68:71], v11 offset:2752
    v_mfma_f32_16x16x32_bf16 v[44:47], v[12:15], v[72:75], v[44:47]
    v_mfma_f32_16x16x32_bf16 v[116:119], v[72:75], v[36:39], 0
    ds_read_b128 v[72:75], v11 offset:2816
    s_waitcnt lgkmcnt(6)
    v_mfma_f32_16x16x32_bf16 v[120:123], v[76:79], v[32:35], 0
    ds_write_b128 v7, v[60:63] offset:14592
    v_mfma_f32_16x16x32_bf16 v[64:67], v[220:223], v[80:83], v[64:67]
    ds_read_b128 v[76:79], v11 offset:2880
    ds_write_b32 v88, v88 offset:64
    v_mfma_f32_16x16x32_bf16 v[44:47], v[252:255], v[80:83], v[44:47]
    v_mfma_f32_16x16x32_bf16 v[64:67], v[96:99], v[40:43], v[64:67]
    s_waitcnt lgkmcnt(6)
    v_mfma_f32_16x16x32_bf16 v[64:67], v[92:95], v[16:19], v[64:67]
    ds_read_b128 v[80:83], v11 offset:2944
    v_mfma_f32_16x16x32_bf16 v[64:67], v[216:219], v[84:87], v[64:67]
    v_mfma_f32_16x16x32_bf16 v[44:47], v[248:251], v[84:87], v[44:47]
    v_mfma_f32_16x16x32_bf16 v[64:67], v[144:147], v[184:187], v[64:67]
    ds_read_b128 v[84:87], v11 offset:3008
    s_waitcnt lgkmcnt(6)
    v_mfma_f32_16x16x32_bf16 v[64:67], v[212:215], v[132:135], v[64:67]
    v_cvt_pk_bf16_f32 v136, v120, v116
    v_mfma_f32_16x16x32_bf16 v[44:47], v[244:247], v[132:135], v[44:47]
    v_cvt_pk_bf16_f32 v137, v112, v108
    v_mfma_f32_16x16x32_bf16 v[64:67], v[148:151], v[188:191], v[64:67]
    v_cvt_pk_bf16_f32 v138, v121, v117
    v_mfma_f32_16x16x32_bf16 v[64:67], v[208:211], v[68:71], v[64:67]
    v_cvt_pk_bf16_f32 v139, v113, v109
    v_mfma_f32_16x16x32_bf16 v[44:47], v[240:243], v[68:71], v[44:47]
    v_cvt_pk_bf16_f32 v140, v122, v118
    v_mfma_f32_16x16x32_bf16 v[64:67], v[152:155], v[176:179], v[64:67]
    s_waitcnt lgkmcnt(3)
    v_cvt_pk_bf16_f32 v141, v114, v110
    v_mfma_f32_16x16x32_bf16 v[64:67], v[204:207], v[72:75], v[64:67]
    ds_read_b128 v[132:135], v11 offset:2992
    v_cvt_pk_bf16_f32 v142, v123, v119
    v_mfma_f32_16x16x32_bf16 v[44:47], v[236:239], v[72:75], v[44:47]
    ds_read_b128 v[68:71], v11 offset:3072
    v_cvt_pk_bf16_f32 v143, v115, v111
    v_mfma_f32_16x16x32_bf16 v[64:67], v[156:159], v[180:183], v[64:67]
    v_mfma_f32_16x16x32_bf16 v[64:67], v[200:203], v[76:79], v[64:67]
    v_mfma_f32_16x16x32_bf16 v[44:47], v[232:235], v[76:79], v[44:47]
    ds_read_b128 v[72:75], v11 offset:3136
    v_mfma_f32_16x16x32_bf16 v[64:67], v[160:163], v[168:171], v[64:67]
    ds_read2_b32 v[20:21], v4 offset0:16 offset1:17
    s_waitcnt lgkmcnt(4)
    v_mfma_f32_16x16x32_bf16 v[64:67], v[196:199], v[80:83], v[64:67]
    ds_read2_b32 v[22:23], v4 offset0:18 offset1:19
    v_mfma_f32_16x16x32_bf16 v[44:47], v[228:231], v[80:83], v[44:47]
    v_mfma_f32_16x16x32_bf16 v[64:67], v[164:167], v[172:175], v[64:67]
    ds_read_b128 v[76:79], v11 offset:3200
    v_mfma_f32_16x16x32_bf16 v[64:67], v[192:195], v[84:87], v[64:67]
    v_mfma_f32_16x16x32_bf16 v[44:47], v[224:227], v[84:87], v[44:47]
    ds_read_b128 v[80:83], v11 offset:3264
    v_mfma_f32_16x16x32_bf16 v[108:111], v[84:87], v[28:31], 0
    v_mfma_f32_16x16x32_bf16 v[112:115], v[84:87], v[32:35], 0
    v_mfma_f32_16x16x32_bf16 v[48:51], v[12:15], v[84:87], v[48:51]
    v_mfma_f32_16x16x32_bf16 v[116:119], v[84:87], v[36:39], 0
    ds_read_b128 v[84:87], v11 offset:3328
    s_waitcnt lgkmcnt(6)
    v_mfma_f32_16x16x32_bf16 v[120:123], v[132:135], v[32:35], 0
    ds_read_b128 v[132:135], v11 offset:3392
    ds_write_b128 v7, v[64:67] offset:15872
    v_mfma_f32_16x16x32_bf16 v[44:47], v[220:223], v[68:71], v[44:47]
    ds_read_b128 v[68:71], v11 offset:3456
    ds_write_b32 v88, v88 offset:80
    v_mfma_f32_16x16x32_bf16 v[44:47], v[100:103], v[40:43], v[44:47]
    v_mfma_f32_16x16x32_bf16 v[44:47], v[96:99], v[16:19], v[44:47]
    s_waitcnt lgkmcnt(7)
    v_mfma_f32_16x16x32_bf16 v[44:47], v[216:219], v[72:75], v[44:47]
    ds_read_b128 v[72:75], v11 offset:3520
    v_mfma_f32_16x16x32_bf16 v[44:47], v[92:95], v[20:23], v[44:47]
    v_mfma_f32_16x16x32_bf16 v[44:47], v[152:155], v[184:187], v[44:47]
    s_waitcnt lgkmcnt(6)
    v_cvt_pk_bf16_f32 v144, v120, v116
    v_mfma_f32_16x16x32_bf16 v[44:47], v[212:215], v[76:79], v[44:47]
    ds_read_b128 v[76:79], v11 offset:3584
    v_cvt_pk_bf16_f32 v145, v112, v108
    v_mfma_f32_16x16x32_bf16 v[44:47], v[156:159], v[188:191], v[44:47]
    v_cvt_pk_bf16_f32 v146, v121, v117
    v_mfma_f32_16x16x32_bf16 v[44:47], v[208:211], v[80:83], v[44:47]
    ds_read_b128 v[80:83], v11 offset:3072
    v_cvt_pk_bf16_f32 v147, v113, v109
    v_mfma_f32_16x16x32_bf16 v[44:47], v[160:163], v[176:179], v[44:47]
    s_waitcnt lgkmcnt(6)
    v_cvt_pk_bf16_f32 v148, v122, v118
    v_mfma_f32_16x16x32_bf16 v[44:47], v[204:207], v[84:87], v[44:47]
    ds_read_b128 v[84:87], v11 offset:3648
    v_cvt_pk_bf16_f32 v149, v114, v110
    v_mfma_f32_16x16x32_bf16 v[44:47], v[164:167], v[180:183], v[44:47]
    v_cvt_pk_bf16_f32 v150, v123, v119
    v_mfma_f32_16x16x32_bf16 v[44:47], v[200:203], v[132:135], v[44:47]
    ds_read_b128 v[132:135], v11 offset:3136
    v_cvt_pk_bf16_f32 v151, v115, v111
    v_mfma_f32_16x16x32_bf16 v[44:47], v[136:139], v[168:171], v[44:47]
    ds_read2_b32 v[24:25], v4 offset0:0 offset1:1
    s_waitcnt lgkmcnt(4)
    v_mfma_f32_16x16x32_bf16 v[44:47], v[196:199], v[68:71], v[44:47]
    ds_read2_b32 v[26:27], v4 offset0:2 offset1:3
    v_mfma_f32_16x16x32_bf16 v[44:47], v[140:143], v[172:175], v[44:47]
    ds_read_b128 v[68:71], v11 offset:3712
    v_mfma_f32_16x16x32_bf16 v[44:47], v[192:195], v[72:75], v[44:47]
    ds_read_b128 v[72:75], v11 offset:3200
    v_mfma_f32_16x16x32_bf16 v[48:51], v[220:223], v[76:79], v[48:51]
    ds_read_b128 v[76:79], v11 offset:3776
    s_waitcnt lgkmcnt(6)
    v_mfma_f32_16x16x32_bf16 v[48:51], v[252:255], v[80:83], v[48:51]
    ds_read_b128 v[80:83], v11 offset:3264
    v_mfma_f32_16x16x32_bf16 v[48:51], v[104:107], v[40:43], v[48:51]
    v_mfma_f32_16x16x32_bf16 v[48:51], v[100:103], v[16:19], v[48:51]
    v_mfma_f32_16x16x32_bf16 v[48:51], v[216:219], v[84:87], v[48:51]
    ds_read_b128 v[84:87], v11 offset:3840
    s_waitcnt lgkmcnt(5)
    v_mfma_f32_16x16x32_bf16 v[48:51], v[248:251], v[132:135], v[48:51]
    ds_read_b128 v[132:135], v11 offset:3328
    v_mfma_f32_16x16x32_bf16 v[48:51], v[96:99], v[20:23], v[48:51]
    v_mfma_f32_16x16x32_bf16 v[48:51], v[92:95], v[24:27], v[48:51]
    s_waitcnt lgkmcnt(4)
    ds_write_b128 v7, v[44:47] offset:17152
    v_mfma_f32_16x16x32_bf16 v[48:51], v[212:215], v[68:71], v[48:51]
    ds_read_b128 v[68:71], v11 offset:3904
    ds_write_b32 v88, v88 offset:96
    v_mfma_f32_16x16x32_bf16 v[48:51], v[244:247], v[72:75], v[48:51]
    ds_read_b128 v[72:75], v11 offset:3392
    v_mfma_f32_16x16x32_bf16 v[48:51], v[160:163], v[184:187], v[48:51]
    v_mfma_f32_16x16x32_bf16 v[48:51], v[164:167], v[188:191], v[48:51]
    s_waitcnt lgkmcnt(5)
    v_mfma_f32_16x16x32_bf16 v[48:51], v[208:211], v[76:79], v[48:51]
    ds_read_b128 v[76:79], v11 offset:3968
    v_mfma_f32_16x16x32_bf16 v[48:51], v[240:243], v[80:83], v[48:51]
    ds_read_b128 v[80:83], v11 offset:3456
    v_mfma_f32_16x16x32_bf16 v[48:51], v[136:139], v[176:179], v[48:51]
    v_mfma_f32_16x16x32_bf16 v[48:51], v[204:207], v[84:87], v[48:51]
    ds_read_b128 v[84:87], v11 offset:4032
    s_waitcnt lgkmcnt(3)
    v_mfma_f32_16x16x32_bf16 v[48:51], v[236:239], v[132:135], v[48:51]
    ds_read_b128 v[132:135], v11 offset:3520
    v_mfma_f32_16x16x32_bf16 v[48:51], v[140:143], v[180:183], v[48:51]
    v_mfma_f32_16x16x32_bf16 v[48:51], v[200:203], v[68:71], v[48:51]
    v_mfma_f32_16x16x32_bf16 v[48:51], v[232:235], v[72:75], v[48:51]
    v_mfma_f32_16x16x32_bf16 v[48:51], v[144:147], v[168:171], v[48:51]
    s_waitcnt lgkmcnt(1)
    v_mfma_f32_16x16x32_bf16 v[48:51], v[196:199], v[76:79], v[48:51]
    v_mfma_f32_16x16x32_bf16 v[48:51], v[228:231], v[80:83], v[48:51]
    v_mfma_f32_16x16x32_bf16 v[48:51], v[148:151], v[172:175], v[48:51]
    v_mfma_f32_16x16x32_bf16 v[48:51], v[192:195], v[84:87], v[48:51]
    s_waitcnt lgkmcnt(0)
    v_mfma_f32_16x16x32_bf16 v[48:51], v[224:227], v[132:135], v[48:51]
    s_nop 7
    ds_write_b128 v7, v[48:51] offset:18432
    ds_write_b32 v88, v88 offset:112
    s_cmp_lg_u32 s39, 0
    s_cbranch_scc1 L_mw_end
    s_mul_i32 s42, s50, 9344
    s_add_u32 s42, s42, 69632
    v_add_u32 v18, s42, v3
    v_add_u32 v20, 4096, v18
    v_and_b32 v21, 0x70, v3
    s_add_u32 s42, s42, 5120
    v_add_u32 v21, s42, v21
    s_mov_b32 s61, 131072
    v_lshl_add_u32 v24, v9, 1, s54
    v_mov_b32 v35, s45
    s_barrier
L_part_poll:
    global_load_dwordx4 v[164:167], v21, s[36:37] sc1
    global_load_dwordx4 v[128:131], v18, s[36:37] offset:-4096 sc1
    global_load_dwordx4 v[132:135], v18, s[36:37] offset:-3072 sc1
    global_load_dwordx4 v[136:139], v18, s[36:37] offset:-2048 sc1
    global_load_dwordx4 v[140:143], v18, s[36:37] offset:-1024 sc1
    global_load_dwordx4 v[144:147], v18, s[36:37] offset:0 sc1
    global_load_dwordx4 v[148:151], v18, s[36:37] offset:1024 sc1
    global_load_dwordx4 v[152:155], v18, s[36:37] offset:2048 sc1
    global_load_dwordx4 v[156:159], v18, s[36:37] offset:3072 sc1
    global_load_dwordx4 v[160:163], v20, s[36:37] offset:0 sc1
    v_mul_u32_u24 v26, 4640, v9
    v_add_u32 v26, 135648, v26
    v_mul_u32_u24 v27, 33792, v9
    v_mov_b32 v25, 1280
    s_waitcnt vmcnt(9)
    v_bfe_u32 v28, v164, 8, 11
    v_lshl_add_u32 v29, v28, 1, v26
    v_lshrrev_b32 v30, 8, v28
    v_mad_u32_u24 v27, v30, v25, v27
    v_bfe_u32 v30, v28, 2, 2
    v_mul_u32_u24 v30, 320, v30
    v_and_b32 v33, 0xf0, v28
    v_add3_u32 v27, v27, v30, v33
    v_and_b32 v33, 3, v28
    v_lshl_add_u32 v30, v33, 2, v27
    ds_read_b128 v[36:39], v88 offset:112
    ds_read_u16_d16_hi v31, v29
    ds_read_b32 v32, v30 offset:9472
    v_mul_u32_u24 v28, 1152, v28
    v_add_u32 v28, v28, v24
    v_xor_b32 v22, v35, v164
    s_waitcnt vmcnt(8)
    v_xor_b32 v128, v35, v128
    v_or_b32 v22, v22, v128
    s_waitcnt vmcnt(7)
    v_xor_b32 v132, v35, v132
    v_pk_add_f32 v[130:131], v[130:131], v[134:135]
    v_pk_add_f32 v[128:129], v[128:129], v[132:133]
    s_waitcnt vmcnt(6)
    v_xor_b32 v136, v35, v136
    v_pk_add_f32 v[130:131], v[130:131], v[138:139]
    v_pk_add_f32 v[128:129], v[128:129], v[136:137]
    v_bitop3_b32 v22, v22, v132, v136 bitop3:0xfe
    s_waitcnt vmcnt(5)
    v_xor_b32 v140, v35, v140
    v_pk_add_f32 v[130:131], v[130:131], v[142:143]
    v_pk_add_f32 v[128:129], v[128:129], v[140:141]
    s_waitcnt vmcnt(4)
    v_xor_b32 v144, v35, v144
    v_pk_add_f32 v[130:131], v[130:131], v[146:147]
    v_pk_add_f32 v[128:129], v[128:129], v[144:145]
    v_bitop3_b32 v22, v22, v140, v144 bitop3:0xfe
    s_waitcnt vmcnt(3)
    v_xor_b32 v148, v35, v148
    v_pk_add_f32 v[130:131], v[130:131], v[150:151]
    v_pk_add_f32 v[128:129], v[128:129], v[148:149]
    s_waitcnt vmcnt(2)
    v_xor_b32 v152, v35, v152
    v_pk_add_f32 v[130:131], v[130:131], v[154:155]
    v_pk_add_f32 v[128:129], v[128:129], v[152:153]
    v_bitop3_b32 v22, v22, v148, v152 bitop3:0xfe
    s_waitcnt vmcnt(1)
    v_xor_b32 v156, v35, v156
    v_pk_add_f32 v[130:131], v[130:131], v[158:159]
    v_pk_add_f32 v[128:129], v[128:129], v[156:157]
    s_waitcnt vmcnt(0)
    v_xor_b32 v160, v35, v160
    v_pk_add_f32 v[130:131], v[130:131], v[162:163]
    v_pk_add_f32 v[128:129], v[128:129], v[160:161]
    v_bitop3_b32 v22, v22, v156, v160 bitop3:0xfe
    s_waitcnt lgkmcnt(0)
    v_bitop3_b32 v36, v37, v38, v39 bitop3:0x7f
    v_and_b32 v36, 128, v36
    v_or_b32 v22, v22, v36
    v_and_b32 v22, 0xff, v22
    v_cmp_ne_u32 vcc, 0, v22
    v_permlane32_swap_b32 v128, v130
    s_sub_u32 s61, s61, 1
    s_cselect_b64 vcc, 0, vcc
    s_cbranch_vccnz L_part_poll
    v_permlane32_swap_b32 v129, v131
    v_add_f32 v128, v128, v130
    v_add_f32 v129, v129, v131
    v_and_b32 v31, 0xffff0000, v31
    v_fma_f32 v34, v31, v167, v166
    v_permlane16_swap_b32 v128, v129
    v_add_f32 v128, v128, v129
    v_mul_f32 v31, 0x42000000, v31
    v_mul_f32 v32, 0x3d000000, v32
    v_add_f32_dpp v128, v128, v128 row_ror:8 row_mask:0xf bank_mask:0xf
    v_fma_f32 v128, v128, v165, v31
    v_mul_f32 v33, 0xbfb8aa3b, v128
    v_exp_f32 v33, v33
    v_mul_f32 v128, v128, v32
    v_add_f32 v33, 1.0, v33
    v_rcp_f32 v33, v33
    s_nop 0
    v_fmac_f32 v34, v128, v33
    v_cvt_pk_bf16_f32 v34, v34, v34
    global_store_short v28, v34, s[32:33]
L_mw_end:
    s_endpgm
L_helper:
    s_lshr_b32 s42, s50, 1
    s_lshl_b32 s42, s42, 15
    s_and_b32 s43, s50, 1
    s_lshl_b32 s43, s43, 6
    s_add_u32 s42, s42, s43
    s_add_u32 s42, s42, 2097152
    s_add_u32 s12, s36, s42
    s_addc_u32 s13, s37, 0
    s_add_u32 s14, s12, 8192
    s_addc_u32 s15, s13, 0
    s_add_u32 s16, s12, 16384
    s_addc_u32 s17, s13, 0
    s_add_u32 s18, s12, 24576
    s_addc_u32 s19, s13, 0
    v_bfe_u32 v63, v0, 2, 6
    v_and_b32 v6, 0x30, v3
    v_lshl_add_u32 v6, v63, 7, v6
    global_load_dwordx4 v[40:43], v6, s[12:13] sc1
    global_load_dwordx4 v[44:47], v6, s[14:15] sc1
    global_load_dwordx4 v[48:51], v6, s[16:17] sc1
    global_load_dwordx4 v[52:55], v6, s[18:19] sc1
    s_waitcnt lgkmcnt(0)
    s_barrier
    s_setprio 0
    v_and_b32 v62, 255, v0
    v_lshlrev_b32 v4, 4, v62
    v_add_u32 v4, 20480, v4
    v_add_u32 v7, 8192, v4
    v_mov_b32 v38, v63
    s_xor_b32 s42, s51, 0
    s_mul_i32 s42, s42, 1152
    s_lshl_b32 s43, s41, 6
    s_add_u32 s42, s42, s43
    s_add_u32 s42, s42, 640
    s_mov_b32 s58, 2
    s_mul_i32 s43, s40, 1152
    s_add_u32 s43, s43, 884736
    s_mul_i32 s59, s40, 663552
    s_cmp_eq_u32 s58, 0
    s_cselect_b32 s56, s26, s28
    s_cselect_b32 s57, s27, s29
    s_cmp_eq_u32 s58, 2
    s_cselect_b32 s56, s30, s56
    s_cselect_b32 s57, s31, s57
    s_cselect_b32 s43, s59, s43
    s_movk_i32 s58, 128
    s_movk_i32 s59, 8064
    s_movk_i32 s60, 4319
    s_cmov_b32 s58, 73728
    s_cmov_b32 s59, -663424
    s_cmovk_i32 s60, 5183
    v_add_u32 v76, s42, v2
    v_min_u32 v76, s60, v76
    v_mul_u32_u24 v63, 7282, v76
    v_lshrrev_b32 v63, 16, v63
    v_mul_u32_u24 v76, s58, v76
    v_mad_i32_i24 v76, v63, s59, v76
    v_add_u32 v76, s43, v76
    v_mov_b32 v63, v38
    s_bfe_u32 s43, s46, 131072
    s_mul_i32 s43, s43, 0x20004000
    s_and_b32 s43, s43, 0x40004000
    v_mov_b32 v56, s43
    s_bfe_u32 s43, s46, 131074
    s_mul_i32 s43, s43, 0x20004000
    s_and_b32 s43, s43, 0x40004000
    v_mov_b32 v57, s43
    s_bfe_u32 s43, s46, 131076
    s_mul_i32 s43, s43, 0x20004000
    s_and_b32 s43, s43, 0x40004000
    v_mov_b32 v58, s43
    s_bfe_u32 s43, s46, 131078
    s_mul_i32 s43, s43, 0x20004000
    s_and_b32 s43, s43, 0x40004000
    v_mov_b32 v59, s43
    v_and_b32 v88, 3, v0
    v_mul_u32_u24 v5, 4640, v88
    v_lshl_add_u32 v5, v63, 4, v5
    v_add_u32 v5, 135648, v5
    v_mov_b32 v63, 0x40004000
    s_lshr_b32 s43, s51, 1
    s_lshl_b32 s43, s43, 4
    s_add_u32 s43, s43, 153728
    v_lshl_add_u32 v88, v88, 2, s43
    s_mov_b32 s61, 131072
    v_lshlrev_b32 v37, 2, v62
    v_add_u32 v64, 135648, v37
    v_add_u32 v65, 140288, v37
    v_add_u32 v66, 144928, v37
    v_add_u32 v67, 149568, v37
    v_bfe_u32 v37, v0, 1, 2
    v_mul_u32_u24 v37, 320, v37
    v_and_b32 v39, 0x78, v0
    v_lshl_add_u32 v37, v39, 1, v37
    v_and_b32 v39, 1, v0
    v_lshl_add_u32 v37, v39, 3, v37
    s_lshr_b32 s43, s51, 1
    s_mul_i32 s43, s43, 1280
    s_add_u32 s43, s43, 9472
    v_add_u32 v37, s43, v37
    v_add_u32 v39, 67584, v37
    v_mul_u32_u24 v36, 2304, v62
    v_add_u32 v36, s54, v36
    v_mov_b32 v8, 0xc238aa3b
    v_mov_b32 v9, 0xffff0000
    v_lshlrev_b32 v62, 6, v62
    v_xor_b32 v62, s44, v62
    v_and_b32 v10, 15, v0
    v_lshrrev_b32 v11, 1, v0
    v_and_b32 v11, 24, v11
    s_lshl_b32 s42, s51, 4
    s_mov_b32 s58, 939536384
    s_mov_b32 s59, 3672000
    s_lshr_b64 s[58:59], s[58:59], s42
    s_and_b32 s58, s58, 0xffff
    s_lshr_b32 s59, 535826400, s42
    s_and_b32 s59, s59, 0xffff
    s_lshl_b32 s42, s51, 10
    s_add_u32 s42, s42, 154048
    v_add_u32 v12, s42, v3
    v_lshlrev_b32 v13, v10, s58
    v_bfe_u32 v13, v13, v11, 8
    v_lshl_or_b32 v13, v13, 15, v13
    v_and_b32 v16, 65537, v13
    v_mul_u32_u24 v16, 16256, v16
    v_and_b32 v17, 262148, v13
    v_mul_u32_u24 v17, 4064, v17
    v_and_b32 v18, 1048592, v13
    v_mul_u32_u24 v18, 1016, v18
    v_and_b32 v19, 4194368, v13
    v_mul_u32_u24 v19, 254, v19
    ds_write_b128 v12, v[16:19] offset:0
    v_lshlrev_b32 v13, v10, s59
    v_bfe_u32 v13, v13, v11, 8
    v_lshl_or_b32 v13, v13, 15, v13
    v_and_b32 v20, 65537, v13
    v_mul_u32_u24 v20, 16256, v20
    v_and_b32 v21, 262148, v13
    v_mul_u32_u24 v21, 4064, v21
    v_and_b32 v22, 1048592, v13
    v_mul_u32_u24 v22, 1016, v22
    v_and_b32 v23, 4194368, v13
    v_mul_u32_u24 v23, 254, v23
    ds_write_b128 v12, v[20:23] offset:4096
    global_load_dwordx4 v[224:227], v4, s[36:37] offset:-4096 sc1
    global_load_dwordx4 v[228:231], v4, s[36:37] offset:0 sc1
    global_load_dwordx4 v[232:235], v7, s[36:37] offset:-4096 sc1
    global_load_dwordx4 v[236:239], v7, s[36:37] offset:0 sc1
    s_waitcnt vmcnt(4)
    s_setprio 3
L_tile_chk:
    v_xor_b32 v40, v56, v40
    v_xor_b32 v41, v57, v41
    v_xor_b32 v42, v58, v42
    v_xor_b32 v43, v59, v43
    ds_write_b128 v5, v[40:43] offset:0
    v_xor_b32 v44, v56, v44
    v_xor_b32 v45, v57, v45
    v_xor_b32 v46, v58, v46
    v_xor_b32 v47, v59, v47
    ds_write_b128 v5, v[44:47] offset:1024
    v_xor_b32 v48, v56, v48
    v_xor_b32 v49, v57, v49
    v_xor_b32 v50, v58, v50
    v_xor_b32 v51, v59, v51
    ds_write_b128 v5, v[48:51] offset:2048
    v_xor_b32 v52, v56, v52
    v_xor_b32 v53, v57, v53
    v_xor_b32 v54, v58, v54
    v_xor_b32 v55, v59, v55
    ds_write_b128 v5, v[52:55] offset:3072
    v_bitop3_b32 v38, v40, v41, v42 bitop3:0xfe
    v_bitop3_b32 v38, v38, v43, v44 bitop3:0xfe
    v_bitop3_b32 v38, v38, v45, v46 bitop3:0xfe
    v_bitop3_b32 v38, v38, v47, v48 bitop3:0xfe
    v_bitop3_b32 v38, v38, v49, v50 bitop3:0xfe
    v_bitop3_b32 v38, v38, v51, v52 bitop3:0xfe
    v_bitop3_b32 v38, v38, v53, v54 bitop3:0xfe
    v_bitop3_b32 v38, v38, v55, v63 bitop3:0xa8
    v_cmp_ne_u32 vcc, 0, v38
    s_cbranch_vccz L_tile_ok
    global_load_dwordx4 v[40:43], v6, s[12:13] sc1
    global_load_dwordx4 v[44:47], v6, s[14:15] sc1
    global_load_dwordx4 v[48:51], v6, s[16:17] sc1
    global_load_dwordx4 v[52:55], v6, s[18:19] sc1
    s_waitcnt vmcnt(0)
    s_sub_u32 s61, s61, 1
    s_cbranch_scc0 L_tile_chk
L_tile_ok:
    s_mov_b32 s61, 2097152
    s_waitcnt vmcnt(0)
L_h_poll:
    v_mov_b32 v38, 0
    v_xor_b32 v13, 65504, v225
    v_bitop3_b32 v38, v38, v13, v62 bitop3:0xf6
    v_xor_b32 v13, 65472, v227
    v_bitop3_b32 v38, v38, v13, v62 bitop3:0xf6
    v_xor_b32 v13, 49120, v229
    v_bitop3_b32 v38, v38, v13, v62 bitop3:0xf6
    v_xor_b32 v13, 49088, v231
    v_bitop3_b32 v38, v38, v13, v62 bitop3:0xf6
    v_xor_b32 v13, 32736, v233
    v_bitop3_b32 v38, v38, v13, v62 bitop3:0xf6
    v_xor_b32 v13, 32704, v235
    v_bitop3_b32 v38, v38, v13, v62 bitop3:0xf6
    v_xor_b32 v13, 16352, v237
    v_bitop3_b32 v38, v38, v13, v62 bitop3:0xf6
    v_xor_b32 v13, 16320, v239
    v_bitop3_b32 v38, v38, v13, v62 bitop3:0xf6
    v_and_b32 v38, 0xffff, v38
    v_cmp_ne_u32 vcc, 0, v38
    s_cbranch_vccz L_h_ok
    global_load_dwordx4 v[224:227], v4, s[36:37] offset:-4096 sc1
    global_load_dwordx4 v[228:231], v4, s[36:37] offset:0 sc1
    global_load_dwordx4 v[232:235], v7, s[36:37] offset:-4096 sc1
    global_load_dwordx4 v[236:239], v7, s[36:37] offset:0 sc1
    s_waitcnt vmcnt(0)
    s_sub_u32 s61, s61, 16
    s_cbranch_scc0 L_h_poll
L_h_ok:
    s_setprio 3
    s_waitcnt lgkmcnt(0)
    s_barrier
    ds_read2st64_b32 v[16:17], v64 offset0:0 offset1:4
    ds_read2st64_b32 v[18:19], v65 offset0:0 offset1:4
    ds_read2st64_b32 v[20:21], v66 offset0:0 offset1:4
    ds_read2st64_b32 v[22:23], v67 offset0:0 offset1:4
    ds_read2st64_b32 v[24:25], v64 offset0:8 offset1:12
    ds_read2st64_b32 v[26:27], v65 offset0:8 offset1:12
    ds_read2st64_b32 v[28:29], v66 offset0:8 offset1:12
    ds_read2st64_b32 v[30:31], v67 offset0:8 offset1:12
    s_setprio 0
    s_waitcnt lgkmcnt(4)
    s_cmp_lt_u32 s51, 2
    s_cbranch_scc0 L_ct2
    global_load_dword v1, v76, s[56:57]
L_ct2:
    v_lshlrev_b32 v96, 16, v16
    v_lshlrev_b32 v97, 16, v18
    v_lshlrev_b32 v98, 16, v20
    v_lshlrev_b32 v99, 16, v22
    v_mul_f32 v104, v8, v96
    v_mul_f32 v105, v8, v97
    v_mul_f32 v106, v8, v98
    v_mul_f32 v107, v8, v99
    v_exp_f32 v104, v104
    v_exp_f32 v105, v105
    v_exp_f32 v106, v106
    v_exp_f32 v107, v107
    v_and_b32 v121, v9, v224
    v_add_f32 v104, 1.0, v104
    v_add_f32 v105, 1.0, v105
    v_add_f32 v106, 1.0, v106
    v_add_f32 v107, 1.0, v107
    v_rcp_f32 v104, v104
    v_rcp_f32 v105, v105
    v_rcp_f32 v106, v106
    v_rcp_f32 v107, v107
    v_lshlrev_b32 v120, 16, v224
    v_and_b32 v100, v9, v16
    v_and_b32 v101, v9, v18
    v_and_b32 v102, v9, v20
    v_and_b32 v103, v9, v22
    v_mul_f32 v108, v8, v100
    v_mul_f32 v109, v8, v101
    v_mul_f32 v110, v8, v102
    v_mul_f32 v111, v8, v103
    v_exp_f32 v108, v108
    v_exp_f32 v109, v109
    v_exp_f32 v110, v110
    v_exp_f32 v111, v111
    v_and_b32 v123, v9, v226
    v_add_f32 v108, 1.0, v108
    v_add_f32 v109, 1.0, v109
    v_add_f32 v110, 1.0, v110
    v_add_f32 v111, 1.0, v111
    v_rcp_f32 v108, v108
    v_rcp_f32 v109, v109
    v_rcp_f32 v110, v110
    v_rcp_f32 v111, v111
    v_lshlrev_b32 v122, 16, v226
    s_setprio 2
L_w0:
    ds_read_b32 v41, v88 offset:0
    s_waitcnt lgkmcnt(0)
    v_cmp_eq_u32 vcc, 0, v41
    s_cbranch_vccz L_w0_ok
    s_sleep 2
    s_sub_u32 s61, s61, 1
    s_cbranch_scc0 L_w0
L_w0_ok:
    ds_read_b64 v[44:45], v37 offset:0
    ds_read_b64 v[46:47], v37 offset:33792
    ds_read_b64 v[48:49], v39 offset:0
    ds_read_b64 v[50:51], v39 offset:33792
    s_setprio 0
    s_waitcnt lgkmcnt(0)
    v_fma_f32 v112, v44, v104, v121
    v_fma_f32 v113, v46, v105, v121
    v_fma_f32 v114, v48, v106, v121
    v_fma_f32 v115, v50, v107, v121
    v_fma_f32 v96, v96, v112, v120
    v_fma_f32 v97, v97, v113, v120
    v_fma_f32 v98, v98, v114, v120
    v_fma_f32 v99, v99, v115, v120
    v_cvt_pk_bf16_f32 v104, v96, v97
    v_cvt_pk_bf16_f32 v105, v98, v99
    global_store_dwordx2 v36, v[104:105], s[32:33] offset:0
    v_fma_f32 v116, v45, v108, v123
    v_fma_f32 v117, v47, v109, v123
    v_fma_f32 v118, v49, v110, v123
    v_fma_f32 v119, v51, v111, v123
    v_fma_f32 v100, v100, v116, v122
    v_fma_f32 v101, v101, v117, v122
    v_fma_f32 v102, v102, v118, v122
    v_fma_f32 v103, v103, v119, v122
    v_cvt_pk_bf16_f32 v108, v100, v101
    v_cvt_pk_bf16_f32 v109, v102, v103
    global_store_dwordx2 v36, v[108:109], s[32:33] offset:1152
    v_add_u32 v36, 589824, v36
    v_lshlrev_b32 v128, 16, v17
    v_lshlrev_b32 v129, 16, v19
    v_lshlrev_b32 v130, 16, v21
    v_lshlrev_b32 v131, 16, v23
    v_mul_f32 v136, v8, v128
    v_mul_f32 v137, v8, v129
    v_mul_f32 v138, v8, v130
    v_mul_f32 v139, v8, v131
    v_exp_f32 v136, v136
    v_exp_f32 v137, v137
    v_exp_f32 v138, v138
    v_exp_f32 v139, v139
    v_and_b32 v153, v9, v228
    v_add_f32 v136, 1.0, v136
    v_add_f32 v137, 1.0, v137
    v_add_f32 v138, 1.0, v138
    v_add_f32 v139, 1.0, v139
    v_rcp_f32 v136, v136
    v_rcp_f32 v137, v137
    v_rcp_f32 v138, v138
    v_rcp_f32 v139, v139
    v_lshlrev_b32 v152, 16, v228
    v_and_b32 v132, v9, v17
    v_and_b32 v133, v9, v19
    v_and_b32 v134, v9, v21
    v_and_b32 v135, v9, v23
    v_mul_f32 v140, v8, v132
    v_mul_f32 v141, v8, v133
    v_mul_f32 v142, v8, v134
    v_mul_f32 v143, v8, v135
    v_exp_f32 v140, v140
    v_exp_f32 v141, v141
    v_exp_f32 v142, v142
    v_exp_f32 v143, v143
    v_and_b32 v155, v9, v230
    v_add_f32 v140, 1.0, v140
    v_add_f32 v141, 1.0, v141
    v_add_f32 v142, 1.0, v142
    v_add_f32 v143, 1.0, v143
    v_rcp_f32 v140, v140
    v_rcp_f32 v141, v141
    v_rcp_f32 v142, v142
    v_rcp_f32 v143, v143
    v_lshlrev_b32 v154, 16, v230
    s_setprio 2
L_w1:
    ds_read_b32 v41, v88 offset:32
    s_waitcnt lgkmcnt(0)
    v_cmp_eq_u32 vcc, 0, v41
    s_cbranch_vccz L_w1_ok
    s_sleep 2
    s_sub_u32 s61, s61, 1
    s_cbranch_scc0 L_w1
L_w1_ok:
    ds_read_b64 v[44:45], v37 offset:2560
    ds_read_b64 v[46:47], v37 offset:36352
    ds_read_b64 v[48:49], v39 offset:2560
    ds_read_b64 v[50:51], v39 offset:36352
    s_setprio 0
    s_waitcnt lgkmcnt(0)
    v_fma_f32 v144, v44, v136, v153
    v_fma_f32 v145, v46, v137, v153
    v_fma_f32 v146, v48, v138, v153
    v_fma_f32 v147, v50, v139, v153
    v_fma_f32 v128, v128, v144, v152
    v_fma_f32 v129, v129, v145, v152
    v_fma_f32 v130, v130, v146, v152
    v_fma_f32 v131, v131, v147, v152
    v_cvt_pk_bf16_f32 v136, v128, v129
    v_cvt_pk_bf16_f32 v137, v130, v131
    global_store_dwordx2 v36, v[136:137], s[32:33] offset:0
    v_fma_f32 v148, v45, v140, v155
    v_fma_f32 v149, v47, v141, v155
    v_fma_f32 v150, v49, v142, v155
    v_fma_f32 v151, v51, v143, v155
    v_fma_f32 v132, v132, v148, v154
    v_fma_f32 v133, v133, v149, v154
    v_fma_f32 v134, v134, v150, v154
    v_fma_f32 v135, v135, v151, v154
    v_cvt_pk_bf16_f32 v140, v132, v133
    v_cvt_pk_bf16_f32 v141, v134, v135
    global_store_dwordx2 v36, v[140:141], s[32:33] offset:1152
    v_add_u32 v36, 589824, v36
    v_lshlrev_b32 v160, 16, v24
    v_lshlrev_b32 v161, 16, v26
    v_lshlrev_b32 v162, 16, v28
    v_lshlrev_b32 v163, 16, v30
    v_mul_f32 v168, v8, v160
    v_mul_f32 v169, v8, v161
    v_mul_f32 v170, v8, v162
    v_mul_f32 v171, v8, v163
    v_exp_f32 v168, v168
    v_exp_f32 v169, v169
    v_exp_f32 v170, v170
    v_exp_f32 v171, v171
    v_and_b32 v185, v9, v232
    v_add_f32 v168, 1.0, v168
    v_add_f32 v169, 1.0, v169
    v_add_f32 v170, 1.0, v170
    v_add_f32 v171, 1.0, v171
    v_rcp_f32 v168, v168
    v_rcp_f32 v169, v169
    v_rcp_f32 v170, v170
    v_rcp_f32 v171, v171
    v_lshlrev_b32 v184, 16, v232
    v_and_b32 v164, v9, v24
    v_and_b32 v165, v9, v26
    v_and_b32 v166, v9, v28
    v_and_b32 v167, v9, v30
    v_mul_f32 v172, v8, v164
    v_mul_f32 v173, v8, v165
    v_mul_f32 v174, v8, v166
    v_mul_f32 v175, v8, v167
    v_exp_f32 v172, v172
    v_exp_f32 v173, v173
    v_exp_f32 v174, v174
    v_exp_f32 v175, v175
    v_and_b32 v187, v9, v234
    v_add_f32 v172, 1.0, v172
    v_add_f32 v173, 1.0, v173
    v_add_f32 v174, 1.0, v174
    v_add_f32 v175, 1.0, v175
    v_rcp_f32 v172, v172
    v_rcp_f32 v173, v173
    v_rcp_f32 v174, v174
    v_rcp_f32 v175, v175
    v_lshlrev_b32 v186, 16, v234
    s_setprio 2
L_w2:
    ds_read_b32 v41, v88 offset:64
    s_waitcnt lgkmcnt(0)
    v_cmp_eq_u32 vcc, 0, v41
    s_cbranch_vccz L_w2_ok
    s_sleep 2
    s_sub_u32 s61, s61, 1
    s_cbranch_scc0 L_w2
L_w2_ok:
    ds_read_b64 v[44:45], v37 offset:5120
    ds_read_b64 v[46:47], v37 offset:38912
    ds_read_b64 v[48:49], v39 offset:5120
    ds_read_b64 v[50:51], v39 offset:38912
    s_setprio 0
    s_waitcnt lgkmcnt(0)
    v_fma_f32 v176, v44, v168, v185
    v_fma_f32 v177, v46, v169, v185
    v_fma_f32 v178, v48, v170, v185
    v_fma_f32 v179, v50, v171, v185
    v_fma_f32 v160, v160, v176, v184
    v_fma_f32 v161, v161, v177, v184
    v_fma_f32 v162, v162, v178, v184
    v_fma_f32 v163, v163, v179, v184
    v_cvt_pk_bf16_f32 v168, v160, v161
    v_cvt_pk_bf16_f32 v169, v162, v163
    global_store_dwordx2 v36, v[168:169], s[32:33] offset:0
    v_fma_f32 v180, v45, v172, v187
    v_fma_f32 v181, v47, v173, v187
    v_fma_f32 v182, v49, v174, v187
    v_fma_f32 v183, v51, v175, v187
    v_fma_f32 v164, v164, v180, v186
    v_fma_f32 v165, v165, v181, v186
    v_fma_f32 v166, v166, v182, v186
    v_fma_f32 v167, v167, v183, v186
    v_cvt_pk_bf16_f32 v172, v164, v165
    v_cvt_pk_bf16_f32 v173, v166, v167
    global_store_dwordx2 v36, v[172:173], s[32:33] offset:1152
    v_add_u32 v36, 589824, v36
    v_lshlrev_b32 v192, 16, v25
    v_lshlrev_b32 v193, 16, v27
    v_lshlrev_b32 v194, 16, v29
    v_lshlrev_b32 v195, 16, v31
    v_mul_f32 v200, v8, v192
    v_mul_f32 v201, v8, v193
    v_mul_f32 v202, v8, v194
    v_mul_f32 v203, v8, v195
    v_exp_f32 v200, v200
    v_exp_f32 v201, v201
    v_exp_f32 v202, v202
    v_exp_f32 v203, v203
    v_and_b32 v217, v9, v236
    v_add_f32 v200, 1.0, v200
    v_add_f32 v201, 1.0, v201
    v_add_f32 v202, 1.0, v202
    v_add_f32 v203, 1.0, v203
    v_rcp_f32 v200, v200
    v_rcp_f32 v201, v201
    v_rcp_f32 v202, v202
    v_rcp_f32 v203, v203
    v_lshlrev_b32 v216, 16, v236
    v_and_b32 v196, v9, v25
    v_and_b32 v197, v9, v27
    v_and_b32 v198, v9, v29
    v_and_b32 v199, v9, v31
    v_mul_f32 v204, v8, v196
    v_mul_f32 v205, v8, v197
    v_mul_f32 v206, v8, v198
    v_mul_f32 v207, v8, v199
    v_exp_f32 v204, v204
    v_exp_f32 v205, v205
    v_exp_f32 v206, v206
    v_exp_f32 v207, v207
    v_and_b32 v219, v9, v238
    v_add_f32 v204, 1.0, v204
    v_add_f32 v205, 1.0, v205
    v_add_f32 v206, 1.0, v206
    v_add_f32 v207, 1.0, v207
    v_rcp_f32 v204, v204
    v_rcp_f32 v205, v205
    v_rcp_f32 v206, v206
    v_rcp_f32 v207, v207
    v_lshlrev_b32 v218, 16, v238
    s_setprio 2
L_w3:
    ds_read_b32 v41, v88 offset:96
    ds_read_b64 v[44:45], v37 offset:7680
    ds_read_b64 v[46:47], v37 offset:41472
    ds_read_b64 v[48:49], v39 offset:7680
    ds_read_b64 v[50:51], v39 offset:41472
    s_waitcnt lgkmcnt(0)
    v_cmp_eq_u32 vcc, 0, v41
    s_cbranch_vccz L_w3_ok
    s_sleep 1
    s_sub_u32 s61, s61, 1
    s_cbranch_scc0 L_w3
L_w3_ok:
    v_fma_f32 v208, v44, v200, v217
    v_fma_f32 v209, v46, v201, v217
    v_fma_f32 v210, v48, v202, v217
    v_fma_f32 v211, v50, v203, v217
    v_fma_f32 v192, v192, v208, v216
    v_fma_f32 v193, v193, v209, v216
    v_fma_f32 v194, v194, v210, v216
    v_fma_f32 v195, v195, v211, v216
    v_cvt_pk_bf16_f32 v200, v192, v193
    v_cvt_pk_bf16_f32 v201, v194, v195
    global_store_dwordx2 v36, v[200:201], s[32:33] offset:0
    v_fma_f32 v212, v45, v204, v219
    v_fma_f32 v213, v47, v205, v219
    v_fma_f32 v214, v49, v206, v219
    v_fma_f32 v215, v51, v207, v219
    v_fma_f32 v196, v196, v212, v218
    v_fma_f32 v197, v197, v213, v218
    v_fma_f32 v198, v198, v214, v218
    v_fma_f32 v199, v199, v215, v218
    v_cvt_pk_bf16_f32 v204, v196, v197
    v_cvt_pk_bf16_f32 v205, v198, v199
    global_store_dwordx2 v36, v[204:205], s[32:33] offset:1152
    s_waitcnt vmcnt(0)
    s_barrier
    s_endpgm
L_lnp:
    s_mul_i32 s43, s39, 1216
    s_add_u32 s43, s43, 154048
    v_add_u32 v52, s43, v3
    v_add_u32 v53, s43, v4
    s_lshl_b32 s43, s39, 3
    s_add_u32 s43, s43, 163776
    v_mov_b32 v54, s43
    v_bfe_u32 v55, v0, 2, 2
    v_mul_u32_u24 v55, 1216, v55
    v_and_b32 v56, 3, v0
    v_lshl_add_u32 v55, v56, 3, v55
    v_lshrrev_b32 v56, 4, v0
    v_lshl_add_u32 v55, v56, 5, v55
    v_add_u32 v55, 154048, v55
    v_lshrrev_b32 v56, 3, v0
    v_lshlrev_b32 v56, 15, v56
    v_and_b32 v57, 112, v3
    s_lshl_b32 s43, s2, 7
    s_add_u32 s43, s43, 2097152
    v_add3_u32 v56, v56, v57, s43
    v_mov_b32 v40, 0
    v_mov_b32 v41, 0
    v_mov_b32 v42, 0
    v_mov_b32 v43, 0
    v_mov_b32 v44, 0x3ae38e39
    v_mov_b32 v38, 0xbfffbfff
    v_mov_b32 v37, 0xffff
    s_lshl_b32 s58, s2, 3
    s_add_u32 s58, s58, s39
    s_xor_b32 s58, s58, 0x7ff
    s_lshl_b32 s58, s58, 5
    s_waitcnt lgkmcnt(0)
    s_add_u32 s38, s38, 0x9e370001
    s_lshr_b32 s44, s38, 16
    s_and_b32 s45, s38, 0xff
    s_and_b32 s46, s38, 0xfb
    s_bitcmp0_b32 s38, 0
    s_cselect_b32 s43, 4, 0
    s_or_b32 s46, s46, s43
    s_bitcmp1_b32 s46, s39
    s_cselect_b32 s43, 0x40004000, 0
    v_mov_b32 v39, s43
    s_xor_b32 s58, s58, s44
    v_mov_b32 v57, s58
    s_mov_b32 s42, 0x3f803f80
    s_cmp_lt_u32 s41, 27
    s_cbranch_scc1 L_lw2
    s_cmp_lt_u32 s39, 2
    s_cbranch_scc0 L_lw1
    global_load_dword v1, v76, s[56:57]
    s_waitcnt vmcnt(1)
    s_branch L_ln
L_lw1:
    s_waitcnt vmcnt(0)
    s_branch L_ln
L_lw2:
    s_add_u32 m0, s49, 0
    s_nop 0
    global_load_lds_dwordx4 v76, s[56:57]
    v_add_u32 v76, 294912, v76
    s_add_u32 m0, s49, 4096
    s_nop 0
    global_load_lds_dwordx4 v76, s[56:57]
    v_add_u32 v76, 294912, v76
    s_add_u32 m0, s49, 8192
    s_nop 0
    global_load_lds_dwordx4 v76, s[56:57]
    v_add_u32 v76, 294912, v76
    s_waitcnt vmcnt(3)
L_ln:
    v_dot2c_f32_bf16 v40, s42, v12
    v_dot2c_f32_bf16 v41, v12, v12
    v_dot2c_f32_bf16 v42, v12, v20
    v_dot2c_f32_bf16 v43, s42, v20
    v_dot2c_f32_bf16 v40, s42, v13
    v_dot2c_f32_bf16 v41, v13, v13
    v_dot2c_f32_bf16 v42, v13, v21
    v_dot2c_f32_bf16 v43, s42, v21
    v_dot2c_f32_bf16 v40, s42, v14
    v_dot2c_f32_bf16 v41, v14, v14
    v_dot2c_f32_bf16 v42, v14, v22
    v_dot2c_f32_bf16 v43, s42, v22
    v_dot2c_f32_bf16 v40, s42, v15
    v_dot2c_f32_bf16 v41, v15, v15
    v_dot2c_f32_bf16 v42, v15, v23
    v_dot2c_f32_bf16 v43, s42, v23
    v_dot2c_f32_bf16 v40, s42, v16
    v_dot2c_f32_bf16 v41, v16, v16
    v_dot2c_f32_bf16 v42, v16, v24
    v_dot2c_f32_bf16 v43, s42, v24
    v_lshlrev_b32 v36, 16, v16
    v_lshlrev_b32 v28, 16, v12
    v_and_b32 v29, 0xffff0000, v12
    v_permlane32_swap_b32 v40, v42
    v_permlane32_swap_b32 v41, v43
    v_add_f32 v40, v40, v42
    v_add_f32 v41, v41, v43
    v_lshlrev_b32 v30, 16, v13
    v_and_b32 v31, 0xffff0000, v13
    v_permlane16_swap_b32 v40, v41
    v_add_f32 v40, v40, v41
    v_lshlrev_b32 v32, 16, v14
    v_and_b32 v33, 0xffff0000, v14
    v_add_f32_dpp v40, v40, v40 row_ror:8 row_mask:0xf bank_mask:0xf
    v_lshlrev_b32 v34, 16, v15
    v_and_b32 v35, 0xffff0000, v15
    v_add_f32_dpp v40, v40, v40 row_ror:4 row_mask:0xf bank_mask:0xf
    s_nop 1
    v_add_f32_dpp v40, v40, v40 row_ror:2 row_mask:0xf bank_mask:0xf
    s_nop 1
    v_add_f32_dpp v40, v40, v40 row_ror:1 row_mask:0xf bank_mask:0xf
    s_nop 0
    v_readlane_b32 s58, v40, 0
    v_readlane_b32 s59, v40, 16
    v_readlane_b32 s60, v40, 32
    v_readlane_b32 s61, v40, 48
    v_mul_f32 v40, s58, v44
    v_mul_f32 v41, s59, v44
    v_fma_f32 v41, -v40, v40, v41
    v_max_f32 v41, 0, v41
    v_cvt_pk_bf16_f32 v44, v41, v40
    v_lshlrev_b32 v41, 16, v44
    v_add_f32 v41, 0x3727c5ac, v41
    v_cvt_pk_bf16_f32 v41, v41, v41
    v_and_b32 v41, 0xffff0000, v41
    v_mul_f32 v41, 0x44800000, v41
    v_sqrt_f32 v41, v41
    v_and_b32 v49, 0xffff0000, v44
    v_cvt_pk_bf16_f32 v50, v49, v41
    v_and_b32 v41, 0xffff0000, v50
    v_rcp_f32 v46, v41
    v_mul_f32 v42, s61, v49
    v_mul_f32 v47, v49, v46
    v_fma_f32 v28, v28, v46, -v47
    v_fma_f32 v29, v29, v46, -v47
    v_fma_f32 v30, v30, v46, -v47
    v_fma_f32 v31, v31, v46, -v47
    v_fma_f32 v32, v32, v46, -v47
    v_fma_f32 v33, v33, v46, -v47
    v_fma_f32 v34, v34, v46, -v47
    v_fma_f32 v35, v35, v46, -v47
    v_fma_f32 v36, v36, v46, -v47
    v_cvt_pk_bf16_f32 v28, v28, v29
    v_cvt_pk_bf16_f32 v29, v30, v31
    v_cvt_pk_bf16_f32 v30, v32, v33
    v_cvt_pk_bf16_f32 v31, v34, v35
    v_cvt_pk_bf16_f32 v32, v36, v36
    v_bitop3_b32 v28, v28, v38, v39 bitop3:0xea
    v_bitop3_b32 v29, v29, v38, v39 bitop3:0xea
    v_bitop3_b32 v30, v30, v38, v39 bitop3:0xea
    v_bitop3_b32 v31, v31, v38, v39 bitop3:0xea
    v_bitop3_b32 v32, v32, v38, v39 bitop3:0xea
    ds_write_b128 v52, v[28:31]
    ds_write_b16 v53, v32 offset:1024
    v_sub_f32 v42, s60, v42
    v_mul_f32 v42, 0x42000000, v42
    v_mul_f32 v42, v42, v46
    v_cvt_pk_bf16_f32 v42, v42, v42
    v_ashrrev_i32 v43, 31, v42
    v_or_b32 v43, 0x80000000, v43
    v_xor_b32 v42, v42, v43
    v_bitop3_b32 v51, v37, v57, v42 bitop3:0xca
    s_mov_b64 exec, 1
    ds_write_b64 v54, v[50:51]
    s_mov_b64 exec, -1
    s_waitcnt lgkmcnt(0)
    s_barrier
    s_cmp_eq_u32 s39, 1
    s_cbranch_scc1 L_ln_stat
    ds_read_b64_tr_b16 v[28:29], v55
    ds_read_b64_tr_b16 v[30:31], v55 offset:4864
    s_cmp_eq_u32 s39, 0
    s_cbranch_scc0 L_ln_st
    ds_read_b64_tr_b16 v[32:33], v55 offset:1024
    ds_read_b64_tr_b16 v[34:35], v55 offset:5888
    v_add_u32 v38, 2097152, v56
    s_waitcnt lgkmcnt(0)
    global_store_dwordx4 v38, v[32:35], s[36:37] sc1
    s_branch L_ln_st
L_ln_stat:
    v_and_b32 v41, 0x30, v3
    v_add_u32 v40, 163776, v41
    ds_read_b128 v[48:51], v40
    ds_read_b64_tr_b16 v[28:29], v55
    ds_read_b64_tr_b16 v[30:31], v55 offset:4864
    s_lshl_b32 s43, s2, 6
    s_add_u32 s43, s43, 16384
    v_add_u32 v41, s43, v41
    s_mov_b64 exec, 15
    s_waitcnt lgkmcnt(2)
    global_store_dwordx4 v41, v[48:51], s[36:37] sc1
    s_mov_b64 exec, -1
L_ln_st:
    s_waitcnt lgkmcnt(0)
    global_store_dwordx4 v56, v[28:31], s[36:37] sc1
    s_barrier
    s_cmp_lt_u32 s41, 27
    s_cbranch_scc1 L_ffn
    s_cmp_lt_u32 s39, 2
    s_cbranch_scc1 L_sp2
    global_load_dword v1, v76, s[56:57]
L_sp2:
    s_mul_i32 s42, s39, 320
    s_add_u32 s42, s42, s53
    s_add_u32 s42, s42, 2624
    s_mov_b32 s58, 2
    s_mul_i32 s43, s40, 1152
    s_add_u32 s43, s43, 884736
    s_mul_i32 s59, s40, 663552
    s_cmp_eq_u32 s58, 0
    s_cselect_b32 s56, s26, s28
    s_cselect_b32 s57, s27, s29
    s_cmp_eq_u32 s58, 2
    s_cselect_b32 s56, s30, s56
    s_cselect_b32 s57, s31, s57
    s_cselect_b32 s43, s59, s43
    s_movk_i32 s58, 128
    s_movk_i32 s59, 8064
    s_movk_i32 s60, 4319
    s_cmov_b32 s58, 73728
    s_cmov_b32 s59, -663424
    s_cmovk_i32 s60, 5183
    v_add_u32 v76, s42, v2
    v_min_u32 v76, s60, v76
    v_mul_u32_u24 v63, 7282, v76
    v_lshrrev_b32 v63, 16, v63
    v_mul_u32_u24 v76, s58, v76
    v_mad_i32_i24 v76, v63, s59, v76
    v_add_u32 v76, s43, v76
    s_barrier
    s_cmp_ge_u32 s39, 8
    s_cbranch_scc1 L_sp3
    global_load_dword v1, v76, s[56:57]
L_sp3:
    s_sub_u32 s42, s2, 216
    s_cmp_ge_u32 s42, 32
    s_cbranch_scc1 L_sp4
    s_cmp_ge_u32 s39, 1
    s_cbranch_scc1 L_sp4
    s_lshl_b32 s42, s42, 6
    v_add_u32 v76, s42, v2
    v_mul_u32_u24 v76, 1152, v76
    s_lshl_b32 s42, s39, 7
    v_subrev_u32 v76, s42, v76
    v_add_u32 v76, 1024, v76
    global_load_dword v1, v76, s[32:33]
L_sp4:
    s_waitcnt vmcnt(0)
    s_endpgm
L_ffn:
    v_bfe_u32 v14, v0, 4, 2
    v_and_b32 v11, 7, v0
    v_mov_b32 v26, 147456
    v_mov_b32 v27, 4
    s_cmp_eq_u32 s52, 0
    s_cbranch_scc0 L_gu
    s_setprio 1
    v_lshlrev_b32 v8, 4, v0
    v_add_u32 v9, 20480, v8
    v_add_u32 v10, 8192, v9
    v_lshlrev_b32 v13, 6, v0
    v_xor_b32 v128, 65504, v13
    v_xor_b32 v129, 65472, v13
    v_xor_b32 v130, 49120, v13
    v_xor_b32 v131, 49088, v13
    v_xor_b32 v132, 32736, v13
    v_xor_b32 v133, 32704, v13
    v_xor_b32 v134, 16352, v13
    v_xor_b32 v135, 16320, v13
    v_mov_b32 v36, s44
    v_lshrrev_b32 v25, 5, v0
    v_lshl_add_u32 v25, v25, 2, v26
    s_mul_i32 s62, s39, 80
    s_add_u32 s62, s62, 147584
    v_and_b32 v15, 0x3c, v0
    v_add_u32 v15, s62, v15
    v_and_b32 v16, 3, v0
    v_mul_u32_u24 v16, 80, v16
    v_add_u32 v16, 147584, v16
    v_lshrrev_b32 v12, 3, v2
    v_lshl_add_u32 v17, v12, 2, v26
    v_lshl_add_u32 v18, v11, 2, v26
    v_and_b32 v12, 6, v12
    v_xor_b32 v12, v12, v11
    v_lshlrev_b32 v12, 4, v12
    v_lshl_add_u32 v12, v1, 7, v12
    v_add_u32 v12, 2358144, v12
    s_lshl_b32 s63, s54, 7
    s_add_u32 s63, s63, 2358144
    v_mov_b32 v37, s63
    s_movk_i32 s63, -1152
    s_mul_i32 s64, s39, 1056
    s_mul_i32 s42, s50, 73728
    s_add_u32 s12, s30, s42
    s_addc_u32 s13, s31, 0
    s_add_u32 s14, s12, 18432
    s_addc_u32 s15, s13, 0
    s_add_u32 s16, s12, 36864
    s_addc_u32 s17, s13, 0
    s_add_u32 s18, s12, 55296
    s_addc_u32 s19, s13, 0
    v_mul_u32_u24 v19, 4608, v14
    v_and_b32 v20, 0xf0, v3
    s_lshl_b32 s42, s51, 8
    v_add3_u32 v19, v19, v20, s42
    v_lshrrev_b32 v20, 1, v2
    v_mul_u32_u24 v20, 1152, v20
    v_and_b32 v21, 16, v3
    s_lshl_b32 s42, s51, 5
    v_add3_u32 v20, v20, v21, s42
    v_bfe_i32 v232, v0, 3, 1
    v_mul_u32_u24 v4, 74752, v14
    v_lshl_add_u32 v4, v11, 4, v4
    v_and_b32 v5, 37376, v232
    s_lshl_b32 s43, s50, 7
    s_add_u32 s43, s43, 65536
    s_mul_i32 s42, s51, 299008
    s_add_u32 s42, s42, s43
    v_add3_u32 v4, v4, v5, s42
    v_add_u32 v5, 18688, v4
    v_add_u32 v6, 9344, v4
    v_add_u32 v7, 28032, v4
    v_mul_u32_u24 v8, 9344, v14
    v_lshl_add_u32 v8, v11, 4, v8
    s_mul_i32 s42, s51, 37376
    s_add_u32 s42, s42, s43
    s_add_u32 s42, s42, 1196032
    v_add_u32 v8, s42, v8
    v_mov_b32 v233, s45
    v_mov_b32 v234, 0xff
    v_and_b32 v235, 0x370, v3
    v_add_u32 v235, 147968, v235
    s_lshl_b32 s42, s51, 10
    s_add_u32 s42, s42, 159520
    v_add_u32 v236, s42, v3
    v_lshl_add_u32 v237, v2, 3, s42
    s_mov_b32 s66, 0x05040100
    s_mov_b32 s67, 0x07060302
    s_mov_b32 s55, 131072
    s_waitcnt vmcnt(0)
    s_barrier
    global_load_dwordx4 v[112:115], v9, s[36:37] offset:-4096 sc1
    global_load_dwordx4 v[116:119], v9, s[36:37] offset:0 sc1
    global_load_dwordx4 v[120:123], v10, s[36:37] offset:-4096 sc1
    global_load_dwordx4 v[124:127], v10, s[36:37] offset:0 sc1
L_ffn_poll:
    v_mov_b32 v24, 0
    s_waitcnt vmcnt(3)
    v_xor_b32 v28, v36, v113
    v_bitop3_b32 v24, v24, v28, v128 bitop3:0xf6
    v_xor_b32 v29, v36, v115
    v_bitop3_b32 v24, v24, v29, v129 bitop3:0xf6
    s_waitcnt vmcnt(2)
    v_xor_b32 v30, v36, v117
    v_bitop3_b32 v24, v24, v30, v130 bitop3:0xf6
    v_xor_b32 v31, v36, v119
    v_bitop3_b32 v24, v24, v31, v131 bitop3:0xf6
    s_waitcnt vmcnt(1)
    v_xor_b32 v32, v36, v121
    v_bitop3_b32 v24, v24, v32, v132 bitop3:0xf6
    v_xor_b32 v33, v36, v123
    v_bitop3_b32 v24, v24, v33, v133 bitop3:0xf6
    s_waitcnt vmcnt(0)
    v_xor_b32 v34, v36, v125
    v_bitop3_b32 v24, v24, v34, v134 bitop3:0xf6
    v_xor_b32 v35, v36, v127
    v_bitop3_b32 v24, v24, v35, v135 bitop3:0xf6
    v_and_b32 v24, 0xffff, v24
    v_cmp_ne_u32 vcc, 0, v24
    v_max3_u32 v38, v28, v29, v30
    v_max3_u32 v39, v31, v32, v33
    s_cbranch_vccz L_ffn_go
    global_load_dwordx4 v[112:115], v9, s[36:37] offset:-4096 sc1
    global_load_dwordx4 v[116:119], v9, s[36:37] offset:0 sc1
    global_load_dwordx4 v[120:123], v10, s[36:37] offset:-4096 sc1
    global_load_dwordx4 v[124:127], v10, s[36:37] offset:0 sc1
    s_sub_u32 s55, s55, 1
    s_cbranch_scc0 L_ffn_poll
    s_waitcnt vmcnt(0)
L_ffn_go:
    s_barrier
    v_max3_u32 v38, v38, v34, v35
    v_max_u32 v38, v38, v39
    v_alignbit_b32 v24, 1, v38, 5
    v_sub_u32 v128, v28, v38
    v_sub_u32 v129, v29, v38
    v_max_u32_dpp v21, v24, v24 row_ror:1 row_mask:0xf bank_mask:0xf
    v_sub_u32 v130, v30, v38
    v_sub_u32 v131, v31, v38
    v_max_u32_dpp v21, v21, v21 row_ror:2 row_mask:0xf bank_mask:0xf
    v_sub_u32 v132, v32, v38
    v_sub_u32 v133, v33, v38
    v_max_u32_dpp v21, v21, v21 row_ror:4 row_mask:0xf bank_mask:0xf
    v_sub_u32 v134, v34, v38
    v_sub_u32 v135, v35, v38
    v_max_u32_dpp v21, v21, v21 row_ror:8 row_mask:0xf bank_mask:0xf
    v_max3_u32 v39, v128, v129, v130
    v_max3_u32 v22, v131, v132, v133
    v_max_u32_dpp v21, v21, v21 row_bcast:15 row_mask:0xa bank_mask:0xf
    s_mov_b32 exec_lo, 0x80000000
    s_mov_b32 exec_hi, 0x80000000
    ds_write_b32 v25, v21
    s_mov_b64 exec, -1
    s_mov_b32 s55, 2097152
    ds_read_b128 v[112:115], v26
    ds_read_b128 v[116:119], v26 offset:16
    v_max3_u32 v39, v39, v134, v135
    v_max_u32 v39, v39, v22
    v_add_u32 v39, v39, v38
    v_alignbit_b32 v23, 1, v39, 5
L_s1:
    s_waitcnt lgkmcnt(0)
    v_min3_u32 v21, v112, v113, v114
    v_min3_u32 v22, v115, v116, v117
    v_min3_u32 v21, v21, v118, v119
    v_min_u32 v21, v21, v22
    v_cmp_eq_u32 vcc, 0, v21
    v_cmp_ge_u32 s[6:7], v24, v21
    v_cmp_ge_u32 s[8:9], v23, v21
    s_cbranch_vccz L_s1_ok
    ds_read_b128 v[112:115], v26
    ds_read_b128 v[116:119], v26 offset:16
    s_sub_u32 s55, s55, 1
    s_cbranch_scc0 L_s1
L_s1_ok:
    s_bcnt1_i32_b64 s10, s[6:7]
    v_mbcnt_lo_u32_b32 v22, s6, 0
    v_mbcnt_lo_u32_b32 v13, s8, 0
    v_mbcnt_hi_u32_b32 v22, s7, v22
    v_mbcnt_hi_u32_b32 v13, s9, v13
    v_min_u32 v22, 16, v22
    v_add_u32 v13, s10, v13
    v_lshl_add_u32 v22, v22, 2, s62
    v_min_u32 v13, 16, v13
    s_mov_b64 exec, s[6:7]
    ds_write_b32 v22, v24
    v_lshl_add_u32 v13, v13, 2, s62
    s_mov_b64 exec, s[8:9]
    ds_write_b32 v13, v23
    s_mov_b64 exec, 1
    ds_add_u32 v26, v27 offset:32
    s_mov_b64 exec, -1
    ds_read_b32 v22, v26 offset:32
    ds_read_b32 v13, v15
    ds_read_b128 v[112:115], v16 offset:0
    ds_read_b128 v[116:119], v16 offset:16
    ds_read_b128 v[120:123], v16 offset:32
    ds_read_b128 v[124:127], v16 offset:48
    v_and_b32 v24, 0x7ff, v24
    v_and_b32 v23, 0x7ff, v23
    v_mad_i32_i24 v24, v24, s63, v37
    v_mad_i32_i24 v23, v23, s63, v37
    s_mov_b64 exec, s[6:7]
    global_load_dword v239, v24, s[4:5]
    s_cmp_eq_u64 s[8:9], 0
    s_cbranch_scc1 L_no2
    s_mov_b64 exec, s[8:9]
    global_load_dword v239, v23, s[4:5]
L_no2:
    s_mov_b64 exec, -1
L_s2:
    s_waitcnt lgkmcnt(0)
    v_cmp_ne_u32 vcc, 16, v22
    v_mov_b32 v24, 0
    s_cbranch_vccz L_s2_ok
    ds_read_b32 v22, v26 offset:32
    ds_read_b32 v13, v15
    ds_read_b128 v[112:115], v16 offset:0
    ds_read_b128 v[116:119], v16 offset:16
    ds_read_b128 v[120:123], v16 offset:32
    ds_read_b128 v[124:127], v16 offset:48
    s_sub_u32 s55, s55, 1
    s_cbranch_scc0 L_s2
L_s2_ok:
    v_sub_u32 v112, v13, v112
    v_alignbit_b32 v24, v24, v112, 31
    v_sub_u32 v113, v13, v113
    v_alignbit_b32 v24, v24, v113, 31
    v_sub_u32 v114, v13, v114
    v_alignbit_b32 v24, v24, v114, 31
    v_sub_u32 v115, v13, v115
    v_alignbit_b32 v24, v24, v115, 31
    v_sub_u32 v116, v13, v116
    v_alignbit_b32 v24, v24, v116, 31
    v_sub_u32 v117, v13, v117
    v_alignbit_b32 v24, v24, v117, 31
    v_sub_u32 v118, v13, v118
    v_alignbit_b32 v24, v24, v118, 31
    v_sub_u32 v119, v13, v119
    v_alignbit_b32 v24, v24, v119, 31
    v_sub_u32 v120, v13, v120
    v_alignbit_b32 v24, v24, v120, 31
    v_sub_u32 v121, v13, v121
    v_alignbit_b32 v24, v24, v121, 31
    v_sub_u32 v122, v13, v122
    v_alignbit_b32 v24, v24, v122, 31
    v_sub_u32 v123, v13, v123
    v_alignbit_b32 v24, v24, v123, 31
    v_sub_u32 v124, v13, v124
    v_alignbit_b32 v24, v24, v124, 31
    v_sub_u32 v125, v13, v125
    v_alignbit_b32 v24, v24, v125, 31
    v_sub_u32 v126, v13, v126
    v_alignbit_b32 v24, v24, v126, 31
    v_sub_u32 v127, v13, v127
    v_alignbit_b32 v24, v24, v127, 31
    v_bcnt_u32_b32 v24, v24, 0
    s_nop 1
    v_add_u32_dpp v24, v24, v24 quad_perm:[1,0,3,2] row_mask:0xf bank_mask:0xf
    s_nop 1
    v_add_u32_dpp v24, v24, v24 quad_perm:[2,3,0,1] row_mask:0xf bank_mask:0xf
    v_cmp_gt_u32 vcc, 8, v24
    v_lshl_add_u32 v24, v24, 2, v26
    s_mov_b64 exec, vcc
    ds_write_b32 v24, v13 offset:64
    s_mov_b64 exec, -1
L_s3:
    ds_read_b32 v23, v17 offset:64
    ds_read_b32 v13, v18 offset:64
    s_add_u32 m0, s64, 150016
    s_waitcnt lgkmcnt(0)
    v_cmp_eq_u32 vcc, 0, v23
    v_and_b32 v23, 0x7ff, v23
    s_sub_u32 s55, s55, 1
    s_cselect_b64 vcc, 0, vcc
    s_cbranch_vccnz L_s3
    v_mad_i32_i24 v23, v23, s63, v12
    global_load_lds_dwordx4 v23, s[4:5]
    s_add_u32 m0, s64, 153728
    v_and_b32 v22, 0x7ff, v13
    global_load_lds_dwordx4 v23, s[4:5] offset:512
    v_sub_u32 v22, 2047, v22
    s_cmp_lg_u32 s39, 0
    s_cbranch_scc1 L_nox9
    s_mov_b32 m0, 157440
    s_nop 0
    global_load_lds_dwordx4 v23, s[4:5] offset:1024
    s_branch L_x3
L_nox9:
    v_lshlrev_b32 v24, 3, v22
    v_add_u32 v24, 16384, v24
    global_load_dword v25, v24, s[36:37] sc1
L_x3:
    s_barrier
    v_readlane_b32 s10, v13, 7
    s_mov_b32 s11, 0
    s_lshl_b32 s10, s10, 5
    v_cmp_le_u32 vcc, s10, v28
    s_nop 0
    s_bcnt1_i32_b64 s56, vcc
    s_add_u32 s11, s11, s56
    v_cmp_le_u32 vcc, s10, v29
    s_nop 0
    s_bcnt1_i32_b64 s56, vcc
    s_add_u32 s11, s11, s56
    v_cmp_le_u32 vcc, s10, v30
    s_nop 0
    s_bcnt1_i32_b64 s56, vcc
    s_add_u32 s11, s11, s56
    v_cmp_le_u32 vcc, s10, v31
    s_nop 0
    s_bcnt1_i32_b64 s56, vcc
    s_add_u32 s11, s11, s56
    v_cmp_le_u32 vcc, s10, v32
    s_nop 0
    s_bcnt1_i32_b64 s56, vcc
    s_add_u32 s11, s11, s56
    v_cmp_le_u32 vcc, s10, v33
    s_nop 0
    s_bcnt1_i32_b64 s56, vcc
    s_add_u32 s11, s11, s56
    v_cmp_le_u32 vcc, s10, v34
    s_nop 0
    s_bcnt1_i32_b64 s56, vcc
    s_add_u32 s11, s11, s56
    v_cmp_le_u32 vcc, s10, v35
    s_nop 0
    s_bcnt1_i32_b64 s56, vcc
    s_add_u32 s11, s11, s56
    s_lshl_b32 s11, s11, 16
    s_or_b32 s11, s11, 4
    v_mov_b32 v36, s11
    s_barrier
    global_load_dwordx4 v[40:43], v19, s[12:13] offset:0
    global_load_dwordx4 v[44:47], v19, s[12:13] offset:1152
    s_waitcnt vmcnt(2)
    s_cmp_lg_u32 s39, 1
    s_cbranch_scc1 L_nost
    ds_write_b32 v18, v25 offset:448
L_nost:
    s_mov_b64 exec, 1
    ds_add_u32 v26, v36 offset:36
    s_mov_b64 exec, -1
    s_setprio 0
    global_load_dwordx4 v[48:51], v19, s[12:13] offset:2304
    global_load_dwordx4 v[52:55], v19, s[12:13] offset:3456
    global_load_dwordx4 v[56:59], v19, s[14:15] offset:0
    global_load_dwordx4 v[60:63], v19, s[14:15] offset:1152
    global_load_dwordx4 v[64:67], v19, s[14:15] offset:2304
    global_load_dwordx4 v[68:71], v19, s[14:15] offset:3456
    global_load_dwordx4 v[216:219], v20, s[12:13] offset:1024
    global_load_dwordx4 v[220:223], v20, s[16:17] offset:1024
L_s4:
    ds_read_b32 v24, v26 offset:36
    s_waitcnt lgkmcnt(0)
    v_readfirstlane_b32 s61, v24
    s_nop 0
    s_and_b32 s60, s61, 255
    s_cmp_ge_u32 s60, 16
    s_cbranch_scc1 L_s4_ok
    s_sub_u32 s55, s55, 1
    s_cbranch_scc0 L_s4
L_s4_ok:
    s_lshr_b32 s61, s61, 16
    s_cmp_eq_u32 s61, 8
    s_cbranch_scc0 L_slow
L_dgo:
    global_load_dwordx4 v[72:75], v19, s[16:17] offset:0
    s_waitcnt vmcnt(9)
    v_perm_b32 v112, v44, v40, s66
    v_perm_b32 v116, v44, v40, s67
    v_perm_b32 v120, v45, v41, s66
    v_perm_b32 v124, v45, v41, s67
    v_perm_b32 v128, v46, v42, s66
    v_perm_b32 v132, v46, v42, s67
    v_perm_b32 v136, v47, v43, s66
    v_perm_b32 v140, v47, v43, s67
    global_load_dwordx4 v[76:79], v19, s[16:17] offset:1152
    s_waitcnt vmcnt(8)
    v_perm_b32 v113, v52, v48, s66
    v_perm_b32 v117, v52, v48, s67
    v_perm_b32 v121, v53, v49, s66
    v_perm_b32 v125, v53, v49, s67
    v_perm_b32 v129, v54, v50, s66
    v_perm_b32 v133, v54, v50, s67
    v_perm_b32 v137, v55, v51, s66
    v_perm_b32 v141, v55, v51, s67
    global_load_dwordx4 v[80:83], v19, s[16:17] offset:2304
    global_load_dwordx4 v[84:87], v19, s[16:17] offset:3456
    s_waitcnt vmcnt(8)
    v_perm_b32 v114, v60, v56, s66
    v_perm_b32 v118, v60, v56, s67
    v_perm_b32 v122, v61, v57, s66
    v_perm_b32 v126, v61, v57, s67
    v_perm_b32 v130, v62, v58, s66
    v_perm_b32 v134, v62, v58, s67
    v_perm_b32 v138, v63, v59, s66
    v_perm_b32 v142, v63, v59, s67
    global_load_dwordx4 v[88:91], v19, s[18:19] offset:0
    global_load_dwordx4 v[92:95], v19, s[18:19] offset:1152
    s_waitcnt vmcnt(8)
    v_perm_b32 v115, v68, v64, s66
    v_perm_b32 v119, v68, v64, s67
    v_perm_b32 v123, v69, v65, s66
    v_perm_b32 v127, v69, v65, s67
    v_perm_b32 v131, v70, v66, s66
    v_perm_b32 v135, v70, v66, s67
    v_perm_b32 v139, v71, v67, s66
    v_perm_b32 v143, v71, v67, s67
    global_load_dwordx4 v[96:99], v19, s[18:19] offset:2304
    global_load_dwordx4 v[100:103], v19, s[18:19] offset:3456
    s_waitcnt vmcnt(6)
    ds_write_b128 v236, v[216:219]
    ds_read_b64_tr_b16 v[104:105], v237
    ds_read_b64_tr_b16 v[106:107], v237 offset:512
    ds_write_b128 v236, v[220:223]
    ds_read_b64_tr_b16 v[108:109], v237
    ds_read_b64_tr_b16 v[110:111], v237 offset:512
    v_perm_b32 v144, v76, v72, s66
    v_perm_b32 v148, v76, v72, s67
    v_perm_b32 v152, v77, v73, s66
    v_perm_b32 v156, v77, v73, s67
    v_perm_b32 v160, v78, v74, s66
    v_perm_b32 v164, v78, v74, s67
    v_perm_b32 v168, v79, v75, s66
    v_perm_b32 v172, v79, v75, s67
    s_waitcnt vmcnt(4)
    v_perm_b32 v145, v84, v80, s66
    v_perm_b32 v149, v84, v80, s67
    v_perm_b32 v153, v85, v81, s66
    v_perm_b32 v157, v85, v81, s67
    v_perm_b32 v161, v86, v82, s66
    v_perm_b32 v165, v86, v82, s67
    v_perm_b32 v169, v87, v83, s66
    v_perm_b32 v173, v87, v83, s67
    s_barrier
    ds_read_b128 v[28:31], v235
    ds_read_b128 v[32:35], v235 offset:1024
    s_mov_b32 s58, 0x00ff00ff
    s_mov_b32 s59, 0x00ff00ff
    s_waitcnt vmcnt(2)
    v_perm_b32 v146, v92, v88, s66
    v_perm_b32 v150, v92, v88, s67
    v_perm_b32 v154, v93, v89, s66
    v_perm_b32 v158, v93, v89, s67
    v_perm_b32 v162, v94, v90, s66
    v_perm_b32 v166, v94, v90, s67
    v_perm_b32 v170, v95, v91, s66
    v_perm_b32 v174, v95, v91, s67
    s_waitcnt lgkmcnt(0)
    v_mfma_f32_16x16x32_bf16 v[208:211], v[104:107], v[28:31], 0
    s_waitcnt vmcnt(0)
    v_perm_b32 v147, v100, v96, s66
    v_mfma_f32_16x16x32_bf16 v[208:211], v[108:111], v[32:35], v[208:211]
    v_perm_b32 v151, v100, v96, s67
    v_perm_b32 v155, v101, v97, s66
    v_mfma_f32_16x16x32_bf16 v[176:179], v[112:115], v[28:31], 0
    v_perm_b32 v159, v101, v97, s67
    v_perm_b32 v163, v102, v98, s66
    v_mfma_f32_16x16x32_bf16 v[180:183], v[116:119], v[28:31], 0
    v_perm_b32 v167, v102, v98, s67
    v_perm_b32 v171, v103, v99, s66
    v_mfma_f32_16x16x32_bf16 v[184:187], v[120:123], v[28:31], 0
    v_perm_b32 v175, v103, v99, s67
    v_mfma_f32_16x16x32_bf16 v[188:191], v[124:127], v[28:31], 0
    v_mfma_f32_16x16x32_bf16 v[176:179], v[144:147], v[32:35], v[176:179]
    v_mfma_f32_16x16x32_bf16 v[180:183], v[148:151], v[32:35], v[180:183]
    v_bitop3_b32 v208, v234, v233, v208 bitop3:0xca
    s_mov_b64 exec, s[58:59]
    global_store_dwordx4 v8, v[208:211], s[36:37] sc1
    s_mov_b64 exec, -1
    v_mfma_f32_16x16x32_bf16 v[184:187], v[152:155], v[32:35], v[184:187]
    v_mfma_f32_16x16x32_bf16 v[188:191], v[156:159], v[32:35], v[188:191]
    v_mfma_f32_16x16x32_bf16 v[192:195], v[128:131], v[28:31], 0
    v_mfma_f32_16x16x32_bf16 v[196:199], v[132:135], v[28:31], 0
    v_mfma_f32_16x16x32_bf16 v[200:203], v[136:139], v[28:31], 0
    v_bitop3_b32 v212, v232, v178, v176 bitop3:0xca
    v_bitop3_b32 v213, v232, v182, v180 bitop3:0xca
    v_mfma_f32_16x16x32_bf16 v[204:207], v[140:143], v[28:31], 0
    s_nop 0
    v_bitop3_b32 v214, v232, v186, v184 bitop3:0xca
    v_bitop3_b32 v215, v232, v190, v188 bitop3:0xca
    v_mfma_f32_16x16x32_bf16 v[192:195], v[160:163], v[32:35], v[192:195]
    v_bitop3_b32 v212, v234, v233, v212 bitop3:0xca
    global_store_dwordx4 v4, v[212:215], s[36:37] sc1
    v_mfma_f32_16x16x32_bf16 v[196:199], v[164:167], v[32:35], v[196:199]
    v_bitop3_b32 v216, v232, v179, v177 bitop3:0xca
    v_bitop3_b32 v217, v232, v183, v181 bitop3:0xca
    v_mfma_f32_16x16x32_bf16 v[200:203], v[168:171], v[32:35], v[200:203]
    v_bitop3_b32 v218, v232, v187, v185 bitop3:0xca
    v_bitop3_b32 v219, v232, v191, v189 bitop3:0xca
    v_mfma_f32_16x16x32_bf16 v[204:207], v[172:175], v[32:35], v[204:207]
    v_bitop3_b32 v216, v234, v233, v216 bitop3:0xca
    global_store_dwordx4 v5, v[216:219], s[36:37] sc1
    v_bitop3_b32 v220, v232, v194, v192 bitop3:0xca
    v_bitop3_b32 v221, v232, v198, v196 bitop3:0xca
    s_nop 0
    v_bitop3_b32 v222, v232, v202, v200 bitop3:0xca
    s_nop 1
    v_bitop3_b32 v223, v232, v206, v204 bitop3:0xca
    v_bitop3_b32 v220, v234, v233, v220 bitop3:0xca
    global_store_dwordx4 v6, v[220:223], s[36:37] sc1
    v_bitop3_b32 v224, v232, v195, v193 bitop3:0xca
    v_bitop3_b32 v225, v232, v199, v197 bitop3:0xca
    v_bitop3_b32 v226, v232, v203, v201 bitop3:0xca
    v_bitop3_b32 v227, v232, v207, v205 bitop3:0xca
    v_bitop3_b32 v224, v234, v233, v224 bitop3:0xca
    global_store_dwordx4 v7, v[224:227], s[36:37] sc1
    s_endpgm
L_slow:
    v_mov_b32 v21, 0
    v_mov_b32 v38, v26
    s_mov_b32 s10, 16
L_slow_r:
    v_sub_u32 v176, v28, v21
    v_sub_u32 v177, v29, v21
    v_sub_u32 v178, v30, v21
    v_sub_u32 v179, v31, v21
    v_sub_u32 v180, v32, v21
    v_sub_u32 v181, v33, v21
    v_sub_u32 v182, v34, v21
    v_sub_u32 v183, v35, v21
    v_max3_u32 v24, v176, v177, v178
    v_max3_u32 v24, v24, v179, v180
    v_max3_u32 v24, v24, v181, v182
    v_max_u32 v24, v24, v183
    ds_max_u32 v38, v24 offset:96
    s_mov_b64 exec, 1
    ds_add_u32 v26, v27 offset:40
    s_mov_b64 exec, -1
L_slow_s:
    ds_read_b32 v24, v26 offset:40
    ds_read_b32 v39, v38 offset:96
    s_waitcnt lgkmcnt(0)
    v_readfirstlane_b32 s11, v24
    s_nop 0
    s_cmp_ge_u32 s11, s10
    s_cbranch_scc1 L_slow_ok
    s_sub_u32 s55, s55, 1
    s_cbranch_scc0 L_slow_s
L_slow_ok:
    v_add_u32 v21, v21, v39
    v_alignbit_b32 v24, 1, v21, 5
    ds_write_b32 v38, v24 offset:64
    v_add_u32 v38, 4, v38
    s_add_u32 s10, s10, 16
    s_cmp_le_u32 s10, 128
    s_cbranch_scc1 L_slow_r
    ds_read_b32 v23, v17 offset:64
    ds_read_b32 v13, v18 offset:64
    s_add_u32 m0, s64, 150016
    s_waitcnt lgkmcnt(0)
    v_and_b32 v23, 0x7ff, v23
    v_mad_i32_i24 v23, v23, s63, v12
    global_load_lds_dwordx4 v23, s[4:5]
    s_add_u32 m0, s64, 153728
    v_and_b32 v22, 0x7ff, v13
    global_load_lds_dwordx4 v23, s[4:5] offset:512
    v_sub_u32 v22, 2047, v22
    s_cmp_lg_u32 s39, 0
    s_cbranch_scc1 L_nox9b
    s_mov_b32 m0, 157440
    s_nop 0
    global_load_lds_dwordx4 v23, s[4:5] offset:1024
    s_branch L_x3b
L_nox9b:
    v_lshlrev_b32 v24, 3, v22
    v_add_u32 v24, 16384, v24
    global_load_dword v25, v24, s[36:37] sc1
L_x3b:
    v_mov_b32 v36, 4
    s_waitcnt vmcnt(0)
    s_cmp_lg_u32 s39, 1
    s_cbranch_scc1 L_nostb
    ds_write_b32 v18, v25 offset:448
L_nostb:
    s_mov_b64 exec, 1
    ds_add_u32 v26, v36 offset:36
    s_mov_b64 exec, -1
    s_branch L_dgo
L_gu:
    s_add_u32 s53, s53, 12288
    v_mov_b32 v1, v76
    s_movk_i32 s55, 5
L_dma1:
    s_mov_b32 m0, s53
    s_add_u32 s42, s53, 73728
    global_load_lds_dwordx4 v1, s[26:27]
    s_mov_b32 m0, s42
    s_add_u32 s53, s53, 4096
    global_load_lds_dwordx4 v1, s[28:29]
    v_add_u32 v1, 294912, v1
    s_sub_u32 s55, s55, 1
    s_cmp_lg_u32 s55, 0
    s_cbranch_scc1 L_dma1
    v_lshrrev_b32 v12, 1, v2
    v_min_u32 v12, 8, v12
    v_mul_u32_u24 v12, 1056, v12
    v_and_b32 v13, 16, v3
    v_add_u32 v12, v12, v13
    v_add_u32 v12, 151040, v12
    v_mov_b32 v20, 0x3f803f80
    v_mov_b32 v21, v20
    v_mov_b32 v22, v20
    v_mov_b32 v23, v20
    ds_write_b128 v12, v[20:23]
    v_bfe_u32 v15, v0, 2, 2
    v_and_b32 v16, 3, v0
    v_lshl_add_u32 v17, v14, 3, v15
    v_bfe_u32 v18, v0, 3, 2
    v_xor_b32 v18, s51, v18
    v_lshlrev_b32 v18, 5, v18
    v_lshl_add_u32 v18, v16, 3, v18
    v_lshl_add_u32 v4, v17, 7, v18
    v_add_u32 v5, 36864, v4
    v_add_u32 v6, 73728, v4
    v_add_u32 v7, 110592, v4
    v_and_b32 v19, 6, v11
    v_xor_b32 v19, v19, v14
    v_lshlrev_b32 v19, 4, v19
    v_lshl_add_u32 v19, v11, 7, v19
    v_xor_b32 v20, 64, v19
    v_bfe_i32 v21, v0, 3, 1
    v_lshlrev_b32 v22, 2, v0
    v_xor_b32 v22, v22, v0
    v_and_b32 v22, 16, v22
    v_or_b32 v22, 1024, v22
    v_bfi_b32 v19, v21, v22, v19
    v_xor_b32 v22, 16, v22
    v_bfi_b32 v20, v21, v22, v20
    v_add_u32 v19, 150016, v19
    v_add_u32 v20, 150016, v20
    v_lshl_add_u32 v18, v11, 2, v26
    s_lshr_b32 s42, s51, 1
    s_lshl_b32 s42, s42, 10
    s_and_b32 s43, s51, 1
    s_lshl_b32 s43, s43, 3
    s_add_u32 s42, s42, s43
    s_add_u32 s42, s42, 147968
    v_add_u32 v27, s42, v3
    v_and_b32 v8, 9344, v21
    v_lshl_add_u32 v8, v11, 4, v8
    s_mul_i32 s42, s50, 18688
    s_add_u32 s42, s42, 74752
    v_add_u32 v8, s42, v8
    s_waitcnt vmcnt(0)
    s_barrier
    ds_read_b64_tr_b16 v[112:113], v4 offset:0
    ds_read_b64_tr_b16 v[114:115], v4 offset:512
    ds_read_b64_tr_b16 v[184:185], v6 offset:0
    ds_read_b64_tr_b16 v[186:187], v6 offset:512
    ds_read_b64_tr_b16 v[116:117], v4 offset:4096
    ds_read_b64_tr_b16 v[118:119], v4 offset:4608
    ds_read_b64_tr_b16 v[188:189], v6 offset:4096
    ds_read_b64_tr_b16 v[190:191], v6 offset:4608
    ds_read_b64_tr_b16 v[120:121], v4 offset:8192
    ds_read_b64_tr_b16 v[122:123], v4 offset:8704
    ds_read_b64_tr_b16 v[192:193], v6 offset:8192
    ds_read_b64_tr_b16 v[194:195], v6 offset:8704
    ds_read_b64_tr_b16 v[124:125], v4 offset:12288
    ds_read_b64_tr_b16 v[126:127], v4 offset:12800
    ds_read_b64_tr_b16 v[196:197], v6 offset:12288
    ds_read_b64_tr_b16 v[198:199], v6 offset:12800
    ds_read_b64_tr_b16 v[128:129], v4 offset:16384
    ds_read_b64_tr_b16 v[130:131], v4 offset:16896
    ds_read_b64_tr_b16 v[200:201], v6 offset:16384
    ds_read_b64_tr_b16 v[202:203], v6 offset:16896
    ds_read_b64_tr_b16 v[132:133], v4 offset:20480
    ds_read_b64_tr_b16 v[134:135], v4 offset:20992
    ds_read_b64_tr_b16 v[204:205], v6 offset:20480
    ds_read_b64_tr_b16 v[206:207], v6 offset:20992
    ds_read_b64_tr_b16 v[136:137], v4 offset:24576
    ds_read_b64_tr_b16 v[138:139], v4 offset:25088
    ds_read_b64_tr_b16 v[208:209], v6 offset:24576
    ds_read_b64_tr_b16 v[210:211], v6 offset:25088
    ds_read_b64_tr_b16 v[140:141], v4 offset:28672
    ds_read_b64_tr_b16 v[142:143], v4 offset:29184
    ds_read_b64_tr_b16 v[212:213], v6 offset:28672
    ds_read_b64_tr_b16 v[214:215], v6 offset:29184
    s_barrier
    s_movk_i32 s55, 6
L_dma4:
    s_mov_b32 m0, s53
    s_add_u32 s42, s53, 73728
    global_load_lds_dwordx4 v1, s[26:27]
    s_mov_b32 m0, s42
    s_add_u32 s53, s53, 4096
    global_load_lds_dwordx4 v1, s[28:29]
    v_add_u32 v1, 294912, v1
    s_waitcnt vmcnt(4)
    s_sub_u32 s55, s55, 1
    s_cmp_lg_u32 s55, 0
    s_cbranch_scc1 L_dma4
    s_mov_b32 s55, 2097152
    v_mov_b32 v23, 0x100
    s_waitcnt vmcnt(0)
    s_barrier
    s_setprio 2
    s_add_u32 m0, s53, 0
    s_nop 0
    global_load_lds_dwordx4 v1, s[26:27]
    ds_read_b64_tr_b16 v[144:145], v4 offset:32768
    ds_read_b64_tr_b16 v[146:147], v4 offset:33280
    ds_read_b64_tr_b16 v[216:217], v6 offset:32768
    s_add_u32 m0, s53, 73728
    s_nop 0
    global_load_lds_dwordx4 v1, s[28:29]
    ds_read_b64_tr_b16 v[218:219], v6 offset:33280
    ds_read_b64_tr_b16 v[148:149], v5 offset:0
    ds_read_b64_tr_b16 v[150:151], v5 offset:512
    v_add_u32 v1, 294912, v1
    s_add_u32 m0, s53, 4096
    s_nop 0
    global_load_lds_dwordx4 v1, s[26:27]
    ds_read_b64_tr_b16 v[220:221], v7 offset:0
    ds_read_b64_tr_b16 v[222:223], v7 offset:512
    ds_read_b64_tr_b16 v[152:153], v5 offset:4096
    s_add_u32 m0, s53, 77824
    s_nop 0
    global_load_lds_dwordx4 v1, s[28:29]
    ds_read_b64_tr_b16 v[154:155], v5 offset:4608
    ds_read_b64_tr_b16 v[224:225], v7 offset:4096
    ds_read_b64_tr_b16 v[226:227], v7 offset:4608
    v_add_u32 v1, 294912, v1
    s_add_u32 m0, s53, 8192
    s_nop 0
    global_load_lds_dwordx4 v1, s[26:27]
    ds_read_b64_tr_b16 v[156:157], v5 offset:8192
    ds_read_b64_tr_b16 v[158:159], v5 offset:8704
    ds_read_b64_tr_b16 v[228:229], v7 offset:8192
    s_add_u32 m0, s53, 81920
    s_nop 0
    global_load_lds_dwordx4 v1, s[28:29]
    ds_read_b64_tr_b16 v[230:231], v7 offset:8704
    ds_read_b64_tr_b16 v[160:161], v5 offset:12288
    ds_read_b64_tr_b16 v[162:163], v5 offset:12800
    v_add_u32 v1, 294912, v1
    s_add_u32 m0, s53, 12288
    s_nop 0
    global_load_lds_dwordx4 v1, s[26:27]
    ds_read_b64_tr_b16 v[232:233], v7 offset:12288
    ds_read_b64_tr_b16 v[234:235], v7 offset:12800
    ds_read_b64_tr_b16 v[164:165], v5 offset:16384
    s_add_u32 m0, s53, 86016
    s_nop 0
    global_load_lds_dwordx4 v1, s[28:29]
    ds_read_b64_tr_b16 v[166:167], v5 offset:16896
    ds_read_b64_tr_b16 v[236:237], v7 offset:16384
    ds_read_b64_tr_b16 v[238:239], v7 offset:16896
    v_add_u32 v1, 294912, v1
    s_barrier
    s_waitcnt vmcnt(0)
    s_mov_b64 exec, 1
    ds_add_u32 v26, v23 offset:36
    s_mov_b64 exec, -1
L_s6:
    ds_read_b32 v24, v26 offset:36
    s_waitcnt lgkmcnt(0)
    v_readfirstlane_b32 s61, v24
    s_nop 0
    s_cmp_eq_u32 s61, 0x80410
    s_cbranch_scc1 L_s6_ok
    s_and_b32 s60, s61, 0xffff
    s_cmp_eq_u32 s60, 0x420
    s_cbranch_scc1 L_s6_ok
    s_sub_u32 s55, s55, 1
    s_cbranch_scc0 L_s6
L_s6_ok:
    ds_read_b128 v[40:43], v19 offset:0
    ds_read_b128 v[44:47], v20 offset:0
    ds_read_b128 v[48:51], v19 offset:1056
    ds_read_b128 v[52:55], v20 offset:1056
    ds_read_b128 v[56:59], v19 offset:2112
    ds_read_b128 v[60:63], v20 offset:2112
    s_waitcnt lgkmcnt(5)
    v_mfma_f32_16x16x32_bf16 v[28:31], v[112:115], v[40:43], 0
    ds_read_b128 v[64:67], v19 offset:3168
    ds_read_b128 v[68:71], v20 offset:3168
    v_mfma_f32_16x16x32_bf16 v[32:35], v[184:187], v[40:43], 0
    ds_read_b128 v[72:75], v19 offset:4224
    s_waitcnt lgkmcnt(6)
    v_mfma_f32_16x16x32_bf16 v[28:31], v[116:119], v[44:47], v[28:31]
    ds_read_b128 v[76:79], v20 offset:4224
    ds_read_b32 v25, v18 offset:448
    v_mfma_f32_16x16x32_bf16 v[32:35], v[188:191], v[44:47], v[32:35]
    ds_read_b32 v13, v18 offset:64
    ds_read_b128 v[80:83], v19 offset:5280
    v_mfma_f32_16x16x32_bf16 v[28:31], v[120:123], v[48:51], v[28:31]
    ds_read_b128 v[84:87], v20 offset:5280
    v_mfma_f32_16x16x32_bf16 v[32:35], v[192:195], v[48:51], v[32:35]
    ds_read_b128 v[88:91], v19 offset:6336
    s_waitcnt lgkmcnt(10)
    v_mfma_f32_16x16x32_bf16 v[28:31], v[124:127], v[52:55], v[28:31]
    ds_read_b128 v[92:95], v20 offset:6336
    v_mfma_f32_16x16x32_bf16 v[32:35], v[196:199], v[52:55], v[32:35]
    ds_read_b128 v[96:99], v19 offset:7392
    ds_read_b64_tr_b16 v[168:169], v5 offset:20480
    v_mfma_f32_16x16x32_bf16 v[28:31], v[128:131], v[56:59], v[28:31]
    ds_read_b64_tr_b16 v[170:171], v5 offset:20992
    v_mfma_f32_16x16x32_bf16 v[32:35], v[200:203], v[56:59], v[32:35]
    s_waitcnt lgkmcnt(11)
    v_mfma_f32_16x16x32_bf16 v[28:31], v[132:135], v[60:63], v[28:31]
    ds_read_b128 v[100:103], v20 offset:7392
    ds_read_b64_tr_b16 v[172:173], v5 offset:24576
    v_mfma_f32_16x16x32_bf16 v[28:31], v[136:139], v[64:67], v[28:31]
    ds_read_b64_tr_b16 v[174:175], v5 offset:25088
    v_mfma_f32_16x16x32_bf16 v[28:31], v[140:143], v[68:71], v[28:31]
    s_waitcnt lgkmcnt(9)
    v_mfma_f32_16x16x32_bf16 v[28:31], v[144:147], v[72:75], v[28:31]
    ds_read_b128 v[104:107], v19 offset:8448
    ds_read_b64_tr_b16 v[176:177], v5 offset:28672
    v_mfma_f32_16x16x32_bf16 v[28:31], v[148:151], v[76:79], v[28:31]
    ds_read_b64_tr_b16 v[178:179], v5 offset:29184
    ds_read_b128 v[108:111], v20 offset:8448
    v_mfma_f32_16x16x32_bf16 v[28:31], v[152:155], v[80:83], v[28:31]
    ds_read_b64_tr_b16 v[180:181], v5 offset:32768
    v_and_b32 v15, 0xffff0000, v25
    s_waitcnt lgkmcnt(11)
    v_mfma_f32_16x16x32_bf16 v[28:31], v[156:159], v[84:87], v[28:31]
    ds_read_b64_tr_b16 v[182:183], v5 offset:33280
    v_rcp_f32 v16, v15
    v_mfma_f32_16x16x32_bf16 v[28:31], v[160:163], v[88:91], v[28:31]
    ds_read_b64_tr_b16 v[240:241], v7 offset:20480
    v_lshlrev_b32 v12, 16, v25
    v_mfma_f32_16x16x32_bf16 v[28:31], v[164:167], v[92:95], v[28:31]
    ds_read_b64_tr_b16 v[242:243], v7 offset:20992
    v_xor_b32 v25, 0x80000000, v12
    s_waitcnt lgkmcnt(5)
    v_mfma_f32_16x16x32_bf16 v[28:31], v[168:171], v[96:99], v[28:31]
    ds_read_b64_tr_b16 v[244:245], v7 offset:24576
    v_mul_f32 v16, 0x42000000, v16
    v_mfma_f32_16x16x32_bf16 v[28:31], v[172:175], v[100:103], v[28:31]
    ds_read_b64_tr_b16 v[246:247], v7 offset:25088
    v_mul_f32 v9, 0xbfb8aa3b, v16
    v_mfma_f32_16x16x32_bf16 v[28:31], v[176:179], v[104:107], v[28:31]
    ds_read_b64_tr_b16 v[248:249], v7 offset:28672
    v_mul_f32 v10, v16, v16
    s_waitcnt lgkmcnt(5)
    v_mfma_f32_16x16x32_bf16 v[28:31], v[180:183], v[108:111], v[28:31]
    ds_read_b64_tr_b16 v[250:251], v7 offset:29184
    v_mfma_f32_16x16x32_bf16 v[32:35], v[204:207], v[60:63], v[32:35]
    ds_read_b64_tr_b16 v[252:253], v7 offset:32768
    ds_read_b64_tr_b16 v[254:255], v7 offset:33280
    v_mfma_f32_16x16x32_bf16 v[32:35], v[208:211], v[64:67], v[32:35]
    v_mfma_f32_16x16x32_bf16 v[32:35], v[212:215], v[68:71], v[32:35]
    v_mfma_f32_16x16x32_bf16 v[32:35], v[216:219], v[72:75], v[32:35]
    s_nop 0
    v_fmac_f32_dpp v28, v28, v25 row_newbcast:8 row_mask:0xf bank_mask:0xf
    v_fmac_f32_dpp v29, v29, v25 row_newbcast:8 row_mask:0xf bank_mask:0xf
    v_mfma_f32_16x16x32_bf16 v[32:35], v[220:223], v[76:79], v[32:35]
    v_fmac_f32_dpp v30, v30, v25 row_newbcast:8 row_mask:0xf bank_mask:0xf
    v_fmac_f32_dpp v31, v31, v25 row_newbcast:8 row_mask:0xf bank_mask:0xf
    v_mfma_f32_16x16x32_bf16 v[32:35], v[224:227], v[80:83], v[32:35]
    v_mul_f32 v36, v9, v28
    v_mul_f32 v37, v9, v29
    v_mfma_f32_16x16x32_bf16 v[32:35], v[228:231], v[84:87], v[32:35]
    v_mul_f32 v38, v9, v30
    v_mul_f32 v39, v9, v31
    v_mfma_f32_16x16x32_bf16 v[32:35], v[232:235], v[88:91], v[32:35]
    v_exp_f32 v36, v36
    v_exp_f32 v37, v37
    v_mfma_f32_16x16x32_bf16 v[32:35], v[236:239], v[92:95], v[32:35]
    v_exp_f32 v38, v38
    v_exp_f32 v39, v39
    s_waitcnt lgkmcnt(2)
    v_mfma_f32_16x16x32_bf16 v[32:35], v[240:243], v[96:99], v[32:35]
    v_mul_f32 v28, v28, v10
    v_mul_f32 v29, v29, v10
    v_mfma_f32_16x16x32_bf16 v[32:35], v[244:247], v[100:103], v[32:35]
    v_mul_f32 v30, v30, v10
    v_mul_f32 v31, v31, v10
    v_mfma_f32_16x16x32_bf16 v[32:35], v[248:251], v[104:107], v[32:35]
    v_add_f32 v36, 1.0, v36
    v_add_f32 v37, 1.0, v37
    s_waitcnt lgkmcnt(0)
    v_mfma_f32_16x16x32_bf16 v[32:35], v[252:255], v[108:111], v[32:35]
    v_add_f32 v38, 1.0, v38
    v_add_f32 v39, 1.0, v39
    v_rcp_f32 v36, v36
    v_rcp_f32 v37, v37
    v_rcp_f32 v38, v38
    v_rcp_f32 v39, v39
    v_mul_f32 v28, v28, v36
    v_mul_f32 v29, v29, v37
    v_mul_f32 v30, v30, v38
    v_mul_f32 v31, v31, v39
    v_fmac_f32_dpp v32, v32, v25 row_newbcast:8 row_mask:0xf bank_mask:0xf
    v_fmac_f32_dpp v33, v33, v25 row_newbcast:8 row_mask:0xf bank_mask:0xf
    v_fmac_f32_dpp v34, v34, v25 row_newbcast:8 row_mask:0xf bank_mask:0xf
    v_fmac_f32_dpp v35, v35, v25 row_newbcast:8 row_mask:0xf bank_mask:0xf
    v_mul_f32 v28, v28, v32
    v_mul_f32 v29, v29, v33
    v_mul_f32 v30, v30, v34
    v_mul_f32 v31, v31, v35
    v_cvt_pk_bf16_f32 v28, v28, v29
    v_cvt_pk_bf16_f32 v29, v30, v31
    ds_write_b64 v27, v[28:29]
    s_waitcnt lgkmcnt(0)
    s_barrier
    s_cmp_lg_u32 s39, 4
    s_cbranch_scc1 L_gu_end
    v_lshlrev_b32 v36, 5, v13
    v_not_b32 v37, v36
    v_ashrrev_i32 v38, 31, v37
    v_or_b32 v38, 0x80000000, v38
    v_xor_b32 v36, v36, v38
    v_and_b32 v36, 0xffff0000, v36
    v_mul_f32 v36, 0xbfb8aa3b, v36
    v_exp_f32 v36, v36
    v_bfe_u32 v4, v37, 5, 11
    v_mov_b32 v6, v12
    v_mov_b32 v7, v15
    v_add_f32 v36, 1.0, v36
    v_rcp_f32 v5, v36
    v_lshl_or_b32 v4, v4, 8, s45
    s_mov_b64 exec, 0xffff
    global_store_dwordx4 v8, v[4:7], s[36:37] sc1
    s_cmp_lg_u32 s50, 0
    s_cbranch_scc1 L_gu_end
    v_mov_b32 v9, 0
    v_mov_b32 v10, s38
    s_mov_b64 exec, 1
    global_store_dword v9, v10, s[36:37]
L_gu_end:
    s_endpgm
L_end:
    s_endpgm
.fill 96, 4, 0xbf810000
L_last:
.section .rodata,"a"
.p2align 6
.amdhsa_kernel recurrent_scan__ssm_conv_s4__moe_arch_mod__prompt_kernel
  .amdhsa_next_free_vgpr 256
  .amdhsa_next_free_sgpr 102
  .amdhsa_accum_offset 256
  .amdhsa_group_segment_fixed_size 0
  .amdhsa_kernarg_size 136
  .amdhsa_user_sgpr_count 2
  .amdhsa_user_sgpr_kernarg_segment_ptr 1
  .amdhsa_system_sgpr_workgroup_id_x 1
  .amdhsa_float_denorm_mode_32 3
.end_amdhsa_kernel
```

```asm
; @launch grid=(256,1,1) block=(512,1,1) lds=163840
.amdgcn_target "amdgcn-amd-amdhsa--gfx950"
.text
.globl recurrent_scan__ssm_conv_s4__moe_arch_mod__prompt_kernel
.p2align 8
.type recurrent_scan__ssm_conv_s4__moe_arch_mod__prompt_kernel,@function
recurrent_scan__ssm_conv_s4__moe_arch_mod__prompt_kernel:
    s_load_dwordx16 s[4:19], s[0:1], 0
    s_load_dwordx16 s[20:35], s[0:1], 64
    s_load_dwordx2 s[36:37], s[0:1], 128
    s_cmp_ge_u32 s2, 256
    s_cbranch_scc1 L_end
    s_lshr_b32 s41, s2, 3
    s_getpc_b64 s[42:43]
L_pc:
    s_mul_i32 s47, s41, 768
    s_add_u32 s42, s42, s47
    s_addc_u32 s43, s43, 0
    v_lshlrev_b32 v4, 7, v0
    v_mov_b32 v5, s43
    v_add_co_u32 v4, vcc, s42, v4
    v_lshrrev_b32 v1, 6, v0
    v_and_b32 v2, 63, v0
    v_addc_co_u32 v5, vcc, 0, v5, vcc
    s_sub_u32 s47, L_last - L_pc - 4, s47
    s_ashr_i32 s47, s47, 7
    s_min_i32 s47, s47, 5
    v_cmp_ge_i32 vcc, s47, v0
    s_nop 0
    s_and_saveexec_b64 s[48:49], vcc
    s_cbranch_execz L_nopf
    global_load_dword v255, v[4:5], off
L_nopf:
    s_mov_b64 exec, -1
    v_readfirstlane_b32 s39, v1
    s_and_b32 s40, s2, 7
    s_mul_i32 s42, s2, 9216
    v_lshlrev_b32 v3, 4, v2
    v_lshlrev_b32 v4, 1, v2
    v_mul_u32_u24 v5, 1152, v1
    v_add3_u32 v6, v5, v3, s42
    v_add3_u32 v7, v5, v4, s42
    s_waitcnt lgkmcnt(0)
    global_load_dwordx4 v[12:15], v6, s[4:5]
    global_load_ushort v16, v7, s[4:5] offset:1024
    s_load_dword s38, s[36:37], 0
    global_load_dwordx4 v[20:23], v3, s[24:25]
    global_load_ushort v24, v4, s[24:25] offset:1024
    s_and_b32 s51, s39, 3
    s_lshr_b32 s52, s39, 2
    s_cmp_lt_u32 s41, 18
    s_cbranch_scc1 L_conv_pre
    s_cmp_lt_u32 s41, 27
    s_cbranch_scc1 L_ffn_pre
    s_sub_u32 s53, s41, 27
    s_and_b32 s58, s39, 1
    s_lshr_b32 s43, s39, 1
    s_mul_i32 s42, s43, 320
    s_add_u32 s42, s42, 1152
    s_cmp_eq_u32 s43, 0
    s_cmovk_i32 s42, 1152
    s_cmp_eq_u32 s43, 1
    s_cselect_b32 s48, 1, 0
    s_mul_i32 s59, s58, 320
    s_add_u32 s59, s59, 0
    s_cmp_eq_u32 s43, 3
    s_cselect_b32 s42, s59, s42
    s_cmovk_i32 s58, 2
    s_lshl_b32 s53, s53, 6
    s_add_u32 s42, s42, s53
    s_mul_i32 s43, s40, 1152
    s_add_u32 s43, s43, 884736
    s_mul_i32 s59, s40, 663552
    s_cmp_eq_u32 s58, 0
    s_cselect_b32 s56, s26, s28
    s_cselect_b32 s57, s27, s29
    s_cmp_eq_u32 s58, 2
    s_cselect_b32 s56, s30, s56
    s_cselect_b32 s57, s31, s57
    s_cselect_b32 s43, s59, s43
    s_movk_i32 s58, 128
    s_movk_i32 s59, 8064
    s_movk_i32 s60, 4319
    s_cmov_b32 s58, 73728
    s_cmov_b32 s59, -663424
    s_cmovk_i32 s60, 5183
    v_add_u32 v76, s42, v2
    v_min_u32 v76, s60, v76
    v_mul_u32_u24 v63, 7282, v76
    v_lshrrev_b32 v63, 16, v63
    v_mul_u32_u24 v76, s58, v76
    v_mad_i32_i24 v76, v63, s59, v76
    v_add_u32 v76, s43, v76
    s_mov_b32 s49, 0
    s_branch L_lnp
L_ffn_pre:
    s_sub_u32 s54, s41, 18
    s_mul_i32 s50, s40, 9
    s_add_u32 s50, s50, s54
    v_bfe_u32 v76, v0, 3, 5
    v_bfe_u32 v61, v0, 4, 1
    v_bfe_u32 v62, v0, 6, 1
    v_lshl_add_u32 v61, v62, 1, v61
    v_lshlrev_b32 v61, 1, v61
    v_and_b32 v62, 7, v0
    v_xor_b32 v61, v61, v62
    v_mul_u32_u24 v76, 9216, v76
    v_lshlrev_b32 v61, 4, v61
    s_lshl_b32 s42, s50, 7
    v_add3_u32 v76, v76, v61, s42
    s_lshl_b32 s53, s51, 10
    s_cmp_eq_u32 s52, 0
    s_cselect_b32 s56, s26, s28
    s_cselect_b32 s57, s27, s29
    s_cselect_b32 s42, 0, 73728
    s_add_u32 s42, s53, s42
    s_mov_b32 s49, s42
    v_mov_b32 v62, 0
    v_mov_b32 v63, 0
    v_lshrrev_b32 v61, 1, v3
    v_add_u32 v61, 147456, v61
    ds_write_b64 v61, v[62:63]
    s_mov_b32 s47, 3
    s_mov_b32 s48, 0
    s_branch L_lnp
L_conv_pre:
    s_lshl_b32 s50, s40, 4
    s_lshl_b32 s42, s40, 1
    s_add_u32 s42, s42, 112
    s_cmp_ge_u32 s41, 16
    s_cselect_b32 s50, s42, s50
    s_add_u32 s50, s50, s41
    s_lshl_b32 s53, s50, 2
    s_add_u32 s53, s53, s51
    s_lshl_b32 s42, s53, 8
    s_lshl_b32 s43, s52, 7
    s_add_u32 s42, s42, s43
    v_add_u32 v60, s42, v4
    s_lshl_b32 s54, s50, 3
    s_lshl_b32 s42, s53, 1
    v_mov_b32 v61, s42
    v_mov_b64 v[64:65], 0
    v_mov_b64 v[66:67], 0
    v_mov_b64 v[68:69], 0
    v_mov_b64 v[70:71], 0
    s_barrier
    global_load_short_d16_hi v70, v61, s[18:19]
    global_load_short_d16_hi v64, v60, s[6:7]
    global_load_short_d16_hi v65, v60, s[8:9]
    global_load_short_d16_hi v66, v60, s[10:11]
    global_load_short_d16_hi v67, v60, s[12:13]
    global_load_short_d16_hi v68, v60, s[14:15]
    global_load_short_d16_hi v69, v60, s[16:17]
    global_load_short_d16_hi v71, v61, s[20:21]
    global_load_ushort v1, v61, s[20:21]
    s_lshr_b32 s42, s51, 1
    s_mul_i32 s42, s42, 2112
    s_and_b32 s58, s51, 1
    s_mul_i32 s43, s51, 1152
    s_add_u32 s43, s43, 640
    s_lshr_b32 s47, s39, 1
    s_cmp_eq_u32 s47, 0
    s_cmovk_i32 s42, 3168
    s_cmp_eq_u32 s52, 0
    s_cselect_b32 s42, s43, s42
    s_cmovk_i32 s58, 2
    s_lshl_b32 s43, s41, 6
    s_add_u32 s42, s42, s43
    s_mul_i32 s43, s40, 1152
    s_add_u32 s43, s43, 884736
    s_mul_i32 s59, s40, 663552
    s_cmp_eq_u32 s58, 0
    s_cselect_b32 s56, s26, s28
    s_cselect_b32 s57, s27, s29
    s_cmp_eq_u32 s58, 2
    s_cselect_b32 s56, s30, s56
    s_cselect_b32 s57, s31, s57
    s_cselect_b32 s43, s59, s43
    s_movk_i32 s58, 128
    s_movk_i32 s59, 8064
    s_movk_i32 s60, 4319
    s_cmov_b32 s58, 73728
    s_cmov_b32 s59, -663424
    s_cmovk_i32 s60, 5183
    v_add_u32 v76, s42, v2
    v_min_u32 v76, s60, v76
    v_mul_u32_u24 v63, 7282, v76
    v_lshrrev_b32 v63, 16, v63
    v_mul_u32_u24 v76, s58, v76
    v_mad_i32_i24 v76, v63, s59, v76
    v_add_u32 v76, s43, v76
    s_mul_i32 s55, s51, 33792
    s_lshl_b32 s42, s52, 8
    s_add_u32 m0, s55, s42
    s_mul_i32 s63, s51, 4640
    s_add_u32 s63, s63, 135168
    v_mov_b64 v[84:85], 0
    v_mov_b64 v[86:87], 0
    s_cmp_eq_u32 s52, 0
    s_cbranch_scc1 L_cp_m
    s_setprio 1
    v_min_u32 v83, 29, v2
    v_lshl_add_u32 v83, v83, 4, s63
    ds_write_b128 v83, v[84:87]
    v_and_b32 v88, 0x70, v3
    v_add_u32 v88, 153728, v88
    ds_write_b128 v88, v[84:87]
    s_branch L_cp_e
L_cp_m:
    v_and_b32 v8, 15, v0
    v_bfe_u32 v9, v0, 4, 2
    v_and_b32 v10, 31, v0
    v_and_b32 v11, 32, v0
    v_mul_u32_u24 v78, 528, v10
    v_lshrrev_b32 v11, 1, v11
    v_add3_u32 v78, v78, v11, s55
    v_lshl_add_u32 v10, v10, 5, v11
    s_add_u32 s42, s55, 1072
    v_sub_u32 v81, s42, v10
    v_lshrrev_b32 v77, 2, v10
    s_add_u32 s42, s55, 5564
    v_sub_u32 v77, s42, v77
    v_bfe_i32 v79, v0, 4, 1
    v_sub_u32 v80, 495, v10
    v_ashrrev_i32 v80, 31, v80
    v_sub_u32 v82, 1007, v10
    v_ashrrev_i32 v82, 31, v82
    v_bfe_u32 v10, v0, 3, 2
    v_and_b32 v11, 7, v0
    v_mul_u32_u24 v73, 1216, v10
    v_and_b32 v83, 4, v0
    v_lshl_add_u32 v83, v83, 4, v11
    v_lshl_add_u32 v83, v83, 4, v73
    v_lshlrev_b32 v72, 4, v10
    v_add_u32 v72, 5120, v72
    v_sub_u32 v74, 5, v11
    v_ashrrev_i32 v74, 31, v74
    v_bfi_b32 v83, v74, v72, v83
    v_and_b32 v72, 8, v0
    v_mad_u32_u24 v72, v72, 3, v11
    v_lshlrev_b32 v72, 4, v72
    v_add_u32 v72, 5184, v72
    v_bfe_i32 v74, v0, 5, 1
    v_bfi_b32 v83, v74, v72, v83
    v_add_u32 v83, s55, v83
    v_sub_u32 v74, 4, v11
    v_ashrrev_i32 v74, 31, v74
    v_add_u32 v72, 507, v11
    v_min_u32 v75, 2, v11
    v_bfi_b32 v74, v74, v72, v75
    v_sub_u32 v74, v74, v10
    v_lshl_add_u32 v73, v74, 1, v73
    v_min_u32 v74, 1, v10
    v_lshl_add_u32 v73, v74, 3, v73
    s_add_u32 s42, s55, 58
    v_add_u32 v73, s42, v73
    v_max_u32 v72, 4, v11
    v_mul_u32_u24 v72, 0x202, v72
    v_add_u32 v72, 1284, v72
    v_and_b32 v72, 0x707, v72
L_cp_e:
L_clnp:
    s_mul_i32 s43, s39, 1216
    s_add_u32 s43, s43, 154048
    v_add_u32 v52, s43, v3
    v_add_u32 v53, s43, v4
    s_lshl_b32 s43, s39, 3
    s_add_u32 s43, s43, 163776
    v_mov_b32 v54, s43
    v_bfe_u32 v55, v0, 2, 2
    v_mul_u32_u24 v55, 1216, v55
    v_and_b32 v56, 3, v0
    v_lshl_add_u32 v55, v56, 3, v55
    v_lshrrev_b32 v56, 4, v0
    v_lshl_add_u32 v55, v56, 5, v55
    v_add_u32 v55, 154048, v55
    v_lshrrev_b32 v56, 3, v0
    v_lshlrev_b32 v56, 15, v56
    v_and_b32 v57, 112, v3
    s_lshl_b32 s43, s2, 7
    s_add_u32 s43, s43, 2101248
    v_add3_u32 v56, v56, v57, s43
    v_mov_b32 v40, 0
    v_mov_b32 v41, 0
    v_mov_b32 v42, 0
    v_mov_b32 v43, 0
    v_mov_b32 v44, 0x3ae38e39
    v_mov_b32 v38, 0xbfffbfff
    v_mov_b32 v37, 0xffff
    s_lshl_b32 s58, s2, 3
    s_add_u32 s58, s58, s39
    s_xor_b32 s58, s58, 0x7ff
    s_lshl_b32 s58, s58, 5
    s_waitcnt lgkmcnt(0)
    s_add_u32 s38, s38, 0x9e370001
    s_lshr_b32 s44, s38, 16
    s_and_b32 s45, s38, 0xff
    s_and_b32 s46, s38, 0xfb
    s_bitcmp0_b32 s38, 0
    s_cselect_b32 s43, 4, 0
    s_or_b32 s46, s46, s43
    s_bitcmp1_b32 s46, s39
    s_cselect_b32 s43, 0x40004000, 0
    v_mov_b32 v39, s43
    s_xor_b32 s58, s58, s44
    v_mov_b32 v57, s58
    s_mov_b32 s42, 0x3f803f80
    s_cmp_eq_u32 s47, 2
    s_cbranch_scc0 L_clw
    global_load_dword v1, v76, s[56:57]
    s_waitcnt vmcnt(10)
    s_branch L_cln
L_clw:
    s_waitcnt vmcnt(9)
L_cln:
    v_dot2c_f32_bf16 v40, s42, v12
    v_dot2c_f32_bf16 v41, v12, v12
    v_dot2c_f32_bf16 v42, v12, v20
    v_dot2c_f32_bf16 v43, s42, v20
    v_dot2c_f32_bf16 v40, s42, v13
    v_dot2c_f32_bf16 v41, v13, v13
    v_dot2c_f32_bf16 v42, v13, v21
    v_dot2c_f32_bf16 v43, s42, v21
    v_dot2c_f32_bf16 v40, s42, v14
    v_dot2c_f32_bf16 v41, v14, v14
    v_dot2c_f32_bf16 v42, v14, v22
    v_dot2c_f32_bf16 v43, s42, v22
    v_dot2c_f32_bf16 v40, s42, v15
    v_dot2c_f32_bf16 v41, v15, v15
    v_dot2c_f32_bf16 v42, v15, v23
    v_dot2c_f32_bf16 v43, s42, v23
    v_dot2c_f32_bf16 v40, s42, v16
    v_dot2c_f32_bf16 v41, v16, v16
    v_dot2c_f32_bf16 v42, v16, v24
    v_dot2c_f32_bf16 v43, s42, v24
    v_lshlrev_b32 v36, 16, v16
    v_lshlrev_b32 v28, 16, v12
    v_and_b32 v29, 0xffff0000, v12
    v_permlane32_swap_b32 v40, v42
    v_permlane32_swap_b32 v41, v43
    v_add_f32 v40, v40, v42
    v_add_f32 v41, v41, v43
    v_lshlrev_b32 v30, 16, v13
    v_and_b32 v31, 0xffff0000, v13
    v_permlane16_swap_b32 v40, v41
    v_add_f32 v40, v40, v41
    v_lshlrev_b32 v32, 16, v14
    v_and_b32 v33, 0xffff0000, v14
    v_add_f32_dpp v40, v40, v40 row_ror:8 row_mask:0xf bank_mask:0xf
    v_lshlrev_b32 v34, 16, v15
    v_and_b32 v35, 0xffff0000, v15
    v_add_f32_dpp v40, v40, v40 row_ror:4 row_mask:0xf bank_mask:0xf
    s_nop 1
    v_add_f32_dpp v40, v40, v40 row_ror:2 row_mask:0xf bank_mask:0xf
    s_nop 1
    v_add_f32_dpp v40, v40, v40 row_ror:1 row_mask:0xf bank_mask:0xf
    s_nop 0
    v_readlane_b32 s58, v40, 0
    v_readlane_b32 s59, v40, 16
    v_readlane_b32 s60, v40, 32
    v_readlane_b32 s61, v40, 48
    v_mul_f32 v40, s58, v44
    v_mul_f32 v41, s59, v44
    v_fma_f32 v41, -v40, v40, v41
    v_max_f32 v41, 0, v41
    v_cvt_pk_bf16_f32 v44, v41, v40
    v_lshlrev_b32 v41, 16, v44
    v_add_f32 v41, 0x3727c5ac, v41
    v_cvt_pk_bf16_f32 v41, v41, v41
    v_and_b32 v41, 0xffff0000, v41
    v_mul_f32 v41, 0x44800000, v41
    v_sqrt_f32 v41, v41
    v_and_b32 v49, 0xffff0000, v44
    v_cvt_pk_bf16_f32 v50, v49, v41
    v_and_b32 v41, 0xffff0000, v50
    v_rcp_f32 v46, v41
    v_mul_f32 v42, s61, v49
    v_mul_f32 v47, v49, v46
    v_fma_f32 v28, v28, v46, -v47
    v_fma_f32 v29, v29, v46, -v47
    v_fma_f32 v30, v30, v46, -v47
    v_fma_f32 v31, v31, v46, -v47
    v_fma_f32 v32, v32, v46, -v47
    v_fma_f32 v33, v33, v46, -v47
    v_fma_f32 v34, v34, v46, -v47
    v_fma_f32 v35, v35, v46, -v47
    v_fma_f32 v36, v36, v46, -v47
    v_cvt_pk_bf16_f32 v28, v28, v29
    v_cvt_pk_bf16_f32 v29, v30, v31
    v_cvt_pk_bf16_f32 v30, v32, v33
    v_cvt_pk_bf16_f32 v31, v34, v35
    v_cvt_pk_bf16_f32 v32, v36, v36
    v_bitop3_b32 v28, v28, v38, v39 bitop3:0xea
    v_bitop3_b32 v29, v29, v38, v39 bitop3:0xea
    v_bitop3_b32 v30, v30, v38, v39 bitop3:0xea
    v_bitop3_b32 v31, v31, v38, v39 bitop3:0xea
    v_bitop3_b32 v32, v32, v38, v39 bitop3:0xea
    ds_write_b128 v52, v[28:31]
    ds_write_b16 v53, v32 offset:1024
    v_sub_f32 v42, s60, v42
    v_mul_f32 v42, 0x42000000, v42
    v_mul_f32 v42, v42, v46
    v_cvt_pk_bf16_f32 v42, v42, v42
    v_ashrrev_i32 v43, 31, v42
    v_or_b32 v43, 0x80000000, v43
    v_xor_b32 v42, v42, v43
    v_bitop3_b32 v51, v37, v57, v42 bitop3:0xca
    s_mov_b64 exec, 1
    ds_write_b64 v54, v[50:51]
    s_mov_b64 exec, -1
    s_waitcnt lgkmcnt(0)
    s_barrier
    s_cmp_eq_u32 s39, 1
    s_cbranch_scc1 L_cln_stat
    ds_read_b64_tr_b16 v[28:29], v55
    ds_read_b64_tr_b16 v[30:31], v55 offset:4864
    s_cmp_eq_u32 s39, 0
    s_cbranch_scc0 L_cln_st
    ds_read_b64_tr_b16 v[32:33], v55 offset:1024
    ds_read_b64_tr_b16 v[34:35], v55 offset:5888
    v_add_u32 v38, 2097152, v56
    s_waitcnt lgkmcnt(0)
    global_store_dwordx4 v38, v[32:35], s[36:37] sc1
    s_branch L_cln_st
L_cln_stat:
    v_and_b32 v41, 0x30, v3
    v_add_u32 v40, 163776, v41
    ds_read_b128 v[48:51], v40
    ds_read_b64_tr_b16 v[28:29], v55
    ds_read_b64_tr_b16 v[30:31], v55 offset:4864
    s_lshl_b32 s43, s2, 6
    s_add_u32 s43, s43, 16384
    v_add_u32 v41, s43, v41
    s_mov_b64 exec, 15
    s_waitcnt lgkmcnt(2)
    global_store_dwordx4 v41, v[48:51], s[36:37] sc1
    s_mov_b64 exec, -1
L_cln_st:
    s_waitcnt lgkmcnt(0)
    global_store_dwordx4 v56, v[28:31], s[36:37] sc1
    s_waitcnt vmcnt(2)
    v_mul_f32 v70, 0x3fb8aa3b, v70
    v_exp_f32 v70, v70
    v_mov_b32 v34, 0x3f80
    ds_write_addtid_b32 v34
    v_cvt_pk_bf16_f32 v70, v70, v70
    v_and_b32 v70, 0xffff0000, v70
    v_mul_f32 v64, v70, v64
    v_mul_f32 v65, v70, v65
    v_mul_f32 v70, 0x44800000, v70
    v_mul_f32 v64, 0x3fb8aa3b, v64
    v_mul_f32 v65, 0x3e22f983, v65
    v_mul_f32 v66, v70, v66
    v_mul_f32 v67, v70, v67
    v_mul_f32 v13, 0x41800000, v64
    v_mul_f32 v17, 0x41800000, v65
    v_mul_f32 v14, 0x44000000, v64
    v_mul_f32 v18, 0x44000000, v65
    v_exp_f32 v12, v64
    v_fract_f32 v16, v65
    v_exp_f32 v13, v13
    v_fract_f32 v17, v17
    v_exp_f32 v14, v14
    v_fract_f32 v18, v18
    v_pk_mul_f32 v[20:21], v[68:69], v[66:67] op_sel:[0,0] op_sel_hi:[0,1] neg_hi:[0,1]
    v_pk_fma_f32 v[90:91], v[68:69], v[66:67], v[20:21] op_sel:[1,1,0] op_sel_hi:[1,0,1] neg_lo:[0,1,0] neg_hi:[0,1,0]
    v_cos_f32 v22, v16
    v_sin_f32 v23, v16
    v_cos_f32 v24, v17
    v_sin_f32 v25, v17
    v_cos_f32 v26, v18
    v_sin_f32 v27, v18
    v_cvt_pk_bf16_f32 v35, v90, v91
    ds_write_addtid_b32 v35 offset:16896
    v_mul_f32 v22, v12, v22
    v_mul_f32 v23, -v12, v23
    v_mul_f32 v24, v13, v24
    v_mul_f32 v25, v13, v25
    v_mul_f32 v26, v14, v26
    v_mul_f32 v27, -v14, v27
    v_cvt_pk_bf16_f32 v36, v24, v25
    ds_write_addtid_b32 v36 offset:528
L_cs2:
    v_pk_mul_f32 v[30:31], v[24:25], v[24:25] op_sel:[0,0] op_sel_hi:[0,1]
    v_pk_fma_f32 v[28:29], v[24:25], v[24:25], v[30:31] op_sel:[1,1,0] op_sel_hi:[1,0,1] neg_lo:[0,1,0]
    v_cvt_pk_bf16_f32 v34, v28, v29
    ds_write_addtid_b32 v34 offset:1056
    v_pk_mul_f32 v[32:33], v[90:91], v[22:23] op_sel:[0,0] op_sel_hi:[0,1]
    v_pk_fma_f32 v[92:93], v[90:91], v[22:23], v[32:33] op_sel:[1,1,0] op_sel_hi:[1,0,1] neg_lo:[0,1,0]
    v_cvt_pk_bf16_f32 v35, v92, v93
    ds_write_addtid_b32 v35 offset:17424
    v_pk_mul_f32 v[30:31], v[28:29], v[24:25] op_sel:[0,0] op_sel_hi:[0,1]
    v_pk_fma_f32 v[28:29], v[28:29], v[24:25], v[30:31] op_sel:[1,1,0] op_sel_hi:[1,0,1] neg_lo:[0,1,0]
    v_cvt_pk_bf16_f32 v36, v28, v29
    ds_write_addtid_b32 v36 offset:1584
    v_pk_mul_f32 v[32:33], v[92:93], v[22:23] op_sel:[0,0] op_sel_hi:[0,1]
    v_pk_fma_f32 v[94:95], v[92:93], v[22:23], v[32:33] op_sel:[1,1,0] op_sel_hi:[1,0,1] neg_lo:[0,1,0]
    v_cvt_pk_bf16_f32 v37, v94, v95
    ds_write_addtid_b32 v37 offset:17952
    s_cmp_eq_u32 s47, 3
    s_cbranch_scc0 L_ct1
    global_load_dword v1, v76, s[56:57]
L_ct1:
    v_pk_mul_f32 v[30:31], v[28:29], v[24:25] op_sel:[0,0] op_sel_hi:[0,1]
    v_pk_fma_f32 v[28:29], v[28:29], v[24:25], v[30:31] op_sel:[1,1,0] op_sel_hi:[1,0,1] neg_lo:[0,1,0]
    v_cvt_pk_bf16_f32 v34, v28, v29
    ds_write_addtid_b32 v34 offset:2112
    v_pk_mul_f32 v[32:33], v[94:95], v[22:23] op_sel:[0,0] op_sel_hi:[0,1]
    v_pk_fma_f32 v[96:97], v[94:95], v[22:23], v[32:33] op_sel:[1,1,0] op_sel_hi:[1,0,1] neg_lo:[0,1,0]
    v_cvt_pk_bf16_f32 v35, v96, v97
    ds_write_addtid_b32 v35 offset:18480
    v_pk_mul_f32 v[30:31], v[28:29], v[24:25] op_sel:[0,0] op_sel_hi:[0,1]
    v_pk_fma_f32 v[28:29], v[28:29], v[24:25], v[30:31] op_sel:[1,1,0] op_sel_hi:[1,0,1] neg_lo:[0,1,0]
    v_cvt_pk_bf16_f32 v36, v28, v29
    ds_write_addtid_b32 v36 offset:2640
    v_pk_mul_f32 v[32:33], v[96:97], v[22:23] op_sel:[0,0] op_sel_hi:[0,1]
    v_pk_fma_f32 v[98:99], v[96:97], v[22:23], v[32:33] op_sel:[1,1,0] op_sel_hi:[1,0,1] neg_lo:[0,1,0]
    v_cvt_pk_bf16_f32 v37, v98, v99
    ds_write_addtid_b32 v37 offset:21120
    v_pk_mul_f32 v[30:31], v[28:29], v[24:25] op_sel:[0,0] op_sel_hi:[0,1]
    v_pk_fma_f32 v[28:29], v[28:29], v[24:25], v[30:31] op_sel:[1,1,0] op_sel_hi:[1,0,1] neg_lo:[0,1,0]
    v_cvt_pk_bf16_f32 v34, v28, v29
    ds_write_addtid_b32 v34 offset:3168
    v_pk_mul_f32 v[32:33], v[98:99], v[22:23] op_sel:[0,0] op_sel_hi:[0,1]
    v_pk_fma_f32 v[100:101], v[98:99], v[22:23], v[32:33] op_sel:[1,1,0] op_sel_hi:[1,0,1] neg_lo:[0,1,0]
    v_cvt_pk_bf16_f32 v35, v100, v101
    ds_write_addtid_b32 v35 offset:21648
    v_pk_mul_f32 v[30:31], v[28:29], v[24:25] op_sel:[0,0] op_sel_hi:[0,1]
    v_pk_fma_f32 v[28:29], v[28:29], v[24:25], v[30:31] op_sel:[1,1,0] op_sel_hi:[1,0,1] neg_lo:[0,1,0]
    v_cvt_pk_bf16_f32 v36, v28, v29
    ds_write_addtid_b32 v36 offset:3696
    v_pk_mul_f32 v[32:33], v[100:101], v[22:23] op_sel:[0,0] op_sel_hi:[0,1]
    v_pk_fma_f32 v[102:103], v[100:101], v[22:23], v[32:33] op_sel:[1,1,0] op_sel_hi:[1,0,1] neg_lo:[0,1,0]
    v_cvt_pk_bf16_f32 v37, v102, v103
    ds_write_addtid_b32 v37 offset:22176
    v_pk_mul_f32 v[30:31], v[28:29], v[24:25] op_sel:[0,0] op_sel_hi:[0,1]
    v_pk_fma_f32 v[28:29], v[28:29], v[24:25], v[30:31] op_sel:[1,1,0] op_sel_hi:[1,0,1] neg_lo:[0,1,0]
    v_cvt_pk_bf16_f32 v34, v28, v29
    ds_write_addtid_b32 v34 offset:4224
    v_pk_mul_f32 v[32:33], v[102:103], v[22:23] op_sel:[0,0] op_sel_hi:[0,1]
    v_pk_fma_f32 v[104:105], v[102:103], v[22:23], v[32:33] op_sel:[1,1,0] op_sel_hi:[1,0,1] neg_lo:[0,1,0]
    v_cvt_pk_bf16_f32 v35, v104, v105
    ds_write_addtid_b32 v35 offset:22704
    v_pk_mul_f32 v[30:31], v[28:29], v[24:25] op_sel:[0,0] op_sel_hi:[0,1]
    v_pk_fma_f32 v[28:29], v[28:29], v[24:25], v[30:31] op_sel:[1,1,0] op_sel_hi:[1,0,1] neg_lo:[0,1,0]
    v_cvt_pk_bf16_f32 v36, v28, v29
    ds_write_addtid_b32 v36 offset:4752
    v_pk_mul_f32 v[32:33], v[104:105], v[22:23] op_sel:[0,0] op_sel_hi:[0,1]
    v_pk_fma_f32 v[106:107], v[104:105], v[22:23], v[32:33] op_sel:[1,1,0] op_sel_hi:[1,0,1] neg_lo:[0,1,0]
    v_cvt_pk_bf16_f32 v12, v106, v107
    ds_write_addtid_b32 v12 offset:19008
    v_pk_mul_f32 v[30:31], v[28:29], v[24:25] op_sel:[0,0] op_sel_hi:[0,1]
    v_pk_fma_f32 v[28:29], v[28:29], v[24:25], v[30:31] op_sel:[1,1,0] op_sel_hi:[1,0,1] neg_lo:[0,1,0]
    v_cvt_pk_bf16_f32 v34, v28, v29
    ds_write_addtid_b32 v34 offset:5280
    v_pk_mul_f32 v[32:33], v[106:107], v[22:23] op_sel:[0,0] op_sel_hi:[0,1]
    v_pk_fma_f32 v[108:109], v[106:107], v[22:23], v[32:33] op_sel:[1,1,0] op_sel_hi:[1,0,1] neg_lo:[0,1,0]
    v_cvt_pk_bf16_f32 v13, v108, v109
    ds_write_addtid_b32 v13 offset:19536
    v_pk_mul_f32 v[30:31], v[28:29], v[24:25] op_sel:[0,0] op_sel_hi:[0,1]
    v_pk_fma_f32 v[28:29], v[28:29], v[24:25], v[30:31] op_sel:[1,1,0] op_sel_hi:[1,0,1] neg_lo:[0,1,0]
    v_cvt_pk_bf16_f32 v36, v28, v29
    ds_write_addtid_b32 v36 offset:5808
    v_pk_mul_f32 v[32:33], v[108:109], v[22:23] op_sel:[0,0] op_sel_hi:[0,1]
    v_pk_fma_f32 v[110:111], v[108:109], v[22:23], v[32:33] op_sel:[1,1,0] op_sel_hi:[1,0,1] neg_lo:[0,1,0]
    v_cvt_pk_bf16_f32 v14, v110, v111
    ds_write_addtid_b32 v14 offset:20064
    v_pk_mul_f32 v[30:31], v[28:29], v[24:25] op_sel:[0,0] op_sel_hi:[0,1]
    v_pk_fma_f32 v[28:29], v[28:29], v[24:25], v[30:31] op_sel:[1,1,0] op_sel_hi:[1,0,1] neg_lo:[0,1,0]
    v_cvt_pk_bf16_f32 v34, v28, v29
    ds_write_addtid_b32 v34 offset:6336
    v_pk_mul_f32 v[32:33], v[110:111], v[22:23] op_sel:[0,0] op_sel_hi:[0,1]
    v_pk_fma_f32 v[112:113], v[110:111], v[22:23], v[32:33] op_sel:[1,1,0] op_sel_hi:[1,0,1] neg_lo:[0,1,0]
    v_cvt_pk_bf16_f32 v35, v112, v113
    ds_write_addtid_b32 v35 offset:20592
    v_pk_mul_f32 v[30:31], v[28:29], v[24:25] op_sel:[0,0] op_sel_hi:[0,1]
    v_pk_fma_f32 v[28:29], v[28:29], v[24:25], v[30:31] op_sel:[1,1,0] op_sel_hi:[1,0,1] neg_lo:[0,1,0]
    v_cvt_pk_bf16_f32 v36, v28, v29
    ds_write_addtid_b32 v36 offset:6864
    v_pk_mul_f32 v[32:33], v[112:113], v[22:23] op_sel:[0,0] op_sel_hi:[0,1]
    v_pk_fma_f32 v[114:115], v[112:113], v[22:23], v[32:33] op_sel:[1,1,0] op_sel_hi:[1,0,1] neg_lo:[0,1,0]
    v_cvt_pk_bf16_f32 v37, v114, v115
    ds_write_addtid_b32 v37 offset:23232
    v_pk_mul_f32 v[30:31], v[28:29], v[24:25] op_sel:[0,0] op_sel_hi:[0,1]
    v_pk_fma_f32 v[28:29], v[28:29], v[24:25], v[30:31] op_sel:[1,1,0] op_sel_hi:[1,0,1] neg_lo:[0,1,0]
    v_cvt_pk_bf16_f32 v34, v28, v29
    ds_write_addtid_b32 v34 offset:7392
    v_pk_mul_f32 v[32:33], v[114:115], v[22:23] op_sel:[0,0] op_sel_hi:[0,1]
    v_pk_fma_f32 v[116:117], v[114:115], v[22:23], v[32:33] op_sel:[1,1,0] op_sel_hi:[1,0,1] neg_lo:[0,1,0]
    v_cvt_pk_bf16_f32 v35, v116, v117
    ds_write_addtid_b32 v35 offset:23760
    v_pk_mul_f32 v[30:31], v[28:29], v[24:25] op_sel:[0,0] op_sel_hi:[0,1]
    v_pk_fma_f32 v[28:29], v[28:29], v[24:25], v[30:31] op_sel:[1,1,0] op_sel_hi:[1,0,1] neg_lo:[0,1,0]
    v_cvt_pk_bf16_f32 v36, v28, v29
    ds_write_addtid_b32 v36 offset:7920
    v_pk_mul_f32 v[32:33], v[116:117], v[22:23] op_sel:[0,0] op_sel_hi:[0,1]
    v_pk_fma_f32 v[118:119], v[116:117], v[22:23], v[32:33] op_sel:[1,1,0] op_sel_hi:[1,0,1] neg_lo:[0,1,0]
    v_cvt_pk_bf16_f32 v37, v118, v119
    ds_write_addtid_b32 v37 offset:24288
    v_pk_mul_f32 v[30:31], v[28:29], v[24:25] op_sel:[0,0] op_sel_hi:[0,1]
    v_pk_fma_f32 v[28:29], v[28:29], v[24:25], v[30:31] op_sel:[1,1,0] op_sel_hi:[1,0,1] neg_lo:[0,1,0]
    v_cvt_pk_bf16_f32 v34, v28, v29
    ds_write_addtid_b32 v34 offset:8448
    v_pk_mul_f32 v[32:33], v[118:119], v[22:23] op_sel:[0,0] op_sel_hi:[0,1]
    v_pk_fma_f32 v[120:121], v[118:119], v[22:23], v[32:33] op_sel:[1,1,0] op_sel_hi:[1,0,1] neg_lo:[0,1,0]
    v_cvt_pk_bf16_f32 v35, v120, v121
    ds_write_addtid_b32 v35 offset:24816
    v_pk_mul_f32 v[30:31], v[28:29], v[24:25] op_sel:[0,0] op_sel_hi:[0,1]
    v_pk_fma_f32 v[28:29], v[28:29], v[24:25], v[30:31] op_sel:[1,1,0] op_sel_hi:[1,0,1] neg_lo:[0,1,0]
    v_cvt_pk_bf16_f32 v36, v28, v29
    ds_write_addtid_b32 v36 offset:8976
    v_pk_mul_f32 v[32:33], v[120:121], v[22:23] op_sel:[0,0] op_sel_hi:[0,1]
    v_pk_fma_f32 v[122:123], v[120:121], v[22:23], v[32:33] op_sel:[1,1,0] op_sel_hi:[1,0,1] neg_lo:[0,1,0]
    v_cvt_pk_bf16_f32 v37, v122, v123
    ds_write_addtid_b32 v37 offset:27456
    v_pk_mul_f32 v[30:31], v[28:29], v[24:25] op_sel:[0,0] op_sel_hi:[0,1]
    v_pk_fma_f32 v[28:29], v[28:29], v[24:25], v[30:31] op_sel:[1,1,0] op_sel_hi:[1,0,1] neg_lo:[0,1,0]
    v_cvt_pk_bf16_f32 v34, v28, v29
    ds_write_addtid_b32 v34 offset:9504
    v_pk_mul_f32 v[32:33], v[122:123], v[22:23] op_sel:[0,0] op_sel_hi:[0,1]
    v_pk_fma_f32 v[124:125], v[122:123], v[22:23], v[32:33] op_sel:[1,1,0] op_sel_hi:[1,0,1] neg_lo:[0,1,0]
    v_cvt_pk_bf16_f32 v35, v124, v125
    ds_write_addtid_b32 v35 offset:27984
    v_pk_mul_f32 v[30:31], v[28:29], v[24:25] op_sel:[0,0] op_sel_hi:[0,1]
    v_pk_fma_f32 v[28:29], v[28:29], v[24:25], v[30:31] op_sel:[1,1,0] op_sel_hi:[1,0,1] neg_lo:[0,1,0]
    v_cvt_pk_bf16_f32 v36, v28, v29
    ds_write_addtid_b32 v36 offset:10032
    v_pk_mul_f32 v[32:33], v[124:125], v[22:23] op_sel:[0,0] op_sel_hi:[0,1]
    v_pk_fma_f32 v[126:127], v[124:125], v[22:23], v[32:33] op_sel:[1,1,0] op_sel_hi:[1,0,1] neg_lo:[0,1,0]
    v_cvt_pk_bf16_f32 v37, v126, v127
    ds_write_addtid_b32 v37 offset:28512
    v_pk_mul_f32 v[30:31], v[28:29], v[24:25] op_sel:[0,0] op_sel_hi:[0,1]
    v_pk_fma_f32 v[28:29], v[28:29], v[24:25], v[30:31] op_sel:[1,1,0] op_sel_hi:[1,0,1] neg_lo:[0,1,0]
    v_cvt_pk_bf16_f32 v34, v28, v29
    ds_write_addtid_b32 v34 offset:10560
    v_pk_mul_f32 v[32:33], v[98:99], v[26:27] op_sel:[0,0] op_sel_hi:[0,1]
    v_pk_fma_f32 v[98:99], v[98:99], v[26:27], v[32:33] op_sel:[1,1,0] op_sel_hi:[1,0,1] neg_lo:[0,1,0]
    v_cvt_pk_bf16_f32 v35, v98, v99
    ds_write_addtid_b32 v35 offset:29568
    v_pk_mul_f32 v[30:31], v[28:29], v[24:25] op_sel:[0,0] op_sel_hi:[0,1]
    v_pk_fma_f32 v[28:29], v[28:29], v[24:25], v[30:31] op_sel:[1,1,0] op_sel_hi:[1,0,1] neg_lo:[0,1,0]
    v_cvt_pk_bf16_f32 v36, v28, v29
    ds_write_addtid_b32 v36 offset:11088
    v_pk_mul_f32 v[32:33], v[106:107], v[26:27] op_sel:[0,0] op_sel_hi:[0,1]
    v_pk_fma_f32 v[106:107], v[106:107], v[26:27], v[32:33] op_sel:[1,1,0] op_sel_hi:[1,0,1] neg_lo:[0,1,0]
    v_cvt_pk_bf16_f32 v37, v106, v107
    ds_write_addtid_b32 v37 offset:30096
    v_pk_mul_f32 v[30:31], v[28:29], v[24:25] op_sel:[0,0] op_sel_hi:[0,1]
    v_pk_fma_f32 v[28:29], v[28:29], v[24:25], v[30:31] op_sel:[1,1,0] op_sel_hi:[1,0,1] neg_lo:[0,1,0]
    v_cvt_pk_bf16_f32 v34, v28, v29
    ds_write_addtid_b32 v34 offset:11616
    v_pk_mul_f32 v[32:33], v[114:115], v[26:27] op_sel:[0,0] op_sel_hi:[0,1]
    v_pk_fma_f32 v[114:115], v[114:115], v[26:27], v[32:33] op_sel:[1,1,0] op_sel_hi:[1,0,1] neg_lo:[0,1,0]
    v_cvt_pk_bf16_f32 v35, v114, v115
    ds_write_addtid_b32 v35 offset:31680
    v_pk_mul_f32 v[30:31], v[28:29], v[24:25] op_sel:[0,0] op_sel_hi:[0,1]
    v_pk_fma_f32 v[28:29], v[28:29], v[24:25], v[30:31] op_sel:[1,1,0] op_sel_hi:[1,0,1] neg_lo:[0,1,0]
    v_cvt_pk_bf16_f32 v36, v28, v29
    ds_write_addtid_b32 v36 offset:12144
    v_pk_mul_f32 v[32:33], v[122:123], v[26:27] op_sel:[0,0] op_sel_hi:[0,1]
    v_pk_fma_f32 v[122:123], v[122:123], v[26:27], v[32:33] op_sel:[1,1,0] op_sel_hi:[1,0,1] neg_lo:[0,1,0]
    v_cvt_pk_bf16_f32 v37, v122, v123
    ds_write_addtid_b32 v37 offset:32208
    v_pk_mul_f32 v[30:31], v[28:29], v[24:25] op_sel:[0,0] op_sel_hi:[0,1]
    v_pk_fma_f32 v[28:29], v[28:29], v[24:25], v[30:31] op_sel:[1,1,0] op_sel_hi:[1,0,1] neg_lo:[0,1,0]
    v_cvt_pk_bf16_f32 v34, v28, v29
    ds_write_addtid_b32 v34 offset:12672
    v_pk_mul_f32 v[32:33], v[106:107], v[26:27] op_sel:[0,0] op_sel_hi:[0,1]
    v_pk_fma_f32 v[106:107], v[106:107], v[26:27], v[32:33] op_sel:[1,1,0] op_sel_hi:[1,0,1] neg_lo:[0,1,0]
    v_cvt_pk_bf16_f32 v35, v106, v107
    ds_write_addtid_b32 v35 offset:30624
    v_pk_mul_f32 v[30:31], v[28:29], v[24:25] op_sel:[0,0] op_sel_hi:[0,1]
    v_pk_fma_f32 v[28:29], v[28:29], v[24:25], v[30:31] op_sel:[1,1,0] op_sel_hi:[1,0,1] neg_lo:[0,1,0]
    v_cvt_pk_bf16_f32 v36, v28, v29
    ds_write_addtid_b32 v36 offset:13200
    v_pk_mul_f32 v[32:33], v[122:123], v[26:27] op_sel:[0,0] op_sel_hi:[0,1]
    v_pk_fma_f32 v[122:123], v[122:123], v[26:27], v[32:33] op_sel:[1,1,0] op_sel_hi:[1,0,1] neg_lo:[0,1,0]
    v_cvt_pk_bf16_f32 v37, v122, v123
    ds_write_addtid_b32 v37 offset:31152
    v_pk_mul_f32 v[30:31], v[28:29], v[24:25] op_sel:[0,0] op_sel_hi:[0,1]
    v_pk_fma_f32 v[28:29], v[28:29], v[24:25], v[30:31] op_sel:[1,1,0] op_sel_hi:[1,0,1] neg_lo:[0,1,0]
    v_cvt_pk_bf16_f32 v34, v28, v29
    ds_write_addtid_b32 v34 offset:13728
    v_pk_mul_f32 v[32:33], v[106:107], v[26:27] op_sel:[0,0] op_sel_hi:[0,1]
    v_pk_fma_f32 v[106:107], v[106:107], v[26:27], v[32:33] op_sel:[1,1,0] op_sel_hi:[1,0,1] neg_lo:[0,1,0]
    v_cvt_pk_bf16_f32 v35, v106, v107
    ds_write_addtid_b32 v35 offset:32736
    v_pk_mul_f32 v[30:31], v[28:29], v[24:25] op_sel:[0,0] op_sel_hi:[0,1]
    v_pk_fma_f32 v[28:29], v[28:29], v[24:25], v[30:31] op_sel:[1,1,0] op_sel_hi:[1,0,1] neg_lo:[0,1,0]
    v_cvt_pk_bf16_f32 v36, v28, v29
    ds_write_addtid_b32 v36 offset:14256
    v_pk_mul_f32 v[32:33], v[122:123], v[26:27] op_sel:[0,0] op_sel_hi:[0,1]
    v_pk_fma_f32 v[122:123], v[122:123], v[26:27], v[32:33] op_sel:[1,1,0] op_sel_hi:[1,0,1] neg_lo:[0,1,0]
    v_cvt_pk_bf16_f32 v37, v122, v123
    ds_write_addtid_b32 v37 offset:33264
    v_pk_mul_f32 v[30:31], v[28:29], v[24:25] op_sel:[0,0] op_sel_hi:[0,1]
    v_pk_fma_f32 v[28:29], v[28:29], v[24:25], v[30:31] op_sel:[1,1,0] op_sel_hi:[1,0,1] neg_lo:[0,1,0]
    v_cvt_pk_bf16_f32 v34, v28, v29
    ds_write_addtid_b32 v34 offset:14784
    v_pk_mul_f32 v[30:31], v[28:29], v[24:25] op_sel:[0,0] op_sel_hi:[0,1]
    v_pk_fma_f32 v[28:29], v[28:29], v[24:25], v[30:31] op_sel:[1,1,0] op_sel_hi:[1,0,1] neg_lo:[0,1,0]
    v_cvt_pk_bf16_f32 v36, v28, v29
    ds_write_addtid_b32 v36 offset:15312
    v_pk_mul_f32 v[30:31], v[28:29], v[24:25] op_sel:[0,0] op_sel_hi:[0,1]
    v_pk_fma_f32 v[28:29], v[28:29], v[24:25], v[30:31] op_sel:[1,1,0] op_sel_hi:[1,0,1] neg_lo:[0,1,0]
    v_cvt_pk_bf16_f32 v34, v28, v29
    ds_write_addtid_b32 v34 offset:15840
    v_pk_mul_f32 v[30:31], v[28:29], v[24:25] op_sel:[0,0] op_sel_hi:[0,1]
    v_pk_fma_f32 v[28:29], v[28:29], v[24:25], v[30:31] op_sel:[1,1,0] op_sel_hi:[1,0,1] neg_lo:[0,1,0]
    v_cvt_pk_bf16_f32 v36, v28, v29
    ds_write_addtid_b32 v36 offset:16368
    ds_write_addtid_b32 v12 offset:25344
    ds_write_addtid_b32 v13 offset:25872
    ds_write_addtid_b32 v14 offset:26400
    s_cmp_eq_u32 s52, 0
    s_cbranch_scc0 L_helper
    s_setprio 2
    s_barrier
    ds_read_b128 v[128:131], v78 offset:16896
    ds_read_b128 v[132:135], v78 offset:0
    ds_read_b128 v[136:139], v78 offset:16928
    ds_read_b128 v[140:143], v78 offset:32
    ds_read_b128 v[144:147], v78 offset:16960
    ds_read_b128 v[148:151], v78 offset:64
    ds_read_b128 v[152:155], v78 offset:16992
    ds_read_b128 v[156:159], v78 offset:96
    ds_read_b128 v[160:163], v78 offset:17024
    ds_read_b128 v[164:167], v78 offset:128
    ds_read_b128 v[168:171], v78 offset:17056
    ds_read_b128 v[172:175], v78 offset:160
    v_add_u32 v74, -1, v2
    v_and_b32 v71, v71, v74
    v_mul_f32 v71, 0x44800000, v71
    v_and_b32 v10, 3, v8
    v_add_u32 v5, 1, v10
    v_mul_u32_u24 v10, 1214, v10
    s_waitcnt lgkmcnt(10)
    v_mfma_f32_32x32x16_bf16 v[48:63], v[128:131], v[132:135], 0
    ds_read_b128 v[176:179], v78 offset:17088
    ds_read_b128 v[180:183], v78 offset:192
    v_lshl_add_u32 v11, v8, 1, v9
    s_waitcnt lgkmcnt(10)
    v_mfma_f32_32x32x16_bf16 v[48:63], v[136:139], v[140:143], v[48:63]
    ds_read_b128 v[184:187], v78 offset:17120
    ds_read_b128 v[188:191], v78 offset:224
    v_mul_u32_u24 v4, 17, v9
    s_waitcnt lgkmcnt(10)
    v_mfma_f32_32x32x16_bf16 v[48:63], v[144:147], v[148:151], v[48:63]
    ds_read_b128 v[192:195], v78 offset:17152
    ds_read_b128 v[196:199], v78 offset:256
    v_sub_u32 v4, v4, v11
    s_waitcnt lgkmcnt(10)
    v_mfma_f32_32x32x16_bf16 v[48:63], v[152:155], v[156:159], v[48:63]
    ds_read_b128 v[200:203], v78 offset:17184
    ds_read_b128 v[204:207], v78 offset:288
    v_and_b32 v5, 4, v5
    s_waitcnt lgkmcnt(10)
    v_mfma_f32_32x32x16_bf16 v[48:63], v[160:163], v[164:167], v[48:63]
    ds_read_b128 v[208:211], v78 offset:17216
    ds_read_b128 v[212:215], v78 offset:320
    s_add_u32 s43, s55, 3680
    s_waitcnt lgkmcnt(10)
    v_mfma_f32_32x32x16_bf16 v[48:63], v[168:171], v[172:175], v[48:63]
    ds_read_b128 v[216:219], v78 offset:17248
    ds_read_b128 v[220:223], v78 offset:352
    v_lshl_add_u32 v10, v5, 1, v10
    s_waitcnt lgkmcnt(10)
    v_mfma_f32_32x32x16_bf16 v[48:63], v[176:179], v[180:183], v[48:63]
    ds_read_b128 v[224:227], v78 offset:17280
    ds_read_b128 v[228:231], v78 offset:384
    v_sub_u32 v10, v4, v10
    s_waitcnt lgkmcnt(10)
    v_mfma_f32_32x32x16_bf16 v[48:63], v[184:187], v[188:191], v[48:63]
    ds_read_b128 v[232:235], v78 offset:17312
    ds_read_b128 v[236:239], v78 offset:416
    v_add_u32 v10, s43, v10
    s_waitcnt lgkmcnt(10)
    v_mfma_f32_32x32x16_bf16 v[48:63], v[192:195], v[196:199], v[48:63]
    ds_read_b128 v[240:243], v78 offset:17344
    ds_read_b128 v[244:247], v78 offset:448
    v_lshl_add_u32 v11, v11, 4, s63
    s_waitcnt lgkmcnt(10)
    v_mfma_f32_32x32x16_bf16 v[48:63], v[200:203], v[204:207], v[48:63]
    ds_read_b128 v[248:251], v78 offset:17376
    ds_read_b128 v[252:255], v78 offset:480
    s_add_u32 s43, s55, 5116
    s_waitcnt lgkmcnt(10)
    v_mfma_f32_32x32x16_bf16 v[48:63], v[208:211], v[212:215], v[48:63]
    v_lshrrev_b32 v75, 2, v3
    s_waitcnt lgkmcnt(8)
    v_mfma_f32_32x32x16_bf16 v[48:63], v[216:219], v[220:223], v[48:63]
    v_sub_u32 v75, s43, v75
    s_waitcnt lgkmcnt(6)
    v_mfma_f32_32x32x16_bf16 v[48:63], v[224:227], v[228:231], v[48:63]
    v_lshl_add_u32 v7, v9, 6, v3
    s_waitcnt lgkmcnt(4)
    v_mfma_f32_32x32x16_bf16 v[48:63], v[232:235], v[236:239], v[48:63]
    v_add_u32 v7, s55, v7
    s_waitcnt lgkmcnt(2)
    v_mfma_f32_32x32x16_bf16 v[48:63], v[240:243], v[244:247], v[48:63]
    v_lshlrev_b32 v4, 2, v9
    s_waitcnt lgkmcnt(0)
    v_mfma_f32_32x32x16_bf16 v[48:63], v[248:251], v[252:255], v[48:63]
    v_sub_u32 v4, v4, v8
    ds_write_b128 v83, v[84:87]
    s_add_u32 s43, s55, 5304
    v_lshl_add_u32 v89, v4, 3, s43
    s_add_u32 s43, s55, 4924
    v_lshl_add_u32 v4, v4, 2, s43
    s_lshl_b32 s43, s51, 2
    s_add_u32 s43, s43, 153728
    v_mov_b32 v88, s43
    v_add_u32 v5, 154048, v3
    s_nop 1
    v_add_f32 v48, v48, v71
    v_bitop3_b32 v49, v79, v48, v49 bitop3:0xca
    v_bitop3_b32 v51, v79, v52, v51 bitop3:0xca
    v_bitop3_b32 v53, v79, v52, v53 bitop3:0xca
    v_bitop3_b32 v55, v79, v56, v55 bitop3:0xca
    v_cvt_pk_bf16_f32 v128, v55, v54
    v_cvt_pk_bf16_f32 v129, v53, v52
    v_cvt_pk_bf16_f32 v130, v51, v50
    v_cvt_pk_bf16_f32 v131, v49, v48
    ds_write_b128 v81, v[128:131] offset:0
    v_bitop3_b32 v57, v80, v56, v57 bitop3:0xca
    v_bitop3_b32 v58, v82, v56, v58 bitop3:0xca
    v_cvt_pk_bf16_f32 v132, v56, v55
    v_cvt_pk_bf16_f32 v133, v54, v53
    v_cvt_pk_bf16_f32 v134, v52, v51
    v_cvt_pk_bf16_f32 v135, v50, v49
    ds_write_b128 v81, v[132:135] offset:3648
    v_readlane_b32 s42, v130, 0
    v_readlane_b32 s43, v131, 0
    v_readlane_b32 s58, v128, 63
    v_cvt_pk_bf16_f32 v136, v57, v56
    v_cvt_pk_bf16_f32 v137, v55, v54
    v_cvt_pk_bf16_f32 v138, v53, v52
    v_cvt_pk_bf16_f32 v139, v51, v50
    ds_write_b128 v81, v[136:139] offset:2432
    s_pack_lh_b32_b16 s42, s58, s42
    v_mov_b32 v71, s42
    v_perm_b32 v71, v71, s43, v72
    v_cvt_pk_bf16_f32 v140, v58, v57
    v_cvt_pk_bf16_f32 v141, v56, v55
    v_cvt_pk_bf16_f32 v142, v54, v53
    v_cvt_pk_bf16_f32 v143, v52, v51
    ds_write_b128 v81, v[140:143] offset:1216
    ds_write_b16 v73, v71
    v_cvt_pk_bf16_f32 v72, v61, v60
    v_cvt_pk_bf16_f32 v74, v63, v62
    ds_write_b32 v77, v72
    v_readlane_b32 s59, v72, 63
    ds_write_b32 v75, v74
    s_and_b32 s59, s59, 0xffff
    v_mov_b32 v90, v76
    ds_read_b64 v[220:221], v10 offset:576
    ds_read_b64 v[222:223], v10 offset:584
    ds_read_b64 v[252:253], v10 offset:64
    ds_read_b64 v[254:255], v10 offset:72
    ds_read_b64 v[216:217], v10 offset:640
    ds_read_b64 v[218:219], v10 offset:648
    ds_read_b64 v[248:249], v10 offset:128
    ds_read_b64 v[250:251], v10 offset:136
    ds_read_b64 v[212:213], v10 offset:704
    ds_read_b64 v[214:215], v10 offset:712
    ds_read_b64 v[244:245], v10 offset:192
    ds_read_b64 v[246:247], v10 offset:200
    ds_read_b64 v[208:209], v10 offset:768
    s_movk_i32 s43, 0x3000
    ds_read_b64 v[210:211], v10 offset:776
    v_lshlrev_b32 v6, v8, s43
    ds_read_b64 v[240:241], v10 offset:256
    v_lshlrev_b32 v16, 3, v9
    ds_read_b64 v[242:243], v10 offset:264
    v_bfe_u32 v6, v6, v16, 8
    ds_read_b64 v[204:205], v10 offset:832
    v_lshl_or_b32 v6, v6, 15, v6
    ds_read_b64 v[206:207], v10 offset:840
    v_lshrrev_b32 v16, 0, v6
    ds_read_b64 v[236:237], v10 offset:320
    v_and_b32 v16, 0x10001, v16
    ds_read_b64 v[238:239], v10 offset:328
    v_mul_u32_u24 v16, s59, v16
    ds_read_b64 v[200:201], v10 offset:896
    v_lshrrev_b32 v17, 2, v6
    ds_read_b64 v[202:203], v10 offset:904
    v_and_b32 v17, 0x10001, v17
    ds_read_b64 v[232:233], v10 offset:384
    v_mul_u32_u24 v17, s59, v17
    ds_read_b64 v[234:235], v10 offset:392
    v_lshrrev_b32 v18, 4, v6
    v_and_b32 v18, 0x10001, v18
    v_mul_u32_u24 v18, s59, v18
    v_lshrrev_b32 v19, 6, v6
    v_and_b32 v19, 0x10001, v19
    v_mul_u32_u24 v19, s59, v19
    s_waitcnt lgkmcnt(6)
    s_barrier
    s_setprio 1
    ds_read_b128 v[68:71], v11 offset:0
    ds_read_b128 v[72:75], v11 offset:64
    ds_read_b128 v[76:79], v11 offset:128
    ds_read_b128 v[80:83], v11 offset:192
    ds_read_b128 v[84:87], v11 offset:256
    ds_read_b128 v[132:135], v11 offset:320
    ds_read_b64 v[196:197], v10 offset:960
    ds_read_b64 v[198:199], v10 offset:968
    s_waitcnt lgkmcnt(7)
    v_mfma_f32_16x16x32_bf16 v[44:47], v[220:223], v[68:71], 0
    v_mfma_f32_16x16x32_bf16 v[48:51], v[252:255], v[68:71], 0
    s_cmp_lt_u32 s39, 2
    s_cbranch_scc0 L_ct3
    global_load_dword v1, v90, s[56:57]
L_ct3:
    ds_read_b128 v[68:71], v11 offset:384
    s_waitcnt lgkmcnt(6)
    v_mfma_f32_16x16x32_bf16 v[44:47], v[216:219], v[72:75], v[44:47]
    ds_read_b64 v[228:229], v10 offset:448
    v_mfma_f32_16x16x32_bf16 v[48:51], v[248:251], v[72:75], v[48:51]
    ds_read_b64 v[230:231], v10 offset:456
    v_mfma_f32_16x16x32_bf16 v[44:47], v[212:215], v[76:79], v[44:47]
    ds_read_b64 v[192:193], v10 offset:1024
    ds_read_b64 v[194:195], v10 offset:1032
    v_mfma_f32_16x16x32_bf16 v[48:51], v[244:247], v[76:79], v[48:51]
    ds_read_b128 v[72:75], v11 offset:448
    ds_read_b64 v[224:225], v10 offset:512
    s_waitcnt lgkmcnt(10)
    v_mfma_f32_16x16x32_bf16 v[44:47], v[208:211], v[80:83], v[44:47]
    ds_read_b64 v[226:227], v10 offset:520
    ds_read_b128 v[28:31], v5 offset:1024
    v_mfma_f32_16x16x32_bf16 v[48:51], v[240:243], v[80:83], v[48:51]
    ds_read_b128 v[32:35], v5 offset:2048
    ds_read_b128 v[36:39], v5 offset:3072
    v_mfma_f32_16x16x32_bf16 v[44:47], v[204:207], v[84:87], v[44:47]
    ds_read_b128 v[20:23], v5 offset:4096
    v_mfma_f32_16x16x32_bf16 v[48:51], v[236:239], v[84:87], v[48:51]
    s_waitcnt lgkmcnt(9)
    v_mfma_f32_16x16x32_bf16 v[44:47], v[200:203], v[132:135], v[44:47]
    ds_read_b128 v[24:27], v5 offset:5120
    ds_read_b64 v[12:13], v10 offset:0
    v_mfma_f32_16x16x32_bf16 v[48:51], v[232:235], v[132:135], v[48:51]
    ds_read_b64 v[14:15], v10 offset:8
    v_mfma_f32_16x16x32_bf16 v[44:47], v[196:199], v[68:71], v[44:47]
    ds_read_b128 v[76:79], v11 offset:432
    v_mfma_f32_16x16x32_bf16 v[48:51], v[228:231], v[68:71], v[48:51]
    ds_read_b128 v[80:83], v11 offset:512
    s_waitcnt lgkmcnt(9)
    v_mfma_f32_16x16x32_bf16 v[44:47], v[192:195], v[72:75], v[44:47]
    ds_read_b128 v[84:87], v11 offset:576
    v_mfma_f32_16x16x32_bf16 v[48:51], v[224:227], v[72:75], v[48:51]
    s_waitcnt lgkmcnt(5)
    ds_read_b128 v[132:135], v11 offset:640
    v_mfma_f32_16x16x32_bf16 v[108:111], v[72:75], v[28:31], 0
    ds_read_b128 v[68:71], v11 offset:704
    v_mfma_f32_16x16x32_bf16 v[112:115], v[72:75], v[32:35], 0
    s_waitcnt lgkmcnt(5)
    v_mfma_f32_16x16x32_bf16 v[52:55], v[12:15], v[72:75], 0
    v_mfma_f32_16x16x32_bf16 v[116:119], v[72:75], v[36:39], 0
    ds_write_b128 v7, v[44:47] offset:9472
    v_mfma_f32_16x16x32_bf16 v[124:127], v[72:75], v[20:23], 0
    v_mfma_f32_16x16x32_bf16 v[60:63], v[16:19], v[72:75], 0
    ds_read_b128 v[72:75], v11 offset:768
    s_waitcnt lgkmcnt(5)
    v_mfma_f32_16x16x32_bf16 v[120:123], v[76:79], v[32:35], 0
    ds_write_b32 v88, v88 offset:0
    v_mfma_f32_16x16x32_bf16 v[128:131], v[76:79], v[24:27], 0
    ds_read_b128 v[76:79], v11 offset:832
    v_mfma_f32_16x16x32_bf16 v[48:51], v[220:223], v[80:83], v[48:51]
    v_mfma_f32_16x16x32_bf16 v[52:55], v[252:255], v[80:83], v[52:55]
    ds_read_b128 v[80:83], v11 offset:896
    s_waitcnt lgkmcnt(6)
    v_mfma_f32_16x16x32_bf16 v[48:51], v[216:219], v[84:87], v[48:51]
    v_mfma_f32_16x16x32_bf16 v[52:55], v[248:251], v[84:87], v[52:55]
    ds_read_b128 v[84:87], v11 offset:960
    v_cvt_pk_bf16_f32 v136, v120, v116
    v_mfma_f32_16x16x32_bf16 v[48:51], v[212:215], v[132:135], v[48:51]
    v_cvt_pk_bf16_f32 v137, v112, v108
    v_mfma_f32_16x16x32_bf16 v[52:55], v[244:247], v[132:135], v[52:55]
    s_waitcnt lgkmcnt(4)
    v_cvt_pk_bf16_f32 v138, v121, v117
    v_mfma_f32_16x16x32_bf16 v[48:51], v[208:211], v[68:71], v[48:51]
    v_cvt_pk_bf16_f32 v139, v113, v109
    v_mfma_f32_16x16x32_bf16 v[52:55], v[240:243], v[68:71], v[52:55]
    ds_read_b128 v[132:135], v11 offset:944
    v_cvt_pk_bf16_f32 v140, v122, v118
    v_mfma_f32_16x16x32_bf16 v[48:51], v[204:207], v[72:75], v[48:51]
    v_cvt_pk_bf16_f32 v141, v114, v110
    v_mfma_f32_16x16x32_bf16 v[52:55], v[236:239], v[72:75], v[52:55]
    ds_read_b128 v[68:71], v11 offset:1024
    s_waitcnt lgkmcnt(3)
    v_mfma_f32_16x16x32_bf16 v[48:51], v[200:203], v[76:79], v[48:51]
    v_cvt_pk_bf16_f32 v142, v123, v119
    v_mfma_f32_16x16x32_bf16 v[52:55], v[232:235], v[76:79], v[52:55]
    ds_read_b64 v[168:169], v89 offset:256
    v_cvt_pk_bf16_f32 v143, v115, v111
    v_mfma_f32_16x16x32_bf16 v[48:51], v[196:199], v[80:83], v[48:51]
    ds_read_b64 v[170:171], v89 offset:264
    v_cvt_pk_bf16_f32 v92, v128, v124
    v_mfma_f32_16x16x32_bf16 v[52:55], v[228:231], v[80:83], v[52:55]
    ds_read_b128 v[72:75], v11 offset:1088
    s_waitcnt lgkmcnt(5)
    v_mfma_f32_16x16x32_bf16 v[48:51], v[192:195], v[84:87], v[48:51]
    ds_read_b64 v[172:173], v89 offset:272
    v_cvt_pk_bf16_f32 v93, v129, v125
    v_mfma_f32_16x16x32_bf16 v[52:55], v[224:227], v[84:87], v[52:55]
    ds_read_b64 v[174:175], v89 offset:280
    v_cvt_pk_bf16_f32 v94, v130, v126
    v_mfma_f32_16x16x32_bf16 v[108:111], v[84:87], v[28:31], 0
    ds_read_b128 v[76:79], v11 offset:1152
    v_cvt_pk_bf16_f32 v95, v131, v127
    v_mfma_f32_16x16x32_bf16 v[112:115], v[84:87], v[32:35], 0
    v_mfma_f32_16x16x32_bf16 v[56:59], v[12:15], v[84:87], 0
    ds_read_b128 v[80:83], v11 offset:1216
    v_mfma_f32_16x16x32_bf16 v[116:119], v[84:87], v[36:39], 0
    ds_write_b128 v7, v[48:51] offset:10752
    v_mfma_f32_16x16x32_bf16 v[124:127], v[84:87], v[20:23], 0
    v_mfma_f32_16x16x32_bf16 v[64:67], v[16:19], v[84:87], 0
    ds_read_b128 v[84:87], v11 offset:1280
    s_waitcnt lgkmcnt(9)
    v_mfma_f32_16x16x32_bf16 v[120:123], v[132:135], v[32:35], 0
    ds_write_b32 v88, v88 offset:16
    v_mfma_f32_16x16x32_bf16 v[128:131], v[132:135], v[24:27], 0
    ds_read_b128 v[132:135], v11 offset:1344
    v_mfma_f32_16x16x32_bf16 v[52:55], v[220:223], v[68:71], v[52:55]
    v_mfma_f32_16x16x32_bf16 v[56:59], v[252:255], v[68:71], v[56:59]
    ds_read_b128 v[68:71], v11 offset:1408
    s_waitcnt lgkmcnt(7)
    v_mfma_f32_16x16x32_bf16 v[52:55], v[136:139], v[168:171], v[52:55]
    v_mfma_f32_16x16x32_bf16 v[52:55], v[216:219], v[72:75], v[52:55]
    v_mfma_f32_16x16x32_bf16 v[56:59], v[248:251], v[72:75], v[56:59]
    ds_read_b128 v[72:75], v11 offset:1472
    v_mfma_f32_16x16x32_bf16 v[52:55], v[140:143], v[172:175], v[52:55]
    s_waitcnt lgkmcnt(6)
    v_cvt_pk_bf16_f32 v144, v120, v116
    v_mfma_f32_16x16x32_bf16 v[52:55], v[212:215], v[76:79], v[52:55]
    v_cvt_pk_bf16_f32 v145, v112, v108
    v_mfma_f32_16x16x32_bf16 v[56:59], v[244:247], v[76:79], v[56:59]
    v_cvt_pk_bf16_f32 v146, v121, v117
    v_mfma_f32_16x16x32_bf16 v[52:55], v[208:211], v[80:83], v[52:55]
    v_cvt_pk_bf16_f32 v147, v113, v109
    v_mfma_f32_16x16x32_bf16 v[56:59], v[240:243], v[80:83], v[56:59]
    ds_read_b128 v[76:79], v11 offset:1456
    s_waitcnt lgkmcnt(3)
    v_mfma_f32_16x16x32_bf16 v[52:55], v[204:207], v[84:87], v[52:55]
    v_cvt_pk_bf16_f32 v148, v122, v118
    v_mfma_f32_16x16x32_bf16 v[56:59], v[236:239], v[84:87], v[56:59]
    ds_read_b128 v[80:83], v11 offset:1536
    v_cvt_pk_bf16_f32 v149, v114, v110
    v_mfma_f32_16x16x32_bf16 v[52:55], v[200:203], v[132:135], v[52:55]
    v_cvt_pk_bf16_f32 v150, v123, v119
    v_mfma_f32_16x16x32_bf16 v[56:59], v[232:235], v[132:135], v[56:59]
    ds_read_b64 v[176:177], v89 offset:128
    s_waitcnt lgkmcnt(3)
    v_mfma_f32_16x16x32_bf16 v[52:55], v[196:199], v[68:71], v[52:55]
    ds_read_b64 v[178:179], v89 offset:136
    v_cvt_pk_bf16_f32 v151, v115, v111
    v_mfma_f32_16x16x32_bf16 v[56:59], v[228:231], v[68:71], v[56:59]
    ds_read_b128 v[84:87], v11 offset:1600
    v_cvt_pk_bf16_f32 v96, v128, v124
    v_mfma_f32_16x16x32_bf16 v[52:55], v[192:195], v[72:75], v[52:55]
    ds_read_b64 v[180:181], v89 offset:144
    v_cvt_pk_bf16_f32 v97, v129, v125
    v_mfma_f32_16x16x32_bf16 v[56:59], v[224:227], v[72:75], v[56:59]
    ds_read_b64 v[182:183], v89 offset:152
    v_cvt_pk_bf16_f32 v98, v130, v126
    v_mfma_f32_16x16x32_bf16 v[108:111], v[72:75], v[28:31], 0
    ds_read_b128 v[132:135], v11 offset:1664
    v_cvt_pk_bf16_f32 v99, v131, v127
    v_mfma_f32_16x16x32_bf16 v[112:115], v[72:75], v[32:35], 0
    v_mfma_f32_16x16x32_bf16 v[60:63], v[12:15], v[72:75], v[60:63]
    v_mfma_f32_16x16x32_bf16 v[116:119], v[72:75], v[36:39], 0
    ds_read_b128 v[68:71], v11 offset:1728
    ds_write_b128 v7, v[52:55] offset:12032
    v_mfma_f32_16x16x32_bf16 v[124:127], v[72:75], v[20:23], 0
    v_mfma_f32_16x16x32_bf16 v[44:47], v[16:19], v[72:75], 0
    ds_read_b128 v[72:75], v11 offset:1792
    s_waitcnt lgkmcnt(9)
    v_mfma_f32_16x16x32_bf16 v[120:123], v[76:79], v[32:35], 0
    ds_write_b32 v88, v88 offset:32
    v_mfma_f32_16x16x32_bf16 v[128:131], v[76:79], v[24:27], 0
    ds_read_b128 v[76:79], v11 offset:1856
    v_mfma_f32_16x16x32_bf16 v[56:59], v[220:223], v[80:83], v[56:59]
    v_mfma_f32_16x16x32_bf16 v[60:63], v[252:255], v[80:83], v[60:63]
    ds_read_b128 v[80:83], v11 offset:1920
    s_waitcnt lgkmcnt(7)
    v_mfma_f32_16x16x32_bf16 v[56:59], v[136:139], v[176:179], v[56:59]
    v_mfma_f32_16x16x32_bf16 v[56:59], v[216:219], v[84:87], v[56:59]
    v_mfma_f32_16x16x32_bf16 v[60:63], v[248:251], v[84:87], v[60:63]
    ds_read_b128 v[84:87], v11 offset:1984
    v_mfma_f32_16x16x32_bf16 v[56:59], v[140:143], v[180:183], v[56:59]
    s_waitcnt lgkmcnt(6)
    v_cvt_pk_bf16_f32 v152, v120, v116
    v_mfma_f32_16x16x32_bf16 v[56:59], v[212:215], v[132:135], v[56:59]
    v_cvt_pk_bf16_f32 v153, v112, v108
    v_mfma_f32_16x16x32_bf16 v[60:63], v[244:247], v[132:135], v[60:63]
    v_cvt_pk_bf16_f32 v154, v121, v117
    v_mfma_f32_16x16x32_bf16 v[56:59], v[144:147], v[168:171], v[56:59]
    v_cvt_pk_bf16_f32 v155, v113, v109
    v_mfma_f32_16x16x32_bf16 v[56:59], v[208:211], v[68:71], v[56:59]
    v_cvt_pk_bf16_f32 v156, v122, v118
    v_mfma_f32_16x16x32_bf16 v[60:63], v[240:243], v[68:71], v[60:63]
    v_cvt_pk_bf16_f32 v157, v114, v110
    v_mfma_f32_16x16x32_bf16 v[56:59], v[148:151], v[172:175], v[56:59]
    ds_read_b128 v[132:135], v11 offset:1968
    s_waitcnt lgkmcnt(3)
    v_mfma_f32_16x16x32_bf16 v[56:59], v[204:207], v[72:75], v[56:59]
    v_cvt_pk_bf16_f32 v158, v123, v119
    v_mfma_f32_16x16x32_bf16 v[60:63], v[236:239], v[72:75], v[60:63]
    ds_read_b128 v[68:71], v11 offset:2048
    v_cvt_pk_bf16_f32 v159, v115, v111
    v_mfma_f32_16x16x32_bf16 v[56:59], v[200:203], v[76:79], v[56:59]
    v_cvt_pk_bf16_f32 v100, v128, v124
    v_mfma_f32_16x16x32_bf16 v[60:63], v[232:235], v[76:79], v[60:63]
    ds_read2_b32 v[40:41], v4 offset0:48 offset1:49
    s_waitcnt lgkmcnt(3)
    v_mfma_f32_16x16x32_bf16 v[56:59], v[196:199], v[80:83], v[56:59]
    ds_read2_b32 v[42:43], v4 offset0:50 offset1:51
    v_cvt_pk_bf16_f32 v101, v129, v125
    v_mfma_f32_16x16x32_bf16 v[60:63], v[228:231], v[80:83], v[60:63]
    ds_read_b128 v[72:75], v11 offset:2112
    v_cvt_pk_bf16_f32 v102, v130, v126
    v_mfma_f32_16x16x32_bf16 v[56:59], v[192:195], v[84:87], v[56:59]
    ds_read_b64 v[184:185], v89 offset:0
    v_cvt_pk_bf16_f32 v103, v131, v127
    v_mfma_f32_16x16x32_bf16 v[60:63], v[224:227], v[84:87], v[60:63]
    ds_read_b64 v[186:187], v89 offset:8
    v_mfma_f32_16x16x32_bf16 v[108:111], v[84:87], v[28:31], 0
    ds_read_b128 v[76:79], v11 offset:2176
    v_mfma_f32_16x16x32_bf16 v[112:115], v[84:87], v[32:35], 0
    v_mfma_f32_16x16x32_bf16 v[64:67], v[12:15], v[84:87], v[64:67]
    ds_read_b64 v[188:189], v89 offset:16
    v_mfma_f32_16x16x32_bf16 v[116:119], v[84:87], v[36:39], 0
    ds_read_b64 v[190:191], v89 offset:24
    ds_write_b128 v7, v[56:59] offset:13312
    v_mfma_f32_16x16x32_bf16 v[124:127], v[84:87], v[20:23], 0
    ds_read_b128 v[80:83], v11 offset:2240
    v_mfma_f32_16x16x32_bf16 v[48:51], v[16:19], v[84:87], 0
    ds_read_b128 v[84:87], v11 offset:2304
    s_waitcnt lgkmcnt(11)
    v_mfma_f32_16x16x32_bf16 v[120:123], v[132:135], v[32:35], 0
    ds_write_b32 v88, v88 offset:48
    v_mfma_f32_16x16x32_bf16 v[128:131], v[132:135], v[24:27], 0
    ds_read_b128 v[132:135], v11 offset:2368
    v_mfma_f32_16x16x32_bf16 v[60:63], v[220:223], v[68:71], v[60:63]
    v_mfma_f32_16x16x32_bf16 v[64:67], v[252:255], v[68:71], v[64:67]
    s_waitcnt lgkmcnt(8)
    v_mfma_f32_16x16x32_bf16 v[60:63], v[92:95], v[40:43], v[60:63]
    ds_read_b128 v[68:71], v11 offset:2432
    v_mfma_f32_16x16x32_bf16 v[60:63], v[216:219], v[72:75], v[60:63]
    v_mfma_f32_16x16x32_bf16 v[64:67], v[248:251], v[72:75], v[64:67]
    v_mfma_f32_16x16x32_bf16 v[60:63], v[136:139], v[184:187], v[60:63]
    ds_read_b128 v[72:75], v11 offset:2496
    s_waitcnt lgkmcnt(5)
    v_mfma_f32_16x16x32_bf16 v[60:63], v[212:215], v[76:79], v[60:63]
    v_cvt_pk_bf16_f32 v160, v120, v116
    v_mfma_f32_16x16x32_bf16 v[64:67], v[244:247], v[76:79], v[64:67]
    v_cvt_pk_bf16_f32 v161, v112, v108
    v_mfma_f32_16x16x32_bf16 v[60:63], v[140:143], v[188:191], v[60:63]
    v_cvt_pk_bf16_f32 v162, v121, v117
    v_mfma_f32_16x16x32_bf16 v[60:63], v[208:211], v[80:83], v[60:63]
    v_cvt_pk_bf16_f32 v163, v113, v109
    v_mfma_f32_16x16x32_bf16 v[64:67], v[240:243], v[80:83], v[64:67]
    v_cvt_pk_bf16_f32 v164, v122, v118
    v_mfma_f32_16x16x32_bf16 v[60:63], v[144:147], v[176:179], v[60:63]
    s_waitcnt lgkmcnt(2)
    v_cvt_pk_bf16_f32 v165, v114, v110
    v_mfma_f32_16x16x32_bf16 v[60:63], v[204:207], v[84:87], v[60:63]
    ds_read_b128 v[76:79], v11 offset:2480
    v_cvt_pk_bf16_f32 v166, v123, v119
    v_mfma_f32_16x16x32_bf16 v[64:67], v[236:239], v[84:87], v[64:67]
    ds_read_b128 v[80:83], v11 offset:2560
    v_cvt_pk_bf16_f32 v167, v115, v111
    v_mfma_f32_16x16x32_bf16 v[60:63], v[148:151], v[180:183], v[60:63]
    v_cvt_pk_bf16_f32 v104, v128, v124
    v_mfma_f32_16x16x32_bf16 v[60:63], v[200:203], v[132:135], v[60:63]
    v_cvt_pk_bf16_f32 v105, v129, v125
    v_mfma_f32_16x16x32_bf16 v[64:67], v[232:235], v[132:135], v[64:67]
    ds_read2_b32 v[16:17], v4 offset0:32 offset1:33
    v_cvt_pk_bf16_f32 v106, v130, v126
    v_mfma_f32_16x16x32_bf16 v[60:63], v[152:155], v[168:171], v[60:63]
    ds_read2_b32 v[18:19], v4 offset0:34 offset1:35
    s_waitcnt lgkmcnt(4)
    v_mfma_f32_16x16x32_bf16 v[60:63], v[196:199], v[68:71], v[60:63]
    ds_read_b128 v[84:87], v11 offset:2624
    v_cvt_pk_bf16_f32 v107, v131, v127
    v_mfma_f32_16x16x32_bf16 v[64:67], v[228:231], v[68:71], v[64:67]
    v_mfma_f32_16x16x32_bf16 v[60:63], v[156:159], v[172:175], v[60:63]
    v_mfma_f32_16x16x32_bf16 v[60:63], v[192:195], v[72:75], v[60:63]
    ds_read_b128 v[132:135], v11 offset:2688
    v_mfma_f32_16x16x32_bf16 v[64:67], v[224:227], v[72:75], v[64:67]
    v_mfma_f32_16x16x32_bf16 v[108:111], v[72:75], v[28:31], 0
    v_mfma_f32_16x16x32_bf16 v[112:115], v[72:75], v[32:35], 0
    ds_read_b128 v[68:71], v11 offset:2752
    v_mfma_f32_16x16x32_bf16 v[44:47], v[12:15], v[72:75], v[44:47]
    v_mfma_f32_16x16x32_bf16 v[116:119], v[72:75], v[36:39], 0
    ds_read_b128 v[72:75], v11 offset:2816
    s_waitcnt lgkmcnt(6)
    v_mfma_f32_16x16x32_bf16 v[120:123], v[76:79], v[32:35], 0
    ds_write_b128 v7, v[60:63] offset:14592
    v_mfma_f32_16x16x32_bf16 v[64:67], v[220:223], v[80:83], v[64:67]
    ds_read_b128 v[76:79], v11 offset:2880
    ds_write_b32 v88, v88 offset:64
    v_mfma_f32_16x16x32_bf16 v[44:47], v[252:255], v[80:83], v[44:47]
    v_mfma_f32_16x16x32_bf16 v[64:67], v[96:99], v[40:43], v[64:67]
    s_waitcnt lgkmcnt(6)
    v_mfma_f32_16x16x32_bf16 v[64:67], v[92:95], v[16:19], v[64:67]
    ds_read_b128 v[80:83], v11 offset:2944
    v_mfma_f32_16x16x32_bf16 v[64:67], v[216:219], v[84:87], v[64:67]
    v_mfma_f32_16x16x32_bf16 v[44:47], v[248:251], v[84:87], v[44:47]
    v_mfma_f32_16x16x32_bf16 v[64:67], v[144:147], v[184:187], v[64:67]
    ds_read_b128 v[84:87], v11 offset:3008
    s_waitcnt lgkmcnt(6)
    v_mfma_f32_16x16x32_bf16 v[64:67], v[212:215], v[132:135], v[64:67]
    v_cvt_pk_bf16_f32 v136, v120, v116
    v_mfma_f32_16x16x32_bf16 v[44:47], v[244:247], v[132:135], v[44:47]
    v_cvt_pk_bf16_f32 v137, v112, v108
    v_mfma_f32_16x16x32_bf16 v[64:67], v[148:151], v[188:191], v[64:67]
    v_cvt_pk_bf16_f32 v138, v121, v117
    v_mfma_f32_16x16x32_bf16 v[64:67], v[208:211], v[68:71], v[64:67]
    v_cvt_pk_bf16_f32 v139, v113, v109
    v_mfma_f32_16x16x32_bf16 v[44:47], v[240:243], v[68:71], v[44:47]
    v_cvt_pk_bf16_f32 v140, v122, v118
    v_mfma_f32_16x16x32_bf16 v[64:67], v[152:155], v[176:179], v[64:67]
    s_waitcnt lgkmcnt(3)
    v_cvt_pk_bf16_f32 v141, v114, v110
    v_mfma_f32_16x16x32_bf16 v[64:67], v[204:207], v[72:75], v[64:67]
    ds_read_b128 v[132:135], v11 offset:2992
    v_cvt_pk_bf16_f32 v142, v123, v119
    v_mfma_f32_16x16x32_bf16 v[44:47], v[236:239], v[72:75], v[44:47]
    ds_read_b128 v[68:71], v11 offset:3072
    v_cvt_pk_bf16_f32 v143, v115, v111
    v_mfma_f32_16x16x32_bf16 v[64:67], v[156:159], v[180:183], v[64:67]
    v_mfma_f32_16x16x32_bf16 v[64:67], v[200:203], v[76:79], v[64:67]
    v_mfma_f32_16x16x32_bf16 v[44:47], v[232:235], v[76:79], v[44:47]
    ds_read_b128 v[72:75], v11 offset:3136
    v_mfma_f32_16x16x32_bf16 v[64:67], v[160:163], v[168:171], v[64:67]
    ds_read2_b32 v[20:21], v4 offset0:16 offset1:17
    s_waitcnt lgkmcnt(4)
    v_mfma_f32_16x16x32_bf16 v[64:67], v[196:199], v[80:83], v[64:67]
    ds_read2_b32 v[22:23], v4 offset0:18 offset1:19
    v_mfma_f32_16x16x32_bf16 v[44:47], v[228:231], v[80:83], v[44:47]
    v_mfma_f32_16x16x32_bf16 v[64:67], v[164:167], v[172:175], v[64:67]
    ds_read_b128 v[76:79], v11 offset:3200
    v_mfma_f32_16x16x32_bf16 v[64:67], v[192:195], v[84:87], v[64:67]
    v_mfma_f32_16x16x32_bf16 v[44:47], v[224:227], v[84:87], v[44:47]
    ds_read_b128 v[80:83], v11 offset:3264
    v_mfma_f32_16x16x32_bf16 v[108:111], v[84:87], v[28:31], 0
    v_mfma_f32_16x16x32_bf16 v[112:115], v[84:87], v[32:35], 0
    v_mfma_f32_16x16x32_bf16 v[48:51], v[12:15], v[84:87], v[48:51]
    v_mfma_f32_16x16x32_bf16 v[116:119], v[84:87], v[36:39], 0
    ds_read_b128 v[84:87], v11 offset:3328
    s_waitcnt lgkmcnt(6)
    v_mfma_f32_16x16x32_bf16 v[120:123], v[132:135], v[32:35], 0
    ds_read_b128 v[132:135], v11 offset:3392
    ds_write_b128 v7, v[64:67] offset:15872
    v_mfma_f32_16x16x32_bf16 v[44:47], v[220:223], v[68:71], v[44:47]
    ds_read_b128 v[68:71], v11 offset:3456
    ds_write_b32 v88, v88 offset:80
    v_mfma_f32_16x16x32_bf16 v[44:47], v[100:103], v[40:43], v[44:47]
    v_mfma_f32_16x16x32_bf16 v[44:47], v[96:99], v[16:19], v[44:47]
    s_waitcnt lgkmcnt(7)
    v_mfma_f32_16x16x32_bf16 v[44:47], v[216:219], v[72:75], v[44:47]
    ds_read_b128 v[72:75], v11 offset:3520
    v_mfma_f32_16x16x32_bf16 v[44:47], v[92:95], v[20:23], v[44:47]
    v_mfma_f32_16x16x32_bf16 v[44:47], v[152:155], v[184:187], v[44:47]
    s_waitcnt lgkmcnt(6)
    v_cvt_pk_bf16_f32 v144, v120, v116
    v_mfma_f32_16x16x32_bf16 v[44:47], v[212:215], v[76:79], v[44:47]
    ds_read_b128 v[76:79], v11 offset:3584
    v_cvt_pk_bf16_f32 v145, v112, v108
    v_mfma_f32_16x16x32_bf16 v[44:47], v[156:159], v[188:191], v[44:47]
    v_cvt_pk_bf16_f32 v146, v121, v117
    v_mfma_f32_16x16x32_bf16 v[44:47], v[208:211], v[80:83], v[44:47]
    ds_read_b128 v[80:83], v11 offset:3072
    v_cvt_pk_bf16_f32 v147, v113, v109
    v_mfma_f32_16x16x32_bf16 v[44:47], v[160:163], v[176:179], v[44:47]
    s_waitcnt lgkmcnt(6)
    v_cvt_pk_bf16_f32 v148, v122, v118
    v_mfma_f32_16x16x32_bf16 v[44:47], v[204:207], v[84:87], v[44:47]
    ds_read_b128 v[84:87], v11 offset:3648
    v_cvt_pk_bf16_f32 v149, v114, v110
    v_mfma_f32_16x16x32_bf16 v[44:47], v[164:167], v[180:183], v[44:47]
    v_cvt_pk_bf16_f32 v150, v123, v119
    v_mfma_f32_16x16x32_bf16 v[44:47], v[200:203], v[132:135], v[44:47]
    ds_read_b128 v[132:135], v11 offset:3136
    v_cvt_pk_bf16_f32 v151, v115, v111
    v_mfma_f32_16x16x32_bf16 v[44:47], v[136:139], v[168:171], v[44:47]
    ds_read2_b32 v[24:25], v4 offset0:0 offset1:1
    s_waitcnt lgkmcnt(4)
    v_mfma_f32_16x16x32_bf16 v[44:47], v[196:199], v[68:71], v[44:47]
    ds_read2_b32 v[26:27], v4 offset0:2 offset1:3
    v_mfma_f32_16x16x32_bf16 v[44:47], v[140:143], v[172:175], v[44:47]
    ds_read_b128 v[68:71], v11 offset:3712
    v_mfma_f32_16x16x32_bf16 v[44:47], v[192:195], v[72:75], v[44:47]
    ds_read_b128 v[72:75], v11 offset:3200
    v_mfma_f32_16x16x32_bf16 v[48:51], v[220:223], v[76:79], v[48:51]
    ds_read_b128 v[76:79], v11 offset:3776
    s_waitcnt lgkmcnt(6)
    v_mfma_f32_16x16x32_bf16 v[48:51], v[252:255], v[80:83], v[48:51]
    ds_read_b128 v[80:83], v11 offset:3264
    v_mfma_f32_16x16x32_bf16 v[48:51], v[104:107], v[40:43], v[48:51]
    v_mfma_f32_16x16x32_bf16 v[48:51], v[100:103], v[16:19], v[48:51]
    v_mfma_f32_16x16x32_bf16 v[48:51], v[216:219], v[84:87], v[48:51]
    ds_read_b128 v[84:87], v11 offset:3840
    s_waitcnt lgkmcnt(5)
    v_mfma_f32_16x16x32_bf16 v[48:51], v[248:251], v[132:135], v[48:51]
    ds_read_b128 v[132:135], v11 offset:3328
    v_mfma_f32_16x16x32_bf16 v[48:51], v[96:99], v[20:23], v[48:51]
    v_mfma_f32_16x16x32_bf16 v[48:51], v[92:95], v[24:27], v[48:51]
    s_waitcnt lgkmcnt(4)
    ds_write_b128 v7, v[44:47] offset:17152
    v_mfma_f32_16x16x32_bf16 v[48:51], v[212:215], v[68:71], v[48:51]
    ds_read_b128 v[68:71], v11 offset:3904
    ds_write_b32 v88, v88 offset:96
    v_mfma_f32_16x16x32_bf16 v[48:51], v[244:247], v[72:75], v[48:51]
    ds_read_b128 v[72:75], v11 offset:3392
    v_mfma_f32_16x16x32_bf16 v[48:51], v[160:163], v[184:187], v[48:51]
    v_mfma_f32_16x16x32_bf16 v[48:51], v[164:167], v[188:191], v[48:51]
    s_waitcnt lgkmcnt(5)
    v_mfma_f32_16x16x32_bf16 v[48:51], v[208:211], v[76:79], v[48:51]
    ds_read_b128 v[76:79], v11 offset:3968
    v_mfma_f32_16x16x32_bf16 v[48:51], v[240:243], v[80:83], v[48:51]
    ds_read_b128 v[80:83], v11 offset:3456
    v_mfma_f32_16x16x32_bf16 v[48:51], v[136:139], v[176:179], v[48:51]
    v_mfma_f32_16x16x32_bf16 v[48:51], v[204:207], v[84:87], v[48:51]
    ds_read_b128 v[84:87], v11 offset:4032
    s_waitcnt lgkmcnt(3)
    v_mfma_f32_16x16x32_bf16 v[48:51], v[236:239], v[132:135], v[48:51]
    ds_read_b128 v[132:135], v11 offset:3520
    v_mfma_f32_16x16x32_bf16 v[48:51], v[140:143], v[180:183], v[48:51]
    v_mfma_f32_16x16x32_bf16 v[48:51], v[200:203], v[68:71], v[48:51]
    v_mfma_f32_16x16x32_bf16 v[48:51], v[232:235], v[72:75], v[48:51]
    v_mfma_f32_16x16x32_bf16 v[48:51], v[144:147], v[168:171], v[48:51]
    s_waitcnt lgkmcnt(1)
    v_mfma_f32_16x16x32_bf16 v[48:51], v[196:199], v[76:79], v[48:51]
    v_mfma_f32_16x16x32_bf16 v[48:51], v[228:231], v[80:83], v[48:51]
    v_mfma_f32_16x16x32_bf16 v[48:51], v[148:151], v[172:175], v[48:51]
    v_mfma_f32_16x16x32_bf16 v[48:51], v[192:195], v[84:87], v[48:51]
    s_waitcnt lgkmcnt(0)
    v_mfma_f32_16x16x32_bf16 v[48:51], v[224:227], v[132:135], v[48:51]
    s_nop 7
    ds_write_b128 v7, v[48:51] offset:18432
    ds_write_b32 v88, v88 offset:112
    s_cmp_lg_u32 s39, 0
    s_cbranch_scc1 L_mw_end
    s_mul_i32 s42, s50, 9344
    s_add_u32 s42, s42, 69632
    v_add_u32 v18, s42, v3
    v_add_u32 v20, 4096, v18
    v_and_b32 v21, 0x70, v3
    s_add_u32 s42, s42, 5120
    v_add_u32 v21, s42, v21
    s_mov_b32 s61, 131072
    v_lshl_add_u32 v24, v9, 1, s54
    v_mov_b32 v35, s45
    s_barrier
L_part_poll:
    global_load_dwordx4 v[164:167], v21, s[36:37] sc1
    global_load_dwordx4 v[128:131], v18, s[36:37] offset:-4096 sc1
    global_load_dwordx4 v[132:135], v18, s[36:37] offset:-3072 sc1
    global_load_dwordx4 v[136:139], v18, s[36:37] offset:-2048 sc1
    global_load_dwordx4 v[140:143], v18, s[36:37] offset:-1024 sc1
    global_load_dwordx4 v[144:147], v18, s[36:37] offset:0 sc1
    global_load_dwordx4 v[148:151], v18, s[36:37] offset:1024 sc1
    global_load_dwordx4 v[152:155], v18, s[36:37] offset:2048 sc1
    global_load_dwordx4 v[156:159], v18, s[36:37] offset:3072 sc1
    global_load_dwordx4 v[160:163], v20, s[36:37] offset:0 sc1
    v_mul_u32_u24 v26, 4640, v9
    v_add_u32 v26, 135648, v26
    v_mul_u32_u24 v27, 33792, v9
    v_mov_b32 v25, 1280
    s_waitcnt vmcnt(9)
    v_bfe_u32 v28, v164, 8, 11
    v_lshl_add_u32 v29, v28, 1, v26
    v_lshrrev_b32 v30, 8, v28
    v_mad_u32_u24 v27, v30, v25, v27
    v_bfe_u32 v30, v28, 2, 2
    v_mul_u32_u24 v30, 320, v30
    v_and_b32 v33, 0xf0, v28
    v_add3_u32 v27, v27, v30, v33
    v_and_b32 v33, 3, v28
    v_lshl_add_u32 v30, v33, 2, v27
    ds_read_b128 v[36:39], v88 offset:112
    ds_read_u16_d16_hi v31, v29
    ds_read_b32 v32, v30 offset:9472
    v_mul_u32_u24 v28, 1152, v28
    v_add_u32 v28, v28, v24
    v_xor_b32 v22, v35, v164
    s_waitcnt vmcnt(8)
    v_xor_b32 v128, v35, v128
    v_or_b32 v22, v22, v128
    s_waitcnt vmcnt(7)
    v_xor_b32 v132, v35, v132
    v_pk_add_f32 v[130:131], v[130:131], v[134:135]
    v_pk_add_f32 v[128:129], v[128:129], v[132:133]
    s_waitcnt vmcnt(6)
    v_xor_b32 v136, v35, v136
    v_pk_add_f32 v[130:131], v[130:131], v[138:139]
    v_pk_add_f32 v[128:129], v[128:129], v[136:137]
    v_bitop3_b32 v22, v22, v132, v136 bitop3:0xfe
    s_waitcnt vmcnt(5)
    v_xor_b32 v140, v35, v140
    v_pk_add_f32 v[130:131], v[130:131], v[142:143]
    v_pk_add_f32 v[128:129], v[128:129], v[140:141]
    s_waitcnt vmcnt(4)
    v_xor_b32 v144, v35, v144
    v_pk_add_f32 v[130:131], v[130:131], v[146:147]
    v_pk_add_f32 v[128:129], v[128:129], v[144:145]
    v_bitop3_b32 v22, v22, v140, v144 bitop3:0xfe
    s_waitcnt vmcnt(3)
    v_xor_b32 v148, v35, v148
    v_pk_add_f32 v[130:131], v[130:131], v[150:151]
    v_pk_add_f32 v[128:129], v[128:129], v[148:149]
    s_waitcnt vmcnt(2)
    v_xor_b32 v152, v35, v152
    v_pk_add_f32 v[130:131], v[130:131], v[154:155]
    v_pk_add_f32 v[128:129], v[128:129], v[152:153]
    v_bitop3_b32 v22, v22, v148, v152 bitop3:0xfe
    s_waitcnt vmcnt(1)
    v_xor_b32 v156, v35, v156
    v_pk_add_f32 v[130:131], v[130:131], v[158:159]
    v_pk_add_f32 v[128:129], v[128:129], v[156:157]
    s_waitcnt vmcnt(0)
    v_xor_b32 v160, v35, v160
    v_pk_add_f32 v[130:131], v[130:131], v[162:163]
    v_pk_add_f32 v[128:129], v[128:129], v[160:161]
    v_bitop3_b32 v22, v22, v156, v160 bitop3:0xfe
    s_waitcnt lgkmcnt(0)
    v_bitop3_b32 v36, v37, v38, v39 bitop3:0x7f
    v_and_b32 v36, 128, v36
    v_or_b32 v22, v22, v36
    v_and_b32 v22, 0xff, v22
    v_cmp_ne_u32 vcc, 0, v22
    v_permlane32_swap_b32 v128, v130
    s_sub_u32 s61, s61, 1
    s_cselect_b64 vcc, 0, vcc
    s_cbranch_vccnz L_part_poll
    v_permlane32_swap_b32 v129, v131
    v_add_f32 v128, v128, v130
    v_add_f32 v129, v129, v131
    v_and_b32 v31, 0xffff0000, v31
    v_fma_f32 v34, v31, v167, v166
    v_permlane16_swap_b32 v128, v129
    v_add_f32 v128, v128, v129
    v_mul_f32 v31, 0x42000000, v31
    v_mul_f32 v32, 0x3d000000, v32
    v_add_f32_dpp v128, v128, v128 row_ror:8 row_mask:0xf bank_mask:0xf
    v_fma_f32 v128, v128, v165, v31
    v_mul_f32 v33, 0xbfb8aa3b, v128
    v_exp_f32 v33, v33
    v_mul_f32 v128, v128, v32
    v_add_f32 v33, 1.0, v33
    v_rcp_f32 v33, v33
    s_nop 0
    v_fmac_f32 v34, v128, v33
    v_cvt_pk_bf16_f32 v34, v34, v34
    global_store_short v28, v34, s[32:33]
L_mw_end:
    s_endpgm
L_helper:
    s_waitcnt lgkmcnt(0)
    s_barrier
    s_setprio 0
    s_lshr_b32 s42, s50, 1
    s_lshl_b32 s42, s42, 15
    s_and_b32 s43, s50, 1
    s_lshl_b32 s43, s43, 6
    s_add_u32 s42, s42, s43
    s_add_u32 s42, s42, 2101248
    s_add_u32 s12, s36, s42
    s_addc_u32 s13, s37, 0
    s_add_u32 s14, s12, 8192
    s_addc_u32 s15, s13, 0
    s_add_u32 s16, s12, 16384
    s_addc_u32 s17, s13, 0
    s_add_u32 s18, s12, 24576
    s_addc_u32 s19, s13, 0
    v_bfe_u32 v63, v0, 2, 6
    v_and_b32 v6, 0x30, v3
    v_lshl_add_u32 v6, v63, 7, v6
    global_load_dwordx4 v[40:43], v6, s[12:13] sc1
    global_load_dwordx4 v[44:47], v6, s[14:15] sc1
    global_load_dwordx4 v[48:51], v6, s[16:17] sc1
    global_load_dwordx4 v[52:55], v6, s[18:19] sc1
    v_and_b32 v62, 255, v0
    v_lshlrev_b32 v4, 4, v62
    v_add_u32 v4, 20480, v4
    v_add_u32 v7, 8192, v4
    s_cmp_eq_u32 s47, 2
    s_cbranch_scc0 L_ct4
    v_add_u32 v76, 3244032, v76
    global_load_dword v1, v76, s[56:57]
L_ct4:
    s_bfe_u32 s43, s46, 131072
    s_mul_i32 s43, s43, 0x20004000
    s_and_b32 s43, s43, 0x40004000
    v_mov_b32 v56, s43
    s_bfe_u32 s43, s46, 131074
    s_mul_i32 s43, s43, 0x20004000
    s_and_b32 s43, s43, 0x40004000
    v_mov_b32 v57, s43
    s_bfe_u32 s43, s46, 131076
    s_mul_i32 s43, s43, 0x20004000
    s_and_b32 s43, s43, 0x40004000
    v_mov_b32 v58, s43
    s_bfe_u32 s43, s46, 131078
    s_mul_i32 s43, s43, 0x20004000
    s_and_b32 s43, s43, 0x40004000
    v_mov_b32 v59, s43
    v_and_b32 v88, 3, v0
    v_mul_u32_u24 v5, 4640, v88
    v_lshl_add_u32 v5, v63, 4, v5
    v_add_u32 v5, 135648, v5
    v_mov_b32 v63, 0x40004000
    s_lshr_b32 s43, s51, 1
    s_lshl_b32 s43, s43, 4
    s_add_u32 s43, s43, 153728
    v_lshl_add_u32 v88, v88, 2, s43
    s_mov_b32 s61, 131072
    v_lshlrev_b32 v37, 2, v62
    v_add_u32 v64, 135648, v37
    v_add_u32 v65, 140288, v37
    v_add_u32 v66, 144928, v37
    v_add_u32 v67, 149568, v37
    v_bfe_u32 v37, v0, 1, 2
    v_mul_u32_u24 v37, 320, v37
    v_and_b32 v39, 0x78, v0
    v_lshl_add_u32 v37, v39, 1, v37
    v_and_b32 v39, 1, v0
    v_lshl_add_u32 v37, v39, 3, v37
    s_lshr_b32 s43, s51, 1
    s_mul_i32 s43, s43, 1280
    s_add_u32 s43, s43, 9472
    v_add_u32 v37, s43, v37
    v_add_u32 v39, 67584, v37
    v_mul_u32_u24 v36, 2304, v62
    v_add_u32 v36, s54, v36
    v_mov_b32 v8, 0xc238aa3b
    v_mov_b32 v9, 0xffff0000
    v_lshlrev_b32 v62, 6, v62
    v_xor_b32 v62, s44, v62
    v_and_b32 v10, 15, v0
    v_lshrrev_b32 v11, 1, v0
    v_and_b32 v11, 24, v11
    s_lshl_b32 s42, s51, 4
    s_mov_b32 s58, 939536384
    s_mov_b32 s59, 3672000
    s_lshr_b64 s[58:59], s[58:59], s42
    s_and_b32 s58, s58, 0xffff
    s_lshr_b32 s59, 535826400, s42
    s_and_b32 s59, s59, 0xffff
    s_lshl_b32 s42, s51, 10
    s_add_u32 s42, s42, 154048
    v_add_u32 v12, s42, v3
    v_lshlrev_b32 v13, v10, s58
    v_bfe_u32 v13, v13, v11, 8
    v_lshl_or_b32 v13, v13, 15, v13
    v_and_b32 v16, 65537, v13
    v_mul_u32_u24 v16, 16256, v16
    v_and_b32 v17, 262148, v13
    v_mul_u32_u24 v17, 4064, v17
    v_and_b32 v18, 1048592, v13
    v_mul_u32_u24 v18, 1016, v18
    v_and_b32 v19, 4194368, v13
    v_mul_u32_u24 v19, 254, v19
    ds_write_b128 v12, v[16:19] offset:0
    v_lshlrev_b32 v13, v10, s59
    v_bfe_u32 v13, v13, v11, 8
    v_lshl_or_b32 v13, v13, 15, v13
    v_and_b32 v20, 65537, v13
    v_mul_u32_u24 v20, 16256, v20
    v_and_b32 v21, 262148, v13
    v_mul_u32_u24 v21, 4064, v21
    v_and_b32 v22, 1048592, v13
    v_mul_u32_u24 v22, 1016, v22
    v_and_b32 v23, 4194368, v13
    v_mul_u32_u24 v23, 254, v23
    ds_write_b128 v12, v[20:23] offset:4096
    global_load_dwordx4 v[224:227], v4, s[36:37] offset:-4096 sc1
    global_load_dwordx4 v[228:231], v4, s[36:37] offset:0 sc1
    global_load_dwordx4 v[232:235], v7, s[36:37] offset:-4096 sc1
    global_load_dwordx4 v[236:239], v7, s[36:37] offset:0 sc1
    s_waitcnt vmcnt(5)
    s_cmp_eq_u32 s47, 2
    s_cbranch_scc1 L_tw
    s_waitcnt vmcnt(4)
L_tw:
    s_setprio 3
L_tile_chk:
    v_xor_b32 v40, v56, v40
    v_xor_b32 v41, v57, v41
    v_xor_b32 v42, v58, v42
    v_xor_b32 v43, v59, v43
    ds_write_b128 v5, v[40:43] offset:0
    v_xor_b32 v44, v56, v44
    v_xor_b32 v45, v57, v45
    v_xor_b32 v46, v58, v46
    v_xor_b32 v47, v59, v47
    ds_write_b128 v5, v[44:47] offset:1024
    v_xor_b32 v48, v56, v48
    v_xor_b32 v49, v57, v49
    v_xor_b32 v50, v58, v50
    v_xor_b32 v51, v59, v51
    ds_write_b128 v5, v[48:51] offset:2048
    v_xor_b32 v52, v56, v52
    v_xor_b32 v53, v57, v53
    v_xor_b32 v54, v58, v54
    v_xor_b32 v55, v59, v55
    ds_write_b128 v5, v[52:55] offset:3072
    v_bitop3_b32 v38, v40, v41, v42 bitop3:0xfe
    v_bitop3_b32 v38, v38, v43, v44 bitop3:0xfe
    v_bitop3_b32 v38, v38, v45, v46 bitop3:0xfe
    v_bitop3_b32 v38, v38, v47, v48 bitop3:0xfe
    v_bitop3_b32 v38, v38, v49, v50 bitop3:0xfe
    v_bitop3_b32 v38, v38, v51, v52 bitop3:0xfe
    v_bitop3_b32 v38, v38, v53, v54 bitop3:0xfe
    v_bitop3_b32 v38, v38, v55, v63 bitop3:0xa8
    v_cmp_ne_u32 vcc, 0, v38
    s_cbranch_vccz L_tile_ok
    global_load_dwordx4 v[40:43], v6, s[12:13] sc1
    global_load_dwordx4 v[44:47], v6, s[14:15] sc1
    global_load_dwordx4 v[48:51], v6, s[16:17] sc1
    global_load_dwordx4 v[52:55], v6, s[18:19] sc1
    s_waitcnt vmcnt(0)
    s_sub_u32 s61, s61, 1
    s_cbranch_scc0 L_tile_chk
L_tile_ok:
    s_mov_b32 s61, 2097152
    s_setprio 3
    s_waitcnt lgkmcnt(0)
    s_barrier
    ds_read2st64_b32 v[16:17], v64 offset0:0 offset1:4
    ds_read2st64_b32 v[18:19], v65 offset0:0 offset1:4
    ds_read2st64_b32 v[20:21], v66 offset0:0 offset1:4
    ds_read2st64_b32 v[22:23], v67 offset0:0 offset1:4
    ds_read2st64_b32 v[24:25], v64 offset0:8 offset1:12
    ds_read2st64_b32 v[26:27], v65 offset0:8 offset1:12
    ds_read2st64_b32 v[28:29], v66 offset0:8 offset1:12
    ds_read2st64_b32 v[30:31], v67 offset0:8 offset1:12
    s_setprio 0
    s_waitcnt lgkmcnt(4)
    v_lshlrev_b32 v96, 16, v16
    v_lshlrev_b32 v97, 16, v18
    v_lshlrev_b32 v98, 16, v20
    v_lshlrev_b32 v99, 16, v22
    v_mul_f32 v104, v8, v96
    v_mul_f32 v105, v8, v97
    v_mul_f32 v106, v8, v98
    v_mul_f32 v107, v8, v99
    v_exp_f32 v104, v104
    v_exp_f32 v105, v105
    v_exp_f32 v106, v106
    v_exp_f32 v107, v107
    v_add_f32 v104, 1.0, v104
    v_add_f32 v105, 1.0, v105
    v_add_f32 v106, 1.0, v106
    v_add_f32 v107, 1.0, v107
    v_rcp_f32 v104, v104
    v_rcp_f32 v105, v105
    v_rcp_f32 v106, v106
    v_rcp_f32 v107, v107
    v_and_b32 v100, v9, v16
    v_and_b32 v101, v9, v18
    v_and_b32 v102, v9, v20
    v_and_b32 v103, v9, v22
    v_mul_f32 v108, v8, v100
    v_mul_f32 v109, v8, v101
    v_mul_f32 v110, v8, v102
    v_mul_f32 v111, v8, v103
    v_exp_f32 v108, v108
    v_exp_f32 v109, v109
    v_exp_f32 v110, v110
    v_exp_f32 v111, v111
    v_add_f32 v108, 1.0, v108
    v_add_f32 v109, 1.0, v109
    v_add_f32 v110, 1.0, v110
    v_add_f32 v111, 1.0, v111
    v_rcp_f32 v108, v108
    v_rcp_f32 v109, v109
    v_rcp_f32 v110, v110
    v_rcp_f32 v111, v111
    s_setprio 2
    ds_read_b32 v41, v88 offset:0
    ds_read_b64 v[44:45], v37 offset:0
    ds_read_b64 v[46:47], v37 offset:33792
    ds_read_b64 v[48:49], v39 offset:0
    ds_read_b64 v[50:51], v39 offset:33792
    s_setprio 0
    s_waitcnt vmcnt(0)
L_h_poll:
    v_mov_b32 v38, 0
    v_xor_b32 v13, 65504, v225
    v_bitop3_b32 v38, v38, v13, v62 bitop3:0xf6
    v_xor_b32 v13, 65472, v227
    v_bitop3_b32 v38, v38, v13, v62 bitop3:0xf6
    v_xor_b32 v13, 49120, v229
    v_bitop3_b32 v38, v38, v13, v62 bitop3:0xf6
    v_xor_b32 v13, 49088, v231
    v_bitop3_b32 v38, v38, v13, v62 bitop3:0xf6
    v_xor_b32 v13, 32736, v233
    v_bitop3_b32 v38, v38, v13, v62 bitop3:0xf6
    v_xor_b32 v13, 32704, v235
    v_bitop3_b32 v38, v38, v13, v62 bitop3:0xf6
    v_xor_b32 v13, 16352, v237
    v_bitop3_b32 v38, v38, v13, v62 bitop3:0xf6
    v_xor_b32 v13, 16320, v239
    v_bitop3_b32 v38, v38, v13, v62 bitop3:0xf6
    v_and_b32 v38, 0xffff, v38
    v_cmp_ne_u32 vcc, 0, v38
    s_cbranch_vccz L_h_ok
    global_load_dwordx4 v[224:227], v4, s[36:37] offset:-4096 sc1
    global_load_dwordx4 v[228:231], v4, s[36:37] offset:0 sc1
    global_load_dwordx4 v[232:235], v7, s[36:37] offset:-4096 sc1
    global_load_dwordx4 v[236:239], v7, s[36:37] offset:0 sc1
    s_waitcnt vmcnt(0)
    s_sub_u32 s61, s61, 16
    s_cbranch_scc0 L_h_poll
L_h_ok:
    v_and_b32 v121, v9, v224
    v_lshlrev_b32 v120, 16, v224
    v_and_b32 v123, v9, v226
    v_lshlrev_b32 v122, 16, v226
    s_waitcnt lgkmcnt(0)
    v_cmp_eq_u32 vcc, 0, v41
    s_cbranch_vccz L_w0_go
    s_setprio 2
L_w0:
    ds_read_b32 v41, v88 offset:0
    s_waitcnt lgkmcnt(0)
    v_cmp_eq_u32 vcc, 0, v41
    s_cbranch_vccz L_w0_ok
    s_sleep 2
    s_sub_u32 s61, s61, 1
    s_cbranch_scc0 L_w0
L_w0_ok:
    ds_read_b64 v[44:45], v37 offset:0
    ds_read_b64 v[46:47], v37 offset:33792
    ds_read_b64 v[48:49], v39 offset:0
    ds_read_b64 v[50:51], v39 offset:33792
    s_setprio 0
    s_waitcnt lgkmcnt(0)
L_w0_go:
    v_fma_f32 v112, v44, v104, v121
    v_fma_f32 v113, v46, v105, v121
    v_fma_f32 v114, v48, v106, v121
    v_fma_f32 v115, v50, v107, v121
    v_fma_f32 v96, v96, v112, v120
    v_fma_f32 v97, v97, v113, v120
    v_fma_f32 v98, v98, v114, v120
    v_fma_f32 v99, v99, v115, v120
    v_cvt_pk_bf16_f32 v104, v96, v97
    v_cvt_pk_bf16_f32 v105, v98, v99
    global_store_dwordx2 v36, v[104:105], s[32:33] offset:0
    v_fma_f32 v116, v45, v108, v123
    v_fma_f32 v117, v47, v109, v123
    v_fma_f32 v118, v49, v110, v123
    v_fma_f32 v119, v51, v111, v123
    v_fma_f32 v100, v100, v116, v122
    v_fma_f32 v101, v101, v117, v122
    v_fma_f32 v102, v102, v118, v122
    v_fma_f32 v103, v103, v119, v122
    v_cvt_pk_bf16_f32 v108, v100, v101
    v_cvt_pk_bf16_f32 v109, v102, v103
    global_store_dwordx2 v36, v[108:109], s[32:33] offset:1152
    v_add_u32 v36, 589824, v36
    v_lshlrev_b32 v128, 16, v17
    v_lshlrev_b32 v129, 16, v19
    v_lshlrev_b32 v130, 16, v21
    v_lshlrev_b32 v131, 16, v23
    v_mul_f32 v136, v8, v128
    v_mul_f32 v137, v8, v129
    v_mul_f32 v138, v8, v130
    v_mul_f32 v139, v8, v131
    v_exp_f32 v136, v136
    v_exp_f32 v137, v137
    v_exp_f32 v138, v138
    v_exp_f32 v139, v139
    v_and_b32 v153, v9, v228
    v_add_f32 v136, 1.0, v136
    v_add_f32 v137, 1.0, v137
    v_add_f32 v138, 1.0, v138
    v_add_f32 v139, 1.0, v139
    v_rcp_f32 v136, v136
    v_rcp_f32 v137, v137
    v_rcp_f32 v138, v138
    v_rcp_f32 v139, v139
    v_lshlrev_b32 v152, 16, v228
    s_setprio 2
    ds_read_b32 v41, v88 offset:32
    ds_read_b64 v[44:45], v37 offset:2560
    ds_read_b64 v[46:47], v37 offset:36352
    ds_read_b64 v[48:49], v39 offset:2560
    ds_read_b64 v[50:51], v39 offset:36352
    s_setprio 0
    v_and_b32 v132, v9, v17
    v_and_b32 v133, v9, v19
    v_and_b32 v134, v9, v21
    v_and_b32 v135, v9, v23
    v_mul_f32 v140, v8, v132
    v_mul_f32 v141, v8, v133
    v_mul_f32 v142, v8, v134
    v_mul_f32 v143, v8, v135
    v_exp_f32 v140, v140
    v_exp_f32 v141, v141
    v_exp_f32 v142, v142
    v_exp_f32 v143, v143
    v_and_b32 v155, v9, v230
    v_add_f32 v140, 1.0, v140
    v_add_f32 v141, 1.0, v141
    v_add_f32 v142, 1.0, v142
    v_add_f32 v143, 1.0, v143
    v_rcp_f32 v140, v140
    v_rcp_f32 v141, v141
    v_rcp_f32 v142, v142
    v_rcp_f32 v143, v143
    v_lshlrev_b32 v154, 16, v230
    s_waitcnt lgkmcnt(0)
    v_cmp_eq_u32 vcc, 0, v41
    s_cbranch_vccz L_w1_go
    s_setprio 2
L_w1:
    ds_read_b32 v41, v88 offset:32
    s_waitcnt lgkmcnt(0)
    v_cmp_eq_u32 vcc, 0, v41
    s_cbranch_vccz L_w1_ok
    s_sleep 2
    s_sub_u32 s61, s61, 1
    s_cbranch_scc0 L_w1
L_w1_ok:
    ds_read_b64 v[44:45], v37 offset:2560
    ds_read_b64 v[46:47], v37 offset:36352
    ds_read_b64 v[48:49], v39 offset:2560
    ds_read_b64 v[50:51], v39 offset:36352
    s_setprio 0
    s_waitcnt lgkmcnt(0)
L_w1_go:
    v_fma_f32 v144, v44, v136, v153
    v_fma_f32 v145, v46, v137, v153
    v_fma_f32 v146, v48, v138, v153
    v_fma_f32 v147, v50, v139, v153
    v_fma_f32 v128, v128, v144, v152
    v_fma_f32 v129, v129, v145, v152
    v_fma_f32 v130, v130, v146, v152
    v_fma_f32 v131, v131, v147, v152
    v_cvt_pk_bf16_f32 v136, v128, v129
    v_cvt_pk_bf16_f32 v137, v130, v131
    global_store_dwordx2 v36, v[136:137], s[32:33] offset:0
    v_fma_f32 v148, v45, v140, v155
    v_fma_f32 v149, v47, v141, v155
    v_fma_f32 v150, v49, v142, v155
    v_fma_f32 v151, v51, v143, v155
    v_fma_f32 v132, v132, v148, v154
    v_fma_f32 v133, v133, v149, v154
    v_fma_f32 v134, v134, v150, v154
    v_fma_f32 v135, v135, v151, v154
    v_cvt_pk_bf16_f32 v140, v132, v133
    v_cvt_pk_bf16_f32 v141, v134, v135
    global_store_dwordx2 v36, v[140:141], s[32:33] offset:1152
    v_add_u32 v36, 589824, v36
    v_lshlrev_b32 v160, 16, v24
    v_lshlrev_b32 v161, 16, v26
    v_lshlrev_b32 v162, 16, v28
    v_lshlrev_b32 v163, 16, v30
    v_mul_f32 v168, v8, v160
    v_mul_f32 v169, v8, v161
    v_mul_f32 v170, v8, v162
    v_mul_f32 v171, v8, v163
    v_exp_f32 v168, v168
    v_exp_f32 v169, v169
    v_exp_f32 v170, v170
    v_exp_f32 v171, v171
    v_and_b32 v185, v9, v232
    v_add_f32 v168, 1.0, v168
    v_add_f32 v169, 1.0, v169
    v_add_f32 v170, 1.0, v170
    v_add_f32 v171, 1.0, v171
    v_rcp_f32 v168, v168
    v_rcp_f32 v169, v169
    v_rcp_f32 v170, v170
    v_rcp_f32 v171, v171
    v_lshlrev_b32 v184, 16, v232
    s_setprio 2
    ds_read_b32 v41, v88 offset:64
    ds_read_b64 v[44:45], v37 offset:5120
    ds_read_b64 v[46:47], v37 offset:38912
    ds_read_b64 v[48:49], v39 offset:5120
    ds_read_b64 v[50:51], v39 offset:38912
    s_setprio 0
    v_and_b32 v164, v9, v24
    v_and_b32 v165, v9, v26
    v_and_b32 v166, v9, v28
    v_and_b32 v167, v9, v30
    v_mul_f32 v172, v8, v164
    v_mul_f32 v173, v8, v165
    v_mul_f32 v174, v8, v166
    v_mul_f32 v175, v8, v167
    v_exp_f32 v172, v172
    v_exp_f32 v173, v173
    v_exp_f32 v174, v174
    v_exp_f32 v175, v175
    v_and_b32 v187, v9, v234
    v_add_f32 v172, 1.0, v172
    v_add_f32 v173, 1.0, v173
    v_add_f32 v174, 1.0, v174
    v_add_f32 v175, 1.0, v175
    v_rcp_f32 v172, v172
    v_rcp_f32 v173, v173
    v_rcp_f32 v174, v174
    v_rcp_f32 v175, v175
    v_lshlrev_b32 v186, 16, v234
    s_waitcnt lgkmcnt(0)
    v_cmp_eq_u32 vcc, 0, v41
    s_cbranch_vccz L_w2_go
    s_setprio 2
L_w2:
    ds_read_b32 v41, v88 offset:64
    s_waitcnt lgkmcnt(0)
    v_cmp_eq_u32 vcc, 0, v41
    s_cbranch_vccz L_w2_ok
    s_sleep 2
    s_sub_u32 s61, s61, 1
    s_cbranch_scc0 L_w2
L_w2_ok:
    ds_read_b64 v[44:45], v37 offset:5120
    ds_read_b64 v[46:47], v37 offset:38912
    ds_read_b64 v[48:49], v39 offset:5120
    ds_read_b64 v[50:51], v39 offset:38912
    s_setprio 0
    s_waitcnt lgkmcnt(0)
L_w2_go:
    v_fma_f32 v176, v44, v168, v185
    v_fma_f32 v177, v46, v169, v185
    v_fma_f32 v178, v48, v170, v185
    v_fma_f32 v179, v50, v171, v185
    v_fma_f32 v160, v160, v176, v184
    v_fma_f32 v161, v161, v177, v184
    v_fma_f32 v162, v162, v178, v184
    v_fma_f32 v163, v163, v179, v184
    v_cvt_pk_bf16_f32 v168, v160, v161
    v_cvt_pk_bf16_f32 v169, v162, v163
    global_store_dwordx2 v36, v[168:169], s[32:33] offset:0
    v_fma_f32 v180, v45, v172, v187
    v_fma_f32 v181, v47, v173, v187
    v_fma_f32 v182, v49, v174, v187
    v_fma_f32 v183, v51, v175, v187
    v_fma_f32 v164, v164, v180, v186
    v_fma_f32 v165, v165, v181, v186
    v_fma_f32 v166, v166, v182, v186
    v_fma_f32 v167, v167, v183, v186
    v_cvt_pk_bf16_f32 v172, v164, v165
    v_cvt_pk_bf16_f32 v173, v166, v167
    global_store_dwordx2 v36, v[172:173], s[32:33] offset:1152
    v_add_u32 v36, 589824, v36
    v_lshlrev_b32 v192, 16, v25
    v_lshlrev_b32 v193, 16, v27
    v_lshlrev_b32 v194, 16, v29
    v_lshlrev_b32 v195, 16, v31
    v_mul_f32 v200, v8, v192
    v_mul_f32 v201, v8, v193
    v_mul_f32 v202, v8, v194
    v_mul_f32 v203, v8, v195
    v_exp_f32 v200, v200
    v_exp_f32 v201, v201
    v_exp_f32 v202, v202
    v_exp_f32 v203, v203
    v_and_b32 v217, v9, v236
    v_add_f32 v200, 1.0, v200
    v_add_f32 v201, 1.0, v201
    v_add_f32 v202, 1.0, v202
    v_add_f32 v203, 1.0, v203
    v_rcp_f32 v200, v200
    v_rcp_f32 v201, v201
    v_rcp_f32 v202, v202
    v_rcp_f32 v203, v203
    v_lshlrev_b32 v216, 16, v236
    s_setprio 2
    ds_read_b32 v41, v88 offset:96
    ds_read_b64 v[44:45], v37 offset:7680
    ds_read_b64 v[46:47], v37 offset:41472
    ds_read_b64 v[48:49], v39 offset:7680
    ds_read_b64 v[50:51], v39 offset:41472
    s_setprio 0
    v_and_b32 v196, v9, v25
    v_and_b32 v197, v9, v27
    v_and_b32 v198, v9, v29
    v_and_b32 v199, v9, v31
    v_mul_f32 v204, v8, v196
    v_mul_f32 v205, v8, v197
    v_mul_f32 v206, v8, v198
    v_mul_f32 v207, v8, v199
    v_exp_f32 v204, v204
    v_exp_f32 v205, v205
    v_exp_f32 v206, v206
    v_exp_f32 v207, v207
    v_and_b32 v219, v9, v238
    v_add_f32 v204, 1.0, v204
    v_add_f32 v205, 1.0, v205
    v_add_f32 v206, 1.0, v206
    v_add_f32 v207, 1.0, v207
    v_rcp_f32 v204, v204
    v_rcp_f32 v205, v205
    v_rcp_f32 v206, v206
    v_rcp_f32 v207, v207
    v_lshlrev_b32 v218, 16, v238
    s_waitcnt lgkmcnt(0)
    v_cmp_eq_u32 vcc, 0, v41
    s_cbranch_vccz L_w3_go
    s_setprio 2
L_w3:
    ds_read_b32 v41, v88 offset:96
    ds_read_b64 v[44:45], v37 offset:7680
    ds_read_b64 v[46:47], v37 offset:41472
    ds_read_b64 v[48:49], v39 offset:7680
    ds_read_b64 v[50:51], v39 offset:41472
    s_waitcnt lgkmcnt(0)
    v_cmp_eq_u32 vcc, 0, v41
    s_cbranch_vccz L_w3_ok
    s_sleep 1
    s_sub_u32 s61, s61, 1
    s_cbranch_scc0 L_w3
L_w3_ok:
L_w3_go:
    v_fma_f32 v208, v44, v200, v217
    v_fma_f32 v209, v46, v201, v217
    v_fma_f32 v210, v48, v202, v217
    v_fma_f32 v211, v50, v203, v217
    v_fma_f32 v192, v192, v208, v216
    v_fma_f32 v193, v193, v209, v216
    v_fma_f32 v194, v194, v210, v216
    v_fma_f32 v195, v195, v211, v216
    v_cvt_pk_bf16_f32 v200, v192, v193
    v_cvt_pk_bf16_f32 v201, v194, v195
    global_store_dwordx2 v36, v[200:201], s[32:33] offset:0
    v_fma_f32 v212, v45, v204, v219
    v_fma_f32 v213, v47, v205, v219
    v_fma_f32 v214, v49, v206, v219
    v_fma_f32 v215, v51, v207, v219
    v_fma_f32 v196, v196, v212, v218
    v_fma_f32 v197, v197, v213, v218
    v_fma_f32 v198, v198, v214, v218
    v_fma_f32 v199, v199, v215, v218
    v_cvt_pk_bf16_f32 v204, v196, v197
    v_cvt_pk_bf16_f32 v205, v198, v199
    global_store_dwordx2 v36, v[204:205], s[32:33] offset:1152
    s_waitcnt vmcnt(0)
    s_barrier
    s_endpgm
L_lnp:
    s_mul_i32 s43, s39, 1216
    s_add_u32 s43, s43, 154048
    v_add_u32 v52, s43, v3
    v_add_u32 v53, s43, v4
    s_lshl_b32 s43, s39, 3
    s_add_u32 s43, s43, 163776
    v_mov_b32 v54, s43
    v_bfe_u32 v55, v0, 2, 2
    v_mul_u32_u24 v55, 1216, v55
    v_and_b32 v56, 3, v0
    v_lshl_add_u32 v55, v56, 3, v55
    v_lshrrev_b32 v56, 4, v0
    v_lshl_add_u32 v55, v56, 5, v55
    v_add_u32 v55, 154048, v55
    v_lshrrev_b32 v56, 3, v0
    v_lshlrev_b32 v56, 15, v56
    v_and_b32 v57, 112, v3
    s_lshl_b32 s43, s2, 7
    s_add_u32 s43, s43, 2101248
    v_add3_u32 v56, v56, v57, s43
    v_mov_b32 v40, 0
    v_mov_b32 v41, 0
    v_mov_b32 v42, 0
    v_mov_b32 v43, 0
    v_mov_b32 v44, 0x3ae38e39
    v_mov_b32 v38, 0xbfffbfff
    v_mov_b32 v37, 0xffff
    s_lshl_b32 s58, s2, 3
    s_add_u32 s58, s58, s39
    s_xor_b32 s58, s58, 0x7ff
    s_lshl_b32 s58, s58, 5
    s_waitcnt lgkmcnt(0)
    s_add_u32 s38, s38, 0x9e370001
    s_lshr_b32 s44, s38, 16
    s_and_b32 s45, s38, 0xff
    s_and_b32 s46, s38, 0xfb
    s_bitcmp0_b32 s38, 0
    s_cselect_b32 s43, 4, 0
    s_or_b32 s46, s46, s43
    s_bitcmp1_b32 s46, s39
    s_cselect_b32 s43, 0x40004000, 0
    v_mov_b32 v39, s43
    s_xor_b32 s58, s58, s44
    v_mov_b32 v57, s58
    s_mov_b32 s42, 0x3f803f80
    s_cmp_lt_u32 s41, 27
    s_cbranch_scc1 L_lw2
    s_cmp_lt_u32 s39, 2
    s_cbranch_scc0 L_lw1
    global_load_dword v1, v76, s[56:57]
    s_waitcnt vmcnt(1)
    s_branch L_ln
L_lw1:
    s_waitcnt vmcnt(0)
    s_branch L_ln
L_lw2:
    s_add_u32 m0, s49, 0
    s_nop 0
    global_load_lds_dwordx4 v76, s[56:57]
    v_add_u32 v76, 294912, v76
    s_add_u32 m0, s49, 4096
    s_nop 0
    global_load_lds_dwordx4 v76, s[56:57]
    v_add_u32 v76, 294912, v76
    s_add_u32 m0, s49, 8192
    s_nop 0
    global_load_lds_dwordx4 v76, s[56:57]
    v_add_u32 v76, 294912, v76
    s_waitcnt vmcnt(3)
L_ln:
    v_dot2c_f32_bf16 v40, s42, v12
    v_dot2c_f32_bf16 v41, v12, v12
    v_dot2c_f32_bf16 v42, v12, v20
    v_dot2c_f32_bf16 v43, s42, v20
    v_dot2c_f32_bf16 v40, s42, v13
    v_dot2c_f32_bf16 v41, v13, v13
    v_dot2c_f32_bf16 v42, v13, v21
    v_dot2c_f32_bf16 v43, s42, v21
    v_dot2c_f32_bf16 v40, s42, v14
    v_dot2c_f32_bf16 v41, v14, v14
    v_dot2c_f32_bf16 v42, v14, v22
    v_dot2c_f32_bf16 v43, s42, v22
    v_dot2c_f32_bf16 v40, s42, v15
    v_dot2c_f32_bf16 v41, v15, v15
    v_dot2c_f32_bf16 v42, v15, v23
    v_dot2c_f32_bf16 v43, s42, v23
    v_dot2c_f32_bf16 v40, s42, v16
    v_dot2c_f32_bf16 v41, v16, v16
    v_dot2c_f32_bf16 v42, v16, v24
    v_dot2c_f32_bf16 v43, s42, v24
    v_lshlrev_b32 v36, 16, v16
    v_lshlrev_b32 v28, 16, v12
    v_and_b32 v29, 0xffff0000, v12
    v_permlane32_swap_b32 v40, v42
    v_permlane32_swap_b32 v41, v43
    v_add_f32 v40, v40, v42
    v_add_f32 v41, v41, v43
    v_lshlrev_b32 v30, 16, v13
    v_and_b32 v31, 0xffff0000, v13
    v_permlane16_swap_b32 v40, v41
    v_add_f32 v40, v40, v41
    v_lshlrev_b32 v32, 16, v14
    v_and_b32 v33, 0xffff0000, v14
    v_add_f32_dpp v40, v40, v40 row_ror:8 row_mask:0xf bank_mask:0xf
    v_lshlrev_b32 v34, 16, v15
    v_and_b32 v35, 0xffff0000, v15
    v_add_f32_dpp v40, v40, v40 row_ror:4 row_mask:0xf bank_mask:0xf
    s_nop 1
    v_add_f32_dpp v40, v40, v40 row_ror:2 row_mask:0xf bank_mask:0xf
    s_nop 1
    v_add_f32_dpp v40, v40, v40 row_ror:1 row_mask:0xf bank_mask:0xf
    s_nop 0
    v_readlane_b32 s58, v40, 0
    v_readlane_b32 s59, v40, 16
    v_readlane_b32 s60, v40, 32
    v_readlane_b32 s61, v40, 48
    v_mul_f32 v40, s58, v44
    v_mul_f32 v41, s59, v44
    v_fma_f32 v41, -v40, v40, v41
    v_max_f32 v41, 0, v41
    v_cvt_pk_bf16_f32 v44, v41, v40
    v_lshlrev_b32 v41, 16, v44
    v_add_f32 v41, 0x3727c5ac, v41
    v_cvt_pk_bf16_f32 v41, v41, v41
    v_and_b32 v41, 0xffff0000, v41
    v_mul_f32 v41, 0x44800000, v41
    v_sqrt_f32 v41, v41
    v_and_b32 v49, 0xffff0000, v44
    v_cvt_pk_bf16_f32 v50, v49, v41
    v_and_b32 v41, 0xffff0000, v50
    v_rcp_f32 v46, v41
    v_mul_f32 v42, s61, v49
    v_mul_f32 v47, v49, v46
    v_fma_f32 v28, v28, v46, -v47
    v_fma_f32 v29, v29, v46, -v47
    v_fma_f32 v30, v30, v46, -v47
    v_fma_f32 v31, v31, v46, -v47
    v_fma_f32 v32, v32, v46, -v47
    v_fma_f32 v33, v33, v46, -v47
    v_fma_f32 v34, v34, v46, -v47
    v_fma_f32 v35, v35, v46, -v47
    v_fma_f32 v36, v36, v46, -v47
    v_cvt_pk_bf16_f32 v28, v28, v29
    v_cvt_pk_bf16_f32 v29, v30, v31
    v_cvt_pk_bf16_f32 v30, v32, v33
    v_cvt_pk_bf16_f32 v31, v34, v35
    v_cvt_pk_bf16_f32 v32, v36, v36
    v_bitop3_b32 v28, v28, v38, v39 bitop3:0xea
    v_bitop3_b32 v29, v29, v38, v39 bitop3:0xea
    v_bitop3_b32 v30, v30, v38, v39 bitop3:0xea
    v_bitop3_b32 v31, v31, v38, v39 bitop3:0xea
    v_bitop3_b32 v32, v32, v38, v39 bitop3:0xea
    ds_write_b128 v52, v[28:31]
    ds_write_b16 v53, v32 offset:1024
    v_sub_f32 v42, s60, v42
    v_mul_f32 v42, 0x42000000, v42
    v_mul_f32 v42, v42, v46
    v_cvt_pk_bf16_f32 v42, v42, v42
    v_ashrrev_i32 v43, 31, v42
    v_or_b32 v43, 0x80000000, v43
    v_xor_b32 v42, v42, v43
    v_bitop3_b32 v51, v37, v57, v42 bitop3:0xca
    s_mov_b64 exec, 1
    ds_write_b64 v54, v[50:51]
    s_mov_b64 exec, -1
    s_waitcnt lgkmcnt(0)
    s_barrier
    s_cmp_eq_u32 s39, 1
    s_cbranch_scc1 L_ln_stat
    ds_read_b64_tr_b16 v[28:29], v55
    ds_read_b64_tr_b16 v[30:31], v55 offset:4864
    s_cmp_eq_u32 s39, 0
    s_cbranch_scc0 L_ln_st
    ds_read_b64_tr_b16 v[32:33], v55 offset:1024
    ds_read_b64_tr_b16 v[34:35], v55 offset:5888
    v_add_u32 v38, 2097152, v56
    s_waitcnt lgkmcnt(0)
    global_store_dwordx4 v38, v[32:35], s[36:37] sc1
    s_branch L_ln_st
L_ln_stat:
    v_and_b32 v41, 0x30, v3
    v_add_u32 v40, 163776, v41
    ds_read_b128 v[48:51], v40
    ds_read_b64_tr_b16 v[28:29], v55
    ds_read_b64_tr_b16 v[30:31], v55 offset:4864
    s_lshl_b32 s43, s2, 6
    s_add_u32 s43, s43, 16384
    v_add_u32 v41, s43, v41
    s_mov_b64 exec, 15
    s_waitcnt lgkmcnt(2)
    global_store_dwordx4 v41, v[48:51], s[36:37] sc1
    s_mov_b64 exec, -1
L_ln_st:
    s_waitcnt lgkmcnt(0)
    global_store_dwordx4 v56, v[28:31], s[36:37] sc1
    s_barrier
    s_cmp_lt_u32 s41, 27
    s_cbranch_scc1 L_ffn
    s_cmp_lt_u32 s39, 2
    s_cbranch_scc1 L_sp2
    global_load_dword v1, v76, s[56:57]
L_sp2:
    s_mul_i32 s42, s39, 320
    s_add_u32 s42, s42, s53
    s_add_u32 s42, s42, 2944
    s_mov_b32 s58, 2
    s_mul_i32 s43, s40, 1152
    s_add_u32 s43, s43, 884736
    s_mul_i32 s59, s40, 663552
    s_cmp_eq_u32 s58, 0
    s_cselect_b32 s56, s26, s28
    s_cselect_b32 s57, s27, s29
    s_cmp_eq_u32 s58, 2
    s_cselect_b32 s56, s30, s56
    s_cselect_b32 s57, s31, s57
    s_cselect_b32 s43, s59, s43
    s_movk_i32 s58, 128
    s_movk_i32 s59, 8064
    s_movk_i32 s60, 4319
    s_cmov_b32 s58, 73728
    s_cmov_b32 s59, -663424
    s_cmovk_i32 s60, 5183
    v_add_u32 v76, s42, v2
    v_min_u32 v76, s60, v76
    v_mul_u32_u24 v63, 7282, v76
    v_lshrrev_b32 v63, 16, v63
    v_mul_u32_u24 v76, s58, v76
    v_mad_i32_i24 v76, v63, s59, v76
    v_add_u32 v76, s43, v76
    s_barrier
    s_cmp_ge_u32 s39, 7
    s_cbranch_scc1 L_sp3
    global_load_dword v1, v76, s[56:57]
L_sp3:
    s_sub_u32 s42, s2, 216
    s_cmp_ge_u32 s42, 32
    s_cbranch_scc1 L_sp4
    s_cmp_ge_u32 s39, 1
    s_cbranch_scc1 L_sp4
    s_lshl_b32 s42, s42, 6
    v_add_u32 v76, s42, v2
    v_mul_u32_u24 v76, 1152, v76
    s_lshl_b32 s42, s39, 7
    v_subrev_u32 v76, s42, v76
    v_add_u32 v76, 1024, v76
    global_load_dword v1, v76, s[32:33]
L_sp4:
    s_waitcnt vmcnt(0) lgkmcnt(0)
    s_endpgm
L_ffn:
    v_bfe_u32 v14, v0, 4, 2
    v_and_b32 v11, 7, v0
    v_mov_b32 v26, 147456
    v_mov_b32 v27, 4
    s_cmp_eq_u32 s52, 0
    s_cbranch_scc0 L_gu
    s_setprio 1
    v_lshlrev_b32 v8, 4, v0
    v_add_u32 v9, 20480, v8
    v_add_u32 v10, 8192, v9
    v_lshlrev_b32 v13, 6, v0
    v_xor_b32 v128, 65504, v13
    v_xor_b32 v129, 65472, v13
    v_xor_b32 v130, 49120, v13
    v_xor_b32 v131, 49088, v13
    v_xor_b32 v132, 32736, v13
    v_xor_b32 v133, 32704, v13
    v_xor_b32 v134, 16352, v13
    v_xor_b32 v135, 16320, v13
    v_mov_b32 v36, s44
    v_lshrrev_b32 v25, 5, v0
    v_lshl_add_u32 v25, v25, 2, v26
    s_mul_i32 s62, s39, 80
    s_add_u32 s62, s62, 147584
    v_and_b32 v15, 0x3c, v0
    v_add_u32 v15, s62, v15
    v_and_b32 v16, 3, v0
    v_mul_u32_u24 v16, 80, v16
    v_add_u32 v16, 147584, v16
    v_lshrrev_b32 v12, 3, v2
    v_lshl_add_u32 v17, v12, 2, v26
    v_lshl_add_u32 v18, v11, 2, v26
    v_and_b32 v12, 6, v12
    v_xor_b32 v12, v12, v11
    v_lshlrev_b32 v12, 4, v12
    v_lshl_add_u32 v12, v1, 7, v12
    v_add_u32 v12, 2358144, v12
    s_lshl_b32 s63, s54, 7
    s_add_u32 s63, s63, 2358144
    v_mov_b32 v37, s63
    s_movk_i32 s63, -1152
    s_mul_i32 s64, s39, 1056
    s_mul_i32 s42, s50, 73728
    s_add_u32 s12, s30, s42
    s_addc_u32 s13, s31, 0
    s_add_u32 s14, s12, 18432
    s_addc_u32 s15, s13, 0
    s_add_u32 s16, s12, 36864
    s_addc_u32 s17, s13, 0
    s_add_u32 s18, s12, 55296
    s_addc_u32 s19, s13, 0
    v_mul_u32_u24 v19, 4608, v14
    v_and_b32 v20, 0xf0, v3
    s_lshl_b32 s42, s51, 8
    v_add3_u32 v19, v19, v20, s42
    v_lshrrev_b32 v20, 1, v2
    v_mul_u32_u24 v20, 1152, v20
    v_and_b32 v21, 16, v3
    s_lshl_b32 s42, s51, 5
    v_add3_u32 v20, v20, v21, s42
    v_bfe_i32 v232, v0, 3, 1
    v_mul_u32_u24 v4, 74752, v14
    v_lshl_add_u32 v4, v11, 4, v4
    v_and_b32 v5, 37376, v232
    s_lshl_b32 s43, s50, 7
    s_add_u32 s43, s43, 65536
    s_mul_i32 s42, s51, 299008
    s_add_u32 s42, s42, s43
    v_add3_u32 v4, v4, v5, s42
    v_add_u32 v5, 18688, v4
    v_add_u32 v6, 9344, v4
    v_add_u32 v7, 28032, v4
    v_mul_u32_u24 v8, 9344, v14
    v_lshl_add_u32 v8, v11, 4, v8
    s_mul_i32 s42, s51, 37376
    s_add_u32 s42, s42, s43
    s_add_u32 s42, s42, 1196032
    v_add_u32 v8, s42, v8
    v_mov_b32 v233, s45
    v_mov_b32 v234, 0xff
    v_and_b32 v235, 0x370, v3
    v_add_u32 v235, 147968, v235
    s_lshl_b32 s42, s51, 10
    s_add_u32 s42, s42, 159520
    v_add_u32 v236, s42, v3
    v_lshl_add_u32 v237, v2, 3, s42
    s_mov_b32 s66, 0x05040100
    s_mov_b32 s67, 0x07060302
    s_mov_b32 s55, 131072
    s_waitcnt vmcnt(0)
    s_barrier
    global_load_dwordx4 v[112:115], v9, s[36:37] offset:-4096 sc1
    global_load_dwordx4 v[116:119], v9, s[36:37] offset:0 sc1
    global_load_dwordx4 v[120:123], v10, s[36:37] offset:-4096 sc1
    global_load_dwordx4 v[124:127], v10, s[36:37] offset:0 sc1
L_ffn_poll:
    v_mov_b32 v24, 0
    s_waitcnt vmcnt(3)
    v_xor_b32 v28, v36, v113
    v_bitop3_b32 v24, v24, v28, v128 bitop3:0xf6
    v_xor_b32 v29, v36, v115
    v_bitop3_b32 v24, v24, v29, v129 bitop3:0xf6
    s_waitcnt vmcnt(2)
    v_xor_b32 v30, v36, v117
    v_bitop3_b32 v24, v24, v30, v130 bitop3:0xf6
    v_xor_b32 v31, v36, v119
    v_bitop3_b32 v24, v24, v31, v131 bitop3:0xf6
    s_waitcnt vmcnt(1)
    v_xor_b32 v32, v36, v121
    v_bitop3_b32 v24, v24, v32, v132 bitop3:0xf6
    v_xor_b32 v33, v36, v123
    v_bitop3_b32 v24, v24, v33, v133 bitop3:0xf6
    s_waitcnt vmcnt(0)
    v_xor_b32 v34, v36, v125
    v_bitop3_b32 v24, v24, v34, v134 bitop3:0xf6
    v_xor_b32 v35, v36, v127
    v_bitop3_b32 v24, v24, v35, v135 bitop3:0xf6
    v_and_b32 v24, 0xffff, v24
    v_cmp_ne_u32 vcc, 0, v24
    v_max3_u32 v38, v28, v29, v30
    v_max3_u32 v39, v31, v32, v33
    s_cbranch_vccz L_ffn_go
    global_load_dwordx4 v[112:115], v9, s[36:37] offset:-4096 sc1
    global_load_dwordx4 v[116:119], v9, s[36:37] offset:0 sc1
    global_load_dwordx4 v[120:123], v10, s[36:37] offset:-4096 sc1
    global_load_dwordx4 v[124:127], v10, s[36:37] offset:0 sc1
    s_sub_u32 s55, s55, 1
    s_cbranch_scc0 L_ffn_poll
    s_waitcnt vmcnt(0)
L_ffn_go:
    s_barrier
    v_max3_u32 v38, v38, v34, v35
    v_max_u32 v38, v38, v39
    v_alignbit_b32 v24, 1, v38, 5
    v_sub_u32 v128, v28, v38
    v_sub_u32 v129, v29, v38
    v_max_u32_dpp v21, v24, v24 row_ror:1 row_mask:0xf bank_mask:0xf
    v_sub_u32 v130, v30, v38
    v_sub_u32 v131, v31, v38
    v_max_u32_dpp v21, v21, v21 row_ror:2 row_mask:0xf bank_mask:0xf
    v_sub_u32 v132, v32, v38
    v_sub_u32 v133, v33, v38
    v_max_u32_dpp v21, v21, v21 row_ror:4 row_mask:0xf bank_mask:0xf
    v_sub_u32 v134, v34, v38
    v_sub_u32 v135, v35, v38
    v_max_u32_dpp v21, v21, v21 row_ror:8 row_mask:0xf bank_mask:0xf
    v_max3_u32 v39, v128, v129, v130
    v_max3_u32 v22, v131, v132, v133
    v_max_u32_dpp v21, v21, v21 row_bcast:15 row_mask:0xa bank_mask:0xf
    s_mov_b32 exec_lo, 0x80000000
    s_mov_b32 exec_hi, 0x80000000
    ds_write_b32 v25, v21
    s_mov_b64 exec, -1
    s_mov_b32 s55, 2097152
    ds_read_b128 v[112:115], v26
    ds_read_b128 v[116:119], v26 offset:16
    v_max3_u32 v39, v39, v134, v135
    v_max_u32 v39, v39, v22
    v_add_u32 v39, v39, v38
    v_alignbit_b32 v23, 1, v39, 5
L_s1:
    s_waitcnt lgkmcnt(0)
    v_min3_u32 v21, v112, v113, v114
    v_min3_u32 v22, v115, v116, v117
    v_min3_u32 v21, v21, v118, v119
    v_min_u32 v21, v21, v22
    v_cmp_eq_u32 vcc, 0, v21
    v_cmp_ge_u32 s[6:7], v24, v21
    v_cmp_ge_u32 s[8:9], v23, v21
    s_cbranch_vccz L_s1_ok
    ds_read_b128 v[112:115], v26
    ds_read_b128 v[116:119], v26 offset:16
    s_sub_u32 s55, s55, 1
    s_cbranch_scc0 L_s1
L_s1_ok:
    s_bcnt1_i32_b64 s10, s[6:7]
    v_mbcnt_lo_u32_b32 v22, s6, 0
    v_mbcnt_lo_u32_b32 v13, s8, 0
    v_mbcnt_hi_u32_b32 v22, s7, v22
    v_mbcnt_hi_u32_b32 v13, s9, v13
    v_min_u32 v22, 16, v22
    v_add_u32 v13, s10, v13
    v_lshl_add_u32 v22, v22, 2, s62
    v_min_u32 v13, 16, v13
    s_mov_b64 exec, s[6:7]
    ds_write_b32 v22, v24
    v_lshl_add_u32 v13, v13, 2, s62
    s_mov_b64 exec, s[8:9]
    ds_write_b32 v13, v23
    s_mov_b64 exec, 1
    ds_add_u32 v26, v27 offset:32
    s_mov_b64 exec, -1
    ds_read_b32 v22, v26 offset:32
    ds_read_b32 v13, v15
    ds_read_b128 v[112:115], v16 offset:0
    ds_read_b128 v[116:119], v16 offset:16
    ds_read_b128 v[120:123], v16 offset:32
    ds_read_b128 v[124:127], v16 offset:48
    v_and_b32 v24, 0x7ff, v24
    v_and_b32 v23, 0x7ff, v23
    v_mad_i32_i24 v24, v24, s63, v37
    v_mad_i32_i24 v23, v23, s63, v37
    s_mov_b64 exec, s[6:7]
    global_load_dword v239, v24, s[4:5]
    s_cmp_eq_u64 s[8:9], 0
    s_cbranch_scc1 L_no2
    s_mov_b64 exec, s[8:9]
    global_load_dword v239, v23, s[4:5]
L_no2:
    s_mov_b64 exec, -1
L_s2:
    s_waitcnt lgkmcnt(0)
    v_cmp_ne_u32 vcc, 16, v22
    v_mov_b32 v24, 0
    s_cbranch_vccz L_s2_ok
    ds_read_b32 v22, v26 offset:32
    ds_read_b32 v13, v15
    ds_read_b128 v[112:115], v16 offset:0
    ds_read_b128 v[116:119], v16 offset:16
    ds_read_b128 v[120:123], v16 offset:32
    ds_read_b128 v[124:127], v16 offset:48
    s_sub_u32 s55, s55, 1
    s_cbranch_scc0 L_s2
L_s2_ok:
    v_sub_u32 v112, v13, v112
    v_alignbit_b32 v24, v24, v112, 31
    v_sub_u32 v113, v13, v113
    v_alignbit_b32 v24, v24, v113, 31
    v_sub_u32 v114, v13, v114
    v_alignbit_b32 v24, v24, v114, 31
    v_sub_u32 v115, v13, v115
    v_alignbit_b32 v24, v24, v115, 31
    v_sub_u32 v116, v13, v116
    v_alignbit_b32 v24, v24, v116, 31
    v_sub_u32 v117, v13, v117
    v_alignbit_b32 v24, v24, v117, 31
    v_sub_u32 v118, v13, v118
    v_alignbit_b32 v24, v24, v118, 31
    v_sub_u32 v119, v13, v119
    v_alignbit_b32 v24, v24, v119, 31
    v_sub_u32 v120, v13, v120
    v_alignbit_b32 v24, v24, v120, 31
    v_sub_u32 v121, v13, v121
    v_alignbit_b32 v24, v24, v121, 31
    v_sub_u32 v122, v13, v122
    v_alignbit_b32 v24, v24, v122, 31
    v_sub_u32 v123, v13, v123
    v_alignbit_b32 v24, v24, v123, 31
    v_sub_u32 v124, v13, v124
    v_alignbit_b32 v24, v24, v124, 31
    v_sub_u32 v125, v13, v125
    v_alignbit_b32 v24, v24, v125, 31
    v_sub_u32 v126, v13, v126
    v_alignbit_b32 v24, v24, v126, 31
    v_sub_u32 v127, v13, v127
    v_alignbit_b32 v24, v24, v127, 31
    v_bcnt_u32_b32 v24, v24, 0
    s_nop 1
    v_add_u32_dpp v24, v24, v24 quad_perm:[1,0,3,2] row_mask:0xf bank_mask:0xf
    s_nop 1
    v_add_u32_dpp v24, v24, v24 quad_perm:[2,3,0,1] row_mask:0xf bank_mask:0xf
    v_cmp_gt_u32 vcc, 8, v24
    v_lshl_add_u32 v24, v24, 2, v26
    s_mov_b64 exec, vcc
    ds_write_b32 v24, v13 offset:64
    s_mov_b64 exec, -1
L_s3:
    ds_read_b32 v23, v17 offset:64
    ds_read_b32 v13, v18 offset:64
    s_add_u32 m0, s64, 150016
    s_waitcnt lgkmcnt(0)
    v_cmp_eq_u32 vcc, 0, v23
    v_and_b32 v23, 0x7ff, v23
    s_sub_u32 s55, s55, 1
    s_cselect_b64 vcc, 0, vcc
    s_cbranch_vccnz L_s3
    v_mad_i32_i24 v23, v23, s63, v12
    global_load_lds_dwordx4 v23, s[4:5]
    s_add_u32 m0, s64, 153728
    v_and_b32 v22, 0x7ff, v13
    global_load_lds_dwordx4 v23, s[4:5] offset:512
    v_sub_u32 v22, 2047, v22
    s_cmp_lg_u32 s39, 0
    s_cbranch_scc1 L_nox9
    s_mov_b32 m0, 157440
    s_nop 0
    global_load_lds_dwordx4 v23, s[4:5] offset:1024
    s_branch L_x3
L_nox9:
    v_lshlrev_b32 v24, 3, v22
    v_add_u32 v24, 16384, v24
    global_load_dword v25, v24, s[36:37] sc1
L_x3:
    s_barrier
    v_readlane_b32 s10, v13, 7
    s_mov_b32 s11, 0
    s_lshl_b32 s10, s10, 5
    v_cmp_le_u32 vcc, s10, v28
    s_nop 0
    s_bcnt1_i32_b64 s56, vcc
    s_add_u32 s11, s11, s56
    v_cmp_le_u32 vcc, s10, v29
    s_nop 0
    s_bcnt1_i32_b64 s56, vcc
    s_add_u32 s11, s11, s56
    v_cmp_le_u32 vcc, s10, v30
    s_nop 0
    s_bcnt1_i32_b64 s56, vcc
    s_add_u32 s11, s11, s56
    v_cmp_le_u32 vcc, s10, v31
    s_nop 0
    s_bcnt1_i32_b64 s56, vcc
    s_add_u32 s11, s11, s56
    v_cmp_le_u32 vcc, s10, v32
    s_nop 0
    s_bcnt1_i32_b64 s56, vcc
    s_add_u32 s11, s11, s56
    v_cmp_le_u32 vcc, s10, v33
    s_nop 0
    s_bcnt1_i32_b64 s56, vcc
    s_add_u32 s11, s11, s56
    v_cmp_le_u32 vcc, s10, v34
    s_nop 0
    s_bcnt1_i32_b64 s56, vcc
    s_add_u32 s11, s11, s56
    v_cmp_le_u32 vcc, s10, v35
    s_nop 0
    s_bcnt1_i32_b64 s56, vcc
    s_add_u32 s11, s11, s56
    s_lshl_b32 s11, s11, 16
    s_or_b32 s11, s11, 4
    v_mov_b32 v36, s11
    s_barrier
    global_load_dwordx4 v[40:43], v19, s[12:13] offset:0
    global_load_dwordx4 v[44:47], v19, s[12:13] offset:1152
    s_waitcnt vmcnt(2)
    s_cmp_lg_u32 s39, 1
    s_cbranch_scc1 L_nost
    ds_write_b32 v18, v25 offset:448
L_nost:
    s_mov_b64 exec, 1
    ds_add_u32 v26, v36 offset:36
    s_mov_b64 exec, -1
    s_setprio 0
    global_load_dwordx4 v[48:51], v19, s[12:13] offset:2304
    global_load_dwordx4 v[52:55], v19, s[12:13] offset:3456
    global_load_dwordx4 v[56:59], v19, s[14:15] offset:0
    global_load_dwordx4 v[60:63], v19, s[14:15] offset:1152
    global_load_dwordx4 v[64:67], v19, s[14:15] offset:2304
    global_load_dwordx4 v[68:71], v19, s[14:15] offset:3456
    global_load_dwordx4 v[216:219], v20, s[12:13] offset:1024
    global_load_dwordx4 v[220:223], v20, s[16:17] offset:1024
L_s4:
    ds_read_b32 v24, v26 offset:36
    s_waitcnt lgkmcnt(0)
    v_readfirstlane_b32 s61, v24
    s_nop 0
    s_and_b32 s60, s61, 255
    s_cmp_ge_u32 s60, 16
    s_cbranch_scc1 L_s4_ok
    s_sub_u32 s55, s55, 1
    s_cbranch_scc0 L_s4
L_s4_ok:
    s_lshr_b32 s61, s61, 16
    s_cmp_eq_u32 s61, 8
    s_cbranch_scc0 L_slow
L_dgo:
    global_load_dwordx4 v[72:75], v19, s[16:17] offset:0
    s_waitcnt vmcnt(9)
    v_perm_b32 v112, v44, v40, s66
    v_perm_b32 v116, v44, v40, s67
    v_perm_b32 v120, v45, v41, s66
    v_perm_b32 v124, v45, v41, s67
    v_perm_b32 v128, v46, v42, s66
    v_perm_b32 v132, v46, v42, s67
    v_perm_b32 v136, v47, v43, s66
    v_perm_b32 v140, v47, v43, s67
    global_load_dwordx4 v[76:79], v19, s[16:17] offset:1152
    s_waitcnt vmcnt(8)
    v_perm_b32 v113, v52, v48, s66
    v_perm_b32 v117, v52, v48, s67
    v_perm_b32 v121, v53, v49, s66
    v_perm_b32 v125, v53, v49, s67
    v_perm_b32 v129, v54, v50, s66
    v_perm_b32 v133, v54, v50, s67
    v_perm_b32 v137, v55, v51, s66
    v_perm_b32 v141, v55, v51, s67
    global_load_dwordx4 v[80:83], v19, s[16:17] offset:2304
    global_load_dwordx4 v[84:87], v19, s[16:17] offset:3456
    s_waitcnt vmcnt(8)
    v_perm_b32 v114, v60, v56, s66
    v_perm_b32 v118, v60, v56, s67
    v_perm_b32 v122, v61, v57, s66
    v_perm_b32 v126, v61, v57, s67
    v_perm_b32 v130, v62, v58, s66
    v_perm_b32 v134, v62, v58, s67
    v_perm_b32 v138, v63, v59, s66
    v_perm_b32 v142, v63, v59, s67
    global_load_dwordx4 v[88:91], v19, s[18:19] offset:0
    global_load_dwordx4 v[92:95], v19, s[18:19] offset:1152
    s_waitcnt vmcnt(8)
    v_perm_b32 v115, v68, v64, s66
    v_perm_b32 v119, v68, v64, s67
    v_perm_b32 v123, v69, v65, s66
    v_perm_b32 v127, v69, v65, s67
    v_perm_b32 v131, v70, v66, s66
    v_perm_b32 v135, v70, v66, s67
    v_perm_b32 v139, v71, v67, s66
    v_perm_b32 v143, v71, v67, s67
    global_load_dwordx4 v[96:99], v19, s[18:19] offset:2304
    global_load_dwordx4 v[100:103], v19, s[18:19] offset:3456
    s_waitcnt vmcnt(6)
    ds_write_b128 v236, v[216:219]
    ds_read_b64_tr_b16 v[104:105], v237
    ds_read_b64_tr_b16 v[106:107], v237 offset:512
    ds_write_b128 v236, v[220:223]
    ds_read_b64_tr_b16 v[108:109], v237
    ds_read_b64_tr_b16 v[110:111], v237 offset:512
    v_perm_b32 v144, v76, v72, s66
    v_perm_b32 v148, v76, v72, s67
    v_perm_b32 v152, v77, v73, s66
    v_perm_b32 v156, v77, v73, s67
    v_perm_b32 v160, v78, v74, s66
    v_perm_b32 v164, v78, v74, s67
    v_perm_b32 v168, v79, v75, s66
    v_perm_b32 v172, v79, v75, s67
    s_barrier
    ds_read_b128 v[28:31], v235
    ds_read_b128 v[32:35], v235 offset:1024
    s_mov_b32 s58, 0x00ff00ff
    s_mov_b32 s59, 0x00ff00ff
    s_waitcnt vmcnt(4)
    v_perm_b32 v145, v84, v80, s66
    v_perm_b32 v149, v84, v80, s67
    v_perm_b32 v153, v85, v81, s66
    v_perm_b32 v157, v85, v81, s67
    v_perm_b32 v161, v86, v82, s66
    v_perm_b32 v165, v86, v82, s67
    v_perm_b32 v169, v87, v83, s66
    v_perm_b32 v173, v87, v83, s67
    s_waitcnt lgkmcnt(0)
    v_mfma_f32_16x16x32_bf16 v[208:211], v[104:107], v[28:31], 0
    s_waitcnt vmcnt(2)
    v_perm_b32 v146, v92, v88, s66
    v_mfma_f32_16x16x32_bf16 v[208:211], v[108:111], v[32:35], v[208:211]
    v_perm_b32 v150, v92, v88, s67
    v_perm_b32 v154, v93, v89, s66
    v_mfma_f32_16x16x32_bf16 v[176:179], v[112:115], v[28:31], 0
    v_perm_b32 v158, v93, v89, s67
    v_perm_b32 v162, v94, v90, s66
    v_mfma_f32_16x16x32_bf16 v[180:183], v[116:119], v[28:31], 0
    v_perm_b32 v166, v94, v90, s67
    v_perm_b32 v170, v95, v91, s66
    v_mfma_f32_16x16x32_bf16 v[184:187], v[120:123], v[28:31], 0
    v_perm_b32 v174, v95, v91, s67
    s_waitcnt vmcnt(0)
    v_mfma_f32_16x16x32_bf16 v[188:191], v[124:127], v[28:31], 0
    v_perm_b32 v147, v100, v96, s66
    v_perm_b32 v151, v100, v96, s67
    v_perm_b32 v155, v101, v97, s66
    v_perm_b32 v159, v101, v97, s67
    v_perm_b32 v163, v102, v98, s66
    v_perm_b32 v167, v102, v98, s67
    v_perm_b32 v171, v103, v99, s66
    v_perm_b32 v175, v103, v99, s67
    v_mfma_f32_16x16x32_bf16 v[176:179], v[144:147], v[32:35], v[176:179]
    v_mfma_f32_16x16x32_bf16 v[180:183], v[148:151], v[32:35], v[180:183]
    v_bitop3_b32 v208, v234, v233, v208 bitop3:0xca
    s_mov_b64 exec, s[58:59]
    global_store_dwordx4 v8, v[208:211], s[36:37] sc1
    s_mov_b64 exec, -1
    v_mfma_f32_16x16x32_bf16 v[184:187], v[152:155], v[32:35], v[184:187]
    v_mfma_f32_16x16x32_bf16 v[188:191], v[156:159], v[32:35], v[188:191]
    v_mfma_f32_16x16x32_bf16 v[192:195], v[128:131], v[28:31], 0
    v_mfma_f32_16x16x32_bf16 v[196:199], v[132:135], v[28:31], 0
    v_mfma_f32_16x16x32_bf16 v[200:203], v[136:139], v[28:31], 0
    v_bitop3_b32 v212, v232, v178, v176 bitop3:0xca
    v_bitop3_b32 v213, v232, v182, v180 bitop3:0xca
    v_mfma_f32_16x16x32_bf16 v[204:207], v[140:143], v[28:31], 0
    s_nop 0
    v_bitop3_b32 v214, v232, v186, v184 bitop3:0xca
    v_bitop3_b32 v215, v232, v190, v188 bitop3:0xca
    v_mfma_f32_16x16x32_bf16 v[192:195], v[160:163], v[32:35], v[192:195]
    v_bitop3_b32 v212, v234, v233, v212 bitop3:0xca
    global_store_dwordx4 v4, v[212:215], s[36:37] sc1
    v_mfma_f32_16x16x32_bf16 v[196:199], v[164:167], v[32:35], v[196:199]
    v_bitop3_b32 v216, v232, v179, v177 bitop3:0xca
    v_bitop3_b32 v217, v232, v183, v181 bitop3:0xca
    v_mfma_f32_16x16x32_bf16 v[200:203], v[168:171], v[32:35], v[200:203]
    v_bitop3_b32 v218, v232, v187, v185 bitop3:0xca
    v_bitop3_b32 v219, v232, v191, v189 bitop3:0xca
    v_mfma_f32_16x16x32_bf16 v[204:207], v[172:175], v[32:35], v[204:207]
    v_bitop3_b32 v216, v234, v233, v216 bitop3:0xca
    global_store_dwordx4 v5, v[216:219], s[36:37] sc1
    v_bitop3_b32 v220, v232, v194, v192 bitop3:0xca
    v_bitop3_b32 v221, v232, v198, v196 bitop3:0xca
    s_nop 0
    v_bitop3_b32 v222, v232, v202, v200 bitop3:0xca
    s_nop 1
    v_bitop3_b32 v223, v232, v206, v204 bitop3:0xca
    v_bitop3_b32 v220, v234, v233, v220 bitop3:0xca
    global_store_dwordx4 v6, v[220:223], s[36:37] sc1
    v_bitop3_b32 v224, v232, v195, v193 bitop3:0xca
    v_bitop3_b32 v225, v232, v199, v197 bitop3:0xca
    v_bitop3_b32 v226, v232, v203, v201 bitop3:0xca
    v_bitop3_b32 v227, v232, v207, v205 bitop3:0xca
    v_bitop3_b32 v224, v234, v233, v224 bitop3:0xca
    global_store_dwordx4 v7, v[224:227], s[36:37] sc1
    s_endpgm
L_slow:
    v_mov_b32 v21, 0
    v_mov_b32 v38, v26
    s_mov_b32 s10, 16
L_slow_r:
    v_sub_u32 v176, v28, v21
    v_sub_u32 v177, v29, v21
    v_sub_u32 v178, v30, v21
    v_sub_u32 v179, v31, v21
    v_sub_u32 v180, v32, v21
    v_sub_u32 v181, v33, v21
    v_sub_u32 v182, v34, v21
    v_sub_u32 v183, v35, v21
    v_max3_u32 v24, v176, v177, v178
    v_max3_u32 v24, v24, v179, v180
    v_max3_u32 v24, v24, v181, v182
    v_max_u32 v24, v24, v183
    ds_max_u32 v38, v24 offset:96
    s_mov_b64 exec, 1
    ds_add_u32 v26, v27 offset:40
    s_mov_b64 exec, -1
L_slow_s:
    ds_read_b32 v24, v26 offset:40
    ds_read_b32 v39, v38 offset:96
    s_waitcnt lgkmcnt(0)
    v_readfirstlane_b32 s11, v24
    s_nop 0
    s_cmp_ge_u32 s11, s10
    s_cbranch_scc1 L_slow_ok
    s_sub_u32 s55, s55, 1
    s_cbranch_scc0 L_slow_s
L_slow_ok:
    v_add_u32 v21, v21, v39
    v_alignbit_b32 v24, 1, v21, 5
    ds_write_b32 v38, v24 offset:64
    v_add_u32 v38, 4, v38
    s_add_u32 s10, s10, 16
    s_cmp_le_u32 s10, 128
    s_cbranch_scc1 L_slow_r
    ds_read_b32 v23, v17 offset:64
    ds_read_b32 v13, v18 offset:64
    s_add_u32 m0, s64, 150016
    s_waitcnt lgkmcnt(0)
    v_and_b32 v23, 0x7ff, v23
    v_mad_i32_i24 v23, v23, s63, v12
    global_load_lds_dwordx4 v23, s[4:5]
    s_add_u32 m0, s64, 153728
    v_and_b32 v22, 0x7ff, v13
    global_load_lds_dwordx4 v23, s[4:5] offset:512
    v_sub_u32 v22, 2047, v22
    s_cmp_lg_u32 s39, 0
    s_cbranch_scc1 L_nox9b
    s_mov_b32 m0, 157440
    s_nop 0
    global_load_lds_dwordx4 v23, s[4:5] offset:1024
    s_branch L_x3b
L_nox9b:
    v_lshlrev_b32 v24, 3, v22
    v_add_u32 v24, 16384, v24
    global_load_dword v25, v24, s[36:37] sc1
L_x3b:
    v_mov_b32 v36, 4
    s_waitcnt vmcnt(0)
    s_cmp_lg_u32 s39, 1
    s_cbranch_scc1 L_nostb
    ds_write_b32 v18, v25 offset:448
L_nostb:
    s_mov_b64 exec, 1
    ds_add_u32 v26, v36 offset:36
    s_mov_b64 exec, -1
    s_branch L_dgo
L_gu:
    s_setprio 0
    s_add_u32 s53, s53, 12288
    v_mov_b32 v1, v76
    s_movk_i32 s55, 5
L_dma1:
    s_mov_b32 m0, s53
    s_add_u32 s42, s53, 73728
    global_load_lds_dwordx4 v1, s[26:27]
    s_mov_b32 m0, s42
    s_add_u32 s53, s53, 4096
    global_load_lds_dwordx4 v1, s[28:29]
    v_add_u32 v1, 294912, v1
    s_sub_u32 s55, s55, 1
    s_cmp_lg_u32 s55, 0
    s_cbranch_scc1 L_dma1
    v_lshrrev_b32 v12, 1, v2
    v_min_u32 v12, 8, v12
    v_mul_u32_u24 v12, 1056, v12
    v_and_b32 v13, 16, v3
    v_add_u32 v12, v12, v13
    v_add_u32 v12, 151040, v12
    v_mov_b32 v20, 0x3f803f80
    v_mov_b32 v21, v20
    v_mov_b32 v22, v20
    v_mov_b32 v23, v20
    ds_write_b128 v12, v[20:23]
    v_bfe_u32 v15, v0, 2, 2
    v_and_b32 v16, 3, v0
    v_lshl_add_u32 v17, v14, 3, v15
    v_bfe_u32 v18, v0, 3, 2
    v_xor_b32 v18, s51, v18
    v_lshlrev_b32 v18, 5, v18
    v_lshl_add_u32 v18, v16, 3, v18
    v_lshl_add_u32 v4, v17, 7, v18
    v_add_u32 v5, 36864, v4
    v_add_u32 v6, 73728, v4
    v_add_u32 v7, 110592, v4
    v_and_b32 v19, 6, v11
    v_xor_b32 v19, v19, v14
    v_lshlrev_b32 v19, 4, v19
    v_lshl_add_u32 v19, v11, 7, v19
    v_xor_b32 v20, 64, v19
    v_bfe_i32 v21, v0, 3, 1
    v_lshlrev_b32 v22, 2, v0
    v_xor_b32 v22, v22, v0
    v_and_b32 v22, 16, v22
    v_or_b32 v22, 1024, v22
    v_bfi_b32 v19, v21, v22, v19
    v_xor_b32 v22, 16, v22
    v_bfi_b32 v20, v21, v22, v20
    v_add_u32 v19, 150016, v19
    v_add_u32 v20, 150016, v20
    v_lshl_add_u32 v18, v11, 2, v26
    s_lshr_b32 s42, s51, 1
    s_lshl_b32 s42, s42, 10
    s_and_b32 s43, s51, 1
    s_lshl_b32 s43, s43, 3
    s_add_u32 s42, s42, s43
    s_add_u32 s42, s42, 147968
    v_add_u32 v27, s42, v3
    v_and_b32 v8, 9344, v21
    v_lshl_add_u32 v8, v11, 4, v8
    s_mul_i32 s42, s50, 18688
    s_add_u32 s42, s42, 74752
    v_add_u32 v8, s42, v8
    s_waitcnt vmcnt(0)
    s_barrier
    ds_read_b64_tr_b16 v[112:113], v4 offset:0
    ds_read_b64_tr_b16 v[114:115], v4 offset:512
    ds_read_b64_tr_b16 v[184:185], v6 offset:0
    ds_read_b64_tr_b16 v[186:187], v6 offset:512
    ds_read_b64_tr_b16 v[116:117], v4 offset:4096
    ds_read_b64_tr_b16 v[118:119], v4 offset:4608
    ds_read_b64_tr_b16 v[188:189], v6 offset:4096
    ds_read_b64_tr_b16 v[190:191], v6 offset:4608
    ds_read_b64_tr_b16 v[120:121], v4 offset:8192
    ds_read_b64_tr_b16 v[122:123], v4 offset:8704
    ds_read_b64_tr_b16 v[192:193], v6 offset:8192
    ds_read_b64_tr_b16 v[194:195], v6 offset:8704
    ds_read_b64_tr_b16 v[124:125], v4 offset:12288
    ds_read_b64_tr_b16 v[126:127], v4 offset:12800
    ds_read_b64_tr_b16 v[196:197], v6 offset:12288
    ds_read_b64_tr_b16 v[198:199], v6 offset:12800
    ds_read_b64_tr_b16 v[128:129], v4 offset:16384
    ds_read_b64_tr_b16 v[130:131], v4 offset:16896
    ds_read_b64_tr_b16 v[200:201], v6 offset:16384
    ds_read_b64_tr_b16 v[202:203], v6 offset:16896
    ds_read_b64_tr_b16 v[132:133], v4 offset:20480
    ds_read_b64_tr_b16 v[134:135], v4 offset:20992
    ds_read_b64_tr_b16 v[204:205], v6 offset:20480
    ds_read_b64_tr_b16 v[206:207], v6 offset:20992
    ds_read_b64_tr_b16 v[136:137], v4 offset:24576
    ds_read_b64_tr_b16 v[138:139], v4 offset:25088
    ds_read_b64_tr_b16 v[208:209], v6 offset:24576
    ds_read_b64_tr_b16 v[210:211], v6 offset:25088
    ds_read_b64_tr_b16 v[140:141], v4 offset:28672
    ds_read_b64_tr_b16 v[142:143], v4 offset:29184
    ds_read_b64_tr_b16 v[212:213], v6 offset:28672
    ds_read_b64_tr_b16 v[214:215], v6 offset:29184
    s_barrier
    s_movk_i32 s55, 6
L_dma4:
    s_mov_b32 m0, s53
    s_add_u32 s42, s53, 73728
    global_load_lds_dwordx4 v1, s[26:27]
    s_mov_b32 m0, s42
    s_add_u32 s53, s53, 4096
    global_load_lds_dwordx4 v1, s[28:29]
    v_add_u32 v1, 294912, v1
    s_waitcnt vmcnt(2)
    s_sub_u32 s55, s55, 1
    s_cmp_lg_u32 s55, 0
    s_cbranch_scc1 L_dma4
    s_mov_b32 s55, 2097152
    v_mov_b32 v23, 0x100
    s_waitcnt vmcnt(0)
    s_barrier
    s_setprio 2
    s_add_u32 m0, s53, 0
    s_nop 0
    global_load_lds_dwordx4 v1, s[26:27]
    ds_read_b64_tr_b16 v[144:145], v4 offset:32768
    ds_read_b64_tr_b16 v[146:147], v4 offset:33280
    ds_read_b64_tr_b16 v[216:217], v6 offset:32768
    s_add_u32 m0, s53, 73728
    s_nop 0
    global_load_lds_dwordx4 v1, s[28:29]
    ds_read_b64_tr_b16 v[218:219], v6 offset:33280
    ds_read_b64_tr_b16 v[148:149], v5 offset:0
    ds_read_b64_tr_b16 v[150:151], v5 offset:512
    v_add_u32 v1, 294912, v1
    s_add_u32 m0, s53, 4096
    s_nop 0
    global_load_lds_dwordx4 v1, s[26:27]
    ds_read_b64_tr_b16 v[220:221], v7 offset:0
    ds_read_b64_tr_b16 v[222:223], v7 offset:512
    ds_read_b64_tr_b16 v[152:153], v5 offset:4096
    s_add_u32 m0, s53, 77824
    s_nop 0
    global_load_lds_dwordx4 v1, s[28:29]
    ds_read_b64_tr_b16 v[154:155], v5 offset:4608
    ds_read_b64_tr_b16 v[224:225], v7 offset:4096
    ds_read_b64_tr_b16 v[226:227], v7 offset:4608
    v_add_u32 v1, 294912, v1
    s_add_u32 m0, s53, 8192
    s_nop 0
    global_load_lds_dwordx4 v1, s[26:27]
    ds_read_b64_tr_b16 v[156:157], v5 offset:8192
    ds_read_b64_tr_b16 v[158:159], v5 offset:8704
    ds_read_b64_tr_b16 v[228:229], v7 offset:8192
    s_add_u32 m0, s53, 81920
    s_nop 0
    global_load_lds_dwordx4 v1, s[28:29]
    ds_read_b64_tr_b16 v[230:231], v7 offset:8704
    ds_read_b64_tr_b16 v[160:161], v5 offset:12288
    ds_read_b64_tr_b16 v[162:163], v5 offset:12800
    v_add_u32 v1, 294912, v1
    s_add_u32 m0, s53, 12288
    s_nop 0
    global_load_lds_dwordx4 v1, s[26:27]
    ds_read_b64_tr_b16 v[232:233], v7 offset:12288
    ds_read_b64_tr_b16 v[234:235], v7 offset:12800
    ds_read_b64_tr_b16 v[164:165], v5 offset:16384
    s_add_u32 m0, s53, 86016
    s_nop 0
    global_load_lds_dwordx4 v1, s[28:29]
    ds_read_b64_tr_b16 v[166:167], v5 offset:16896
    ds_read_b64_tr_b16 v[236:237], v7 offset:16384
    ds_read_b64_tr_b16 v[238:239], v7 offset:16896
    v_add_u32 v1, 294912, v1
    s_barrier
    s_waitcnt vmcnt(0)
    s_mov_b64 exec, 1
    ds_add_u32 v26, v23 offset:36
    s_mov_b64 exec, -1
L_s6:
    ds_read_b32 v24, v26 offset:36
    s_waitcnt lgkmcnt(0)
    v_readfirstlane_b32 s61, v24
    s_nop 0
    s_cmp_eq_u32 s61, 0x80410
    s_cbranch_scc1 L_s6_ok
    s_and_b32 s60, s61, 0xffff
    s_cmp_eq_u32 s60, 0x420
    s_cbranch_scc1 L_s6_ok
    s_sub_u32 s55, s55, 1
    s_cbranch_scc0 L_s6
L_s6_ok:
    ds_read_b128 v[40:43], v19 offset:0
    ds_read_b128 v[44:47], v20 offset:0
    ds_read_b128 v[48:51], v19 offset:1056
    ds_read_b128 v[52:55], v20 offset:1056
    ds_read_b128 v[56:59], v19 offset:2112
    ds_read_b128 v[60:63], v20 offset:2112
    s_waitcnt lgkmcnt(5)
    v_mfma_f32_16x16x32_bf16 v[28:31], v[112:115], v[40:43], 0
    ds_read_b128 v[64:67], v19 offset:3168
    ds_read_b128 v[68:71], v20 offset:3168
    v_mfma_f32_16x16x32_bf16 v[32:35], v[184:187], v[40:43], 0
    ds_read_b128 v[72:75], v19 offset:4224
    s_waitcnt lgkmcnt(6)
    v_mfma_f32_16x16x32_bf16 v[28:31], v[116:119], v[44:47], v[28:31]
    ds_read_b128 v[76:79], v20 offset:4224
    ds_read_b32 v25, v18 offset:448
    v_mfma_f32_16x16x32_bf16 v[32:35], v[188:191], v[44:47], v[32:35]
    ds_read_b32 v13, v18 offset:64
    ds_read_b128 v[80:83], v19 offset:5280
    v_mfma_f32_16x16x32_bf16 v[28:31], v[120:123], v[48:51], v[28:31]
    ds_read_b128 v[84:87], v20 offset:5280
    v_mfma_f32_16x16x32_bf16 v[32:35], v[192:195], v[48:51], v[32:35]
    ds_read_b128 v[88:91], v19 offset:6336
    s_waitcnt lgkmcnt(10)
    v_mfma_f32_16x16x32_bf16 v[28:31], v[124:127], v[52:55], v[28:31]
    ds_read_b128 v[92:95], v20 offset:6336
    v_mfma_f32_16x16x32_bf16 v[32:35], v[196:199], v[52:55], v[32:35]
    ds_read_b128 v[96:99], v19 offset:7392
    ds_read_b64_tr_b16 v[168:169], v5 offset:20480
    v_mfma_f32_16x16x32_bf16 v[28:31], v[128:131], v[56:59], v[28:31]
    ds_read_b64_tr_b16 v[170:171], v5 offset:20992
    v_mfma_f32_16x16x32_bf16 v[32:35], v[200:203], v[56:59], v[32:35]
    s_waitcnt lgkmcnt(11)
    v_mfma_f32_16x16x32_bf16 v[28:31], v[132:135], v[60:63], v[28:31]
    ds_read_b128 v[100:103], v20 offset:7392
    ds_read_b64_tr_b16 v[172:173], v5 offset:24576
    v_mfma_f32_16x16x32_bf16 v[28:31], v[136:139], v[64:67], v[28:31]
    ds_read_b64_tr_b16 v[174:175], v5 offset:25088
    v_mfma_f32_16x16x32_bf16 v[28:31], v[140:143], v[68:71], v[28:31]
    s_waitcnt lgkmcnt(9)
    v_mfma_f32_16x16x32_bf16 v[28:31], v[144:147], v[72:75], v[28:31]
    ds_read_b128 v[104:107], v19 offset:8448
    ds_read_b64_tr_b16 v[176:177], v5 offset:28672
    v_mfma_f32_16x16x32_bf16 v[28:31], v[148:151], v[76:79], v[28:31]
    ds_read_b64_tr_b16 v[178:179], v5 offset:29184
    ds_read_b128 v[108:111], v20 offset:8448
    v_mfma_f32_16x16x32_bf16 v[28:31], v[152:155], v[80:83], v[28:31]
    ds_read_b64_tr_b16 v[180:181], v5 offset:32768
    v_and_b32 v15, 0xffff0000, v25
    s_waitcnt lgkmcnt(11)
    v_mfma_f32_16x16x32_bf16 v[28:31], v[156:159], v[84:87], v[28:31]
    ds_read_b64_tr_b16 v[182:183], v5 offset:33280
    v_rcp_f32 v16, v15
    v_mfma_f32_16x16x32_bf16 v[28:31], v[160:163], v[88:91], v[28:31]
    ds_read_b64_tr_b16 v[240:241], v7 offset:20480
    v_lshlrev_b32 v12, 16, v25
    v_mfma_f32_16x16x32_bf16 v[28:31], v[164:167], v[92:95], v[28:31]
    ds_read_b64_tr_b16 v[242:243], v7 offset:20992
    v_xor_b32 v25, 0x80000000, v12
    s_waitcnt lgkmcnt(5)
    v_mfma_f32_16x16x32_bf16 v[28:31], v[168:171], v[96:99], v[28:31]
    ds_read_b64_tr_b16 v[244:245], v7 offset:24576
    v_mul_f32 v16, 0x42000000, v16
    v_mfma_f32_16x16x32_bf16 v[28:31], v[172:175], v[100:103], v[28:31]
    ds_read_b64_tr_b16 v[246:247], v7 offset:25088
    v_mul_f32 v9, 0xbfb8aa3b, v16
    v_mfma_f32_16x16x32_bf16 v[28:31], v[176:179], v[104:107], v[28:31]
    ds_read_b64_tr_b16 v[248:249], v7 offset:28672
    v_mul_f32 v10, v16, v16
    s_waitcnt lgkmcnt(5)
    v_mfma_f32_16x16x32_bf16 v[28:31], v[180:183], v[108:111], v[28:31]
    ds_read_b64_tr_b16 v[250:251], v7 offset:29184
    v_mfma_f32_16x16x32_bf16 v[32:35], v[204:207], v[60:63], v[32:35]
    ds_read_b64_tr_b16 v[252:253], v7 offset:32768
    ds_read_b64_tr_b16 v[254:255], v7 offset:33280
    v_mfma_f32_16x16x32_bf16 v[32:35], v[208:211], v[64:67], v[32:35]
    v_mfma_f32_16x16x32_bf16 v[32:35], v[212:215], v[68:71], v[32:35]
    v_mfma_f32_16x16x32_bf16 v[32:35], v[216:219], v[72:75], v[32:35]
    s_nop 0
    v_fmac_f32_dpp v28, v28, v25 row_newbcast:8 row_mask:0xf bank_mask:0xf
    v_fmac_f32_dpp v29, v29, v25 row_newbcast:8 row_mask:0xf bank_mask:0xf
    v_mfma_f32_16x16x32_bf16 v[32:35], v[220:223], v[76:79], v[32:35]
    v_fmac_f32_dpp v30, v30, v25 row_newbcast:8 row_mask:0xf bank_mask:0xf
    v_fmac_f32_dpp v31, v31, v25 row_newbcast:8 row_mask:0xf bank_mask:0xf
    v_mfma_f32_16x16x32_bf16 v[32:35], v[224:227], v[80:83], v[32:35]
    v_mul_f32 v36, v9, v28
    v_mul_f32 v37, v9, v29
    v_mfma_f32_16x16x32_bf16 v[32:35], v[228:231], v[84:87], v[32:35]
    v_mul_f32 v38, v9, v30
    v_mul_f32 v39, v9, v31
    v_mfma_f32_16x16x32_bf16 v[32:35], v[232:235], v[88:91], v[32:35]
    v_exp_f32 v36, v36
    v_exp_f32 v37, v37
    v_mfma_f32_16x16x32_bf16 v[32:35], v[236:239], v[92:95], v[32:35]
    v_exp_f32 v38, v38
    v_exp_f32 v39, v39
    s_waitcnt lgkmcnt(2)
    v_mfma_f32_16x16x32_bf16 v[32:35], v[240:243], v[96:99], v[32:35]
    v_mul_f32 v28, v28, v10
    v_mul_f32 v29, v29, v10
    v_mfma_f32_16x16x32_bf16 v[32:35], v[244:247], v[100:103], v[32:35]
    v_mul_f32 v30, v30, v10
    v_mul_f32 v31, v31, v10
    v_mfma_f32_16x16x32_bf16 v[32:35], v[248:251], v[104:107], v[32:35]
    v_add_f32 v36, 1.0, v36
    v_add_f32 v37, 1.0, v37
    s_waitcnt lgkmcnt(0)
    v_mfma_f32_16x16x32_bf16 v[32:35], v[252:255], v[108:111], v[32:35]
    v_add_f32 v38, 1.0, v38
    v_add_f32 v39, 1.0, v39
    v_rcp_f32 v36, v36
    v_rcp_f32 v37, v37
    v_rcp_f32 v38, v38
    v_rcp_f32 v39, v39
    v_mul_f32 v28, v28, v36
    v_mul_f32 v29, v29, v37
    v_mul_f32 v30, v30, v38
    v_mul_f32 v31, v31, v39
    v_fmac_f32_dpp v32, v32, v25 row_newbcast:8 row_mask:0xf bank_mask:0xf
    v_fmac_f32_dpp v33, v33, v25 row_newbcast:8 row_mask:0xf bank_mask:0xf
    v_fmac_f32_dpp v34, v34, v25 row_newbcast:8 row_mask:0xf bank_mask:0xf
    v_fmac_f32_dpp v35, v35, v25 row_newbcast:8 row_mask:0xf bank_mask:0xf
    v_mul_f32 v28, v28, v32
    v_mul_f32 v29, v29, v33
    v_mul_f32 v30, v30, v34
    v_mul_f32 v31, v31, v35
    v_cvt_pk_bf16_f32 v28, v28, v29
    v_cvt_pk_bf16_f32 v29, v30, v31
    ds_write_b64 v27, v[28:29]
    s_waitcnt lgkmcnt(0)
    s_barrier
    s_cmp_lg_u32 s39, 4
    s_cbranch_scc1 L_gu_end
    v_lshlrev_b32 v36, 5, v13
    v_not_b32 v37, v36
    v_ashrrev_i32 v38, 31, v37
    v_or_b32 v38, 0x80000000, v38
    v_xor_b32 v36, v36, v38
    v_and_b32 v36, 0xffff0000, v36
    v_mul_f32 v36, 0xbfb8aa3b, v36
    v_exp_f32 v36, v36
    v_bfe_u32 v4, v37, 5, 11
    v_mov_b32 v6, v12
    v_mov_b32 v7, v15
    v_add_f32 v36, 1.0, v36
    v_rcp_f32 v5, v36
    v_lshl_or_b32 v4, v4, 8, s45
    s_mov_b64 exec, 0xffff
    global_store_dwordx4 v8, v[4:7], s[36:37] sc1
    s_cmp_lg_u32 s50, 0
    s_cbranch_scc1 L_gu_end
    v_mov_b32 v9, 0
    v_mov_b32 v10, s38
    s_mov_b64 exec, 1
    global_store_dword v9, v10, s[36:37] sc1
L_gu_end:
    s_endpgm
L_end:
    s_endpgm
.fill 96, 4, 0xbf810000
L_last:
.section .rodata,"a"
.p2align 6
.amdhsa_kernel recurrent_scan__ssm_conv_s4__moe_arch_mod__prompt_kernel
  .amdhsa_next_free_vgpr 256
  .amdhsa_next_free_sgpr 102
  .amdhsa_accum_offset 256
  .amdhsa_group_segment_fixed_size 0
  .amdhsa_kernarg_size 136
  .amdhsa_user_sgpr_count 2
  .amdhsa_user_sgpr_kernarg_segment_ptr 1
  .amdhsa_system_sgpr_workgroup_id_x 1
  .amdhsa_float_denorm_mode_32 3
.end_amdhsa_kernel
```

```asm
; @launch grid=(256,1,1) block=(512,1,1) lds=163840
.amdgcn_target "amdgcn-amd-amdhsa--gfx950"
.text
.globl recurrent_scan__ssm_conv_s4__moe_arch_mod__prompt_kernel
.p2align 8
.type recurrent_scan__ssm_conv_s4__moe_arch_mod__prompt_kernel,@function
recurrent_scan__ssm_conv_s4__moe_arch_mod__prompt_kernel:
    s_load_dwordx16 s[4:19], s[0:1], 0
    s_load_dwordx16 s[20:35], s[0:1], 64
    s_load_dwordx2 s[36:37], s[0:1], 128
    s_cmp_ge_u32 s2, 256
    s_cbranch_scc1 L_end
    s_lshr_b32 s41, s2, 3
    s_getpc_b64 s[42:43]
L_pc:
    s_mul_i32 s47, s41, 768
    s_add_u32 s42, s42, s47
    s_addc_u32 s43, s43, 0
    v_lshlrev_b32 v4, 7, v0
    v_mov_b32 v5, s43
    v_add_co_u32 v4, vcc, s42, v4
    v_lshrrev_b32 v1, 6, v0
    v_and_b32 v2, 63, v0
    v_addc_co_u32 v5, vcc, 0, v5, vcc
    s_sub_u32 s47, L_last - L_pc - 4, s47
    s_ashr_i32 s47, s47, 7
    s_min_i32 s47, s47, 5
    v_cmp_ge_i32 vcc, s47, v0
    s_nop 0
    s_and_saveexec_b64 s[48:49], vcc
    s_cbranch_execz L_nopf
    global_load_dword v255, v[4:5], off
L_nopf:
    s_mov_b64 exec, -1
    v_readfirstlane_b32 s39, v1
    s_and_b32 s40, s2, 7
    s_mul_i32 s42, s2, 9216
    v_lshlrev_b32 v3, 4, v2
    v_lshlrev_b32 v4, 1, v2
    v_mul_u32_u24 v5, 1152, v1
    v_add3_u32 v6, v5, v3, s42
    v_add3_u32 v7, v5, v4, s42
    s_waitcnt lgkmcnt(0)
    global_load_dwordx4 v[12:15], v6, s[4:5]
    global_load_ushort v16, v7, s[4:5] offset:1024
    s_load_dword s38, s[36:37], 0
    global_load_dwordx4 v[20:23], v3, s[24:25]
    global_load_ushort v24, v4, s[24:25] offset:1024
    s_and_b32 s51, s39, 3
    s_lshr_b32 s52, s39, 2
    s_cmp_lt_u32 s41, 18
    s_cbranch_scc1 L_conv_pre
    s_cmp_lt_u32 s41, 27
    s_cbranch_scc1 L_ffn_pre
    s_sub_u32 s53, s41, 27
    s_and_b32 s58, s39, 1
    s_lshr_b32 s43, s39, 1
    s_mul_i32 s42, s43, 320
    s_add_u32 s42, s42, 1152
    s_cmp_eq_u32 s43, 0
    s_cmovk_i32 s42, 1152
    s_cmp_eq_u32 s43, 1
    s_cselect_b32 s48, 1, 0
    s_mul_i32 s59, s58, 320
    s_add_u32 s59, s59, 0
    s_cmp_eq_u32 s43, 3
    s_cselect_b32 s42, s59, s42
    s_cmovk_i32 s58, 2
    s_lshl_b32 s53, s53, 6
    s_add_u32 s42, s42, s53
    s_mul_i32 s43, s40, 1152
    s_add_u32 s43, s43, 884736
    s_mul_i32 s59, s40, 663552
    s_cmp_eq_u32 s58, 0
    s_cselect_b32 s56, s26, s28
    s_cselect_b32 s57, s27, s29
    s_cmp_eq_u32 s58, 2
    s_cselect_b32 s56, s30, s56
    s_cselect_b32 s57, s31, s57
    s_cselect_b32 s43, s59, s43
    s_movk_i32 s58, 128
    s_movk_i32 s59, 8064
    s_movk_i32 s60, 4319
    s_cmov_b32 s58, 73728
    s_cmov_b32 s59, -663424
    s_cmovk_i32 s60, 5183
    v_add_u32 v76, s42, v2
    v_min_u32 v76, s60, v76
    v_mul_u32_u24 v63, 7282, v76
    v_lshrrev_b32 v63, 16, v63
    v_mul_u32_u24 v76, s58, v76
    v_mad_i32_i24 v76, v63, s59, v76
    v_add_u32 v76, s43, v76
    s_mov_b32 s49, 0
    s_branch L_lnp
L_ffn_pre:
    s_sub_u32 s54, s41, 18
    s_mul_i32 s50, s40, 9
    s_add_u32 s50, s50, s54
    v_bfe_u32 v76, v0, 3, 5
    v_bfe_u32 v61, v0, 4, 1
    v_bfe_u32 v62, v0, 6, 1
    v_lshl_add_u32 v61, v62, 1, v61
    v_lshlrev_b32 v61, 1, v61
    v_and_b32 v62, 7, v0
    v_xor_b32 v61, v61, v62
    v_mul_u32_u24 v76, 9216, v76
    v_lshlrev_b32 v61, 4, v61
    s_lshl_b32 s42, s50, 7
    v_add3_u32 v76, v76, v61, s42
    s_lshl_b32 s53, s51, 10
    s_cmp_eq_u32 s52, 0
    s_cselect_b32 s56, s26, s28
    s_cselect_b32 s57, s27, s29
    s_cselect_b32 s42, 0, 73728
    s_add_u32 s42, s53, s42
    s_mov_b32 s49, s42
    v_mov_b32 v62, 0
    v_mov_b32 v63, 0
    v_lshrrev_b32 v61, 1, v3
    v_add_u32 v61, 147456, v61
    ds_write_b64 v61, v[62:63]
    s_mov_b32 s47, 3
    s_mov_b32 s48, 0
    s_branch L_lnp
L_conv_pre:
    s_lshl_b32 s50, s40, 4
    s_lshl_b32 s42, s40, 1
    s_add_u32 s42, s42, 112
    s_cmp_ge_u32 s41, 16
    s_cselect_b32 s50, s42, s50
    s_add_u32 s50, s50, s41
    s_lshl_b32 s53, s50, 2
    s_add_u32 s53, s53, s51
    s_lshl_b32 s42, s53, 8
    s_lshl_b32 s43, s52, 7
    s_add_u32 s42, s42, s43
    v_add_u32 v60, s42, v4
    s_lshl_b32 s54, s50, 3
    s_lshl_b32 s42, s53, 1
    v_mov_b32 v61, s42
    v_mov_b64 v[64:65], 0
    v_mov_b64 v[66:67], 0
    v_mov_b64 v[68:69], 0
    v_mov_b64 v[70:71], 0
    s_barrier
    global_load_short_d16_hi v70, v61, s[18:19]
    global_load_short_d16_hi v64, v60, s[6:7]
    global_load_short_d16_hi v65, v60, s[8:9]
    global_load_short_d16_hi v66, v60, s[10:11]
    global_load_short_d16_hi v67, v60, s[12:13]
    global_load_short_d16_hi v68, v60, s[14:15]
    global_load_short_d16_hi v69, v60, s[16:17]
    global_load_short_d16_hi v71, v61, s[20:21]
    global_load_ushort v1, v61, s[20:21]
    s_lshr_b32 s42, s51, 1
    s_mul_i32 s42, s42, 2112
    s_and_b32 s58, s51, 1
    s_mul_i32 s43, s51, 1152
    s_add_u32 s43, s43, 640
    s_lshr_b32 s47, s39, 1
    s_cmp_eq_u32 s47, 0
    s_cmovk_i32 s42, 3168
    s_cmp_eq_u32 s52, 0
    s_cselect_b32 s42, s43, s42
    s_cmovk_i32 s58, 2
    s_lshl_b32 s43, s41, 6
    s_add_u32 s42, s42, s43
    s_mul_i32 s43, s40, 1152
    s_add_u32 s43, s43, 884736
    s_mul_i32 s59, s40, 663552
    s_cmp_eq_u32 s58, 0
    s_cselect_b32 s56, s26, s28
    s_cselect_b32 s57, s27, s29
    s_cmp_eq_u32 s58, 2
    s_cselect_b32 s56, s30, s56
    s_cselect_b32 s57, s31, s57
    s_cselect_b32 s43, s59, s43
    s_movk_i32 s58, 128
    s_movk_i32 s59, 8064
    s_movk_i32 s60, 4319
    s_cmov_b32 s58, 73728
    s_cmov_b32 s59, -663424
    s_cmovk_i32 s60, 5183
    v_add_u32 v76, s42, v2
    v_min_u32 v76, s60, v76
    v_mul_u32_u24 v63, 7282, v76
    v_lshrrev_b32 v63, 16, v63
    v_mul_u32_u24 v76, s58, v76
    v_mad_i32_i24 v76, v63, s59, v76
    v_add_u32 v76, s43, v76
    s_mul_i32 s55, s51, 33792
    s_lshl_b32 s42, s52, 8
    s_add_u32 m0, s55, s42
    s_mul_i32 s63, s51, 4640
    s_add_u32 s63, s63, 135168
    v_mov_b64 v[84:85], 0
    v_mov_b64 v[86:87], 0
    s_cmp_eq_u32 s52, 0
    s_cbranch_scc1 L_cp_m
    s_setprio 1
    v_min_u32 v83, 29, v2
    v_lshl_add_u32 v83, v83, 4, s63
    ds_write_b128 v83, v[84:87]
    v_and_b32 v88, 0x70, v3
    v_add_u32 v88, 153728, v88
    ds_write_b128 v88, v[84:87]
    s_branch L_cp_e
L_cp_m:
    v_and_b32 v8, 15, v0
    v_bfe_u32 v9, v0, 4, 2
    v_and_b32 v10, 31, v0
    v_and_b32 v11, 32, v0
    v_mul_u32_u24 v78, 528, v10
    v_lshrrev_b32 v11, 1, v11
    v_add3_u32 v78, v78, v11, s55
    v_lshl_add_u32 v10, v10, 5, v11
    s_add_u32 s42, s55, 1072
    v_sub_u32 v81, s42, v10
    v_lshrrev_b32 v77, 2, v10
    s_add_u32 s42, s55, 5564
    v_sub_u32 v77, s42, v77
    v_bfe_i32 v79, v0, 4, 1
    v_sub_u32 v80, 495, v10
    v_ashrrev_i32 v80, 31, v80
    v_sub_u32 v82, 1007, v10
    v_ashrrev_i32 v82, 31, v82
    v_bfe_u32 v10, v0, 3, 2
    v_and_b32 v11, 7, v0
    v_mul_u32_u24 v73, 1216, v10
    v_and_b32 v83, 4, v0
    v_lshl_add_u32 v83, v83, 4, v11
    v_lshl_add_u32 v83, v83, 4, v73
    v_lshlrev_b32 v72, 4, v10
    v_add_u32 v72, 5120, v72
    v_sub_u32 v74, 5, v11
    v_ashrrev_i32 v74, 31, v74
    v_bfi_b32 v83, v74, v72, v83
    v_and_b32 v72, 8, v0
    v_mad_u32_u24 v72, v72, 3, v11
    v_lshlrev_b32 v72, 4, v72
    v_add_u32 v72, 5184, v72
    v_bfe_i32 v74, v0, 5, 1
    v_bfi_b32 v83, v74, v72, v83
    v_add_u32 v83, s55, v83
    v_sub_u32 v74, 4, v11
    v_ashrrev_i32 v74, 31, v74
    v_add_u32 v72, 507, v11
    v_min_u32 v75, 2, v11
    v_bfi_b32 v74, v74, v72, v75
    v_sub_u32 v74, v74, v10
    v_lshl_add_u32 v73, v74, 1, v73
    v_min_u32 v74, 1, v10
    v_lshl_add_u32 v73, v74, 3, v73
    s_add_u32 s42, s55, 58
    v_add_u32 v73, s42, v73
    v_max_u32 v72, 4, v11
    v_mul_u32_u24 v72, 0x202, v72
    v_add_u32 v72, 1284, v72
    v_and_b32 v72, 0x707, v72
L_cp_e:
L_clnp:
    s_mul_i32 s43, s39, 1216
    s_add_u32 s43, s43, 154048
    v_add_u32 v52, s43, v3
    v_add_u32 v53, s43, v4
    s_lshl_b32 s43, s39, 3
    s_add_u32 s43, s43, 163776
    v_mov_b32 v54, s43
    v_bfe_u32 v55, v0, 2, 2
    v_mul_u32_u24 v55, 1216, v55
    v_and_b32 v56, 3, v0
    v_lshl_add_u32 v55, v56, 3, v55
    v_lshrrev_b32 v56, 4, v0
    v_lshl_add_u32 v55, v56, 5, v55
    v_add_u32 v55, 154048, v55
    v_lshrrev_b32 v56, 3, v0
    v_lshlrev_b32 v56, 15, v56
    v_and_b32 v57, 112, v3
    s_lshl_b32 s43, s2, 7
    s_add_u32 s43, s43, 2101248
    v_add3_u32 v56, v56, v57, s43
    v_mov_b32 v40, 0
    v_mov_b32 v41, 0
    v_mov_b32 v42, 0
    v_mov_b32 v43, 0
    v_mov_b32 v44, 0x3ae38e39
    v_mov_b32 v38, 0xbfffbfff
    v_mov_b32 v37, 0xffff
    s_lshl_b32 s58, s2, 3
    s_add_u32 s58, s58, s39
    s_xor_b32 s58, s58, 0x7ff
    s_lshl_b32 s58, s58, 5
    s_waitcnt lgkmcnt(0)
    s_add_u32 s38, s38, 0x9e370001
    s_lshr_b32 s44, s38, 16
    s_and_b32 s45, s38, 0xff
    s_and_b32 s46, s38, 0xfb
    s_bitcmp0_b32 s38, 0
    s_cselect_b32 s43, 4, 0
    s_or_b32 s46, s46, s43
    s_bitcmp1_b32 s46, s39
    s_cselect_b32 s43, 0x40004000, 0
    v_mov_b32 v39, s43
    s_xor_b32 s58, s58, s44
    v_mov_b32 v57, s58
    s_mov_b32 s42, 0x3f803f80
    s_cmp_eq_u32 s47, 2
    s_cbranch_scc0 L_clw
    global_load_dword v1, v76, s[56:57]
    s_waitcnt vmcnt(10)
    s_branch L_cln
L_clw:
    s_waitcnt vmcnt(9)
L_cln:
    v_dot2c_f32_bf16 v40, s42, v12
    v_dot2c_f32_bf16 v41, v12, v12
    v_dot2c_f32_bf16 v42, v12, v20
    v_dot2c_f32_bf16 v43, s42, v20
    v_dot2c_f32_bf16 v40, s42, v13
    v_dot2c_f32_bf16 v41, v13, v13
    v_dot2c_f32_bf16 v42, v13, v21
    v_dot2c_f32_bf16 v43, s42, v21
    v_dot2c_f32_bf16 v40, s42, v14
    v_dot2c_f32_bf16 v41, v14, v14
    v_dot2c_f32_bf16 v42, v14, v22
    v_dot2c_f32_bf16 v43, s42, v22
    v_dot2c_f32_bf16 v40, s42, v15
    v_dot2c_f32_bf16 v41, v15, v15
    v_dot2c_f32_bf16 v42, v15, v23
    v_dot2c_f32_bf16 v43, s42, v23
    v_dot2c_f32_bf16 v40, s42, v16
    v_dot2c_f32_bf16 v41, v16, v16
    v_dot2c_f32_bf16 v42, v16, v24
    v_dot2c_f32_bf16 v43, s42, v24
    v_lshlrev_b32 v36, 16, v16
    v_lshlrev_b32 v28, 16, v12
    v_and_b32 v29, 0xffff0000, v12
    v_permlane32_swap_b32 v40, v42
    v_permlane32_swap_b32 v41, v43
    v_add_f32 v40, v40, v42
    v_add_f32 v41, v41, v43
    v_lshlrev_b32 v30, 16, v13
    v_and_b32 v31, 0xffff0000, v13
    v_permlane16_swap_b32 v40, v41
    v_add_f32 v40, v40, v41
    v_lshlrev_b32 v32, 16, v14
    v_and_b32 v33, 0xffff0000, v14
    v_add_f32_dpp v40, v40, v40 row_ror:8 row_mask:0xf bank_mask:0xf
    v_lshlrev_b32 v34, 16, v15
    v_and_b32 v35, 0xffff0000, v15
    v_add_f32_dpp v40, v40, v40 row_ror:4 row_mask:0xf bank_mask:0xf
    s_nop 1
    v_add_f32_dpp v40, v40, v40 row_ror:2 row_mask:0xf bank_mask:0xf
    s_nop 1
    v_add_f32_dpp v40, v40, v40 row_ror:1 row_mask:0xf bank_mask:0xf
    s_nop 0
    v_readlane_b32 s58, v40, 0
    v_readlane_b32 s59, v40, 16
    v_readlane_b32 s60, v40, 32
    v_readlane_b32 s61, v40, 48
    v_mul_f32 v40, s58, v44
    v_mul_f32 v41, s59, v44
    v_fma_f32 v41, -v40, v40, v41
    v_max_f32 v41, 0, v41
    v_cvt_pk_bf16_f32 v44, v41, v40
    v_lshlrev_b32 v41, 16, v44
    v_add_f32 v41, 0x3727c5ac, v41
    v_cvt_pk_bf16_f32 v41, v41, v41
    v_and_b32 v41, 0xffff0000, v41
    v_mul_f32 v41, 0x44800000, v41
    v_sqrt_f32 v41, v41
    v_and_b32 v49, 0xffff0000, v44
    v_cvt_pk_bf16_f32 v50, v49, v41
    v_and_b32 v41, 0xffff0000, v50
    v_rcp_f32 v46, v41
    v_mul_f32 v42, s61, v49
    v_mul_f32 v47, v49, v46
    v_fma_f32 v28, v28, v46, -v47
    v_fma_f32 v29, v29, v46, -v47
    v_fma_f32 v30, v30, v46, -v47
    v_fma_f32 v31, v31, v46, -v47
    v_fma_f32 v32, v32, v46, -v47
    v_fma_f32 v33, v33, v46, -v47
    v_fma_f32 v34, v34, v46, -v47
    v_fma_f32 v35, v35, v46, -v47
    v_fma_f32 v36, v36, v46, -v47
    v_cvt_pk_bf16_f32 v28, v28, v29
    v_cvt_pk_bf16_f32 v29, v30, v31
    v_cvt_pk_bf16_f32 v30, v32, v33
    v_cvt_pk_bf16_f32 v31, v34, v35
    v_cvt_pk_bf16_f32 v32, v36, v36
    v_bitop3_b32 v28, v28, v38, v39 bitop3:0xea
    v_bitop3_b32 v29, v29, v38, v39 bitop3:0xea
    v_bitop3_b32 v30, v30, v38, v39 bitop3:0xea
    v_bitop3_b32 v31, v31, v38, v39 bitop3:0xea
    v_bitop3_b32 v32, v32, v38, v39 bitop3:0xea
    ds_write_b128 v52, v[28:31]
    ds_write_b16 v53, v32 offset:1024
    v_sub_f32 v42, s60, v42
    v_mul_f32 v42, 0x42000000, v42
    v_mul_f32 v42, v42, v46
    v_cvt_pk_bf16_f32 v42, v42, v42
    v_ashrrev_i32 v43, 31, v42
    v_or_b32 v43, 0x80000000, v43
    v_xor_b32 v42, v42, v43
    v_bitop3_b32 v51, v37, v57, v42 bitop3:0xca
    s_mov_b64 exec, 1
    ds_write_b64 v54, v[50:51]
    s_mov_b64 exec, -1
    s_waitcnt lgkmcnt(0)
    s_barrier
    s_cmp_eq_u32 s39, 1
    s_cbranch_scc1 L_cln_stat
    ds_read_b64_tr_b16 v[28:29], v55
    ds_read_b64_tr_b16 v[30:31], v55 offset:4864
    s_cmp_eq_u32 s39, 0
    s_cbranch_scc0 L_cln_st
    ds_read_b64_tr_b16 v[32:33], v55 offset:1024
    ds_read_b64_tr_b16 v[34:35], v55 offset:5888
    v_add_u32 v38, 2097152, v56
    s_waitcnt lgkmcnt(0)
    global_store_dwordx4 v38, v[32:35], s[36:37] sc1
    s_branch L_cln_st
L_cln_stat:
    v_and_b32 v41, 0x30, v3
    v_add_u32 v40, 163776, v41
    ds_read_b128 v[48:51], v40
    ds_read_b64_tr_b16 v[28:29], v55
    ds_read_b64_tr_b16 v[30:31], v55 offset:4864
    s_lshl_b32 s43, s2, 6
    s_add_u32 s43, s43, 16384
    v_add_u32 v41, s43, v41
    s_mov_b64 exec, 15
    s_waitcnt lgkmcnt(2)
    global_store_dwordx4 v41, v[48:51], s[36:37] sc1
    s_mov_b64 exec, -1
L_cln_st:
    s_waitcnt lgkmcnt(0)
    global_store_dwordx4 v56, v[28:31], s[36:37] sc1
    s_waitcnt vmcnt(2)
    v_mul_f32 v70, 0x3fb8aa3b, v70
    v_exp_f32 v70, v70
    v_mov_b32 v34, 0x3f80
    ds_write_addtid_b32 v34
    v_cvt_pk_bf16_f32 v70, v70, v70
    v_and_b32 v70, 0xffff0000, v70
    v_mul_f32 v64, v70, v64
    v_mul_f32 v65, v70, v65
    v_mul_f32 v70, 0x44800000, v70
    v_mul_f32 v64, 0x3fb8aa3b, v64
    v_mul_f32 v65, 0x3e22f983, v65
    v_mul_f32 v66, v70, v66
    v_mul_f32 v67, v70, v67
    v_mul_f32 v13, 0x41800000, v64
    v_mul_f32 v17, 0x41800000, v65
    v_mul_f32 v14, 0x44000000, v64
    v_mul_f32 v18, 0x44000000, v65
    v_exp_f32 v12, v64
    v_fract_f32 v16, v65
    v_exp_f32 v13, v13
    v_fract_f32 v17, v17
    v_exp_f32 v14, v14
    v_fract_f32 v18, v18
    v_pk_mul_f32 v[20:21], v[68:69], v[66:67] op_sel:[0,0] op_sel_hi:[0,1] neg_hi:[0,1]
    v_pk_fma_f32 v[90:91], v[68:69], v[66:67], v[20:21] op_sel:[1,1,0] op_sel_hi:[1,0,1] neg_lo:[0,1,0] neg_hi:[0,1,0]
    v_cos_f32 v22, v16
    v_sin_f32 v23, v16
    v_cos_f32 v24, v17
    v_sin_f32 v25, v17
    v_cos_f32 v26, v18
    v_sin_f32 v27, v18
    v_cvt_pk_bf16_f32 v35, v90, v91
    ds_write_addtid_b32 v35 offset:16896
    v_mul_f32 v22, v12, v22
    v_mul_f32 v23, -v12, v23
    v_mul_f32 v24, v13, v24
    v_mul_f32 v25, v13, v25
    v_mul_f32 v26, v14, v26
    v_mul_f32 v27, -v14, v27
    v_cvt_pk_bf16_f32 v36, v24, v25
    ds_write_addtid_b32 v36 offset:528
L_cs2:
    v_pk_mul_f32 v[30:31], v[24:25], v[24:25] op_sel:[0,0] op_sel_hi:[0,1]
    v_pk_fma_f32 v[28:29], v[24:25], v[24:25], v[30:31] op_sel:[1,1,0] op_sel_hi:[1,0,1] neg_lo:[0,1,0]
    v_cvt_pk_bf16_f32 v34, v28, v29
    ds_write_addtid_b32 v34 offset:1056
    v_pk_mul_f32 v[32:33], v[90:91], v[22:23] op_sel:[0,0] op_sel_hi:[0,1]
    v_pk_fma_f32 v[92:93], v[90:91], v[22:23], v[32:33] op_sel:[1,1,0] op_sel_hi:[1,0,1] neg_lo:[0,1,0]
    v_cvt_pk_bf16_f32 v35, v92, v93
    ds_write_addtid_b32 v35 offset:17424
    v_pk_mul_f32 v[30:31], v[28:29], v[24:25] op_sel:[0,0] op_sel_hi:[0,1]
    v_pk_fma_f32 v[28:29], v[28:29], v[24:25], v[30:31] op_sel:[1,1,0] op_sel_hi:[1,0,1] neg_lo:[0,1,0]
    v_cvt_pk_bf16_f32 v36, v28, v29
    ds_write_addtid_b32 v36 offset:1584
    v_pk_mul_f32 v[32:33], v[92:93], v[22:23] op_sel:[0,0] op_sel_hi:[0,1]
    v_pk_fma_f32 v[94:95], v[92:93], v[22:23], v[32:33] op_sel:[1,1,0] op_sel_hi:[1,0,1] neg_lo:[0,1,0]
    v_cvt_pk_bf16_f32 v37, v94, v95
    ds_write_addtid_b32 v37 offset:17952
    s_cmp_eq_u32 s47, 3
    s_cbranch_scc0 L_ct1
    global_load_dword v1, v76, s[56:57]
L_ct1:
    v_pk_mul_f32 v[30:31], v[28:29], v[24:25] op_sel:[0,0] op_sel_hi:[0,1]
    v_pk_fma_f32 v[28:29], v[28:29], v[24:25], v[30:31] op_sel:[1,1,0] op_sel_hi:[1,0,1] neg_lo:[0,1,0]
    v_cvt_pk_bf16_f32 v34, v28, v29
    ds_write_addtid_b32 v34 offset:2112
    v_pk_mul_f32 v[32:33], v[94:95], v[22:23] op_sel:[0,0] op_sel_hi:[0,1]
    v_pk_fma_f32 v[96:97], v[94:95], v[22:23], v[32:33] op_sel:[1,1,0] op_sel_hi:[1,0,1] neg_lo:[0,1,0]
    v_cvt_pk_bf16_f32 v35, v96, v97
    ds_write_addtid_b32 v35 offset:18480
    v_pk_mul_f32 v[30:31], v[28:29], v[24:25] op_sel:[0,0] op_sel_hi:[0,1]
    v_pk_fma_f32 v[28:29], v[28:29], v[24:25], v[30:31] op_sel:[1,1,0] op_sel_hi:[1,0,1] neg_lo:[0,1,0]
    v_cvt_pk_bf16_f32 v36, v28, v29
    ds_write_addtid_b32 v36 offset:2640
    v_pk_mul_f32 v[32:33], v[96:97], v[22:23] op_sel:[0,0] op_sel_hi:[0,1]
    v_pk_fma_f32 v[98:99], v[96:97], v[22:23], v[32:33] op_sel:[1,1,0] op_sel_hi:[1,0,1] neg_lo:[0,1,0]
    v_cvt_pk_bf16_f32 v37, v98, v99
    ds_write_addtid_b32 v37 offset:21120
    v_pk_mul_f32 v[30:31], v[28:29], v[24:25] op_sel:[0,0] op_sel_hi:[0,1]
    v_pk_fma_f32 v[28:29], v[28:29], v[24:25], v[30:31] op_sel:[1,1,0] op_sel_hi:[1,0,1] neg_lo:[0,1,0]
    v_cvt_pk_bf16_f32 v34, v28, v29
    ds_write_addtid_b32 v34 offset:3168
    v_pk_mul_f32 v[32:33], v[98:99], v[22:23] op_sel:[0,0] op_sel_hi:[0,1]
    v_pk_fma_f32 v[100:101], v[98:99], v[22:23], v[32:33] op_sel:[1,1,0] op_sel_hi:[1,0,1] neg_lo:[0,1,0]
    v_cvt_pk_bf16_f32 v35, v100, v101
    ds_write_addtid_b32 v35 offset:21648
    v_pk_mul_f32 v[30:31], v[28:29], v[24:25] op_sel:[0,0] op_sel_hi:[0,1]
    v_pk_fma_f32 v[28:29], v[28:29], v[24:25], v[30:31] op_sel:[1,1,0] op_sel_hi:[1,0,1] neg_lo:[0,1,0]
    v_cvt_pk_bf16_f32 v36, v28, v29
    ds_write_addtid_b32 v36 offset:3696
    v_pk_mul_f32 v[32:33], v[100:101], v[22:23] op_sel:[0,0] op_sel_hi:[0,1]
    v_pk_fma_f32 v[102:103], v[100:101], v[22:23], v[32:33] op_sel:[1,1,0] op_sel_hi:[1,0,1] neg_lo:[0,1,0]
    v_cvt_pk_bf16_f32 v37, v102, v103
    ds_write_addtid_b32 v37 offset:22176
    v_pk_mul_f32 v[30:31], v[28:29], v[24:25] op_sel:[0,0] op_sel_hi:[0,1]
    v_pk_fma_f32 v[28:29], v[28:29], v[24:25], v[30:31] op_sel:[1,1,0] op_sel_hi:[1,0,1] neg_lo:[0,1,0]
    v_cvt_pk_bf16_f32 v34, v28, v29
    ds_write_addtid_b32 v34 offset:4224
    v_pk_mul_f32 v[32:33], v[102:103], v[22:23] op_sel:[0,0] op_sel_hi:[0,1]
    v_pk_fma_f32 v[104:105], v[102:103], v[22:23], v[32:33] op_sel:[1,1,0] op_sel_hi:[1,0,1] neg_lo:[0,1,0]
    v_cvt_pk_bf16_f32 v35, v104, v105
    ds_write_addtid_b32 v35 offset:22704
    v_pk_mul_f32 v[30:31], v[28:29], v[24:25] op_sel:[0,0] op_sel_hi:[0,1]
    v_pk_fma_f32 v[28:29], v[28:29], v[24:25], v[30:31] op_sel:[1,1,0] op_sel_hi:[1,0,1] neg_lo:[0,1,0]
    v_cvt_pk_bf16_f32 v36, v28, v29
    ds_write_addtid_b32 v36 offset:4752
    v_pk_mul_f32 v[32:33], v[104:105], v[22:23] op_sel:[0,0] op_sel_hi:[0,1]
    v_pk_fma_f32 v[106:107], v[104:105], v[22:23], v[32:33] op_sel:[1,1,0] op_sel_hi:[1,0,1] neg_lo:[0,1,0]
    v_cvt_pk_bf16_f32 v12, v106, v107
    ds_write_addtid_b32 v12 offset:19008
    v_pk_mul_f32 v[30:31], v[28:29], v[24:25] op_sel:[0,0] op_sel_hi:[0,1]
    v_pk_fma_f32 v[28:29], v[28:29], v[24:25], v[30:31] op_sel:[1,1,0] op_sel_hi:[1,0,1] neg_lo:[0,1,0]
    v_cvt_pk_bf16_f32 v34, v28, v29
    ds_write_addtid_b32 v34 offset:5280
    v_pk_mul_f32 v[32:33], v[106:107], v[22:23] op_sel:[0,0] op_sel_hi:[0,1]
    v_pk_fma_f32 v[108:109], v[106:107], v[22:23], v[32:33] op_sel:[1,1,0] op_sel_hi:[1,0,1] neg_lo:[0,1,0]
    v_cvt_pk_bf16_f32 v13, v108, v109
    ds_write_addtid_b32 v13 offset:19536
    v_pk_mul_f32 v[30:31], v[28:29], v[24:25] op_sel:[0,0] op_sel_hi:[0,1]
    v_pk_fma_f32 v[28:29], v[28:29], v[24:25], v[30:31] op_sel:[1,1,0] op_sel_hi:[1,0,1] neg_lo:[0,1,0]
    v_cvt_pk_bf16_f32 v36, v28, v29
    ds_write_addtid_b32 v36 offset:5808
    v_pk_mul_f32 v[32:33], v[108:109], v[22:23] op_sel:[0,0] op_sel_hi:[0,1]
    v_pk_fma_f32 v[110:111], v[108:109], v[22:23], v[32:33] op_sel:[1,1,0] op_sel_hi:[1,0,1] neg_lo:[0,1,0]
    v_cvt_pk_bf16_f32 v14, v110, v111
    ds_write_addtid_b32 v14 offset:20064
    v_pk_mul_f32 v[30:31], v[28:29], v[24:25] op_sel:[0,0] op_sel_hi:[0,1]
    v_pk_fma_f32 v[28:29], v[28:29], v[24:25], v[30:31] op_sel:[1,1,0] op_sel_hi:[1,0,1] neg_lo:[0,1,0]
    v_cvt_pk_bf16_f32 v34, v28, v29
    ds_write_addtid_b32 v34 offset:6336
    v_pk_mul_f32 v[32:33], v[110:111], v[22:23] op_sel:[0,0] op_sel_hi:[0,1]
    v_pk_fma_f32 v[112:113], v[110:111], v[22:23], v[32:33] op_sel:[1,1,0] op_sel_hi:[1,0,1] neg_lo:[0,1,0]
    v_cvt_pk_bf16_f32 v35, v112, v113
    ds_write_addtid_b32 v35 offset:20592
    v_pk_mul_f32 v[30:31], v[28:29], v[24:25] op_sel:[0,0] op_sel_hi:[0,1]
    v_pk_fma_f32 v[28:29], v[28:29], v[24:25], v[30:31] op_sel:[1,1,0] op_sel_hi:[1,0,1] neg_lo:[0,1,0]
    v_cvt_pk_bf16_f32 v36, v28, v29
    ds_write_addtid_b32 v36 offset:6864
    v_pk_mul_f32 v[32:33], v[112:113], v[22:23] op_sel:[0,0] op_sel_hi:[0,1]
    v_pk_fma_f32 v[114:115], v[112:113], v[22:23], v[32:33] op_sel:[1,1,0] op_sel_hi:[1,0,1] neg_lo:[0,1,0]
    v_cvt_pk_bf16_f32 v37, v114, v115
    ds_write_addtid_b32 v37 offset:23232
    v_pk_mul_f32 v[30:31], v[28:29], v[24:25] op_sel:[0,0] op_sel_hi:[0,1]
    v_pk_fma_f32 v[28:29], v[28:29], v[24:25], v[30:31] op_sel:[1,1,0] op_sel_hi:[1,0,1] neg_lo:[0,1,0]
    v_cvt_pk_bf16_f32 v34, v28, v29
    ds_write_addtid_b32 v34 offset:7392
    v_pk_mul_f32 v[32:33], v[114:115], v[22:23] op_sel:[0,0] op_sel_hi:[0,1]
    v_pk_fma_f32 v[116:117], v[114:115], v[22:23], v[32:33] op_sel:[1,1,0] op_sel_hi:[1,0,1] neg_lo:[0,1,0]
    v_cvt_pk_bf16_f32 v35, v116, v117
    ds_write_addtid_b32 v35 offset:23760
    v_pk_mul_f32 v[30:31], v[28:29], v[24:25] op_sel:[0,0] op_sel_hi:[0,1]
    v_pk_fma_f32 v[28:29], v[28:29], v[24:25], v[30:31] op_sel:[1,1,0] op_sel_hi:[1,0,1] neg_lo:[0,1,0]
    v_cvt_pk_bf16_f32 v36, v28, v29
    ds_write_addtid_b32 v36 offset:7920
    v_pk_mul_f32 v[32:33], v[116:117], v[22:23] op_sel:[0,0] op_sel_hi:[0,1]
    v_pk_fma_f32 v[118:119], v[116:117], v[22:23], v[32:33] op_sel:[1,1,0] op_sel_hi:[1,0,1] neg_lo:[0,1,0]
    v_cvt_pk_bf16_f32 v37, v118, v119
    ds_write_addtid_b32 v37 offset:24288
    v_pk_mul_f32 v[30:31], v[28:29], v[24:25] op_sel:[0,0] op_sel_hi:[0,1]
    v_pk_fma_f32 v[28:29], v[28:29], v[24:25], v[30:31] op_sel:[1,1,0] op_sel_hi:[1,0,1] neg_lo:[0,1,0]
    v_cvt_pk_bf16_f32 v34, v28, v29
    ds_write_addtid_b32 v34 offset:8448
    v_pk_mul_f32 v[32:33], v[118:119], v[22:23] op_sel:[0,0] op_sel_hi:[0,1]
    v_pk_fma_f32 v[120:121], v[118:119], v[22:23], v[32:33] op_sel:[1,1,0] op_sel_hi:[1,0,1] neg_lo:[0,1,0]
    v_cvt_pk_bf16_f32 v35, v120, v121
    ds_write_addtid_b32 v35 offset:24816
    v_pk_mul_f32 v[30:31], v[28:29], v[24:25] op_sel:[0,0] op_sel_hi:[0,1]
    v_pk_fma_f32 v[28:29], v[28:29], v[24:25], v[30:31] op_sel:[1,1,0] op_sel_hi:[1,0,1] neg_lo:[0,1,0]
    v_cvt_pk_bf16_f32 v36, v28, v29
    ds_write_addtid_b32 v36 offset:8976
    v_pk_mul_f32 v[32:33], v[120:121], v[22:23] op_sel:[0,0] op_sel_hi:[0,1]
    v_pk_fma_f32 v[122:123], v[120:121], v[22:23], v[32:33] op_sel:[1,1,0] op_sel_hi:[1,0,1] neg_lo:[0,1,0]
    v_cvt_pk_bf16_f32 v37, v122, v123
    ds_write_addtid_b32 v37 offset:27456
    v_pk_mul_f32 v[30:31], v[28:29], v[24:25] op_sel:[0,0] op_sel_hi:[0,1]
    v_pk_fma_f32 v[28:29], v[28:29], v[24:25], v[30:31] op_sel:[1,1,0] op_sel_hi:[1,0,1] neg_lo:[0,1,0]
    v_cvt_pk_bf16_f32 v34, v28, v29
    ds_write_addtid_b32 v34 offset:9504
    v_pk_mul_f32 v[32:33], v[122:123], v[22:23] op_sel:[0,0] op_sel_hi:[0,1]
    v_pk_fma_f32 v[124:125], v[122:123], v[22:23], v[32:33] op_sel:[1,1,0] op_sel_hi:[1,0,1] neg_lo:[0,1,0]
    v_cvt_pk_bf16_f32 v35, v124, v125
    ds_write_addtid_b32 v35 offset:27984
    v_pk_mul_f32 v[30:31], v[28:29], v[24:25] op_sel:[0,0] op_sel_hi:[0,1]
    v_pk_fma_f32 v[28:29], v[28:29], v[24:25], v[30:31] op_sel:[1,1,0] op_sel_hi:[1,0,1] neg_lo:[0,1,0]
    v_cvt_pk_bf16_f32 v36, v28, v29
    ds_write_addtid_b32 v36 offset:10032
    v_pk_mul_f32 v[32:33], v[124:125], v[22:23] op_sel:[0,0] op_sel_hi:[0,1]
    v_pk_fma_f32 v[126:127], v[124:125], v[22:23], v[32:33] op_sel:[1,1,0] op_sel_hi:[1,0,1] neg_lo:[0,1,0]
    v_cvt_pk_bf16_f32 v37, v126, v127
    ds_write_addtid_b32 v37 offset:28512
    v_pk_mul_f32 v[30:31], v[28:29], v[24:25] op_sel:[0,0] op_sel_hi:[0,1]
    v_pk_fma_f32 v[28:29], v[28:29], v[24:25], v[30:31] op_sel:[1,1,0] op_sel_hi:[1,0,1] neg_lo:[0,1,0]
    v_cvt_pk_bf16_f32 v34, v28, v29
    ds_write_addtid_b32 v34 offset:10560
    v_pk_mul_f32 v[32:33], v[98:99], v[26:27] op_sel:[0,0] op_sel_hi:[0,1]
    v_pk_fma_f32 v[98:99], v[98:99], v[26:27], v[32:33] op_sel:[1,1,0] op_sel_hi:[1,0,1] neg_lo:[0,1,0]
    v_cvt_pk_bf16_f32 v35, v98, v99
    ds_write_addtid_b32 v35 offset:29568
    v_pk_mul_f32 v[30:31], v[28:29], v[24:25] op_sel:[0,0] op_sel_hi:[0,1]
    v_pk_fma_f32 v[28:29], v[28:29], v[24:25], v[30:31] op_sel:[1,1,0] op_sel_hi:[1,0,1] neg_lo:[0,1,0]
    v_cvt_pk_bf16_f32 v36, v28, v29
    ds_write_addtid_b32 v36 offset:11088
    v_pk_mul_f32 v[32:33], v[106:107], v[26:27] op_sel:[0,0] op_sel_hi:[0,1]
    v_pk_fma_f32 v[106:107], v[106:107], v[26:27], v[32:33] op_sel:[1,1,0] op_sel_hi:[1,0,1] neg_lo:[0,1,0]
    v_cvt_pk_bf16_f32 v37, v106, v107
    ds_write_addtid_b32 v37 offset:30096
    v_pk_mul_f32 v[30:31], v[28:29], v[24:25] op_sel:[0,0] op_sel_hi:[0,1]
    v_pk_fma_f32 v[28:29], v[28:29], v[24:25], v[30:31] op_sel:[1,1,0] op_sel_hi:[1,0,1] neg_lo:[0,1,0]
    v_cvt_pk_bf16_f32 v34, v28, v29
    ds_write_addtid_b32 v34 offset:11616
    v_pk_mul_f32 v[32:33], v[114:115], v[26:27] op_sel:[0,0] op_sel_hi:[0,1]
    v_pk_fma_f32 v[114:115], v[114:115], v[26:27], v[32:33] op_sel:[1,1,0] op_sel_hi:[1,0,1] neg_lo:[0,1,0]
    v_cvt_pk_bf16_f32 v35, v114, v115
    ds_write_addtid_b32 v35 offset:31680
    v_pk_mul_f32 v[30:31], v[28:29], v[24:25] op_sel:[0,0] op_sel_hi:[0,1]
    v_pk_fma_f32 v[28:29], v[28:29], v[24:25], v[30:31] op_sel:[1,1,0] op_sel_hi:[1,0,1] neg_lo:[0,1,0]
    v_cvt_pk_bf16_f32 v36, v28, v29
    ds_write_addtid_b32 v36 offset:12144
    v_pk_mul_f32 v[32:33], v[122:123], v[26:27] op_sel:[0,0] op_sel_hi:[0,1]
    v_pk_fma_f32 v[122:123], v[122:123], v[26:27], v[32:33] op_sel:[1,1,0] op_sel_hi:[1,0,1] neg_lo:[0,1,0]
    v_cvt_pk_bf16_f32 v37, v122, v123
    ds_write_addtid_b32 v37 offset:32208
    v_pk_mul_f32 v[30:31], v[28:29], v[24:25] op_sel:[0,0] op_sel_hi:[0,1]
    v_pk_fma_f32 v[28:29], v[28:29], v[24:25], v[30:31] op_sel:[1,1,0] op_sel_hi:[1,0,1] neg_lo:[0,1,0]
    v_cvt_pk_bf16_f32 v34, v28, v29
    ds_write_addtid_b32 v34 offset:12672
    v_pk_mul_f32 v[32:33], v[106:107], v[26:27] op_sel:[0,0] op_sel_hi:[0,1]
    v_pk_fma_f32 v[106:107], v[106:107], v[26:27], v[32:33] op_sel:[1,1,0] op_sel_hi:[1,0,1] neg_lo:[0,1,0]
    v_cvt_pk_bf16_f32 v35, v106, v107
    ds_write_addtid_b32 v35 offset:30624
    v_pk_mul_f32 v[30:31], v[28:29], v[24:25] op_sel:[0,0] op_sel_hi:[0,1]
    v_pk_fma_f32 v[28:29], v[28:29], v[24:25], v[30:31] op_sel:[1,1,0] op_sel_hi:[1,0,1] neg_lo:[0,1,0]
    v_cvt_pk_bf16_f32 v36, v28, v29
    ds_write_addtid_b32 v36 offset:13200
    v_pk_mul_f32 v[32:33], v[122:123], v[26:27] op_sel:[0,0] op_sel_hi:[0,1]
    v_pk_fma_f32 v[122:123], v[122:123], v[26:27], v[32:33] op_sel:[1,1,0] op_sel_hi:[1,0,1] neg_lo:[0,1,0]
    v_cvt_pk_bf16_f32 v37, v122, v123
    ds_write_addtid_b32 v37 offset:31152
    v_pk_mul_f32 v[30:31], v[28:29], v[24:25] op_sel:[0,0] op_sel_hi:[0,1]
    v_pk_fma_f32 v[28:29], v[28:29], v[24:25], v[30:31] op_sel:[1,1,0] op_sel_hi:[1,0,1] neg_lo:[0,1,0]
    v_cvt_pk_bf16_f32 v34, v28, v29
    ds_write_addtid_b32 v34 offset:13728
    v_pk_mul_f32 v[32:33], v[106:107], v[26:27] op_sel:[0,0] op_sel_hi:[0,1]
    v_pk_fma_f32 v[106:107], v[106:107], v[26:27], v[32:33] op_sel:[1,1,0] op_sel_hi:[1,0,1] neg_lo:[0,1,0]
    v_cvt_pk_bf16_f32 v35, v106, v107
    ds_write_addtid_b32 v35 offset:32736
    v_pk_mul_f32 v[30:31], v[28:29], v[24:25] op_sel:[0,0] op_sel_hi:[0,1]
    v_pk_fma_f32 v[28:29], v[28:29], v[24:25], v[30:31] op_sel:[1,1,0] op_sel_hi:[1,0,1] neg_lo:[0,1,0]
    v_cvt_pk_bf16_f32 v36, v28, v29
    ds_write_addtid_b32 v36 offset:14256
    v_pk_mul_f32 v[32:33], v[122:123], v[26:27] op_sel:[0,0] op_sel_hi:[0,1]
    v_pk_fma_f32 v[122:123], v[122:123], v[26:27], v[32:33] op_sel:[1,1,0] op_sel_hi:[1,0,1] neg_lo:[0,1,0]
    v_cvt_pk_bf16_f32 v37, v122, v123
    ds_write_addtid_b32 v37 offset:33264
    v_pk_mul_f32 v[30:31], v[28:29], v[24:25] op_sel:[0,0] op_sel_hi:[0,1]
    v_pk_fma_f32 v[28:29], v[28:29], v[24:25], v[30:31] op_sel:[1,1,0] op_sel_hi:[1,0,1] neg_lo:[0,1,0]
    v_cvt_pk_bf16_f32 v34, v28, v29
    ds_write_addtid_b32 v34 offset:14784
    v_pk_mul_f32 v[30:31], v[28:29], v[24:25] op_sel:[0,0] op_sel_hi:[0,1]
    v_pk_fma_f32 v[28:29], v[28:29], v[24:25], v[30:31] op_sel:[1,1,0] op_sel_hi:[1,0,1] neg_lo:[0,1,0]
    v_cvt_pk_bf16_f32 v36, v28, v29
    ds_write_addtid_b32 v36 offset:15312
    v_pk_mul_f32 v[30:31], v[28:29], v[24:25] op_sel:[0,0] op_sel_hi:[0,1]
    v_pk_fma_f32 v[28:29], v[28:29], v[24:25], v[30:31] op_sel:[1,1,0] op_sel_hi:[1,0,1] neg_lo:[0,1,0]
    v_cvt_pk_bf16_f32 v34, v28, v29
    ds_write_addtid_b32 v34 offset:15840
    v_pk_mul_f32 v[30:31], v[28:29], v[24:25] op_sel:[0,0] op_sel_hi:[0,1]
    v_pk_fma_f32 v[28:29], v[28:29], v[24:25], v[30:31] op_sel:[1,1,0] op_sel_hi:[1,0,1] neg_lo:[0,1,0]
    v_cvt_pk_bf16_f32 v36, v28, v29
    ds_write_addtid_b32 v36 offset:16368
    ds_write_addtid_b32 v12 offset:25344
    ds_write_addtid_b32 v13 offset:25872
    ds_write_addtid_b32 v14 offset:26400
    s_cmp_eq_u32 s52, 0
    s_cbranch_scc0 L_helper
    s_setprio 2
    s_barrier
    ds_read_b128 v[128:131], v78 offset:16896
    ds_read_b128 v[132:135], v78 offset:0
    ds_read_b128 v[136:139], v78 offset:16928
    ds_read_b128 v[140:143], v78 offset:32
    ds_read_b128 v[144:147], v78 offset:16960
    ds_read_b128 v[148:151], v78 offset:64
    ds_read_b128 v[152:155], v78 offset:16992
    ds_read_b128 v[156:159], v78 offset:96
    ds_read_b128 v[160:163], v78 offset:17024
    ds_read_b128 v[164:167], v78 offset:128
    ds_read_b128 v[168:171], v78 offset:17056
    ds_read_b128 v[172:175], v78 offset:160
    v_add_u32 v74, -1, v2
    v_and_b32 v71, v71, v74
    v_mul_f32 v71, 0x44800000, v71
    v_and_b32 v10, 3, v8
    v_add_u32 v5, 1, v10
    v_mul_u32_u24 v10, 1214, v10
    s_waitcnt lgkmcnt(10)
    v_mfma_f32_32x32x16_bf16 v[48:63], v[128:131], v[132:135], 0
    ds_read_b128 v[176:179], v78 offset:17088
    ds_read_b128 v[180:183], v78 offset:192
    v_lshl_add_u32 v11, v8, 1, v9
    s_waitcnt lgkmcnt(10)
    v_mfma_f32_32x32x16_bf16 v[48:63], v[136:139], v[140:143], v[48:63]
    ds_read_b128 v[184:187], v78 offset:17120
    ds_read_b128 v[188:191], v78 offset:224
    v_mul_u32_u24 v4, 17, v9
    s_waitcnt lgkmcnt(10)
    v_mfma_f32_32x32x16_bf16 v[48:63], v[144:147], v[148:151], v[48:63]
    ds_read_b128 v[192:195], v78 offset:17152
    ds_read_b128 v[196:199], v78 offset:256
    v_sub_u32 v4, v4, v11
    s_waitcnt lgkmcnt(10)
    v_mfma_f32_32x32x16_bf16 v[48:63], v[152:155], v[156:159], v[48:63]
    ds_read_b128 v[200:203], v78 offset:17184
    ds_read_b128 v[204:207], v78 offset:288
    v_and_b32 v5, 4, v5
    s_waitcnt lgkmcnt(10)
    v_mfma_f32_32x32x16_bf16 v[48:63], v[160:163], v[164:167], v[48:63]
    ds_read_b128 v[208:211], v78 offset:17216
    ds_read_b128 v[212:215], v78 offset:320
    s_add_u32 s43, s55, 3680
    s_waitcnt lgkmcnt(10)
    v_mfma_f32_32x32x16_bf16 v[48:63], v[168:171], v[172:175], v[48:63]
    ds_read_b128 v[216:219], v78 offset:17248
    ds_read_b128 v[220:223], v78 offset:352
    v_lshl_add_u32 v10, v5, 1, v10
    s_waitcnt lgkmcnt(10)
    v_mfma_f32_32x32x16_bf16 v[48:63], v[176:179], v[180:183], v[48:63]
    ds_read_b128 v[224:227], v78 offset:17280
    ds_read_b128 v[228:231], v78 offset:384
    v_sub_u32 v10, v4, v10
    s_waitcnt lgkmcnt(10)
    v_mfma_f32_32x32x16_bf16 v[48:63], v[184:187], v[188:191], v[48:63]
    ds_read_b128 v[232:235], v78 offset:17312
    ds_read_b128 v[236:239], v78 offset:416
    v_add_u32 v10, s43, v10
    s_waitcnt lgkmcnt(10)
    v_mfma_f32_32x32x16_bf16 v[48:63], v[192:195], v[196:199], v[48:63]
    ds_read_b128 v[240:243], v78 offset:17344
    ds_read_b128 v[244:247], v78 offset:448
    v_lshl_add_u32 v11, v11, 4, s63
    s_waitcnt lgkmcnt(10)
    v_mfma_f32_32x32x16_bf16 v[48:63], v[200:203], v[204:207], v[48:63]
    ds_read_b128 v[248:251], v78 offset:17376
    ds_read_b128 v[252:255], v78 offset:480
    s_add_u32 s43, s55, 5116
    s_waitcnt lgkmcnt(10)
    v_mfma_f32_32x32x16_bf16 v[48:63], v[208:211], v[212:215], v[48:63]
    v_lshrrev_b32 v75, 2, v3
    s_waitcnt lgkmcnt(8)
    v_mfma_f32_32x32x16_bf16 v[48:63], v[216:219], v[220:223], v[48:63]
    v_sub_u32 v75, s43, v75
    s_waitcnt lgkmcnt(6)
    v_mfma_f32_32x32x16_bf16 v[48:63], v[224:227], v[228:231], v[48:63]
    v_lshl_add_u32 v7, v9, 6, v3
    s_waitcnt lgkmcnt(4)
    v_mfma_f32_32x32x16_bf16 v[48:63], v[232:235], v[236:239], v[48:63]
    v_add_u32 v7, s55, v7
    s_waitcnt lgkmcnt(2)
    v_mfma_f32_32x32x16_bf16 v[48:63], v[240:243], v[244:247], v[48:63]
    v_lshlrev_b32 v4, 2, v9
    s_waitcnt lgkmcnt(0)
    v_mfma_f32_32x32x16_bf16 v[48:63], v[248:251], v[252:255], v[48:63]
    v_sub_u32 v4, v4, v8
    ds_write_b128 v83, v[84:87]
    s_add_u32 s43, s55, 5304
    v_lshl_add_u32 v89, v4, 3, s43
    s_add_u32 s43, s55, 4924
    v_lshl_add_u32 v4, v4, 2, s43
    s_lshl_b32 s43, s51, 2
    s_add_u32 s43, s43, 153728
    v_mov_b32 v88, s43
    v_add_u32 v5, 154048, v3
    s_nop 1
    v_add_f32 v48, v48, v71
    v_bitop3_b32 v49, v79, v48, v49 bitop3:0xca
    v_bitop3_b32 v51, v79, v52, v51 bitop3:0xca
    v_bitop3_b32 v53, v79, v52, v53 bitop3:0xca
    v_bitop3_b32 v55, v79, v56, v55 bitop3:0xca
    v_cvt_pk_bf16_f32 v128, v55, v54
    v_cvt_pk_bf16_f32 v129, v53, v52
    v_cvt_pk_bf16_f32 v130, v51, v50
    v_cvt_pk_bf16_f32 v131, v49, v48
    ds_write_b128 v81, v[128:131] offset:0
    v_bitop3_b32 v57, v80, v56, v57 bitop3:0xca
    v_bitop3_b32 v58, v82, v56, v58 bitop3:0xca
    v_cvt_pk_bf16_f32 v132, v56, v55
    v_cvt_pk_bf16_f32 v133, v54, v53
    v_cvt_pk_bf16_f32 v134, v52, v51
    v_cvt_pk_bf16_f32 v135, v50, v49
    ds_write_b128 v81, v[132:135] offset:3648
    v_readlane_b32 s42, v130, 0
    v_readlane_b32 s43, v131, 0
    v_readlane_b32 s58, v128, 63
    v_cvt_pk_bf16_f32 v136, v57, v56
    v_cvt_pk_bf16_f32 v137, v55, v54
    v_cvt_pk_bf16_f32 v138, v53, v52
    v_cvt_pk_bf16_f32 v139, v51, v50
    ds_write_b128 v81, v[136:139] offset:2432
    s_pack_lh_b32_b16 s42, s58, s42
    v_mov_b32 v71, s42
    v_perm_b32 v71, v71, s43, v72
    v_cvt_pk_bf16_f32 v140, v58, v57
    v_cvt_pk_bf16_f32 v141, v56, v55
    v_cvt_pk_bf16_f32 v142, v54, v53
    v_cvt_pk_bf16_f32 v143, v52, v51
    ds_write_b128 v81, v[140:143] offset:1216
    ds_write_b16 v73, v71
    v_cvt_pk_bf16_f32 v72, v61, v60
    v_cvt_pk_bf16_f32 v74, v63, v62
    ds_write_b32 v77, v72
    v_readlane_b32 s59, v72, 63
    ds_write_b32 v75, v74
    s_and_b32 s59, s59, 0xffff
    v_mov_b32 v90, v76
    ds_read_b64 v[220:221], v10 offset:576
    ds_read_b64 v[222:223], v10 offset:584
    ds_read_b64 v[252:253], v10 offset:64
    ds_read_b64 v[254:255], v10 offset:72
    ds_read_b64 v[216:217], v10 offset:640
    ds_read_b64 v[218:219], v10 offset:648
    ds_read_b64 v[248:249], v10 offset:128
    ds_read_b64 v[250:251], v10 offset:136
    ds_read_b64 v[212:213], v10 offset:704
    ds_read_b64 v[214:215], v10 offset:712
    ds_read_b64 v[244:245], v10 offset:192
    ds_read_b64 v[246:247], v10 offset:200
    ds_read_b64 v[208:209], v10 offset:768
    s_movk_i32 s43, 0x3000
    ds_read_b64 v[210:211], v10 offset:776
    v_lshlrev_b32 v6, v8, s43
    ds_read_b64 v[240:241], v10 offset:256
    v_lshlrev_b32 v16, 3, v9
    ds_read_b64 v[242:243], v10 offset:264
    v_bfe_u32 v6, v6, v16, 8
    ds_read_b64 v[204:205], v10 offset:832
    v_lshl_or_b32 v6, v6, 15, v6
    ds_read_b64 v[206:207], v10 offset:840
    v_lshrrev_b32 v16, 0, v6
    ds_read_b64 v[236:237], v10 offset:320
    v_and_b32 v16, 0x10001, v16
    ds_read_b64 v[238:239], v10 offset:328
    v_mul_u32_u24 v16, s59, v16
    ds_read_b64 v[200:201], v10 offset:896
    v_lshrrev_b32 v17, 2, v6
    ds_read_b64 v[202:203], v10 offset:904
    v_and_b32 v17, 0x10001, v17
    ds_read_b64 v[232:233], v10 offset:384
    v_mul_u32_u24 v17, s59, v17
    ds_read_b64 v[234:235], v10 offset:392
    v_lshrrev_b32 v18, 4, v6
    v_and_b32 v18, 0x10001, v18
    v_mul_u32_u24 v18, s59, v18
    v_lshrrev_b32 v19, 6, v6
    v_and_b32 v19, 0x10001, v19
    v_mul_u32_u24 v19, s59, v19
    s_waitcnt lgkmcnt(6)
    s_barrier
    s_setprio 1
    ds_read_b128 v[68:71], v11 offset:0
    ds_read_b128 v[72:75], v11 offset:64
    ds_read_b128 v[76:79], v11 offset:128
    ds_read_b128 v[80:83], v11 offset:192
    ds_read_b128 v[84:87], v11 offset:256
    ds_read_b128 v[132:135], v11 offset:320
    ds_read_b64 v[196:197], v10 offset:960
    ds_read_b64 v[198:199], v10 offset:968
    s_waitcnt lgkmcnt(7)
    v_mfma_f32_16x16x32_bf16 v[44:47], v[220:223], v[68:71], 0
    v_mfma_f32_16x16x32_bf16 v[48:51], v[252:255], v[68:71], 0
    s_cmp_lt_u32 s39, 2
    s_cbranch_scc0 L_ct3
    global_load_dword v1, v90, s[56:57]
L_ct3:
    ds_read_b128 v[68:71], v11 offset:384
    s_waitcnt lgkmcnt(6)
    v_mfma_f32_16x16x32_bf16 v[44:47], v[216:219], v[72:75], v[44:47]
    ds_read_b64 v[228:229], v10 offset:448
    v_mfma_f32_16x16x32_bf16 v[48:51], v[248:251], v[72:75], v[48:51]
    ds_read_b64 v[230:231], v10 offset:456
    v_mfma_f32_16x16x32_bf16 v[44:47], v[212:215], v[76:79], v[44:47]
    ds_read_b64 v[192:193], v10 offset:1024
    ds_read_b64 v[194:195], v10 offset:1032
    v_mfma_f32_16x16x32_bf16 v[48:51], v[244:247], v[76:79], v[48:51]
    ds_read_b128 v[72:75], v11 offset:448
    ds_read_b64 v[224:225], v10 offset:512
    s_waitcnt lgkmcnt(10)
    v_mfma_f32_16x16x32_bf16 v[44:47], v[208:211], v[80:83], v[44:47]
    ds_read_b64 v[226:227], v10 offset:520
    ds_read_b128 v[28:31], v5 offset:1024
    v_mfma_f32_16x16x32_bf16 v[48:51], v[240:243], v[80:83], v[48:51]
    ds_read_b128 v[32:35], v5 offset:2048
    ds_read_b128 v[36:39], v5 offset:3072
    v_mfma_f32_16x16x32_bf16 v[44:47], v[204:207], v[84:87], v[44:47]
    ds_read_b128 v[20:23], v5 offset:4096
    v_mfma_f32_16x16x32_bf16 v[48:51], v[236:239], v[84:87], v[48:51]
    s_waitcnt lgkmcnt(9)
    v_mfma_f32_16x16x32_bf16 v[44:47], v[200:203], v[132:135], v[44:47]
    ds_read_b128 v[24:27], v5 offset:5120
    ds_read_b64 v[12:13], v10 offset:0
    v_mfma_f32_16x16x32_bf16 v[48:51], v[232:235], v[132:135], v[48:51]
    ds_read_b64 v[14:15], v10 offset:8
    v_mfma_f32_16x16x32_bf16 v[44:47], v[196:199], v[68:71], v[44:47]
    ds_read_b128 v[76:79], v11 offset:432
    v_mfma_f32_16x16x32_bf16 v[48:51], v[228:231], v[68:71], v[48:51]
    ds_read_b128 v[80:83], v11 offset:512
    s_waitcnt lgkmcnt(9)
    v_mfma_f32_16x16x32_bf16 v[44:47], v[192:195], v[72:75], v[44:47]
    ds_read_b128 v[84:87], v11 offset:576
    v_mfma_f32_16x16x32_bf16 v[48:51], v[224:227], v[72:75], v[48:51]
    s_waitcnt lgkmcnt(5)
    ds_read_b128 v[132:135], v11 offset:640
    v_mfma_f32_16x16x32_bf16 v[108:111], v[72:75], v[28:31], 0
    ds_read_b128 v[68:71], v11 offset:704
    v_mfma_f32_16x16x32_bf16 v[112:115], v[72:75], v[32:35], 0
    s_waitcnt lgkmcnt(5)
    v_mfma_f32_16x16x32_bf16 v[52:55], v[12:15], v[72:75], 0
    v_mfma_f32_16x16x32_bf16 v[116:119], v[72:75], v[36:39], 0
    ds_write_b128 v7, v[44:47] offset:9472
    v_mfma_f32_16x16x32_bf16 v[124:127], v[72:75], v[20:23], 0
    v_mfma_f32_16x16x32_bf16 v[60:63], v[16:19], v[72:75], 0
    ds_read_b128 v[72:75], v11 offset:768
    s_waitcnt lgkmcnt(5)
    v_mfma_f32_16x16x32_bf16 v[120:123], v[76:79], v[32:35], 0
    ds_write_b32 v88, v88 offset:0
    v_mfma_f32_16x16x32_bf16 v[128:131], v[76:79], v[24:27], 0
    ds_read_b128 v[76:79], v11 offset:832
    v_mfma_f32_16x16x32_bf16 v[48:51], v[220:223], v[80:83], v[48:51]
    v_mfma_f32_16x16x32_bf16 v[52:55], v[252:255], v[80:83], v[52:55]
    ds_read_b128 v[80:83], v11 offset:896
    s_waitcnt lgkmcnt(6)
    v_mfma_f32_16x16x32_bf16 v[48:51], v[216:219], v[84:87], v[48:51]
    v_mfma_f32_16x16x32_bf16 v[52:55], v[248:251], v[84:87], v[52:55]
    ds_read_b128 v[84:87], v11 offset:960
    v_cvt_pk_bf16_f32 v136, v120, v116
    v_mfma_f32_16x16x32_bf16 v[48:51], v[212:215], v[132:135], v[48:51]
    v_cvt_pk_bf16_f32 v137, v112, v108
    v_mfma_f32_16x16x32_bf16 v[52:55], v[244:247], v[132:135], v[52:55]
    s_waitcnt lgkmcnt(4)
    v_cvt_pk_bf16_f32 v138, v121, v117
    v_mfma_f32_16x16x32_bf16 v[48:51], v[208:211], v[68:71], v[48:51]
    v_cvt_pk_bf16_f32 v139, v113, v109
    v_mfma_f32_16x16x32_bf16 v[52:55], v[240:243], v[68:71], v[52:55]
    ds_read_b128 v[132:135], v11 offset:944
    v_cvt_pk_bf16_f32 v140, v122, v118
    v_mfma_f32_16x16x32_bf16 v[48:51], v[204:207], v[72:75], v[48:51]
    v_cvt_pk_bf16_f32 v141, v114, v110
    v_mfma_f32_16x16x32_bf16 v[52:55], v[236:239], v[72:75], v[52:55]
    ds_read_b128 v[68:71], v11 offset:1024
    s_waitcnt lgkmcnt(3)
    v_mfma_f32_16x16x32_bf16 v[48:51], v[200:203], v[76:79], v[48:51]
    v_cvt_pk_bf16_f32 v142, v123, v119
    v_mfma_f32_16x16x32_bf16 v[52:55], v[232:235], v[76:79], v[52:55]
    ds_read_b64 v[168:169], v89 offset:256
    v_cvt_pk_bf16_f32 v143, v115, v111
    v_mfma_f32_16x16x32_bf16 v[48:51], v[196:199], v[80:83], v[48:51]
    ds_read_b64 v[170:171], v89 offset:264
    v_cvt_pk_bf16_f32 v92, v128, v124
    v_mfma_f32_16x16x32_bf16 v[52:55], v[228:231], v[80:83], v[52:55]
    ds_read_b128 v[72:75], v11 offset:1088
    s_waitcnt lgkmcnt(5)
    v_mfma_f32_16x16x32_bf16 v[48:51], v[192:195], v[84:87], v[48:51]
    ds_read_b64 v[172:173], v89 offset:272
    v_cvt_pk_bf16_f32 v93, v129, v125
    v_mfma_f32_16x16x32_bf16 v[52:55], v[224:227], v[84:87], v[52:55]
    ds_read_b64 v[174:175], v89 offset:280
    v_cvt_pk_bf16_f32 v94, v130, v126
    v_mfma_f32_16x16x32_bf16 v[108:111], v[84:87], v[28:31], 0
    ds_read_b128 v[76:79], v11 offset:1152
    v_cvt_pk_bf16_f32 v95, v131, v127
    v_mfma_f32_16x16x32_bf16 v[112:115], v[84:87], v[32:35], 0
    v_mfma_f32_16x16x32_bf16 v[56:59], v[12:15], v[84:87], 0
    ds_read_b128 v[80:83], v11 offset:1216
    v_mfma_f32_16x16x32_bf16 v[116:119], v[84:87], v[36:39], 0
    ds_write_b128 v7, v[48:51] offset:10752
    v_mfma_f32_16x16x32_bf16 v[124:127], v[84:87], v[20:23], 0
    v_mfma_f32_16x16x32_bf16 v[64:67], v[16:19], v[84:87], 0
    ds_read_b128 v[84:87], v11 offset:1280
    s_waitcnt lgkmcnt(9)
    v_mfma_f32_16x16x32_bf16 v[120:123], v[132:135], v[32:35], 0
    ds_write_b32 v88, v88 offset:16
    v_mfma_f32_16x16x32_bf16 v[128:131], v[132:135], v[24:27], 0
    ds_read_b128 v[132:135], v11 offset:1344
    v_mfma_f32_16x16x32_bf16 v[52:55], v[220:223], v[68:71], v[52:55]
    v_mfma_f32_16x16x32_bf16 v[56:59], v[252:255], v[68:71], v[56:59]
    ds_read_b128 v[68:71], v11 offset:1408
    s_waitcnt lgkmcnt(7)
    v_mfma_f32_16x16x32_bf16 v[52:55], v[136:139], v[168:171], v[52:55]
    v_mfma_f32_16x16x32_bf16 v[52:55], v[216:219], v[72:75], v[52:55]
    v_mfma_f32_16x16x32_bf16 v[56:59], v[248:251], v[72:75], v[56:59]
    ds_read_b128 v[72:75], v11 offset:1472
    v_mfma_f32_16x16x32_bf16 v[52:55], v[140:143], v[172:175], v[52:55]
    s_waitcnt lgkmcnt(6)
    v_cvt_pk_bf16_f32 v144, v120, v116
    v_mfma_f32_16x16x32_bf16 v[52:55], v[212:215], v[76:79], v[52:55]
    v_cvt_pk_bf16_f32 v145, v112, v108
    v_mfma_f32_16x16x32_bf16 v[56:59], v[244:247], v[76:79], v[56:59]
    v_cvt_pk_bf16_f32 v146, v121, v117
    v_mfma_f32_16x16x32_bf16 v[52:55], v[208:211], v[80:83], v[52:55]
    v_cvt_pk_bf16_f32 v147, v113, v109
    v_mfma_f32_16x16x32_bf16 v[56:59], v[240:243], v[80:83], v[56:59]
    ds_read_b128 v[76:79], v11 offset:1456
    s_waitcnt lgkmcnt(3)
    v_mfma_f32_16x16x32_bf16 v[52:55], v[204:207], v[84:87], v[52:55]
    v_cvt_pk_bf16_f32 v148, v122, v118
    v_mfma_f32_16x16x32_bf16 v[56:59], v[236:239], v[84:87], v[56:59]
    ds_read_b128 v[80:83], v11 offset:1536
    v_cvt_pk_bf16_f32 v149, v114, v110
    v_mfma_f32_16x16x32_bf16 v[52:55], v[200:203], v[132:135], v[52:55]
    v_cvt_pk_bf16_f32 v150, v123, v119
    v_mfma_f32_16x16x32_bf16 v[56:59], v[232:235], v[132:135], v[56:59]
    ds_read_b64 v[176:177], v89 offset:128
    s_waitcnt lgkmcnt(3)
    v_mfma_f32_16x16x32_bf16 v[52:55], v[196:199], v[68:71], v[52:55]
    ds_read_b64 v[178:179], v89 offset:136
    v_cvt_pk_bf16_f32 v151, v115, v111
    v_mfma_f32_16x16x32_bf16 v[56:59], v[228:231], v[68:71], v[56:59]
    ds_read_b128 v[84:87], v11 offset:1600
    v_cvt_pk_bf16_f32 v96, v128, v124
    v_mfma_f32_16x16x32_bf16 v[52:55], v[192:195], v[72:75], v[52:55]
    ds_read_b64 v[180:181], v89 offset:144
    v_cvt_pk_bf16_f32 v97, v129, v125
    v_mfma_f32_16x16x32_bf16 v[56:59], v[224:227], v[72:75], v[56:59]
    ds_read_b64 v[182:183], v89 offset:152
    v_cvt_pk_bf16_f32 v98, v130, v126
    v_mfma_f32_16x16x32_bf16 v[108:111], v[72:75], v[28:31], 0
    ds_read_b128 v[132:135], v11 offset:1664
    v_cvt_pk_bf16_f32 v99, v131, v127
    v_mfma_f32_16x16x32_bf16 v[112:115], v[72:75], v[32:35], 0
    v_mfma_f32_16x16x32_bf16 v[60:63], v[12:15], v[72:75], v[60:63]
    v_mfma_f32_16x16x32_bf16 v[116:119], v[72:75], v[36:39], 0
    ds_read_b128 v[68:71], v11 offset:1728
    ds_write_b128 v7, v[52:55] offset:12032
    v_mfma_f32_16x16x32_bf16 v[124:127], v[72:75], v[20:23], 0
    v_mfma_f32_16x16x32_bf16 v[44:47], v[16:19], v[72:75], 0
    ds_read_b128 v[72:75], v11 offset:1792
    s_waitcnt lgkmcnt(9)
    v_mfma_f32_16x16x32_bf16 v[120:123], v[76:79], v[32:35], 0
    ds_write_b32 v88, v88 offset:32
    v_mfma_f32_16x16x32_bf16 v[128:131], v[76:79], v[24:27], 0
    ds_read_b128 v[76:79], v11 offset:1856
    v_mfma_f32_16x16x32_bf16 v[56:59], v[220:223], v[80:83], v[56:59]
    v_mfma_f32_16x16x32_bf16 v[60:63], v[252:255], v[80:83], v[60:63]
    ds_read_b128 v[80:83], v11 offset:1920
    s_waitcnt lgkmcnt(7)
    v_mfma_f32_16x16x32_bf16 v[56:59], v[136:139], v[176:179], v[56:59]
    v_mfma_f32_16x16x32_bf16 v[56:59], v[216:219], v[84:87], v[56:59]
    v_mfma_f32_16x16x32_bf16 v[60:63], v[248:251], v[84:87], v[60:63]
    ds_read_b128 v[84:87], v11 offset:1984
    v_mfma_f32_16x16x32_bf16 v[56:59], v[140:143], v[180:183], v[56:59]
    s_waitcnt lgkmcnt(6)
    v_cvt_pk_bf16_f32 v152, v120, v116
    v_mfma_f32_16x16x32_bf16 v[56:59], v[212:215], v[132:135], v[56:59]
    v_cvt_pk_bf16_f32 v153, v112, v108
    v_mfma_f32_16x16x32_bf16 v[60:63], v[244:247], v[132:135], v[60:63]
    v_cvt_pk_bf16_f32 v154, v121, v117
    v_mfma_f32_16x16x32_bf16 v[56:59], v[144:147], v[168:171], v[56:59]
    v_cvt_pk_bf16_f32 v155, v113, v109
    v_mfma_f32_16x16x32_bf16 v[56:59], v[208:211], v[68:71], v[56:59]
    v_cvt_pk_bf16_f32 v156, v122, v118
    v_mfma_f32_16x16x32_bf16 v[60:63], v[240:243], v[68:71], v[60:63]
    v_cvt_pk_bf16_f32 v157, v114, v110
    v_mfma_f32_16x16x32_bf16 v[56:59], v[148:151], v[172:175], v[56:59]
    ds_read_b128 v[132:135], v11 offset:1968
    s_waitcnt lgkmcnt(3)
    v_mfma_f32_16x16x32_bf16 v[56:59], v[204:207], v[72:75], v[56:59]
    v_cvt_pk_bf16_f32 v158, v123, v119
    v_mfma_f32_16x16x32_bf16 v[60:63], v[236:239], v[72:75], v[60:63]
    ds_read_b128 v[68:71], v11 offset:2048
    v_cvt_pk_bf16_f32 v159, v115, v111
    v_mfma_f32_16x16x32_bf16 v[56:59], v[200:203], v[76:79], v[56:59]
    v_cvt_pk_bf16_f32 v100, v128, v124
    v_mfma_f32_16x16x32_bf16 v[60:63], v[232:235], v[76:79], v[60:63]
    ds_read2_b32 v[40:41], v4 offset0:48 offset1:49
    s_waitcnt lgkmcnt(3)
    v_mfma_f32_16x16x32_bf16 v[56:59], v[196:199], v[80:83], v[56:59]
    ds_read2_b32 v[42:43], v4 offset0:50 offset1:51
    v_cvt_pk_bf16_f32 v101, v129, v125
    v_mfma_f32_16x16x32_bf16 v[60:63], v[228:231], v[80:83], v[60:63]
    ds_read_b128 v[72:75], v11 offset:2112
    v_cvt_pk_bf16_f32 v102, v130, v126
    v_mfma_f32_16x16x32_bf16 v[56:59], v[192:195], v[84:87], v[56:59]
    ds_read_b64 v[184:185], v89 offset:0
    v_cvt_pk_bf16_f32 v103, v131, v127
    v_mfma_f32_16x16x32_bf16 v[60:63], v[224:227], v[84:87], v[60:63]
    ds_read_b64 v[186:187], v89 offset:8
    v_mfma_f32_16x16x32_bf16 v[108:111], v[84:87], v[28:31], 0
    ds_read_b128 v[76:79], v11 offset:2176
    v_mfma_f32_16x16x32_bf16 v[112:115], v[84:87], v[32:35], 0
    v_mfma_f32_16x16x32_bf16 v[64:67], v[12:15], v[84:87], v[64:67]
    ds_read_b64 v[188:189], v89 offset:16
    v_mfma_f32_16x16x32_bf16 v[116:119], v[84:87], v[36:39], 0
    ds_read_b64 v[190:191], v89 offset:24
    ds_write_b128 v7, v[56:59] offset:13312
    v_mfma_f32_16x16x32_bf16 v[124:127], v[84:87], v[20:23], 0
    ds_read_b128 v[80:83], v11 offset:2240
    v_mfma_f32_16x16x32_bf16 v[48:51], v[16:19], v[84:87], 0
    ds_read_b128 v[84:87], v11 offset:2304
    s_waitcnt lgkmcnt(11)
    v_mfma_f32_16x16x32_bf16 v[120:123], v[132:135], v[32:35], 0
    ds_write_b32 v88, v88 offset:48
    v_mfma_f32_16x16x32_bf16 v[128:131], v[132:135], v[24:27], 0
    ds_read_b128 v[132:135], v11 offset:2368
    v_mfma_f32_16x16x32_bf16 v[60:63], v[220:223], v[68:71], v[60:63]
    v_mfma_f32_16x16x32_bf16 v[64:67], v[252:255], v[68:71], v[64:67]
    s_waitcnt lgkmcnt(8)
    v_mfma_f32_16x16x32_bf16 v[60:63], v[92:95], v[40:43], v[60:63]
    ds_read_b128 v[68:71], v11 offset:2432
    v_mfma_f32_16x16x32_bf16 v[60:63], v[216:219], v[72:75], v[60:63]
    v_mfma_f32_16x16x32_bf16 v[64:67], v[248:251], v[72:75], v[64:67]
    v_mfma_f32_16x16x32_bf16 v[60:63], v[136:139], v[184:187], v[60:63]
    ds_read_b128 v[72:75], v11 offset:2496
    s_waitcnt lgkmcnt(5)
    v_mfma_f32_16x16x32_bf16 v[60:63], v[212:215], v[76:79], v[60:63]
    v_cvt_pk_bf16_f32 v160, v120, v116
    v_mfma_f32_16x16x32_bf16 v[64:67], v[244:247], v[76:79], v[64:67]
    v_cvt_pk_bf16_f32 v161, v112, v108
    v_mfma_f32_16x16x32_bf16 v[60:63], v[140:143], v[188:191], v[60:63]
    v_cvt_pk_bf16_f32 v162, v121, v117
    v_mfma_f32_16x16x32_bf16 v[60:63], v[208:211], v[80:83], v[60:63]
    v_cvt_pk_bf16_f32 v163, v113, v109
    v_mfma_f32_16x16x32_bf16 v[64:67], v[240:243], v[80:83], v[64:67]
    v_cvt_pk_bf16_f32 v164, v122, v118
    v_mfma_f32_16x16x32_bf16 v[60:63], v[144:147], v[176:179], v[60:63]
    s_waitcnt lgkmcnt(2)
    v_cvt_pk_bf16_f32 v165, v114, v110
    v_mfma_f32_16x16x32_bf16 v[60:63], v[204:207], v[84:87], v[60:63]
    ds_read_b128 v[76:79], v11 offset:2480
    v_cvt_pk_bf16_f32 v166, v123, v119
    v_mfma_f32_16x16x32_bf16 v[64:67], v[236:239], v[84:87], v[64:67]
    ds_read_b128 v[80:83], v11 offset:2560
    v_cvt_pk_bf16_f32 v167, v115, v111
    v_mfma_f32_16x16x32_bf16 v[60:63], v[148:151], v[180:183], v[60:63]
    v_cvt_pk_bf16_f32 v104, v128, v124
    v_mfma_f32_16x16x32_bf16 v[60:63], v[200:203], v[132:135], v[60:63]
    v_cvt_pk_bf16_f32 v105, v129, v125
    v_mfma_f32_16x16x32_bf16 v[64:67], v[232:235], v[132:135], v[64:67]
    ds_read2_b32 v[16:17], v4 offset0:32 offset1:33
    v_cvt_pk_bf16_f32 v106, v130, v126
    v_mfma_f32_16x16x32_bf16 v[60:63], v[152:155], v[168:171], v[60:63]
    ds_read2_b32 v[18:19], v4 offset0:34 offset1:35
    s_waitcnt lgkmcnt(4)
    v_mfma_f32_16x16x32_bf16 v[60:63], v[196:199], v[68:71], v[60:63]
    ds_read_b128 v[84:87], v11 offset:2624
    v_cvt_pk_bf16_f32 v107, v131, v127
    v_mfma_f32_16x16x32_bf16 v[64:67], v[228:231], v[68:71], v[64:67]
    v_mfma_f32_16x16x32_bf16 v[60:63], v[156:159], v[172:175], v[60:63]
    v_mfma_f32_16x16x32_bf16 v[60:63], v[192:195], v[72:75], v[60:63]
    ds_read_b128 v[132:135], v11 offset:2688
    v_mfma_f32_16x16x32_bf16 v[64:67], v[224:227], v[72:75], v[64:67]
    v_mfma_f32_16x16x32_bf16 v[108:111], v[72:75], v[28:31], 0
    v_mfma_f32_16x16x32_bf16 v[112:115], v[72:75], v[32:35], 0
    ds_read_b128 v[68:71], v11 offset:2752
    v_mfma_f32_16x16x32_bf16 v[44:47], v[12:15], v[72:75], v[44:47]
    v_mfma_f32_16x16x32_bf16 v[116:119], v[72:75], v[36:39], 0
    ds_read_b128 v[72:75], v11 offset:2816
    s_waitcnt lgkmcnt(6)
    v_mfma_f32_16x16x32_bf16 v[120:123], v[76:79], v[32:35], 0
    ds_write_b128 v7, v[60:63] offset:14592
    v_mfma_f32_16x16x32_bf16 v[64:67], v[220:223], v[80:83], v[64:67]
    ds_read_b128 v[76:79], v11 offset:2880
    ds_write_b32 v88, v88 offset:64
    v_mfma_f32_16x16x32_bf16 v[44:47], v[252:255], v[80:83], v[44:47]
    v_mfma_f32_16x16x32_bf16 v[64:67], v[96:99], v[40:43], v[64:67]
    s_waitcnt lgkmcnt(6)
    v_mfma_f32_16x16x32_bf16 v[64:67], v[92:95], v[16:19], v[64:67]
    ds_read_b128 v[80:83], v11 offset:2944
    v_mfma_f32_16x16x32_bf16 v[64:67], v[216:219], v[84:87], v[64:67]
    v_mfma_f32_16x16x32_bf16 v[44:47], v[248:251], v[84:87], v[44:47]
    v_mfma_f32_16x16x32_bf16 v[64:67], v[144:147], v[184:187], v[64:67]
    ds_read_b128 v[84:87], v11 offset:3008
    s_waitcnt lgkmcnt(6)
    v_mfma_f32_16x16x32_bf16 v[64:67], v[212:215], v[132:135], v[64:67]
    v_cvt_pk_bf16_f32 v136, v120, v116
    v_mfma_f32_16x16x32_bf16 v[44:47], v[244:247], v[132:135], v[44:47]
    v_cvt_pk_bf16_f32 v137, v112, v108
    v_mfma_f32_16x16x32_bf16 v[64:67], v[148:151], v[188:191], v[64:67]
    v_cvt_pk_bf16_f32 v138, v121, v117
    v_mfma_f32_16x16x32_bf16 v[64:67], v[208:211], v[68:71], v[64:67]
    v_cvt_pk_bf16_f32 v139, v113, v109
    v_mfma_f32_16x16x32_bf16 v[44:47], v[240:243], v[68:71], v[44:47]
    v_cvt_pk_bf16_f32 v140, v122, v118
    v_mfma_f32_16x16x32_bf16 v[64:67], v[152:155], v[176:179], v[64:67]
    s_waitcnt lgkmcnt(3)
    v_cvt_pk_bf16_f32 v141, v114, v110
    v_mfma_f32_16x16x32_bf16 v[64:67], v[204:207], v[72:75], v[64:67]
    ds_read_b128 v[132:135], v11 offset:2992
    v_cvt_pk_bf16_f32 v142, v123, v119
    v_mfma_f32_16x16x32_bf16 v[44:47], v[236:239], v[72:75], v[44:47]
    ds_read_b128 v[68:71], v11 offset:3072
    v_cvt_pk_bf16_f32 v143, v115, v111
    v_mfma_f32_16x16x32_bf16 v[64:67], v[156:159], v[180:183], v[64:67]
    v_mfma_f32_16x16x32_bf16 v[64:67], v[200:203], v[76:79], v[64:67]
    v_mfma_f32_16x16x32_bf16 v[44:47], v[232:235], v[76:79], v[44:47]
    ds_read_b128 v[72:75], v11 offset:3136
    v_mfma_f32_16x16x32_bf16 v[64:67], v[160:163], v[168:171], v[64:67]
    ds_read2_b32 v[20:21], v4 offset0:16 offset1:17
    s_waitcnt lgkmcnt(4)
    v_mfma_f32_16x16x32_bf16 v[64:67], v[196:199], v[80:83], v[64:67]
    ds_read2_b32 v[22:23], v4 offset0:18 offset1:19
    v_mfma_f32_16x16x32_bf16 v[44:47], v[228:231], v[80:83], v[44:47]
    v_mfma_f32_16x16x32_bf16 v[64:67], v[164:167], v[172:175], v[64:67]
    ds_read_b128 v[76:79], v11 offset:3200
    v_mfma_f32_16x16x32_bf16 v[64:67], v[192:195], v[84:87], v[64:67]
    v_mfma_f32_16x16x32_bf16 v[44:47], v[224:227], v[84:87], v[44:47]
    ds_read_b128 v[80:83], v11 offset:3264
    v_mfma_f32_16x16x32_bf16 v[108:111], v[84:87], v[28:31], 0
    v_mfma_f32_16x16x32_bf16 v[112:115], v[84:87], v[32:35], 0
    v_mfma_f32_16x16x32_bf16 v[48:51], v[12:15], v[84:87], v[48:51]
    v_mfma_f32_16x16x32_bf16 v[116:119], v[84:87], v[36:39], 0
    ds_read_b128 v[84:87], v11 offset:3328
    s_waitcnt lgkmcnt(6)
    v_mfma_f32_16x16x32_bf16 v[120:123], v[132:135], v[32:35], 0
    ds_read_b128 v[132:135], v11 offset:3392
    ds_write_b128 v7, v[64:67] offset:15872
    v_mfma_f32_16x16x32_bf16 v[44:47], v[220:223], v[68:71], v[44:47]
    ds_read_b128 v[68:71], v11 offset:3456
    ds_write_b32 v88, v88 offset:80
    v_mfma_f32_16x16x32_bf16 v[44:47], v[100:103], v[40:43], v[44:47]
    v_mfma_f32_16x16x32_bf16 v[44:47], v[96:99], v[16:19], v[44:47]
    s_waitcnt lgkmcnt(7)
    v_mfma_f32_16x16x32_bf16 v[44:47], v[216:219], v[72:75], v[44:47]
    ds_read_b128 v[72:75], v11 offset:3520
    v_mfma_f32_16x16x32_bf16 v[44:47], v[92:95], v[20:23], v[44:47]
    v_mfma_f32_16x16x32_bf16 v[44:47], v[152:155], v[184:187], v[44:47]
    s_waitcnt lgkmcnt(6)
    v_cvt_pk_bf16_f32 v144, v120, v116
    v_mfma_f32_16x16x32_bf16 v[44:47], v[212:215], v[76:79], v[44:47]
    ds_read_b128 v[76:79], v11 offset:3584
    v_cvt_pk_bf16_f32 v145, v112, v108
    v_mfma_f32_16x16x32_bf16 v[44:47], v[156:159], v[188:191], v[44:47]
    v_cvt_pk_bf16_f32 v146, v121, v117
    v_mfma_f32_16x16x32_bf16 v[44:47], v[208:211], v[80:83], v[44:47]
    ds_read_b128 v[80:83], v11 offset:3072
    v_cvt_pk_bf16_f32 v147, v113, v109
    v_mfma_f32_16x16x32_bf16 v[44:47], v[160:163], v[176:179], v[44:47]
    s_waitcnt lgkmcnt(6)
    v_cvt_pk_bf16_f32 v148, v122, v118
    v_mfma_f32_16x16x32_bf16 v[44:47], v[204:207], v[84:87], v[44:47]
    ds_read_b128 v[84:87], v11 offset:3648
    v_cvt_pk_bf16_f32 v149, v114, v110
    v_mfma_f32_16x16x32_bf16 v[44:47], v[164:167], v[180:183], v[44:47]
    v_cvt_pk_bf16_f32 v150, v123, v119
    v_mfma_f32_16x16x32_bf16 v[44:47], v[200:203], v[132:135], v[44:47]
    ds_read_b128 v[132:135], v11 offset:3136
    v_cvt_pk_bf16_f32 v151, v115, v111
    v_mfma_f32_16x16x32_bf16 v[44:47], v[136:139], v[168:171], v[44:47]
    ds_read2_b32 v[24:25], v4 offset0:0 offset1:1
    s_waitcnt lgkmcnt(4)
    v_mfma_f32_16x16x32_bf16 v[44:47], v[196:199], v[68:71], v[44:47]
    ds_read2_b32 v[26:27], v4 offset0:2 offset1:3
    v_mfma_f32_16x16x32_bf16 v[44:47], v[140:143], v[172:175], v[44:47]
    ds_read_b128 v[68:71], v11 offset:3712
    v_mfma_f32_16x16x32_bf16 v[44:47], v[192:195], v[72:75], v[44:47]
    ds_read_b128 v[72:75], v11 offset:3200
    v_mfma_f32_16x16x32_bf16 v[48:51], v[220:223], v[76:79], v[48:51]
    ds_read_b128 v[76:79], v11 offset:3776
    s_waitcnt lgkmcnt(6)
    v_mfma_f32_16x16x32_bf16 v[48:51], v[252:255], v[80:83], v[48:51]
    ds_read_b128 v[80:83], v11 offset:3264
    v_mfma_f32_16x16x32_bf16 v[48:51], v[104:107], v[40:43], v[48:51]
    v_mfma_f32_16x16x32_bf16 v[48:51], v[100:103], v[16:19], v[48:51]
    v_mfma_f32_16x16x32_bf16 v[48:51], v[216:219], v[84:87], v[48:51]
    ds_read_b128 v[84:87], v11 offset:3840
    s_waitcnt lgkmcnt(5)
    v_mfma_f32_16x16x32_bf16 v[48:51], v[248:251], v[132:135], v[48:51]
    ds_read_b128 v[132:135], v11 offset:3328
    v_mfma_f32_16x16x32_bf16 v[48:51], v[96:99], v[20:23], v[48:51]
    v_mfma_f32_16x16x32_bf16 v[48:51], v[92:95], v[24:27], v[48:51]
    s_waitcnt lgkmcnt(4)
    ds_write_b128 v7, v[44:47] offset:17152
    v_mfma_f32_16x16x32_bf16 v[48:51], v[212:215], v[68:71], v[48:51]
    ds_read_b128 v[68:71], v11 offset:3904
    ds_write_b32 v88, v88 offset:96
    v_mfma_f32_16x16x32_bf16 v[48:51], v[244:247], v[72:75], v[48:51]
    ds_read_b128 v[72:75], v11 offset:3392
    v_mfma_f32_16x16x32_bf16 v[48:51], v[160:163], v[184:187], v[48:51]
    v_mfma_f32_16x16x32_bf16 v[48:51], v[164:167], v[188:191], v[48:51]
    s_waitcnt lgkmcnt(5)
    v_mfma_f32_16x16x32_bf16 v[48:51], v[208:211], v[76:79], v[48:51]
    ds_read_b128 v[76:79], v11 offset:3968
    v_mfma_f32_16x16x32_bf16 v[48:51], v[240:243], v[80:83], v[48:51]
    ds_read_b128 v[80:83], v11 offset:3456
    v_mfma_f32_16x16x32_bf16 v[48:51], v[136:139], v[176:179], v[48:51]
    v_mfma_f32_16x16x32_bf16 v[48:51], v[204:207], v[84:87], v[48:51]
    ds_read_b128 v[84:87], v11 offset:4032
    s_waitcnt lgkmcnt(3)
    v_mfma_f32_16x16x32_bf16 v[48:51], v[236:239], v[132:135], v[48:51]
    ds_read_b128 v[132:135], v11 offset:3520
    v_mfma_f32_16x16x32_bf16 v[48:51], v[140:143], v[180:183], v[48:51]
    v_mfma_f32_16x16x32_bf16 v[48:51], v[200:203], v[68:71], v[48:51]
    v_mfma_f32_16x16x32_bf16 v[48:51], v[232:235], v[72:75], v[48:51]
    v_mfma_f32_16x16x32_bf16 v[48:51], v[144:147], v[168:171], v[48:51]
    s_waitcnt lgkmcnt(1)
    v_mfma_f32_16x16x32_bf16 v[48:51], v[196:199], v[76:79], v[48:51]
    v_mfma_f32_16x16x32_bf16 v[48:51], v[228:231], v[80:83], v[48:51]
    v_mfma_f32_16x16x32_bf16 v[48:51], v[148:151], v[172:175], v[48:51]
    v_mfma_f32_16x16x32_bf16 v[48:51], v[192:195], v[84:87], v[48:51]
    s_waitcnt lgkmcnt(0)
    v_mfma_f32_16x16x32_bf16 v[48:51], v[224:227], v[132:135], v[48:51]
    s_nop 7
    ds_write_b128 v7, v[48:51] offset:18432
    ds_write_b32 v88, v88 offset:112
    s_cmp_lg_u32 s39, 0
    s_cbranch_scc1 L_mw_end
    s_mul_i32 s42, s50, 9344
    s_add_u32 s42, s42, 69632
    v_add_u32 v18, s42, v3
    v_add_u32 v20, 4096, v18
    v_and_b32 v21, 0x70, v3
    s_add_u32 s42, s42, 5120
    v_add_u32 v21, s42, v21
    s_mov_b32 s61, 131072
    v_lshl_add_u32 v24, v9, 1, s54
    v_mov_b32 v35, s45
    s_barrier
L_part_poll:
    global_load_dwordx4 v[164:167], v21, s[36:37] sc1
    global_load_dwordx4 v[128:131], v18, s[36:37] offset:-4096 sc1
    global_load_dwordx4 v[132:135], v18, s[36:37] offset:-3072 sc1
    global_load_dwordx4 v[136:139], v18, s[36:37] offset:-2048 sc1
    global_load_dwordx4 v[140:143], v18, s[36:37] offset:-1024 sc1
    global_load_dwordx4 v[144:147], v18, s[36:37] offset:0 sc1
    global_load_dwordx4 v[148:151], v18, s[36:37] offset:1024 sc1
    global_load_dwordx4 v[152:155], v18, s[36:37] offset:2048 sc1
    global_load_dwordx4 v[156:159], v18, s[36:37] offset:3072 sc1
    global_load_dwordx4 v[160:163], v20, s[36:37] offset:0 sc1
    v_mul_u32_u24 v26, 4640, v9
    v_add_u32 v26, 135648, v26
    v_mul_u32_u24 v27, 33792, v9
    v_mov_b32 v25, 1280
    s_waitcnt vmcnt(9)
    v_bfe_u32 v28, v164, 8, 11
    v_lshl_add_u32 v29, v28, 1, v26
    v_lshrrev_b32 v30, 8, v28
    v_mad_u32_u24 v27, v30, v25, v27
    v_bfe_u32 v30, v28, 2, 2
    v_mul_u32_u24 v30, 320, v30
    v_and_b32 v33, 0xf0, v28
    v_add3_u32 v27, v27, v30, v33
    v_and_b32 v33, 3, v28
    v_lshl_add_u32 v30, v33, 2, v27
    ds_read_b128 v[36:39], v88 offset:112
    ds_read_u16_d16_hi v31, v29
    ds_read_b32 v32, v30 offset:9472
    v_mul_u32_u24 v28, 1152, v28
    v_add_u32 v28, v28, v24
    v_xor_b32 v22, v35, v164
    s_waitcnt vmcnt(8)
    v_xor_b32 v128, v35, v128
    v_or_b32 v22, v22, v128
    s_waitcnt vmcnt(7)
    v_xor_b32 v132, v35, v132
    v_pk_add_f32 v[130:131], v[130:131], v[134:135]
    v_pk_add_f32 v[128:129], v[128:129], v[132:133]
    s_waitcnt vmcnt(6)
    v_xor_b32 v136, v35, v136
    v_pk_add_f32 v[130:131], v[130:131], v[138:139]
    v_pk_add_f32 v[128:129], v[128:129], v[136:137]
    v_bitop3_b32 v22, v22, v132, v136 bitop3:0xfe
    s_waitcnt vmcnt(5)
    v_xor_b32 v140, v35, v140
    v_pk_add_f32 v[130:131], v[130:131], v[142:143]
    v_pk_add_f32 v[128:129], v[128:129], v[140:141]
    s_waitcnt vmcnt(4)
    v_xor_b32 v144, v35, v144
    v_pk_add_f32 v[130:131], v[130:131], v[146:147]
    v_pk_add_f32 v[128:129], v[128:129], v[144:145]
    v_bitop3_b32 v22, v22, v140, v144 bitop3:0xfe
    s_waitcnt vmcnt(3)
    v_xor_b32 v148, v35, v148
    v_pk_add_f32 v[130:131], v[130:131], v[150:151]
    v_pk_add_f32 v[128:129], v[128:129], v[148:149]
    s_waitcnt vmcnt(2)
    v_xor_b32 v152, v35, v152
    v_pk_add_f32 v[130:131], v[130:131], v[154:155]
    v_pk_add_f32 v[128:129], v[128:129], v[152:153]
    v_bitop3_b32 v22, v22, v148, v152 bitop3:0xfe
    s_waitcnt vmcnt(1)
    v_xor_b32 v156, v35, v156
    v_pk_add_f32 v[130:131], v[130:131], v[158:159]
    v_pk_add_f32 v[128:129], v[128:129], v[156:157]
    s_waitcnt vmcnt(0)
    v_xor_b32 v160, v35, v160
    v_pk_add_f32 v[130:131], v[130:131], v[162:163]
    v_pk_add_f32 v[128:129], v[128:129], v[160:161]
    v_bitop3_b32 v22, v22, v156, v160 bitop3:0xfe
    s_waitcnt lgkmcnt(0)
    v_bitop3_b32 v36, v37, v38, v39 bitop3:0x7f
    v_and_b32 v36, 128, v36
    v_or_b32 v22, v22, v36
    v_and_b32 v22, 0xff, v22
    v_cmp_ne_u32 vcc, 0, v22
    v_permlane32_swap_b32 v128, v130
    s_sub_u32 s61, s61, 1
    s_cselect_b64 vcc, 0, vcc
    s_cbranch_vccnz L_part_poll
    v_permlane32_swap_b32 v129, v131
    v_add_f32 v128, v128, v130
    v_add_f32 v129, v129, v131
    v_and_b32 v31, 0xffff0000, v31
    v_fma_f32 v34, v31, v167, v166
    v_permlane16_swap_b32 v128, v129
    v_add_f32 v128, v128, v129
    v_mul_f32 v31, 0x42000000, v31
    v_mul_f32 v32, 0x3d000000, v32
    v_add_f32_dpp v128, v128, v128 row_ror:8 row_mask:0xf bank_mask:0xf
    v_fma_f32 v128, v128, v165, v31
    v_mul_f32 v33, 0xbfb8aa3b, v128
    v_exp_f32 v33, v33
    v_mul_f32 v128, v128, v32
    v_add_f32 v33, 1.0, v33
    v_rcp_f32 v33, v33
    s_nop 0
    v_fmac_f32 v34, v128, v33
    v_cvt_pk_bf16_f32 v34, v34, v34
    s_barrier
    global_store_short v28, v34, s[32:33]
L_mw_end:
    s_endpgm
L_helper:
    s_waitcnt lgkmcnt(0)
    s_barrier
    s_setprio 0
    s_lshr_b32 s42, s50, 1
    s_lshl_b32 s42, s42, 15
    s_and_b32 s43, s50, 1
    s_lshl_b32 s43, s43, 6
    s_add_u32 s42, s42, s43
    s_add_u32 s42, s42, 2101248
    s_add_u32 s12, s36, s42
    s_addc_u32 s13, s37, 0
    s_add_u32 s14, s12, 8192
    s_addc_u32 s15, s13, 0
    s_add_u32 s16, s12, 16384
    s_addc_u32 s17, s13, 0
    s_add_u32 s18, s12, 24576
    s_addc_u32 s19, s13, 0
    v_bfe_u32 v63, v0, 2, 6
    v_and_b32 v6, 0x30, v3
    v_lshl_add_u32 v6, v63, 7, v6
    global_load_dwordx4 v[40:43], v6, s[12:13] sc1
    global_load_dwordx4 v[44:47], v6, s[14:15] sc1
    global_load_dwordx4 v[48:51], v6, s[16:17] sc1
    global_load_dwordx4 v[52:55], v6, s[18:19] sc1
    v_and_b32 v62, 255, v0
    v_lshlrev_b32 v4, 4, v62
    v_add_u32 v4, 20480, v4
    v_add_u32 v7, 8192, v4
    s_bfe_u32 s43, s46, 131072
    s_mul_i32 s43, s43, 0x20004000
    s_and_b32 s43, s43, 0x40004000
    v_mov_b32 v56, s43
    s_bfe_u32 s43, s46, 131074
    s_mul_i32 s43, s43, 0x20004000
    s_and_b32 s43, s43, 0x40004000
    v_mov_b32 v57, s43
    s_bfe_u32 s43, s46, 131076
    s_mul_i32 s43, s43, 0x20004000
    s_and_b32 s43, s43, 0x40004000
    v_mov_b32 v58, s43
    s_bfe_u32 s43, s46, 131078
    s_mul_i32 s43, s43, 0x20004000
    s_and_b32 s43, s43, 0x40004000
    v_mov_b32 v59, s43
    v_and_b32 v88, 3, v0
    v_mul_u32_u24 v5, 4640, v88
    v_lshl_add_u32 v5, v63, 4, v5
    v_add_u32 v5, 135648, v5
    v_mov_b32 v63, 0x40004000
    s_lshr_b32 s43, s51, 1
    s_lshl_b32 s43, s43, 4
    s_add_u32 s43, s43, 153728
    v_lshl_add_u32 v88, v88, 2, s43
    s_mov_b32 s61, 131072
    v_lshlrev_b32 v37, 2, v62
    v_add_u32 v64, 135648, v37
    v_add_u32 v65, 140288, v37
    v_add_u32 v66, 144928, v37
    v_add_u32 v67, 149568, v37
    v_bfe_u32 v37, v0, 1, 2
    v_mul_u32_u24 v37, 320, v37
    v_and_b32 v39, 0x78, v0
    v_lshl_add_u32 v37, v39, 1, v37
    v_and_b32 v39, 1, v0
    v_lshl_add_u32 v37, v39, 3, v37
    s_lshr_b32 s43, s51, 1
    s_mul_i32 s43, s43, 1280
    s_add_u32 s43, s43, 9472
    v_add_u32 v37, s43, v37
    v_add_u32 v39, 67584, v37
    v_mul_u32_u24 v36, 2304, v62
    v_add_u32 v36, s54, v36
    v_mov_b32 v8, 0xc238aa3b
    v_mov_b32 v9, 0xffff0000
    v_lshlrev_b32 v62, 6, v62
    v_xor_b32 v62, s44, v62
    v_and_b32 v10, 15, v0
    v_lshrrev_b32 v11, 1, v0
    v_and_b32 v11, 24, v11
    s_lshl_b32 s42, s51, 4
    s_mov_b32 s58, 939536384
    s_mov_b32 s59, 3672000
    s_lshr_b64 s[58:59], s[58:59], s42
    s_and_b32 s58, s58, 0xffff
    s_lshr_b32 s59, 535826400, s42
    s_and_b32 s59, s59, 0xffff
    s_lshl_b32 s42, s51, 10
    s_add_u32 s42, s42, 154048
    v_add_u32 v12, s42, v3
    v_lshlrev_b32 v13, v10, s58
    v_bfe_u32 v13, v13, v11, 8
    v_lshl_or_b32 v13, v13, 15, v13
    v_and_b32 v16, 65537, v13
    v_mul_u32_u24 v16, 16256, v16
    v_and_b32 v17, 262148, v13
    v_mul_u32_u24 v17, 4064, v17
    v_and_b32 v18, 1048592, v13
    v_mul_u32_u24 v18, 1016, v18
    v_and_b32 v19, 4194368, v13
    v_mul_u32_u24 v19, 254, v19
    ds_write_b128 v12, v[16:19] offset:0
    v_lshlrev_b32 v13, v10, s59
    v_bfe_u32 v13, v13, v11, 8
    v_lshl_or_b32 v13, v13, 15, v13
    v_and_b32 v20, 65537, v13
    v_mul_u32_u24 v20, 16256, v20
    v_and_b32 v21, 262148, v13
    v_mul_u32_u24 v21, 4064, v21
    v_and_b32 v22, 1048592, v13
    v_mul_u32_u24 v22, 1016, v22
    v_and_b32 v23, 4194368, v13
    v_mul_u32_u24 v23, 254, v23
    ds_write_b128 v12, v[20:23] offset:4096
    s_setprio 3
    s_cmp_eq_u32 s47, 2
    s_cbranch_scc0 L_ct4
    v_add_u32 v76, 3244032, v76
    global_load_dword v1, v76, s[56:57]
    s_branch L_ct5
L_ct4:
    global_load_dword v1, v11, s[24:25]
L_ct5:
    s_waitcnt vmcnt(4)
    v_xor_b32 v40, v56, v40
    v_xor_b32 v41, v57, v41
    v_xor_b32 v42, v58, v42
    v_xor_b32 v43, v59, v43
    ds_write_b128 v5, v[40:43] offset:0
    s_waitcnt vmcnt(3)
    v_xor_b32 v44, v56, v44
    v_xor_b32 v45, v57, v45
    v_xor_b32 v46, v58, v46
    v_xor_b32 v47, v59, v47
    ds_write_b128 v5, v[44:47] offset:1024
    s_waitcnt vmcnt(2)
    v_xor_b32 v48, v56, v48
    v_xor_b32 v49, v57, v49
    v_xor_b32 v50, v58, v50
    v_xor_b32 v51, v59, v51
    ds_write_b128 v5, v[48:51] offset:2048
    s_waitcnt vmcnt(1)
    v_xor_b32 v52, v56, v52
    v_xor_b32 v53, v57, v53
    v_xor_b32 v54, v58, v54
    v_xor_b32 v55, v59, v55
    ds_write_b128 v5, v[52:55] offset:3072
    global_load_dwordx4 v[224:227], v4, s[36:37] offset:-4096 sc1
    global_load_dwordx4 v[228:231], v4, s[36:37] offset:0 sc1
    global_load_dwordx4 v[232:235], v7, s[36:37] offset:-4096 sc1
    global_load_dwordx4 v[236:239], v7, s[36:37] offset:0 sc1
    s_branch L_tile_or
L_tile_chk:
    v_xor_b32 v40, v56, v40
    v_xor_b32 v41, v57, v41
    v_xor_b32 v42, v58, v42
    v_xor_b32 v43, v59, v43
    ds_write_b128 v5, v[40:43] offset:0
    v_xor_b32 v44, v56, v44
    v_xor_b32 v45, v57, v45
    v_xor_b32 v46, v58, v46
    v_xor_b32 v47, v59, v47
    ds_write_b128 v5, v[44:47] offset:1024
    v_xor_b32 v48, v56, v48
    v_xor_b32 v49, v57, v49
    v_xor_b32 v50, v58, v50
    v_xor_b32 v51, v59, v51
    ds_write_b128 v5, v[48:51] offset:2048
    v_xor_b32 v52, v56, v52
    v_xor_b32 v53, v57, v53
    v_xor_b32 v54, v58, v54
    v_xor_b32 v55, v59, v55
    ds_write_b128 v5, v[52:55] offset:3072
L_tile_or:
    v_bitop3_b32 v38, v40, v41, v42 bitop3:0xfe
    v_bitop3_b32 v38, v38, v43, v44 bitop3:0xfe
    v_bitop3_b32 v38, v38, v45, v46 bitop3:0xfe
    v_bitop3_b32 v38, v38, v47, v48 bitop3:0xfe
    v_bitop3_b32 v38, v38, v49, v50 bitop3:0xfe
    v_bitop3_b32 v38, v38, v51, v52 bitop3:0xfe
    v_bitop3_b32 v38, v38, v53, v54 bitop3:0xfe
    v_bitop3_b32 v38, v38, v55, v63 bitop3:0xa8
    v_cmp_ne_u32 vcc, 0, v38
    s_cbranch_vccz L_tile_ok
    global_load_dwordx4 v[40:43], v6, s[12:13] sc1
    global_load_dwordx4 v[44:47], v6, s[14:15] sc1
    global_load_dwordx4 v[48:51], v6, s[16:17] sc1
    global_load_dwordx4 v[52:55], v6, s[18:19] sc1
    s_waitcnt vmcnt(0)
    s_sub_u32 s61, s61, 1
    s_cbranch_scc0 L_tile_chk
L_tile_ok:
    s_mov_b32 s61, 2097152
    s_setprio 3
    s_waitcnt lgkmcnt(0)
    s_barrier
    ds_read2st64_b32 v[16:17], v64 offset0:0 offset1:4
    ds_read2st64_b32 v[18:19], v65 offset0:0 offset1:4
    ds_read2st64_b32 v[20:21], v66 offset0:0 offset1:4
    ds_read2st64_b32 v[22:23], v67 offset0:0 offset1:4
    ds_read2st64_b32 v[24:25], v64 offset0:8 offset1:12
    ds_read2st64_b32 v[26:27], v65 offset0:8 offset1:12
    ds_read2st64_b32 v[28:29], v66 offset0:8 offset1:12
    ds_read2st64_b32 v[30:31], v67 offset0:8 offset1:12
    s_setprio 0
    s_waitcnt lgkmcnt(4)
    v_lshlrev_b32 v96, 16, v16
    v_lshlrev_b32 v97, 16, v18
    v_lshlrev_b32 v98, 16, v20
    v_lshlrev_b32 v99, 16, v22
    v_mul_f32 v104, v8, v96
    v_mul_f32 v105, v8, v97
    v_mul_f32 v106, v8, v98
    v_mul_f32 v107, v8, v99
    v_exp_f32 v104, v104
    v_exp_f32 v105, v105
    v_exp_f32 v106, v106
    v_exp_f32 v107, v107
    v_add_f32 v104, 1.0, v104
    v_add_f32 v105, 1.0, v105
    v_add_f32 v106, 1.0, v106
    v_add_f32 v107, 1.0, v107
    v_rcp_f32 v104, v104
    v_rcp_f32 v105, v105
    v_rcp_f32 v106, v106
    v_rcp_f32 v107, v107
    v_and_b32 v100, v9, v16
    v_and_b32 v101, v9, v18
    v_and_b32 v102, v9, v20
    v_and_b32 v103, v9, v22
    v_mul_f32 v108, v8, v100
    v_mul_f32 v109, v8, v101
    v_mul_f32 v110, v8, v102
    v_mul_f32 v111, v8, v103
    v_exp_f32 v108, v108
    v_exp_f32 v109, v109
    v_exp_f32 v110, v110
    v_exp_f32 v111, v111
    v_add_f32 v108, 1.0, v108
    v_add_f32 v109, 1.0, v109
    v_add_f32 v110, 1.0, v110
    v_add_f32 v111, 1.0, v111
    v_rcp_f32 v108, v108
    v_rcp_f32 v109, v109
    v_rcp_f32 v110, v110
    v_rcp_f32 v111, v111
    s_setprio 2
    ds_read_b32 v41, v88 offset:0
    ds_read_b64 v[44:45], v37 offset:0
    ds_read_b64 v[46:47], v37 offset:33792
    ds_read_b64 v[48:49], v39 offset:0
    ds_read_b64 v[50:51], v39 offset:33792
    s_setprio 0
    s_waitcnt vmcnt(0)
L_h_poll:
    v_mov_b32 v38, 0
    v_xor_b32 v13, 65504, v225
    v_bitop3_b32 v38, v38, v13, v62 bitop3:0xf6
    v_xor_b32 v13, 65472, v227
    v_bitop3_b32 v38, v38, v13, v62 bitop3:0xf6
    v_xor_b32 v13, 49120, v229
    v_bitop3_b32 v38, v38, v13, v62 bitop3:0xf6
    v_xor_b32 v13, 49088, v231
    v_bitop3_b32 v38, v38, v13, v62 bitop3:0xf6
    v_xor_b32 v13, 32736, v233
    v_bitop3_b32 v38, v38, v13, v62 bitop3:0xf6
    v_xor_b32 v13, 32704, v235
    v_bitop3_b32 v38, v38, v13, v62 bitop3:0xf6
    v_xor_b32 v13, 16352, v237
    v_bitop3_b32 v38, v38, v13, v62 bitop3:0xf6
    v_xor_b32 v13, 16320, v239
    v_bitop3_b32 v38, v38, v13, v62 bitop3:0xf6
    v_and_b32 v38, 0xffff, v38
    v_cmp_ne_u32 vcc, 0, v38
    s_cbranch_vccz L_h_ok
    global_load_dwordx4 v[224:227], v4, s[36:37] offset:-4096 sc1
    global_load_dwordx4 v[228:231], v4, s[36:37] offset:0 sc1
    global_load_dwordx4 v[232:235], v7, s[36:37] offset:-4096 sc1
    global_load_dwordx4 v[236:239], v7, s[36:37] offset:0 sc1
    s_waitcnt vmcnt(0)
    s_sub_u32 s61, s61, 16
    s_cbranch_scc0 L_h_poll
L_h_ok:
    v_and_b32 v121, v9, v224
    v_lshlrev_b32 v120, 16, v224
    v_and_b32 v123, v9, v226
    v_lshlrev_b32 v122, 16, v226
    s_waitcnt lgkmcnt(0)
    v_cmp_eq_u32 vcc, 0, v41
    s_cbranch_vccz L_w0_go
    s_setprio 2
L_w0:
    ds_read_b32 v41, v88 offset:0
    s_waitcnt lgkmcnt(0)
    v_cmp_eq_u32 vcc, 0, v41
    s_cbranch_vccz L_w0_ok
    s_sleep 2
    s_sub_u32 s61, s61, 1
    s_cbranch_scc0 L_w0
L_w0_ok:
    ds_read_b64 v[44:45], v37 offset:0
    ds_read_b64 v[46:47], v37 offset:33792
    ds_read_b64 v[48:49], v39 offset:0
    ds_read_b64 v[50:51], v39 offset:33792
    s_setprio 0
    s_waitcnt lgkmcnt(0)
L_w0_go:
    v_fma_f32 v112, v44, v104, v121
    v_fma_f32 v113, v46, v105, v121
    v_fma_f32 v114, v48, v106, v121
    v_fma_f32 v115, v50, v107, v121
    v_fma_f32 v96, v96, v112, v120
    v_fma_f32 v97, v97, v113, v120
    v_fma_f32 v98, v98, v114, v120
    v_fma_f32 v99, v99, v115, v120
    v_cvt_pk_bf16_f32 v104, v96, v97
    v_cvt_pk_bf16_f32 v105, v98, v99
    global_store_dwordx2 v36, v[104:105], s[32:33] offset:0
    v_fma_f32 v116, v45, v108, v123
    v_fma_f32 v117, v47, v109, v123
    v_fma_f32 v118, v49, v110, v123
    v_fma_f32 v119, v51, v111, v123
    v_fma_f32 v100, v100, v116, v122
    v_fma_f32 v101, v101, v117, v122
    v_fma_f32 v102, v102, v118, v122
    v_fma_f32 v103, v103, v119, v122
    v_cvt_pk_bf16_f32 v108, v100, v101
    v_cvt_pk_bf16_f32 v109, v102, v103
    global_store_dwordx2 v36, v[108:109], s[32:33] offset:1152
    v_add_u32 v36, 589824, v36
    v_lshlrev_b32 v128, 16, v17
    v_lshlrev_b32 v129, 16, v19
    v_lshlrev_b32 v130, 16, v21
    v_lshlrev_b32 v131, 16, v23
    v_mul_f32 v136, v8, v128
    v_mul_f32 v137, v8, v129
    v_mul_f32 v138, v8, v130
    v_mul_f32 v139, v8, v131
    v_exp_f32 v136, v136
    v_exp_f32 v137, v137
    v_exp_f32 v138, v138
    v_exp_f32 v139, v139
    v_and_b32 v153, v9, v228
    v_add_f32 v136, 1.0, v136
    v_add_f32 v137, 1.0, v137
    v_add_f32 v138, 1.0, v138
    v_add_f32 v139, 1.0, v139
    v_rcp_f32 v136, v136
    v_rcp_f32 v137, v137
    v_rcp_f32 v138, v138
    v_rcp_f32 v139, v139
    v_lshlrev_b32 v152, 16, v228
    s_setprio 2
    ds_read_b32 v41, v88 offset:32
    ds_read_b64 v[44:45], v37 offset:2560
    ds_read_b64 v[46:47], v37 offset:36352
    ds_read_b64 v[48:49], v39 offset:2560
    ds_read_b64 v[50:51], v39 offset:36352
    s_setprio 0
    v_and_b32 v132, v9, v17
    v_and_b32 v133, v9, v19
    v_and_b32 v134, v9, v21
    v_and_b32 v135, v9, v23
    v_mul_f32 v140, v8, v132
    v_mul_f32 v141, v8, v133
    v_mul_f32 v142, v8, v134
    v_mul_f32 v143, v8, v135
    v_exp_f32 v140, v140
    v_exp_f32 v141, v141
    v_exp_f32 v142, v142
    v_exp_f32 v143, v143
    v_and_b32 v155, v9, v230
    v_add_f32 v140, 1.0, v140
    v_add_f32 v141, 1.0, v141
    v_add_f32 v142, 1.0, v142
    v_add_f32 v143, 1.0, v143
    v_rcp_f32 v140, v140
    v_rcp_f32 v141, v141
    v_rcp_f32 v142, v142
    v_rcp_f32 v143, v143
    v_lshlrev_b32 v154, 16, v230
    s_waitcnt lgkmcnt(0)
    v_cmp_eq_u32 vcc, 0, v41
    s_cbranch_vccz L_w1_go
    s_setprio 2
L_w1:
    ds_read_b32 v41, v88 offset:32
    s_waitcnt lgkmcnt(0)
    v_cmp_eq_u32 vcc, 0, v41
    s_cbranch_vccz L_w1_ok
    s_sleep 2
    s_sub_u32 s61, s61, 1
    s_cbranch_scc0 L_w1
L_w1_ok:
    ds_read_b64 v[44:45], v37 offset:2560
    ds_read_b64 v[46:47], v37 offset:36352
    ds_read_b64 v[48:49], v39 offset:2560
    ds_read_b64 v[50:51], v39 offset:36352
    s_setprio 0
    s_waitcnt lgkmcnt(0)
L_w1_go:
    v_fma_f32 v144, v44, v136, v153
    v_fma_f32 v145, v46, v137, v153
    v_fma_f32 v146, v48, v138, v153
    v_fma_f32 v147, v50, v139, v153
    v_fma_f32 v128, v128, v144, v152
    v_fma_f32 v129, v129, v145, v152
    v_fma_f32 v130, v130, v146, v152
    v_fma_f32 v131, v131, v147, v152
    v_cvt_pk_bf16_f32 v136, v128, v129
    v_cvt_pk_bf16_f32 v137, v130, v131
    global_store_dwordx2 v36, v[136:137], s[32:33] offset:0
    v_fma_f32 v148, v45, v140, v155
    v_fma_f32 v149, v47, v141, v155
    v_fma_f32 v150, v49, v142, v155
    v_fma_f32 v151, v51, v143, v155
    v_fma_f32 v132, v132, v148, v154
    v_fma_f32 v133, v133, v149, v154
    v_fma_f32 v134, v134, v150, v154
    v_fma_f32 v135, v135, v151, v154
    v_cvt_pk_bf16_f32 v140, v132, v133
    v_cvt_pk_bf16_f32 v141, v134, v135
    global_store_dwordx2 v36, v[140:141], s[32:33] offset:1152
    v_add_u32 v36, 589824, v36
    v_lshlrev_b32 v160, 16, v24
    v_lshlrev_b32 v161, 16, v26
    v_lshlrev_b32 v162, 16, v28
    v_lshlrev_b32 v163, 16, v30
    v_mul_f32 v168, v8, v160
    v_mul_f32 v169, v8, v161
    v_mul_f32 v170, v8, v162
    v_mul_f32 v171, v8, v163
    v_exp_f32 v168, v168
    v_exp_f32 v169, v169
    v_exp_f32 v170, v170
    v_exp_f32 v171, v171
    v_and_b32 v185, v9, v232
    v_add_f32 v168, 1.0, v168
    v_add_f32 v169, 1.0, v169
    v_add_f32 v170, 1.0, v170
    v_add_f32 v171, 1.0, v171
    v_rcp_f32 v168, v168
    v_rcp_f32 v169, v169
    v_rcp_f32 v170, v170
    v_rcp_f32 v171, v171
    v_lshlrev_b32 v184, 16, v232
    s_setprio 2
    ds_read_b32 v41, v88 offset:64
    ds_read_b64 v[44:45], v37 offset:5120
    ds_read_b64 v[46:47], v37 offset:38912
    ds_read_b64 v[48:49], v39 offset:5120
    ds_read_b64 v[50:51], v39 offset:38912
    s_setprio 0
    v_and_b32 v164, v9, v24
    v_and_b32 v165, v9, v26
    v_and_b32 v166, v9, v28
    v_and_b32 v167, v9, v30
    v_mul_f32 v172, v8, v164
    v_mul_f32 v173, v8, v165
    v_mul_f32 v174, v8, v166
    v_mul_f32 v175, v8, v167
    v_exp_f32 v172, v172
    v_exp_f32 v173, v173
    v_exp_f32 v174, v174
    v_exp_f32 v175, v175
    v_and_b32 v187, v9, v234
    v_add_f32 v172, 1.0, v172
    v_add_f32 v173, 1.0, v173
    v_add_f32 v174, 1.0, v174
    v_add_f32 v175, 1.0, v175
    v_rcp_f32 v172, v172
    v_rcp_f32 v173, v173
    v_rcp_f32 v174, v174
    v_rcp_f32 v175, v175
    v_lshlrev_b32 v186, 16, v234
    s_waitcnt lgkmcnt(0)
    v_cmp_eq_u32 vcc, 0, v41
    s_cbranch_vccz L_w2_go
    s_setprio 2
L_w2:
    ds_read_b32 v41, v88 offset:64
    s_waitcnt lgkmcnt(0)
    v_cmp_eq_u32 vcc, 0, v41
    s_cbranch_vccz L_w2_ok
    s_sleep 2
    s_sub_u32 s61, s61, 1
    s_cbranch_scc0 L_w2
L_w2_ok:
    ds_read_b64 v[44:45], v37 offset:5120
    ds_read_b64 v[46:47], v37 offset:38912
    ds_read_b64 v[48:49], v39 offset:5120
    ds_read_b64 v[50:51], v39 offset:38912
    s_setprio 0
    s_waitcnt lgkmcnt(0)
L_w2_go:
    v_fma_f32 v176, v44, v168, v185
    v_fma_f32 v177, v46, v169, v185
    v_fma_f32 v178, v48, v170, v185
    v_fma_f32 v179, v50, v171, v185
    v_fma_f32 v160, v160, v176, v184
    v_fma_f32 v161, v161, v177, v184
    v_fma_f32 v162, v162, v178, v184
    v_fma_f32 v163, v163, v179, v184
    v_cvt_pk_bf16_f32 v168, v160, v161
    v_cvt_pk_bf16_f32 v169, v162, v163
    global_store_dwordx2 v36, v[168:169], s[32:33] offset:0
    v_fma_f32 v180, v45, v172, v187
    v_fma_f32 v181, v47, v173, v187
    v_fma_f32 v182, v49, v174, v187
    v_fma_f32 v183, v51, v175, v187
    v_fma_f32 v164, v164, v180, v186
    v_fma_f32 v165, v165, v181, v186
    v_fma_f32 v166, v166, v182, v186
    v_fma_f32 v167, v167, v183, v186
    v_cvt_pk_bf16_f32 v172, v164, v165
    v_cvt_pk_bf16_f32 v173, v166, v167
    global_store_dwordx2 v36, v[172:173], s[32:33] offset:1152
    v_add_u32 v36, 589824, v36
    v_lshlrev_b32 v192, 16, v25
    v_lshlrev_b32 v193, 16, v27
    v_lshlrev_b32 v194, 16, v29
    v_lshlrev_b32 v195, 16, v31
    v_mul_f32 v200, v8, v192
    v_mul_f32 v201, v8, v193
    v_mul_f32 v202, v8, v194
    v_mul_f32 v203, v8, v195
    v_exp_f32 v200, v200
    v_exp_f32 v201, v201
    v_exp_f32 v202, v202
    v_exp_f32 v203, v203
    v_and_b32 v217, v9, v236
    v_add_f32 v200, 1.0, v200
    v_add_f32 v201, 1.0, v201
    v_add_f32 v202, 1.0, v202
    v_add_f32 v203, 1.0, v203
    v_rcp_f32 v200, v200
    v_rcp_f32 v201, v201
    v_rcp_f32 v202, v202
    v_rcp_f32 v203, v203
    v_lshlrev_b32 v216, 16, v236
    s_setprio 2
    ds_read_b32 v41, v88 offset:96
    ds_read_b64 v[44:45], v37 offset:7680
    ds_read_b64 v[46:47], v37 offset:41472
    ds_read_b64 v[48:49], v39 offset:7680
    ds_read_b64 v[50:51], v39 offset:41472
    s_setprio 0
    v_and_b32 v196, v9, v25
    v_and_b32 v197, v9, v27
    v_and_b32 v198, v9, v29
    v_and_b32 v199, v9, v31
    v_mul_f32 v204, v8, v196
    v_mul_f32 v205, v8, v197
    v_mul_f32 v206, v8, v198
    v_mul_f32 v207, v8, v199
    v_exp_f32 v204, v204
    v_exp_f32 v205, v205
    v_exp_f32 v206, v206
    v_exp_f32 v207, v207
    v_and_b32 v219, v9, v238
    v_add_f32 v204, 1.0, v204
    v_add_f32 v205, 1.0, v205
    v_add_f32 v206, 1.0, v206
    v_add_f32 v207, 1.0, v207
    v_rcp_f32 v204, v204
    v_rcp_f32 v205, v205
    v_rcp_f32 v206, v206
    v_rcp_f32 v207, v207
    v_lshlrev_b32 v218, 16, v238
    s_waitcnt lgkmcnt(0)
    v_cmp_eq_u32 vcc, 0, v41
    s_cbranch_vccz L_w3_go
    s_setprio 2
L_w3:
    ds_read_b32 v41, v88 offset:96
    ds_read_b64 v[44:45], v37 offset:7680
    ds_read_b64 v[46:47], v37 offset:41472
    ds_read_b64 v[48:49], v39 offset:7680
    ds_read_b64 v[50:51], v39 offset:41472
    s_waitcnt lgkmcnt(0)
    v_cmp_eq_u32 vcc, 0, v41
    s_cbranch_vccz L_w3_ok
    s_sleep 1
    s_sub_u32 s61, s61, 1
    s_cbranch_scc0 L_w3
L_w3_ok:
L_w3_go:
    v_fma_f32 v208, v44, v200, v217
    v_fma_f32 v209, v46, v201, v217
    v_fma_f32 v210, v48, v202, v217
    v_fma_f32 v211, v50, v203, v217
    v_fma_f32 v192, v192, v208, v216
    v_fma_f32 v193, v193, v209, v216
    v_fma_f32 v194, v194, v210, v216
    v_fma_f32 v195, v195, v211, v216
    v_cvt_pk_bf16_f32 v200, v192, v193
    v_cvt_pk_bf16_f32 v201, v194, v195
    global_store_dwordx2 v36, v[200:201], s[32:33] offset:0
    v_fma_f32 v212, v45, v204, v219
    v_fma_f32 v213, v47, v205, v219
    v_fma_f32 v214, v49, v206, v219
    v_fma_f32 v215, v51, v207, v219
    v_fma_f32 v196, v196, v212, v218
    v_fma_f32 v197, v197, v213, v218
    v_fma_f32 v198, v198, v214, v218
    v_fma_f32 v199, v199, v215, v218
    v_cvt_pk_bf16_f32 v204, v196, v197
    v_cvt_pk_bf16_f32 v205, v198, v199
    global_store_dwordx2 v36, v[204:205], s[32:33] offset:1152
    s_waitcnt vmcnt(63)
    s_barrier
    s_waitcnt vmcnt(0)
    s_barrier
    s_endpgm
L_lnp:
    s_mul_i32 s43, s39, 1216
    s_add_u32 s43, s43, 154048
    v_add_u32 v52, s43, v3
    v_add_u32 v53, s43, v4
    s_lshl_b32 s43, s39, 3
    s_add_u32 s43, s43, 163776
    v_mov_b32 v54, s43
    v_bfe_u32 v55, v0, 2, 2
    v_mul_u32_u24 v55, 1216, v55
    v_and_b32 v56, 3, v0
    v_lshl_add_u32 v55, v56, 3, v55
    v_lshrrev_b32 v56, 4, v0
    v_lshl_add_u32 v55, v56, 5, v55
    v_add_u32 v55, 154048, v55
    v_lshrrev_b32 v56, 3, v0
    v_lshlrev_b32 v56, 15, v56
    v_and_b32 v57, 112, v3
    s_lshl_b32 s43, s2, 7
    s_add_u32 s43, s43, 2101248
    v_add3_u32 v56, v56, v57, s43
    v_mov_b32 v40, 0
    v_mov_b32 v41, 0
    v_mov_b32 v42, 0
    v_mov_b32 v43, 0
    v_mov_b32 v44, 0x3ae38e39
    v_mov_b32 v38, 0xbfffbfff
    v_mov_b32 v37, 0xffff
    s_lshl_b32 s58, s2, 3
    s_add_u32 s58, s58, s39
    s_xor_b32 s58, s58, 0x7ff
    s_lshl_b32 s58, s58, 5
    s_waitcnt lgkmcnt(0)
    s_add_u32 s38, s38, 0x9e370001
    s_lshr_b32 s44, s38, 16
    s_and_b32 s45, s38, 0xff
    s_and_b32 s46, s38, 0xfb
    s_bitcmp0_b32 s38, 0
    s_cselect_b32 s43, 4, 0
    s_or_b32 s46, s46, s43
    s_bitcmp1_b32 s46, s39
    s_cselect_b32 s43, 0x40004000, 0
    v_mov_b32 v39, s43
    s_xor_b32 s58, s58, s44
    v_mov_b32 v57, s58
    s_mov_b32 s42, 0x3f803f80
    s_cmp_lt_u32 s41, 27
    s_cbranch_scc1 L_lw2
    s_cmp_lt_u32 s39, 2
    s_cbranch_scc0 L_lw1
    global_load_dword v1, v76, s[56:57]
    s_waitcnt vmcnt(1)
    s_branch L_ln
L_lw1:
    s_waitcnt vmcnt(0)
    s_branch L_ln
L_lw2:
    s_add_u32 m0, s49, 0
    s_nop 0
    global_load_lds_dwordx4 v76, s[56:57]
    v_add_u32 v76, 294912, v76
    s_add_u32 m0, s49, 4096
    s_nop 0
    global_load_lds_dwordx4 v76, s[56:57]
    v_add_u32 v76, 294912, v76
    s_add_u32 m0, s49, 8192
    s_nop 0
    global_load_lds_dwordx4 v76, s[56:57]
    v_add_u32 v76, 294912, v76
    s_waitcnt vmcnt(3)
L_ln:
    v_dot2c_f32_bf16 v40, s42, v12
    v_dot2c_f32_bf16 v41, v12, v12
    v_dot2c_f32_bf16 v42, v12, v20
    v_dot2c_f32_bf16 v43, s42, v20
    v_dot2c_f32_bf16 v40, s42, v13
    v_dot2c_f32_bf16 v41, v13, v13
    v_dot2c_f32_bf16 v42, v13, v21
    v_dot2c_f32_bf16 v43, s42, v21
    v_dot2c_f32_bf16 v40, s42, v14
    v_dot2c_f32_bf16 v41, v14, v14
    v_dot2c_f32_bf16 v42, v14, v22
    v_dot2c_f32_bf16 v43, s42, v22
    v_dot2c_f32_bf16 v40, s42, v15
    v_dot2c_f32_bf16 v41, v15, v15
    v_dot2c_f32_bf16 v42, v15, v23
    v_dot2c_f32_bf16 v43, s42, v23
    v_dot2c_f32_bf16 v40, s42, v16
    v_dot2c_f32_bf16 v41, v16, v16
    v_dot2c_f32_bf16 v42, v16, v24
    v_dot2c_f32_bf16 v43, s42, v24
    v_lshlrev_b32 v36, 16, v16
    v_lshlrev_b32 v28, 16, v12
    v_and_b32 v29, 0xffff0000, v12
    v_permlane32_swap_b32 v40, v42
    v_permlane32_swap_b32 v41, v43
    v_add_f32 v40, v40, v42
    v_add_f32 v41, v41, v43
    v_lshlrev_b32 v30, 16, v13
    v_and_b32 v31, 0xffff0000, v13
    v_permlane16_swap_b32 v40, v41
    v_add_f32 v40, v40, v41
    v_lshlrev_b32 v32, 16, v14
    v_and_b32 v33, 0xffff0000, v14
    v_add_f32_dpp v40, v40, v40 row_ror:8 row_mask:0xf bank_mask:0xf
    v_lshlrev_b32 v34, 16, v15
    v_and_b32 v35, 0xffff0000, v15
    v_add_f32_dpp v40, v40, v40 row_ror:4 row_mask:0xf bank_mask:0xf
    s_nop 1
    v_add_f32_dpp v40, v40, v40 row_ror:2 row_mask:0xf bank_mask:0xf
    s_nop 1
    v_add_f32_dpp v40, v40, v40 row_ror:1 row_mask:0xf bank_mask:0xf
    s_nop 0
    v_readlane_b32 s58, v40, 0
    v_readlane_b32 s59, v40, 16
    v_readlane_b32 s60, v40, 32
    v_readlane_b32 s61, v40, 48
    v_mul_f32 v40, s58, v44
    v_mul_f32 v41, s59, v44
    v_fma_f32 v41, -v40, v40, v41
    v_max_f32 v41, 0, v41
    v_cvt_pk_bf16_f32 v44, v41, v40
    v_lshlrev_b32 v41, 16, v44
    v_add_f32 v41, 0x3727c5ac, v41
    v_cvt_pk_bf16_f32 v41, v41, v41
    v_and_b32 v41, 0xffff0000, v41
    v_mul_f32 v41, 0x44800000, v41
    v_sqrt_f32 v41, v41
    v_and_b32 v49, 0xffff0000, v44
    v_cvt_pk_bf16_f32 v50, v49, v41
    v_and_b32 v41, 0xffff0000, v50
    v_rcp_f32 v46, v41
    v_mul_f32 v42, s61, v49
    v_mul_f32 v47, v49, v46
    v_fma_f32 v28, v28, v46, -v47
    v_fma_f32 v29, v29, v46, -v47
    v_fma_f32 v30, v30, v46, -v47
    v_fma_f32 v31, v31, v46, -v47
    v_fma_f32 v32, v32, v46, -v47
    v_fma_f32 v33, v33, v46, -v47
    v_fma_f32 v34, v34, v46, -v47
    v_fma_f32 v35, v35, v46, -v47
    v_fma_f32 v36, v36, v46, -v47
    v_cvt_pk_bf16_f32 v28, v28, v29
    v_cvt_pk_bf16_f32 v29, v30, v31
    v_cvt_pk_bf16_f32 v30, v32, v33
    v_cvt_pk_bf16_f32 v31, v34, v35
    v_cvt_pk_bf16_f32 v32, v36, v36
    v_bitop3_b32 v28, v28, v38, v39 bitop3:0xea
    v_bitop3_b32 v29, v29, v38, v39 bitop3:0xea
    v_bitop3_b32 v30, v30, v38, v39 bitop3:0xea
    v_bitop3_b32 v31, v31, v38, v39 bitop3:0xea
    v_bitop3_b32 v32, v32, v38, v39 bitop3:0xea
    ds_write_b128 v52, v[28:31]
    ds_write_b16 v53, v32 offset:1024
    v_sub_f32 v42, s60, v42
    v_mul_f32 v42, 0x42000000, v42
    v_mul_f32 v42, v42, v46
    v_cvt_pk_bf16_f32 v42, v42, v42
    v_ashrrev_i32 v43, 31, v42
    v_or_b32 v43, 0x80000000, v43
    v_xor_b32 v42, v42, v43
    v_bitop3_b32 v51, v37, v57, v42 bitop3:0xca
    s_mov_b64 exec, 1
    ds_write_b64 v54, v[50:51]
    s_mov_b64 exec, -1
    s_waitcnt lgkmcnt(0)
    s_barrier
    s_cmp_eq_u32 s39, 1
    s_cbranch_scc1 L_ln_stat
    ds_read_b64_tr_b16 v[28:29], v55
    ds_read_b64_tr_b16 v[30:31], v55 offset:4864
    s_cmp_eq_u32 s39, 0
    s_cbranch_scc0 L_ln_st
    ds_read_b64_tr_b16 v[32:33], v55 offset:1024
    ds_read_b64_tr_b16 v[34:35], v55 offset:5888
    v_add_u32 v38, 2097152, v56
    s_waitcnt lgkmcnt(0)
    global_store_dwordx4 v38, v[32:35], s[36:37] sc1
    s_branch L_ln_st
L_ln_stat:
    v_and_b32 v41, 0x30, v3
    v_add_u32 v40, 163776, v41
    ds_read_b128 v[48:51], v40
    ds_read_b64_tr_b16 v[28:29], v55
    ds_read_b64_tr_b16 v[30:31], v55 offset:4864
    s_lshl_b32 s43, s2, 6
    s_add_u32 s43, s43, 16384
    v_add_u32 v41, s43, v41
    s_mov_b64 exec, 15
    s_waitcnt lgkmcnt(2)
    global_store_dwordx4 v41, v[48:51], s[36:37] sc1
    s_mov_b64 exec, -1
L_ln_st:
    s_waitcnt lgkmcnt(0)
    global_store_dwordx4 v56, v[28:31], s[36:37] sc1
    s_barrier
    s_cmp_lt_u32 s41, 27
    s_cbranch_scc1 L_ffn
    s_cmp_lt_u32 s39, 2
    s_cbranch_scc1 L_sp2
    global_load_dword v1, v76, s[56:57]
L_sp2:
    s_mul_i32 s42, s39, 320
    s_add_u32 s42, s42, s53
    s_add_u32 s42, s42, 2944
    s_mov_b32 s58, 2
    s_mul_i32 s43, s40, 1152
    s_add_u32 s43, s43, 884736
    s_mul_i32 s59, s40, 663552
    s_cmp_eq_u32 s58, 0
    s_cselect_b32 s56, s26, s28
    s_cselect_b32 s57, s27, s29
    s_cmp_eq_u32 s58, 2
    s_cselect_b32 s56, s30, s56
    s_cselect_b32 s57, s31, s57
    s_cselect_b32 s43, s59, s43
    s_movk_i32 s58, 128
    s_movk_i32 s59, 8064
    s_movk_i32 s60, 4319
    s_cmov_b32 s58, 73728
    s_cmov_b32 s59, -663424
    s_cmovk_i32 s60, 5183
    v_add_u32 v76, s42, v2
    v_min_u32 v76, s60, v76
    v_mul_u32_u24 v63, 7282, v76
    v_lshrrev_b32 v63, 16, v63
    v_mul_u32_u24 v76, s58, v76
    v_mad_i32_i24 v76, v63, s59, v76
    v_add_u32 v76, s43, v76
    s_barrier
    s_cmp_ge_u32 s39, 7
    s_cbranch_scc1 L_sp3
    global_load_dword v1, v76, s[56:57]
L_sp3:
    s_sub_u32 s42, s2, 216
    s_cmp_ge_u32 s42, 32
    s_cbranch_scc1 L_sp4
    s_cmp_ge_u32 s39, 1
    s_cbranch_scc1 L_sp4
    s_lshl_b32 s42, s42, 6
    v_add_u32 v76, s42, v2
    v_mul_u32_u24 v76, 1152, v76
    s_lshl_b32 s42, s39, 7
    v_subrev_u32 v76, s42, v76
    v_add_u32 v76, 1024, v76
    global_load_dword v1, v76, s[32:33]
L_sp4:
    s_waitcnt vmcnt(0) lgkmcnt(0)
    s_endpgm
L_ffn:
    v_bfe_u32 v14, v0, 4, 2
    v_and_b32 v11, 7, v0
    v_mov_b32 v26, 147456
    v_mov_b32 v27, 4
    s_cmp_eq_u32 s52, 0
    s_cbranch_scc0 L_gu
    s_setprio 1
    v_lshlrev_b32 v8, 4, v0
    v_add_u32 v9, 20480, v8
    v_add_u32 v10, 8192, v9
    v_lshlrev_b32 v13, 6, v0
    v_xor_b32 v128, 65504, v13
    v_xor_b32 v129, 65472, v13
    v_xor_b32 v130, 49120, v13
    v_xor_b32 v131, 49088, v13
    v_xor_b32 v132, 32736, v13
    v_xor_b32 v133, 32704, v13
    v_xor_b32 v134, 16352, v13
    v_xor_b32 v135, 16320, v13
    v_mov_b32 v36, s44
    v_lshrrev_b32 v25, 5, v0
    v_lshl_add_u32 v25, v25, 2, v26
    s_mul_i32 s62, s39, 80
    s_add_u32 s62, s62, 147584
    v_and_b32 v15, 0x3c, v0
    v_add_u32 v15, s62, v15
    v_and_b32 v16, 3, v0
    v_mul_u32_u24 v16, 80, v16
    v_add_u32 v16, 147584, v16
    v_lshrrev_b32 v12, 3, v2
    v_lshl_add_u32 v17, v12, 2, v26
    v_lshl_add_u32 v18, v11, 2, v26
    v_and_b32 v12, 6, v12
    v_xor_b32 v12, v12, v11
    v_lshlrev_b32 v12, 4, v12
    v_lshl_add_u32 v12, v1, 7, v12
    v_add_u32 v12, 2358144, v12
    s_lshl_b32 s63, s54, 7
    s_add_u32 s63, s63, 2358144
    v_mov_b32 v37, s63
    s_movk_i32 s63, -1152
    s_mul_i32 s64, s39, 1056
    s_mul_i32 s42, s50, 73728
    s_add_u32 s12, s30, s42
    s_addc_u32 s13, s31, 0
    s_add_u32 s14, s12, 18432
    s_addc_u32 s15, s13, 0
    s_add_u32 s16, s12, 36864
    s_addc_u32 s17, s13, 0
    s_add_u32 s18, s12, 55296
    s_addc_u32 s19, s13, 0
    v_mul_u32_u24 v19, 4608, v14
    v_and_b32 v20, 0xf0, v3
    s_lshl_b32 s42, s51, 8
    v_add3_u32 v19, v19, v20, s42
    v_lshrrev_b32 v20, 1, v2
    v_mul_u32_u24 v20, 1152, v20
    v_and_b32 v21, 16, v3
    s_lshl_b32 s42, s51, 5
    v_add3_u32 v20, v20, v21, s42
    v_bfe_i32 v232, v0, 3, 1
    v_mul_u32_u24 v4, 74752, v14
    v_lshl_add_u32 v4, v11, 4, v4
    v_and_b32 v5, 37376, v232
    s_lshl_b32 s43, s50, 7
    s_add_u32 s43, s43, 65536
    s_mul_i32 s42, s51, 299008
    s_add_u32 s42, s42, s43
    v_add3_u32 v4, v4, v5, s42
    v_add_u32 v5, 18688, v4
    v_add_u32 v6, 9344, v4
    v_add_u32 v7, 28032, v4
    v_mul_u32_u24 v8, 9344, v14
    v_lshl_add_u32 v8, v11, 4, v8
    s_mul_i32 s42, s51, 37376
    s_add_u32 s42, s42, s43
    s_add_u32 s42, s42, 1196032
    v_add_u32 v8, s42, v8
    v_mov_b32 v233, s45
    v_mov_b32 v234, 0xff
    v_and_b32 v235, 0x370, v3
    v_add_u32 v235, 147968, v235
    s_lshl_b32 s42, s51, 10
    s_add_u32 s42, s42, 159520
    v_add_u32 v236, s42, v3
    v_lshl_add_u32 v237, v2, 3, s42
    s_mov_b32 s66, 0x05040100
    s_mov_b32 s67, 0x07060302
    s_mov_b32 s55, 131072
    s_waitcnt vmcnt(0)
    s_barrier
    global_load_dwordx4 v[112:115], v9, s[36:37] offset:-4096 sc1
    global_load_dwordx4 v[116:119], v9, s[36:37] offset:0 sc1
    global_load_dwordx4 v[120:123], v10, s[36:37] offset:-4096 sc1
    global_load_dwordx4 v[124:127], v10, s[36:37] offset:0 sc1
L_ffn_poll:
    v_mov_b32 v24, 0
    s_waitcnt vmcnt(3)
    v_xor_b32 v28, v36, v113
    v_bitop3_b32 v24, v24, v28, v128 bitop3:0xf6
    v_xor_b32 v29, v36, v115
    v_bitop3_b32 v24, v24, v29, v129 bitop3:0xf6
    s_waitcnt vmcnt(2)
    v_xor_b32 v30, v36, v117
    v_bitop3_b32 v24, v24, v30, v130 bitop3:0xf6
    v_xor_b32 v31, v36, v119
    v_bitop3_b32 v24, v24, v31, v131 bitop3:0xf6
    s_waitcnt vmcnt(1)
    v_xor_b32 v32, v36, v121
    v_bitop3_b32 v24, v24, v32, v132 bitop3:0xf6
    v_xor_b32 v33, v36, v123
    v_bitop3_b32 v24, v24, v33, v133 bitop3:0xf6
    s_waitcnt vmcnt(0)
    v_xor_b32 v34, v36, v125
    v_bitop3_b32 v24, v24, v34, v134 bitop3:0xf6
    v_xor_b32 v35, v36, v127
    v_bitop3_b32 v24, v24, v35, v135 bitop3:0xf6
    v_and_b32 v24, 0xffff, v24
    v_cmp_ne_u32 vcc, 0, v24
    v_max3_u32 v38, v28, v29, v30
    v_max3_u32 v39, v31, v32, v33
    s_cbranch_vccz L_ffn_go
    global_load_dwordx4 v[112:115], v9, s[36:37] offset:-4096 sc1
    global_load_dwordx4 v[116:119], v9, s[36:37] offset:0 sc1
    global_load_dwordx4 v[120:123], v10, s[36:37] offset:-4096 sc1
    global_load_dwordx4 v[124:127], v10, s[36:37] offset:0 sc1
    s_sub_u32 s55, s55, 1
    s_cbranch_scc0 L_ffn_poll
    s_waitcnt vmcnt(0)
L_ffn_go:
    s_barrier
    v_max3_u32 v38, v38, v34, v35
    v_max_u32 v38, v38, v39
    v_alignbit_b32 v24, 1, v38, 5
    v_sub_u32 v128, v28, v38
    v_sub_u32 v129, v29, v38
    v_max_u32_dpp v21, v24, v24 row_ror:1 row_mask:0xf bank_mask:0xf
    v_sub_u32 v130, v30, v38
    v_sub_u32 v131, v31, v38
    v_max_u32_dpp v21, v21, v21 row_ror:2 row_mask:0xf bank_mask:0xf
    v_sub_u32 v132, v32, v38
    v_sub_u32 v133, v33, v38
    v_max_u32_dpp v21, v21, v21 row_ror:4 row_mask:0xf bank_mask:0xf
    v_sub_u32 v134, v34, v38
    v_sub_u32 v135, v35, v38
    v_max_u32_dpp v21, v21, v21 row_ror:8 row_mask:0xf bank_mask:0xf
    v_max3_u32 v39, v128, v129, v130
    v_max3_u32 v22, v131, v132, v133
    v_max_u32_dpp v21, v21, v21 row_bcast:15 row_mask:0xa bank_mask:0xf
    s_mov_b32 exec_lo, 0x80000000
    s_mov_b32 exec_hi, 0x80000000
    ds_write_b32 v25, v21
    s_mov_b64 exec, -1
    s_mov_b32 s55, 2097152
    ds_read_b128 v[112:115], v26
    ds_read_b128 v[116:119], v26 offset:16
    v_max3_u32 v39, v39, v134, v135
    v_max_u32 v39, v39, v22
    v_add_u32 v39, v39, v38
    v_alignbit_b32 v23, 1, v39, 5
L_s1:
    s_waitcnt lgkmcnt(0)
    v_min3_u32 v21, v112, v113, v114
    v_min3_u32 v22, v115, v116, v117
    v_min3_u32 v21, v21, v118, v119
    v_min_u32 v21, v21, v22
    v_cmp_eq_u32 vcc, 0, v21
    v_cmp_ge_u32 s[6:7], v24, v21
    v_cmp_ge_u32 s[8:9], v23, v21
    s_cbranch_vccz L_s1_ok
    ds_read_b128 v[112:115], v26
    ds_read_b128 v[116:119], v26 offset:16
    s_sub_u32 s55, s55, 1
    s_cbranch_scc0 L_s1
L_s1_ok:
    s_bcnt1_i32_b64 s10, s[6:7]
    v_mbcnt_lo_u32_b32 v22, s6, 0
    v_mbcnt_lo_u32_b32 v13, s8, 0
    v_mbcnt_hi_u32_b32 v22, s7, v22
    v_mbcnt_hi_u32_b32 v13, s9, v13
    v_min_u32 v22, 16, v22
    v_add_u32 v13, s10, v13
    v_lshl_add_u32 v22, v22, 2, s62
    v_min_u32 v13, 16, v13
    s_mov_b64 exec, s[6:7]
    ds_write_b32 v22, v24
    v_lshl_add_u32 v13, v13, 2, s62
    s_mov_b64 exec, s[8:9]
    ds_write_b32 v13, v23
    s_mov_b64 exec, 1
    ds_add_u32 v26, v27 offset:32
    s_mov_b64 exec, -1
    ds_read_b32 v22, v26 offset:32
    ds_read_b32 v13, v15
    ds_read_b128 v[112:115], v16 offset:0
    ds_read_b128 v[116:119], v16 offset:16
    ds_read_b128 v[120:123], v16 offset:32
    ds_read_b128 v[124:127], v16 offset:48
    v_and_b32 v24, 0x7ff, v24
    v_and_b32 v23, 0x7ff, v23
    v_mad_i32_i24 v24, v24, s63, v37
    v_mad_i32_i24 v23, v23, s63, v37
    s_mov_b64 exec, s[6:7]
    global_load_dword v239, v24, s[4:5]
    s_cmp_eq_u64 s[8:9], 0
    s_cbranch_scc1 L_no2
    s_mov_b64 exec, s[8:9]
    global_load_dword v239, v23, s[4:5]
L_no2:
    s_mov_b64 exec, -1
L_s2:
    s_waitcnt lgkmcnt(0)
    v_cmp_ne_u32 vcc, 16, v22
    v_mov_b32 v24, 0
    s_cbranch_vccz L_s2_ok
    ds_read_b32 v22, v26 offset:32
    ds_read_b32 v13, v15
    ds_read_b128 v[112:115], v16 offset:0
    ds_read_b128 v[116:119], v16 offset:16
    ds_read_b128 v[120:123], v16 offset:32
    ds_read_b128 v[124:127], v16 offset:48
    s_sub_u32 s55, s55, 1
    s_cbranch_scc0 L_s2
L_s2_ok:
    v_sub_u32 v112, v13, v112
    v_alignbit_b32 v24, v24, v112, 31
    v_sub_u32 v113, v13, v113
    v_alignbit_b32 v24, v24, v113, 31
    v_sub_u32 v114, v13, v114
    v_alignbit_b32 v24, v24, v114, 31
    v_sub_u32 v115, v13, v115
    v_alignbit_b32 v24, v24, v115, 31
    v_sub_u32 v116, v13, v116
    v_alignbit_b32 v24, v24, v116, 31
    v_sub_u32 v117, v13, v117
    v_alignbit_b32 v24, v24, v117, 31
    v_sub_u32 v118, v13, v118
    v_alignbit_b32 v24, v24, v118, 31
    v_sub_u32 v119, v13, v119
    v_alignbit_b32 v24, v24, v119, 31
    v_sub_u32 v120, v13, v120
    v_alignbit_b32 v24, v24, v120, 31
    v_sub_u32 v121, v13, v121
    v_alignbit_b32 v24, v24, v121, 31
    v_sub_u32 v122, v13, v122
    v_alignbit_b32 v24, v24, v122, 31
    v_sub_u32 v123, v13, v123
    v_alignbit_b32 v24, v24, v123, 31
    v_sub_u32 v124, v13, v124
    v_alignbit_b32 v24, v24, v124, 31
    v_sub_u32 v125, v13, v125
    v_alignbit_b32 v24, v24, v125, 31
    v_sub_u32 v126, v13, v126
    v_alignbit_b32 v24, v24, v126, 31
    v_sub_u32 v127, v13, v127
    v_alignbit_b32 v24, v24, v127, 31
    v_bcnt_u32_b32 v24, v24, 0
    s_nop 1
    v_add_u32_dpp v24, v24, v24 quad_perm:[1,0,3,2] row_mask:0xf bank_mask:0xf
    s_nop 1
    v_add_u32_dpp v24, v24, v24 quad_perm:[2,3,0,1] row_mask:0xf bank_mask:0xf
    v_cmp_gt_u32 vcc, 8, v24
    v_lshl_add_u32 v24, v24, 2, v26
    s_mov_b64 exec, vcc
    ds_write_b32 v24, v13 offset:64
    s_mov_b64 exec, -1
L_s3:
    ds_read_b32 v23, v17 offset:64
    ds_read_b32 v13, v18 offset:64
    s_add_u32 m0, s64, 150016
    s_waitcnt lgkmcnt(0)
    v_cmp_eq_u32 vcc, 0, v23
    v_and_b32 v23, 0x7ff, v23
    s_sub_u32 s55, s55, 1
    s_cselect_b64 vcc, 0, vcc
    s_cbranch_vccnz L_s3
    v_mad_i32_i24 v23, v23, s63, v12
    global_load_lds_dwordx4 v23, s[4:5]
    s_add_u32 m0, s64, 153728
    v_and_b32 v22, 0x7ff, v13
    global_load_lds_dwordx4 v23, s[4:5] offset:512
    v_sub_u32 v22, 2047, v22
    s_cmp_lg_u32 s39, 0
    s_cbranch_scc1 L_nox9
    s_mov_b32 m0, 157440
    s_nop 0
    global_load_lds_dwordx4 v23, s[4:5] offset:1024
    s_branch L_x3
L_nox9:
    v_lshlrev_b32 v24, 3, v22
    v_add_u32 v24, 16384, v24
    global_load_dword v25, v24, s[36:37] sc1
L_x3:
    s_barrier
    v_readlane_b32 s10, v13, 7
    s_mov_b32 s11, 0
    s_lshl_b32 s10, s10, 5
    v_cmp_le_u32 vcc, s10, v28
    s_nop 0
    s_bcnt1_i32_b64 s56, vcc
    s_add_u32 s11, s11, s56
    v_cmp_le_u32 vcc, s10, v29
    s_nop 0
    s_bcnt1_i32_b64 s56, vcc
    s_add_u32 s11, s11, s56
    v_cmp_le_u32 vcc, s10, v30
    s_nop 0
    s_bcnt1_i32_b64 s56, vcc
    s_add_u32 s11, s11, s56
    v_cmp_le_u32 vcc, s10, v31
    s_nop 0
    s_bcnt1_i32_b64 s56, vcc
    s_add_u32 s11, s11, s56
    v_cmp_le_u32 vcc, s10, v32
    s_nop 0
    s_bcnt1_i32_b64 s56, vcc
    s_add_u32 s11, s11, s56
    v_cmp_le_u32 vcc, s10, v33
    s_nop 0
    s_bcnt1_i32_b64 s56, vcc
    s_add_u32 s11, s11, s56
    v_cmp_le_u32 vcc, s10, v34
    s_nop 0
    s_bcnt1_i32_b64 s56, vcc
    s_add_u32 s11, s11, s56
    v_cmp_le_u32 vcc, s10, v35
    s_nop 0
    s_bcnt1_i32_b64 s56, vcc
    s_add_u32 s11, s11, s56
    s_lshl_b32 s11, s11, 16
    s_or_b32 s11, s11, 4
    v_mov_b32 v36, s11
    s_barrier
    global_load_dwordx4 v[40:43], v19, s[12:13] offset:0
    global_load_dwordx4 v[44:47], v19, s[12:13] offset:1152
    s_waitcnt vmcnt(2)
    s_cmp_lg_u32 s39, 1
    s_cbranch_scc1 L_nost
    ds_write_b32 v18, v25 offset:448
L_nost:
    s_mov_b64 exec, 1
    ds_add_u32 v26, v36 offset:36
    s_mov_b64 exec, -1
    s_setprio 0
    global_load_dwordx4 v[48:51], v19, s[12:13] offset:2304
    global_load_dwordx4 v[52:55], v19, s[12:13] offset:3456
    global_load_dwordx4 v[56:59], v19, s[14:15] offset:0
    global_load_dwordx4 v[60:63], v19, s[14:15] offset:1152
    global_load_dwordx4 v[64:67], v19, s[14:15] offset:2304
    global_load_dwordx4 v[68:71], v19, s[14:15] offset:3456
    global_load_dwordx4 v[216:219], v20, s[12:13] offset:1024
    global_load_dwordx4 v[220:223], v20, s[16:17] offset:1024
L_s4:
    ds_read_b32 v24, v26 offset:36
    s_waitcnt lgkmcnt(0)
    v_readfirstlane_b32 s61, v24
    s_nop 0
    s_and_b32 s60, s61, 255
    s_cmp_ge_u32 s60, 16
    s_cbranch_scc1 L_s4_ok
    s_sub_u32 s55, s55, 1
    s_cbranch_scc0 L_s4
L_s4_ok:
    s_lshr_b32 s61, s61, 16
    s_cmp_eq_u32 s61, 8
    s_cbranch_scc0 L_slow
L_dgo:
    global_load_dwordx4 v[72:75], v19, s[16:17] offset:0
    s_waitcnt vmcnt(9)
    v_perm_b32 v112, v44, v40, s66
    v_perm_b32 v116, v44, v40, s67
    v_perm_b32 v120, v45, v41, s66
    v_perm_b32 v124, v45, v41, s67
    v_perm_b32 v128, v46, v42, s66
    v_perm_b32 v132, v46, v42, s67
    v_perm_b32 v136, v47, v43, s66
    v_perm_b32 v140, v47, v43, s67
    global_load_dwordx4 v[76:79], v19, s[16:17] offset:1152
    s_waitcnt vmcnt(8)
    v_perm_b32 v113, v52, v48, s66
    v_perm_b32 v117, v52, v48, s67
    v_perm_b32 v121, v53, v49, s66
    v_perm_b32 v125, v53, v49, s67
    v_perm_b32 v129, v54, v50, s66
    v_perm_b32 v133, v54, v50, s67
    v_perm_b32 v137, v55, v51, s66
    v_perm_b32 v141, v55, v51, s67
    global_load_dwordx4 v[80:83], v19, s[16:17] offset:2304
    global_load_dwordx4 v[84:87], v19, s[16:17] offset:3456
    s_waitcnt vmcnt(8)
    v_perm_b32 v114, v60, v56, s66
    v_perm_b32 v118, v60, v56, s67
    v_perm_b32 v122, v61, v57, s66
    v_perm_b32 v126, v61, v57, s67
    v_perm_b32 v130, v62, v58, s66
    v_perm_b32 v134, v62, v58, s67
    v_perm_b32 v138, v63, v59, s66
    v_perm_b32 v142, v63, v59, s67
    global_load_dwordx4 v[88:91], v19, s[18:19] offset:0
    global_load_dwordx4 v[92:95], v19, s[18:19] offset:1152
    s_waitcnt vmcnt(8)
    v_perm_b32 v115, v68, v64, s66
    v_perm_b32 v119, v68, v64, s67
    v_perm_b32 v123, v69, v65, s66
    v_perm_b32 v127, v69, v65, s67
    v_perm_b32 v131, v70, v66, s66
    v_perm_b32 v135, v70, v66, s67
    v_perm_b32 v139, v71, v67, s66
    v_perm_b32 v143, v71, v67, s67
    global_load_dwordx4 v[96:99], v19, s[18:19] offset:2304
    global_load_dwordx4 v[100:103], v19, s[18:19] offset:3456
    s_waitcnt vmcnt(6)
    ds_write_b128 v236, v[216:219]
    ds_read_b64_tr_b16 v[104:105], v237
    ds_read_b64_tr_b16 v[106:107], v237 offset:512
    ds_write_b128 v236, v[220:223]
    ds_read_b64_tr_b16 v[108:109], v237
    ds_read_b64_tr_b16 v[110:111], v237 offset:512
    v_perm_b32 v144, v76, v72, s66
    v_perm_b32 v148, v76, v72, s67
    v_perm_b32 v152, v77, v73, s66
    v_perm_b32 v156, v77, v73, s67
    v_perm_b32 v160, v78, v74, s66
    v_perm_b32 v164, v78, v74, s67
    v_perm_b32 v168, v79, v75, s66
    v_perm_b32 v172, v79, v75, s67
    s_barrier
    ds_read_b128 v[28:31], v235
    ds_read_b128 v[32:35], v235 offset:1024
    s_mov_b32 s58, 0x00ff00ff
    s_mov_b32 s59, 0x00ff00ff
    s_waitcnt vmcnt(4)
    v_perm_b32 v145, v84, v80, s66
    v_perm_b32 v149, v84, v80, s67
    v_perm_b32 v153, v85, v81, s66
    v_perm_b32 v157, v85, v81, s67
    v_perm_b32 v161, v86, v82, s66
    v_perm_b32 v165, v86, v82, s67
    v_perm_b32 v169, v87, v83, s66
    v_perm_b32 v173, v87, v83, s67
    s_waitcnt lgkmcnt(0)
    v_mfma_f32_16x16x32_bf16 v[208:211], v[104:107], v[28:31], 0
    s_waitcnt vmcnt(2)
    v_perm_b32 v146, v92, v88, s66
    v_mfma_f32_16x16x32_bf16 v[208:211], v[108:111], v[32:35], v[208:211]
    v_perm_b32 v150, v92, v88, s67
    v_perm_b32 v154, v93, v89, s66
    v_mfma_f32_16x16x32_bf16 v[176:179], v[112:115], v[28:31], 0
    v_perm_b32 v158, v93, v89, s67
    v_perm_b32 v162, v94, v90, s66
    v_mfma_f32_16x16x32_bf16 v[180:183], v[116:119], v[28:31], 0
    v_perm_b32 v166, v94, v90, s67
    v_perm_b32 v170, v95, v91, s66
    v_mfma_f32_16x16x32_bf16 v[184:187], v[120:123], v[28:31], 0
    v_perm_b32 v174, v95, v91, s67
    s_waitcnt vmcnt(0)
    v_mfma_f32_16x16x32_bf16 v[188:191], v[124:127], v[28:31], 0
    v_perm_b32 v147, v100, v96, s66
    v_perm_b32 v151, v100, v96, s67
    v_perm_b32 v155, v101, v97, s66
    v_perm_b32 v159, v101, v97, s67
    v_perm_b32 v163, v102, v98, s66
    v_perm_b32 v167, v102, v98, s67
    v_perm_b32 v171, v103, v99, s66
    v_perm_b32 v175, v103, v99, s67
    v_mfma_f32_16x16x32_bf16 v[176:179], v[144:147], v[32:35], v[176:179]
    v_mfma_f32_16x16x32_bf16 v[180:183], v[148:151], v[32:35], v[180:183]
    v_bitop3_b32 v208, v234, v233, v208 bitop3:0xca
    s_mov_b64 exec, s[58:59]
    global_store_dwordx4 v8, v[208:211], s[36:37] sc1
    s_mov_b64 exec, -1
    v_mfma_f32_16x16x32_bf16 v[184:187], v[152:155], v[32:35], v[184:187]
    v_mfma_f32_16x16x32_bf16 v[188:191], v[156:159], v[32:35], v[188:191]
    v_mfma_f32_16x16x32_bf16 v[192:195], v[128:131], v[28:31], 0
    v_mfma_f32_16x16x32_bf16 v[196:199], v[132:135], v[28:31], 0
    v_mfma_f32_16x16x32_bf16 v[200:203], v[136:139], v[28:31], 0
    v_bitop3_b32 v212, v232, v178, v176 bitop3:0xca
    v_bitop3_b32 v213, v232, v182, v180 bitop3:0xca
    v_mfma_f32_16x16x32_bf16 v[204:207], v[140:143], v[28:31], 0
    s_nop 0
    v_bitop3_b32 v214, v232, v186, v184 bitop3:0xca
    v_bitop3_b32 v215, v232, v190, v188 bitop3:0xca
    v_mfma_f32_16x16x32_bf16 v[192:195], v[160:163], v[32:35], v[192:195]
    v_bitop3_b32 v212, v234, v233, v212 bitop3:0xca
    global_store_dwordx4 v4, v[212:215], s[36:37] sc1
    v_mfma_f32_16x16x32_bf16 v[196:199], v[164:167], v[32:35], v[196:199]
    v_bitop3_b32 v216, v232, v179, v177 bitop3:0xca
    v_bitop3_b32 v217, v232, v183, v181 bitop3:0xca
    v_mfma_f32_16x16x32_bf16 v[200:203], v[168:171], v[32:35], v[200:203]
    v_bitop3_b32 v218, v232, v187, v185 bitop3:0xca
    v_bitop3_b32 v219, v232, v191, v189 bitop3:0xca
    v_mfma_f32_16x16x32_bf16 v[204:207], v[172:175], v[32:35], v[204:207]
    v_bitop3_b32 v216, v234, v233, v216 bitop3:0xca
    global_store_dwordx4 v5, v[216:219], s[36:37] sc1
    v_bitop3_b32 v220, v232, v194, v192 bitop3:0xca
    v_bitop3_b32 v221, v232, v198, v196 bitop3:0xca
    s_nop 0
    v_bitop3_b32 v222, v232, v202, v200 bitop3:0xca
    s_nop 1
    v_bitop3_b32 v223, v232, v206, v204 bitop3:0xca
    v_bitop3_b32 v220, v234, v233, v220 bitop3:0xca
    global_store_dwordx4 v6, v[220:223], s[36:37] sc1
    v_bitop3_b32 v224, v232, v195, v193 bitop3:0xca
    v_bitop3_b32 v225, v232, v199, v197 bitop3:0xca
    v_bitop3_b32 v226, v232, v203, v201 bitop3:0xca
    v_bitop3_b32 v227, v232, v207, v205 bitop3:0xca
    v_bitop3_b32 v224, v234, v233, v224 bitop3:0xca
    global_store_dwordx4 v7, v[224:227], s[36:37] sc1
    s_lshl_b32 s42, s40, 3
    s_add_u32 s42, s42, s54
    s_add_u32 s43, s40, 64
    s_cmp_eq_u32 s54, 8
    s_cselect_b32 s42, s43, s42
    s_mul_i32 s42, s42, 18688
    s_add_u32 s42, s42, 65536
    v_min_u32 v9, 145, v0
    v_lshl_add_u32 v9, v9, 7, s42
    s_waitcnt vmcnt(0)
    global_load_dword v10, v9, s[36:37] sc1
    s_waitcnt vmcnt(0)
    s_endpgm
L_slow:
    v_mov_b32 v21, 0
    v_mov_b32 v38, v26
    s_mov_b32 s10, 16
L_slow_r:
    v_sub_u32 v176, v28, v21
    v_sub_u32 v177, v29, v21
    v_sub_u32 v178, v30, v21
    v_sub_u32 v179, v31, v21
    v_sub_u32 v180, v32, v21
    v_sub_u32 v181, v33, v21
    v_sub_u32 v182, v34, v21
    v_sub_u32 v183, v35, v21
    v_max3_u32 v24, v176, v177, v178
    v_max3_u32 v24, v24, v179, v180
    v_max3_u32 v24, v24, v181, v182
    v_max_u32 v24, v24, v183
    ds_max_u32 v38, v24 offset:96
    s_mov_b64 exec, 1
    ds_add_u32 v26, v27 offset:40
    s_mov_b64 exec, -1
L_slow_s:
    ds_read_b32 v24, v26 offset:40
    ds_read_b32 v39, v38 offset:96
    s_waitcnt lgkmcnt(0)
    v_readfirstlane_b32 s11, v24
    s_nop 0
    s_cmp_ge_u32 s11, s10
    s_cbranch_scc1 L_slow_ok
    s_sub_u32 s55, s55, 1
    s_cbranch_scc0 L_slow_s
L_slow_ok:
    v_add_u32 v21, v21, v39
    v_alignbit_b32 v24, 1, v21, 5
    ds_write_b32 v38, v24 offset:64
    v_add_u32 v38, 4, v38
    s_add_u32 s10, s10, 16
    s_cmp_le_u32 s10, 128
    s_cbranch_scc1 L_slow_r
    ds_read_b32 v23, v17 offset:64
    ds_read_b32 v13, v18 offset:64
    s_add_u32 m0, s64, 150016
    s_waitcnt lgkmcnt(0)
    v_and_b32 v23, 0x7ff, v23
    v_mad_i32_i24 v23, v23, s63, v12
    global_load_lds_dwordx4 v23, s[4:5]
    s_add_u32 m0, s64, 153728
    v_and_b32 v22, 0x7ff, v13
    global_load_lds_dwordx4 v23, s[4:5] offset:512
    v_sub_u32 v22, 2047, v22
    s_cmp_lg_u32 s39, 0
    s_cbranch_scc1 L_nox9b
    s_mov_b32 m0, 157440
    s_nop 0
    global_load_lds_dwordx4 v23, s[4:5] offset:1024
    s_branch L_x3b
L_nox9b:
    v_lshlrev_b32 v24, 3, v22
    v_add_u32 v24, 16384, v24
    global_load_dword v25, v24, s[36:37] sc1
L_x3b:
    v_mov_b32 v36, 4
    s_waitcnt vmcnt(0)
    s_cmp_lg_u32 s39, 1
    s_cbranch_scc1 L_nostb
    ds_write_b32 v18, v25 offset:448
L_nostb:
    s_mov_b64 exec, 1
    ds_add_u32 v26, v36 offset:36
    s_mov_b64 exec, -1
    s_branch L_dgo
L_gu:
    s_setprio 0
    s_add_u32 s53, s53, 12288
    v_mov_b32 v1, v76
    s_movk_i32 s55, 5
L_dma1:
    s_mov_b32 m0, s53
    s_add_u32 s42, s53, 73728
    global_load_lds_dwordx4 v1, s[26:27]
    s_mov_b32 m0, s42
    s_add_u32 s53, s53, 4096
    global_load_lds_dwordx4 v1, s[28:29]
    v_add_u32 v1, 294912, v1
    s_sub_u32 s55, s55, 1
    s_cmp_lg_u32 s55, 0
    s_cbranch_scc1 L_dma1
    v_lshrrev_b32 v12, 1, v2
    v_min_u32 v12, 8, v12
    v_mul_u32_u24 v12, 1056, v12
    v_and_b32 v13, 16, v3
    v_add_u32 v12, v12, v13
    v_add_u32 v12, 151040, v12
    v_mov_b32 v20, 0x3f803f80
    v_mov_b32 v21, v20
    v_mov_b32 v22, v20
    v_mov_b32 v23, v20
    ds_write_b128 v12, v[20:23]
    v_bfe_u32 v15, v0, 2, 2
    v_and_b32 v16, 3, v0
    v_lshl_add_u32 v17, v14, 3, v15
    v_bfe_u32 v18, v0, 3, 2
    v_xor_b32 v18, s51, v18
    v_lshlrev_b32 v18, 5, v18
    v_lshl_add_u32 v18, v16, 3, v18
    v_lshl_add_u32 v4, v17, 7, v18
    v_add_u32 v5, 36864, v4
    v_add_u32 v6, 73728, v4
    v_add_u32 v7, 110592, v4
    v_and_b32 v19, 6, v11
    v_xor_b32 v19, v19, v14
    v_lshlrev_b32 v19, 4, v19
    v_lshl_add_u32 v19, v11, 7, v19
    v_xor_b32 v20, 64, v19
    v_bfe_i32 v21, v0, 3, 1
    v_lshlrev_b32 v22, 2, v0
    v_xor_b32 v22, v22, v0
    v_and_b32 v22, 16, v22
    v_or_b32 v22, 1024, v22
    v_bfi_b32 v19, v21, v22, v19
    v_xor_b32 v22, 16, v22
    v_bfi_b32 v20, v21, v22, v20
    v_add_u32 v19, 150016, v19
    v_add_u32 v20, 150016, v20
    v_lshl_add_u32 v18, v11, 2, v26
    s_lshr_b32 s42, s51, 1
    s_lshl_b32 s42, s42, 10
    s_and_b32 s43, s51, 1
    s_lshl_b32 s43, s43, 3
    s_add_u32 s42, s42, s43
    s_add_u32 s42, s42, 147968
    v_add_u32 v27, s42, v3
    v_and_b32 v8, 9344, v21
    v_lshl_add_u32 v8, v11, 4, v8
    s_mul_i32 s42, s50, 18688
    s_add_u32 s42, s42, 74752
    v_add_u32 v8, s42, v8
    s_waitcnt vmcnt(0)
    s_barrier
    ds_read_b64_tr_b16 v[112:113], v4 offset:0
    ds_read_b64_tr_b16 v[114:115], v4 offset:512
    ds_read_b64_tr_b16 v[184:185], v6 offset:0
    ds_read_b64_tr_b16 v[186:187], v6 offset:512
    ds_read_b64_tr_b16 v[116:117], v4 offset:4096
    ds_read_b64_tr_b16 v[118:119], v4 offset:4608
    ds_read_b64_tr_b16 v[188:189], v6 offset:4096
    ds_read_b64_tr_b16 v[190:191], v6 offset:4608
    ds_read_b64_tr_b16 v[120:121], v4 offset:8192
    ds_read_b64_tr_b16 v[122:123], v4 offset:8704
    ds_read_b64_tr_b16 v[192:193], v6 offset:8192
    ds_read_b64_tr_b16 v[194:195], v6 offset:8704
    ds_read_b64_tr_b16 v[124:125], v4 offset:12288
    ds_read_b64_tr_b16 v[126:127], v4 offset:12800
    ds_read_b64_tr_b16 v[196:197], v6 offset:12288
    ds_read_b64_tr_b16 v[198:199], v6 offset:12800
    ds_read_b64_tr_b16 v[128:129], v4 offset:16384
    ds_read_b64_tr_b16 v[130:131], v4 offset:16896
    ds_read_b64_tr_b16 v[200:201], v6 offset:16384
    ds_read_b64_tr_b16 v[202:203], v6 offset:16896
    ds_read_b64_tr_b16 v[132:133], v4 offset:20480
    ds_read_b64_tr_b16 v[134:135], v4 offset:20992
    ds_read_b64_tr_b16 v[204:205], v6 offset:20480
    ds_read_b64_tr_b16 v[206:207], v6 offset:20992
    ds_read_b64_tr_b16 v[136:137], v4 offset:24576
    ds_read_b64_tr_b16 v[138:139], v4 offset:25088
    ds_read_b64_tr_b16 v[208:209], v6 offset:24576
    ds_read_b64_tr_b16 v[210:211], v6 offset:25088
    ds_read_b64_tr_b16 v[140:141], v4 offset:28672
    ds_read_b64_tr_b16 v[142:143], v4 offset:29184
    ds_read_b64_tr_b16 v[212:213], v6 offset:28672
    ds_read_b64_tr_b16 v[214:215], v6 offset:29184
    s_barrier
    s_movk_i32 s55, 6
L_dma4:
    s_mov_b32 m0, s53
    s_add_u32 s42, s53, 73728
    global_load_lds_dwordx4 v1, s[26:27]
    s_mov_b32 m0, s42
    s_add_u32 s53, s53, 4096
    global_load_lds_dwordx4 v1, s[28:29]
    v_add_u32 v1, 294912, v1
    s_waitcnt vmcnt(3)
    s_sub_u32 s55, s55, 1
    s_cmp_lg_u32 s55, 0
    s_cbranch_scc1 L_dma4
    s_mov_b32 s55, 2097152
    v_mov_b32 v23, 0x100
    s_waitcnt vmcnt(2)
    s_barrier
    s_setprio 2
    s_add_u32 m0, s53, 0
    s_nop 0
    global_load_lds_dwordx4 v1, s[26:27]
    ds_read_b64_tr_b16 v[144:145], v4 offset:32768
    ds_read_b64_tr_b16 v[146:147], v4 offset:33280
    ds_read_b64_tr_b16 v[216:217], v6 offset:32768
    s_add_u32 m0, s53, 73728
    s_nop 0
    global_load_lds_dwordx4 v1, s[28:29]
    ds_read_b64_tr_b16 v[218:219], v6 offset:33280
    ds_read_b64_tr_b16 v[148:149], v5 offset:0
    ds_read_b64_tr_b16 v[150:151], v5 offset:512
    v_add_u32 v1, 294912, v1
    s_add_u32 m0, s53, 4096
    s_nop 0
    global_load_lds_dwordx4 v1, s[26:27]
    ds_read_b64_tr_b16 v[220:221], v7 offset:0
    ds_read_b64_tr_b16 v[222:223], v7 offset:512
    ds_read_b64_tr_b16 v[152:153], v5 offset:4096
    s_add_u32 m0, s53, 77824
    s_nop 0
    global_load_lds_dwordx4 v1, s[28:29]
    ds_read_b64_tr_b16 v[154:155], v5 offset:4608
    ds_read_b64_tr_b16 v[224:225], v7 offset:4096
    ds_read_b64_tr_b16 v[226:227], v7 offset:4608
    v_add_u32 v1, 294912, v1
    s_add_u32 m0, s53, 8192
    s_nop 0
    global_load_lds_dwordx4 v1, s[26:27]
    ds_read_b64_tr_b16 v[156:157], v5 offset:8192
    ds_read_b64_tr_b16 v[158:159], v5 offset:8704
    ds_read_b64_tr_b16 v[228:229], v7 offset:8192
    s_add_u32 m0, s53, 81920
    s_nop 0
    global_load_lds_dwordx4 v1, s[28:29]
    ds_read_b64_tr_b16 v[230:231], v7 offset:8704
    ds_read_b64_tr_b16 v[160:161], v5 offset:12288
    ds_read_b64_tr_b16 v[162:163], v5 offset:12800
    v_add_u32 v1, 294912, v1
    s_add_u32 m0, s53, 12288
    s_nop 0
    global_load_lds_dwordx4 v1, s[26:27]
    ds_read_b64_tr_b16 v[232:233], v7 offset:12288
    ds_read_b64_tr_b16 v[234:235], v7 offset:12800
    s_add_u32 m0, s53, 86016
    s_nop 0
    global_load_lds_dwordx4 v1, s[28:29]
    v_add_u32 v1, 294912, v1
    s_barrier
    s_waitcnt vmcnt(0)
    s_mov_b64 exec, 1
    ds_add_u32 v26, v23 offset:36
    s_mov_b64 exec, -1
L_s6:
    ds_read_b32 v24, v26 offset:36
    s_waitcnt lgkmcnt(0)
    v_readfirstlane_b32 s61, v24
    s_nop 0
    s_cmp_eq_u32 s61, 0x80410
    s_cbranch_scc1 L_s6_ok
    s_and_b32 s60, s61, 0xffff
    s_cmp_eq_u32 s60, 0x420
    s_cbranch_scc1 L_s6_ok
    s_sub_u32 s55, s55, 1
    s_cbranch_scc0 L_s6
L_s6_ok:
    ds_read_b128 v[40:43], v19 offset:0
    ds_read_b128 v[44:47], v20 offset:0
    ds_read_b128 v[48:51], v19 offset:1056
    ds_read_b128 v[52:55], v20 offset:1056
    ds_read_b128 v[56:59], v19 offset:2112
    ds_read_b128 v[60:63], v20 offset:2112
    s_waitcnt lgkmcnt(5)
    v_mfma_f32_16x16x32_bf16 v[28:31], v[112:115], v[40:43], 0
    ds_read_b128 v[64:67], v19 offset:3168
    ds_read_b128 v[68:71], v20 offset:3168
    v_mfma_f32_16x16x32_bf16 v[32:35], v[184:187], v[40:43], 0
    ds_read_b128 v[72:75], v19 offset:4224
    s_waitcnt lgkmcnt(6)
    v_mfma_f32_16x16x32_bf16 v[28:31], v[116:119], v[44:47], v[28:31]
    ds_read_b128 v[76:79], v20 offset:4224
    ds_read_b32 v25, v18 offset:448
    v_mfma_f32_16x16x32_bf16 v[32:35], v[188:191], v[44:47], v[32:35]
    ds_read_b32 v13, v18 offset:64
    ds_read_b128 v[80:83], v19 offset:5280
    v_mfma_f32_16x16x32_bf16 v[28:31], v[120:123], v[48:51], v[28:31]
    ds_read_b128 v[84:87], v20 offset:5280
    v_mfma_f32_16x16x32_bf16 v[32:35], v[192:195], v[48:51], v[32:35]
    ds_read_b128 v[88:91], v19 offset:6336
    s_waitcnt lgkmcnt(10)
    v_mfma_f32_16x16x32_bf16 v[28:31], v[124:127], v[52:55], v[28:31]
    ds_read_b128 v[92:95], v20 offset:6336
    ds_read_b64_tr_b16 v[164:165], v5 offset:16384
    v_mfma_f32_16x16x32_bf16 v[32:35], v[196:199], v[52:55], v[32:35]
    ds_read_b64_tr_b16 v[166:167], v5 offset:16896
    ds_read_b128 v[96:99], v19 offset:7392
    v_mfma_f32_16x16x32_bf16 v[28:31], v[128:131], v[56:59], v[28:31]
    v_mfma_f32_16x16x32_bf16 v[32:35], v[200:203], v[56:59], v[32:35]
    s_waitcnt lgkmcnt(11)
    v_mfma_f32_16x16x32_bf16 v[28:31], v[132:135], v[60:63], v[28:31]
    ds_read_b64_tr_b16 v[168:169], v5 offset:20480
    ds_read_b64_tr_b16 v[170:171], v5 offset:20992
    v_mfma_f32_16x16x32_bf16 v[28:31], v[136:139], v[64:67], v[28:31]
    ds_read_b128 v[100:103], v20 offset:7392
    v_mfma_f32_16x16x32_bf16 v[28:31], v[140:143], v[68:71], v[28:31]
    s_waitcnt lgkmcnt(9)
    v_mfma_f32_16x16x32_bf16 v[28:31], v[144:147], v[72:75], v[28:31]
    ds_read_b64_tr_b16 v[172:173], v5 offset:24576
    ds_read_b64_tr_b16 v[174:175], v5 offset:25088
    v_mfma_f32_16x16x32_bf16 v[28:31], v[148:151], v[76:79], v[28:31]
    ds_read_b128 v[104:107], v19 offset:8448
    ds_read_b64_tr_b16 v[176:177], v5 offset:28672
    v_mfma_f32_16x16x32_bf16 v[28:31], v[152:155], v[80:83], v[28:31]
    ds_read_b64_tr_b16 v[178:179], v5 offset:29184
    v_and_b32 v15, 0xffff0000, v25
    s_waitcnt lgkmcnt(9)
    v_mfma_f32_16x16x32_bf16 v[28:31], v[156:159], v[84:87], v[28:31]
    ds_read_b128 v[108:111], v20 offset:8448
    ds_read_b64_tr_b16 v[180:181], v5 offset:32768
    v_mfma_f32_16x16x32_bf16 v[28:31], v[160:163], v[88:91], v[28:31]
    ds_read_b64_tr_b16 v[182:183], v5 offset:33280
    v_rcp_f32 v16, v15
    v_mfma_f32_16x16x32_bf16 v[28:31], v[164:167], v[92:95], v[28:31]
    ds_read_b64_tr_b16 v[236:237], v7 offset:16384
    v_lshlrev_b32 v12, 16, v25
    s_waitcnt lgkmcnt(4)
    v_mfma_f32_16x16x32_bf16 v[28:31], v[168:171], v[96:99], v[28:31]
    ds_read_b64_tr_b16 v[238:239], v7 offset:16896
    v_xor_b32 v25, 0x80000000, v12
    v_mfma_f32_16x16x32_bf16 v[28:31], v[172:175], v[100:103], v[28:31]
    ds_read_b64_tr_b16 v[240:241], v7 offset:20480
    ds_read_b64_tr_b16 v[242:243], v7 offset:20992
    v_mfma_f32_16x16x32_bf16 v[28:31], v[176:179], v[104:107], v[28:31]
    ds_read_b64_tr_b16 v[244:245], v7 offset:24576
    ds_read_b64_tr_b16 v[246:247], v7 offset:25088
    s_waitcnt lgkmcnt(6)
    v_mfma_f32_16x16x32_bf16 v[28:31], v[180:183], v[108:111], v[28:31]
    ds_read_b64_tr_b16 v[248:249], v7 offset:28672
    ds_read_b64_tr_b16 v[250:251], v7 offset:29184
    v_mfma_f32_16x16x32_bf16 v[32:35], v[204:207], v[60:63], v[32:35]
    ds_read_b64_tr_b16 v[252:253], v7 offset:32768
    ds_read_b64_tr_b16 v[254:255], v7 offset:33280
    v_mfma_f32_16x16x32_bf16 v[32:35], v[208:211], v[64:67], v[32:35]
    v_mul_f32 v16, 0x42000000, v16
    v_mul_f32 v9, 0xbfb8aa3b, v16
    v_mfma_f32_16x16x32_bf16 v[32:35], v[212:215], v[68:71], v[32:35]
    v_mul_f32 v10, v16, v16
    v_mfma_f32_16x16x32_bf16 v[32:35], v[216:219], v[72:75], v[32:35]
    v_fmac_f32_dpp v28, v28, v25 row_newbcast:8 row_mask:0xf bank_mask:0xf
    v_fmac_f32_dpp v29, v29, v25 row_newbcast:8 row_mask:0xf bank_mask:0xf
    v_mfma_f32_16x16x32_bf16 v[32:35], v[220:223], v[76:79], v[32:35]
    v_fmac_f32_dpp v30, v30, v25 row_newbcast:8 row_mask:0xf bank_mask:0xf
    v_fmac_f32_dpp v31, v31, v25 row_newbcast:8 row_mask:0xf bank_mask:0xf
    v_mfma_f32_16x16x32_bf16 v[32:35], v[224:227], v[80:83], v[32:35]
    v_mul_f32 v36, v9, v28
    v_mul_f32 v37, v9, v29
    v_mfma_f32_16x16x32_bf16 v[32:35], v[228:231], v[84:87], v[32:35]
    v_mul_f32 v38, v9, v30
    v_mul_f32 v39, v9, v31
    v_mfma_f32_16x16x32_bf16 v[32:35], v[232:235], v[88:91], v[32:35]
    v_exp_f32 v36, v36
    v_exp_f32 v37, v37
    s_waitcnt lgkmcnt(4)
    v_mfma_f32_16x16x32_bf16 v[32:35], v[236:239], v[92:95], v[32:35]
    v_exp_f32 v38, v38
    v_exp_f32 v39, v39
    v_mfma_f32_16x16x32_bf16 v[32:35], v[240:243], v[96:99], v[32:35]
    v_mul_f32 v28, v28, v10
    v_mul_f32 v29, v29, v10
    v_mfma_f32_16x16x32_bf16 v[32:35], v[244:247], v[100:103], v[32:35]
    v_mul_f32 v30, v30, v10
    v_mul_f32 v31, v31, v10
    s_waitcnt lgkmcnt(0)
    v_mfma_f32_16x16x32_bf16 v[32:35], v[248:251], v[104:107], v[32:35]
    v_add_f32 v36, 1.0, v36
    v_add_f32 v37, 1.0, v37
    v_mfma_f32_16x16x32_bf16 v[32:35], v[252:255], v[108:111], v[32:35]
    v_add_f32 v38, 1.0, v38
    v_add_f32 v39, 1.0, v39
    v_rcp_f32 v36, v36
    v_rcp_f32 v37, v37
    v_rcp_f32 v38, v38
    v_rcp_f32 v39, v39
    v_mul_f32 v28, v28, v36
    v_mul_f32 v29, v29, v37
    v_mul_f32 v30, v30, v38
    v_mul_f32 v31, v31, v39
    v_fmac_f32_dpp v32, v32, v25 row_newbcast:8 row_mask:0xf bank_mask:0xf
    v_fmac_f32_dpp v33, v33, v25 row_newbcast:8 row_mask:0xf bank_mask:0xf
    v_fmac_f32_dpp v34, v34, v25 row_newbcast:8 row_mask:0xf bank_mask:0xf
    v_fmac_f32_dpp v35, v35, v25 row_newbcast:8 row_mask:0xf bank_mask:0xf
    v_mul_f32 v28, v28, v32
    v_mul_f32 v29, v29, v33
    v_mul_f32 v30, v30, v34
    v_mul_f32 v31, v31, v35
    v_cvt_pk_bf16_f32 v28, v28, v29
    v_cvt_pk_bf16_f32 v29, v30, v31
    ds_write_b64 v27, v[28:29]
    s_waitcnt lgkmcnt(0)
    s_barrier
    s_cmp_lg_u32 s39, 4
    s_cbranch_scc1 L_gu_end
    v_lshlrev_b32 v36, 5, v13
    v_not_b32 v37, v36
    v_ashrrev_i32 v38, 31, v37
    v_or_b32 v38, 0x80000000, v38
    v_xor_b32 v36, v36, v38
    v_and_b32 v36, 0xffff0000, v36
    v_mul_f32 v36, 0xbfb8aa3b, v36
    v_exp_f32 v36, v36
    v_bfe_u32 v4, v37, 5, 11
    v_mov_b32 v6, v12
    v_mov_b32 v7, v15
    v_add_f32 v36, 1.0, v36
    v_rcp_f32 v5, v36
    v_lshl_or_b32 v4, v4, 8, s45
    s_mov_b64 exec, 0xffff
    global_store_dwordx4 v8, v[4:7], s[36:37] sc1
    s_cmp_lg_u32 s50, 0
    s_cbranch_scc1 L_gu_end
    v_mov_b32 v9, 0
    v_mov_b32 v10, s38
    s_mov_b64 exec, 1
    global_store_dword v9, v10, s[36:37] sc1
L_gu_end:
    s_endpgm
L_end:
    s_endpgm
.fill 96, 4, 0xbf810000
L_last:
.section .rodata,"a"
.p2align 6
.amdhsa_kernel recurrent_scan__ssm_conv_s4__moe_arch_mod__prompt_kernel
  .amdhsa_next_free_vgpr 256
  .amdhsa_next_free_sgpr 102
  .amdhsa_accum_offset 256
  .amdhsa_group_segment_fixed_size 0
  .amdhsa_kernarg_size 136
  .amdhsa_user_sgpr_count 2
  .amdhsa_user_sgpr_kernarg_segment_ptr 1
  .amdhsa_system_sgpr_workgroup_id_x 1
  .amdhsa_float_denorm_mode_32 3
.end_amdhsa_kernel
```

```asm
; @launch grid=(256,1,1) block=(512,1,1) lds=163840
.amdgcn_target "amdgcn-amd-amdhsa--gfx950"
.text
.globl recurrent_scan__ssm_conv_s4__moe_arch_mod__prompt_kernel
.p2align 8
.type recurrent_scan__ssm_conv_s4__moe_arch_mod__prompt_kernel,@function
recurrent_scan__ssm_conv_s4__moe_arch_mod__prompt_kernel:
    s_load_dwordx16 s[4:19], s[0:1], 0
    s_load_dwordx16 s[20:35], s[0:1], 64
    s_load_dwordx2 s[36:37], s[0:1], 128
    s_cmp_ge_u32 s2, 256
    s_cbranch_scc1 L_end
    s_lshr_b32 s41, s2, 3
    s_getpc_b64 s[42:43]
L_pc:
    s_mul_i32 s47, s41, 768
    s_add_u32 s42, s42, s47
    s_addc_u32 s43, s43, 0
    v_lshlrev_b32 v4, 7, v0
    v_mov_b32 v5, s43
    v_add_co_u32 v4, vcc, s42, v4
    v_lshrrev_b32 v1, 6, v0
    v_and_b32 v2, 63, v0
    v_addc_co_u32 v5, vcc, 0, v5, vcc
    s_sub_u32 s47, L_last - L_pc - 4, s47
    s_ashr_i32 s47, s47, 7
    s_min_i32 s47, s47, 5
    v_cmp_ge_i32 vcc, s47, v0
    s_nop 0
    s_and_saveexec_b64 s[48:49], vcc
    s_cbranch_execz L_nopf
    global_load_dword v255, v[4:5], off
L_nopf:
    s_mov_b64 exec, -1
    v_readfirstlane_b32 s39, v1
    s_and_b32 s40, s2, 7
    s_mul_i32 s42, s2, 9216
    v_lshlrev_b32 v3, 4, v2
    v_lshlrev_b32 v4, 1, v2
    v_mul_u32_u24 v5, 1152, v1
    v_add3_u32 v6, v5, v3, s42
    v_add3_u32 v7, v5, v4, s42
    s_waitcnt lgkmcnt(0)
    global_load_dwordx4 v[12:15], v6, s[4:5]
    global_load_ushort v16, v7, s[4:5] offset:1024
    s_load_dword s38, s[36:37], 0
    global_load_dwordx4 v[20:23], v3, s[24:25]
    global_load_ushort v24, v4, s[24:25] offset:1024
    s_and_b32 s51, s39, 3
    s_lshr_b32 s52, s39, 2
    s_cmp_lt_u32 s41, 18
    s_cbranch_scc1 L_conv_pre
    s_cmp_lt_u32 s41, 27
    s_cbranch_scc1 L_ffn_pre
    s_sub_u32 s53, s41, 27
    s_and_b32 s58, s39, 1
    s_lshr_b32 s43, s39, 1
    s_mul_i32 s42, s43, 320
    s_add_u32 s42, s42, 1152
    s_cmp_eq_u32 s43, 0
    s_cmovk_i32 s42, 1152
    s_cmp_eq_u32 s43, 1
    s_cselect_b32 s48, 1, 0
    s_mul_i32 s59, s58, 320
    s_add_u32 s59, s59, 0
    s_cmp_eq_u32 s43, 3
    s_cselect_b32 s42, s59, s42
    s_cmovk_i32 s58, 2
    s_lshl_b32 s53, s53, 6
    s_add_u32 s42, s42, s53
    s_mul_i32 s43, s40, 1152
    s_add_u32 s43, s43, 884736
    s_mul_i32 s59, s40, 663552
    s_cmp_eq_u32 s58, 0
    s_cselect_b32 s56, s26, s28
    s_cselect_b32 s57, s27, s29
    s_cmp_eq_u32 s58, 2
    s_cselect_b32 s56, s30, s56
    s_cselect_b32 s57, s31, s57
    s_cselect_b32 s43, s59, s43
    s_movk_i32 s58, 128
    s_movk_i32 s59, 8064
    s_movk_i32 s60, 4319
    s_cmov_b32 s58, 73728
    s_cmov_b32 s59, -663424
    s_cmovk_i32 s60, 5183
    v_add_u32 v76, s42, v2
    v_min_u32 v76, s60, v76
    v_mul_u32_u24 v63, 7282, v76
    v_lshrrev_b32 v63, 16, v63
    v_mul_u32_u24 v76, s58, v76
    v_mad_i32_i24 v76, v63, s59, v76
    v_add_u32 v76, s43, v76
    s_mov_b32 s49, 0
    s_branch L_lnp
L_ffn_pre:
    s_sub_u32 s54, s41, 18
    s_mul_i32 s50, s40, 9
    s_add_u32 s50, s50, s54
    v_bfe_u32 v76, v0, 3, 5
    v_bfe_u32 v61, v0, 4, 1
    v_bfe_u32 v62, v0, 6, 1
    v_lshl_add_u32 v61, v62, 1, v61
    v_lshlrev_b32 v61, 1, v61
    v_and_b32 v62, 7, v0
    v_xor_b32 v61, v61, v62
    v_mul_u32_u24 v76, 9216, v76
    v_lshlrev_b32 v61, 4, v61
    s_lshl_b32 s42, s50, 7
    v_add3_u32 v76, v76, v61, s42
    s_lshl_b32 s53, s51, 10
    s_cmp_eq_u32 s52, 0
    s_cselect_b32 s56, s26, s28
    s_cselect_b32 s57, s27, s29
    s_cselect_b32 s42, 0, 73728
    s_add_u32 s42, s53, s42
    s_mov_b32 s49, s42
    v_mov_b32 v62, 0
    v_mov_b32 v63, 0
    v_lshrrev_b32 v61, 1, v3
    v_add_u32 v61, 147456, v61
    ds_write_b64 v61, v[62:63]
    s_mov_b32 s47, 3
    s_mov_b32 s48, 0
    s_branch L_lnp
L_conv_pre:
    s_lshl_b32 s50, s40, 4
    s_lshl_b32 s42, s40, 1
    s_add_u32 s42, s42, 112
    s_cmp_ge_u32 s41, 16
    s_cselect_b32 s50, s42, s50
    s_add_u32 s50, s50, s41
    s_lshl_b32 s53, s50, 2
    s_add_u32 s53, s53, s51
    s_lshl_b32 s42, s53, 8
    s_lshl_b32 s43, s52, 7
    s_add_u32 s42, s42, s43
    v_add_u32 v60, s42, v4
    s_lshl_b32 s54, s50, 3
    s_lshl_b32 s42, s53, 1
    v_mov_b32 v61, s42
    v_mov_b64 v[64:65], 0
    v_mov_b64 v[66:67], 0
    v_mov_b64 v[68:69], 0
    v_mov_b64 v[70:71], 0
    s_barrier
    global_load_short_d16_hi v70, v61, s[18:19]
    global_load_short_d16_hi v64, v60, s[6:7]
    global_load_short_d16_hi v65, v60, s[8:9]
    global_load_short_d16_hi v66, v60, s[10:11]
    global_load_short_d16_hi v67, v60, s[12:13]
    global_load_short_d16_hi v68, v60, s[14:15]
    global_load_short_d16_hi v69, v60, s[16:17]
    global_load_short_d16_hi v71, v61, s[20:21]
    global_load_ushort v1, v61, s[20:21]
    s_lshr_b32 s42, s51, 1
    s_mul_i32 s42, s42, 2112
    s_and_b32 s58, s51, 1
    s_mul_i32 s43, s51, 1152
    s_add_u32 s43, s43, 640
    s_lshr_b32 s47, s39, 1
    s_cmp_eq_u32 s47, 0
    s_cmovk_i32 s42, 3168
    s_cmp_eq_u32 s52, 0
    s_cselect_b32 s42, s43, s42
    s_cmovk_i32 s58, 2
    s_lshl_b32 s43, s41, 6
    s_add_u32 s42, s42, s43
    s_mul_i32 s43, s40, 1152
    s_add_u32 s43, s43, 884736
    s_mul_i32 s59, s40, 663552
    s_cmp_eq_u32 s58, 0
    s_cselect_b32 s56, s26, s28
    s_cselect_b32 s57, s27, s29
    s_cmp_eq_u32 s58, 2
    s_cselect_b32 s56, s30, s56
    s_cselect_b32 s57, s31, s57
    s_cselect_b32 s43, s59, s43
    s_movk_i32 s58, 128
    s_movk_i32 s59, 8064
    s_movk_i32 s60, 4319
    s_cmov_b32 s58, 73728
    s_cmov_b32 s59, -663424
    s_cmovk_i32 s60, 5183
    v_add_u32 v76, s42, v2
    v_min_u32 v76, s60, v76
    v_mul_u32_u24 v63, 7282, v76
    v_lshrrev_b32 v63, 16, v63
    v_mul_u32_u24 v76, s58, v76
    v_mad_i32_i24 v76, v63, s59, v76
    v_add_u32 v76, s43, v76
    s_mul_i32 s55, s51, 33792
    s_lshl_b32 s42, s52, 8
    s_add_u32 m0, s55, s42
    s_mul_i32 s63, s51, 4640
    s_add_u32 s63, s63, 135168
    v_mov_b64 v[84:85], 0
    v_mov_b64 v[86:87], 0
    s_cmp_eq_u32 s52, 0
    s_cbranch_scc1 L_cp_m
    s_setprio 1
    v_min_u32 v83, 29, v2
    v_lshl_add_u32 v83, v83, 4, s63
    ds_write_b128 v83, v[84:87]
    v_and_b32 v88, 0x70, v3
    v_add_u32 v88, 153728, v88
    ds_write_b128 v88, v[84:87]
    s_branch L_cp_e
L_cp_m:
    v_and_b32 v8, 15, v0
    v_bfe_u32 v9, v0, 4, 2
    v_and_b32 v10, 31, v0
    v_and_b32 v11, 32, v0
    v_mul_u32_u24 v78, 528, v10
    v_lshrrev_b32 v11, 1, v11
    v_add3_u32 v78, v78, v11, s55
    v_lshl_add_u32 v10, v10, 5, v11
    s_add_u32 s42, s55, 1072
    v_sub_u32 v81, s42, v10
    v_lshrrev_b32 v77, 2, v10
    s_add_u32 s42, s55, 5564
    v_sub_u32 v77, s42, v77
    v_bfe_i32 v79, v0, 4, 1
    v_sub_u32 v80, 495, v10
    v_ashrrev_i32 v80, 31, v80
    v_sub_u32 v82, 1007, v10
    v_ashrrev_i32 v82, 31, v82
    v_bfe_u32 v10, v0, 3, 2
    v_and_b32 v11, 7, v0
    v_mul_u32_u24 v73, 1216, v10
    v_and_b32 v83, 4, v0
    v_lshl_add_u32 v83, v83, 4, v11
    v_lshl_add_u32 v83, v83, 4, v73
    v_lshlrev_b32 v72, 4, v10
    v_add_u32 v72, 5120, v72
    v_sub_u32 v74, 5, v11
    v_ashrrev_i32 v74, 31, v74
    v_bfi_b32 v83, v74, v72, v83
    v_and_b32 v72, 8, v0
    v_mad_u32_u24 v72, v72, 3, v11
    v_lshlrev_b32 v72, 4, v72
    v_add_u32 v72, 5184, v72
    v_bfe_i32 v74, v0, 5, 1
    v_bfi_b32 v83, v74, v72, v83
    v_add_u32 v83, s55, v83
    v_sub_u32 v74, 4, v11
    v_ashrrev_i32 v74, 31, v74
    v_add_u32 v72, 507, v11
    v_min_u32 v75, 2, v11
    v_bfi_b32 v74, v74, v72, v75
    v_sub_u32 v74, v74, v10
    v_lshl_add_u32 v73, v74, 1, v73
    v_min_u32 v74, 1, v10
    v_lshl_add_u32 v73, v74, 3, v73
    s_add_u32 s42, s55, 58
    v_add_u32 v73, s42, v73
    v_max_u32 v72, 4, v11
    v_mul_u32_u24 v72, 0x202, v72
    v_add_u32 v72, 1284, v72
    v_and_b32 v72, 0x707, v72
L_cp_e:
L_clnp:
    s_mul_i32 s43, s39, 1216
    s_add_u32 s43, s43, 154048
    v_add_u32 v52, s43, v3
    v_add_u32 v53, s43, v4
    s_lshl_b32 s43, s39, 3
    s_add_u32 s43, s43, 163776
    v_mov_b32 v54, s43
    v_bfe_u32 v55, v0, 2, 2
    v_mul_u32_u24 v55, 1216, v55
    v_and_b32 v56, 3, v0
    v_lshl_add_u32 v55, v56, 3, v55
    v_lshrrev_b32 v56, 4, v0
    v_lshl_add_u32 v55, v56, 5, v55
    v_add_u32 v55, 154048, v55
    v_lshrrev_b32 v56, 3, v0
    v_lshlrev_b32 v56, 15, v56
    v_and_b32 v57, 112, v3
    s_lshl_b32 s43, s2, 7
    s_add_u32 s43, s43, 2101248
    v_add3_u32 v56, v56, v57, s43
    v_mov_b32 v40, 0
    v_mov_b32 v41, 0
    v_mov_b32 v42, 0
    v_mov_b32 v43, 0
    v_mov_b32 v44, 0x3ae38e39
    v_mov_b32 v38, 0xbfffbfff
    v_mov_b32 v37, 0xffff
    s_lshl_b32 s58, s2, 3
    s_add_u32 s58, s58, s39
    s_xor_b32 s58, s58, 0x7ff
    s_lshl_b32 s58, s58, 5
    s_waitcnt lgkmcnt(0)
    s_add_u32 s38, s38, 0x9e370001
    s_lshr_b32 s44, s38, 16
    s_and_b32 s45, s38, 0xff
    s_and_b32 s46, s38, 0xfb
    s_bitcmp0_b32 s38, 0
    s_cselect_b32 s43, 4, 0
    s_or_b32 s46, s46, s43
    s_bitcmp1_b32 s46, s39
    s_cselect_b32 s43, 0x40004000, 0
    v_mov_b32 v39, s43
    s_xor_b32 s58, s58, s44
    v_mov_b32 v57, s58
    s_mov_b32 s42, 0x3f803f80
    s_cmp_eq_u32 s47, 2
    s_cbranch_scc0 L_clw
    global_load_dword v1, v76, s[56:57]
    s_waitcnt vmcnt(10)
    s_branch L_cln
L_clw:
    s_waitcnt vmcnt(9)
L_cln:
    v_dot2c_f32_bf16 v40, s42, v12
    v_dot2c_f32_bf16 v41, v12, v12
    v_dot2c_f32_bf16 v42, v12, v20
    v_dot2c_f32_bf16 v43, s42, v20
    v_dot2c_f32_bf16 v40, s42, v13
    v_dot2c_f32_bf16 v41, v13, v13
    v_dot2c_f32_bf16 v42, v13, v21
    v_dot2c_f32_bf16 v43, s42, v21
    v_dot2c_f32_bf16 v40, s42, v14
    v_dot2c_f32_bf16 v41, v14, v14
    v_dot2c_f32_bf16 v42, v14, v22
    v_dot2c_f32_bf16 v43, s42, v22
    v_dot2c_f32_bf16 v40, s42, v15
    v_dot2c_f32_bf16 v41, v15, v15
    v_dot2c_f32_bf16 v42, v15, v23
    v_dot2c_f32_bf16 v43, s42, v23
    v_dot2c_f32_bf16 v40, s42, v16
    v_dot2c_f32_bf16 v41, v16, v16
    v_dot2c_f32_bf16 v42, v16, v24
    v_dot2c_f32_bf16 v43, s42, v24
    v_lshlrev_b32 v36, 16, v16
    v_lshlrev_b32 v28, 16, v12
    v_and_b32 v29, 0xffff0000, v12
    v_permlane32_swap_b32 v40, v42
    v_permlane32_swap_b32 v41, v43
    v_add_f32 v40, v40, v42
    v_add_f32 v41, v41, v43
    v_lshlrev_b32 v30, 16, v13
    v_and_b32 v31, 0xffff0000, v13
    v_permlane16_swap_b32 v40, v41
    v_add_f32 v40, v40, v41
    v_lshlrev_b32 v32, 16, v14
    v_and_b32 v33, 0xffff0000, v14
    v_add_f32_dpp v40, v40, v40 row_ror:8 row_mask:0xf bank_mask:0xf
    v_lshlrev_b32 v34, 16, v15
    v_and_b32 v35, 0xffff0000, v15
    v_add_f32_dpp v40, v40, v40 row_ror:4 row_mask:0xf bank_mask:0xf
    s_nop 1
    v_add_f32_dpp v40, v40, v40 row_ror:2 row_mask:0xf bank_mask:0xf
    s_nop 1
    v_add_f32_dpp v40, v40, v40 row_ror:1 row_mask:0xf bank_mask:0xf
    s_nop 0
    v_readlane_b32 s58, v40, 0
    v_readlane_b32 s59, v40, 16
    v_readlane_b32 s60, v40, 32
    v_readlane_b32 s61, v40, 48
    v_mul_f32 v40, s58, v44
    v_mul_f32 v41, s59, v44
    v_fma_f32 v41, -v40, v40, v41
    v_max_f32 v41, 0, v41
    v_cvt_pk_bf16_f32 v44, v41, v40
    v_lshlrev_b32 v41, 16, v44
    v_add_f32 v41, 0x3727c5ac, v41
    v_cvt_pk_bf16_f32 v41, v41, v41
    v_and_b32 v41, 0xffff0000, v41
    v_mul_f32 v41, 0x44800000, v41
    v_sqrt_f32 v41, v41
    v_and_b32 v49, 0xffff0000, v44
    v_cvt_pk_bf16_f32 v50, v49, v41
    v_and_b32 v41, 0xffff0000, v50
    v_rcp_f32 v46, v41
    v_mul_f32 v42, s61, v49
    v_mul_f32 v47, v49, v46
    v_fma_f32 v28, v28, v46, -v47
    v_fma_f32 v29, v29, v46, -v47
    v_fma_f32 v30, v30, v46, -v47
    v_fma_f32 v31, v31, v46, -v47
    v_fma_f32 v32, v32, v46, -v47
    v_fma_f32 v33, v33, v46, -v47
    v_fma_f32 v34, v34, v46, -v47
    v_fma_f32 v35, v35, v46, -v47
    v_fma_f32 v36, v36, v46, -v47
    v_cvt_pk_bf16_f32 v28, v28, v29
    v_cvt_pk_bf16_f32 v29, v30, v31
    v_cvt_pk_bf16_f32 v30, v32, v33
    v_cvt_pk_bf16_f32 v31, v34, v35
    v_cvt_pk_bf16_f32 v32, v36, v36
    v_bitop3_b32 v28, v28, v38, v39 bitop3:0xea
    v_bitop3_b32 v29, v29, v38, v39 bitop3:0xea
    v_bitop3_b32 v30, v30, v38, v39 bitop3:0xea
    v_bitop3_b32 v31, v31, v38, v39 bitop3:0xea
    v_bitop3_b32 v32, v32, v38, v39 bitop3:0xea
    ds_write_b128 v52, v[28:31]
    ds_write_b16 v53, v32 offset:1024
    v_sub_f32 v42, s60, v42
    v_mul_f32 v42, 0x42000000, v42
    v_mul_f32 v42, v42, v46
    v_cvt_pk_bf16_f32 v42, v42, v42
    v_ashrrev_i32 v43, 31, v42
    v_or_b32 v43, 0x80000000, v43
    v_xor_b32 v42, v42, v43
    v_bitop3_b32 v51, v37, v57, v42 bitop3:0xca
    s_mov_b64 exec, 1
    ds_write_b64 v54, v[50:51]
    s_mov_b64 exec, -1
    s_waitcnt lgkmcnt(0)
    s_barrier
    s_cmp_eq_u32 s39, 1
    s_cbranch_scc1 L_cln_stat
    ds_read_b64_tr_b16 v[28:29], v55
    ds_read_b64_tr_b16 v[30:31], v55 offset:4864
    s_cmp_eq_u32 s39, 0
    s_cbranch_scc0 L_cln_st
    ds_read_b64_tr_b16 v[32:33], v55 offset:1024
    ds_read_b64_tr_b16 v[34:35], v55 offset:5888
    v_add_u32 v38, 2097152, v56
    s_waitcnt lgkmcnt(0)
    global_store_dwordx4 v38, v[32:35], s[36:37] sc1
    s_branch L_cln_st
L_cln_stat:
    v_and_b32 v41, 0x30, v3
    v_add_u32 v40, 163776, v41
    ds_read_b128 v[48:51], v40
    ds_read_b64_tr_b16 v[28:29], v55
    ds_read_b64_tr_b16 v[30:31], v55 offset:4864
    s_lshl_b32 s43, s2, 6
    s_add_u32 s43, s43, 16384
    v_add_u32 v41, s43, v41
    s_mov_b64 exec, 15
    s_waitcnt lgkmcnt(2)
    global_store_dwordx4 v41, v[48:51], s[36:37] sc1
    s_mov_b64 exec, -1
L_cln_st:
    s_waitcnt lgkmcnt(0)
    global_store_dwordx4 v56, v[28:31], s[36:37] sc1
    s_waitcnt vmcnt(2)
    v_mul_f32 v70, 0x3fb8aa3b, v70
    v_exp_f32 v70, v70
    v_mov_b32 v34, 0x3f80
    ds_write_addtid_b32 v34
    v_cvt_pk_bf16_f32 v70, v70, v70
    v_and_b32 v70, 0xffff0000, v70
    v_mul_f32 v64, v70, v64
    v_mul_f32 v65, v70, v65
    v_mul_f32 v70, 0x44800000, v70
    v_mul_f32 v64, 0x3fb8aa3b, v64
    v_mul_f32 v65, 0x3e22f983, v65
    v_mul_f32 v66, v70, v66
    v_mul_f32 v67, v70, v67
    v_mul_f32 v13, 0x41800000, v64
    v_mul_f32 v17, 0x41800000, v65
    v_mul_f32 v14, 0x44000000, v64
    v_mul_f32 v18, 0x44000000, v65
    v_exp_f32 v12, v64
    v_fract_f32 v16, v65
    v_exp_f32 v13, v13
    v_fract_f32 v17, v17
    v_exp_f32 v14, v14
    v_fract_f32 v18, v18
    v_pk_mul_f32 v[20:21], v[68:69], v[66:67] op_sel:[0,0] op_sel_hi:[0,1] neg_hi:[0,1]
    v_pk_fma_f32 v[90:91], v[68:69], v[66:67], v[20:21] op_sel:[1,1,0] op_sel_hi:[1,0,1] neg_lo:[0,1,0] neg_hi:[0,1,0]
    v_cos_f32 v22, v16
    v_sin_f32 v23, v16
    v_cos_f32 v24, v17
    v_sin_f32 v25, v17
    v_cos_f32 v26, v18
    v_sin_f32 v27, v18
    v_cvt_pk_bf16_f32 v35, v90, v91
    ds_write_addtid_b32 v35 offset:16896
    v_mul_f32 v22, v12, v22
    v_mul_f32 v23, -v12, v23
    v_mul_f32 v24, v13, v24
    v_mul_f32 v25, v13, v25
    v_mul_f32 v26, v14, v26
    v_mul_f32 v27, -v14, v27
    v_cvt_pk_bf16_f32 v36, v24, v25
    ds_write_addtid_b32 v36 offset:528
L_cs2:
    v_pk_mul_f32 v[30:31], v[24:25], v[24:25] op_sel:[0,0] op_sel_hi:[0,1]
    v_pk_fma_f32 v[28:29], v[24:25], v[24:25], v[30:31] op_sel:[1,1,0] op_sel_hi:[1,0,1] neg_lo:[0,1,0]
    v_cvt_pk_bf16_f32 v34, v28, v29
    ds_write_addtid_b32 v34 offset:1056
    v_pk_mul_f32 v[32:33], v[90:91], v[22:23] op_sel:[0,0] op_sel_hi:[0,1]
    v_pk_fma_f32 v[92:93], v[90:91], v[22:23], v[32:33] op_sel:[1,1,0] op_sel_hi:[1,0,1] neg_lo:[0,1,0]
    v_cvt_pk_bf16_f32 v35, v92, v93
    ds_write_addtid_b32 v35 offset:17424
    v_pk_mul_f32 v[30:31], v[28:29], v[24:25] op_sel:[0,0] op_sel_hi:[0,1]
    v_pk_fma_f32 v[28:29], v[28:29], v[24:25], v[30:31] op_sel:[1,1,0] op_sel_hi:[1,0,1] neg_lo:[0,1,0]
    v_cvt_pk_bf16_f32 v36, v28, v29
    ds_write_addtid_b32 v36 offset:1584
    v_pk_mul_f32 v[32:33], v[92:93], v[22:23] op_sel:[0,0] op_sel_hi:[0,1]
    v_pk_fma_f32 v[94:95], v[92:93], v[22:23], v[32:33] op_sel:[1,1,0] op_sel_hi:[1,0,1] neg_lo:[0,1,0]
    v_cvt_pk_bf16_f32 v37, v94, v95
    ds_write_addtid_b32 v37 offset:17952
    s_cmp_eq_u32 s47, 3
    s_cbranch_scc0 L_ct1
    global_load_dword v1, v76, s[56:57]
L_ct1:
    v_pk_mul_f32 v[30:31], v[28:29], v[24:25] op_sel:[0,0] op_sel_hi:[0,1]
    v_pk_fma_f32 v[28:29], v[28:29], v[24:25], v[30:31] op_sel:[1,1,0] op_sel_hi:[1,0,1] neg_lo:[0,1,0]
    v_cvt_pk_bf16_f32 v34, v28, v29
    ds_write_addtid_b32 v34 offset:2112
    v_pk_mul_f32 v[32:33], v[94:95], v[22:23] op_sel:[0,0] op_sel_hi:[0,1]
    v_pk_fma_f32 v[96:97], v[94:95], v[22:23], v[32:33] op_sel:[1,1,0] op_sel_hi:[1,0,1] neg_lo:[0,1,0]
    v_cvt_pk_bf16_f32 v35, v96, v97
    ds_write_addtid_b32 v35 offset:18480
    v_pk_mul_f32 v[30:31], v[28:29], v[24:25] op_sel:[0,0] op_sel_hi:[0,1]
    v_pk_fma_f32 v[28:29], v[28:29], v[24:25], v[30:31] op_sel:[1,1,0] op_sel_hi:[1,0,1] neg_lo:[0,1,0]
    v_cvt_pk_bf16_f32 v36, v28, v29
    ds_write_addtid_b32 v36 offset:2640
    v_pk_mul_f32 v[32:33], v[96:97], v[22:23] op_sel:[0,0] op_sel_hi:[0,1]
    v_pk_fma_f32 v[98:99], v[96:97], v[22:23], v[32:33] op_sel:[1,1,0] op_sel_hi:[1,0,1] neg_lo:[0,1,0]
    v_cvt_pk_bf16_f32 v37, v98, v99
    ds_write_addtid_b32 v37 offset:21120
    v_pk_mul_f32 v[30:31], v[28:29], v[24:25] op_sel:[0,0] op_sel_hi:[0,1]
    v_pk_fma_f32 v[28:29], v[28:29], v[24:25], v[30:31] op_sel:[1,1,0] op_sel_hi:[1,0,1] neg_lo:[0,1,0]
    v_cvt_pk_bf16_f32 v34, v28, v29
    ds_write_addtid_b32 v34 offset:3168
    v_pk_mul_f32 v[32:33], v[98:99], v[22:23] op_sel:[0,0] op_sel_hi:[0,1]
    v_pk_fma_f32 v[100:101], v[98:99], v[22:23], v[32:33] op_sel:[1,1,0] op_sel_hi:[1,0,1] neg_lo:[0,1,0]
    v_cvt_pk_bf16_f32 v35, v100, v101
    ds_write_addtid_b32 v35 offset:21648
    v_pk_mul_f32 v[30:31], v[28:29], v[24:25] op_sel:[0,0] op_sel_hi:[0,1]
    v_pk_fma_f32 v[28:29], v[28:29], v[24:25], v[30:31] op_sel:[1,1,0] op_sel_hi:[1,0,1] neg_lo:[0,1,0]
    v_cvt_pk_bf16_f32 v36, v28, v29
    ds_write_addtid_b32 v36 offset:3696
    v_pk_mul_f32 v[32:33], v[100:101], v[22:23] op_sel:[0,0] op_sel_hi:[0,1]
    v_pk_fma_f32 v[102:103], v[100:101], v[22:23], v[32:33] op_sel:[1,1,0] op_sel_hi:[1,0,1] neg_lo:[0,1,0]
    v_cvt_pk_bf16_f32 v37, v102, v103
    ds_write_addtid_b32 v37 offset:22176
    v_pk_mul_f32 v[30:31], v[28:29], v[24:25] op_sel:[0,0] op_sel_hi:[0,1]
    v_pk_fma_f32 v[28:29], v[28:29], v[24:25], v[30:31] op_sel:[1,1,0] op_sel_hi:[1,0,1] neg_lo:[0,1,0]
    v_cvt_pk_bf16_f32 v34, v28, v29
    ds_write_addtid_b32 v34 offset:4224
    v_pk_mul_f32 v[32:33], v[102:103], v[22:23] op_sel:[0,0] op_sel_hi:[0,1]
    v_pk_fma_f32 v[104:105], v[102:103], v[22:23], v[32:33] op_sel:[1,1,0] op_sel_hi:[1,0,1] neg_lo:[0,1,0]
    v_cvt_pk_bf16_f32 v35, v104, v105
    ds_write_addtid_b32 v35 offset:22704
    v_pk_mul_f32 v[30:31], v[28:29], v[24:25] op_sel:[0,0] op_sel_hi:[0,1]
    v_pk_fma_f32 v[28:29], v[28:29], v[24:25], v[30:31] op_sel:[1,1,0] op_sel_hi:[1,0,1] neg_lo:[0,1,0]
    v_cvt_pk_bf16_f32 v36, v28, v29
    ds_write_addtid_b32 v36 offset:4752
    v_pk_mul_f32 v[32:33], v[104:105], v[22:23] op_sel:[0,0] op_sel_hi:[0,1]
    v_pk_fma_f32 v[106:107], v[104:105], v[22:23], v[32:33] op_sel:[1,1,0] op_sel_hi:[1,0,1] neg_lo:[0,1,0]
    v_cvt_pk_bf16_f32 v12, v106, v107
    ds_write_addtid_b32 v12 offset:19008
    v_pk_mul_f32 v[30:31], v[28:29], v[24:25] op_sel:[0,0] op_sel_hi:[0,1]
    v_pk_fma_f32 v[28:29], v[28:29], v[24:25], v[30:31] op_sel:[1,1,0] op_sel_hi:[1,0,1] neg_lo:[0,1,0]
    v_cvt_pk_bf16_f32 v34, v28, v29
    ds_write_addtid_b32 v34 offset:5280
    v_pk_mul_f32 v[32:33], v[106:107], v[22:23] op_sel:[0,0] op_sel_hi:[0,1]
    v_pk_fma_f32 v[108:109], v[106:107], v[22:23], v[32:33] op_sel:[1,1,0] op_sel_hi:[1,0,1] neg_lo:[0,1,0]
    v_cvt_pk_bf16_f32 v13, v108, v109
    ds_write_addtid_b32 v13 offset:19536
    v_pk_mul_f32 v[30:31], v[28:29], v[24:25] op_sel:[0,0] op_sel_hi:[0,1]
    v_pk_fma_f32 v[28:29], v[28:29], v[24:25], v[30:31] op_sel:[1,1,0] op_sel_hi:[1,0,1] neg_lo:[0,1,0]
    v_cvt_pk_bf16_f32 v36, v28, v29
    ds_write_addtid_b32 v36 offset:5808
    v_pk_mul_f32 v[32:33], v[108:109], v[22:23] op_sel:[0,0] op_sel_hi:[0,1]
    v_pk_fma_f32 v[110:111], v[108:109], v[22:23], v[32:33] op_sel:[1,1,0] op_sel_hi:[1,0,1] neg_lo:[0,1,0]
    v_cvt_pk_bf16_f32 v14, v110, v111
    ds_write_addtid_b32 v14 offset:20064
    v_pk_mul_f32 v[30:31], v[28:29], v[24:25] op_sel:[0,0] op_sel_hi:[0,1]
    v_pk_fma_f32 v[28:29], v[28:29], v[24:25], v[30:31] op_sel:[1,1,0] op_sel_hi:[1,0,1] neg_lo:[0,1,0]
    v_cvt_pk_bf16_f32 v34, v28, v29
    ds_write_addtid_b32 v34 offset:6336
    v_pk_mul_f32 v[32:33], v[110:111], v[22:23] op_sel:[0,0] op_sel_hi:[0,1]
    v_pk_fma_f32 v[112:113], v[110:111], v[22:23], v[32:33] op_sel:[1,1,0] op_sel_hi:[1,0,1] neg_lo:[0,1,0]
    v_cvt_pk_bf16_f32 v35, v112, v113
    ds_write_addtid_b32 v35 offset:20592
    v_pk_mul_f32 v[30:31], v[28:29], v[24:25] op_sel:[0,0] op_sel_hi:[0,1]
    v_pk_fma_f32 v[28:29], v[28:29], v[24:25], v[30:31] op_sel:[1,1,0] op_sel_hi:[1,0,1] neg_lo:[0,1,0]
    v_cvt_pk_bf16_f32 v36, v28, v29
    ds_write_addtid_b32 v36 offset:6864
    v_pk_mul_f32 v[32:33], v[112:113], v[22:23] op_sel:[0,0] op_sel_hi:[0,1]
    v_pk_fma_f32 v[114:115], v[112:113], v[22:23], v[32:33] op_sel:[1,1,0] op_sel_hi:[1,0,1] neg_lo:[0,1,0]
    v_cvt_pk_bf16_f32 v37, v114, v115
    ds_write_addtid_b32 v37 offset:23232
    v_pk_mul_f32 v[30:31], v[28:29], v[24:25] op_sel:[0,0] op_sel_hi:[0,1]
    v_pk_fma_f32 v[28:29], v[28:29], v[24:25], v[30:31] op_sel:[1,1,0] op_sel_hi:[1,0,1] neg_lo:[0,1,0]
    v_cvt_pk_bf16_f32 v34, v28, v29
    ds_write_addtid_b32 v34 offset:7392
    v_pk_mul_f32 v[32:33], v[114:115], v[22:23] op_sel:[0,0] op_sel_hi:[0,1]
    v_pk_fma_f32 v[116:117], v[114:115], v[22:23], v[32:33] op_sel:[1,1,0] op_sel_hi:[1,0,1] neg_lo:[0,1,0]
    v_cvt_pk_bf16_f32 v35, v116, v117
    ds_write_addtid_b32 v35 offset:23760
    v_pk_mul_f32 v[30:31], v[28:29], v[24:25] op_sel:[0,0] op_sel_hi:[0,1]
    v_pk_fma_f32 v[28:29], v[28:29], v[24:25], v[30:31] op_sel:[1,1,0] op_sel_hi:[1,0,1] neg_lo:[0,1,0]
    v_cvt_pk_bf16_f32 v36, v28, v29
    ds_write_addtid_b32 v36 offset:7920
    v_pk_mul_f32 v[32:33], v[116:117], v[22:23] op_sel:[0,0] op_sel_hi:[0,1]
    v_pk_fma_f32 v[118:119], v[116:117], v[22:23], v[32:33] op_sel:[1,1,0] op_sel_hi:[1,0,1] neg_lo:[0,1,0]
    v_cvt_pk_bf16_f32 v37, v118, v119
    ds_write_addtid_b32 v37 offset:24288
    v_pk_mul_f32 v[30:31], v[28:29], v[24:25] op_sel:[0,0] op_sel_hi:[0,1]
    v_pk_fma_f32 v[28:29], v[28:29], v[24:25], v[30:31] op_sel:[1,1,0] op_sel_hi:[1,0,1] neg_lo:[0,1,0]
    v_cvt_pk_bf16_f32 v34, v28, v29
    ds_write_addtid_b32 v34 offset:8448
    v_pk_mul_f32 v[32:33], v[118:119], v[22:23] op_sel:[0,0] op_sel_hi:[0,1]
    v_pk_fma_f32 v[120:121], v[118:119], v[22:23], v[32:33] op_sel:[1,1,0] op_sel_hi:[1,0,1] neg_lo:[0,1,0]
    v_cvt_pk_bf16_f32 v35, v120, v121
    ds_write_addtid_b32 v35 offset:24816
    v_pk_mul_f32 v[30:31], v[28:29], v[24:25] op_sel:[0,0] op_sel_hi:[0,1]
    v_pk_fma_f32 v[28:29], v[28:29], v[24:25], v[30:31] op_sel:[1,1,0] op_sel_hi:[1,0,1] neg_lo:[0,1,0]
    v_cvt_pk_bf16_f32 v36, v28, v29
    ds_write_addtid_b32 v36 offset:8976
    v_pk_mul_f32 v[32:33], v[120:121], v[22:23] op_sel:[0,0] op_sel_hi:[0,1]
    v_pk_fma_f32 v[122:123], v[120:121], v[22:23], v[32:33] op_sel:[1,1,0] op_sel_hi:[1,0,1] neg_lo:[0,1,0]
    v_cvt_pk_bf16_f32 v37, v122, v123
    ds_write_addtid_b32 v37 offset:27456
    v_pk_mul_f32 v[30:31], v[28:29], v[24:25] op_sel:[0,0] op_sel_hi:[0,1]
    v_pk_fma_f32 v[28:29], v[28:29], v[24:25], v[30:31] op_sel:[1,1,0] op_sel_hi:[1,0,1] neg_lo:[0,1,0]
    v_cvt_pk_bf16_f32 v34, v28, v29
    ds_write_addtid_b32 v34 offset:9504
    v_pk_mul_f32 v[32:33], v[122:123], v[22:23] op_sel:[0,0] op_sel_hi:[0,1]
    v_pk_fma_f32 v[124:125], v[122:123], v[22:23], v[32:33] op_sel:[1,1,0] op_sel_hi:[1,0,1] neg_lo:[0,1,0]
    v_cvt_pk_bf16_f32 v35, v124, v125
    ds_write_addtid_b32 v35 offset:27984
    v_pk_mul_f32 v[30:31], v[28:29], v[24:25] op_sel:[0,0] op_sel_hi:[0,1]
    v_pk_fma_f32 v[28:29], v[28:29], v[24:25], v[30:31] op_sel:[1,1,0] op_sel_hi:[1,0,1] neg_lo:[0,1,0]
    v_cvt_pk_bf16_f32 v36, v28, v29
    ds_write_addtid_b32 v36 offset:10032
    v_pk_mul_f32 v[32:33], v[124:125], v[22:23] op_sel:[0,0] op_sel_hi:[0,1]
    v_pk_fma_f32 v[126:127], v[124:125], v[22:23], v[32:33] op_sel:[1,1,0] op_sel_hi:[1,0,1] neg_lo:[0,1,0]
    v_cvt_pk_bf16_f32 v37, v126, v127
    ds_write_addtid_b32 v37 offset:28512
    v_pk_mul_f32 v[30:31], v[28:29], v[24:25] op_sel:[0,0] op_sel_hi:[0,1]
    v_pk_fma_f32 v[28:29], v[28:29], v[24:25], v[30:31] op_sel:[1,1,0] op_sel_hi:[1,0,1] neg_lo:[0,1,0]
    v_cvt_pk_bf16_f32 v34, v28, v29
    ds_write_addtid_b32 v34 offset:10560
    v_pk_mul_f32 v[32:33], v[98:99], v[26:27] op_sel:[0,0] op_sel_hi:[0,1]
    v_pk_fma_f32 v[98:99], v[98:99], v[26:27], v[32:33] op_sel:[1,1,0] op_sel_hi:[1,0,1] neg_lo:[0,1,0]
    v_cvt_pk_bf16_f32 v35, v98, v99
    ds_write_addtid_b32 v35 offset:29568
    v_pk_mul_f32 v[30:31], v[28:29], v[24:25] op_sel:[0,0] op_sel_hi:[0,1]
    v_pk_fma_f32 v[28:29], v[28:29], v[24:25], v[30:31] op_sel:[1,1,0] op_sel_hi:[1,0,1] neg_lo:[0,1,0]
    v_cvt_pk_bf16_f32 v36, v28, v29
    ds_write_addtid_b32 v36 offset:11088
    v_pk_mul_f32 v[32:33], v[106:107], v[26:27] op_sel:[0,0] op_sel_hi:[0,1]
    v_pk_fma_f32 v[106:107], v[106:107], v[26:27], v[32:33] op_sel:[1,1,0] op_sel_hi:[1,0,1] neg_lo:[0,1,0]
    v_cvt_pk_bf16_f32 v37, v106, v107
    ds_write_addtid_b32 v37 offset:30096
    v_pk_mul_f32 v[30:31], v[28:29], v[24:25] op_sel:[0,0] op_sel_hi:[0,1]
    v_pk_fma_f32 v[28:29], v[28:29], v[24:25], v[30:31] op_sel:[1,1,0] op_sel_hi:[1,0,1] neg_lo:[0,1,0]
    v_cvt_pk_bf16_f32 v34, v28, v29
    ds_write_addtid_b32 v34 offset:11616
    v_pk_mul_f32 v[32:33], v[114:115], v[26:27] op_sel:[0,0] op_sel_hi:[0,1]
    v_pk_fma_f32 v[114:115], v[114:115], v[26:27], v[32:33] op_sel:[1,1,0] op_sel_hi:[1,0,1] neg_lo:[0,1,0]
    v_cvt_pk_bf16_f32 v35, v114, v115
    ds_write_addtid_b32 v35 offset:31680
    v_pk_mul_f32 v[30:31], v[28:29], v[24:25] op_sel:[0,0] op_sel_hi:[0,1]
    v_pk_fma_f32 v[28:29], v[28:29], v[24:25], v[30:31] op_sel:[1,1,0] op_sel_hi:[1,0,1] neg_lo:[0,1,0]
    v_cvt_pk_bf16_f32 v36, v28, v29
    ds_write_addtid_b32 v36 offset:12144
    v_pk_mul_f32 v[32:33], v[122:123], v[26:27] op_sel:[0,0] op_sel_hi:[0,1]
    v_pk_fma_f32 v[122:123], v[122:123], v[26:27], v[32:33] op_sel:[1,1,0] op_sel_hi:[1,0,1] neg_lo:[0,1,0]
    v_cvt_pk_bf16_f32 v37, v122, v123
    ds_write_addtid_b32 v37 offset:32208
    v_pk_mul_f32 v[30:31], v[28:29], v[24:25] op_sel:[0,0] op_sel_hi:[0,1]
    v_pk_fma_f32 v[28:29], v[28:29], v[24:25], v[30:31] op_sel:[1,1,0] op_sel_hi:[1,0,1] neg_lo:[0,1,0]
    v_cvt_pk_bf16_f32 v34, v28, v29
    ds_write_addtid_b32 v34 offset:12672
    v_pk_mul_f32 v[32:33], v[106:107], v[26:27] op_sel:[0,0] op_sel_hi:[0,1]
    v_pk_fma_f32 v[106:107], v[106:107], v[26:27], v[32:33] op_sel:[1,1,0] op_sel_hi:[1,0,1] neg_lo:[0,1,0]
    v_cvt_pk_bf16_f32 v35, v106, v107
    ds_write_addtid_b32 v35 offset:30624
    v_pk_mul_f32 v[30:31], v[28:29], v[24:25] op_sel:[0,0] op_sel_hi:[0,1]
    v_pk_fma_f32 v[28:29], v[28:29], v[24:25], v[30:31] op_sel:[1,1,0] op_sel_hi:[1,0,1] neg_lo:[0,1,0]
    v_cvt_pk_bf16_f32 v36, v28, v29
    ds_write_addtid_b32 v36 offset:13200
    v_pk_mul_f32 v[32:33], v[122:123], v[26:27] op_sel:[0,0] op_sel_hi:[0,1]
    v_pk_fma_f32 v[122:123], v[122:123], v[26:27], v[32:33] op_sel:[1,1,0] op_sel_hi:[1,0,1] neg_lo:[0,1,0]
    v_cvt_pk_bf16_f32 v37, v122, v123
    ds_write_addtid_b32 v37 offset:31152
    v_pk_mul_f32 v[30:31], v[28:29], v[24:25] op_sel:[0,0] op_sel_hi:[0,1]
    v_pk_fma_f32 v[28:29], v[28:29], v[24:25], v[30:31] op_sel:[1,1,0] op_sel_hi:[1,0,1] neg_lo:[0,1,0]
    v_cvt_pk_bf16_f32 v34, v28, v29
    ds_write_addtid_b32 v34 offset:13728
    v_pk_mul_f32 v[32:33], v[106:107], v[26:27] op_sel:[0,0] op_sel_hi:[0,1]
    v_pk_fma_f32 v[106:107], v[106:107], v[26:27], v[32:33] op_sel:[1,1,0] op_sel_hi:[1,0,1] neg_lo:[0,1,0]
    v_cvt_pk_bf16_f32 v35, v106, v107
    ds_write_addtid_b32 v35 offset:32736
    v_pk_mul_f32 v[30:31], v[28:29], v[24:25] op_sel:[0,0] op_sel_hi:[0,1]
    v_pk_fma_f32 v[28:29], v[28:29], v[24:25], v[30:31] op_sel:[1,1,0] op_sel_hi:[1,0,1] neg_lo:[0,1,0]
    v_cvt_pk_bf16_f32 v36, v28, v29
    ds_write_addtid_b32 v36 offset:14256
    v_pk_mul_f32 v[32:33], v[122:123], v[26:27] op_sel:[0,0] op_sel_hi:[0,1]
    v_pk_fma_f32 v[122:123], v[122:123], v[26:27], v[32:33] op_sel:[1,1,0] op_sel_hi:[1,0,1] neg_lo:[0,1,0]
    v_cvt_pk_bf16_f32 v37, v122, v123
    ds_write_addtid_b32 v37 offset:33264
    v_pk_mul_f32 v[30:31], v[28:29], v[24:25] op_sel:[0,0] op_sel_hi:[0,1]
    v_pk_fma_f32 v[28:29], v[28:29], v[24:25], v[30:31] op_sel:[1,1,0] op_sel_hi:[1,0,1] neg_lo:[0,1,0]
    v_cvt_pk_bf16_f32 v34, v28, v29
    ds_write_addtid_b32 v34 offset:14784
    v_pk_mul_f32 v[30:31], v[28:29], v[24:25] op_sel:[0,0] op_sel_hi:[0,1]
    v_pk_fma_f32 v[28:29], v[28:29], v[24:25], v[30:31] op_sel:[1,1,0] op_sel_hi:[1,0,1] neg_lo:[0,1,0]
    v_cvt_pk_bf16_f32 v36, v28, v29
    ds_write_addtid_b32 v36 offset:15312
    v_pk_mul_f32 v[30:31], v[28:29], v[24:25] op_sel:[0,0] op_sel_hi:[0,1]
    v_pk_fma_f32 v[28:29], v[28:29], v[24:25], v[30:31] op_sel:[1,1,0] op_sel_hi:[1,0,1] neg_lo:[0,1,0]
    v_cvt_pk_bf16_f32 v34, v28, v29
    ds_write_addtid_b32 v34 offset:15840
    v_pk_mul_f32 v[30:31], v[28:29], v[24:25] op_sel:[0,0] op_sel_hi:[0,1]
    v_pk_fma_f32 v[28:29], v[28:29], v[24:25], v[30:31] op_sel:[1,1,0] op_sel_hi:[1,0,1] neg_lo:[0,1,0]
    v_cvt_pk_bf16_f32 v36, v28, v29
    ds_write_addtid_b32 v36 offset:16368
    ds_write_addtid_b32 v12 offset:25344
    ds_write_addtid_b32 v13 offset:25872
    ds_write_addtid_b32 v14 offset:26400
    s_cmp_eq_u32 s52, 0
    s_cbranch_scc0 L_helper
    s_setprio 2
    s_barrier
    ds_read_b128 v[128:131], v78 offset:16896
    ds_read_b128 v[132:135], v78 offset:0
    ds_read_b128 v[136:139], v78 offset:16928
    ds_read_b128 v[140:143], v78 offset:32
    ds_read_b128 v[144:147], v78 offset:16960
    ds_read_b128 v[148:151], v78 offset:64
    ds_read_b128 v[152:155], v78 offset:16992
    ds_read_b128 v[156:159], v78 offset:96
    ds_read_b128 v[160:163], v78 offset:17024
    ds_read_b128 v[164:167], v78 offset:128
    ds_read_b128 v[168:171], v78 offset:17056
    ds_read_b128 v[172:175], v78 offset:160
    v_add_u32 v74, -1, v2
    v_and_b32 v71, v71, v74
    v_mul_f32 v71, 0x44800000, v71
    v_and_b32 v10, 3, v8
    v_add_u32 v5, 1, v10
    v_mul_u32_u24 v10, 1214, v10
    s_waitcnt lgkmcnt(10)
    v_mfma_f32_32x32x16_bf16 v[48:63], v[128:131], v[132:135], 0
    ds_read_b128 v[176:179], v78 offset:17088
    ds_read_b128 v[180:183], v78 offset:192
    v_lshl_add_u32 v11, v8, 1, v9
    s_waitcnt lgkmcnt(10)
    v_mfma_f32_32x32x16_bf16 v[48:63], v[136:139], v[140:143], v[48:63]
    ds_read_b128 v[184:187], v78 offset:17120
    ds_read_b128 v[188:191], v78 offset:224
    v_mul_u32_u24 v4, 17, v9
    s_waitcnt lgkmcnt(10)
    v_mfma_f32_32x32x16_bf16 v[48:63], v[144:147], v[148:151], v[48:63]
    ds_read_b128 v[192:195], v78 offset:17152
    ds_read_b128 v[196:199], v78 offset:256
    v_sub_u32 v4, v4, v11
    s_waitcnt lgkmcnt(10)
    v_mfma_f32_32x32x16_bf16 v[48:63], v[152:155], v[156:159], v[48:63]
    ds_read_b128 v[200:203], v78 offset:17184
    ds_read_b128 v[204:207], v78 offset:288
    v_and_b32 v5, 4, v5
    s_waitcnt lgkmcnt(10)
    v_mfma_f32_32x32x16_bf16 v[48:63], v[160:163], v[164:167], v[48:63]
    ds_read_b128 v[208:211], v78 offset:17216
    ds_read_b128 v[212:215], v78 offset:320
    s_add_u32 s43, s55, 3680
    s_waitcnt lgkmcnt(10)
    v_mfma_f32_32x32x16_bf16 v[48:63], v[168:171], v[172:175], v[48:63]
    ds_read_b128 v[216:219], v78 offset:17248
    ds_read_b128 v[220:223], v78 offset:352
    v_lshl_add_u32 v10, v5, 1, v10
    s_waitcnt lgkmcnt(10)
    v_mfma_f32_32x32x16_bf16 v[48:63], v[176:179], v[180:183], v[48:63]
    ds_read_b128 v[224:227], v78 offset:17280
    ds_read_b128 v[228:231], v78 offset:384
    v_sub_u32 v10, v4, v10
    s_waitcnt lgkmcnt(10)
    v_mfma_f32_32x32x16_bf16 v[48:63], v[184:187], v[188:191], v[48:63]
    ds_read_b128 v[232:235], v78 offset:17312
    ds_read_b128 v[236:239], v78 offset:416
    v_add_u32 v10, s43, v10
    s_waitcnt lgkmcnt(10)
    v_mfma_f32_32x32x16_bf16 v[48:63], v[192:195], v[196:199], v[48:63]
    ds_read_b128 v[240:243], v78 offset:17344
    ds_read_b128 v[244:247], v78 offset:448
    v_lshl_add_u32 v11, v11, 4, s63
    s_waitcnt lgkmcnt(10)
    v_mfma_f32_32x32x16_bf16 v[48:63], v[200:203], v[204:207], v[48:63]
    ds_read_b128 v[248:251], v78 offset:17376
    ds_read_b128 v[252:255], v78 offset:480
    s_add_u32 s43, s55, 5116
    s_waitcnt lgkmcnt(10)
    v_mfma_f32_32x32x16_bf16 v[48:63], v[208:211], v[212:215], v[48:63]
    v_lshrrev_b32 v75, 2, v3
    v_sub_u32 v75, s43, v75
    v_lshl_add_u32 v7, v9, 6, v3
    s_waitcnt lgkmcnt(8)
    v_mfma_f32_32x32x16_bf16 v[48:63], v[216:219], v[220:223], v[48:63]
    v_add_u32 v7, s55, v7
    v_lshlrev_b32 v4, 2, v9
    v_sub_u32 v4, v4, v8
    s_waitcnt lgkmcnt(6)
    v_mfma_f32_32x32x16_bf16 v[48:63], v[224:227], v[228:231], v[48:63]
    s_add_u32 s43, s55, 5304
    v_lshl_add_u32 v89, v4, 3, s43
    s_add_u32 s43, s55, 4924
    s_waitcnt lgkmcnt(4)
    v_mfma_f32_32x32x16_bf16 v[48:63], v[232:235], v[236:239], v[48:63]
    v_lshl_add_u32 v4, v4, 2, s43
    s_lshl_b32 s43, s51, 2
    s_add_u32 s43, s43, 153728
    s_waitcnt lgkmcnt(2)
    v_mfma_f32_32x32x16_bf16 v[48:63], v[240:243], v[244:247], v[48:63]
    v_mov_b32 v88, s43
    v_add_u32 v5, 154048, v3
    s_movk_i32 s43, 0x3000
    s_waitcnt lgkmcnt(0)
    v_mfma_f32_32x32x16_bf16 v[48:63], v[248:251], v[252:255], v[48:63]
    v_lshlrev_b32 v6, v8, s43
    v_lshlrev_b32 v16, 3, v9
    v_bfe_u32 v6, v6, v16, 8
    ds_write_b128 v83, v[84:87]
    v_lshl_or_b32 v6, v6, 15, v6
    v_lshrrev_b32 v16, 0, v6
    v_and_b32 v16, 0x10001, v16
    v_lshrrev_b32 v17, 2, v6
    v_and_b32 v17, 0x10001, v17
    v_lshrrev_b32 v18, 4, v6
    v_and_b32 v18, 0x10001, v18
    v_lshrrev_b32 v19, 6, v6
    v_and_b32 v19, 0x10001, v19
    v_add_f32 v48, v48, v71
    v_bitop3_b32 v49, v79, v48, v49 bitop3:0xca
    v_bitop3_b32 v51, v79, v52, v51 bitop3:0xca
    v_bitop3_b32 v53, v79, v52, v53 bitop3:0xca
    v_bitop3_b32 v55, v79, v56, v55 bitop3:0xca
    v_cvt_pk_bf16_f32 v128, v55, v54
    v_cvt_pk_bf16_f32 v129, v53, v52
    v_cvt_pk_bf16_f32 v130, v51, v50
    v_cvt_pk_bf16_f32 v131, v49, v48
    ds_write_b128 v81, v[128:131] offset:0
    v_bitop3_b32 v57, v80, v56, v57 bitop3:0xca
    v_bitop3_b32 v58, v82, v56, v58 bitop3:0xca
    v_cvt_pk_bf16_f32 v132, v56, v55
    v_cvt_pk_bf16_f32 v133, v54, v53
    v_cvt_pk_bf16_f32 v134, v52, v51
    v_cvt_pk_bf16_f32 v135, v50, v49
    ds_write_b128 v81, v[132:135] offset:3648
    v_readlane_b32 s42, v130, 0
    v_readlane_b32 s43, v131, 0
    v_readlane_b32 s58, v128, 63
    v_cvt_pk_bf16_f32 v136, v57, v56
    v_cvt_pk_bf16_f32 v137, v55, v54
    v_cvt_pk_bf16_f32 v138, v53, v52
    v_cvt_pk_bf16_f32 v139, v51, v50
    ds_write_b128 v81, v[136:139] offset:2432
    v_cvt_pk_bf16_f32 v140, v58, v57
    v_cvt_pk_bf16_f32 v141, v56, v55
    v_cvt_pk_bf16_f32 v142, v54, v53
    v_cvt_pk_bf16_f32 v143, v52, v51
    ds_write_b128 v81, v[140:143] offset:1216
    v_mov_b32 v90, v76
    ds_read_b64 v[220:221], v10 offset:576
    s_pack_lh_b32_b16 s42, s58, s42
    ds_read_b64 v[222:223], v10 offset:584
    v_mov_b32 v71, s42
    ds_read_b64 v[252:253], v10 offset:64
    v_perm_b32 v71, v71, s43, v72
    ds_read_b64 v[254:255], v10 offset:72
    ds_write_b16 v73, v71
    ds_read_b64 v[216:217], v10 offset:640
    v_cvt_pk_bf16_f32 v72, v61, v60
    ds_read_b64 v[218:219], v10 offset:648
    v_cvt_pk_bf16_f32 v74, v63, v62
    ds_read_b64 v[248:249], v10 offset:128
    ds_write_b32 v77, v72
    ds_read_b64 v[250:251], v10 offset:136
    v_readlane_b32 s59, v72, 63
    ds_read_b64 v[212:213], v10 offset:704
    ds_write_b32 v75, v74
    ds_read_b64 v[214:215], v10 offset:712
    s_and_b32 s59, s59, 0xffff
    ds_read_b64 v[244:245], v10 offset:192
    v_mul_u32_u24 v16, s59, v16
    ds_read_b64 v[246:247], v10 offset:200
    v_mul_u32_u24 v17, s59, v17
    ds_read_b64 v[208:209], v10 offset:768
    v_mul_u32_u24 v18, s59, v18
    ds_read_b64 v[210:211], v10 offset:776
    v_mul_u32_u24 v19, s59, v19
    ds_read_b64 v[240:241], v10 offset:256
    ds_read_b64 v[242:243], v10 offset:264
    ds_read_b64 v[204:205], v10 offset:832
    ds_read_b64 v[206:207], v10 offset:840
    ds_read_b64 v[236:237], v10 offset:320
    ds_read_b64 v[238:239], v10 offset:328
    ds_read_b64 v[200:201], v10 offset:896
    ds_read_b64 v[202:203], v10 offset:904
    ds_read_b64 v[232:233], v10 offset:384
    ds_read_b64 v[234:235], v10 offset:392
    s_waitcnt lgkmcnt(6)
    s_barrier
    s_setprio 1
    ds_read_b128 v[68:71], v11 offset:0
    ds_read_b128 v[72:75], v11 offset:64
    ds_read_b128 v[76:79], v11 offset:128
    ds_read_b128 v[80:83], v11 offset:192
    ds_read_b128 v[84:87], v11 offset:256
    ds_read_b128 v[132:135], v11 offset:320
    ds_read_b64 v[196:197], v10 offset:960
    ds_read_b64 v[198:199], v10 offset:968
    s_waitcnt lgkmcnt(7)
    v_mfma_f32_16x16x32_bf16 v[44:47], v[220:223], v[68:71], 0
    v_mfma_f32_16x16x32_bf16 v[48:51], v[252:255], v[68:71], 0
    s_cmp_lt_u32 s39, 2
    s_cbranch_scc0 L_ct3
    global_load_dword v1, v90, s[56:57]
L_ct3:
    ds_read_b128 v[68:71], v11 offset:384
    s_waitcnt lgkmcnt(6)
    v_mfma_f32_16x16x32_bf16 v[44:47], v[216:219], v[72:75], v[44:47]
    ds_read_b64 v[228:229], v10 offset:448
    v_mfma_f32_16x16x32_bf16 v[48:51], v[248:251], v[72:75], v[48:51]
    ds_read_b64 v[230:231], v10 offset:456
    v_mfma_f32_16x16x32_bf16 v[44:47], v[212:215], v[76:79], v[44:47]
    ds_read_b64 v[192:193], v10 offset:1024
    ds_read_b64 v[194:195], v10 offset:1032
    v_mfma_f32_16x16x32_bf16 v[48:51], v[244:247], v[76:79], v[48:51]
    ds_read_b128 v[72:75], v11 offset:448
    ds_read_b64 v[224:225], v10 offset:512
    s_waitcnt lgkmcnt(10)
    v_mfma_f32_16x16x32_bf16 v[44:47], v[208:211], v[80:83], v[44:47]
    ds_read_b64 v[226:227], v10 offset:520
    ds_read_b128 v[28:31], v5 offset:1024
    v_mfma_f32_16x16x32_bf16 v[48:51], v[240:243], v[80:83], v[48:51]
    ds_read_b128 v[32:35], v5 offset:2048
    ds_read_b128 v[36:39], v5 offset:3072
    v_mfma_f32_16x16x32_bf16 v[44:47], v[204:207], v[84:87], v[44:47]
    ds_read_b128 v[20:23], v5 offset:4096
    v_mfma_f32_16x16x32_bf16 v[48:51], v[236:239], v[84:87], v[48:51]
    s_waitcnt lgkmcnt(9)
    v_mfma_f32_16x16x32_bf16 v[44:47], v[200:203], v[132:135], v[44:47]
    ds_read_b128 v[24:27], v5 offset:5120
    ds_read_b64 v[12:13], v10 offset:0
    v_mfma_f32_16x16x32_bf16 v[48:51], v[232:235], v[132:135], v[48:51]
    ds_read_b64 v[14:15], v10 offset:8
    v_mfma_f32_16x16x32_bf16 v[44:47], v[196:199], v[68:71], v[44:47]
    ds_read_b128 v[76:79], v11 offset:432
    v_mfma_f32_16x16x32_bf16 v[48:51], v[228:231], v[68:71], v[48:51]
    ds_read_b128 v[80:83], v11 offset:512
    s_waitcnt lgkmcnt(9)
    v_mfma_f32_16x16x32_bf16 v[44:47], v[192:195], v[72:75], v[44:47]
    ds_read_b128 v[84:87], v11 offset:576
    v_mfma_f32_16x16x32_bf16 v[48:51], v[224:227], v[72:75], v[48:51]
    s_waitcnt lgkmcnt(5)
    ds_read_b128 v[132:135], v11 offset:640
    v_mfma_f32_16x16x32_bf16 v[108:111], v[72:75], v[28:31], 0
    ds_read_b128 v[68:71], v11 offset:704
    v_mfma_f32_16x16x32_bf16 v[112:115], v[72:75], v[32:35], 0
    s_waitcnt lgkmcnt(5)
    v_mfma_f32_16x16x32_bf16 v[52:55], v[12:15], v[72:75], 0
    v_mfma_f32_16x16x32_bf16 v[116:119], v[72:75], v[36:39], 0
    ds_write_b128 v7, v[44:47] offset:9472
    v_mfma_f32_16x16x32_bf16 v[124:127], v[72:75], v[20:23], 0
    v_mfma_f32_16x16x32_bf16 v[60:63], v[16:19], v[72:75], 0
    ds_read_b128 v[72:75], v11 offset:768
    s_waitcnt lgkmcnt(5)
    v_mfma_f32_16x16x32_bf16 v[120:123], v[76:79], v[32:35], 0
    ds_write_b32 v88, v88 offset:0
    v_mfma_f32_16x16x32_bf16 v[128:131], v[76:79], v[24:27], 0
    ds_read_b128 v[76:79], v11 offset:832
    v_mfma_f32_16x16x32_bf16 v[48:51], v[220:223], v[80:83], v[48:51]
    v_mfma_f32_16x16x32_bf16 v[52:55], v[252:255], v[80:83], v[52:55]
    ds_read_b128 v[80:83], v11 offset:896
    s_waitcnt lgkmcnt(6)
    v_mfma_f32_16x16x32_bf16 v[48:51], v[216:219], v[84:87], v[48:51]
    v_mfma_f32_16x16x32_bf16 v[52:55], v[248:251], v[84:87], v[52:55]
    ds_read_b128 v[84:87], v11 offset:960
    v_cvt_pk_bf16_f32 v136, v120, v116
    v_mfma_f32_16x16x32_bf16 v[48:51], v[212:215], v[132:135], v[48:51]
    v_cvt_pk_bf16_f32 v137, v112, v108
    v_mfma_f32_16x16x32_bf16 v[52:55], v[244:247], v[132:135], v[52:55]
    s_waitcnt lgkmcnt(4)
    v_cvt_pk_bf16_f32 v138, v121, v117
    v_mfma_f32_16x16x32_bf16 v[48:51], v[208:211], v[68:71], v[48:51]
    v_cvt_pk_bf16_f32 v139, v113, v109
    v_mfma_f32_16x16x32_bf16 v[52:55], v[240:243], v[68:71], v[52:55]
    ds_read_b128 v[132:135], v11 offset:944
    v_cvt_pk_bf16_f32 v140, v122, v118
    v_mfma_f32_16x16x32_bf16 v[48:51], v[204:207], v[72:75], v[48:51]
    v_cvt_pk_bf16_f32 v141, v114, v110
    v_mfma_f32_16x16x32_bf16 v[52:55], v[236:239], v[72:75], v[52:55]
    ds_read_b128 v[68:71], v11 offset:1024
    s_waitcnt lgkmcnt(3)
    v_mfma_f32_16x16x32_bf16 v[48:51], v[200:203], v[76:79], v[48:51]
    v_cvt_pk_bf16_f32 v142, v123, v119
    v_mfma_f32_16x16x32_bf16 v[52:55], v[232:235], v[76:79], v[52:55]
    ds_read_b64 v[168:169], v89 offset:256
    v_cvt_pk_bf16_f32 v143, v115, v111
    v_mfma_f32_16x16x32_bf16 v[48:51], v[196:199], v[80:83], v[48:51]
    ds_read_b64 v[170:171], v89 offset:264
    v_cvt_pk_bf16_f32 v92, v128, v124
    v_mfma_f32_16x16x32_bf16 v[52:55], v[228:231], v[80:83], v[52:55]
    ds_read_b128 v[72:75], v11 offset:1088
    s_waitcnt lgkmcnt(5)
    v_mfma_f32_16x16x32_bf16 v[48:51], v[192:195], v[84:87], v[48:51]
    ds_read_b64 v[172:173], v89 offset:272
    v_cvt_pk_bf16_f32 v93, v129, v125
    v_mfma_f32_16x16x32_bf16 v[52:55], v[224:227], v[84:87], v[52:55]
    ds_read_b64 v[174:175], v89 offset:280
    v_cvt_pk_bf16_f32 v94, v130, v126
    v_mfma_f32_16x16x32_bf16 v[108:111], v[84:87], v[28:31], 0
    ds_read_b128 v[76:79], v11 offset:1152
    v_cvt_pk_bf16_f32 v95, v131, v127
    v_mfma_f32_16x16x32_bf16 v[112:115], v[84:87], v[32:35], 0
    v_mfma_f32_16x16x32_bf16 v[56:59], v[12:15], v[84:87], 0
    ds_read_b128 v[80:83], v11 offset:1216
    v_mfma_f32_16x16x32_bf16 v[116:119], v[84:87], v[36:39], 0
    ds_write_b128 v7, v[48:51] offset:10752
    v_mfma_f32_16x16x32_bf16 v[124:127], v[84:87], v[20:23], 0
    v_mfma_f32_16x16x32_bf16 v[64:67], v[16:19], v[84:87], 0
    ds_read_b128 v[84:87], v11 offset:1280
    s_waitcnt lgkmcnt(9)
    v_mfma_f32_16x16x32_bf16 v[120:123], v[132:135], v[32:35], 0
    ds_write_b32 v88, v88 offset:16
    v_mfma_f32_16x16x32_bf16 v[128:131], v[132:135], v[24:27], 0
    ds_read_b128 v[132:135], v11 offset:1344
    v_mfma_f32_16x16x32_bf16 v[52:55], v[220:223], v[68:71], v[52:55]
    v_mfma_f32_16x16x32_bf16 v[56:59], v[252:255], v[68:71], v[56:59]
    ds_read_b128 v[68:71], v11 offset:1408
    s_waitcnt lgkmcnt(7)
    v_mfma_f32_16x16x32_bf16 v[52:55], v[136:139], v[168:171], v[52:55]
    v_mfma_f32_16x16x32_bf16 v[52:55], v[216:219], v[72:75], v[52:55]
    v_mfma_f32_16x16x32_bf16 v[56:59], v[248:251], v[72:75], v[56:59]
    ds_read_b128 v[72:75], v11 offset:1472
    v_mfma_f32_16x16x32_bf16 v[52:55], v[140:143], v[172:175], v[52:55]
    s_waitcnt lgkmcnt(6)
    v_cvt_pk_bf16_f32 v144, v120, v116
    v_mfma_f32_16x16x32_bf16 v[52:55], v[212:215], v[76:79], v[52:55]
    v_cvt_pk_bf16_f32 v145, v112, v108
    v_mfma_f32_16x16x32_bf16 v[56:59], v[244:247], v[76:79], v[56:59]
    v_cvt_pk_bf16_f32 v146, v121, v117
    v_mfma_f32_16x16x32_bf16 v[52:55], v[208:211], v[80:83], v[52:55]
    v_cvt_pk_bf16_f32 v147, v113, v109
    v_mfma_f32_16x16x32_bf16 v[56:59], v[240:243], v[80:83], v[56:59]
    ds_read_b128 v[76:79], v11 offset:1456
    s_waitcnt lgkmcnt(3)
    v_mfma_f32_16x16x32_bf16 v[52:55], v[204:207], v[84:87], v[52:55]
    v_cvt_pk_bf16_f32 v148, v122, v118
    v_mfma_f32_16x16x32_bf16 v[56:59], v[236:239], v[84:87], v[56:59]
    ds_read_b128 v[80:83], v11 offset:1536
    v_cvt_pk_bf16_f32 v149, v114, v110
    v_mfma_f32_16x16x32_bf16 v[52:55], v[200:203], v[132:135], v[52:55]
    v_cvt_pk_bf16_f32 v150, v123, v119
    v_mfma_f32_16x16x32_bf16 v[56:59], v[232:235], v[132:135], v[56:59]
    ds_read_b64 v[176:177], v89 offset:128
    s_waitcnt lgkmcnt(3)
    v_mfma_f32_16x16x32_bf16 v[52:55], v[196:199], v[68:71], v[52:55]
    ds_read_b64 v[178:179], v89 offset:136
    v_cvt_pk_bf16_f32 v151, v115, v111
    v_mfma_f32_16x16x32_bf16 v[56:59], v[228:231], v[68:71], v[56:59]
    ds_read_b128 v[84:87], v11 offset:1600
    v_cvt_pk_bf16_f32 v96, v128, v124
    v_mfma_f32_16x16x32_bf16 v[52:55], v[192:195], v[72:75], v[52:55]
    ds_read_b64 v[180:181], v89 offset:144
    v_cvt_pk_bf16_f32 v97, v129, v125
    v_mfma_f32_16x16x32_bf16 v[56:59], v[224:227], v[72:75], v[56:59]
    ds_read_b64 v[182:183], v89 offset:152
    v_cvt_pk_bf16_f32 v98, v130, v126
    v_mfma_f32_16x16x32_bf16 v[108:111], v[72:75], v[28:31], 0
    ds_read_b128 v[132:135], v11 offset:1664
    v_cvt_pk_bf16_f32 v99, v131, v127
    v_mfma_f32_16x16x32_bf16 v[112:115], v[72:75], v[32:35], 0
    v_mfma_f32_16x16x32_bf16 v[60:63], v[12:15], v[72:75], v[60:63]
    v_mfma_f32_16x16x32_bf16 v[116:119], v[72:75], v[36:39], 0
    ds_read_b128 v[68:71], v11 offset:1728
    ds_write_b128 v7, v[52:55] offset:12032
    v_mfma_f32_16x16x32_bf16 v[124:127], v[72:75], v[20:23], 0
    v_mfma_f32_16x16x32_bf16 v[44:47], v[16:19], v[72:75], 0
    ds_read_b128 v[72:75], v11 offset:1792
    s_waitcnt lgkmcnt(9)
    v_mfma_f32_16x16x32_bf16 v[120:123], v[76:79], v[32:35], 0
    ds_write_b32 v88, v88 offset:32
    v_mfma_f32_16x16x32_bf16 v[128:131], v[76:79], v[24:27], 0
    ds_read_b128 v[76:79], v11 offset:1856
    v_mfma_f32_16x16x32_bf16 v[56:59], v[220:223], v[80:83], v[56:59]
    v_mfma_f32_16x16x32_bf16 v[60:63], v[252:255], v[80:83], v[60:63]
    ds_read_b128 v[80:83], v11 offset:1920
    s_waitcnt lgkmcnt(7)
    v_mfma_f32_16x16x32_bf16 v[56:59], v[136:139], v[176:179], v[56:59]
    v_mfma_f32_16x16x32_bf16 v[56:59], v[216:219], v[84:87], v[56:59]
    v_mfma_f32_16x16x32_bf16 v[60:63], v[248:251], v[84:87], v[60:63]
    ds_read_b128 v[84:87], v11 offset:1984
    v_mfma_f32_16x16x32_bf16 v[56:59], v[140:143], v[180:183], v[56:59]
    s_waitcnt lgkmcnt(6)
    v_cvt_pk_bf16_f32 v152, v120, v116
    v_mfma_f32_16x16x32_bf16 v[56:59], v[212:215], v[132:135], v[56:59]
    v_cvt_pk_bf16_f32 v153, v112, v108
    v_mfma_f32_16x16x32_bf16 v[60:63], v[244:247], v[132:135], v[60:63]
    v_cvt_pk_bf16_f32 v154, v121, v117
    v_mfma_f32_16x16x32_bf16 v[56:59], v[144:147], v[168:171], v[56:59]
    v_cvt_pk_bf16_f32 v155, v113, v109
    v_mfma_f32_16x16x32_bf16 v[56:59], v[208:211], v[68:71], v[56:59]
    v_cvt_pk_bf16_f32 v156, v122, v118
    v_mfma_f32_16x16x32_bf16 v[60:63], v[240:243], v[68:71], v[60:63]
    v_cvt_pk_bf16_f32 v157, v114, v110
    v_mfma_f32_16x16x32_bf16 v[56:59], v[148:151], v[172:175], v[56:59]
    ds_read_b128 v[132:135], v11 offset:1968
    s_waitcnt lgkmcnt(3)
    v_mfma_f32_16x16x32_bf16 v[56:59], v[204:207], v[72:75], v[56:59]
    v_cvt_pk_bf16_f32 v158, v123, v119
    v_mfma_f32_16x16x32_bf16 v[60:63], v[236:239], v[72:75], v[60:63]
    ds_read_b128 v[68:71], v11 offset:2048
    v_cvt_pk_bf16_f32 v159, v115, v111
    v_mfma_f32_16x16x32_bf16 v[56:59], v[200:203], v[76:79], v[56:59]
    v_cvt_pk_bf16_f32 v100, v128, v124
    v_mfma_f32_16x16x32_bf16 v[60:63], v[232:235], v[76:79], v[60:63]
    ds_read2_b32 v[40:41], v4 offset0:48 offset1:49
    s_waitcnt lgkmcnt(3)
    v_mfma_f32_16x16x32_bf16 v[56:59], v[196:199], v[80:83], v[56:59]
    ds_read2_b32 v[42:43], v4 offset0:50 offset1:51
    v_cvt_pk_bf16_f32 v101, v129, v125
    v_mfma_f32_16x16x32_bf16 v[60:63], v[228:231], v[80:83], v[60:63]
    ds_read_b128 v[72:75], v11 offset:2112
    v_cvt_pk_bf16_f32 v102, v130, v126
    v_mfma_f32_16x16x32_bf16 v[56:59], v[192:195], v[84:87], v[56:59]
    ds_read_b64 v[184:185], v89 offset:0
    v_cvt_pk_bf16_f32 v103, v131, v127
    v_mfma_f32_16x16x32_bf16 v[60:63], v[224:227], v[84:87], v[60:63]
    ds_read_b64 v[186:187], v89 offset:8
    v_mfma_f32_16x16x32_bf16 v[108:111], v[84:87], v[28:31], 0
    ds_read_b128 v[76:79], v11 offset:2176
    v_mfma_f32_16x16x32_bf16 v[112:115], v[84:87], v[32:35], 0
    v_mfma_f32_16x16x32_bf16 v[64:67], v[12:15], v[84:87], v[64:67]
    ds_read_b64 v[188:189], v89 offset:16
    v_mfma_f32_16x16x32_bf16 v[116:119], v[84:87], v[36:39], 0
    ds_read_b64 v[190:191], v89 offset:24
    ds_write_b128 v7, v[56:59] offset:13312
    v_mfma_f32_16x16x32_bf16 v[124:127], v[84:87], v[20:23], 0
    ds_read_b128 v[80:83], v11 offset:2240
    v_mfma_f32_16x16x32_bf16 v[48:51], v[16:19], v[84:87], 0
    ds_read_b128 v[84:87], v11 offset:2304
    s_waitcnt lgkmcnt(11)
    v_mfma_f32_16x16x32_bf16 v[120:123], v[132:135], v[32:35], 0
    ds_write_b32 v88, v88 offset:48
    v_mfma_f32_16x16x32_bf16 v[128:131], v[132:135], v[24:27], 0
    ds_read_b128 v[132:135], v11 offset:2368
    v_mfma_f32_16x16x32_bf16 v[60:63], v[220:223], v[68:71], v[60:63]
    v_mfma_f32_16x16x32_bf16 v[64:67], v[252:255], v[68:71], v[64:67]
    s_waitcnt lgkmcnt(8)
    v_mfma_f32_16x16x32_bf16 v[60:63], v[92:95], v[40:43], v[60:63]
    ds_read_b128 v[68:71], v11 offset:2432
    v_mfma_f32_16x16x32_bf16 v[60:63], v[216:219], v[72:75], v[60:63]
    v_mfma_f32_16x16x32_bf16 v[64:67], v[248:251], v[72:75], v[64:67]
    v_mfma_f32_16x16x32_bf16 v[60:63], v[136:139], v[184:187], v[60:63]
    ds_read_b128 v[72:75], v11 offset:2496
    s_waitcnt lgkmcnt(5)
    v_mfma_f32_16x16x32_bf16 v[60:63], v[212:215], v[76:79], v[60:63]
    v_cvt_pk_bf16_f32 v160, v120, v116
    v_mfma_f32_16x16x32_bf16 v[64:67], v[244:247], v[76:79], v[64:67]
    v_cvt_pk_bf16_f32 v161, v112, v108
    v_mfma_f32_16x16x32_bf16 v[60:63], v[140:143], v[188:191], v[60:63]
    v_cvt_pk_bf16_f32 v162, v121, v117
    v_mfma_f32_16x16x32_bf16 v[60:63], v[208:211], v[80:83], v[60:63]
    v_cvt_pk_bf16_f32 v163, v113, v109
    v_mfma_f32_16x16x32_bf16 v[64:67], v[240:243], v[80:83], v[64:67]
    v_cvt_pk_bf16_f32 v164, v122, v118
    v_mfma_f32_16x16x32_bf16 v[60:63], v[144:147], v[176:179], v[60:63]
    s_waitcnt lgkmcnt(2)
    v_cvt_pk_bf16_f32 v165, v114, v110
    v_mfma_f32_16x16x32_bf16 v[60:63], v[204:207], v[84:87], v[60:63]
    ds_read_b128 v[76:79], v11 offset:2480
    v_cvt_pk_bf16_f32 v166, v123, v119
    v_mfma_f32_16x16x32_bf16 v[64:67], v[236:239], v[84:87], v[64:67]
    ds_read_b128 v[80:83], v11 offset:2560
    v_cvt_pk_bf16_f32 v167, v115, v111
    v_mfma_f32_16x16x32_bf16 v[60:63], v[148:151], v[180:183], v[60:63]
    v_cvt_pk_bf16_f32 v104, v128, v124
    v_mfma_f32_16x16x32_bf16 v[60:63], v[200:203], v[132:135], v[60:63]
    v_cvt_pk_bf16_f32 v105, v129, v125
    v_mfma_f32_16x16x32_bf16 v[64:67], v[232:235], v[132:135], v[64:67]
    ds_read2_b32 v[16:17], v4 offset0:32 offset1:33
    v_cvt_pk_bf16_f32 v106, v130, v126
    v_mfma_f32_16x16x32_bf16 v[60:63], v[152:155], v[168:171], v[60:63]
    ds_read2_b32 v[18:19], v4 offset0:34 offset1:35
    s_waitcnt lgkmcnt(4)
    v_mfma_f32_16x16x32_bf16 v[60:63], v[196:199], v[68:71], v[60:63]
    ds_read_b128 v[84:87], v11 offset:2624
    v_cvt_pk_bf16_f32 v107, v131, v127
    v_mfma_f32_16x16x32_bf16 v[64:67], v[228:231], v[68:71], v[64:67]
    v_mfma_f32_16x16x32_bf16 v[60:63], v[156:159], v[172:175], v[60:63]
    v_mfma_f32_16x16x32_bf16 v[60:63], v[192:195], v[72:75], v[60:63]
    ds_read_b128 v[132:135], v11 offset:2688
    v_mfma_f32_16x16x32_bf16 v[64:67], v[224:227], v[72:75], v[64:67]
    v_mfma_f32_16x16x32_bf16 v[108:111], v[72:75], v[28:31], 0
    v_mfma_f32_16x16x32_bf16 v[112:115], v[72:75], v[32:35], 0
    ds_read_b128 v[68:71], v11 offset:2752
    v_mfma_f32_16x16x32_bf16 v[44:47], v[12:15], v[72:75], v[44:47]
    v_mfma_f32_16x16x32_bf16 v[116:119], v[72:75], v[36:39], 0
    ds_read_b128 v[72:75], v11 offset:2816
    s_waitcnt lgkmcnt(6)
    v_mfma_f32_16x16x32_bf16 v[120:123], v[76:79], v[32:35], 0
    ds_write_b128 v7, v[60:63] offset:14592
    v_mfma_f32_16x16x32_bf16 v[64:67], v[220:223], v[80:83], v[64:67]
    ds_read_b128 v[76:79], v11 offset:2880
    ds_write_b32 v88, v88 offset:64
    v_mfma_f32_16x16x32_bf16 v[44:47], v[252:255], v[80:83], v[44:47]
    v_mfma_f32_16x16x32_bf16 v[64:67], v[96:99], v[40:43], v[64:67]
    s_waitcnt lgkmcnt(6)
    v_mfma_f32_16x16x32_bf16 v[64:67], v[92:95], v[16:19], v[64:67]
    ds_read_b128 v[80:83], v11 offset:2944
    v_mfma_f32_16x16x32_bf16 v[64:67], v[216:219], v[84:87], v[64:67]
    v_mfma_f32_16x16x32_bf16 v[44:47], v[248:251], v[84:87], v[44:47]
    v_mfma_f32_16x16x32_bf16 v[64:67], v[144:147], v[184:187], v[64:67]
    ds_read_b128 v[84:87], v11 offset:3008
    s_waitcnt lgkmcnt(6)
    v_mfma_f32_16x16x32_bf16 v[64:67], v[212:215], v[132:135], v[64:67]
    v_cvt_pk_bf16_f32 v136, v120, v116
    v_mfma_f32_16x16x32_bf16 v[44:47], v[244:247], v[132:135], v[44:47]
    v_cvt_pk_bf16_f32 v137, v112, v108
    v_mfma_f32_16x16x32_bf16 v[64:67], v[148:151], v[188:191], v[64:67]
    v_cvt_pk_bf16_f32 v138, v121, v117
    v_mfma_f32_16x16x32_bf16 v[64:67], v[208:211], v[68:71], v[64:67]
    v_cvt_pk_bf16_f32 v139, v113, v109
    v_mfma_f32_16x16x32_bf16 v[44:47], v[240:243], v[68:71], v[44:47]
    v_cvt_pk_bf16_f32 v140, v122, v118
    v_mfma_f32_16x16x32_bf16 v[64:67], v[152:155], v[176:179], v[64:67]
    s_waitcnt lgkmcnt(3)
    v_cvt_pk_bf16_f32 v141, v114, v110
    v_mfma_f32_16x16x32_bf16 v[64:67], v[204:207], v[72:75], v[64:67]
    ds_read_b128 v[132:135], v11 offset:2992
    v_cvt_pk_bf16_f32 v142, v123, v119
    v_mfma_f32_16x16x32_bf16 v[44:47], v[236:239], v[72:75], v[44:47]
    ds_read_b128 v[68:71], v11 offset:3072
    v_cvt_pk_bf16_f32 v143, v115, v111
    v_mfma_f32_16x16x32_bf16 v[64:67], v[156:159], v[180:183], v[64:67]
    v_mfma_f32_16x16x32_bf16 v[64:67], v[200:203], v[76:79], v[64:67]
    v_mfma_f32_16x16x32_bf16 v[44:47], v[232:235], v[76:79], v[44:47]
    ds_read_b128 v[72:75], v11 offset:3136
    v_mfma_f32_16x16x32_bf16 v[64:67], v[160:163], v[168:171], v[64:67]
    ds_read2_b32 v[20:21], v4 offset0:16 offset1:17
    s_waitcnt lgkmcnt(4)
    v_mfma_f32_16x16x32_bf16 v[64:67], v[196:199], v[80:83], v[64:67]
    ds_read2_b32 v[22:23], v4 offset0:18 offset1:19
    v_mfma_f32_16x16x32_bf16 v[44:47], v[228:231], v[80:83], v[44:47]
    v_mfma_f32_16x16x32_bf16 v[64:67], v[164:167], v[172:175], v[64:67]
    ds_read_b128 v[76:79], v11 offset:3200
    v_mfma_f32_16x16x32_bf16 v[64:67], v[192:195], v[84:87], v[64:67]
    v_mfma_f32_16x16x32_bf16 v[44:47], v[224:227], v[84:87], v[44:47]
    ds_read_b128 v[80:83], v11 offset:3264
    v_mfma_f32_16x16x32_bf16 v[108:111], v[84:87], v[28:31], 0
    v_mfma_f32_16x16x32_bf16 v[112:115], v[84:87], v[32:35], 0
    v_mfma_f32_16x16x32_bf16 v[48:51], v[12:15], v[84:87], v[48:51]
    v_mfma_f32_16x16x32_bf16 v[116:119], v[84:87], v[36:39], 0
    ds_read_b128 v[84:87], v11 offset:3328
    s_waitcnt lgkmcnt(6)
    v_mfma_f32_16x16x32_bf16 v[120:123], v[132:135], v[32:35], 0
    ds_read_b128 v[132:135], v11 offset:3392
    ds_write_b128 v7, v[64:67] offset:15872
    v_mfma_f32_16x16x32_bf16 v[44:47], v[220:223], v[68:71], v[44:47]
    ds_read_b128 v[68:71], v11 offset:3456
    ds_write_b32 v88, v88 offset:80
    v_mfma_f32_16x16x32_bf16 v[44:47], v[100:103], v[40:43], v[44:47]
    v_mfma_f32_16x16x32_bf16 v[44:47], v[96:99], v[16:19], v[44:47]
    s_waitcnt lgkmcnt(7)
    v_mfma_f32_16x16x32_bf16 v[44:47], v[216:219], v[72:75], v[44:47]
    ds_read_b128 v[72:75], v11 offset:3520
    v_mfma_f32_16x16x32_bf16 v[44:47], v[92:95], v[20:23], v[44:47]
    v_mfma_f32_16x16x32_bf16 v[44:47], v[152:155], v[184:187], v[44:47]
    s_waitcnt lgkmcnt(6)
    v_cvt_pk_bf16_f32 v144, v120, v116
    v_mfma_f32_16x16x32_bf16 v[44:47], v[212:215], v[76:79], v[44:47]
    ds_read_b128 v[76:79], v11 offset:3584
    v_cvt_pk_bf16_f32 v145, v112, v108
    v_mfma_f32_16x16x32_bf16 v[44:47], v[156:159], v[188:191], v[44:47]
    v_cvt_pk_bf16_f32 v146, v121, v117
    v_mfma_f32_16x16x32_bf16 v[44:47], v[208:211], v[80:83], v[44:47]
    ds_read_b128 v[80:83], v11 offset:3072
    v_cvt_pk_bf16_f32 v147, v113, v109
    v_mfma_f32_16x16x32_bf16 v[44:47], v[160:163], v[176:179], v[44:47]
    s_waitcnt lgkmcnt(6)
    v_cvt_pk_bf16_f32 v148, v122, v118
    v_mfma_f32_16x16x32_bf16 v[44:47], v[204:207], v[84:87], v[44:47]
    ds_read_b128 v[84:87], v11 offset:3648
    v_cvt_pk_bf16_f32 v149, v114, v110
    v_mfma_f32_16x16x32_bf16 v[44:47], v[164:167], v[180:183], v[44:47]
    v_cvt_pk_bf16_f32 v150, v123, v119
    v_mfma_f32_16x16x32_bf16 v[44:47], v[200:203], v[132:135], v[44:47]
    ds_read_b128 v[132:135], v11 offset:3136
    v_cvt_pk_bf16_f32 v151, v115, v111
    v_mfma_f32_16x16x32_bf16 v[44:47], v[136:139], v[168:171], v[44:47]
    ds_read2_b32 v[24:25], v4 offset0:0 offset1:1
    s_waitcnt lgkmcnt(4)
    v_mfma_f32_16x16x32_bf16 v[44:47], v[196:199], v[68:71], v[44:47]
    ds_read2_b32 v[26:27], v4 offset0:2 offset1:3
    v_mfma_f32_16x16x32_bf16 v[44:47], v[140:143], v[172:175], v[44:47]
    ds_read_b128 v[68:71], v11 offset:3712
    v_mfma_f32_16x16x32_bf16 v[44:47], v[192:195], v[72:75], v[44:47]
    ds_read_b128 v[72:75], v11 offset:3200
    v_mfma_f32_16x16x32_bf16 v[48:51], v[220:223], v[76:79], v[48:51]
    ds_read_b128 v[76:79], v11 offset:3776
    s_waitcnt lgkmcnt(6)
    v_mfma_f32_16x16x32_bf16 v[48:51], v[252:255], v[80:83], v[48:51]
    ds_read_b128 v[80:83], v11 offset:3264
    v_mfma_f32_16x16x32_bf16 v[48:51], v[104:107], v[40:43], v[48:51]
    v_mfma_f32_16x16x32_bf16 v[48:51], v[100:103], v[16:19], v[48:51]
    v_mfma_f32_16x16x32_bf16 v[48:51], v[216:219], v[84:87], v[48:51]
    ds_read_b128 v[84:87], v11 offset:3840
    s_waitcnt lgkmcnt(5)
    v_mfma_f32_16x16x32_bf16 v[48:51], v[248:251], v[132:135], v[48:51]
    ds_read_b128 v[132:135], v11 offset:3328
    v_mfma_f32_16x16x32_bf16 v[48:51], v[96:99], v[20:23], v[48:51]
    v_mfma_f32_16x16x32_bf16 v[48:51], v[92:95], v[24:27], v[48:51]
    s_waitcnt lgkmcnt(4)
    ds_write_b128 v7, v[44:47] offset:17152
    v_mfma_f32_16x16x32_bf16 v[48:51], v[212:215], v[68:71], v[48:51]
    ds_read_b128 v[68:71], v11 offset:3904
    ds_write_b32 v88, v88 offset:96
    v_mfma_f32_16x16x32_bf16 v[48:51], v[244:247], v[72:75], v[48:51]
    ds_read_b128 v[72:75], v11 offset:3392
    v_mfma_f32_16x16x32_bf16 v[48:51], v[160:163], v[184:187], v[48:51]
    v_mfma_f32_16x16x32_bf16 v[48:51], v[164:167], v[188:191], v[48:51]
    s_waitcnt lgkmcnt(5)
    v_mfma_f32_16x16x32_bf16 v[48:51], v[208:211], v[76:79], v[48:51]
    ds_read_b128 v[76:79], v11 offset:3968
    v_mfma_f32_16x16x32_bf16 v[48:51], v[240:243], v[80:83], v[48:51]
    ds_read_b128 v[80:83], v11 offset:3456
    v_mfma_f32_16x16x32_bf16 v[48:51], v[136:139], v[176:179], v[48:51]
    v_mfma_f32_16x16x32_bf16 v[48:51], v[204:207], v[84:87], v[48:51]
    ds_read_b128 v[84:87], v11 offset:4032
    s_waitcnt lgkmcnt(3)
    v_mfma_f32_16x16x32_bf16 v[48:51], v[236:239], v[132:135], v[48:51]
    ds_read_b128 v[132:135], v11 offset:3520
    v_mfma_f32_16x16x32_bf16 v[48:51], v[140:143], v[180:183], v[48:51]
    v_mfma_f32_16x16x32_bf16 v[48:51], v[200:203], v[68:71], v[48:51]
    v_mfma_f32_16x16x32_bf16 v[48:51], v[232:235], v[72:75], v[48:51]
    v_mfma_f32_16x16x32_bf16 v[48:51], v[144:147], v[168:171], v[48:51]
    s_waitcnt lgkmcnt(1)
    v_mfma_f32_16x16x32_bf16 v[48:51], v[196:199], v[76:79], v[48:51]
    v_mfma_f32_16x16x32_bf16 v[48:51], v[228:231], v[80:83], v[48:51]
    v_mfma_f32_16x16x32_bf16 v[48:51], v[148:151], v[172:175], v[48:51]
    v_mfma_f32_16x16x32_bf16 v[48:51], v[192:195], v[84:87], v[48:51]
    s_waitcnt lgkmcnt(0)
    v_mfma_f32_16x16x32_bf16 v[48:51], v[224:227], v[132:135], v[48:51]
    s_nop 7
    ds_write_b128 v7, v[48:51] offset:18432
    ds_write_b32 v88, v88 offset:112
    s_cmp_lg_u32 s39, 0
    s_cbranch_scc1 L_mw_end
    s_mul_i32 s42, s50, 9344
    s_add_u32 s42, s42, 69632
    v_add_u32 v18, s42, v3
    v_add_u32 v20, 4096, v18
    v_and_b32 v21, 0x70, v3
    s_add_u32 s42, s42, 5120
    v_add_u32 v21, s42, v21
    s_mov_b32 s61, 131072
    v_lshl_add_u32 v24, v9, 1, s54
    v_mov_b32 v35, s45
    s_barrier
L_part_poll:
    global_load_dwordx4 v[164:167], v21, s[36:37] sc1
    global_load_dwordx4 v[128:131], v18, s[36:37] offset:-4096 sc1
    global_load_dwordx4 v[132:135], v18, s[36:37] offset:-3072 sc1
    global_load_dwordx4 v[136:139], v18, s[36:37] offset:-2048 sc1
    global_load_dwordx4 v[140:143], v18, s[36:37] offset:-1024 sc1
    global_load_dwordx4 v[144:147], v18, s[36:37] offset:0 sc1
    global_load_dwordx4 v[148:151], v18, s[36:37] offset:1024 sc1
    global_load_dwordx4 v[152:155], v18, s[36:37] offset:2048 sc1
    global_load_dwordx4 v[156:159], v18, s[36:37] offset:3072 sc1
    global_load_dwordx4 v[160:163], v20, s[36:37] offset:0 sc1
    v_mul_u32_u24 v26, 4640, v9
    v_add_u32 v26, 135648, v26
    v_mul_u32_u24 v27, 33792, v9
    v_mov_b32 v25, 1280
    s_waitcnt vmcnt(9)
    v_bfe_u32 v28, v164, 8, 11
    v_lshl_add_u32 v29, v28, 1, v26
    v_lshrrev_b32 v30, 8, v28
    v_mad_u32_u24 v27, v30, v25, v27
    v_bfe_u32 v30, v28, 2, 2
    v_mul_u32_u24 v30, 320, v30
    v_and_b32 v33, 0xf0, v28
    v_add3_u32 v27, v27, v30, v33
    v_and_b32 v33, 3, v28
    v_lshl_add_u32 v30, v33, 2, v27
    ds_read_b128 v[36:39], v88 offset:112
    ds_read_u16_d16_hi v31, v29
    ds_read_b32 v32, v30 offset:9472
    v_mul_u32_u24 v28, 1152, v28
    v_add_u32 v28, v28, v24
    v_xor_b32 v22, v35, v164
    s_waitcnt vmcnt(8)
    v_xor_b32 v128, v35, v128
    v_or_b32 v22, v22, v128
    s_waitcnt vmcnt(7)
    v_xor_b32 v132, v35, v132
    v_pk_add_f32 v[130:131], v[130:131], v[134:135]
    v_pk_add_f32 v[128:129], v[128:129], v[132:133]
    s_waitcnt vmcnt(6)
    v_xor_b32 v136, v35, v136
    v_pk_add_f32 v[130:131], v[130:131], v[138:139]
    v_pk_add_f32 v[128:129], v[128:129], v[136:137]
    v_bitop3_b32 v22, v22, v132, v136 bitop3:0xfe
    s_waitcnt vmcnt(5)
    v_xor_b32 v140, v35, v140
    v_pk_add_f32 v[130:131], v[130:131], v[142:143]
    v_pk_add_f32 v[128:129], v[128:129], v[140:141]
    s_waitcnt vmcnt(4)
    v_xor_b32 v144, v35, v144
    v_pk_add_f32 v[130:131], v[130:131], v[146:147]
    v_pk_add_f32 v[128:129], v[128:129], v[144:145]
    v_bitop3_b32 v22, v22, v140, v144 bitop3:0xfe
    s_waitcnt vmcnt(3)
    v_xor_b32 v148, v35, v148
    v_pk_add_f32 v[130:131], v[130:131], v[150:151]
    v_pk_add_f32 v[128:129], v[128:129], v[148:149]
    s_waitcnt vmcnt(2)
    v_xor_b32 v152, v35, v152
    v_pk_add_f32 v[130:131], v[130:131], v[154:155]
    v_pk_add_f32 v[128:129], v[128:129], v[152:153]
    v_bitop3_b32 v22, v22, v148, v152 bitop3:0xfe
    s_waitcnt vmcnt(1)
    v_xor_b32 v156, v35, v156
    v_pk_add_f32 v[130:131], v[130:131], v[158:159]
    v_pk_add_f32 v[128:129], v[128:129], v[156:157]
    s_waitcnt vmcnt(0)
    v_xor_b32 v160, v35, v160
    v_pk_add_f32 v[130:131], v[130:131], v[162:163]
    v_pk_add_f32 v[128:129], v[128:129], v[160:161]
    v_bitop3_b32 v22, v22, v156, v160 bitop3:0xfe
    s_waitcnt lgkmcnt(0)
    v_bitop3_b32 v36, v37, v38, v39 bitop3:0x7f
    v_and_b32 v36, 128, v36
    v_or_b32 v22, v22, v36
    v_and_b32 v22, 0xff, v22
    v_cmp_ne_u32 vcc, 0, v22
    v_permlane32_swap_b32 v128, v130
    s_sub_u32 s61, s61, 1
    s_cselect_b64 vcc, 0, vcc
    s_cbranch_vccnz L_part_poll
    v_permlane32_swap_b32 v129, v131
    v_add_f32 v128, v128, v130
    v_add_f32 v129, v129, v131
    v_and_b32 v31, 0xffff0000, v31
    v_fma_f32 v34, v31, v167, v166
    v_permlane16_swap_b32 v128, v129
    v_add_f32 v128, v128, v129
    v_mul_f32 v31, 0x42000000, v31
    v_mul_f32 v32, 0x3d000000, v32
    v_add_f32_dpp v128, v128, v128 row_ror:8 row_mask:0xf bank_mask:0xf
    v_fma_f32 v128, v128, v165, v31
    v_mul_f32 v33, 0xbfb8aa3b, v128
    v_exp_f32 v33, v33
    v_mul_f32 v128, v128, v32
    v_add_f32 v33, 1.0, v33
    v_rcp_f32 v33, v33
    s_nop 0
    v_fmac_f32 v34, v128, v33
    v_cvt_pk_bf16_f32 v34, v34, v34
    s_barrier
    global_store_short v28, v34, s[32:33]
L_mw_end:
    s_endpgm
L_helper:
    s_waitcnt lgkmcnt(0)
    s_barrier
    s_setprio 0
    s_lshr_b32 s42, s50, 1
    s_lshl_b32 s42, s42, 15
    s_and_b32 s43, s50, 1
    s_lshl_b32 s43, s43, 6
    s_add_u32 s42, s42, s43
    s_add_u32 s42, s42, 2101248
    s_add_u32 s12, s36, s42
    s_addc_u32 s13, s37, 0
    s_add_u32 s14, s12, 8192
    s_addc_u32 s15, s13, 0
    s_add_u32 s16, s12, 16384
    s_addc_u32 s17, s13, 0
    s_add_u32 s18, s12, 24576
    s_addc_u32 s19, s13, 0
    v_bfe_u32 v63, v0, 2, 6
    v_and_b32 v6, 0x30, v3
    v_lshl_add_u32 v6, v63, 7, v6
    global_load_dwordx4 v[40:43], v6, s[12:13] sc1
    global_load_dwordx4 v[44:47], v6, s[14:15] sc1
    global_load_dwordx4 v[48:51], v6, s[16:17] sc1
    global_load_dwordx4 v[52:55], v6, s[18:19] sc1
    v_and_b32 v62, 255, v0
    v_lshlrev_b32 v4, 4, v62
    v_add_u32 v4, 20480, v4
    v_add_u32 v7, 8192, v4
    s_bfe_u32 s43, s46, 131072
    s_mul_i32 s43, s43, 0x20004000
    s_and_b32 s43, s43, 0x40004000
    v_mov_b32 v56, s43
    s_bfe_u32 s43, s46, 131074
    s_mul_i32 s43, s43, 0x20004000
    s_and_b32 s43, s43, 0x40004000
    v_mov_b32 v57, s43
    s_bfe_u32 s43, s46, 131076
    s_mul_i32 s43, s43, 0x20004000
    s_and_b32 s43, s43, 0x40004000
    v_mov_b32 v58, s43
    s_bfe_u32 s43, s46, 131078
    s_mul_i32 s43, s43, 0x20004000
    s_and_b32 s43, s43, 0x40004000
    v_mov_b32 v59, s43
    v_and_b32 v88, 3, v0
    v_mul_u32_u24 v5, 4640, v88
    v_lshl_add_u32 v5, v63, 4, v5
    v_add_u32 v5, 135648, v5
    v_mov_b32 v63, 0x40004000
    s_lshr_b32 s43, s51, 1
    s_lshl_b32 s43, s43, 4
    s_add_u32 s43, s43, 153728
    v_lshl_add_u32 v88, v88, 2, s43
    s_mov_b32 s61, 131072
    v_lshlrev_b32 v37, 2, v62
    v_add_u32 v64, 135648, v37
    v_add_u32 v65, 140288, v37
    v_add_u32 v66, 144928, v37
    v_add_u32 v67, 149568, v37
    v_bfe_u32 v37, v0, 1, 2
    v_mul_u32_u24 v37, 320, v37
    v_and_b32 v39, 0x78, v0
    v_lshl_add_u32 v37, v39, 1, v37
    v_and_b32 v39, 1, v0
    v_lshl_add_u32 v37, v39, 3, v37
    s_lshr_b32 s43, s51, 1
    s_mul_i32 s43, s43, 1280
    s_add_u32 s43, s43, 9472
    v_add_u32 v37, s43, v37
    v_add_u32 v39, 67584, v37
    v_mul_u32_u24 v36, 2304, v62
    v_add_u32 v36, s54, v36
    v_mov_b32 v8, 0xc238aa3b
    v_mov_b32 v9, 0xffff0000
    v_lshlrev_b32 v62, 6, v62
    v_xor_b32 v62, s44, v62
    v_and_b32 v10, 15, v0
    v_lshrrev_b32 v11, 1, v0
    v_and_b32 v11, 24, v11
    s_lshl_b32 s42, s51, 4
    s_mov_b32 s58, 939536384
    s_mov_b32 s59, 3672000
    s_lshr_b64 s[58:59], s[58:59], s42
    s_and_b32 s58, s58, 0xffff
    s_lshr_b32 s59, 535826400, s42
    s_and_b32 s59, s59, 0xffff
    s_lshl_b32 s42, s51, 10
    s_add_u32 s42, s42, 154048
    v_add_u32 v12, s42, v3
    v_lshlrev_b32 v13, v10, s58
    v_bfe_u32 v13, v13, v11, 8
    v_lshl_or_b32 v13, v13, 15, v13
    v_and_b32 v16, 65537, v13
    v_mul_u32_u24 v16, 16256, v16
    v_and_b32 v17, 262148, v13
    v_mul_u32_u24 v17, 4064, v17
    v_and_b32 v18, 1048592, v13
    v_mul_u32_u24 v18, 1016, v18
    v_and_b32 v19, 4194368, v13
    v_mul_u32_u24 v19, 254, v19
    ds_write_b128 v12, v[16:19] offset:0
    v_lshlrev_b32 v13, v10, s59
    v_bfe_u32 v13, v13, v11, 8
    v_lshl_or_b32 v13, v13, 15, v13
    v_and_b32 v20, 65537, v13
    v_mul_u32_u24 v20, 16256, v20
    v_and_b32 v21, 262148, v13
    v_mul_u32_u24 v21, 4064, v21
    v_and_b32 v22, 1048592, v13
    v_mul_u32_u24 v22, 1016, v22
    v_and_b32 v23, 4194368, v13
    v_mul_u32_u24 v23, 254, v23
    ds_write_b128 v12, v[20:23] offset:4096
    s_setprio 3
    s_cmp_eq_u32 s47, 2
    s_cbranch_scc0 L_ct4
    v_add_u32 v76, 3244032, v76
    global_load_dword v1, v76, s[56:57]
    s_branch L_ct5
L_ct4:
    global_load_dword v1, v11, s[24:25]
L_ct5:
    s_waitcnt vmcnt(4)
    v_xor_b32 v40, v56, v40
    v_xor_b32 v41, v57, v41
    v_xor_b32 v42, v58, v42
    v_xor_b32 v43, v59, v43
    ds_write_b128 v5, v[40:43] offset:0
    s_waitcnt vmcnt(3)
    v_xor_b32 v44, v56, v44
    v_xor_b32 v45, v57, v45
    v_xor_b32 v46, v58, v46
    v_xor_b32 v47, v59, v47
    ds_write_b128 v5, v[44:47] offset:1024
    s_waitcnt vmcnt(2)
    v_xor_b32 v48, v56, v48
    v_xor_b32 v49, v57, v49
    v_xor_b32 v50, v58, v50
    v_xor_b32 v51, v59, v51
    ds_write_b128 v5, v[48:51] offset:2048
    s_waitcnt vmcnt(1)
    v_xor_b32 v52, v56, v52
    v_xor_b32 v53, v57, v53
    v_xor_b32 v54, v58, v54
    v_xor_b32 v55, v59, v55
    ds_write_b128 v5, v[52:55] offset:3072
    global_load_dwordx4 v[224:227], v4, s[36:37] offset:-4096 sc1
    global_load_dwordx4 v[228:231], v4, s[36:37] offset:0 sc1
    global_load_dwordx4 v[232:235], v7, s[36:37] offset:-4096 sc1
    global_load_dwordx4 v[236:239], v7, s[36:37] offset:0 sc1
    s_branch L_tile_or
L_tile_chk:
    v_xor_b32 v40, v56, v40
    v_xor_b32 v41, v57, v41
    v_xor_b32 v42, v58, v42
    v_xor_b32 v43, v59, v43
    ds_write_b128 v5, v[40:43] offset:0
    v_xor_b32 v44, v56, v44
    v_xor_b32 v45, v57, v45
    v_xor_b32 v46, v58, v46
    v_xor_b32 v47, v59, v47
    ds_write_b128 v5, v[44:47] offset:1024
    v_xor_b32 v48, v56, v48
    v_xor_b32 v49, v57, v49
    v_xor_b32 v50, v58, v50
    v_xor_b32 v51, v59, v51
    ds_write_b128 v5, v[48:51] offset:2048
    v_xor_b32 v52, v56, v52
    v_xor_b32 v53, v57, v53
    v_xor_b32 v54, v58, v54
    v_xor_b32 v55, v59, v55
    ds_write_b128 v5, v[52:55] offset:3072
L_tile_or:
    v_bitop3_b32 v38, v40, v41, v42 bitop3:0xfe
    v_bitop3_b32 v38, v38, v43, v44 bitop3:0xfe
    v_bitop3_b32 v38, v38, v45, v46 bitop3:0xfe
    v_bitop3_b32 v38, v38, v47, v48 bitop3:0xfe
    v_bitop3_b32 v38, v38, v49, v50 bitop3:0xfe
    v_bitop3_b32 v38, v38, v51, v52 bitop3:0xfe
    v_bitop3_b32 v38, v38, v53, v54 bitop3:0xfe
    v_bitop3_b32 v38, v38, v55, v63 bitop3:0xa8
    v_cmp_ne_u32 vcc, 0, v38
    s_cbranch_vccz L_tile_ok
    global_load_dwordx4 v[40:43], v6, s[12:13] sc1
    global_load_dwordx4 v[44:47], v6, s[14:15] sc1
    global_load_dwordx4 v[48:51], v6, s[16:17] sc1
    global_load_dwordx4 v[52:55], v6, s[18:19] sc1
    s_waitcnt vmcnt(0)
    s_sub_u32 s61, s61, 1
    s_cbranch_scc0 L_tile_chk
L_tile_ok:
    s_mov_b32 s61, 2097152
    s_setprio 3
    s_waitcnt lgkmcnt(0)
    s_barrier
    ds_read2st64_b32 v[16:17], v64 offset0:0 offset1:4
    ds_read2st64_b32 v[18:19], v65 offset0:0 offset1:4
    ds_read2st64_b32 v[20:21], v66 offset0:0 offset1:4
    ds_read2st64_b32 v[22:23], v67 offset0:0 offset1:4
    ds_read2st64_b32 v[24:25], v64 offset0:8 offset1:12
    ds_read2st64_b32 v[26:27], v65 offset0:8 offset1:12
    ds_read2st64_b32 v[28:29], v66 offset0:8 offset1:12
    ds_read2st64_b32 v[30:31], v67 offset0:8 offset1:12
    s_setprio 0
    s_waitcnt lgkmcnt(4)
    v_lshlrev_b32 v96, 16, v16
    v_lshlrev_b32 v97, 16, v18
    v_lshlrev_b32 v98, 16, v20
    v_lshlrev_b32 v99, 16, v22
    v_mul_f32 v104, v8, v96
    v_mul_f32 v105, v8, v97
    v_mul_f32 v106, v8, v98
    v_mul_f32 v107, v8, v99
    v_exp_f32 v104, v104
    v_exp_f32 v105, v105
    v_exp_f32 v106, v106
    v_exp_f32 v107, v107
    v_add_f32 v104, 1.0, v104
    v_add_f32 v105, 1.0, v105
    v_add_f32 v106, 1.0, v106
    v_add_f32 v107, 1.0, v107
    v_rcp_f32 v104, v104
    v_rcp_f32 v105, v105
    v_rcp_f32 v106, v106
    v_rcp_f32 v107, v107
    v_and_b32 v100, v9, v16
    v_and_b32 v101, v9, v18
    v_and_b32 v102, v9, v20
    v_and_b32 v103, v9, v22
    v_mul_f32 v108, v8, v100
    v_mul_f32 v109, v8, v101
    v_mul_f32 v110, v8, v102
    v_mul_f32 v111, v8, v103
    v_exp_f32 v108, v108
    v_exp_f32 v109, v109
    v_exp_f32 v110, v110
    v_exp_f32 v111, v111
    v_add_f32 v108, 1.0, v108
    v_add_f32 v109, 1.0, v109
    v_add_f32 v110, 1.0, v110
    v_add_f32 v111, 1.0, v111
    v_rcp_f32 v108, v108
    v_rcp_f32 v109, v109
    v_rcp_f32 v110, v110
    v_rcp_f32 v111, v111
    s_setprio 2
    ds_read_b32 v41, v88 offset:0
    ds_read_b64 v[44:45], v37 offset:0
    ds_read_b64 v[46:47], v37 offset:33792
    ds_read_b64 v[48:49], v39 offset:0
    ds_read_b64 v[50:51], v39 offset:33792
    s_setprio 0
    s_waitcnt vmcnt(0)
L_h_poll:
    v_mov_b32 v38, 0
    v_xor_b32 v13, 65504, v225
    v_bitop3_b32 v38, v38, v13, v62 bitop3:0xf6
    v_xor_b32 v13, 65472, v227
    v_bitop3_b32 v38, v38, v13, v62 bitop3:0xf6
    v_xor_b32 v13, 49120, v229
    v_bitop3_b32 v38, v38, v13, v62 bitop3:0xf6
    v_xor_b32 v13, 49088, v231
    v_bitop3_b32 v38, v38, v13, v62 bitop3:0xf6
    v_xor_b32 v13, 32736, v233
    v_bitop3_b32 v38, v38, v13, v62 bitop3:0xf6
    v_xor_b32 v13, 32704, v235
    v_bitop3_b32 v38, v38, v13, v62 bitop3:0xf6
    v_xor_b32 v13, 16352, v237
    v_bitop3_b32 v38, v38, v13, v62 bitop3:0xf6
    v_xor_b32 v13, 16320, v239
    v_bitop3_b32 v38, v38, v13, v62 bitop3:0xf6
    v_and_b32 v38, 0xffff, v38
    v_cmp_ne_u32 vcc, 0, v38
    s_cbranch_vccz L_h_ok
    global_load_dwordx4 v[224:227], v4, s[36:37] offset:-4096 sc1
    global_load_dwordx4 v[228:231], v4, s[36:37] offset:0 sc1
    global_load_dwordx4 v[232:235], v7, s[36:37] offset:-4096 sc1
    global_load_dwordx4 v[236:239], v7, s[36:37] offset:0 sc1
    s_waitcnt vmcnt(0)
    s_sub_u32 s61, s61, 16
    s_cbranch_scc0 L_h_poll
L_h_ok:
    v_and_b32 v121, v9, v224
    v_lshlrev_b32 v120, 16, v224
    v_and_b32 v123, v9, v226
    v_lshlrev_b32 v122, 16, v226
    s_waitcnt lgkmcnt(0)
    v_cmp_eq_u32 vcc, 0, v41
    s_cbranch_vccz L_w0_go
    s_setprio 2
L_w0:
    ds_read_b32 v41, v88 offset:0
    s_waitcnt lgkmcnt(0)
    v_cmp_eq_u32 vcc, 0, v41
    s_cbranch_vccz L_w0_ok
    s_sleep 2
    s_sub_u32 s61, s61, 1
    s_cbranch_scc0 L_w0
L_w0_ok:
    ds_read_b64 v[44:45], v37 offset:0
    ds_read_b64 v[46:47], v37 offset:33792
    ds_read_b64 v[48:49], v39 offset:0
    ds_read_b64 v[50:51], v39 offset:33792
    s_setprio 0
    s_waitcnt lgkmcnt(0)
L_w0_go:
    v_fma_f32 v112, v44, v104, v121
    v_fma_f32 v113, v46, v105, v121
    v_fma_f32 v114, v48, v106, v121
    v_fma_f32 v115, v50, v107, v121
    v_fma_f32 v96, v96, v112, v120
    v_fma_f32 v97, v97, v113, v120
    v_fma_f32 v98, v98, v114, v120
    v_fma_f32 v99, v99, v115, v120
    v_cvt_pk_bf16_f32 v104, v96, v97
    v_cvt_pk_bf16_f32 v105, v98, v99
    global_store_dwordx2 v36, v[104:105], s[32:33] offset:0
    v_fma_f32 v116, v45, v108, v123
    v_fma_f32 v117, v47, v109, v123
    v_fma_f32 v118, v49, v110, v123
    v_fma_f32 v119, v51, v111, v123
    v_fma_f32 v100, v100, v116, v122
    v_fma_f32 v101, v101, v117, v122
    v_fma_f32 v102, v102, v118, v122
    v_fma_f32 v103, v103, v119, v122
    v_cvt_pk_bf16_f32 v108, v100, v101
    v_cvt_pk_bf16_f32 v109, v102, v103
    global_store_dwordx2 v36, v[108:109], s[32:33] offset:1152
    v_add_u32 v36, 589824, v36
    v_lshlrev_b32 v128, 16, v17
    v_lshlrev_b32 v129, 16, v19
    v_lshlrev_b32 v130, 16, v21
    v_lshlrev_b32 v131, 16, v23
    v_mul_f32 v136, v8, v128
    v_mul_f32 v137, v8, v129
    v_mul_f32 v138, v8, v130
    v_mul_f32 v139, v8, v131
    v_exp_f32 v136, v136
    v_exp_f32 v137, v137
    v_exp_f32 v138, v138
    v_exp_f32 v139, v139
    v_and_b32 v153, v9, v228
    v_add_f32 v136, 1.0, v136
    v_add_f32 v137, 1.0, v137
    v_add_f32 v138, 1.0, v138
    v_add_f32 v139, 1.0, v139
    v_rcp_f32 v136, v136
    v_rcp_f32 v137, v137
    v_rcp_f32 v138, v138
    v_rcp_f32 v139, v139
    v_lshlrev_b32 v152, 16, v228
    s_setprio 2
    ds_read_b32 v41, v88 offset:32
    ds_read_b64 v[44:45], v37 offset:2560
    ds_read_b64 v[46:47], v37 offset:36352
    ds_read_b64 v[48:49], v39 offset:2560
    ds_read_b64 v[50:51], v39 offset:36352
    s_setprio 0
    v_and_b32 v132, v9, v17
    v_and_b32 v133, v9, v19
    v_and_b32 v134, v9, v21
    v_and_b32 v135, v9, v23
    v_mul_f32 v140, v8, v132
    v_mul_f32 v141, v8, v133
    v_mul_f32 v142, v8, v134
    v_mul_f32 v143, v8, v135
    v_exp_f32 v140, v140
    v_exp_f32 v141, v141
    v_exp_f32 v142, v142
    v_exp_f32 v143, v143
    v_and_b32 v155, v9, v230
    v_add_f32 v140, 1.0, v140
    v_add_f32 v141, 1.0, v141
    v_add_f32 v142, 1.0, v142
    v_add_f32 v143, 1.0, v143
    v_rcp_f32 v140, v140
    v_rcp_f32 v141, v141
    v_rcp_f32 v142, v142
    v_rcp_f32 v143, v143
    v_lshlrev_b32 v154, 16, v230
    s_waitcnt lgkmcnt(0)
    v_cmp_eq_u32 vcc, 0, v41
    s_cbranch_vccz L_w1_go
    s_setprio 2
L_w1:
    ds_read_b32 v41, v88 offset:32
    s_waitcnt lgkmcnt(0)
    v_cmp_eq_u32 vcc, 0, v41
    s_cbranch_vccz L_w1_ok
    s_sleep 2
    s_sub_u32 s61, s61, 1
    s_cbranch_scc0 L_w1
L_w1_ok:
    ds_read_b64 v[44:45], v37 offset:2560
    ds_read_b64 v[46:47], v37 offset:36352
    ds_read_b64 v[48:49], v39 offset:2560
    ds_read_b64 v[50:51], v39 offset:36352
    s_setprio 0
    s_waitcnt lgkmcnt(0)
L_w1_go:
    v_fma_f32 v144, v44, v136, v153
    v_fma_f32 v145, v46, v137, v153
    v_fma_f32 v146, v48, v138, v153
    v_fma_f32 v147, v50, v139, v153
    v_fma_f32 v128, v128, v144, v152
    v_fma_f32 v129, v129, v145, v152
    v_fma_f32 v130, v130, v146, v152
    v_fma_f32 v131, v131, v147, v152
    v_cvt_pk_bf16_f32 v136, v128, v129
    v_cvt_pk_bf16_f32 v137, v130, v131
    global_store_dwordx2 v36, v[136:137], s[32:33] offset:0
    v_fma_f32 v148, v45, v140, v155
    v_fma_f32 v149, v47, v141, v155
    v_fma_f32 v150, v49, v142, v155
    v_fma_f32 v151, v51, v143, v155
    v_fma_f32 v132, v132, v148, v154
    v_fma_f32 v133, v133, v149, v154
    v_fma_f32 v134, v134, v150, v154
    v_fma_f32 v135, v135, v151, v154
    v_cvt_pk_bf16_f32 v140, v132, v133
    v_cvt_pk_bf16_f32 v141, v134, v135
    global_store_dwordx2 v36, v[140:141], s[32:33] offset:1152
    v_add_u32 v36, 589824, v36
    v_lshlrev_b32 v160, 16, v24
    v_lshlrev_b32 v161, 16, v26
    v_lshlrev_b32 v162, 16, v28
    v_lshlrev_b32 v163, 16, v30
    v_mul_f32 v168, v8, v160
    v_mul_f32 v169, v8, v161
    v_mul_f32 v170, v8, v162
    v_mul_f32 v171, v8, v163
    v_exp_f32 v168, v168
    v_exp_f32 v169, v169
    v_exp_f32 v170, v170
    v_exp_f32 v171, v171
    v_and_b32 v185, v9, v232
    v_add_f32 v168, 1.0, v168
    v_add_f32 v169, 1.0, v169
    v_add_f32 v170, 1.0, v170
    v_add_f32 v171, 1.0, v171
    v_rcp_f32 v168, v168
    v_rcp_f32 v169, v169
    v_rcp_f32 v170, v170
    v_rcp_f32 v171, v171
    v_lshlrev_b32 v184, 16, v232
    s_setprio 2
    ds_read_b32 v41, v88 offset:64
    ds_read_b64 v[44:45], v37 offset:5120
    ds_read_b64 v[46:47], v37 offset:38912
    ds_read_b64 v[48:49], v39 offset:5120
    ds_read_b64 v[50:51], v39 offset:38912
    s_setprio 0
    v_and_b32 v164, v9, v24
    v_and_b32 v165, v9, v26
    v_and_b32 v166, v9, v28
    v_and_b32 v167, v9, v30
    v_mul_f32 v172, v8, v164
    v_mul_f32 v173, v8, v165
    v_mul_f32 v174, v8, v166
    v_mul_f32 v175, v8, v167
    v_exp_f32 v172, v172
    v_exp_f32 v173, v173
    v_exp_f32 v174, v174
    v_exp_f32 v175, v175
    v_and_b32 v187, v9, v234
    v_add_f32 v172, 1.0, v172
    v_add_f32 v173, 1.0, v173
    v_add_f32 v174, 1.0, v174
    v_add_f32 v175, 1.0, v175
    v_rcp_f32 v172, v172
    v_rcp_f32 v173, v173
    v_rcp_f32 v174, v174
    v_rcp_f32 v175, v175
    v_lshlrev_b32 v186, 16, v234
    s_waitcnt lgkmcnt(0)
    v_cmp_eq_u32 vcc, 0, v41
    s_cbranch_vccz L_w2_go
    s_setprio 2
L_w2:
    ds_read_b32 v41, v88 offset:64
    s_waitcnt lgkmcnt(0)
    v_cmp_eq_u32 vcc, 0, v41
    s_cbranch_vccz L_w2_ok
    s_sleep 2
    s_sub_u32 s61, s61, 1
    s_cbranch_scc0 L_w2
L_w2_ok:
    ds_read_b64 v[44:45], v37 offset:5120
    ds_read_b64 v[46:47], v37 offset:38912
    ds_read_b64 v[48:49], v39 offset:5120
    ds_read_b64 v[50:51], v39 offset:38912
    s_setprio 0
    s_waitcnt lgkmcnt(0)
L_w2_go:
    v_fma_f32 v176, v44, v168, v185
    v_fma_f32 v177, v46, v169, v185
    v_fma_f32 v178, v48, v170, v185
    v_fma_f32 v179, v50, v171, v185
    v_fma_f32 v160, v160, v176, v184
    v_fma_f32 v161, v161, v177, v184
    v_fma_f32 v162, v162, v178, v184
    v_fma_f32 v163, v163, v179, v184
    v_cvt_pk_bf16_f32 v168, v160, v161
    v_cvt_pk_bf16_f32 v169, v162, v163
    global_store_dwordx2 v36, v[168:169], s[32:33] offset:0
    v_fma_f32 v180, v45, v172, v187
    v_fma_f32 v181, v47, v173, v187
    v_fma_f32 v182, v49, v174, v187
    v_fma_f32 v183, v51, v175, v187
    v_fma_f32 v164, v164, v180, v186
    v_fma_f32 v165, v165, v181, v186
    v_fma_f32 v166, v166, v182, v186
    v_fma_f32 v167, v167, v183, v186
    v_cvt_pk_bf16_f32 v172, v164, v165
    v_cvt_pk_bf16_f32 v173, v166, v167
    global_store_dwordx2 v36, v[172:173], s[32:33] offset:1152
    v_add_u32 v36, 589824, v36
    v_lshlrev_b32 v192, 16, v25
    v_lshlrev_b32 v193, 16, v27
    v_lshlrev_b32 v194, 16, v29
    v_lshlrev_b32 v195, 16, v31
    v_mul_f32 v200, v8, v192
    v_mul_f32 v201, v8, v193
    v_mul_f32 v202, v8, v194
    v_mul_f32 v203, v8, v195
    v_exp_f32 v200, v200
    v_exp_f32 v201, v201
    v_exp_f32 v202, v202
    v_exp_f32 v203, v203
    v_and_b32 v217, v9, v236
    v_add_f32 v200, 1.0, v200
    v_add_f32 v201, 1.0, v201
    v_add_f32 v202, 1.0, v202
    v_add_f32 v203, 1.0, v203
    v_rcp_f32 v200, v200
    v_rcp_f32 v201, v201
    v_rcp_f32 v202, v202
    v_rcp_f32 v203, v203
    v_lshlrev_b32 v216, 16, v236
    s_setprio 2
    ds_read_b32 v41, v88 offset:96
    ds_read_b64 v[44:45], v37 offset:7680
    ds_read_b64 v[46:47], v37 offset:41472
    ds_read_b64 v[48:49], v39 offset:7680
    ds_read_b64 v[50:51], v39 offset:41472
    s_setprio 0
    v_and_b32 v196, v9, v25
    v_and_b32 v197, v9, v27
    v_and_b32 v198, v9, v29
    v_and_b32 v199, v9, v31
    v_mul_f32 v204, v8, v196
    v_mul_f32 v205, v8, v197
    v_mul_f32 v206, v8, v198
    v_mul_f32 v207, v8, v199
    v_exp_f32 v204, v204
    v_exp_f32 v205, v205
    v_exp_f32 v206, v206
    v_exp_f32 v207, v207
    v_and_b32 v219, v9, v238
    v_add_f32 v204, 1.0, v204
    v_add_f32 v205, 1.0, v205
    v_add_f32 v206, 1.0, v206
    v_add_f32 v207, 1.0, v207
    v_rcp_f32 v204, v204
    v_rcp_f32 v205, v205
    v_rcp_f32 v206, v206
    v_rcp_f32 v207, v207
    v_lshlrev_b32 v218, 16, v238
    s_waitcnt lgkmcnt(0)
    v_cmp_eq_u32 vcc, 0, v41
    s_cbranch_vccz L_w3_go
    s_setprio 2
L_w3:
    ds_read_b32 v41, v88 offset:96
    ds_read_b64 v[44:45], v37 offset:7680
    ds_read_b64 v[46:47], v37 offset:41472
    ds_read_b64 v[48:49], v39 offset:7680
    ds_read_b64 v[50:51], v39 offset:41472
    s_waitcnt lgkmcnt(0)
    v_cmp_eq_u32 vcc, 0, v41
    s_cbranch_vccz L_w3_ok
    s_sleep 1
    s_sub_u32 s61, s61, 1
    s_cbranch_scc0 L_w3
L_w3_ok:
L_w3_go:
    v_fma_f32 v208, v44, v200, v217
    v_fma_f32 v209, v46, v201, v217
    v_fma_f32 v210, v48, v202, v217
    v_fma_f32 v211, v50, v203, v217
    v_fma_f32 v192, v192, v208, v216
    v_fma_f32 v193, v193, v209, v216
    v_fma_f32 v194, v194, v210, v216
    v_fma_f32 v195, v195, v211, v216
    v_cvt_pk_bf16_f32 v200, v192, v193
    v_cvt_pk_bf16_f32 v201, v194, v195
    global_store_dwordx2 v36, v[200:201], s[32:33] offset:0
    v_fma_f32 v212, v45, v204, v219
    v_fma_f32 v213, v47, v205, v219
    v_fma_f32 v214, v49, v206, v219
    v_fma_f32 v215, v51, v207, v219
    v_fma_f32 v196, v196, v212, v218
    v_fma_f32 v197, v197, v213, v218
    v_fma_f32 v198, v198, v214, v218
    v_fma_f32 v199, v199, v215, v218
    v_cvt_pk_bf16_f32 v204, v196, v197
    v_cvt_pk_bf16_f32 v205, v198, v199
    global_store_dwordx2 v36, v[204:205], s[32:33] offset:1152
    s_waitcnt vmcnt(63)
    s_barrier
    s_waitcnt vmcnt(0)
    s_barrier
    s_endpgm
L_lnp:
    s_mul_i32 s43, s39, 1216
    s_add_u32 s43, s43, 154048
    v_add_u32 v52, s43, v3
    v_add_u32 v53, s43, v4
    s_lshl_b32 s43, s39, 3
    s_add_u32 s43, s43, 163776
    v_mov_b32 v54, s43
    v_bfe_u32 v55, v0, 2, 2
    v_mul_u32_u24 v55, 1216, v55
    v_and_b32 v56, 3, v0
    v_lshl_add_u32 v55, v56, 3, v55
    v_lshrrev_b32 v56, 4, v0
    v_lshl_add_u32 v55, v56, 5, v55
    v_add_u32 v55, 154048, v55
    v_lshrrev_b32 v56, 3, v0
    v_lshlrev_b32 v56, 15, v56
    v_and_b32 v57, 112, v3
    s_lshl_b32 s43, s2, 7
    s_add_u32 s43, s43, 2101248
    v_add3_u32 v56, v56, v57, s43
    v_mov_b32 v40, 0
    v_mov_b32 v41, 0
    v_mov_b32 v42, 0
    v_mov_b32 v43, 0
    v_mov_b32 v44, 0x3ae38e39
    v_mov_b32 v38, 0xbfffbfff
    v_mov_b32 v37, 0xffff
    s_lshl_b32 s58, s2, 3
    s_add_u32 s58, s58, s39
    s_xor_b32 s58, s58, 0x7ff
    s_lshl_b32 s58, s58, 5
    s_waitcnt lgkmcnt(0)
    s_add_u32 s38, s38, 0x9e370001
    s_lshr_b32 s44, s38, 16
    s_and_b32 s45, s38, 0xff
    s_and_b32 s46, s38, 0xfb
    s_bitcmp0_b32 s38, 0
    s_cselect_b32 s43, 4, 0
    s_or_b32 s46, s46, s43
    s_bitcmp1_b32 s46, s39
    s_cselect_b32 s43, 0x40004000, 0
    v_mov_b32 v39, s43
    s_xor_b32 s58, s58, s44
    v_mov_b32 v57, s58
    s_mov_b32 s42, 0x3f803f80
    s_cmp_lt_u32 s41, 27
    s_cbranch_scc1 L_lw2
    s_cmp_lt_u32 s39, 2
    s_cbranch_scc0 L_lw1
    global_load_dword v1, v76, s[56:57]
    s_waitcnt vmcnt(1)
    s_branch L_ln
L_lw1:
    s_waitcnt vmcnt(0)
    s_branch L_ln
L_lw2:
    s_add_u32 m0, s49, 0
    s_nop 0
    global_load_lds_dwordx4 v76, s[56:57]
    v_add_u32 v76, 294912, v76
    s_add_u32 m0, s49, 4096
    s_nop 0
    global_load_lds_dwordx4 v76, s[56:57]
    v_add_u32 v76, 294912, v76
    s_add_u32 m0, s49, 8192
    s_nop 0
    global_load_lds_dwordx4 v76, s[56:57]
    v_add_u32 v76, 294912, v76
    s_waitcnt vmcnt(3)
L_ln:
    v_dot2c_f32_bf16 v40, s42, v12
    v_dot2c_f32_bf16 v41, v12, v12
    v_dot2c_f32_bf16 v42, v12, v20
    v_dot2c_f32_bf16 v43, s42, v20
    v_dot2c_f32_bf16 v40, s42, v13
    v_dot2c_f32_bf16 v41, v13, v13
    v_dot2c_f32_bf16 v42, v13, v21
    v_dot2c_f32_bf16 v43, s42, v21
    v_dot2c_f32_bf16 v40, s42, v14
    v_dot2c_f32_bf16 v41, v14, v14
    v_dot2c_f32_bf16 v42, v14, v22
    v_dot2c_f32_bf16 v43, s42, v22
    v_dot2c_f32_bf16 v40, s42, v15
    v_dot2c_f32_bf16 v41, v15, v15
    v_dot2c_f32_bf16 v42, v15, v23
    v_dot2c_f32_bf16 v43, s42, v23
    v_dot2c_f32_bf16 v40, s42, v16
    v_dot2c_f32_bf16 v41, v16, v16
    v_dot2c_f32_bf16 v42, v16, v24
    v_dot2c_f32_bf16 v43, s42, v24
    v_lshlrev_b32 v36, 16, v16
    v_lshlrev_b32 v28, 16, v12
    v_and_b32 v29, 0xffff0000, v12
    v_permlane32_swap_b32 v40, v42
    v_permlane32_swap_b32 v41, v43
    v_add_f32 v40, v40, v42
    v_add_f32 v41, v41, v43
    v_lshlrev_b32 v30, 16, v13
    v_and_b32 v31, 0xffff0000, v13
    v_permlane16_swap_b32 v40, v41
    v_add_f32 v40, v40, v41
    v_lshlrev_b32 v32, 16, v14
    v_and_b32 v33, 0xffff0000, v14
    v_add_f32_dpp v40, v40, v40 row_ror:8 row_mask:0xf bank_mask:0xf
    v_lshlrev_b32 v34, 16, v15
    v_and_b32 v35, 0xffff0000, v15
    v_add_f32_dpp v40, v40, v40 row_ror:4 row_mask:0xf bank_mask:0xf
    s_nop 1
    v_add_f32_dpp v40, v40, v40 row_ror:2 row_mask:0xf bank_mask:0xf
    s_nop 1
    v_add_f32_dpp v40, v40, v40 row_ror:1 row_mask:0xf bank_mask:0xf
    s_nop 0
    v_readlane_b32 s58, v40, 0
    v_readlane_b32 s59, v40, 16
    v_readlane_b32 s60, v40, 32
    v_readlane_b32 s61, v40, 48
    v_mul_f32 v40, s58, v44
    v_mul_f32 v41, s59, v44
    v_fma_f32 v41, -v40, v40, v41
    v_max_f32 v41, 0, v41
    v_cvt_pk_bf16_f32 v44, v41, v40
    v_lshlrev_b32 v41, 16, v44
    v_add_f32 v41, 0x3727c5ac, v41
    v_cvt_pk_bf16_f32 v41, v41, v41
    v_and_b32 v41, 0xffff0000, v41
    v_mul_f32 v41, 0x44800000, v41
    v_sqrt_f32 v41, v41
    v_and_b32 v49, 0xffff0000, v44
    v_cvt_pk_bf16_f32 v50, v49, v41
    v_and_b32 v41, 0xffff0000, v50
    v_rcp_f32 v46, v41
    v_mul_f32 v42, s61, v49
    v_mul_f32 v47, v49, v46
    v_fma_f32 v28, v28, v46, -v47
    v_fma_f32 v29, v29, v46, -v47
    v_fma_f32 v30, v30, v46, -v47
    v_fma_f32 v31, v31, v46, -v47
    v_fma_f32 v32, v32, v46, -v47
    v_fma_f32 v33, v33, v46, -v47
    v_fma_f32 v34, v34, v46, -v47
    v_fma_f32 v35, v35, v46, -v47
    v_fma_f32 v36, v36, v46, -v47
    v_cvt_pk_bf16_f32 v28, v28, v29
    v_cvt_pk_bf16_f32 v29, v30, v31
    v_cvt_pk_bf16_f32 v30, v32, v33
    v_cvt_pk_bf16_f32 v31, v34, v35
    v_cvt_pk_bf16_f32 v32, v36, v36
    v_bitop3_b32 v28, v28, v38, v39 bitop3:0xea
    v_bitop3_b32 v29, v29, v38, v39 bitop3:0xea
    v_bitop3_b32 v30, v30, v38, v39 bitop3:0xea
    v_bitop3_b32 v31, v31, v38, v39 bitop3:0xea
    v_bitop3_b32 v32, v32, v38, v39 bitop3:0xea
    ds_write_b128 v52, v[28:31]
    ds_write_b16 v53, v32 offset:1024
    v_sub_f32 v42, s60, v42
    v_mul_f32 v42, 0x42000000, v42
    v_mul_f32 v42, v42, v46
    v_cvt_pk_bf16_f32 v42, v42, v42
    v_ashrrev_i32 v43, 31, v42
    v_or_b32 v43, 0x80000000, v43
    v_xor_b32 v42, v42, v43
    v_bitop3_b32 v51, v37, v57, v42 bitop3:0xca
    s_mov_b64 exec, 1
    ds_write_b64 v54, v[50:51]
    s_mov_b64 exec, -1
    s_waitcnt lgkmcnt(0)
    s_barrier
    s_cmp_eq_u32 s39, 1
    s_cbranch_scc1 L_ln_stat
    ds_read_b64_tr_b16 v[28:29], v55
    ds_read_b64_tr_b16 v[30:31], v55 offset:4864
    s_cmp_eq_u32 s39, 0
    s_cbranch_scc0 L_ln_st
    ds_read_b64_tr_b16 v[32:33], v55 offset:1024
    ds_read_b64_tr_b16 v[34:35], v55 offset:5888
    v_add_u32 v38, 2097152, v56
    s_waitcnt lgkmcnt(0)
    global_store_dwordx4 v38, v[32:35], s[36:37] sc1
    s_branch L_ln_st
L_ln_stat:
    v_and_b32 v41, 0x30, v3
    v_add_u32 v40, 163776, v41
    ds_read_b128 v[48:51], v40
    ds_read_b64_tr_b16 v[28:29], v55
    ds_read_b64_tr_b16 v[30:31], v55 offset:4864
    s_lshl_b32 s43, s2, 6
    s_add_u32 s43, s43, 16384
    v_add_u32 v41, s43, v41
    s_mov_b64 exec, 15
    s_waitcnt lgkmcnt(2)
    global_store_dwordx4 v41, v[48:51], s[36:37] sc1
    s_mov_b64 exec, -1
L_ln_st:
    s_waitcnt lgkmcnt(0)
    global_store_dwordx4 v56, v[28:31], s[36:37] sc1
    s_barrier
    s_cmp_lt_u32 s41, 27
    s_cbranch_scc1 L_ffn
    s_cmp_lt_u32 s39, 2
    s_cbranch_scc1 L_sp2
    global_load_dword v1, v76, s[56:57]
L_sp2:
    s_mul_i32 s42, s39, 320
    s_add_u32 s42, s42, s53
    s_add_u32 s42, s42, 2944
    s_mov_b32 s58, 2
    s_mul_i32 s43, s40, 1152
    s_add_u32 s43, s43, 884736
    s_mul_i32 s59, s40, 663552
    s_cmp_eq_u32 s58, 0
    s_cselect_b32 s56, s26, s28
    s_cselect_b32 s57, s27, s29
    s_cmp_eq_u32 s58, 2
    s_cselect_b32 s56, s30, s56
    s_cselect_b32 s57, s31, s57
    s_cselect_b32 s43, s59, s43
    s_movk_i32 s58, 128
    s_movk_i32 s59, 8064
    s_movk_i32 s60, 4319
    s_cmov_b32 s58, 73728
    s_cmov_b32 s59, -663424
    s_cmovk_i32 s60, 5183
    v_add_u32 v76, s42, v2
    v_min_u32 v76, s60, v76
    v_mul_u32_u24 v63, 7282, v76
    v_lshrrev_b32 v63, 16, v63
    v_mul_u32_u24 v76, s58, v76
    v_mad_i32_i24 v76, v63, s59, v76
    v_add_u32 v76, s43, v76
    s_barrier
    s_cmp_ge_u32 s39, 7
    s_cbranch_scc1 L_sp3
    global_load_dword v1, v76, s[56:57]
L_sp3:
    s_sub_u32 s42, s2, 216
    s_cmp_ge_u32 s42, 32
    s_cbranch_scc1 L_sp4
    s_cmp_ge_u32 s39, 1
    s_cbranch_scc1 L_sp4
    s_lshl_b32 s42, s42, 6
    v_add_u32 v76, s42, v2
    v_mul_u32_u24 v76, 1152, v76
    s_lshl_b32 s42, s39, 7
    v_subrev_u32 v76, s42, v76
    v_add_u32 v76, 1024, v76
    global_load_dword v1, v76, s[32:33]
L_sp4:
    s_waitcnt vmcnt(0) lgkmcnt(0)
    s_endpgm
L_ffn:
    v_bfe_u32 v14, v0, 4, 2
    v_and_b32 v11, 7, v0
    v_mov_b32 v26, 147456
    v_mov_b32 v27, 4
    s_cmp_eq_u32 s52, 0
    s_cbranch_scc0 L_gu
    s_setprio 1
    v_lshlrev_b32 v8, 4, v0
    v_add_u32 v9, 20480, v8
    v_add_u32 v10, 8192, v9
    v_lshlrev_b32 v13, 6, v0
    v_xor_b32 v128, 65504, v13
    v_xor_b32 v129, 65472, v13
    v_xor_b32 v130, 49120, v13
    v_xor_b32 v131, 49088, v13
    v_xor_b32 v132, 32736, v13
    v_xor_b32 v133, 32704, v13
    v_xor_b32 v134, 16352, v13
    v_xor_b32 v135, 16320, v13
    v_mov_b32 v36, s44
    v_lshrrev_b32 v25, 5, v0
    v_lshl_add_u32 v25, v25, 2, v26
    s_mul_i32 s62, s39, 80
    s_add_u32 s62, s62, 147584
    v_and_b32 v15, 0x3c, v0
    v_add_u32 v15, s62, v15
    v_and_b32 v16, 3, v0
    v_mul_u32_u24 v16, 80, v16
    v_add_u32 v16, 147584, v16
    v_lshrrev_b32 v12, 3, v2
    v_lshl_add_u32 v17, v12, 2, v26
    v_lshl_add_u32 v18, v11, 2, v26
    v_and_b32 v12, 6, v12
    v_xor_b32 v12, v12, v11
    v_lshlrev_b32 v12, 4, v12
    v_lshl_add_u32 v12, v1, 7, v12
    v_add_u32 v12, 2358144, v12
    s_lshl_b32 s63, s54, 7
    s_add_u32 s63, s63, 2358144
    v_mov_b32 v37, s63
    s_movk_i32 s63, -1152
    s_mul_i32 s64, s39, 1056
    s_mul_i32 s42, s50, 73728
    s_add_u32 s12, s30, s42
    s_addc_u32 s13, s31, 0
    s_add_u32 s14, s12, 18432
    s_addc_u32 s15, s13, 0
    s_add_u32 s16, s12, 36864
    s_addc_u32 s17, s13, 0
    s_add_u32 s18, s12, 55296
    s_addc_u32 s19, s13, 0
    v_mul_u32_u24 v19, 4608, v14
    v_and_b32 v20, 0xf0, v3
    s_lshl_b32 s42, s51, 8
    v_add3_u32 v19, v19, v20, s42
    v_lshrrev_b32 v20, 1, v2
    v_mul_u32_u24 v20, 1152, v20
    v_and_b32 v21, 16, v3
    s_lshl_b32 s42, s51, 5
    v_add3_u32 v20, v20, v21, s42
    v_bfe_i32 v232, v0, 3, 1
    v_mul_u32_u24 v4, 74752, v14
    v_lshl_add_u32 v4, v11, 4, v4
    v_and_b32 v5, 37376, v232
    s_lshl_b32 s43, s50, 7
    s_add_u32 s43, s43, 65536
    s_mul_i32 s42, s51, 299008
    s_add_u32 s42, s42, s43
    v_add3_u32 v4, v4, v5, s42
    v_add_u32 v5, 18688, v4
    v_add_u32 v6, 9344, v4
    v_add_u32 v7, 28032, v4
    v_mul_u32_u24 v8, 9344, v14
    v_lshl_add_u32 v8, v11, 4, v8
    s_mul_i32 s42, s51, 37376
    s_add_u32 s42, s42, s43
    s_add_u32 s42, s42, 1196032
    v_add_u32 v8, s42, v8
    v_mov_b32 v233, s45
    v_mov_b32 v234, 0xff
    v_and_b32 v235, 0x370, v3
    v_add_u32 v235, 147968, v235
    s_lshl_b32 s42, s51, 10
    s_add_u32 s42, s42, 159520
    v_add_u32 v236, s42, v3
    v_lshl_add_u32 v237, v2, 3, s42
    s_mov_b32 s66, 0x05040100
    s_mov_b32 s67, 0x07060302
    s_mov_b32 s55, 131072
    s_waitcnt vmcnt(0)
    s_barrier
    global_load_dwordx4 v[112:115], v9, s[36:37] offset:-4096 sc1
    global_load_dwordx4 v[116:119], v9, s[36:37] offset:0 sc1
    global_load_dwordx4 v[120:123], v10, s[36:37] offset:-4096 sc1
    global_load_dwordx4 v[124:127], v10, s[36:37] offset:0 sc1
L_ffn_poll:
    v_mov_b32 v24, 0
    s_waitcnt vmcnt(3)
    v_xor_b32 v28, v36, v113
    v_bitop3_b32 v24, v24, v28, v128 bitop3:0xf6
    v_xor_b32 v29, v36, v115
    v_bitop3_b32 v24, v24, v29, v129 bitop3:0xf6
    s_waitcnt vmcnt(2)
    v_xor_b32 v30, v36, v117
    v_bitop3_b32 v24, v24, v30, v130 bitop3:0xf6
    v_xor_b32 v31, v36, v119
    v_bitop3_b32 v24, v24, v31, v131 bitop3:0xf6
    s_waitcnt vmcnt(1)
    v_xor_b32 v32, v36, v121
    v_bitop3_b32 v24, v24, v32, v132 bitop3:0xf6
    v_xor_b32 v33, v36, v123
    v_bitop3_b32 v24, v24, v33, v133 bitop3:0xf6
    s_waitcnt vmcnt(0)
    v_xor_b32 v34, v36, v125
    v_bitop3_b32 v24, v24, v34, v134 bitop3:0xf6
    v_xor_b32 v35, v36, v127
    v_bitop3_b32 v24, v24, v35, v135 bitop3:0xf6
    v_and_b32 v24, 0xffff, v24
    v_cmp_ne_u32 vcc, 0, v24
    v_max3_u32 v38, v28, v29, v30
    v_max3_u32 v39, v31, v32, v33
    s_cbranch_vccz L_ffn_go
    global_load_dwordx4 v[112:115], v9, s[36:37] offset:-4096 sc1
    global_load_dwordx4 v[116:119], v9, s[36:37] offset:0 sc1
    global_load_dwordx4 v[120:123], v10, s[36:37] offset:-4096 sc1
    global_load_dwordx4 v[124:127], v10, s[36:37] offset:0 sc1
    s_sub_u32 s55, s55, 1
    s_cbranch_scc0 L_ffn_poll
    s_waitcnt vmcnt(0)
L_ffn_go:
    s_barrier
    v_max3_u32 v38, v38, v34, v35
    v_max_u32 v38, v38, v39
    v_alignbit_b32 v24, 1, v38, 5
    v_sub_u32 v128, v28, v38
    v_sub_u32 v129, v29, v38
    v_max_u32_dpp v21, v24, v24 row_ror:1 row_mask:0xf bank_mask:0xf
    v_sub_u32 v130, v30, v38
    v_sub_u32 v131, v31, v38
    v_max_u32_dpp v21, v21, v21 row_ror:2 row_mask:0xf bank_mask:0xf
    v_sub_u32 v132, v32, v38
    v_sub_u32 v133, v33, v38
    v_max_u32_dpp v21, v21, v21 row_ror:4 row_mask:0xf bank_mask:0xf
    v_sub_u32 v134, v34, v38
    v_sub_u32 v135, v35, v38
    v_max_u32_dpp v21, v21, v21 row_ror:8 row_mask:0xf bank_mask:0xf
    v_max3_u32 v39, v128, v129, v130
    v_max3_u32 v22, v131, v132, v133
    v_max_u32_dpp v21, v21, v21 row_bcast:15 row_mask:0xa bank_mask:0xf
    s_mov_b32 exec_lo, 0x80000000
    s_mov_b32 exec_hi, 0x80000000
    ds_write_b32 v25, v21
    s_mov_b64 exec, -1
    s_mov_b32 s55, 2097152
    ds_read_b128 v[112:115], v26
    ds_read_b128 v[116:119], v26 offset:16
    v_max3_u32 v39, v39, v134, v135
    v_max_u32 v39, v39, v22
    v_add_u32 v39, v39, v38
    v_alignbit_b32 v23, 1, v39, 5
L_s1:
    s_waitcnt lgkmcnt(0)
    v_min3_u32 v21, v112, v113, v114
    v_min3_u32 v22, v115, v116, v117
    v_min3_u32 v21, v21, v118, v119
    v_min_u32 v21, v21, v22
    v_cmp_eq_u32 vcc, 0, v21
    v_cmp_ge_u32 s[6:7], v24, v21
    v_cmp_ge_u32 s[8:9], v23, v21
    s_cbranch_vccz L_s1_ok
    ds_read_b128 v[112:115], v26
    ds_read_b128 v[116:119], v26 offset:16
    s_sub_u32 s55, s55, 1
    s_cbranch_scc0 L_s1
L_s1_ok:
    s_bcnt1_i32_b64 s10, s[6:7]
    v_mbcnt_lo_u32_b32 v22, s6, 0
    v_mbcnt_lo_u32_b32 v13, s8, 0
    v_mbcnt_hi_u32_b32 v22, s7, v22
    v_mbcnt_hi_u32_b32 v13, s9, v13
    v_min_u32 v22, 16, v22
    v_add_u32 v13, s10, v13
    v_lshl_add_u32 v22, v22, 2, s62
    v_min_u32 v13, 16, v13
    s_mov_b64 exec, s[6:7]
    ds_write_b32 v22, v24
    v_lshl_add_u32 v13, v13, 2, s62
    s_mov_b64 exec, s[8:9]
    ds_write_b32 v13, v23
    s_mov_b64 exec, 1
    ds_add_u32 v26, v27 offset:32
    s_mov_b64 exec, -1
    ds_read_b32 v22, v26 offset:32
    ds_read_b32 v13, v15
    ds_read_b128 v[112:115], v16 offset:0
    ds_read_b128 v[116:119], v16 offset:16
    ds_read_b128 v[120:123], v16 offset:32
    ds_read_b128 v[124:127], v16 offset:48
    v_and_b32 v24, 0x7ff, v24
    v_and_b32 v23, 0x7ff, v23
    v_mad_i32_i24 v24, v24, s63, v37
    v_mad_i32_i24 v23, v23, s63, v37
    s_mov_b64 exec, s[6:7]
    global_load_dword v239, v24, s[4:5]
    s_cmp_eq_u64 s[8:9], 0
    s_cbranch_scc1 L_no2
    s_mov_b64 exec, s[8:9]
    global_load_dword v239, v23, s[4:5]
L_no2:
    s_mov_b64 exec, -1
L_s2:
    s_waitcnt lgkmcnt(0)
    v_cmp_ne_u32 vcc, 16, v22
    v_mov_b32 v24, 0
    s_cbranch_vccz L_s2_ok
    ds_read_b32 v22, v26 offset:32
    ds_read_b32 v13, v15
    ds_read_b128 v[112:115], v16 offset:0
    ds_read_b128 v[116:119], v16 offset:16
    ds_read_b128 v[120:123], v16 offset:32
    ds_read_b128 v[124:127], v16 offset:48
    s_sub_u32 s55, s55, 1
    s_cbranch_scc0 L_s2
L_s2_ok:
    v_sub_u32 v112, v13, v112
    v_alignbit_b32 v24, v24, v112, 31
    v_sub_u32 v113, v13, v113
    v_alignbit_b32 v24, v24, v113, 31
    v_sub_u32 v114, v13, v114
    v_alignbit_b32 v24, v24, v114, 31
    v_sub_u32 v115, v13, v115
    v_alignbit_b32 v24, v24, v115, 31
    v_sub_u32 v116, v13, v116
    v_alignbit_b32 v24, v24, v116, 31
    v_sub_u32 v117, v13, v117
    v_alignbit_b32 v24, v24, v117, 31
    v_sub_u32 v118, v13, v118
    v_alignbit_b32 v24, v24, v118, 31
    v_sub_u32 v119, v13, v119
    v_alignbit_b32 v24, v24, v119, 31
    v_sub_u32 v120, v13, v120
    v_alignbit_b32 v24, v24, v120, 31
    v_sub_u32 v121, v13, v121
    v_alignbit_b32 v24, v24, v121, 31
    v_sub_u32 v122, v13, v122
    v_alignbit_b32 v24, v24, v122, 31
    v_sub_u32 v123, v13, v123
    v_alignbit_b32 v24, v24, v123, 31
    v_sub_u32 v124, v13, v124
    v_alignbit_b32 v24, v24, v124, 31
    v_sub_u32 v125, v13, v125
    v_alignbit_b32 v24, v24, v125, 31
    v_sub_u32 v126, v13, v126
    v_alignbit_b32 v24, v24, v126, 31
    v_sub_u32 v127, v13, v127
    v_alignbit_b32 v24, v24, v127, 31
    v_bcnt_u32_b32 v24, v24, 0
    s_nop 1
    v_add_u32_dpp v24, v24, v24 quad_perm:[1,0,3,2] row_mask:0xf bank_mask:0xf
    s_nop 1
    v_add_u32_dpp v24, v24, v24 quad_perm:[2,3,0,1] row_mask:0xf bank_mask:0xf
    v_cmp_gt_u32 vcc, 8, v24
    v_lshl_add_u32 v24, v24, 2, v26
    s_mov_b64 exec, vcc
    ds_write_b32 v24, v13 offset:64
    s_mov_b64 exec, -1
L_s3:
    ds_read_b32 v23, v17 offset:64
    ds_read_b32 v13, v18 offset:64
    s_add_u32 m0, s64, 150016
    s_waitcnt lgkmcnt(0)
    v_cmp_eq_u32 vcc, 0, v23
    v_and_b32 v23, 0x7ff, v23
    s_sub_u32 s55, s55, 1
    s_cselect_b64 vcc, 0, vcc
    s_cbranch_vccnz L_s3
    v_mad_i32_i24 v23, v23, s63, v12
    global_load_lds_dwordx4 v23, s[4:5]
    s_add_u32 m0, s64, 153728
    v_and_b32 v22, 0x7ff, v13
    global_load_lds_dwordx4 v23, s[4:5] offset:512
    v_sub_u32 v22, 2047, v22
    s_cmp_lg_u32 s39, 0
    s_cbranch_scc1 L_nox9
    s_mov_b32 m0, 157440
    s_nop 0
    global_load_lds_dwordx4 v23, s[4:5] offset:1024
    s_branch L_x3
L_nox9:
    v_lshlrev_b32 v24, 3, v22
    v_add_u32 v24, 16384, v24
    global_load_dword v25, v24, s[36:37] sc1
L_x3:
    s_barrier
    v_readlane_b32 s10, v13, 7
    s_mov_b32 s11, 0
    s_lshl_b32 s10, s10, 5
    v_cmp_le_u32 vcc, s10, v28
    s_nop 0
    s_bcnt1_i32_b64 s56, vcc
    s_add_u32 s11, s11, s56
    v_cmp_le_u32 vcc, s10, v29
    s_nop 0
    s_bcnt1_i32_b64 s56, vcc
    s_add_u32 s11, s11, s56
    v_cmp_le_u32 vcc, s10, v30
    s_nop 0
    s_bcnt1_i32_b64 s56, vcc
    s_add_u32 s11, s11, s56
    v_cmp_le_u32 vcc, s10, v31
    s_nop 0
    s_bcnt1_i32_b64 s56, vcc
    s_add_u32 s11, s11, s56
    v_cmp_le_u32 vcc, s10, v32
    s_nop 0
    s_bcnt1_i32_b64 s56, vcc
    s_add_u32 s11, s11, s56
    v_cmp_le_u32 vcc, s10, v33
    s_nop 0
    s_bcnt1_i32_b64 s56, vcc
    s_add_u32 s11, s11, s56
    v_cmp_le_u32 vcc, s10, v34
    s_nop 0
    s_bcnt1_i32_b64 s56, vcc
    s_add_u32 s11, s11, s56
    v_cmp_le_u32 vcc, s10, v35
    s_nop 0
    s_bcnt1_i32_b64 s56, vcc
    s_add_u32 s11, s11, s56
    s_lshl_b32 s11, s11, 16
    s_or_b32 s11, s11, 4
    v_mov_b32 v36, s11
    s_barrier
    global_load_dwordx4 v[40:43], v19, s[12:13] offset:0
    global_load_dwordx4 v[44:47], v19, s[12:13] offset:1152
    s_waitcnt vmcnt(2)
    s_cmp_lg_u32 s39, 1
    s_cbranch_scc1 L_nost
    ds_write_b32 v18, v25 offset:448
L_nost:
    s_mov_b64 exec, 1
    ds_add_u32 v26, v36 offset:36
    s_mov_b64 exec, -1
    s_setprio 0
    global_load_dwordx4 v[48:51], v19, s[12:13] offset:2304
    global_load_dwordx4 v[52:55], v19, s[12:13] offset:3456
    global_load_dwordx4 v[56:59], v19, s[14:15] offset:0
    global_load_dwordx4 v[60:63], v19, s[14:15] offset:1152
    global_load_dwordx4 v[64:67], v19, s[14:15] offset:2304
    global_load_dwordx4 v[68:71], v19, s[14:15] offset:3456
    global_load_dwordx4 v[216:219], v20, s[12:13] offset:1024
    global_load_dwordx4 v[220:223], v20, s[16:17] offset:1024
L_s4:
    ds_read_b32 v24, v26 offset:36
    s_waitcnt lgkmcnt(0)
    v_readfirstlane_b32 s61, v24
    s_nop 0
    s_and_b32 s60, s61, 255
    s_cmp_ge_u32 s60, 16
    s_cbranch_scc1 L_s4_ok
    s_sub_u32 s55, s55, 1
    s_cbranch_scc0 L_s4
L_s4_ok:
    s_lshr_b32 s61, s61, 16
    s_cmp_eq_u32 s61, 8
    s_cbranch_scc0 L_slow
L_dgo:
    global_load_dwordx4 v[72:75], v19, s[16:17] offset:0
    s_waitcnt vmcnt(9)
    v_perm_b32 v112, v44, v40, s66
    v_perm_b32 v116, v44, v40, s67
    v_perm_b32 v120, v45, v41, s66
    v_perm_b32 v124, v45, v41, s67
    v_perm_b32 v128, v46, v42, s66
    v_perm_b32 v132, v46, v42, s67
    v_perm_b32 v136, v47, v43, s66
    v_perm_b32 v140, v47, v43, s67
    global_load_dwordx4 v[76:79], v19, s[16:17] offset:1152
    s_waitcnt vmcnt(8)
    v_perm_b32 v113, v52, v48, s66
    v_perm_b32 v117, v52, v48, s67
    v_perm_b32 v121, v53, v49, s66
    v_perm_b32 v125, v53, v49, s67
    v_perm_b32 v129, v54, v50, s66
    v_perm_b32 v133, v54, v50, s67
    v_perm_b32 v137, v55, v51, s66
    v_perm_b32 v141, v55, v51, s67
    global_load_dwordx4 v[80:83], v19, s[16:17] offset:2304
    global_load_dwordx4 v[84:87], v19, s[16:17] offset:3456
    s_waitcnt vmcnt(8)
    v_perm_b32 v114, v60, v56, s66
    v_perm_b32 v118, v60, v56, s67
    v_perm_b32 v122, v61, v57, s66
    v_perm_b32 v126, v61, v57, s67
    v_perm_b32 v130, v62, v58, s66
    v_perm_b32 v134, v62, v58, s67
    v_perm_b32 v138, v63, v59, s66
    v_perm_b32 v142, v63, v59, s67
    global_load_dwordx4 v[88:91], v19, s[18:19] offset:0
    global_load_dwordx4 v[92:95], v19, s[18:19] offset:1152
    s_waitcnt vmcnt(8)
    v_perm_b32 v115, v68, v64, s66
    v_perm_b32 v119, v68, v64, s67
    v_perm_b32 v123, v69, v65, s66
    v_perm_b32 v127, v69, v65, s67
    v_perm_b32 v131, v70, v66, s66
    v_perm_b32 v135, v70, v66, s67
    v_perm_b32 v139, v71, v67, s66
    v_perm_b32 v143, v71, v67, s67
    global_load_dwordx4 v[96:99], v19, s[18:19] offset:2304
    global_load_dwordx4 v[100:103], v19, s[18:19] offset:3456
    s_waitcnt vmcnt(6)
    ds_write_b128 v236, v[216:219]
    ds_read_b64_tr_b16 v[104:105], v237
    ds_read_b64_tr_b16 v[106:107], v237 offset:512
    ds_write_b128 v236, v[220:223]
    ds_read_b64_tr_b16 v[108:109], v237
    ds_read_b64_tr_b16 v[110:111], v237 offset:512
    v_perm_b32 v144, v76, v72, s66
    v_perm_b32 v148, v76, v72, s67
    v_perm_b32 v152, v77, v73, s66
    v_perm_b32 v156, v77, v73, s67
    v_perm_b32 v160, v78, v74, s66
    v_perm_b32 v164, v78, v74, s67
    v_perm_b32 v168, v79, v75, s66
    v_perm_b32 v172, v79, v75, s67
    s_barrier
    ds_read_b128 v[28:31], v235
    ds_read_b128 v[32:35], v235 offset:1024
    s_mov_b32 s58, 0x00ff00ff
    s_mov_b32 s59, 0x00ff00ff
    s_waitcnt vmcnt(4)
    v_perm_b32 v145, v84, v80, s66
    v_perm_b32 v149, v84, v80, s67
    v_perm_b32 v153, v85, v81, s66
    v_perm_b32 v157, v85, v81, s67
    v_perm_b32 v161, v86, v82, s66
    v_perm_b32 v165, v86, v82, s67
    v_perm_b32 v169, v87, v83, s66
    v_perm_b32 v173, v87, v83, s67
    s_waitcnt lgkmcnt(0)
    v_mfma_f32_16x16x32_bf16 v[208:211], v[104:107], v[28:31], 0
    s_waitcnt vmcnt(2)
    v_perm_b32 v146, v92, v88, s66
    v_mfma_f32_16x16x32_bf16 v[208:211], v[108:111], v[32:35], v[208:211]
    v_perm_b32 v150, v92, v88, s67
    v_perm_b32 v154, v93, v89, s66
    v_mfma_f32_16x16x32_bf16 v[176:179], v[112:115], v[28:31], 0
    v_perm_b32 v158, v93, v89, s67
    v_perm_b32 v162, v94, v90, s66
    v_mfma_f32_16x16x32_bf16 v[180:183], v[116:119], v[28:31], 0
    v_perm_b32 v166, v94, v90, s67
    v_perm_b32 v170, v95, v91, s66
    v_mfma_f32_16x16x32_bf16 v[184:187], v[120:123], v[28:31], 0
    v_perm_b32 v174, v95, v91, s67
    s_waitcnt vmcnt(0)
    v_mfma_f32_16x16x32_bf16 v[188:191], v[124:127], v[28:31], 0
    v_perm_b32 v147, v100, v96, s66
    v_perm_b32 v151, v100, v96, s67
    v_perm_b32 v155, v101, v97, s66
    v_perm_b32 v159, v101, v97, s67
    v_perm_b32 v163, v102, v98, s66
    v_perm_b32 v167, v102, v98, s67
    v_perm_b32 v171, v103, v99, s66
    v_perm_b32 v175, v103, v99, s67
    v_mfma_f32_16x16x32_bf16 v[176:179], v[144:147], v[32:35], v[176:179]
    v_mfma_f32_16x16x32_bf16 v[180:183], v[148:151], v[32:35], v[180:183]
    v_bitop3_b32 v208, v234, v233, v208 bitop3:0xca
    s_mov_b64 exec, s[58:59]
    global_store_dwordx4 v8, v[208:211], s[36:37] sc1
    s_mov_b64 exec, -1
    v_mfma_f32_16x16x32_bf16 v[184:187], v[152:155], v[32:35], v[184:187]
    v_mfma_f32_16x16x32_bf16 v[188:191], v[156:159], v[32:35], v[188:191]
    v_mfma_f32_16x16x32_bf16 v[192:195], v[128:131], v[28:31], 0
    v_mfma_f32_16x16x32_bf16 v[196:199], v[132:135], v[28:31], 0
    v_mfma_f32_16x16x32_bf16 v[200:203], v[136:139], v[28:31], 0
    v_bitop3_b32 v212, v232, v178, v176 bitop3:0xca
    v_bitop3_b32 v213, v232, v182, v180 bitop3:0xca
    v_mfma_f32_16x16x32_bf16 v[204:207], v[140:143], v[28:31], 0
    s_nop 0
    v_bitop3_b32 v214, v232, v186, v184 bitop3:0xca
    v_bitop3_b32 v215, v232, v190, v188 bitop3:0xca
    v_mfma_f32_16x16x32_bf16 v[192:195], v[160:163], v[32:35], v[192:195]
    v_bitop3_b32 v212, v234, v233, v212 bitop3:0xca
    global_store_dwordx4 v4, v[212:215], s[36:37] sc1
    v_mfma_f32_16x16x32_bf16 v[196:199], v[164:167], v[32:35], v[196:199]
    v_bitop3_b32 v216, v232, v179, v177 bitop3:0xca
    v_bitop3_b32 v217, v232, v183, v181 bitop3:0xca
    v_mfma_f32_16x16x32_bf16 v[200:203], v[168:171], v[32:35], v[200:203]
    v_bitop3_b32 v218, v232, v187, v185 bitop3:0xca
    v_bitop3_b32 v219, v232, v191, v189 bitop3:0xca
    v_mfma_f32_16x16x32_bf16 v[204:207], v[172:175], v[32:35], v[204:207]
    v_bitop3_b32 v216, v234, v233, v216 bitop3:0xca
    global_store_dwordx4 v5, v[216:219], s[36:37] sc1
    v_bitop3_b32 v220, v232, v194, v192 bitop3:0xca
    v_bitop3_b32 v221, v232, v198, v196 bitop3:0xca
    s_nop 0
    v_bitop3_b32 v222, v232, v202, v200 bitop3:0xca
    s_nop 1
    v_bitop3_b32 v223, v232, v206, v204 bitop3:0xca
    v_bitop3_b32 v220, v234, v233, v220 bitop3:0xca
    global_store_dwordx4 v6, v[220:223], s[36:37] sc1
    v_bitop3_b32 v224, v232, v195, v193 bitop3:0xca
    v_bitop3_b32 v225, v232, v199, v197 bitop3:0xca
    v_bitop3_b32 v226, v232, v203, v201 bitop3:0xca
    v_bitop3_b32 v227, v232, v207, v205 bitop3:0xca
    v_bitop3_b32 v224, v234, v233, v224 bitop3:0xca
    global_store_dwordx4 v7, v[224:227], s[36:37] sc1
    s_lshl_b32 s42, s40, 3
    s_add_u32 s42, s42, s54
    s_add_u32 s43, s40, 64
    s_cmp_eq_u32 s54, 8
    s_cselect_b32 s42, s43, s42
    s_mul_i32 s42, s42, 18688
    s_add_u32 s42, s42, 65536
    v_min_u32 v9, 145, v0
    v_lshl_add_u32 v9, v9, 7, s42
    s_waitcnt vmcnt(0)
    global_load_dword v10, v9, s[36:37] sc1
    s_waitcnt vmcnt(0)
    s_endpgm
L_slow:
    v_mov_b32 v21, 0
    v_mov_b32 v38, v26
    s_mov_b32 s10, 16
L_slow_r:
    v_sub_u32 v176, v28, v21
    v_sub_u32 v177, v29, v21
    v_sub_u32 v178, v30, v21
    v_sub_u32 v179, v31, v21
    v_sub_u32 v180, v32, v21
    v_sub_u32 v181, v33, v21
    v_sub_u32 v182, v34, v21
    v_sub_u32 v183, v35, v21
    v_max3_u32 v24, v176, v177, v178
    v_max3_u32 v24, v24, v179, v180
    v_max3_u32 v24, v24, v181, v182
    v_max_u32 v24, v24, v183
    ds_max_u32 v38, v24 offset:96
    s_mov_b64 exec, 1
    ds_add_u32 v26, v27 offset:40
    s_mov_b64 exec, -1
L_slow_s:
    ds_read_b32 v24, v26 offset:40
    ds_read_b32 v39, v38 offset:96
    s_waitcnt lgkmcnt(0)
    v_readfirstlane_b32 s11, v24
    s_nop 0
    s_cmp_ge_u32 s11, s10
    s_cbranch_scc1 L_slow_ok
    s_sub_u32 s55, s55, 1
    s_cbranch_scc0 L_slow_s
L_slow_ok:
    v_add_u32 v21, v21, v39
    v_alignbit_b32 v24, 1, v21, 5
    ds_write_b32 v38, v24 offset:64
    v_add_u32 v38, 4, v38
    s_add_u32 s10, s10, 16
    s_cmp_le_u32 s10, 128
    s_cbranch_scc1 L_slow_r
    ds_read_b32 v23, v17 offset:64
    ds_read_b32 v13, v18 offset:64
    s_add_u32 m0, s64, 150016
    s_waitcnt lgkmcnt(0)
    v_and_b32 v23, 0x7ff, v23
    v_mad_i32_i24 v23, v23, s63, v12
    global_load_lds_dwordx4 v23, s[4:5]
    s_add_u32 m0, s64, 153728
    v_and_b32 v22, 0x7ff, v13
    global_load_lds_dwordx4 v23, s[4:5] offset:512
    v_sub_u32 v22, 2047, v22
    s_cmp_lg_u32 s39, 0
    s_cbranch_scc1 L_nox9b
    s_mov_b32 m0, 157440
    s_nop 0
    global_load_lds_dwordx4 v23, s[4:5] offset:1024
    s_branch L_x3b
L_nox9b:
    v_lshlrev_b32 v24, 3, v22
    v_add_u32 v24, 16384, v24
    global_load_dword v25, v24, s[36:37] sc1
L_x3b:
    v_mov_b32 v36, 4
    s_waitcnt vmcnt(0)
    s_cmp_lg_u32 s39, 1
    s_cbranch_scc1 L_nostb
    ds_write_b32 v18, v25 offset:448
L_nostb:
    s_mov_b64 exec, 1
    ds_add_u32 v26, v36 offset:36
    s_mov_b64 exec, -1
    s_branch L_dgo
L_gu:
    s_setprio 0
    s_add_u32 s53, s53, 12288
    v_mov_b32 v1, v76
    s_movk_i32 s55, 6
L_dma1:
    s_mov_b32 m0, s53
    s_add_u32 s42, s53, 73728
    global_load_lds_dwordx4 v1, s[26:27]
    s_mov_b32 m0, s42
    s_add_u32 s53, s53, 4096
    global_load_lds_dwordx4 v1, s[28:29]
    v_add_u32 v1, 294912, v1
    s_sub_u32 s55, s55, 1
    s_cmp_lg_u32 s55, 0
    s_cbranch_scc1 L_dma1
    v_lshrrev_b32 v12, 1, v2
    v_min_u32 v12, 8, v12
    v_mul_u32_u24 v12, 1056, v12
    v_and_b32 v13, 16, v3
    v_add_u32 v12, v12, v13
    v_add_u32 v12, 151040, v12
    v_mov_b32 v20, 0x3f803f80
    v_mov_b32 v21, v20
    v_mov_b32 v22, v20
    v_mov_b32 v23, v20
    ds_write_b128 v12, v[20:23]
    v_bfe_u32 v15, v0, 2, 2
    v_and_b32 v16, 3, v0
    v_lshl_add_u32 v17, v14, 3, v15
    v_bfe_u32 v18, v0, 3, 2
    v_xor_b32 v18, s51, v18
    v_lshlrev_b32 v18, 5, v18
    v_lshl_add_u32 v18, v16, 3, v18
    v_lshl_add_u32 v4, v17, 7, v18
    v_add_u32 v5, 36864, v4
    v_add_u32 v6, 73728, v4
    v_add_u32 v7, 110592, v4
    v_and_b32 v19, 6, v11
    v_xor_b32 v19, v19, v14
    v_lshlrev_b32 v19, 4, v19
    v_lshl_add_u32 v19, v11, 7, v19
    v_xor_b32 v20, 64, v19
    v_bfe_i32 v21, v0, 3, 1
    v_lshlrev_b32 v22, 2, v0
    v_xor_b32 v22, v22, v0
    v_and_b32 v22, 16, v22
    v_or_b32 v22, 1024, v22
    v_bfi_b32 v19, v21, v22, v19
    v_xor_b32 v22, 16, v22
    v_bfi_b32 v20, v21, v22, v20
    v_add_u32 v19, 150016, v19
    v_add_u32 v20, 150016, v20
    v_lshl_add_u32 v18, v11, 2, v26
    s_lshr_b32 s42, s51, 1
    s_lshl_b32 s42, s42, 10
    s_and_b32 s43, s51, 1
    s_lshl_b32 s43, s43, 3
    s_add_u32 s42, s42, s43
    s_add_u32 s42, s42, 147968
    v_add_u32 v27, s42, v3
    v_and_b32 v8, 9344, v21
    v_lshl_add_u32 v8, v11, 4, v8
    s_mul_i32 s42, s50, 18688
    s_add_u32 s42, s42, 74752
    v_add_u32 v8, s42, v8
    s_waitcnt vmcnt(2)
    s_barrier
    ds_read_b64_tr_b16 v[112:113], v4 offset:0
    ds_read_b64_tr_b16 v[114:115], v4 offset:512
    ds_read_b64_tr_b16 v[184:185], v6 offset:0
    ds_read_b64_tr_b16 v[186:187], v6 offset:512
    ds_read_b64_tr_b16 v[116:117], v4 offset:4096
    ds_read_b64_tr_b16 v[118:119], v4 offset:4608
    ds_read_b64_tr_b16 v[188:189], v6 offset:4096
    ds_read_b64_tr_b16 v[190:191], v6 offset:4608
    ds_read_b64_tr_b16 v[120:121], v4 offset:8192
    ds_read_b64_tr_b16 v[122:123], v4 offset:8704
    ds_read_b64_tr_b16 v[192:193], v6 offset:8192
    ds_read_b64_tr_b16 v[194:195], v6 offset:8704
    ds_read_b64_tr_b16 v[124:125], v4 offset:12288
    ds_read_b64_tr_b16 v[126:127], v4 offset:12800
    ds_read_b64_tr_b16 v[196:197], v6 offset:12288
    ds_read_b64_tr_b16 v[198:199], v6 offset:12800
    ds_read_b64_tr_b16 v[128:129], v4 offset:16384
    ds_read_b64_tr_b16 v[130:131], v4 offset:16896
    ds_read_b64_tr_b16 v[200:201], v6 offset:16384
    ds_read_b64_tr_b16 v[202:203], v6 offset:16896
    ds_read_b64_tr_b16 v[132:133], v4 offset:20480
    ds_read_b64_tr_b16 v[134:135], v4 offset:20992
    ds_read_b64_tr_b16 v[204:205], v6 offset:20480
    ds_read_b64_tr_b16 v[206:207], v6 offset:20992
    ds_read_b64_tr_b16 v[136:137], v4 offset:24576
    ds_read_b64_tr_b16 v[138:139], v4 offset:25088
    ds_read_b64_tr_b16 v[208:209], v6 offset:24576
    ds_read_b64_tr_b16 v[210:211], v6 offset:25088
    ds_read_b64_tr_b16 v[140:141], v4 offset:28672
    ds_read_b64_tr_b16 v[142:143], v4 offset:29184
    ds_read_b64_tr_b16 v[212:213], v6 offset:28672
    ds_read_b64_tr_b16 v[214:215], v6 offset:29184
    s_barrier
    s_movk_i32 s55, 5
L_dma4:
    s_mov_b32 m0, s53
    s_add_u32 s42, s53, 73728
    global_load_lds_dwordx4 v1, s[26:27]
    s_mov_b32 m0, s42
    s_add_u32 s53, s53, 4096
    global_load_lds_dwordx4 v1, s[28:29]
    v_add_u32 v1, 294912, v1
    s_waitcnt vmcnt(3)
    s_sub_u32 s55, s55, 1
    s_cmp_lg_u32 s55, 0
    s_cbranch_scc1 L_dma4
    s_mov_b32 s55, 2097152
    v_mov_b32 v23, 0x100
    s_waitcnt vmcnt(2)
    s_barrier
    s_setprio 2
    s_add_u32 m0, s53, 0
    s_nop 0
    global_load_lds_dwordx4 v1, s[26:27]
    ds_read_b64_tr_b16 v[144:145], v4 offset:32768
    ds_read_b64_tr_b16 v[146:147], v4 offset:33280
    ds_read_b64_tr_b16 v[216:217], v6 offset:32768
    s_add_u32 m0, s53, 73728
    s_nop 0
    global_load_lds_dwordx4 v1, s[28:29]
    ds_read_b64_tr_b16 v[218:219], v6 offset:33280
    ds_read_b64_tr_b16 v[148:149], v5 offset:0
    ds_read_b64_tr_b16 v[150:151], v5 offset:512
    v_add_u32 v1, 294912, v1
    s_add_u32 m0, s53, 4096
    s_nop 0
    global_load_lds_dwordx4 v1, s[26:27]
    ds_read_b64_tr_b16 v[220:221], v7 offset:0
    ds_read_b64_tr_b16 v[222:223], v7 offset:512
    ds_read_b64_tr_b16 v[152:153], v5 offset:4096
    s_add_u32 m0, s53, 77824
    s_nop 0
    global_load_lds_dwordx4 v1, s[28:29]
    ds_read_b64_tr_b16 v[154:155], v5 offset:4608
    ds_read_b64_tr_b16 v[224:225], v7 offset:4096
    ds_read_b64_tr_b16 v[226:227], v7 offset:4608
    v_add_u32 v1, 294912, v1
    s_add_u32 m0, s53, 8192
    s_nop 0
    global_load_lds_dwordx4 v1, s[26:27]
    ds_read_b64_tr_b16 v[156:157], v5 offset:8192
    ds_read_b64_tr_b16 v[158:159], v5 offset:8704
    ds_read_b64_tr_b16 v[228:229], v7 offset:8192
    s_add_u32 m0, s53, 81920
    s_nop 0
    global_load_lds_dwordx4 v1, s[28:29]
    ds_read_b64_tr_b16 v[230:231], v7 offset:8704
    ds_read_b64_tr_b16 v[160:161], v5 offset:12288
    ds_read_b64_tr_b16 v[162:163], v5 offset:12800
    v_add_u32 v1, 294912, v1
    s_add_u32 m0, s53, 12288
    s_nop 0
    global_load_lds_dwordx4 v1, s[26:27]
    ds_read_b64_tr_b16 v[232:233], v7 offset:12288
    ds_read_b64_tr_b16 v[234:235], v7 offset:12800
    s_add_u32 m0, s53, 86016
    s_nop 0
    global_load_lds_dwordx4 v1, s[28:29]
    v_add_u32 v1, 294912, v1
    s_barrier
    s_waitcnt vmcnt(0)
    s_mov_b64 exec, 1
    ds_add_u32 v26, v23 offset:36
    s_mov_b64 exec, -1
L_s6:
    ds_read_b32 v24, v26 offset:36
    s_waitcnt lgkmcnt(0)
    v_readfirstlane_b32 s61, v24
    s_nop 0
    s_cmp_eq_u32 s61, 0x80410
    s_cbranch_scc1 L_s6_ok
    s_and_b32 s60, s61, 0xffff
    s_cmp_eq_u32 s60, 0x420
    s_cbranch_scc1 L_s6_ok
    s_sub_u32 s55, s55, 1
    s_cbranch_scc0 L_s6
L_s6_ok:
    ds_read_b128 v[40:43], v19 offset:0
    ds_read_b128 v[44:47], v20 offset:0
    ds_read_b128 v[48:51], v19 offset:1056
    ds_read_b128 v[52:55], v20 offset:1056
    ds_read_b128 v[56:59], v19 offset:2112
    ds_read_b128 v[60:63], v20 offset:2112
    s_waitcnt lgkmcnt(5)
    v_mfma_f32_16x16x32_bf16 v[28:31], v[112:115], v[40:43], 0
    ds_read_b128 v[64:67], v19 offset:3168
    ds_read_b128 v[68:71], v20 offset:3168
    v_mfma_f32_16x16x32_bf16 v[32:35], v[184:187], v[40:43], 0
    ds_read_b128 v[72:75], v19 offset:4224
    s_waitcnt lgkmcnt(6)
    v_mfma_f32_16x16x32_bf16 v[28:31], v[116:119], v[44:47], v[28:31]
    ds_read_b128 v[76:79], v20 offset:4224
    ds_read_b32 v25, v18 offset:448
    v_mfma_f32_16x16x32_bf16 v[32:35], v[188:191], v[44:47], v[32:35]
    ds_read_b32 v13, v18 offset:64
    ds_read_b128 v[80:83], v19 offset:5280
    v_mfma_f32_16x16x32_bf16 v[28:31], v[120:123], v[48:51], v[28:31]
    ds_read_b128 v[84:87], v20 offset:5280
    v_mfma_f32_16x16x32_bf16 v[32:35], v[192:195], v[48:51], v[32:35]
    ds_read_b128 v[88:91], v19 offset:6336
    s_waitcnt lgkmcnt(10)
    v_mfma_f32_16x16x32_bf16 v[28:31], v[124:127], v[52:55], v[28:31]
    ds_read_b128 v[92:95], v20 offset:6336
    ds_read_b64_tr_b16 v[164:165], v5 offset:16384
    v_mfma_f32_16x16x32_bf16 v[32:35], v[196:199], v[52:55], v[32:35]
    ds_read_b64_tr_b16 v[166:167], v5 offset:16896
    ds_read_b128 v[96:99], v19 offset:7392
    v_mfma_f32_16x16x32_bf16 v[28:31], v[128:131], v[56:59], v[28:31]
    v_mfma_f32_16x16x32_bf16 v[32:35], v[200:203], v[56:59], v[32:35]
    s_waitcnt lgkmcnt(11)
    v_mfma_f32_16x16x32_bf16 v[28:31], v[132:135], v[60:63], v[28:31]
    ds_read_b64_tr_b16 v[168:169], v5 offset:20480
    ds_read_b64_tr_b16 v[170:171], v5 offset:20992
    v_mfma_f32_16x16x32_bf16 v[28:31], v[136:139], v[64:67], v[28:31]
    ds_read_b128 v[100:103], v20 offset:7392
    v_mfma_f32_16x16x32_bf16 v[28:31], v[140:143], v[68:71], v[28:31]
    s_waitcnt lgkmcnt(9)
    v_mfma_f32_16x16x32_bf16 v[28:31], v[144:147], v[72:75], v[28:31]
    ds_read_b64_tr_b16 v[172:173], v5 offset:24576
    ds_read_b64_tr_b16 v[174:175], v5 offset:25088
    v_mfma_f32_16x16x32_bf16 v[28:31], v[148:151], v[76:79], v[28:31]
    ds_read_b128 v[104:107], v19 offset:8448
    ds_read_b64_tr_b16 v[176:177], v5 offset:28672
    v_mfma_f32_16x16x32_bf16 v[28:31], v[152:155], v[80:83], v[28:31]
    ds_read_b64_tr_b16 v[178:179], v5 offset:29184
    v_and_b32 v15, 0xffff0000, v25
    s_waitcnt lgkmcnt(9)
    v_mfma_f32_16x16x32_bf16 v[28:31], v[156:159], v[84:87], v[28:31]
    ds_read_b128 v[108:111], v20 offset:8448
    ds_read_b64_tr_b16 v[180:181], v5 offset:32768
    v_mfma_f32_16x16x32_bf16 v[28:31], v[160:163], v[88:91], v[28:31]
    ds_read_b64_tr_b16 v[182:183], v5 offset:33280
    v_rcp_f32 v16, v15
    v_mfma_f32_16x16x32_bf16 v[28:31], v[164:167], v[92:95], v[28:31]
    ds_read_b64_tr_b16 v[236:237], v7 offset:16384
    v_lshlrev_b32 v12, 16, v25
    s_waitcnt lgkmcnt(4)
    v_mfma_f32_16x16x32_bf16 v[28:31], v[168:171], v[96:99], v[28:31]
    ds_read_b64_tr_b16 v[238:239], v7 offset:16896
    v_xor_b32 v25, 0x80000000, v12
    v_mfma_f32_16x16x32_bf16 v[28:31], v[172:175], v[100:103], v[28:31]
    ds_read_b64_tr_b16 v[240:241], v7 offset:20480
    ds_read_b64_tr_b16 v[242:243], v7 offset:20992
    v_mfma_f32_16x16x32_bf16 v[28:31], v[176:179], v[104:107], v[28:31]
    ds_read_b64_tr_b16 v[244:245], v7 offset:24576
    ds_read_b64_tr_b16 v[246:247], v7 offset:25088
    s_waitcnt lgkmcnt(6)
    v_mfma_f32_16x16x32_bf16 v[28:31], v[180:183], v[108:111], v[28:31]
    ds_read_b64_tr_b16 v[248:249], v7 offset:28672
    ds_read_b64_tr_b16 v[250:251], v7 offset:29184
    v_mfma_f32_16x16x32_bf16 v[32:35], v[204:207], v[60:63], v[32:35]
    ds_read_b64_tr_b16 v[252:253], v7 offset:32768
    ds_read_b64_tr_b16 v[254:255], v7 offset:33280
    v_mfma_f32_16x16x32_bf16 v[32:35], v[208:211], v[64:67], v[32:35]
    v_mul_f32 v16, 0x42000000, v16
    v_mul_f32 v9, 0xbfb8aa3b, v16
    v_mfma_f32_16x16x32_bf16 v[32:35], v[212:215], v[68:71], v[32:35]
    v_mul_f32 v10, v16, v16
    v_mfma_f32_16x16x32_bf16 v[32:35], v[216:219], v[72:75], v[32:35]
    v_fmac_f32_dpp v28, v28, v25 row_newbcast:8 row_mask:0xf bank_mask:0xf
    v_fmac_f32_dpp v29, v29, v25 row_newbcast:8 row_mask:0xf bank_mask:0xf
    v_mfma_f32_16x16x32_bf16 v[32:35], v[220:223], v[76:79], v[32:35]
    v_fmac_f32_dpp v30, v30, v25 row_newbcast:8 row_mask:0xf bank_mask:0xf
    v_fmac_f32_dpp v31, v31, v25 row_newbcast:8 row_mask:0xf bank_mask:0xf
    v_mfma_f32_16x16x32_bf16 v[32:35], v[224:227], v[80:83], v[32:35]
    v_mul_f32 v36, v9, v28
    v_mul_f32 v37, v9, v29
    v_mfma_f32_16x16x32_bf16 v[32:35], v[228:231], v[84:87], v[32:35]
    v_mul_f32 v38, v9, v30
    v_mul_f32 v39, v9, v31
    v_mfma_f32_16x16x32_bf16 v[32:35], v[232:235], v[88:91], v[32:35]
    v_exp_f32 v36, v36
    v_exp_f32 v37, v37
    s_waitcnt lgkmcnt(4)
    v_mfma_f32_16x16x32_bf16 v[32:35], v[236:239], v[92:95], v[32:35]
    v_exp_f32 v38, v38
    v_exp_f32 v39, v39
    v_mfma_f32_16x16x32_bf16 v[32:35], v[240:243], v[96:99], v[32:35]
    v_mul_f32 v28, v28, v10
    v_mul_f32 v29, v29, v10
    v_mfma_f32_16x16x32_bf16 v[32:35], v[244:247], v[100:103], v[32:35]
    v_mul_f32 v30, v30, v10
    v_mul_f32 v31, v31, v10
    s_waitcnt lgkmcnt(0)
    v_mfma_f32_16x16x32_bf16 v[32:35], v[248:251], v[104:107], v[32:35]
    v_add_f32 v36, 1.0, v36
    v_add_f32 v37, 1.0, v37
    v_mfma_f32_16x16x32_bf16 v[32:35], v[252:255], v[108:111], v[32:35]
    v_add_f32 v38, 1.0, v38
    v_add_f32 v39, 1.0, v39
    v_rcp_f32 v36, v36
    v_rcp_f32 v37, v37
    v_rcp_f32 v38, v38
    v_rcp_f32 v39, v39
    v_mul_f32 v28, v28, v36
    v_mul_f32 v29, v29, v37
    v_mul_f32 v30, v30, v38
    v_mul_f32 v31, v31, v39
    v_fmac_f32_dpp v32, v32, v25 row_newbcast:8 row_mask:0xf bank_mask:0xf
    v_fmac_f32_dpp v33, v33, v25 row_newbcast:8 row_mask:0xf bank_mask:0xf
    v_fmac_f32_dpp v34, v34, v25 row_newbcast:8 row_mask:0xf bank_mask:0xf
    v_fmac_f32_dpp v35, v35, v25 row_newbcast:8 row_mask:0xf bank_mask:0xf
    v_mul_f32 v28, v28, v32
    v_mul_f32 v29, v29, v33
    v_mul_f32 v30, v30, v34
    v_mul_f32 v31, v31, v35
    v_cvt_pk_bf16_f32 v28, v28, v29
    v_cvt_pk_bf16_f32 v29, v30, v31
    ds_write_b64 v27, v[28:29]
    s_waitcnt lgkmcnt(0)
    s_barrier
    s_cmp_lg_u32 s39, 4
    s_cbranch_scc1 L_gu_end
    v_lshlrev_b32 v36, 5, v13
    v_not_b32 v37, v36
    v_ashrrev_i32 v38, 31, v37
    v_or_b32 v38, 0x80000000, v38
    v_xor_b32 v36, v36, v38
    v_and_b32 v36, 0xffff0000, v36
    v_mul_f32 v36, 0xbfb8aa3b, v36
    v_exp_f32 v36, v36
    v_bfe_u32 v4, v37, 5, 11
    v_mov_b32 v6, v12
    v_mov_b32 v7, v15
    v_add_f32 v36, 1.0, v36
    v_rcp_f32 v5, v36
    v_lshl_or_b32 v4, v4, 8, s45
    s_mov_b64 exec, 0xffff
    global_store_dwordx4 v8, v[4:7], s[36:37] sc1
    s_cmp_lg_u32 s50, 0
    s_cbranch_scc1 L_gu_end
    v_mov_b32 v9, 0
    v_mov_b32 v10, s38
    s_mov_b64 exec, 1
    global_store_dword v9, v10, s[36:37] sc1
L_gu_end:
    s_endpgm
L_end:
    s_endpgm
.fill 96, 4, 0xbf810000
L_last:
.section .rodata,"a"
.p2align 6
.amdhsa_kernel recurrent_scan__ssm_conv_s4__moe_arch_mod__prompt_kernel
  .amdhsa_next_free_vgpr 256
  .amdhsa_next_free_sgpr 102
  .amdhsa_accum_offset 256
  .amdhsa_group_segment_fixed_size 0
  .amdhsa_kernarg_size 136
  .amdhsa_user_sgpr_count 2
  .amdhsa_user_sgpr_kernarg_segment_ptr 1
  .amdhsa_system_sgpr_workgroup_id_x 1
  .amdhsa_float_denorm_mode_32 3
.end_amdhsa_kernel
```
